```python
import torch

def _softmax(x, axis=-1):
    return torch.softmax(x, dim=axis)

def _gelu(x):
    return torch.nn.functional.gelu(x, approximate='tanh')

def _silu(x):
    return torch.nn.functional.silu(x)

def _sigmoid(x):
    return torch.sigmoid(x)

def _layernorm(x, axis=-1, eps=1e-05):
    m = x.mean(dim=axis, keepdim=True)
    v = x.var(dim=axis, keepdim=True, unbiased=False)
    return (x - m) / torch.sqrt(v + eps)

def _scatter_add(tgt, idx, src, axis=0):
    return tgt.clone().index_add_(axis, idx, src)

def _segment_sum(src, seg, n):
    out = torch.zeros((n,) + src.shape[1:], dtype=src.dtype)
    return out.index_add_(0, seg, src)

def _pad(x, pw):
    flat = tuple((v for pair in reversed(pw) for v in pair))
    return torch.nn.functional.pad(x, flat)
kernel_name = 'adaLN_cond__sliding_block_cached__glu_gated_swiglu__decode'

def setup_inputs():

    _w = lambda a: (lambda t: t.to(torch.bfloat16) if t.is_floating_point() else t)(torch.as_tensor(a))

    def _A_setup():
        B, Sq, D = (2, 1, 512)
        Hq, Hkv, Sk, Dh = (32, 32, 16384, 128)
        assert Hq % Hkv == 0, (Hq, Hkv)
        return {'x': _w((lambda *s: torch.randn(*s, dtype=torch.bfloat16) * 0.05)(B, Sq, D)), 'k_cache': _w((lambda *s: torch.randn(*s, dtype=torch.bfloat16) * 3.2)(B, Hkv, Sk, Dh)), 'v_cache': _w((lambda *s: torch.randn(*s, dtype=torch.bfloat16) * 3.2)(B, Hkv, Sk, Dh)), 'wq': _w((lambda *s: torch.randn(*s, dtype=torch.bfloat16) * 3.2)(D, Hq * Dh) * D ** (-0.5)), 'wo': _w((lambda *s: torch.randn(*s, dtype=torch.bfloat16) * 3.2)(Hq * Dh, D) * (Hq * Dh) ** (-0.5))}
    _A_in = _A_setup()

    def _B_setup():
        B, S, D, F = (2, 1, 512, 1376)
        return {'x': _w((lambda *s: torch.randn(*s, dtype=torch.bfloat16) * 0.05)(B, S, D)), 'w1': _w((lambda *s: torch.randn(*s, dtype=torch.bfloat16) * 1.6)(D, F) * (2.0 / D) ** 0.5), 'w3': _w((lambda *s: torch.randn(*s, dtype=torch.bfloat16) * 1.6)(D, F) * (2.0 / D) ** 0.5), 'w2': _w((lambda *s: torch.randn(*s, dtype=torch.bfloat16) * 1.6)(F, D) * (2.0 / F) ** 0.5)}
    _B_in = _B_setup()
    return {'A_x': _A_in['x'], 'A_k_cache': _A_in['k_cache'], 'A_v_cache': _A_in['v_cache'], 'A_wq': _A_in['wq'], 'A_wo': _A_in['wo'], 'B_x': _B_in['x'], 'B_w1': _B_in['w1'], 'B_w3': _B_in['w3'], 'B_w2': _B_in['w2'], 'c': _w((lambda *s: torch.randn(*s, dtype=torch.bfloat16) * 0.2)(2, 512) * 8.0), 'w_mod': _w((lambda *s: torch.randn(*s, dtype=torch.bfloat16) * 0.2)(512, 6 * 512) * 512 ** (-0.5) * 8.0)}

def reference(A_x, A_k_cache, A_v_cache, A_wq, A_wo, B_x, B_w1, B_w3, B_w2, c, w_mod):

    def _A_ref(x, k_cache, v_cache, wq, wo):
        B, Sq, D = x.shape
        Hq, Dh = (32, 128)
        Hkv, Sk = (k_cache.shape[1], k_cache.shape[2])
        W = min(4096, max(256, Sk // 4))
        rep = Hq // Hkv
        q = (lambda x, *d: x.permute(*d))((x @ wq).reshape(B, Sq, Hq, Dh), 0, 2, 1, 3)
        k = (lambda x, n, axis: torch.repeat_interleave(x, n, dim=axis))(k_cache[:, :, Sk - W:, :], rep, axis=1)
        v = (lambda x, n, axis: torch.repeat_interleave(x, n, dim=axis))(v_cache[:, :, Sk - W:, :], rep, axis=1)
        scores = torch.einsum('bhqd,bhkd->bhqk', q, k) * Dh ** (-0.5)
        p = _softmax(scores, axis=-1)
        o = torch.einsum('bhqk,bhkd->bhqd', p, v)
        return (lambda x, *d: x.permute(*d))(o, 0, 2, 1, 3).reshape(B, Sq, Hq * Dh) @ wo

    def _B_ref(x, w1, w3, w2):
        gate = torch.einsum('bsd,df->bsf', x, w1)
        up = torch.einsum('bsd,df->bsf', x, w3)
        h = _silu(gate) * up
        out = torch.einsum('bsf,fd->bsd', h, w2)
        return out
    x = A_x
    mod = (_silu(c) @ w_mod).reshape(c.shape[0], 6, 1, -1)
    sa, ca, ga, sb, cb, gb = (mod[:, 0].clone(), mod[:, 1].clone(), mod[:, 2].clone(), mod[:, 3].clone(), mod[:, 4].clone(), mod[:, 5].clone())
    h = _layernorm(x, axis=-1) * (1 + ca) + sa
    x = x + ga * _A_ref(h, A_k_cache, A_v_cache, A_wq, A_wo)
    h = _layernorm(x, axis=-1) * (1 + cb) + sb
    x = x + gb * _B_ref(h, B_w1, B_w3, B_w2)
    return x
```

```asm
; @launch grid=(256,1,1) block=(768,1,1) lds=98304
.amdgcn_target "amdgcn-amd-amdhsa--gfx950"
.text
.globl adaLN_cond__sliding_block_cached__glu_gated_swiglu__decode_kernel
.p2align 8
.type adaLN_cond__sliding_block_cached__glu_gated_swiglu__decode_kernel,@function
adaLN_cond__sliding_block_cached__glu_gated_swiglu__decode_kernel:
  s_cmp_ge_u32 s2, 256
  s_cbranch_scc1 L_end
  s_load_dwordx16 s[16:31], s[0:1], 0
  s_load_dwordx8 s[32:39], s[0:1], 64
  s_load_dwordx4 s[40:43], s[0:1], 96
  s_getpc_b64 s[56:57]
L_pc:
  s_lshl_b32 s3, s2, 2
  s_add_u32 s3, s3, L_table-L_pc
  s_sub_u32 s61, s2, 128
  s_cmp_lt_u32 s61, 16
  s_cselect_b32 s13, 1, 0
  s_cmp_lt_u32 s2, 64
  s_cselect_b32 s13, 2, s13
  v_lshrrev_b32 v2, 6, v0
  v_and_b32 v1, 63, v0
  v_readfirstlane_b32 s5, v2
  s_bfe_u32 s7, s2, 0x20003
  s_bfe_u32 s6, s2, 0x20005
  s_and_b32 s8, s2, 7
  s_lshl_b32 s9, s8, 2
  s_add_u32 s6, s6, s9
  s_lshr_b32 s9, s2, 7
  s_lshl_b32 s9, s9, 5
  s_add_u32 s6, s6, s9
  s_mov_b32 s72, 0xfffffffe
  s_mov_b32 s73, 0xffff0000
  s_cmp_lt_u32 s5, 4
  s_cbranch_scc1 L_helper
  s_sub_u32 s9, s5, 4
  s_lshl_b32 s10, s6, 22
  s_lshl_b32 s11, s7, 18
  s_add_u32 s10, s10, s11
  s_add_u32 s10, s10, 0x300000
  s_lshl_b32 s11, s9, 10
  v_lshlrev_b32 v2, 4, v1
  v_add_u32 v2, s11, v2
  s_lshr_b32 s12, s2, 3
  s_mul_i32 s12, s12, 5
  s_mul_i32 s15, s8, 3
  s_add_u32 s12, s12, s15
  s_lshl_b32 s12, s12, 13
  s_and_b32 s12, s12, 0x3ffff
  s_waitcnt lgkmcnt(0)
  s_add_u32 s44, s18, s10
  s_addc_u32 s45, s19, 0
  s_mov_b32 s46, 0x40000
  s_mov_b32 s47, 0x20000
  s_add_u32 s48, s20, s10
  s_addc_u32 s49, s21, 0
  s_mov_b32 s50, 0x40000
  s_mov_b32 s51, 0x20000
  s_cmp_eq_u32 s13, 0
  s_cbranch_scc1 L_nb1
  s_barrier
L_nb1:
  buffer_load_dwordx4 v[40:43], v2, s[44:47], s12 offen nt
  s_add_u32 s12, s12, 0x2000
  s_and_b32 s12, s12, 0x3ffff
  buffer_load_dwordx4 v[44:47], v2, s[44:47], s12 offen nt
  s_add_u32 s12, s12, 0x2000
  s_and_b32 s12, s12, 0x3ffff
  buffer_load_dwordx4 v[48:51], v2, s[44:47], s12 offen nt
  s_add_u32 s12, s12, 0x2000
  s_and_b32 s12, s12, 0x3ffff
  buffer_load_dwordx4 v[52:55], v2, s[44:47], s12 offen nt
  s_add_u32 s12, s12, 0x2000
  s_and_b32 s12, s12, 0x3ffff
  s_load_dword s14, s[56:57], s3
  s_cmp_eq_u32 s13, 0
  s_cbranch_scc0 L_nb2
  s_barrier
L_nb2:
  s_waitcnt lgkmcnt(0)
  s_bfe_u32 s14, s14, 0x80010
  s_mov_b32 s52, 0xcccccccc
  s_mov_b32 s53, 0xcccccccc
  s_mov_b32 s54, 0xaaaaaaaa
  s_mov_b32 s55, 0xaaaaaaaa
  v_and_b32 v3, 15, v1
  v_lshlrev_b32 v3, 4, v3
  v_mov_b32 v38, v3
  s_lshl_b32 s15, s9, 11
  s_add_u32 s15, s15, 81920
  v_lshl_add_u32 v3, v1, 3, s15
  v_mov_b32 v4, 0x7fff0000
  v_mov_b32 v5, 0xff800000
  ds_write_b64 v3, v[4:5] offset:0
  ds_write_b64 v3, v[4:5] offset:512
  ds_write_b64 v3, v[4:5] offset:1024
  v_lshrrev_b32 v3, 4, v1
  v_lshl_add_u32 v39, v38, 1, s15
  v_lshl_add_u32 v39, v3, 3, v39
  s_sub_u32 s61, s12, 32768
  v_bfrev_b32 v24, v1
  v_lshrrev_b32 v24, 15, v24
  v_and_b32 v24, 0x1e000, v24
  v_add_u32 v24, s61, v24
  v_and_b32 v24, 0x3e000, v24
  v_lshl_add_u32 v24, v3, 8, v24
  s_lshl_b32 s11, s9, 10
  v_add_u32 v24, s11, v24
  v_xor_b32 v26, 0x20000, v24
  s_lshl_b32 s11, s9, 9
  s_mov_b32 s58, 0
  s_mov_b32 s60, 0
  s_waitcnt vmcnt(3)
  s_cmp_le_u32 s14, 4
  s_cbranch_scc1 L_th_1
  s_waitcnt vmcnt(1)
L_th_1:
  buffer_load_dwordx4 v[56:59], v2, s[44:47], s12 offen nt
  s_add_u32 s12, s12, 0x2000
  s_and_b32 s12, s12, 0x3ffff
  s_waitcnt vmcnt(2)
  s_cmp_le_u32 s14, 5
  s_cbranch_scc1 L_th_2
  s_waitcnt vmcnt(1)
L_th_2:
  buffer_load_dwordx4 v[60:63], v2, s[44:47], s12 offen nt
  s_add_u32 s12, s12, 0x2000
  s_and_b32 s12, s12, 0x3ffff
  s_waitcnt vmcnt(3)
  s_cmp_le_u32 s14, 6
  s_cbranch_scc1 L_th_3
  s_waitcnt vmcnt(1)
L_th_3:
  buffer_load_dwordx4 v[64:67], v2, s[44:47], s12 offen nt
  s_add_u32 s12, s12, 0x2000
  s_and_b32 s12, s12, 0x3ffff
  s_waitcnt vmcnt(2)
  s_cmp_le_u32 s14, 7
  s_cbranch_scc1 L_th_4
  s_waitcnt vmcnt(1)
L_th_4:
  buffer_load_dwordx4 v[68:71], v2, s[44:47], s12 offen nt
  s_add_u32 s12, s12, 0x2000
  s_and_b32 s12, s12, 0x3ffff
  s_waitcnt vmcnt(3)
  s_cmp_le_u32 s14, 8
  s_cbranch_scc1 L_th_5
  s_waitcnt vmcnt(1)
L_th_5:
  buffer_load_dwordx4 v[72:75], v2, s[44:47], s12 offen nt
  s_add_u32 s12, s12, 0x2000
  s_and_b32 s12, s12, 0x3ffff
  s_waitcnt vmcnt(2)
  s_cmp_le_u32 s14, 9
  s_cbranch_scc1 L_th_6
  s_waitcnt vmcnt(1)
L_th_6:
  buffer_load_dwordx4 v[76:79], v2, s[44:47], s12 offen nt
  s_add_u32 s12, s12, 0x2000
  s_and_b32 s12, s12, 0x3ffff
  s_waitcnt vmcnt(3)
  s_cmp_le_u32 s14, 10
  s_cbranch_scc1 L_th_7
  s_waitcnt vmcnt(1)
L_th_7:
  buffer_load_dwordx4 v[80:83], v2, s[44:47], s12 offen nt
  s_add_u32 s12, s12, 0x2000
  s_and_b32 s12, s12, 0x3ffff
  s_waitcnt vmcnt(2)
  s_cmp_le_u32 s14, 11
  s_cbranch_scc1 L_th_8
  s_waitcnt vmcnt(1)
L_th_8:
  buffer_load_dwordx4 v[84:87], v2, s[44:47], s12 offen nt
  s_add_u32 s12, s12, 0x2000
  s_and_b32 s12, s12, 0x3ffff
  s_waitcnt vmcnt(3)
  s_cmp_le_u32 s14, 12
  s_cbranch_scc1 L_th_9
  s_waitcnt vmcnt(1)
L_th_9:
  buffer_load_dwordx4 v[88:91], v2, s[44:47], s12 offen nt
  s_add_u32 s12, s12, 0x2000
  s_and_b32 s12, s12, 0x3ffff
  s_waitcnt vmcnt(2)
  s_cmp_le_u32 s14, 13
  s_cbranch_scc1 L_th_10
  s_waitcnt vmcnt(1)
L_th_10:
  buffer_load_dwordx4 v[92:95], v2, s[44:47], s12 offen nt
  s_add_u32 s12, s12, 0x2000
  s_and_b32 s12, s12, 0x3ffff
  s_waitcnt vmcnt(3)
  s_cmp_le_u32 s14, 14
  s_cbranch_scc1 L_th_11
  s_waitcnt vmcnt(1)
L_th_11:
  buffer_load_dwordx4 v[96:99], v2, s[44:47], s12 offen nt
  s_add_u32 s12, s12, 0x2000
  s_and_b32 s12, s12, 0x3ffff
  v_mov_b32 v4, 0
  ds_write_b32 v4, v4 offset:6664
  s_waitcnt vmcnt(2)
  s_cmp_le_u32 s14, 15
  s_cbranch_scc1 L_th_12
  s_waitcnt vmcnt(1)
L_th_12:
  buffer_load_dwordx4 v[100:103], v2, s[44:47], s12 offen nt
  s_add_u32 s12, s12, 0x2000
  s_and_b32 s12, s12, 0x3ffff
  s_waitcnt vmcnt(3)
  s_cmp_le_u32 s14, 16
  s_cbranch_scc1 L_th_13
  s_waitcnt vmcnt(1)
L_th_13:
  buffer_load_dwordx4 v[104:107], v2, s[44:47], s12 offen nt
  s_add_u32 s12, s12, 0x2000
  s_and_b32 s12, s12, 0x3ffff
  s_waitcnt vmcnt(2)
  s_cmp_le_u32 s14, 17
  s_cbranch_scc1 L_th_14
  s_waitcnt vmcnt(1)
L_th_14:
  buffer_load_dwordx4 v[108:111], v2, s[44:47], s12 offen nt
  s_add_u32 s12, s12, 0x2000
  s_and_b32 s12, s12, 0x3ffff
  s_waitcnt vmcnt(3)
  s_cmp_le_u32 s14, 18
  s_cbranch_scc1 L_th_15
  s_waitcnt vmcnt(1)
L_th_15:
  buffer_load_dwordx4 v[112:115], v2, s[44:47], s12 offen nt
  s_add_u32 s12, s12, 0x2000
  s_and_b32 s12, s12, 0x3ffff
  s_waitcnt vmcnt(2)
  s_cmp_le_u32 s14, 19
  s_cbranch_scc1 L_th_16
  s_waitcnt vmcnt(1)
L_th_16:
  buffer_load_dwordx4 v[116:119], v2, s[44:47], s12 offen nt
  s_add_u32 s12, s12, 0x2000
  s_and_b32 s12, s12, 0x3ffff
  s_cmp_lg_u32 s58, 0
  s_cbranch_scc1 L_qd_18
  ds_read_b128 v[4:7], v38 offset:6400
L_qd_18:
  s_waitcnt vmcnt(3)
  s_cmp_le_u32 s14, 20
  s_cbranch_scc1 L_th_19
  s_waitcnt vmcnt(1)
L_th_19:
  buffer_load_dwordx4 v[120:123], v2, s[44:47], s12 offen nt
  s_add_u32 s12, s12, 0x2000
  s_and_b32 s12, s12, 0x3ffff
  s_cmp_lg_u32 s58, 0
  s_cbranch_scc1 L_qc_17
  s_waitcnt lgkmcnt(0)
  v_max3_u32 v8, v4, v5, v6
  v_max_u32 v8, v8, v7
  v_cmp_eq_u32 vcc, -1, v8
  s_cmp_lg_u64 vcc, 0
  s_cbranch_scc1 L_qc_17
  s_call_b64 s[62:63], L_sc0
L_qc_17:
  s_waitcnt vmcnt(2)
  buffer_load_dwordx4 v[124:127], v2, s[44:47], s12 offen nt
  s_add_u32 s12, s12, 0x2000
  s_and_b32 s12, s12, 0x3ffff
  s_waitcnt vmcnt(3)
  buffer_load_dwordx4 v[128:131], v2, s[44:47], s12 offen nt
  s_add_u32 s12, s12, 0x2000
  s_and_b32 s12, s12, 0x3ffff
  s_cmp_lg_u32 s58, 0
  s_cbranch_scc1 L_qd_21
  ds_read_b128 v[4:7], v38 offset:6400
L_qd_21:
  s_waitcnt vmcnt(2)
  buffer_load_dwordx4 v[132:135], v2, s[44:47], s12 offen nt
  s_add_u32 s12, s12, 0x2000
  s_and_b32 s12, s12, 0x3ffff
  s_cmp_lg_u32 s58, 0
  s_cbranch_scc1 L_qc_20
  s_waitcnt lgkmcnt(0)
  v_max3_u32 v8, v4, v5, v6
  v_max_u32 v8, v8, v7
  v_cmp_eq_u32 vcc, -1, v8
  s_cmp_lg_u64 vcc, 0
  s_cbranch_scc1 L_qc_20
  s_call_b64 s[62:63], L_sc0
L_qc_20:
  s_waitcnt vmcnt(3)
  buffer_load_dwordx4 v[136:139], v2, s[44:47], s12 offen nt
  s_add_u32 s12, s12, 0x2000
  s_and_b32 s12, s12, 0x3ffff
  s_waitcnt vmcnt(2)
  buffer_load_dwordx4 v[140:143], v2, s[44:47], s12 offen nt
  s_add_u32 s12, s12, 0x2000
  s_and_b32 s12, s12, 0x3ffff
  s_cmp_lg_u32 s58, 0
  s_cbranch_scc1 L_qd_23
  ds_read_b128 v[4:7], v38 offset:6400
L_qd_23:
  s_waitcnt vmcnt(3)
  buffer_load_dwordx4 v[144:147], v2, s[44:47], s12 offen nt
  s_add_u32 s12, s12, 0x2000
  s_and_b32 s12, s12, 0x3ffff
  s_cmp_lg_u32 s58, 0
  s_cbranch_scc1 L_qc_22
  s_waitcnt lgkmcnt(0)
  v_max3_u32 v8, v4, v5, v6
  v_max_u32 v8, v8, v7
  v_cmp_eq_u32 vcc, -1, v8
  s_cmp_lg_u64 vcc, 0
  s_cbranch_scc1 L_qc_22
  s_call_b64 s[62:63], L_sc0
L_qc_22:
  s_waitcnt vmcnt(2)
  buffer_load_dwordx4 v[148:151], v2, s[44:47], s12 offen nt
  s_add_u32 s12, s12, 0x2000
  s_and_b32 s12, s12, 0x3ffff
  s_waitcnt vmcnt(3)
  buffer_load_dwordx4 v[152:155], v2, s[44:47], s12 offen nt
  s_add_u32 s12, s12, 0x2000
  s_and_b32 s12, s12, 0x3ffff
  s_cmp_lg_u32 s58, 0
  s_cbranch_scc1 L_qd_25
  ds_read_b128 v[4:7], v38 offset:6400
L_qd_25:
  s_waitcnt vmcnt(2)
  buffer_load_dwordx4 v[156:159], v2, s[44:47], s12 offen nt
  s_add_u32 s12, s12, 0x2000
  s_and_b32 s12, s12, 0x3ffff
  s_cmp_lg_u32 s58, 0
  s_cbranch_scc1 L_qc_24
  s_waitcnt lgkmcnt(0)
  v_max3_u32 v8, v4, v5, v6
  v_max_u32 v8, v8, v7
  v_cmp_eq_u32 vcc, -1, v8
  s_cmp_lg_u64 vcc, 0
  s_cbranch_scc1 L_qc_24
  s_call_b64 s[62:63], L_sc0
L_qc_24:
  s_waitcnt vmcnt(3)
  buffer_load_dwordx4 v[160:163], v2, s[44:47], s12 offen nt
  s_add_u32 s12, s12, 0x2000
  s_and_b32 s12, s12, 0x3ffff
  s_waitcnt vmcnt(2)
  buffer_load_dwordx4 v[164:167], v2, s[44:47], s12 offen nt
  s_add_u32 s12, s12, 0x2000
  s_and_b32 s12, s12, 0x3ffff
  s_cmp_lg_u32 s58, 0
  s_cbranch_scc1 L_v0
  s_mov_b32 s70, 0
L_pl_26:
  ds_read_b128 v[4:7], v38 offset:6400
  s_waitcnt lgkmcnt(0)
  v_max3_u32 v8, v4, v5, v6
  v_max_u32 v8, v8, v7
  v_cmp_eq_u32 vcc, -1, v8
  s_cmp_eq_u64 vcc, 0
  s_cbranch_scc1 L_pld_27
  s_sleep 2
  s_add_u32 s70, s70, 1
  s_cmp_lt_u32 s70, 1048576
  s_cbranch_scc1 L_pl_26
L_pld_27:
  s_call_b64 s[62:63], L_sc0
L_v0:
  v_add_u32_dpp v3, v28, v38 row_newbcast:0 row_mask:0xf bank_mask:0xf
  s_waitcnt vmcnt(3)
  buffer_load_dwordx4 v[40:43], v3, s[48:51], 0 offen nt
  v_dot2_f32_bf16 v8, v104, v4, 0
  v_dot2_f32_bf16 v9, v108, v4, 0
  v_dot2_f32_bf16 v10, v112, v4, 0
  v_dot2_f32_bf16 v11, v116, v4, 0
  v_dot2_f32_bf16 v12, v120, v4, 0
  v_dot2_f32_bf16 v13, v124, v4, 0
  v_dot2_f32_bf16 v14, v128, v4, 0
  v_dot2_f32_bf16 v15, v132, v4, 0
  v_dot2_f32_bf16 v8, v105, v5, v8
  v_dot2_f32_bf16 v9, v109, v5, v9
  v_dot2_f32_bf16 v10, v113, v5, v10
  v_dot2_f32_bf16 v11, v117, v5, v11
  v_dot2_f32_bf16 v12, v121, v5, v12
  v_dot2_f32_bf16 v13, v125, v5, v13
  v_dot2_f32_bf16 v14, v129, v5, v14
  v_dot2_f32_bf16 v15, v133, v5, v15
  v_dot2_f32_bf16 v8, v106, v6, v8
  v_dot2_f32_bf16 v9, v110, v6, v9
  v_dot2_f32_bf16 v10, v114, v6, v10
  v_dot2_f32_bf16 v11, v118, v6, v11
  v_dot2_f32_bf16 v12, v122, v6, v12
  v_dot2_f32_bf16 v13, v126, v6, v13
  v_dot2_f32_bf16 v14, v130, v6, v14
  v_dot2_f32_bf16 v15, v134, v6, v15
  v_dot2_f32_bf16 v8, v107, v7, v8
  v_dot2_f32_bf16 v9, v111, v7, v9
  v_dot2_f32_bf16 v10, v115, v7, v10
  v_dot2_f32_bf16 v11, v119, v7, v11
  v_dot2_f32_bf16 v12, v123, v7, v12
  v_dot2_f32_bf16 v13, v127, v7, v13
  v_dot2_f32_bf16 v14, v131, v7, v14
  v_dot2_f32_bf16 v15, v135, v7, v15
  s_nop 0
  v_add_f32_dpp v8, v8, v8 row_ror:8 row_mask:0xf bank_mask:0x3
  v_add_f32_dpp v8, v9, v9 row_ror:8 row_mask:0xf bank_mask:0xc
  v_add_f32_dpp v10, v10, v10 row_ror:8 row_mask:0xf bank_mask:0x3
  v_add_f32_dpp v10, v11, v11 row_ror:8 row_mask:0xf bank_mask:0xc
  v_add_f32_dpp v12, v12, v12 row_ror:8 row_mask:0xf bank_mask:0x3
  v_add_f32_dpp v12, v13, v13 row_ror:8 row_mask:0xf bank_mask:0xc
  v_add_f32_dpp v14, v14, v14 row_ror:8 row_mask:0xf bank_mask:0x3
  v_add_f32_dpp v14, v15, v15 row_ror:8 row_mask:0xf bank_mask:0xc
  v_add_f32_dpp v16, v8, v8 row_shl:4 row_mask:0xf bank_mask:0x5
  v_add_f32_dpp v16, v10, v10 row_shr:4 row_mask:0xf bank_mask:0xa
  v_add_f32_dpp v17, v12, v12 row_shl:4 row_mask:0xf bank_mask:0x5
  v_add_f32_dpp v17, v14, v14 row_shr:4 row_mask:0xf bank_mask:0xa
  v_add_u32_dpp v3, v28, v38 row_newbcast:1 row_mask:0xf bank_mask:0xf
  s_waitcnt vmcnt(3)
  buffer_load_dwordx4 v[44:47], v3, s[48:51], 0 offen nt
  v_add_u32_dpp v3, v28, v38 row_newbcast:2 row_mask:0xf bank_mask:0xf
  s_waitcnt vmcnt(3)
  buffer_load_dwordx4 v[48:51], v3, s[48:51], 0 offen nt
  v_add_u32_dpp v3, v28, v38 row_newbcast:3 row_mask:0xf bank_mask:0xf
  s_waitcnt vmcnt(3)
  buffer_load_dwordx4 v[52:55], v3, s[48:51], 0 offen nt
  v_dot2_f32_bf16 v8, v136, v4, 0
  v_dot2_f32_bf16 v9, v140, v4, 0
  v_dot2_f32_bf16 v10, v144, v4, 0
  v_dot2_f32_bf16 v11, v148, v4, 0
  v_dot2_f32_bf16 v12, v152, v4, 0
  v_dot2_f32_bf16 v13, v156, v4, 0
  v_dot2_f32_bf16 v14, v160, v4, 0
  v_dot2_f32_bf16 v15, v164, v4, 0
  v_dot2_f32_bf16 v8, v137, v5, v8
  v_dot2_f32_bf16 v9, v141, v5, v9
  v_dot2_f32_bf16 v10, v145, v5, v10
  v_dot2_f32_bf16 v11, v149, v5, v11
  v_dot2_f32_bf16 v12, v153, v5, v12
  v_dot2_f32_bf16 v13, v157, v5, v13
  v_dot2_f32_bf16 v14, v161, v5, v14
  v_dot2_f32_bf16 v15, v165, v5, v15
  v_dot2_f32_bf16 v8, v138, v6, v8
  v_dot2_f32_bf16 v9, v142, v6, v9
  v_dot2_f32_bf16 v10, v146, v6, v10
  v_dot2_f32_bf16 v11, v150, v6, v11
  v_dot2_f32_bf16 v12, v154, v6, v12
  v_dot2_f32_bf16 v13, v158, v6, v13
  v_dot2_f32_bf16 v14, v162, v6, v14
  v_dot2_f32_bf16 v15, v166, v6, v15
  v_dot2_f32_bf16 v8, v139, v7, v8
  v_dot2_f32_bf16 v9, v143, v7, v9
  v_dot2_f32_bf16 v10, v147, v7, v10
  v_dot2_f32_bf16 v11, v151, v7, v11
  v_dot2_f32_bf16 v12, v155, v7, v12
  v_dot2_f32_bf16 v13, v159, v7, v13
  v_dot2_f32_bf16 v14, v163, v7, v14
  v_dot2_f32_bf16 v15, v167, v7, v15
  s_nop 0
  v_add_f32_dpp v8, v8, v8 row_ror:8 row_mask:0xf bank_mask:0x3
  v_add_f32_dpp v8, v9, v9 row_ror:8 row_mask:0xf bank_mask:0xc
  v_add_f32_dpp v10, v10, v10 row_ror:8 row_mask:0xf bank_mask:0x3
  v_add_f32_dpp v10, v11, v11 row_ror:8 row_mask:0xf bank_mask:0xc
  v_add_f32_dpp v12, v12, v12 row_ror:8 row_mask:0xf bank_mask:0x3
  v_add_f32_dpp v12, v13, v13 row_ror:8 row_mask:0xf bank_mask:0xc
  v_add_f32_dpp v14, v14, v14 row_ror:8 row_mask:0xf bank_mask:0x3
  v_add_f32_dpp v14, v15, v15 row_ror:8 row_mask:0xf bank_mask:0xc
  v_add_f32_dpp v18, v8, v8 row_shl:4 row_mask:0xf bank_mask:0x5
  v_add_f32_dpp v18, v10, v10 row_shr:4 row_mask:0xf bank_mask:0xa
  v_add_f32_dpp v19, v12, v12 row_shl:4 row_mask:0xf bank_mask:0x5
  v_add_f32_dpp v19, v14, v14 row_shr:4 row_mask:0xf bank_mask:0xa
  s_nop 1
  v_add_f32_dpp v16, v16, v16 quad_perm:[2,3,0,1] row_mask:0xf bank_mask:0xf
  v_add_f32_dpp v17, v17, v17 quad_perm:[2,3,0,1] row_mask:0xf bank_mask:0xf
  v_add_f32_dpp v18, v18, v18 quad_perm:[2,3,0,1] row_mask:0xf bank_mask:0xf
  v_add_f32_dpp v19, v19, v19 quad_perm:[2,3,0,1] row_mask:0xf bank_mask:0xf
  v_cndmask_b32 v8, v16, v17, s[52:53]
  v_cndmask_b32 v9, v18, v19, s[52:53]
  v_mov_b32 v3, 0
  v_lshlrev_b32 v21, 3, s9
  v_add_f32_dpp v8, v8, v8 quad_perm:[1,0,3,2] row_mask:0xf bank_mask:0xf
  v_add_f32_dpp v9, v9, v9 quad_perm:[1,0,3,2] row_mask:0xf bank_mask:0xf
  v_cndmask_b32 v27, v8, v9, s[54:55]
  v_cvt_pk_bf16_f32 v27, 0, v27
  v_mul_f32 v27, 0x3db504f3, v27
  v_cvt_pk_bf16_f32 v27, 0, v27
  ds_max_f32 v21, v27 offset:6912
  ds_read_b32 v37, v21 offset:6912
  s_waitcnt lgkmcnt(0)
  v_sub_f32 v16, v25, v37
  v_sub_f32 v17, v27, v37
  s_mov_b64 exec, 1
  ds_max_f32 v3, v37 offset:6676
  s_mov_b64 exec, -1
  v_mul_f32 v16, 0x3fb8aa3b, v16
  v_mul_f32 v17, 0x3fb8aa3b, v17
  v_exp_f32 v16, v16
  v_exp_f32 v17, v17
  v_mov_b32 v20, 1
  v_add_f32 v16, v16, v17
  ds_add_f32 v21, v16 offset:6916
  ds_add_u32 v3, v20 offset:6672
  v_add_f32 v21, 0xc2640000, v37
  v_cmp_nlt_f32 vcc, v27, v21
  s_lshl_b32 s68, s58, 3
  s_add_u32 s68, s68, s15
  s_mov_b64 s[66:67], vcc
  v_mbcnt_lo_u32_b32 v3, s66, 0
  v_mbcnt_hi_u32_b32 v3, s67, v3
  s_bcnt1_i32_b64 s69, s[66:67]
  v_lshl_add_u32 v3, v3, 3, s68
  s_mov_b64 exec, s[66:67]
  ds_write_b64 v3, v[26:27]
  s_mov_b64 exec, -1
  s_add_u32 s58, s58, s69
  v_mov_b32 v8, 0
  v_mov_b32 v9, 0
  v_mov_b32 v10, 0
  v_mov_b32 v11, 0
  v_mov_b32 v12, 0
  v_mov_b32 v13, 0
  v_mov_b32 v14, 0
  v_mov_b32 v15, 0
  s_lshr_b32 s59, s58, 2
  ds_read_b64 v[28:29], v39 offset:0
  ds_read_b64 v[30:31], v39 offset:512
  ds_read_b64 v[32:33], v39 offset:1024
  s_waitcnt lgkmcnt(0)
  v_sub_f32 v29, v29, v37
  v_sub_f32 v31, v31, v37
  v_sub_f32 v33, v33, v37
  v_mul_f32 v29, 0x3fb8aa3b, v29
  v_mul_f32 v31, 0x3fb8aa3b, v31
  v_mul_f32 v33, 0x3fb8aa3b, v33
  v_exp_f32 v29, v29
  v_exp_f32 v31, v31
  v_exp_f32 v33, v33
  s_nop 0
  v_cvt_pk_bf16_f32 v34, 0, v29
  v_cvt_pk_bf16_f32 v35, 0, v31
  v_cvt_pk_bf16_f32 v36, 0, v33
  v_cvt_pk_bf16_f32 v29, v29, 0
  v_cvt_pk_bf16_f32 v31, v31, 0
  v_cvt_pk_bf16_f32 v33, v33, 0
  s_nop 1
  s_cmp_lg_u32 s59, 4
  s_cbranch_scc1 L_vs_28
  s_call_b64 s[62:63], L_hand
L_vs_28:
  v_add_u32_dpp v3, v28, v38 row_newbcast:4 row_mask:0xf bank_mask:0xf
  s_waitcnt vmcnt(3)
  buffer_load_dwordx4 v[56:59], v3, s[48:51], 0 offen nt
  v_dot2c_f32_bf16_dpp v8, v29, v40 row_newbcast:0 row_mask:0xf bank_mask:0xf
  v_dot2c_f32_bf16_dpp v9, v34, v40 row_newbcast:0 row_mask:0xf bank_mask:0xf
  v_dot2c_f32_bf16_dpp v10, v29, v41 row_newbcast:0 row_mask:0xf bank_mask:0xf
  v_dot2c_f32_bf16_dpp v11, v34, v41 row_newbcast:0 row_mask:0xf bank_mask:0xf
  v_dot2c_f32_bf16_dpp v12, v29, v42 row_newbcast:0 row_mask:0xf bank_mask:0xf
  v_dot2c_f32_bf16_dpp v13, v34, v42 row_newbcast:0 row_mask:0xf bank_mask:0xf
  v_dot2c_f32_bf16_dpp v14, v29, v43 row_newbcast:0 row_mask:0xf bank_mask:0xf
  v_dot2c_f32_bf16_dpp v15, v34, v43 row_newbcast:0 row_mask:0xf bank_mask:0xf
  s_cmp_lg_u32 s59, 5
  s_cbranch_scc1 L_vs_29
  s_call_b64 s[62:63], L_hand
L_vs_29:
  v_add_u32_dpp v3, v28, v38 row_newbcast:5 row_mask:0xf bank_mask:0xf
  s_waitcnt vmcnt(3)
  buffer_load_dwordx4 v[60:63], v3, s[48:51], 0 offen nt
  v_dot2c_f32_bf16_dpp v8, v29, v44 row_newbcast:1 row_mask:0xf bank_mask:0xf
  v_dot2c_f32_bf16_dpp v9, v34, v44 row_newbcast:1 row_mask:0xf bank_mask:0xf
  v_dot2c_f32_bf16_dpp v10, v29, v45 row_newbcast:1 row_mask:0xf bank_mask:0xf
  v_dot2c_f32_bf16_dpp v11, v34, v45 row_newbcast:1 row_mask:0xf bank_mask:0xf
  v_dot2c_f32_bf16_dpp v12, v29, v46 row_newbcast:1 row_mask:0xf bank_mask:0xf
  v_dot2c_f32_bf16_dpp v13, v34, v46 row_newbcast:1 row_mask:0xf bank_mask:0xf
  v_dot2c_f32_bf16_dpp v14, v29, v47 row_newbcast:1 row_mask:0xf bank_mask:0xf
  v_dot2c_f32_bf16_dpp v15, v34, v47 row_newbcast:1 row_mask:0xf bank_mask:0xf
  s_cmp_lg_u32 s59, 6
  s_cbranch_scc1 L_vs_30
  s_call_b64 s[62:63], L_hand
L_vs_30:
  v_add_u32_dpp v3, v28, v38 row_newbcast:6 row_mask:0xf bank_mask:0xf
  s_waitcnt vmcnt(3)
  buffer_load_dwordx4 v[64:67], v3, s[48:51], 0 offen nt
  v_dot2c_f32_bf16_dpp v8, v29, v48 row_newbcast:2 row_mask:0xf bank_mask:0xf
  v_dot2c_f32_bf16_dpp v9, v34, v48 row_newbcast:2 row_mask:0xf bank_mask:0xf
  v_dot2c_f32_bf16_dpp v10, v29, v49 row_newbcast:2 row_mask:0xf bank_mask:0xf
  v_dot2c_f32_bf16_dpp v11, v34, v49 row_newbcast:2 row_mask:0xf bank_mask:0xf
  v_dot2c_f32_bf16_dpp v12, v29, v50 row_newbcast:2 row_mask:0xf bank_mask:0xf
  v_dot2c_f32_bf16_dpp v13, v34, v50 row_newbcast:2 row_mask:0xf bank_mask:0xf
  v_dot2c_f32_bf16_dpp v14, v29, v51 row_newbcast:2 row_mask:0xf bank_mask:0xf
  v_dot2c_f32_bf16_dpp v15, v34, v51 row_newbcast:2 row_mask:0xf bank_mask:0xf
  s_cmp_lg_u32 s59, 7
  s_cbranch_scc1 L_vs_31
  s_call_b64 s[62:63], L_hand
L_vs_31:
  v_add_u32_dpp v3, v28, v38 row_newbcast:7 row_mask:0xf bank_mask:0xf
  s_waitcnt vmcnt(3)
  buffer_load_dwordx4 v[68:71], v3, s[48:51], 0 offen nt
  v_dot2c_f32_bf16_dpp v8, v29, v52 row_newbcast:3 row_mask:0xf bank_mask:0xf
  v_dot2c_f32_bf16_dpp v9, v34, v52 row_newbcast:3 row_mask:0xf bank_mask:0xf
  v_dot2c_f32_bf16_dpp v10, v29, v53 row_newbcast:3 row_mask:0xf bank_mask:0xf
  v_dot2c_f32_bf16_dpp v11, v34, v53 row_newbcast:3 row_mask:0xf bank_mask:0xf
  v_dot2c_f32_bf16_dpp v12, v29, v54 row_newbcast:3 row_mask:0xf bank_mask:0xf
  v_dot2c_f32_bf16_dpp v13, v34, v54 row_newbcast:3 row_mask:0xf bank_mask:0xf
  v_dot2c_f32_bf16_dpp v14, v29, v55 row_newbcast:3 row_mask:0xf bank_mask:0xf
  v_dot2c_f32_bf16_dpp v15, v34, v55 row_newbcast:3 row_mask:0xf bank_mask:0xf
  s_cmp_lg_u32 s59, 8
  s_cbranch_scc1 L_vs_32
  s_call_b64 s[62:63], L_hand
L_vs_32:
  v_add_u32_dpp v3, v28, v38 row_newbcast:8 row_mask:0xf bank_mask:0xf
  s_waitcnt vmcnt(3)
  buffer_load_dwordx4 v[72:75], v3, s[48:51], 0 offen nt
  v_dot2c_f32_bf16_dpp v8, v29, v56 row_newbcast:4 row_mask:0xf bank_mask:0xf
  v_dot2c_f32_bf16_dpp v9, v34, v56 row_newbcast:4 row_mask:0xf bank_mask:0xf
  v_dot2c_f32_bf16_dpp v10, v29, v57 row_newbcast:4 row_mask:0xf bank_mask:0xf
  v_dot2c_f32_bf16_dpp v11, v34, v57 row_newbcast:4 row_mask:0xf bank_mask:0xf
  v_dot2c_f32_bf16_dpp v12, v29, v58 row_newbcast:4 row_mask:0xf bank_mask:0xf
  v_dot2c_f32_bf16_dpp v13, v34, v58 row_newbcast:4 row_mask:0xf bank_mask:0xf
  v_dot2c_f32_bf16_dpp v14, v29, v59 row_newbcast:4 row_mask:0xf bank_mask:0xf
  v_dot2c_f32_bf16_dpp v15, v34, v59 row_newbcast:4 row_mask:0xf bank_mask:0xf
  s_cmp_lg_u32 s59, 9
  s_cbranch_scc1 L_vs_33
  s_call_b64 s[62:63], L_hand
L_vs_33:
  v_add_u32_dpp v3, v28, v38 row_newbcast:9 row_mask:0xf bank_mask:0xf
  s_waitcnt vmcnt(3)
  buffer_load_dwordx4 v[76:79], v3, s[48:51], 0 offen nt
  v_dot2c_f32_bf16_dpp v8, v29, v60 row_newbcast:5 row_mask:0xf bank_mask:0xf
  v_dot2c_f32_bf16_dpp v9, v34, v60 row_newbcast:5 row_mask:0xf bank_mask:0xf
  v_dot2c_f32_bf16_dpp v10, v29, v61 row_newbcast:5 row_mask:0xf bank_mask:0xf
  v_dot2c_f32_bf16_dpp v11, v34, v61 row_newbcast:5 row_mask:0xf bank_mask:0xf
  v_dot2c_f32_bf16_dpp v12, v29, v62 row_newbcast:5 row_mask:0xf bank_mask:0xf
  v_dot2c_f32_bf16_dpp v13, v34, v62 row_newbcast:5 row_mask:0xf bank_mask:0xf
  v_dot2c_f32_bf16_dpp v14, v29, v63 row_newbcast:5 row_mask:0xf bank_mask:0xf
  v_dot2c_f32_bf16_dpp v15, v34, v63 row_newbcast:5 row_mask:0xf bank_mask:0xf
  s_cmp_lg_u32 s59, 10
  s_cbranch_scc1 L_vs_34
  s_call_b64 s[62:63], L_hand
L_vs_34:
  v_add_u32_dpp v3, v28, v38 row_newbcast:10 row_mask:0xf bank_mask:0xf
  s_waitcnt vmcnt(3)
  buffer_load_dwordx4 v[80:83], v3, s[48:51], 0 offen nt
  v_dot2c_f32_bf16_dpp v8, v29, v64 row_newbcast:6 row_mask:0xf bank_mask:0xf
  v_dot2c_f32_bf16_dpp v9, v34, v64 row_newbcast:6 row_mask:0xf bank_mask:0xf
  v_dot2c_f32_bf16_dpp v10, v29, v65 row_newbcast:6 row_mask:0xf bank_mask:0xf
  v_dot2c_f32_bf16_dpp v11, v34, v65 row_newbcast:6 row_mask:0xf bank_mask:0xf
  v_dot2c_f32_bf16_dpp v12, v29, v66 row_newbcast:6 row_mask:0xf bank_mask:0xf
  v_dot2c_f32_bf16_dpp v13, v34, v66 row_newbcast:6 row_mask:0xf bank_mask:0xf
  v_dot2c_f32_bf16_dpp v14, v29, v67 row_newbcast:6 row_mask:0xf bank_mask:0xf
  v_dot2c_f32_bf16_dpp v15, v34, v67 row_newbcast:6 row_mask:0xf bank_mask:0xf
  s_cmp_lg_u32 s59, 11
  s_cbranch_scc1 L_vs_35
  s_call_b64 s[62:63], L_hand
L_vs_35:
  v_add_u32_dpp v3, v28, v38 row_newbcast:11 row_mask:0xf bank_mask:0xf
  s_waitcnt vmcnt(3)
  buffer_load_dwordx4 v[84:87], v3, s[48:51], 0 offen nt
  v_dot2c_f32_bf16_dpp v8, v29, v68 row_newbcast:7 row_mask:0xf bank_mask:0xf
  v_dot2c_f32_bf16_dpp v9, v34, v68 row_newbcast:7 row_mask:0xf bank_mask:0xf
  v_dot2c_f32_bf16_dpp v10, v29, v69 row_newbcast:7 row_mask:0xf bank_mask:0xf
  v_dot2c_f32_bf16_dpp v11, v34, v69 row_newbcast:7 row_mask:0xf bank_mask:0xf
  v_dot2c_f32_bf16_dpp v12, v29, v70 row_newbcast:7 row_mask:0xf bank_mask:0xf
  v_dot2c_f32_bf16_dpp v13, v34, v70 row_newbcast:7 row_mask:0xf bank_mask:0xf
  v_dot2c_f32_bf16_dpp v14, v29, v71 row_newbcast:7 row_mask:0xf bank_mask:0xf
  v_dot2c_f32_bf16_dpp v15, v34, v71 row_newbcast:7 row_mask:0xf bank_mask:0xf
  s_cmp_lg_u32 s59, 12
  s_cbranch_scc1 L_vs_36
  s_call_b64 s[62:63], L_hand
L_vs_36:
  v_add_u32_dpp v3, v28, v38 row_newbcast:12 row_mask:0xf bank_mask:0xf
  s_waitcnt vmcnt(3)
  buffer_load_dwordx4 v[88:91], v3, s[48:51], 0 offen nt
  v_dot2c_f32_bf16_dpp v8, v29, v72 row_newbcast:8 row_mask:0xf bank_mask:0xf
  v_dot2c_f32_bf16_dpp v9, v34, v72 row_newbcast:8 row_mask:0xf bank_mask:0xf
  v_dot2c_f32_bf16_dpp v10, v29, v73 row_newbcast:8 row_mask:0xf bank_mask:0xf
  v_dot2c_f32_bf16_dpp v11, v34, v73 row_newbcast:8 row_mask:0xf bank_mask:0xf
  v_dot2c_f32_bf16_dpp v12, v29, v74 row_newbcast:8 row_mask:0xf bank_mask:0xf
  v_dot2c_f32_bf16_dpp v13, v34, v74 row_newbcast:8 row_mask:0xf bank_mask:0xf
  v_dot2c_f32_bf16_dpp v14, v29, v75 row_newbcast:8 row_mask:0xf bank_mask:0xf
  v_dot2c_f32_bf16_dpp v15, v34, v75 row_newbcast:8 row_mask:0xf bank_mask:0xf
  s_cmp_lg_u32 s59, 13
  s_cbranch_scc1 L_vs_37
  s_call_b64 s[62:63], L_hand
L_vs_37:
  v_add_u32_dpp v3, v28, v38 row_newbcast:13 row_mask:0xf bank_mask:0xf
  s_waitcnt vmcnt(3)
  buffer_load_dwordx4 v[92:95], v3, s[48:51], 0 offen nt
  v_dot2c_f32_bf16_dpp v8, v29, v76 row_newbcast:9 row_mask:0xf bank_mask:0xf
  v_dot2c_f32_bf16_dpp v9, v34, v76 row_newbcast:9 row_mask:0xf bank_mask:0xf
  v_dot2c_f32_bf16_dpp v10, v29, v77 row_newbcast:9 row_mask:0xf bank_mask:0xf
  v_dot2c_f32_bf16_dpp v11, v34, v77 row_newbcast:9 row_mask:0xf bank_mask:0xf
  v_dot2c_f32_bf16_dpp v12, v29, v78 row_newbcast:9 row_mask:0xf bank_mask:0xf
  v_dot2c_f32_bf16_dpp v13, v34, v78 row_newbcast:9 row_mask:0xf bank_mask:0xf
  v_dot2c_f32_bf16_dpp v14, v29, v79 row_newbcast:9 row_mask:0xf bank_mask:0xf
  v_dot2c_f32_bf16_dpp v15, v34, v79 row_newbcast:9 row_mask:0xf bank_mask:0xf
  s_cmp_lg_u32 s59, 14
  s_cbranch_scc1 L_vs_38
  s_call_b64 s[62:63], L_hand
L_vs_38:
  v_add_u32_dpp v3, v28, v38 row_newbcast:14 row_mask:0xf bank_mask:0xf
  s_waitcnt vmcnt(3)
  buffer_load_dwordx4 v[96:99], v3, s[48:51], 0 offen nt
  v_dot2c_f32_bf16_dpp v8, v29, v80 row_newbcast:10 row_mask:0xf bank_mask:0xf
  v_dot2c_f32_bf16_dpp v9, v34, v80 row_newbcast:10 row_mask:0xf bank_mask:0xf
  v_dot2c_f32_bf16_dpp v10, v29, v81 row_newbcast:10 row_mask:0xf bank_mask:0xf
  v_dot2c_f32_bf16_dpp v11, v34, v81 row_newbcast:10 row_mask:0xf bank_mask:0xf
  v_dot2c_f32_bf16_dpp v12, v29, v82 row_newbcast:10 row_mask:0xf bank_mask:0xf
  v_dot2c_f32_bf16_dpp v13, v34, v82 row_newbcast:10 row_mask:0xf bank_mask:0xf
  v_dot2c_f32_bf16_dpp v14, v29, v83 row_newbcast:10 row_mask:0xf bank_mask:0xf
  v_dot2c_f32_bf16_dpp v15, v34, v83 row_newbcast:10 row_mask:0xf bank_mask:0xf
  s_cmp_lg_u32 s59, 15
  s_cbranch_scc1 L_vs_39
  s_call_b64 s[62:63], L_hand
L_vs_39:
  v_add_u32_dpp v3, v28, v38 row_newbcast:15 row_mask:0xf bank_mask:0xf
  s_waitcnt vmcnt(3)
  buffer_load_dwordx4 v[100:103], v3, s[48:51], 0 offen nt
  v_dot2c_f32_bf16_dpp v8, v29, v84 row_newbcast:11 row_mask:0xf bank_mask:0xf
  v_dot2c_f32_bf16_dpp v9, v34, v84 row_newbcast:11 row_mask:0xf bank_mask:0xf
  v_dot2c_f32_bf16_dpp v10, v29, v85 row_newbcast:11 row_mask:0xf bank_mask:0xf
  v_dot2c_f32_bf16_dpp v11, v34, v85 row_newbcast:11 row_mask:0xf bank_mask:0xf
  v_dot2c_f32_bf16_dpp v12, v29, v86 row_newbcast:11 row_mask:0xf bank_mask:0xf
  v_dot2c_f32_bf16_dpp v13, v34, v86 row_newbcast:11 row_mask:0xf bank_mask:0xf
  v_dot2c_f32_bf16_dpp v14, v29, v87 row_newbcast:11 row_mask:0xf bank_mask:0xf
  v_dot2c_f32_bf16_dpp v15, v34, v87 row_newbcast:11 row_mask:0xf bank_mask:0xf
  s_cmp_lg_u32 s59, 16
  s_cbranch_scc1 L_vs_40
  s_call_b64 s[62:63], L_hand
L_vs_40:
  v_add_u32_dpp v3, v30, v38 row_newbcast:0 row_mask:0xf bank_mask:0xf
  s_waitcnt vmcnt(3)
  buffer_load_dwordx4 v[104:107], v3, s[48:51], 0 offen nt
  v_dot2c_f32_bf16_dpp v8, v29, v88 row_newbcast:12 row_mask:0xf bank_mask:0xf
  v_dot2c_f32_bf16_dpp v9, v34, v88 row_newbcast:12 row_mask:0xf bank_mask:0xf
  v_dot2c_f32_bf16_dpp v10, v29, v89 row_newbcast:12 row_mask:0xf bank_mask:0xf
  v_dot2c_f32_bf16_dpp v11, v34, v89 row_newbcast:12 row_mask:0xf bank_mask:0xf
  v_dot2c_f32_bf16_dpp v12, v29, v90 row_newbcast:12 row_mask:0xf bank_mask:0xf
  v_dot2c_f32_bf16_dpp v13, v34, v90 row_newbcast:12 row_mask:0xf bank_mask:0xf
  v_dot2c_f32_bf16_dpp v14, v29, v91 row_newbcast:12 row_mask:0xf bank_mask:0xf
  v_dot2c_f32_bf16_dpp v15, v34, v91 row_newbcast:12 row_mask:0xf bank_mask:0xf
  s_cmp_lg_u32 s59, 17
  s_cbranch_scc1 L_vs_41
  s_call_b64 s[62:63], L_hand
L_vs_41:
  v_add_u32_dpp v3, v30, v38 row_newbcast:1 row_mask:0xf bank_mask:0xf
  s_waitcnt vmcnt(3)
  buffer_load_dwordx4 v[108:111], v3, s[48:51], 0 offen nt
  v_dot2c_f32_bf16_dpp v8, v29, v92 row_newbcast:13 row_mask:0xf bank_mask:0xf
  v_dot2c_f32_bf16_dpp v9, v34, v92 row_newbcast:13 row_mask:0xf bank_mask:0xf
  v_dot2c_f32_bf16_dpp v10, v29, v93 row_newbcast:13 row_mask:0xf bank_mask:0xf
  v_dot2c_f32_bf16_dpp v11, v34, v93 row_newbcast:13 row_mask:0xf bank_mask:0xf
  v_dot2c_f32_bf16_dpp v12, v29, v94 row_newbcast:13 row_mask:0xf bank_mask:0xf
  v_dot2c_f32_bf16_dpp v13, v34, v94 row_newbcast:13 row_mask:0xf bank_mask:0xf
  v_dot2c_f32_bf16_dpp v14, v29, v95 row_newbcast:13 row_mask:0xf bank_mask:0xf
  v_dot2c_f32_bf16_dpp v15, v34, v95 row_newbcast:13 row_mask:0xf bank_mask:0xf
  s_cmp_lg_u32 s59, 18
  s_cbranch_scc1 L_vs_42
  s_call_b64 s[62:63], L_hand
L_vs_42:
  v_add_u32_dpp v3, v30, v38 row_newbcast:2 row_mask:0xf bank_mask:0xf
  s_waitcnt vmcnt(3)
  buffer_load_dwordx4 v[112:115], v3, s[48:51], 0 offen nt
  v_dot2c_f32_bf16_dpp v8, v29, v96 row_newbcast:14 row_mask:0xf bank_mask:0xf
  v_dot2c_f32_bf16_dpp v9, v34, v96 row_newbcast:14 row_mask:0xf bank_mask:0xf
  v_dot2c_f32_bf16_dpp v10, v29, v97 row_newbcast:14 row_mask:0xf bank_mask:0xf
  v_dot2c_f32_bf16_dpp v11, v34, v97 row_newbcast:14 row_mask:0xf bank_mask:0xf
  v_dot2c_f32_bf16_dpp v12, v29, v98 row_newbcast:14 row_mask:0xf bank_mask:0xf
  v_dot2c_f32_bf16_dpp v13, v34, v98 row_newbcast:14 row_mask:0xf bank_mask:0xf
  v_dot2c_f32_bf16_dpp v14, v29, v99 row_newbcast:14 row_mask:0xf bank_mask:0xf
  v_dot2c_f32_bf16_dpp v15, v34, v99 row_newbcast:14 row_mask:0xf bank_mask:0xf
  s_cmp_lg_u32 s59, 19
  s_cbranch_scc1 L_vs_43
  s_call_b64 s[62:63], L_hand
L_vs_43:
  v_add_u32_dpp v3, v30, v38 row_newbcast:3 row_mask:0xf bank_mask:0xf
  s_waitcnt vmcnt(3)
  buffer_load_dwordx4 v[116:119], v3, s[48:51], 0 offen nt
  v_dot2c_f32_bf16_dpp v8, v29, v100 row_newbcast:15 row_mask:0xf bank_mask:0xf
  v_dot2c_f32_bf16_dpp v9, v34, v100 row_newbcast:15 row_mask:0xf bank_mask:0xf
  v_dot2c_f32_bf16_dpp v10, v29, v101 row_newbcast:15 row_mask:0xf bank_mask:0xf
  v_dot2c_f32_bf16_dpp v11, v34, v101 row_newbcast:15 row_mask:0xf bank_mask:0xf
  v_dot2c_f32_bf16_dpp v12, v29, v102 row_newbcast:15 row_mask:0xf bank_mask:0xf
  v_dot2c_f32_bf16_dpp v13, v34, v102 row_newbcast:15 row_mask:0xf bank_mask:0xf
  v_dot2c_f32_bf16_dpp v14, v29, v103 row_newbcast:15 row_mask:0xf bank_mask:0xf
  v_dot2c_f32_bf16_dpp v15, v34, v103 row_newbcast:15 row_mask:0xf bank_mask:0xf
  s_cmp_lg_u32 s59, 20
  s_cbranch_scc1 L_vs_44
  s_call_b64 s[62:63], L_hand
L_vs_44:
  v_add_u32_dpp v3, v30, v38 row_newbcast:4 row_mask:0xf bank_mask:0xf
  s_waitcnt vmcnt(3)
  buffer_load_dwordx4 v[120:123], v3, s[48:51], 0 offen nt
  v_dot2c_f32_bf16_dpp v8, v31, v104 row_newbcast:0 row_mask:0xf bank_mask:0xf
  v_dot2c_f32_bf16_dpp v9, v35, v104 row_newbcast:0 row_mask:0xf bank_mask:0xf
  v_dot2c_f32_bf16_dpp v10, v31, v105 row_newbcast:0 row_mask:0xf bank_mask:0xf
  v_dot2c_f32_bf16_dpp v11, v35, v105 row_newbcast:0 row_mask:0xf bank_mask:0xf
  v_dot2c_f32_bf16_dpp v12, v31, v106 row_newbcast:0 row_mask:0xf bank_mask:0xf
  v_dot2c_f32_bf16_dpp v13, v35, v106 row_newbcast:0 row_mask:0xf bank_mask:0xf
  v_dot2c_f32_bf16_dpp v14, v31, v107 row_newbcast:0 row_mask:0xf bank_mask:0xf
  v_dot2c_f32_bf16_dpp v15, v35, v107 row_newbcast:0 row_mask:0xf bank_mask:0xf
  s_cmp_lg_u32 s59, 21
  s_cbranch_scc1 L_vs_45
  s_call_b64 s[62:63], L_hand
L_vs_45:
  v_add_u32_dpp v3, v30, v38 row_newbcast:5 row_mask:0xf bank_mask:0xf
  s_waitcnt vmcnt(3)
  buffer_load_dwordx4 v[124:127], v3, s[48:51], 0 offen nt
  v_dot2c_f32_bf16_dpp v8, v31, v108 row_newbcast:1 row_mask:0xf bank_mask:0xf
  v_dot2c_f32_bf16_dpp v9, v35, v108 row_newbcast:1 row_mask:0xf bank_mask:0xf
  v_dot2c_f32_bf16_dpp v10, v31, v109 row_newbcast:1 row_mask:0xf bank_mask:0xf
  v_dot2c_f32_bf16_dpp v11, v35, v109 row_newbcast:1 row_mask:0xf bank_mask:0xf
  v_dot2c_f32_bf16_dpp v12, v31, v110 row_newbcast:1 row_mask:0xf bank_mask:0xf
  v_dot2c_f32_bf16_dpp v13, v35, v110 row_newbcast:1 row_mask:0xf bank_mask:0xf
  v_dot2c_f32_bf16_dpp v14, v31, v111 row_newbcast:1 row_mask:0xf bank_mask:0xf
  v_dot2c_f32_bf16_dpp v15, v35, v111 row_newbcast:1 row_mask:0xf bank_mask:0xf
  s_cmp_lg_u32 s59, 22
  s_cbranch_scc1 L_vs_46
  s_call_b64 s[62:63], L_hand
L_vs_46:
  v_add_u32_dpp v3, v30, v38 row_newbcast:6 row_mask:0xf bank_mask:0xf
  s_waitcnt vmcnt(3)
  buffer_load_dwordx4 v[128:131], v3, s[48:51], 0 offen nt
  v_dot2c_f32_bf16_dpp v8, v31, v112 row_newbcast:2 row_mask:0xf bank_mask:0xf
  v_dot2c_f32_bf16_dpp v9, v35, v112 row_newbcast:2 row_mask:0xf bank_mask:0xf
  v_dot2c_f32_bf16_dpp v10, v31, v113 row_newbcast:2 row_mask:0xf bank_mask:0xf
  v_dot2c_f32_bf16_dpp v11, v35, v113 row_newbcast:2 row_mask:0xf bank_mask:0xf
  v_dot2c_f32_bf16_dpp v12, v31, v114 row_newbcast:2 row_mask:0xf bank_mask:0xf
  v_dot2c_f32_bf16_dpp v13, v35, v114 row_newbcast:2 row_mask:0xf bank_mask:0xf
  v_dot2c_f32_bf16_dpp v14, v31, v115 row_newbcast:2 row_mask:0xf bank_mask:0xf
  v_dot2c_f32_bf16_dpp v15, v35, v115 row_newbcast:2 row_mask:0xf bank_mask:0xf
  s_cmp_lg_u32 s59, 23
  s_cbranch_scc1 L_vs_47
  s_call_b64 s[62:63], L_hand
L_vs_47:
  v_add_u32_dpp v3, v30, v38 row_newbcast:7 row_mask:0xf bank_mask:0xf
  s_waitcnt vmcnt(3)
  buffer_load_dwordx4 v[132:135], v3, s[48:51], 0 offen nt
  v_dot2c_f32_bf16_dpp v8, v31, v116 row_newbcast:3 row_mask:0xf bank_mask:0xf
  v_dot2c_f32_bf16_dpp v9, v35, v116 row_newbcast:3 row_mask:0xf bank_mask:0xf
  v_dot2c_f32_bf16_dpp v10, v31, v117 row_newbcast:3 row_mask:0xf bank_mask:0xf
  v_dot2c_f32_bf16_dpp v11, v35, v117 row_newbcast:3 row_mask:0xf bank_mask:0xf
  v_dot2c_f32_bf16_dpp v12, v31, v118 row_newbcast:3 row_mask:0xf bank_mask:0xf
  v_dot2c_f32_bf16_dpp v13, v35, v118 row_newbcast:3 row_mask:0xf bank_mask:0xf
  v_dot2c_f32_bf16_dpp v14, v31, v119 row_newbcast:3 row_mask:0xf bank_mask:0xf
  v_dot2c_f32_bf16_dpp v15, v35, v119 row_newbcast:3 row_mask:0xf bank_mask:0xf
  s_cmp_lg_u32 s59, 24
  s_cbranch_scc1 L_vs_48
  s_call_b64 s[62:63], L_hand
L_vs_48:
  v_add_u32_dpp v3, v30, v38 row_newbcast:8 row_mask:0xf bank_mask:0xf
  s_waitcnt vmcnt(3)
  buffer_load_dwordx4 v[136:139], v3, s[48:51], 0 offen nt
  v_dot2c_f32_bf16_dpp v8, v31, v120 row_newbcast:4 row_mask:0xf bank_mask:0xf
  v_dot2c_f32_bf16_dpp v9, v35, v120 row_newbcast:4 row_mask:0xf bank_mask:0xf
  v_dot2c_f32_bf16_dpp v10, v31, v121 row_newbcast:4 row_mask:0xf bank_mask:0xf
  v_dot2c_f32_bf16_dpp v11, v35, v121 row_newbcast:4 row_mask:0xf bank_mask:0xf
  v_dot2c_f32_bf16_dpp v12, v31, v122 row_newbcast:4 row_mask:0xf bank_mask:0xf
  v_dot2c_f32_bf16_dpp v13, v35, v122 row_newbcast:4 row_mask:0xf bank_mask:0xf
  v_dot2c_f32_bf16_dpp v14, v31, v123 row_newbcast:4 row_mask:0xf bank_mask:0xf
  v_dot2c_f32_bf16_dpp v15, v35, v123 row_newbcast:4 row_mask:0xf bank_mask:0xf
  s_cmp_lg_u32 s59, 25
  s_cbranch_scc1 L_vs_49
  s_call_b64 s[62:63], L_hand
L_vs_49:
  v_add_u32_dpp v3, v30, v38 row_newbcast:9 row_mask:0xf bank_mask:0xf
  s_waitcnt vmcnt(3)
  buffer_load_dwordx4 v[140:143], v3, s[48:51], 0 offen nt
  v_dot2c_f32_bf16_dpp v8, v31, v124 row_newbcast:5 row_mask:0xf bank_mask:0xf
  v_dot2c_f32_bf16_dpp v9, v35, v124 row_newbcast:5 row_mask:0xf bank_mask:0xf
  v_dot2c_f32_bf16_dpp v10, v31, v125 row_newbcast:5 row_mask:0xf bank_mask:0xf
  v_dot2c_f32_bf16_dpp v11, v35, v125 row_newbcast:5 row_mask:0xf bank_mask:0xf
  v_dot2c_f32_bf16_dpp v12, v31, v126 row_newbcast:5 row_mask:0xf bank_mask:0xf
  v_dot2c_f32_bf16_dpp v13, v35, v126 row_newbcast:5 row_mask:0xf bank_mask:0xf
  v_dot2c_f32_bf16_dpp v14, v31, v127 row_newbcast:5 row_mask:0xf bank_mask:0xf
  v_dot2c_f32_bf16_dpp v15, v35, v127 row_newbcast:5 row_mask:0xf bank_mask:0xf
  s_cmp_lg_u32 s59, 26
  s_cbranch_scc1 L_vs_50
  s_call_b64 s[62:63], L_hand
L_vs_50:
  v_add_u32_dpp v3, v30, v38 row_newbcast:10 row_mask:0xf bank_mask:0xf
  s_waitcnt vmcnt(3)
  buffer_load_dwordx4 v[144:147], v3, s[48:51], 0 offen nt
  v_dot2c_f32_bf16_dpp v8, v31, v128 row_newbcast:6 row_mask:0xf bank_mask:0xf
  v_dot2c_f32_bf16_dpp v9, v35, v128 row_newbcast:6 row_mask:0xf bank_mask:0xf
  v_dot2c_f32_bf16_dpp v10, v31, v129 row_newbcast:6 row_mask:0xf bank_mask:0xf
  v_dot2c_f32_bf16_dpp v11, v35, v129 row_newbcast:6 row_mask:0xf bank_mask:0xf
  v_dot2c_f32_bf16_dpp v12, v31, v130 row_newbcast:6 row_mask:0xf bank_mask:0xf
  v_dot2c_f32_bf16_dpp v13, v35, v130 row_newbcast:6 row_mask:0xf bank_mask:0xf
  v_dot2c_f32_bf16_dpp v14, v31, v131 row_newbcast:6 row_mask:0xf bank_mask:0xf
  v_dot2c_f32_bf16_dpp v15, v35, v131 row_newbcast:6 row_mask:0xf bank_mask:0xf
  s_cmp_lg_u32 s59, 27
  s_cbranch_scc1 L_vs_51
  s_call_b64 s[62:63], L_hand
L_vs_51:
  v_add_u32_dpp v3, v30, v38 row_newbcast:11 row_mask:0xf bank_mask:0xf
  s_waitcnt vmcnt(3)
  buffer_load_dwordx4 v[148:151], v3, s[48:51], 0 offen nt
  v_dot2c_f32_bf16_dpp v8, v31, v132 row_newbcast:7 row_mask:0xf bank_mask:0xf
  v_dot2c_f32_bf16_dpp v9, v35, v132 row_newbcast:7 row_mask:0xf bank_mask:0xf
  v_dot2c_f32_bf16_dpp v10, v31, v133 row_newbcast:7 row_mask:0xf bank_mask:0xf
  v_dot2c_f32_bf16_dpp v11, v35, v133 row_newbcast:7 row_mask:0xf bank_mask:0xf
  v_dot2c_f32_bf16_dpp v12, v31, v134 row_newbcast:7 row_mask:0xf bank_mask:0xf
  v_dot2c_f32_bf16_dpp v13, v35, v134 row_newbcast:7 row_mask:0xf bank_mask:0xf
  v_dot2c_f32_bf16_dpp v14, v31, v135 row_newbcast:7 row_mask:0xf bank_mask:0xf
  v_dot2c_f32_bf16_dpp v15, v35, v135 row_newbcast:7 row_mask:0xf bank_mask:0xf
  s_cmp_lg_u32 s59, 28
  s_cbranch_scc1 L_vs_52
  s_call_b64 s[62:63], L_hand
L_vs_52:
  v_add_u32_dpp v3, v30, v38 row_newbcast:12 row_mask:0xf bank_mask:0xf
  s_waitcnt vmcnt(3)
  buffer_load_dwordx4 v[152:155], v3, s[48:51], 0 offen nt
  v_dot2c_f32_bf16_dpp v8, v31, v136 row_newbcast:8 row_mask:0xf bank_mask:0xf
  v_dot2c_f32_bf16_dpp v9, v35, v136 row_newbcast:8 row_mask:0xf bank_mask:0xf
  v_dot2c_f32_bf16_dpp v10, v31, v137 row_newbcast:8 row_mask:0xf bank_mask:0xf
  v_dot2c_f32_bf16_dpp v11, v35, v137 row_newbcast:8 row_mask:0xf bank_mask:0xf
  v_dot2c_f32_bf16_dpp v12, v31, v138 row_newbcast:8 row_mask:0xf bank_mask:0xf
  v_dot2c_f32_bf16_dpp v13, v35, v138 row_newbcast:8 row_mask:0xf bank_mask:0xf
  v_dot2c_f32_bf16_dpp v14, v31, v139 row_newbcast:8 row_mask:0xf bank_mask:0xf
  v_dot2c_f32_bf16_dpp v15, v35, v139 row_newbcast:8 row_mask:0xf bank_mask:0xf
  s_cmp_lg_u32 s59, 29
  s_cbranch_scc1 L_vs_53
  s_call_b64 s[62:63], L_hand
L_vs_53:
  v_add_u32_dpp v3, v30, v38 row_newbcast:13 row_mask:0xf bank_mask:0xf
  s_waitcnt vmcnt(3)
  buffer_load_dwordx4 v[156:159], v3, s[48:51], 0 offen nt
  v_dot2c_f32_bf16_dpp v8, v31, v140 row_newbcast:9 row_mask:0xf bank_mask:0xf
  v_dot2c_f32_bf16_dpp v9, v35, v140 row_newbcast:9 row_mask:0xf bank_mask:0xf
  v_dot2c_f32_bf16_dpp v10, v31, v141 row_newbcast:9 row_mask:0xf bank_mask:0xf
  v_dot2c_f32_bf16_dpp v11, v35, v141 row_newbcast:9 row_mask:0xf bank_mask:0xf
  v_dot2c_f32_bf16_dpp v12, v31, v142 row_newbcast:9 row_mask:0xf bank_mask:0xf
  v_dot2c_f32_bf16_dpp v13, v35, v142 row_newbcast:9 row_mask:0xf bank_mask:0xf
  v_dot2c_f32_bf16_dpp v14, v31, v143 row_newbcast:9 row_mask:0xf bank_mask:0xf
  v_dot2c_f32_bf16_dpp v15, v35, v143 row_newbcast:9 row_mask:0xf bank_mask:0xf
  s_cmp_lg_u32 s59, 30
  s_cbranch_scc1 L_vs_54
  s_call_b64 s[62:63], L_hand
L_vs_54:
  v_add_u32_dpp v3, v30, v38 row_newbcast:14 row_mask:0xf bank_mask:0xf
  s_waitcnt vmcnt(3)
  buffer_load_dwordx4 v[160:163], v3, s[48:51], 0 offen nt
  v_dot2c_f32_bf16_dpp v8, v31, v144 row_newbcast:10 row_mask:0xf bank_mask:0xf
  v_dot2c_f32_bf16_dpp v9, v35, v144 row_newbcast:10 row_mask:0xf bank_mask:0xf
  v_dot2c_f32_bf16_dpp v10, v31, v145 row_newbcast:10 row_mask:0xf bank_mask:0xf
  v_dot2c_f32_bf16_dpp v11, v35, v145 row_newbcast:10 row_mask:0xf bank_mask:0xf
  v_dot2c_f32_bf16_dpp v12, v31, v146 row_newbcast:10 row_mask:0xf bank_mask:0xf
  v_dot2c_f32_bf16_dpp v13, v35, v146 row_newbcast:10 row_mask:0xf bank_mask:0xf
  v_dot2c_f32_bf16_dpp v14, v31, v147 row_newbcast:10 row_mask:0xf bank_mask:0xf
  v_dot2c_f32_bf16_dpp v15, v35, v147 row_newbcast:10 row_mask:0xf bank_mask:0xf
  s_cmp_lg_u32 s59, 31
  s_cbranch_scc1 L_vs_55
  s_call_b64 s[62:63], L_hand
L_vs_55:
  v_add_u32_dpp v3, v30, v38 row_newbcast:15 row_mask:0xf bank_mask:0xf
  s_waitcnt vmcnt(3)
  buffer_load_dwordx4 v[164:167], v3, s[48:51], 0 offen nt
  v_dot2c_f32_bf16_dpp v8, v31, v148 row_newbcast:11 row_mask:0xf bank_mask:0xf
  v_dot2c_f32_bf16_dpp v9, v35, v148 row_newbcast:11 row_mask:0xf bank_mask:0xf
  v_dot2c_f32_bf16_dpp v10, v31, v149 row_newbcast:11 row_mask:0xf bank_mask:0xf
  v_dot2c_f32_bf16_dpp v11, v35, v149 row_newbcast:11 row_mask:0xf bank_mask:0xf
  v_dot2c_f32_bf16_dpp v12, v31, v150 row_newbcast:11 row_mask:0xf bank_mask:0xf
  v_dot2c_f32_bf16_dpp v13, v35, v150 row_newbcast:11 row_mask:0xf bank_mask:0xf
  v_dot2c_f32_bf16_dpp v14, v31, v151 row_newbcast:11 row_mask:0xf bank_mask:0xf
  v_dot2c_f32_bf16_dpp v15, v35, v151 row_newbcast:11 row_mask:0xf bank_mask:0xf
  s_cmp_lg_u32 s59, 32
  s_cbranch_scc1 L_vs_56
  s_call_b64 s[62:63], L_hand
L_vs_56:
  v_add_u32_dpp v3, v32, v38 row_newbcast:0 row_mask:0xf bank_mask:0xf
  s_waitcnt vmcnt(3)
  buffer_load_dwordx4 v[40:43], v3, s[48:51], 0 offen nt
  v_dot2c_f32_bf16_dpp v8, v31, v152 row_newbcast:12 row_mask:0xf bank_mask:0xf
  v_dot2c_f32_bf16_dpp v9, v35, v152 row_newbcast:12 row_mask:0xf bank_mask:0xf
  v_dot2c_f32_bf16_dpp v10, v31, v153 row_newbcast:12 row_mask:0xf bank_mask:0xf
  v_dot2c_f32_bf16_dpp v11, v35, v153 row_newbcast:12 row_mask:0xf bank_mask:0xf
  v_dot2c_f32_bf16_dpp v12, v31, v154 row_newbcast:12 row_mask:0xf bank_mask:0xf
  v_dot2c_f32_bf16_dpp v13, v35, v154 row_newbcast:12 row_mask:0xf bank_mask:0xf
  v_dot2c_f32_bf16_dpp v14, v31, v155 row_newbcast:12 row_mask:0xf bank_mask:0xf
  v_dot2c_f32_bf16_dpp v15, v35, v155 row_newbcast:12 row_mask:0xf bank_mask:0xf
  s_cmp_lg_u32 s59, 33
  s_cbranch_scc1 L_vs_57
  s_call_b64 s[62:63], L_hand
L_vs_57:
  v_add_u32_dpp v3, v32, v38 row_newbcast:1 row_mask:0xf bank_mask:0xf
  s_waitcnt vmcnt(3)
  buffer_load_dwordx4 v[44:47], v3, s[48:51], 0 offen nt
  v_dot2c_f32_bf16_dpp v8, v31, v156 row_newbcast:13 row_mask:0xf bank_mask:0xf
  v_dot2c_f32_bf16_dpp v9, v35, v156 row_newbcast:13 row_mask:0xf bank_mask:0xf
  v_dot2c_f32_bf16_dpp v10, v31, v157 row_newbcast:13 row_mask:0xf bank_mask:0xf
  v_dot2c_f32_bf16_dpp v11, v35, v157 row_newbcast:13 row_mask:0xf bank_mask:0xf
  v_dot2c_f32_bf16_dpp v12, v31, v158 row_newbcast:13 row_mask:0xf bank_mask:0xf
  v_dot2c_f32_bf16_dpp v13, v35, v158 row_newbcast:13 row_mask:0xf bank_mask:0xf
  v_dot2c_f32_bf16_dpp v14, v31, v159 row_newbcast:13 row_mask:0xf bank_mask:0xf
  v_dot2c_f32_bf16_dpp v15, v35, v159 row_newbcast:13 row_mask:0xf bank_mask:0xf
  s_cmp_lg_u32 s59, 34
  s_cbranch_scc1 L_vs_58
  s_call_b64 s[62:63], L_hand
L_vs_58:
  v_add_u32_dpp v3, v32, v38 row_newbcast:2 row_mask:0xf bank_mask:0xf
  s_waitcnt vmcnt(3)
  buffer_load_dwordx4 v[48:51], v3, s[48:51], 0 offen nt
  v_dot2c_f32_bf16_dpp v8, v31, v160 row_newbcast:14 row_mask:0xf bank_mask:0xf
  v_dot2c_f32_bf16_dpp v9, v35, v160 row_newbcast:14 row_mask:0xf bank_mask:0xf
  v_dot2c_f32_bf16_dpp v10, v31, v161 row_newbcast:14 row_mask:0xf bank_mask:0xf
  v_dot2c_f32_bf16_dpp v11, v35, v161 row_newbcast:14 row_mask:0xf bank_mask:0xf
  v_dot2c_f32_bf16_dpp v12, v31, v162 row_newbcast:14 row_mask:0xf bank_mask:0xf
  v_dot2c_f32_bf16_dpp v13, v35, v162 row_newbcast:14 row_mask:0xf bank_mask:0xf
  v_dot2c_f32_bf16_dpp v14, v31, v163 row_newbcast:14 row_mask:0xf bank_mask:0xf
  v_dot2c_f32_bf16_dpp v15, v35, v163 row_newbcast:14 row_mask:0xf bank_mask:0xf
  s_cmp_lg_u32 s59, 35
  s_cbranch_scc1 L_vs_59
  s_call_b64 s[62:63], L_hand
L_vs_59:
  v_add_u32_dpp v3, v32, v38 row_newbcast:3 row_mask:0xf bank_mask:0xf
  s_waitcnt vmcnt(3)
  buffer_load_dwordx4 v[52:55], v3, s[48:51], 0 offen nt
  v_dot2c_f32_bf16_dpp v8, v31, v164 row_newbcast:15 row_mask:0xf bank_mask:0xf
  v_dot2c_f32_bf16_dpp v9, v35, v164 row_newbcast:15 row_mask:0xf bank_mask:0xf
  v_dot2c_f32_bf16_dpp v10, v31, v165 row_newbcast:15 row_mask:0xf bank_mask:0xf
  v_dot2c_f32_bf16_dpp v11, v35, v165 row_newbcast:15 row_mask:0xf bank_mask:0xf
  v_dot2c_f32_bf16_dpp v12, v31, v166 row_newbcast:15 row_mask:0xf bank_mask:0xf
  v_dot2c_f32_bf16_dpp v13, v35, v166 row_newbcast:15 row_mask:0xf bank_mask:0xf
  v_dot2c_f32_bf16_dpp v14, v31, v167 row_newbcast:15 row_mask:0xf bank_mask:0xf
  v_dot2c_f32_bf16_dpp v15, v35, v167 row_newbcast:15 row_mask:0xf bank_mask:0xf
  s_cmp_lg_u32 s59, 36
  s_cbranch_scc1 L_vs_60
  s_call_b64 s[62:63], L_hand
L_vs_60:
  v_add_u32_dpp v3, v32, v38 row_newbcast:4 row_mask:0xf bank_mask:0xf
  s_waitcnt vmcnt(3)
  buffer_load_dwordx4 v[56:59], v3, s[48:51], 0 offen nt
  v_dot2c_f32_bf16_dpp v8, v33, v40 row_newbcast:0 row_mask:0xf bank_mask:0xf
  v_dot2c_f32_bf16_dpp v9, v36, v40 row_newbcast:0 row_mask:0xf bank_mask:0xf
  v_dot2c_f32_bf16_dpp v10, v33, v41 row_newbcast:0 row_mask:0xf bank_mask:0xf
  v_dot2c_f32_bf16_dpp v11, v36, v41 row_newbcast:0 row_mask:0xf bank_mask:0xf
  v_dot2c_f32_bf16_dpp v12, v33, v42 row_newbcast:0 row_mask:0xf bank_mask:0xf
  v_dot2c_f32_bf16_dpp v13, v36, v42 row_newbcast:0 row_mask:0xf bank_mask:0xf
  v_dot2c_f32_bf16_dpp v14, v33, v43 row_newbcast:0 row_mask:0xf bank_mask:0xf
  v_dot2c_f32_bf16_dpp v15, v36, v43 row_newbcast:0 row_mask:0xf bank_mask:0xf
  s_cmp_lg_u32 s59, 37
  s_cbranch_scc1 L_vs_61
  s_call_b64 s[62:63], L_hand
L_vs_61:
  v_add_u32_dpp v3, v32, v38 row_newbcast:5 row_mask:0xf bank_mask:0xf
  s_waitcnt vmcnt(3)
  buffer_load_dwordx4 v[60:63], v3, s[48:51], 0 offen nt
  v_dot2c_f32_bf16_dpp v8, v33, v44 row_newbcast:1 row_mask:0xf bank_mask:0xf
  v_dot2c_f32_bf16_dpp v9, v36, v44 row_newbcast:1 row_mask:0xf bank_mask:0xf
  v_dot2c_f32_bf16_dpp v10, v33, v45 row_newbcast:1 row_mask:0xf bank_mask:0xf
  v_dot2c_f32_bf16_dpp v11, v36, v45 row_newbcast:1 row_mask:0xf bank_mask:0xf
  v_dot2c_f32_bf16_dpp v12, v33, v46 row_newbcast:1 row_mask:0xf bank_mask:0xf
  v_dot2c_f32_bf16_dpp v13, v36, v46 row_newbcast:1 row_mask:0xf bank_mask:0xf
  v_dot2c_f32_bf16_dpp v14, v33, v47 row_newbcast:1 row_mask:0xf bank_mask:0xf
  v_dot2c_f32_bf16_dpp v15, v36, v47 row_newbcast:1 row_mask:0xf bank_mask:0xf
  s_cmp_lg_u32 s59, 38
  s_cbranch_scc1 L_vs_62
  s_call_b64 s[62:63], L_hand
L_vs_62:
  v_add_u32_dpp v3, v32, v38 row_newbcast:6 row_mask:0xf bank_mask:0xf
  s_waitcnt vmcnt(3)
  buffer_load_dwordx4 v[64:67], v3, s[48:51], 0 offen nt
  v_dot2c_f32_bf16_dpp v8, v33, v48 row_newbcast:2 row_mask:0xf bank_mask:0xf
  v_dot2c_f32_bf16_dpp v9, v36, v48 row_newbcast:2 row_mask:0xf bank_mask:0xf
  v_dot2c_f32_bf16_dpp v10, v33, v49 row_newbcast:2 row_mask:0xf bank_mask:0xf
  v_dot2c_f32_bf16_dpp v11, v36, v49 row_newbcast:2 row_mask:0xf bank_mask:0xf
  v_dot2c_f32_bf16_dpp v12, v33, v50 row_newbcast:2 row_mask:0xf bank_mask:0xf
  v_dot2c_f32_bf16_dpp v13, v36, v50 row_newbcast:2 row_mask:0xf bank_mask:0xf
  v_dot2c_f32_bf16_dpp v14, v33, v51 row_newbcast:2 row_mask:0xf bank_mask:0xf
  v_dot2c_f32_bf16_dpp v15, v36, v51 row_newbcast:2 row_mask:0xf bank_mask:0xf
  s_cmp_lg_u32 s59, 39
  s_cbranch_scc1 L_vs_63
  s_call_b64 s[62:63], L_hand
L_vs_63:
  v_add_u32_dpp v3, v32, v38 row_newbcast:7 row_mask:0xf bank_mask:0xf
  s_waitcnt vmcnt(3)
  buffer_load_dwordx4 v[68:71], v3, s[48:51], 0 offen nt
  v_dot2c_f32_bf16_dpp v8, v33, v52 row_newbcast:3 row_mask:0xf bank_mask:0xf
  v_dot2c_f32_bf16_dpp v9, v36, v52 row_newbcast:3 row_mask:0xf bank_mask:0xf
  v_dot2c_f32_bf16_dpp v10, v33, v53 row_newbcast:3 row_mask:0xf bank_mask:0xf
  v_dot2c_f32_bf16_dpp v11, v36, v53 row_newbcast:3 row_mask:0xf bank_mask:0xf
  v_dot2c_f32_bf16_dpp v12, v33, v54 row_newbcast:3 row_mask:0xf bank_mask:0xf
  v_dot2c_f32_bf16_dpp v13, v36, v54 row_newbcast:3 row_mask:0xf bank_mask:0xf
  v_dot2c_f32_bf16_dpp v14, v33, v55 row_newbcast:3 row_mask:0xf bank_mask:0xf
  v_dot2c_f32_bf16_dpp v15, v36, v55 row_newbcast:3 row_mask:0xf bank_mask:0xf
  s_cmp_lg_u32 s59, 40
  s_cbranch_scc1 L_vs_64
  s_call_b64 s[62:63], L_hand
L_vs_64:
  s_endpgm
L_sc0:
  v_dot2_f32_bf16 v8, v40, v4, 0
  v_dot2_f32_bf16 v9, v44, v4, 0
  v_dot2_f32_bf16 v10, v48, v4, 0
  v_dot2_f32_bf16 v11, v52, v4, 0
  v_dot2_f32_bf16 v12, v56, v4, 0
  v_dot2_f32_bf16 v13, v60, v4, 0
  v_dot2_f32_bf16 v14, v64, v4, 0
  v_dot2_f32_bf16 v15, v68, v4, 0
  v_dot2_f32_bf16 v8, v41, v5, v8
  v_dot2_f32_bf16 v9, v45, v5, v9
  v_dot2_f32_bf16 v10, v49, v5, v10
  v_dot2_f32_bf16 v11, v53, v5, v11
  v_dot2_f32_bf16 v12, v57, v5, v12
  v_dot2_f32_bf16 v13, v61, v5, v13
  v_dot2_f32_bf16 v14, v65, v5, v14
  v_dot2_f32_bf16 v15, v69, v5, v15
  v_dot2_f32_bf16 v8, v42, v6, v8
  v_dot2_f32_bf16 v9, v46, v6, v9
  v_dot2_f32_bf16 v10, v50, v6, v10
  v_dot2_f32_bf16 v11, v54, v6, v11
  v_dot2_f32_bf16 v12, v58, v6, v12
  v_dot2_f32_bf16 v13, v62, v6, v13
  v_dot2_f32_bf16 v14, v66, v6, v14
  v_dot2_f32_bf16 v15, v70, v6, v15
  v_dot2_f32_bf16 v8, v43, v7, v8
  v_dot2_f32_bf16 v9, v47, v7, v9
  v_dot2_f32_bf16 v10, v51, v7, v10
  v_dot2_f32_bf16 v11, v55, v7, v11
  v_dot2_f32_bf16 v12, v59, v7, v12
  v_dot2_f32_bf16 v13, v63, v7, v13
  v_dot2_f32_bf16 v14, v67, v7, v14
  v_dot2_f32_bf16 v15, v71, v7, v15
  s_nop 0
  v_add_f32_dpp v8, v8, v8 row_ror:8 row_mask:0xf bank_mask:0x3
  v_add_f32_dpp v8, v9, v9 row_ror:8 row_mask:0xf bank_mask:0xc
  v_add_f32_dpp v10, v10, v10 row_ror:8 row_mask:0xf bank_mask:0x3
  v_add_f32_dpp v10, v11, v11 row_ror:8 row_mask:0xf bank_mask:0xc
  v_add_f32_dpp v12, v12, v12 row_ror:8 row_mask:0xf bank_mask:0x3
  v_add_f32_dpp v12, v13, v13 row_ror:8 row_mask:0xf bank_mask:0xc
  v_add_f32_dpp v14, v14, v14 row_ror:8 row_mask:0xf bank_mask:0x3
  v_add_f32_dpp v14, v15, v15 row_ror:8 row_mask:0xf bank_mask:0xc
  v_add_f32_dpp v16, v8, v8 row_shl:4 row_mask:0xf bank_mask:0x5
  v_add_f32_dpp v16, v10, v10 row_shr:4 row_mask:0xf bank_mask:0xa
  v_add_f32_dpp v17, v12, v12 row_shl:4 row_mask:0xf bank_mask:0x5
  v_add_f32_dpp v17, v14, v14 row_shr:4 row_mask:0xf bank_mask:0xa
  v_dot2_f32_bf16 v8, v72, v4, 0
  v_dot2_f32_bf16 v9, v76, v4, 0
  v_dot2_f32_bf16 v10, v80, v4, 0
  v_dot2_f32_bf16 v11, v84, v4, 0
  v_dot2_f32_bf16 v12, v88, v4, 0
  v_dot2_f32_bf16 v13, v92, v4, 0
  v_dot2_f32_bf16 v14, v96, v4, 0
  v_dot2_f32_bf16 v15, v100, v4, 0
  v_dot2_f32_bf16 v8, v73, v5, v8
  v_dot2_f32_bf16 v9, v77, v5, v9
  v_dot2_f32_bf16 v10, v81, v5, v10
  v_dot2_f32_bf16 v11, v85, v5, v11
  v_dot2_f32_bf16 v12, v89, v5, v12
  v_dot2_f32_bf16 v13, v93, v5, v13
  v_dot2_f32_bf16 v14, v97, v5, v14
  v_dot2_f32_bf16 v15, v101, v5, v15
  v_dot2_f32_bf16 v8, v74, v6, v8
  v_dot2_f32_bf16 v9, v78, v6, v9
  v_dot2_f32_bf16 v10, v82, v6, v10
  v_dot2_f32_bf16 v11, v86, v6, v11
  v_dot2_f32_bf16 v12, v90, v6, v12
  v_dot2_f32_bf16 v13, v94, v6, v13
  v_dot2_f32_bf16 v14, v98, v6, v14
  v_dot2_f32_bf16 v15, v102, v6, v15
  v_dot2_f32_bf16 v8, v75, v7, v8
  v_dot2_f32_bf16 v9, v79, v7, v9
  v_dot2_f32_bf16 v10, v83, v7, v10
  v_dot2_f32_bf16 v11, v87, v7, v11
  v_dot2_f32_bf16 v12, v91, v7, v12
  v_dot2_f32_bf16 v13, v95, v7, v13
  v_dot2_f32_bf16 v14, v99, v7, v14
  v_dot2_f32_bf16 v15, v103, v7, v15
  s_nop 0
  v_add_f32_dpp v8, v8, v8 row_ror:8 row_mask:0xf bank_mask:0x3
  v_add_f32_dpp v8, v9, v9 row_ror:8 row_mask:0xf bank_mask:0xc
  v_add_f32_dpp v10, v10, v10 row_ror:8 row_mask:0xf bank_mask:0x3
  v_add_f32_dpp v10, v11, v11 row_ror:8 row_mask:0xf bank_mask:0xc
  v_add_f32_dpp v12, v12, v12 row_ror:8 row_mask:0xf bank_mask:0x3
  v_add_f32_dpp v12, v13, v13 row_ror:8 row_mask:0xf bank_mask:0xc
  v_add_f32_dpp v14, v14, v14 row_ror:8 row_mask:0xf bank_mask:0x3
  v_add_f32_dpp v14, v15, v15 row_ror:8 row_mask:0xf bank_mask:0xc
  v_add_f32_dpp v18, v8, v8 row_shl:4 row_mask:0xf bank_mask:0x5
  v_add_f32_dpp v18, v10, v10 row_shr:4 row_mask:0xf bank_mask:0xa
  v_add_f32_dpp v19, v12, v12 row_shl:4 row_mask:0xf bank_mask:0x5
  v_add_f32_dpp v19, v14, v14 row_shr:4 row_mask:0xf bank_mask:0xa
  s_nop 1
  v_add_f32_dpp v16, v16, v16 quad_perm:[2,3,0,1] row_mask:0xf bank_mask:0xf
  v_add_f32_dpp v17, v17, v17 quad_perm:[2,3,0,1] row_mask:0xf bank_mask:0xf
  v_add_f32_dpp v18, v18, v18 quad_perm:[2,3,0,1] row_mask:0xf bank_mask:0xf
  v_add_f32_dpp v19, v19, v19 quad_perm:[2,3,0,1] row_mask:0xf bank_mask:0xf
  v_cndmask_b32 v8, v16, v17, s[52:53]
  v_cndmask_b32 v9, v18, v19, s[52:53]
  v_mov_b32 v3, 0
  v_lshlrev_b32 v21, 3, s9
  v_add_f32_dpp v8, v8, v8 quad_perm:[1,0,3,2] row_mask:0xf bank_mask:0xf
  v_add_f32_dpp v9, v9, v9 quad_perm:[1,0,3,2] row_mask:0xf bank_mask:0xf
  v_cndmask_b32 v25, v8, v9, s[54:55]
  v_cvt_pk_bf16_f32 v25, 0, v25
  v_mul_f32 v25, 0x3db504f3, v25
  v_cvt_pk_bf16_f32 v25, 0, v25
  ds_max_f32 v21, v25 offset:6912
  ds_read_b32 v37, v21 offset:6912
  s_waitcnt lgkmcnt(0)
  v_add_f32 v21, 0xc24c0000, v37
  v_cmp_nlt_f32 vcc, v25, v21
  s_lshl_b32 s68, s58, 3
  s_add_u32 s68, s68, s15
  s_mov_b64 s[64:65], vcc
  v_mbcnt_lo_u32_b32 v3, s64, 0
  v_mbcnt_hi_u32_b32 v3, s65, v3
  s_bcnt1_i32_b64 s69, s[64:65]
  v_lshl_add_u32 v3, v3, 3, s68
  s_mov_b64 exec, s[64:65]
  ds_write_b64 v3, v[24:25]
  s_mov_b64 exec, -1
  s_add_u32 s58, s58, s69
  s_max_u32 s58, s58, 16
  ds_read_b64 v[28:29], v39 offset:0
  s_waitcnt lgkmcnt(0)
  s_setpc_b64 s[62:63]
L_hand:
  s_cmp_lg_u32 s60, 0
  s_cbranch_scc1 L_epi
  v_mov_b32 v3, 0
  s_mov_b32 s70, 0
L_hp:
  ds_read_b64 v[18:19], v3 offset:6672
  s_waitcnt lgkmcnt(0)
  v_cmp_gt_u32 vcc, 0x10200, v18
  s_cmp_eq_u64 vcc, 0
  s_cbranch_scc1 L_hpd
  s_sleep 1
  s_add_u32 s70, s70, 1
  s_cmp_lt_u32 s70, 1048576
  s_cbranch_scc1 L_hp
L_hpd:
  v_add_f32 v21, 0xc2ba0000, v19
  v_cmp_nlt_f32 vcc, v25, v21
  s_lshl_b32 s68, s58, 3
  s_add_u32 s68, s68, s15
  s_andn2_b64 s[64:65], vcc, s[64:65]
  v_mbcnt_lo_u32_b32 v3, s64, 0
  v_mbcnt_hi_u32_b32 v3, s65, v3
  s_bcnt1_i32_b64 s69, s[64:65]
  v_lshl_add_u32 v3, v3, 3, s68
  s_mov_b64 exec, s[64:65]
  ds_write_b64 v3, v[24:25]
  s_mov_b64 exec, -1
  s_add_u32 s58, s58, s69
  v_cmp_nlt_f32 vcc, v27, v21
  s_lshl_b32 s68, s58, 3
  s_add_u32 s68, s68, s15
  s_andn2_b64 s[66:67], vcc, s[66:67]
  v_mbcnt_lo_u32_b32 v3, s66, 0
  v_mbcnt_hi_u32_b32 v3, s67, v3
  s_bcnt1_i32_b64 s69, s[66:67]
  v_lshl_add_u32 v3, v3, 3, s68
  s_mov_b64 exec, s[66:67]
  ds_write_b64 v3, v[26:27]
  s_mov_b64 exec, -1
  s_add_u32 s58, s58, s69
  v_sub_f32 v23, v37, v19
  v_mul_f32 v23, 0x3fb8aa3b, v23
  v_exp_f32 v23, v23
  v_lshrrev_b32 v16, 4, v1
  v_lshl_add_u32 v22, v38, 1, s11
  v_lshl_add_u32 v22, v16, 3, v22
  s_add_u32 s59, s58, 19
  s_lshr_b32 s59, s59, 2
  s_mov_b32 s60, 1
  ds_read_b64 v[28:29], v39 offset:0
  ds_read_b64 v[30:31], v39 offset:512
  ds_read_b64 v[32:33], v39 offset:1024
  s_waitcnt lgkmcnt(0)
  v_sub_f32 v29, v29, v37
  v_sub_f32 v31, v31, v37
  v_sub_f32 v33, v33, v37
  v_mul_f32 v29, 0x3fb8aa3b, v29
  v_mul_f32 v31, 0x3fb8aa3b, v31
  v_mul_f32 v33, 0x3fb8aa3b, v33
  v_exp_f32 v29, v29
  v_exp_f32 v31, v31
  v_exp_f32 v33, v33
  s_nop 0
  v_cvt_pk_bf16_f32 v34, 0, v29
  v_cvt_pk_bf16_f32 v35, 0, v31
  v_cvt_pk_bf16_f32 v36, 0, v33
  v_cvt_pk_bf16_f32 v29, v29, 0
  v_cvt_pk_bf16_f32 v31, v31, 0
  v_cvt_pk_bf16_f32 v33, v33, 0
  s_nop 1
  s_setpc_b64 s[62:63]
L_epi:
  s_nop 0
  v_permlane32_swap_b32 v8, v12
  v_permlane32_swap_b32 v9, v13
  v_permlane32_swap_b32 v10, v14
  v_permlane32_swap_b32 v11, v15
  v_add_f32 v8, v8, v12
  v_add_f32 v9, v9, v13
  v_add_f32 v10, v10, v14
  v_add_f32 v11, v11, v15
  s_nop 0
  v_permlane16_swap_b32 v8, v10
  v_permlane16_swap_b32 v9, v11
  v_add_f32 v8, v8, v10
  v_add_f32 v9, v9, v11
  v_mul_f32 v8, v8, v23
  v_mul_f32 v9, v9, v23
  ds_write_b64 v22, v[8:9] offset:11008
  s_waitcnt lgkmcnt(0)
L_send:
  s_endpgm
L_helper:
  v_mov_b32 v4, -1
  v_mov_b32 v5, -1
  v_mov_b32 v6, -1
  v_mov_b32 v7, -1
  v_mov_b32 v8, 0xff800000
  v_mov_b32 v9, 0
  v_lshlrev_b32 v2, 3, v1
  ds_write_b64 v2, v[8:9] offset:6912
  v_lshlrev_b32 v2, 2, v1
  ds_write_b32 v2, v4 offset:6400
  v_mov_b32 v38, 0
  ds_write_b128 v38, v[4:7] offset:6656
  ds_write_b32 v38, v38 offset:6720
  v_mov_b32 v39, 0xff800000
  ds_write_b64 v38, v[38:39] offset:6672
  s_getreg_b32 s76, hwreg(HW_REG_XCC_ID, 0, 4)
  v_lshrrev_b32 v12, 3, v0
  v_lshlrev_b32 v12, 5, v12
  v_bfe_u32 v3, v1, 2, 1
  v_lshl_add_u32 v12, v3, 10, v12
  v_and_b32 v8, 3, v1
  v_lshl_add_u32 v13, v8, 3, v12
  v_and_b32 v12, 0xffffffdf, v12
  v_lshl_add_u32 v12, v8, 4, v12
  v_bfe_u32 v8, v1, 3, 1
  v_lshl_add_u32 v12, v8, 3, v12
  v_lshl_add_u32 v12, v3, 5, v12
  s_waitcnt lgkmcnt(0)
  s_load_dword s74, s[42:43], 0
  s_cmp_eq_u32 s13, 2
  s_cbranch_scc1 L_r_q
  s_cmp_eq_u32 s13, 1
  s_cbranch_scc1 L_r_moda
  s_load_dword s14, s[56:57], s3
  s_barrier
  s_waitcnt lgkmcnt(0)
  s_and_b32 s13, s14, 7
  s_bfe_u32 s61, s14, 0x80008
  s_lshr_b32 s59, s14, 24
  s_lshl_b32 s59, s59, 10
  s_cmp_eq_u32 s13, 1
  s_cbranch_scc1 L_r_wo
  s_cmp_eq_u32 s13, 4
  s_cbranch_scc1 L_r_modb
  s_cmp_eq_u32 s13, 2
  s_cbranch_scc1 L_r_f1
  s_cmp_eq_u32 s13, 3
  s_cbranch_scc1 L_r_f2
  s_branch L_r_none
L_r_moda:
  s_lshr_b32 s48, s61, 3
  s_lshl_b32 s48, s48, 1
  s_add_u32 s49, s61, 3
  s_sub_u32 s49, s49, s48
  s_and_b32 s49, s49, 7
  s_and_b32 s61, s61, 8
  s_or_b32 s61, s61, s49
  s_lshl_b32 s48, s61, 7
  s_lshl_b32 s58, s61, 9
  s_add_u32 s58, s58, 4096
  s_mov_b32 s44, s36
  s_mov_b32 s45, s37
  s_mov_b32 s46, 3145728
  s_mov_b32 s47, 0x20000
  global_load_dwordx2 v[14:15], v13, s[34:35]
  v_lshrrev_b32 v2, 3, v1
  v_and_b32 v3, 6, v2
  v_xor_b32 v3, v3, v1
  v_mul_u32_u24 v2, 6144, v2
  v_and_b32 v3, 7, v3
  v_lshl_add_u32 v2, v3, 4, v2
  s_mul_i32 s49, s5, 786432
  s_lshl_b32 s50, s5, 14
  s_add_u32 s49, s49, s48
  s_add_u32 s50, s50, 16384
  s_add_u32 s51, s50, 16384
L_dma_65:
  s_mov_b32 m0, s50
  s_add_u32 s50, s50, 1024
  buffer_load_dwordx4 v2, s[44:47], s49 offen nt lds
  s_add_u32 s49, s49, 49152
  s_cmp_lt_u32 s50, s51
  s_cbranch_scc1 L_dma_65
L_dmae_66:
  s_barrier
  s_waitcnt lgkmcnt(0)
  s_mul_i32 s74, s74, 0x9e3779b1
  s_add_u32 s74, s74, 0x7f4a7c15
  s_add_u32 s76, s76, s74
  s_waitcnt vmcnt(16)
  s_cmp_lg_u32 s5, 3
  s_cbranch_scc1 L_sig_67
  s_and_b32 s56, s2, 7
  s_lshl_b32 s56, s56, 5
  s_lshr_b32 s57, s2, 3
  s_add_u32 s56, s56, s57
  s_lshl_b32 s56, s56, 2
  v_mov_b32 v8, s56
  v_mov_b32 v9, s76
  s_mov_b64 exec, 1
  global_store_dword v8, v9, s[42:43] offset:1024 sc1
  s_mov_b64 exec, -1
L_sig_67:
  v_lshlrev_b32 v16, 16, v14
  v_and_b32 v17, s73, v14
  v_lshlrev_b32 v18, 16, v15
  v_and_b32 v19, s73, v15
  v_mul_f32 v20, 0xbfb8aa3b, v16
  v_mul_f32 v21, 0xbfb8aa3b, v17
  v_mul_f32 v22, 0xbfb8aa3b, v18
  v_mul_f32 v23, 0xbfb8aa3b, v19
  v_exp_f32 v20, v20
  v_exp_f32 v21, v21
  v_exp_f32 v22, v22
  v_exp_f32 v23, v23
  s_nop 0
  v_add_f32 v20, 1.0, v20
  v_add_f32 v21, 1.0, v21
  v_add_f32 v22, 1.0, v22
  v_add_f32 v23, 1.0, v23
  v_rcp_f32 v20, v20
  v_rcp_f32 v21, v21
  v_rcp_f32 v22, v22
  v_rcp_f32 v23, v23
  s_nop 0
  v_mul_f32 v16, v16, v20
  v_mul_f32 v17, v17, v21
  v_mul_f32 v18, v18, v22
  v_mul_f32 v19, v19, v23
  v_cvt_pk_bf16_f32 v14, v16, v17
  v_cvt_pk_bf16_f32 v15, v18, v19
  ds_write_b64 v12, v[14:15] offset:0
  v_and_b32 v13, 1, v1
  v_lshlrev_b32 v13, 6, v13
  v_lshrrev_b32 v3, 4, v1
  v_lshl_add_u32 v13, v3, 4, v13
  s_lshl_b32 s49, s5, 7
  s_add_u32 s49, s49, s58
  v_add_u32 v13, s49, v13
  v_and_b32 v14, 1, v1
  v_mul_u32_u24 v14, 1056, v14
  v_lshrrev_b32 v3, 4, v1
  v_lshl_add_u32 v14, v3, 4, v14
  v_lshrrev_b32 v2, 2, v1
  v_bfe_u32 v3, v1, 1, 1
  s_lshl_b32 s49, s5, 1
  v_or_b32 v3, s49, v3
  v_and_b32 v10, 6, v2
  v_xor_b32 v3, v3, v10
  v_lshlrev_b32 v2, 7, v2
  v_lshl_add_u32 v2, v3, 4, v2
  v_and_b32 v3, 1, v1
  v_lshl_add_u32 v2, v3, 3, v2
  v_add_u32 v2, 16384, v2
  s_waitcnt vmcnt(0) lgkmcnt(0)
  v_mov_b32 v9, 1
  s_mov_b64 exec, 1
  ds_add_u32 v38, v9 offset:6720
  s_mov_b64 exec, -1
  s_mov_b32 s70, 0
L_hs_68:
  ds_read_b32 v9, v38 offset:6720
  s_waitcnt lgkmcnt(0)
  v_cmp_gt_u32 vcc, 4, v9
  s_cmp_eq_u64 vcc, 0
  s_cbranch_scc1 L_hsd_69
  s_add_u32 s70, s70, 1
  s_cmp_lt_u32 s70, 2097152
  s_cbranch_scc1 L_hs_68
L_hsd_69:
  ds_read_b64_tr_b16 v[40:41], v2 offset:0
  ds_read_b64_tr_b16 v[42:43], v2 offset:2048
  ds_read_b128 v[104:107], v14 offset:0
  ds_read_b64_tr_b16 v[44:45], v2 offset:4096
  ds_read_b64_tr_b16 v[46:47], v2 offset:6144
  ds_read_b128 v[108:111], v14 offset:64
  ds_read_b64_tr_b16 v[48:49], v2 offset:8192
  ds_read_b64_tr_b16 v[50:51], v2 offset:10240
  ds_read_b128 v[112:115], v14 offset:128
  ds_read_b64_tr_b16 v[52:53], v2 offset:12288
  ds_read_b64_tr_b16 v[54:55], v2 offset:14336
  ds_read_b128 v[116:119], v14 offset:192
  ds_read_b64_tr_b16 v[56:57], v2 offset:16384
  ds_read_b64_tr_b16 v[58:59], v2 offset:18432
  ds_read_b128 v[120:123], v14 offset:256
  s_waitcnt lgkmcnt(12)
  v_mfma_f32_16x16x32_bf16 v[8:11], v[40:43], v[104:107], 0
  ds_read_b64_tr_b16 v[60:61], v2 offset:20480
  ds_read_b64_tr_b16 v[62:63], v2 offset:22528
  ds_read_b128 v[124:127], v14 offset:320
  s_waitcnt lgkmcnt(12)
  v_mfma_f32_16x16x32_bf16 v[8:11], v[44:47], v[108:111], v[8:11]
  ds_read_b64_tr_b16 v[64:65], v2 offset:24576
  ds_read_b64_tr_b16 v[66:67], v2 offset:26624
  ds_read_b128 v[128:131], v14 offset:384
  s_waitcnt lgkmcnt(12)
  v_mfma_f32_16x16x32_bf16 v[8:11], v[48:51], v[112:115], v[8:11]
  ds_read_b64_tr_b16 v[68:69], v2 offset:28672
  ds_read_b64_tr_b16 v[70:71], v2 offset:30720
  ds_read_b128 v[132:135], v14 offset:448
  s_waitcnt lgkmcnt(12)
  v_mfma_f32_16x16x32_bf16 v[8:11], v[52:55], v[116:119], v[8:11]
  ds_read_b64_tr_b16 v[72:73], v2 offset:32768
  ds_read_b64_tr_b16 v[74:75], v2 offset:34816
  ds_read_b128 v[136:139], v14 offset:512
  s_waitcnt lgkmcnt(12)
  v_mfma_f32_16x16x32_bf16 v[8:11], v[56:59], v[120:123], v[8:11]
  ds_read_b64_tr_b16 v[76:77], v2 offset:36864
  ds_read_b64_tr_b16 v[78:79], v2 offset:38912
  ds_read_b128 v[140:143], v14 offset:576
  s_waitcnt lgkmcnt(12)
  v_mfma_f32_16x16x32_bf16 v[8:11], v[60:63], v[124:127], v[8:11]
  ds_read_b64_tr_b16 v[80:81], v2 offset:40960
  ds_read_b64_tr_b16 v[82:83], v2 offset:43008
  ds_read_b128 v[144:147], v14 offset:640
  s_waitcnt lgkmcnt(12)
  v_mfma_f32_16x16x32_bf16 v[8:11], v[64:67], v[128:131], v[8:11]
  ds_read_b64_tr_b16 v[84:85], v2 offset:45056
  ds_read_b64_tr_b16 v[86:87], v2 offset:47104
  ds_read_b128 v[148:151], v14 offset:704
  s_waitcnt lgkmcnt(12)
  v_mfma_f32_16x16x32_bf16 v[8:11], v[68:71], v[132:135], v[8:11]
  ds_read_b64_tr_b16 v[88:89], v2 offset:49152
  ds_read_b64_tr_b16 v[90:91], v2 offset:51200
  ds_read_b128 v[152:155], v14 offset:768
  s_waitcnt lgkmcnt(12)
  v_mfma_f32_16x16x32_bf16 v[8:11], v[72:75], v[136:139], v[8:11]
  ds_read_b64_tr_b16 v[92:93], v2 offset:53248
  ds_read_b64_tr_b16 v[94:95], v2 offset:55296
  ds_read_b128 v[156:159], v14 offset:832
  s_waitcnt lgkmcnt(12)
  v_mfma_f32_16x16x32_bf16 v[8:11], v[76:79], v[140:143], v[8:11]
  ds_read_b64_tr_b16 v[96:97], v2 offset:57344
  ds_read_b64_tr_b16 v[98:99], v2 offset:59392
  ds_read_b128 v[160:163], v14 offset:896
  s_waitcnt lgkmcnt(12)
  v_mfma_f32_16x16x32_bf16 v[8:11], v[80:83], v[144:147], v[8:11]
  ds_read_b64_tr_b16 v[100:101], v2 offset:61440
  ds_read_b64_tr_b16 v[102:103], v2 offset:63488
  ds_read_b128 v[164:167], v14 offset:960
  s_waitcnt lgkmcnt(12)
  v_mfma_f32_16x16x32_bf16 v[8:11], v[84:87], v[148:151], v[8:11]
  s_waitcnt lgkmcnt(9)
  v_mfma_f32_16x16x32_bf16 v[8:11], v[88:91], v[152:155], v[8:11]
  s_waitcnt lgkmcnt(6)
  v_mfma_f32_16x16x32_bf16 v[8:11], v[92:95], v[156:159], v[8:11]
  s_waitcnt lgkmcnt(3)
  v_mfma_f32_16x16x32_bf16 v[8:11], v[96:99], v[160:163], v[8:11]
  s_waitcnt lgkmcnt(0)
  v_mfma_f32_16x16x32_bf16 v[8:11], v[100:103], v[164:167], v[8:11]
  s_nop 7
  v_cvt_pk_bf16_f32 v8, v8, v9
  v_cvt_pk_bf16_f32 v10, v10, v11
  v_mov_b32 v9, s74
  v_mov_b32 v11, s74
  s_mov_b32 exec_lo, 0x00030003
  s_mov_b32 exec_hi, 0x00030003
  global_store_dwordx4 v13, v[8:11], s[42:43] sc1
  s_mov_b64 exec, -1
  ds_write_b32 v38, v38 offset:6660
  s_mov_b32 s60, 0
  s_branch L_svc1
L_r_q:
  s_lshl_b32 s61, s8, 3
  s_lshr_b32 s48, s2, 3
  s_add_u32 s61, s61, s48
  s_lshl_b32 s48, s61, 7
  s_lshl_b32 s58, s61, 8
  s_add_u32 s58, s58, 32768
  global_load_dwordx2 v[14:15], v13, s[16:17]
  s_mov_b32 s44, s22
  s_mov_b32 s45, s23
  s_mov_b32 s46, 4194304
  s_mov_b32 s47, 0x20000
  v_lshrrev_b32 v2, 3, v1
  v_and_b32 v3, 6, v2
  v_xor_b32 v3, v3, v1
  v_mul_u32_u24 v2, 8192, v2
  v_and_b32 v3, 7, v3
  v_lshl_add_u32 v2, v3, 4, v2
  s_mul_i32 s49, s5, 1048576
  s_lshl_b32 s50, s5, 14
  s_add_u32 s49, s49, s48
  s_add_u32 s50, s50, 16384
  s_add_u32 s51, s50, 16384
L_dma_70:
  s_mov_b32 m0, s50
  s_add_u32 s50, s50, 1024
  buffer_load_dwordx4 v2, s[44:47], s49 offen nt lds
  s_add_u32 s49, s49, 65536
  s_cmp_lt_u32 s50, s51
  s_cbranch_scc1 L_dma_70
L_dmae_71:
  s_barrier
  s_waitcnt lgkmcnt(0)
  s_mul_i32 s74, s74, 0x9e3779b1
  s_add_u32 s74, s74, 0x7f4a7c15
  s_add_u32 s76, s76, s74
  s_waitcnt vmcnt(16)
  s_cmp_lg_u32 s5, 3
  s_cbranch_scc1 L_sig_72
  s_and_b32 s56, s2, 7
  s_lshl_b32 s56, s56, 5
  s_lshr_b32 s57, s2, 3
  s_add_u32 s56, s56, s57
  s_lshl_b32 s56, s56, 2
  v_mov_b32 v8, s56
  v_mov_b32 v9, s76
  s_mov_b64 exec, 1
  global_store_dword v8, v9, s[42:43] offset:1024 sc1
  s_mov_b64 exec, -1
L_sig_72:
  v_bfe_u32 v6, v1, 2, 1
  v_lshlrev_b32 v6, 5, v6
  v_add_u32 v6, 15104, v6
  s_lshl_b32 s49, s5, 3
  v_add_u32 v5, s49, v6
  v_lshlrev_b32 v20, 16, v14
  v_and_b32 v21, s73, v14
  v_lshlrev_b32 v22, 16, v15
  v_and_b32 v23, s73, v15
  v_add_f32 v8, v20, v21
  v_mul_f32 v9, v20, v20
  v_add_f32 v10, v22, v23
  v_mul_f32 v11, v22, v22
  v_fmac_f32 v9, v21, v21
  v_fmac_f32 v11, v23, v23
  v_add_f32 v8, v8, v10
  v_add_f32 v9, v9, v11
  s_nop 0
  v_add_f32_dpp v8, v8, v8 quad_perm:[1,0,3,2] row_mask:0xf bank_mask:0xf
  v_add_f32_dpp v9, v9, v9 quad_perm:[1,0,3,2] row_mask:0xf bank_mask:0xf
  s_nop 0
  v_add_f32_dpp v8, v8, v8 quad_perm:[2,3,0,1] row_mask:0xf bank_mask:0xf
  v_add_f32_dpp v9, v9, v9 quad_perm:[2,3,0,1] row_mask:0xf bank_mask:0xf
  s_nop 0
  v_add_f32_dpp v8, v8, v8 row_ror:8 row_mask:0xf bank_mask:0xf
  v_add_f32_dpp v9, v9, v9 row_ror:8 row_mask:0xf bank_mask:0xf
  s_nop 0
  v_mov_b32 v10, v8
  v_mov_b32 v11, v9
  s_nop 0
  v_permlane16_swap_b32 v10, v8
  v_permlane16_swap_b32 v11, v9
  v_add_f32 v8, v8, v10
  v_add_f32 v9, v9, v11
  v_mov_b32 v10, v8
  v_mov_b32 v11, v9
  s_nop 0
  v_permlane32_swap_b32 v10, v8
  v_permlane32_swap_b32 v11, v9
  v_add_f32 v8, v8, v10
  v_add_f32 v9, v9, v11
  ds_write_b64 v5, v[8:9]
  s_waitcnt vmcnt(0) lgkmcnt(0)
  v_mov_b32 v9, 1
  s_mov_b64 exec, 1
  ds_add_u32 v38, v9 offset:6720
  s_mov_b64 exec, -1
  s_mov_b32 s70, 0
L_hs_73:
  ds_read_b32 v9, v38 offset:6720
  s_waitcnt lgkmcnt(0)
  v_cmp_gt_u32 vcc, 4, v9
  s_cmp_eq_u64 vcc, 0
  s_cbranch_scc1 L_hsd_74
  s_sleep 1
  s_add_u32 s70, s70, 1
  s_cmp_lt_u32 s70, 2097152
  s_cbranch_scc1 L_hs_73
L_hsd_74:
  ds_read_b128 v[24:27], v6
  ds_read_b128 v[28:31], v6 offset:16
  s_waitcnt lgkmcnt(0)
  v_pk_add_f32 v[24:25], v[24:25], v[26:27]
  v_pk_add_f32 v[28:29], v[28:29], v[30:31]
  v_pk_add_f32 v[24:25], v[24:25], v[28:29]
  v_mul_f32 v8, 0x3b000000, v24
  v_mul_f32 v9, 0x3b000000, v25
  v_fma_f32 v9, -v8, v8, v9
  v_cvt_pk_bf16_f32 v8, 0, v8
  v_max_f32 v9, 0, v9
  v_cvt_pk_bf16_f32 v9, 0, v9
  v_sub_f32 v20, v20, v8
  v_sub_f32 v21, v21, v8
  v_add_f32 v9, 0x3727c5ac, v9
  v_sub_f32 v22, v22, v8
  v_sub_f32 v23, v23, v8
  v_cvt_pk_bf16_f32 v9, 0, v9
  v_cvt_pk_bf16_f32 v20, 0, v20
  v_sqrt_f32 v9, v9
  v_cvt_pk_bf16_f32 v21, 0, v21
  v_cvt_pk_bf16_f32 v9, 0, v9
  v_cvt_pk_bf16_f32 v22, 0, v22
  v_rcp_f32 v9, v9
  v_cvt_pk_bf16_f32 v23, 0, v23
  v_mul_f32 v20, v20, v9
  v_mul_f32 v21, v21, v9
  v_mul_f32 v22, v22, v9
  v_mul_f32 v23, v23, v9
  v_cvt_pk_bf16_f32 v20, 0, v20
  v_cvt_pk_bf16_f32 v21, 0, v21
  v_cvt_pk_bf16_f32 v22, 0, v22
  v_cvt_pk_bf16_f32 v23, 0, v23
  v_lshrrev_b32 v2, 2, v1
  v_bfe_u32 v3, v1, 1, 1
  s_lshl_b32 s49, s5, 1
  v_or_b32 v3, s49, v3
  v_and_b32 v10, 6, v2
  v_xor_b32 v3, v3, v10
  v_lshlrev_b32 v2, 7, v2
  v_lshl_add_u32 v2, v3, 4, v2
  v_and_b32 v3, 1, v1
  v_lshl_add_u32 v2, v3, 3, v2
  v_add_u32 v2, 16384, v2
  ds_read_b64_tr_b16 v[40:41], v2 offset:0
  ds_read_b64_tr_b16 v[42:43], v2 offset:2048
  ds_read_b64_tr_b16 v[44:45], v2 offset:4096
  ds_read_b64_tr_b16 v[46:47], v2 offset:6144
  ds_read_b64_tr_b16 v[48:49], v2 offset:8192
  ds_read_b64_tr_b16 v[50:51], v2 offset:10240
  ds_read_b64_tr_b16 v[52:53], v2 offset:12288
  ds_read_b64_tr_b16 v[54:55], v2 offset:14336
  ds_read_b64_tr_b16 v[56:57], v2 offset:16384
  ds_read_b64_tr_b16 v[58:59], v2 offset:18432
  ds_read_b64_tr_b16 v[60:61], v2 offset:20480
  ds_read_b64_tr_b16 v[62:63], v2 offset:22528
  s_waitcnt lgkmcnt(10)
  ds_read_b64_tr_b16 v[64:65], v2 offset:24576
  ds_read_b64_tr_b16 v[66:67], v2 offset:26624
  s_waitcnt lgkmcnt(10)
  ds_read_b64_tr_b16 v[68:69], v2 offset:28672
  ds_read_b64_tr_b16 v[70:71], v2 offset:30720
  s_waitcnt lgkmcnt(10)
  ds_read_b64_tr_b16 v[72:73], v2 offset:32768
  ds_read_b64_tr_b16 v[74:75], v2 offset:34816
  s_waitcnt lgkmcnt(10)
  ds_read_b64_tr_b16 v[76:77], v2 offset:36864
  ds_read_b64_tr_b16 v[78:79], v2 offset:38912
  s_waitcnt lgkmcnt(10)
  ds_read_b64_tr_b16 v[80:81], v2 offset:40960
  ds_read_b64_tr_b16 v[82:83], v2 offset:43008
  s_waitcnt lgkmcnt(10)
  ds_read_b64_tr_b16 v[84:85], v2 offset:45056
  ds_read_b64_tr_b16 v[86:87], v2 offset:47104
  s_waitcnt lgkmcnt(10)
  ds_read_b64_tr_b16 v[88:89], v2 offset:49152
  ds_read_b64_tr_b16 v[90:91], v2 offset:51200
  s_waitcnt lgkmcnt(10)
  ds_read_b64_tr_b16 v[92:93], v2 offset:53248
  ds_read_b64_tr_b16 v[94:95], v2 offset:55296
  s_waitcnt lgkmcnt(10)
  ds_read_b64_tr_b16 v[96:97], v2 offset:57344
  ds_read_b64_tr_b16 v[98:99], v2 offset:59392
  s_waitcnt lgkmcnt(10)
  ds_read_b64_tr_b16 v[100:101], v2 offset:61440
  ds_read_b64_tr_b16 v[102:103], v2 offset:63488
  s_waitcnt lgkmcnt(10)
  s_waitcnt lgkmcnt(0)
  v_and_b32 v13, 1, v1
  v_lshlrev_b32 v13, 14, v13
  v_lshrrev_b32 v3, 4, v1
  v_lshl_add_u32 v13, v3, 4, v13
  s_lshl_b32 s49, s5, 6
  s_add_u32 s49, s49, s58
  v_add_u32 v13, s49, v13
  v_and_b32 v14, 1, v1
  v_mul_u32_u24 v14, 1056, v14
  v_lshrrev_b32 v3, 4, v1
  v_lshl_add_u32 v14, v3, 4, v14
  v_lshlrev_b32 v15, 4, v0
  v_add_u32 v15, 4096, v15
  v_add_u32 v36, 0x1000, v15
  s_and_b32 s71, s2, 7
  s_lshl_b32 s71, s71, 7
  s_add_u32 s71, s71, 1024
  v_and_b32 v8, 31, v1
  v_lshl_add_u32 v8, v8, 2, s71
  s_mov_b64 s[64:65], -1
  s_mov_b64 s[66:67], -1
  s_mov_b32 s70, 0
L_q_p:
  s_mov_b64 exec, s[64:65]
  global_load_dwordx4 v[16:19], v15, s[42:43] sc1
  s_mov_b64 exec, s[66:67]
  global_load_dwordx4 v[32:35], v36, s[42:43] sc1
  s_mov_b64 exec, -1
  global_load_dword v9, v8, s[42:43] sc1
  s_waitcnt vmcnt(0)
  v_cmp_ne_u32 s[64:65], s74, v17
  v_cmp_ne_u32 s[68:69], s74, v19
  s_or_b64 s[64:65], s[64:65], s[68:69]
  v_cmp_ne_u32 s[66:67], s74, v33
  v_cmp_ne_u32 s[68:69], s74, v35
  s_or_b64 s[66:67], s[66:67], s[68:69]
  s_or_b64 vcc, s[64:65], s[66:67]
  s_cmp_eq_u64 vcc, 0
  s_cbranch_scc1 L_q_ok
  s_add_u32 s70, s70, 1
  s_cmp_lt_u32 s70, 262144
  s_cbranch_scc1 L_q_p
L_q_ok:
  v_cmp_ne_u32 vcc, s76, v9
  s_cmp_eq_u64 vcc, 0
  s_cselect_b32 s75, 1, 0
  ds_write_b32 v38, v38 offset:6660
  v_lshlrev_b32 v28, 16, v32
  v_and_b32 v29, s73, v32
  v_lshlrev_b32 v30, 16, v34
  v_and_b32 v31, s73, v34
  v_lshlrev_b32 v24, 16, v16
  v_and_b32 v25, s73, v16
  v_lshlrev_b32 v26, 16, v18
  v_and_b32 v27, s73, v18
  v_add_f32 v28, 1.0, v28
  v_add_f32 v29, 1.0, v29
  v_add_f32 v30, 1.0, v30
  v_add_f32 v31, 1.0, v31
  v_cvt_pk_bf16_f32 v28, 0, v28
  v_cvt_pk_bf16_f32 v29, 0, v29
  v_cvt_pk_bf16_f32 v30, 0, v30
  v_cvt_pk_bf16_f32 v31, 0, v31
  v_mul_f32 v20, v20, v28
  v_mul_f32 v21, v21, v29
  v_mul_f32 v22, v22, v30
  v_mul_f32 v23, v23, v31
  v_cvt_pk_bf16_f32 v20, 0, v20
  v_cvt_pk_bf16_f32 v21, 0, v21
  v_cvt_pk_bf16_f32 v22, 0, v22
  v_cvt_pk_bf16_f32 v23, 0, v23
  v_add_f32 v20, v20, v24
  v_add_f32 v21, v21, v25
  v_add_f32 v22, v22, v26
  v_add_f32 v23, v23, v27
  v_cvt_pk_bf16_f32 v16, v20, v21
  v_cvt_pk_bf16_f32 v17, v22, v23
  ds_write_b64 v12, v[16:17] offset:0
  v_mov_b32 v9, 1
  s_mov_b64 exec, 1
  ds_add_u32 v38, v9 offset:6720
  s_mov_b64 exec, -1
  s_mov_b32 s70, 0
L_hs_75:
  ds_read_b32 v9, v38 offset:6720
  s_waitcnt lgkmcnt(0)
  v_cmp_gt_u32 vcc, 8, v9
  s_cmp_eq_u64 vcc, 0
  s_cbranch_scc1 L_hsd_76
  s_add_u32 s70, s70, 1
  s_cmp_lt_u32 s70, 2097152
  s_cbranch_scc1 L_hs_75
L_hsd_76:
  ds_read_b128 v[104:107], v14 offset:0
  ds_read_b128 v[108:111], v14 offset:64
  ds_read_b128 v[112:115], v14 offset:128
  ds_read_b128 v[116:119], v14 offset:192
  ds_read_b128 v[120:123], v14 offset:256
  ds_read_b128 v[124:127], v14 offset:320
  ds_read_b128 v[128:131], v14 offset:384
  ds_read_b128 v[132:135], v14 offset:448
  ds_read_b128 v[136:139], v14 offset:512
  ds_read_b128 v[140:143], v14 offset:576
  ds_read_b128 v[144:147], v14 offset:640
  ds_read_b128 v[148:151], v14 offset:704
  s_waitcnt lgkmcnt(11)
  v_mfma_f32_16x16x32_bf16 v[8:11], v[40:43], v[104:107], 0
  ds_read_b128 v[152:155], v14 offset:768
  s_waitcnt lgkmcnt(11)
  v_mfma_f32_16x16x32_bf16 v[8:11], v[44:47], v[108:111], v[8:11]
  ds_read_b128 v[156:159], v14 offset:832
  s_waitcnt lgkmcnt(11)
  v_mfma_f32_16x16x32_bf16 v[8:11], v[48:51], v[112:115], v[8:11]
  ds_read_b128 v[160:163], v14 offset:896
  s_waitcnt lgkmcnt(11)
  v_mfma_f32_16x16x32_bf16 v[8:11], v[52:55], v[116:119], v[8:11]
  ds_read_b128 v[164:167], v14 offset:960
  s_waitcnt lgkmcnt(11)
  v_mfma_f32_16x16x32_bf16 v[8:11], v[56:59], v[120:123], v[8:11]
  s_waitcnt lgkmcnt(10)
  v_mfma_f32_16x16x32_bf16 v[8:11], v[60:63], v[124:127], v[8:11]
  s_waitcnt lgkmcnt(9)
  v_mfma_f32_16x16x32_bf16 v[8:11], v[64:67], v[128:131], v[8:11]
  s_waitcnt lgkmcnt(8)
  v_mfma_f32_16x16x32_bf16 v[8:11], v[68:71], v[132:135], v[8:11]
  s_waitcnt lgkmcnt(7)
  v_mfma_f32_16x16x32_bf16 v[8:11], v[72:75], v[136:139], v[8:11]
  s_waitcnt lgkmcnt(6)
  v_mfma_f32_16x16x32_bf16 v[8:11], v[76:79], v[140:143], v[8:11]
  s_waitcnt lgkmcnt(5)
  v_mfma_f32_16x16x32_bf16 v[8:11], v[80:83], v[144:147], v[8:11]
  s_waitcnt lgkmcnt(4)
  v_mfma_f32_16x16x32_bf16 v[8:11], v[84:87], v[148:151], v[8:11]
  s_waitcnt lgkmcnt(3)
  v_mfma_f32_16x16x32_bf16 v[8:11], v[88:91], v[152:155], v[8:11]
  s_waitcnt lgkmcnt(2)
  v_mfma_f32_16x16x32_bf16 v[8:11], v[92:95], v[156:159], v[8:11]
  s_waitcnt lgkmcnt(1)
  v_mfma_f32_16x16x32_bf16 v[8:11], v[96:99], v[160:163], v[8:11]
  s_waitcnt lgkmcnt(0)
  v_mfma_f32_16x16x32_bf16 v[8:11], v[100:103], v[164:167], v[8:11]
  s_nop 7
  v_cvt_pk_bf16_f32 v8, v8, v9
  v_cvt_pk_bf16_f32 v10, v10, v11
  v_mov_b32 v9, s74
  v_mov_b32 v11, s74
  v_min_u32 v8, s72, v8
  v_min_u32 v10, s72, v10
  s_mov_b32 exec_lo, 0x00030003
  s_mov_b32 exec_hi, 0x00030003
  s_cmp_eq_u32 s75, 1
  s_cbranch_scc0 L_pf_77
  global_store_dwordx4 v13, v[8:11], s[42:43]
  s_branch L_pe_78
L_pf_77:
  global_store_dwordx4 v13, v[8:11], s[42:43] sc1
L_pe_78:
  s_mov_b64 exec, -1
  s_mov_b32 s60, 0
  s_branch L_svc1
L_r_modb:
  s_lshl_b32 s48, s61, 7
  s_lshl_b32 s58, s61, 9
  s_add_u32 s58, s58, 4096
  s_mov_b32 s44, s36
  s_mov_b32 s45, s37
  s_mov_b32 s46, 3145728
  s_mov_b32 s47, 0x20000
  global_load_dwordx2 v[14:15], v13, s[34:35]
  s_waitcnt lgkmcnt(0)
  s_mul_i32 s74, s74, 0x9e3779b1
  s_add_u32 s74, s74, 0x7f4a7c15
  s_add_u32 s76, s76, s74
  s_waitcnt vmcnt(0)
  s_cmp_lg_u32 s5, 3
  s_cbranch_scc1 L_sig_79
  s_and_b32 s56, s2, 7
  s_lshl_b32 s56, s56, 5
  s_lshr_b32 s57, s2, 3
  s_add_u32 s56, s56, s57
  s_lshl_b32 s56, s56, 2
  v_mov_b32 v8, s56
  v_mov_b32 v9, s76
  s_waitcnt vmcnt(0)
  s_mov_b64 exec, 1
  global_store_dword v8, v9, s[42:43] offset:1024 sc1
  s_mov_b64 exec, -1
L_sig_79:
  v_lshlrev_b32 v16, 16, v14
  v_and_b32 v17, s73, v14
  v_lshlrev_b32 v18, 16, v15
  v_and_b32 v19, s73, v15
  v_mul_f32 v20, 0xbfb8aa3b, v16
  v_mul_f32 v21, 0xbfb8aa3b, v17
  v_mul_f32 v22, 0xbfb8aa3b, v18
  v_mul_f32 v23, 0xbfb8aa3b, v19
  v_exp_f32 v20, v20
  v_exp_f32 v21, v21
  v_exp_f32 v22, v22
  v_exp_f32 v23, v23
  s_nop 0
  v_add_f32 v20, 1.0, v20
  v_add_f32 v21, 1.0, v21
  v_add_f32 v22, 1.0, v22
  v_add_f32 v23, 1.0, v23
  v_rcp_f32 v20, v20
  v_rcp_f32 v21, v21
  v_rcp_f32 v22, v22
  v_rcp_f32 v23, v23
  s_nop 0
  v_mul_f32 v16, v16, v20
  v_mul_f32 v17, v17, v21
  v_mul_f32 v18, v18, v22
  v_mul_f32 v19, v19, v23
  v_cvt_pk_bf16_f32 v14, v16, v17
  v_cvt_pk_bf16_f32 v15, v18, v19
  ds_write_b64 v12, v[14:15] offset:0
  s_mov_b32 s60, 4
  s_sub_u32 s53, s5, 1
  s_cmp_gt_u32 s53, 1
  s_cbranch_scc1 L_sig
  v_lshrrev_b32 v2, 3, v1
  v_and_b32 v3, 6, v2
  v_xor_b32 v3, v3, v1
  v_mul_u32_u24 v2, 6144, v2
  v_and_b32 v3, 7, v3
  v_lshl_add_u32 v2, v3, 4, v2
  s_mul_i32 s49, s53, 1572864
  s_lshl_b32 s50, s53, 15
  s_add_u32 s49, s49, s48
  s_add_u32 s50, s50, 16384
  s_add_u32 s51, s50, 32768
L_dma_80:
  s_mov_b32 m0, s50
  s_add_u32 s50, s50, 1024
  buffer_load_dwordx4 v2, s[44:47], s49 offen nt lds
  s_add_u32 s49, s49, 49152
  s_waitcnt vmcnt(3)
  s_cmp_lt_u32 s50, s51
  s_cbranch_scc1 L_dma_80
L_dmae_81:
  s_branch L_sig
L_r_wo:
  s_and_b32 s66, s2, 7
  s_lshl_b32 s48, s66, 19
  s_lshl_b32 s49, s61, 7
  s_add_u32 s48, s48, s49
  s_lshr_b32 s58, s66, 1
  s_lshl_b32 s58, s58, 14
  s_and_b32 s49, s66, 1
  s_lshl_b32 s49, s49, 12
  s_add_u32 s58, s58, s49
  s_lshl_b32 s49, s61, 9
  s_add_u32 s58, s58, s49
  s_add_u32 s58, s58, 327680
  s_mov_b32 s44, s24
  s_mov_b32 s45, s25
  s_mov_b32 s46, 4194304
  s_mov_b32 s47, 0x20000
  s_waitcnt lgkmcnt(0)
  s_mul_i32 s74, s74, 0x9e3779b1
  s_add_u32 s74, s74, 0x7f4a7c15
  s_add_u32 s76, s76, s74
  s_cmp_lg_u32 s5, 3
  s_cbranch_scc1 L_sig_82
  s_and_b32 s56, s2, 7
  s_lshl_b32 s56, s56, 5
  s_lshr_b32 s57, s2, 3
  s_add_u32 s56, s56, s57
  s_lshl_b32 s56, s56, 2
  v_mov_b32 v8, s56
  v_mov_b32 v9, s76
  s_waitcnt vmcnt(0)
  s_mov_b64 exec, 1
  global_store_dword v8, v9, s[42:43] offset:1024 sc1
  s_mov_b64 exec, -1
L_sig_82:
  s_cmp_lg_u32 s5, 3
  s_cbranch_scc1 L_nr_83
  s_lshl_b32 s49, s61, 14
  s_lshl_b32 s50, s8, 10
  s_add_u32 s49, s49, s50
  s_add_u32 s49, s49, 524288
  s_add_u32 s50, s49, 256
  s_mov_b32 s54, -1
  s_mov_b32 s55, -1
L_nrl_84:
  s_memtime s[64:65]
  s_waitcnt lgkmcnt(0)
  s_load_dword s51, s[42:43], s49
  s_waitcnt lgkmcnt(0)
  s_memtime s[68:69]
  s_waitcnt lgkmcnt(0)
  s_sub_u32 s68, s68, s64
  s_min_u32 s54, s54, s68
  s_xor_b32 s49, s49, 0x2000
  s_memtime s[64:65]
  s_waitcnt lgkmcnt(0)
  s_load_dword s51, s[42:43], s49
  s_waitcnt lgkmcnt(0)
  s_memtime s[68:69]
  s_waitcnt lgkmcnt(0)
  s_sub_u32 s68, s68, s64
  s_min_u32 s55, s55, s68
  s_xor_b32 s49, s49, 0x2000
  s_add_u32 s49, s49, 128
  s_cmp_lt_u32 s49, s50
  s_cbranch_scc1 L_nrl_84
  s_cmp_lt_u32 s55, s54
  s_cselect_b32 s54, 1, 0
  s_sub_u32 s55, s76, s74
  s_lshr_b32 s55, s55, 2
  s_xor_b32 s54, s54, s55
  s_and_b32 s54, s54, 1
  s_add_u32 s54, s54, s74
  s_sub_u32 s55, s2, 64
  s_lshl_b32 s55, s55, 2
  v_mov_b32 v8, s55
  v_mov_b32 v9, s54
  s_mov_b64 exec, 1
  global_store_dword v8, v9, s[42:43] offset:2048 sc1
  s_mov_b64 exec, -1
L_nr_83:
  s_mov_b32 s60, 1
  s_sub_u32 s53, s5, 1
  s_cmp_gt_u32 s53, 1
  s_cbranch_scc1 L_sig
  v_lshrrev_b32 v2, 3, v1
  v_and_b32 v3, 6, v2
  v_xor_b32 v3, v3, v1
  v_mul_u32_u24 v2, 1024, v2
  v_and_b32 v3, 7, v3
  v_lshl_add_u32 v2, v3, 4, v2
  s_mul_i32 s49, s53, 262144
  s_lshl_b32 s50, s53, 15
  s_add_u32 s49, s49, s48
  s_add_u32 s50, s50, 16384
  s_add_u32 s51, s50, 32768
L_dma_85:
  s_mov_b32 m0, s50
  s_add_u32 s50, s50, 1024
  buffer_load_dwordx4 v2, s[44:47], s49 offen nt lds
  s_add_u32 s49, s49, 8192
  s_waitcnt vmcnt(3)
  s_cmp_lt_u32 s50, s51
  s_cbranch_scc1 L_dma_85
L_dmae_86:
  s_branch L_sig
L_r_f1:
  s_lshl_b32 s48, s61, 6
  s_mul_i32 s49, s61, 47
  s_lshr_b32 s49, s49, 9
  s_mul_i32 s49, s49, 10752
  s_lshl_b32 s58, s61, 9
  s_add_u32 s58, s58, s49
  s_add_u32 s58, s58, 262144
  s_cmp_lg_u32 s5, 3
  s_cbranch_scc1 L_clr_87
  v_lshl_add_u32 v10, v1, 3, s58
  global_store_dwordx2 v10, v[4:5], s[42:43] sc1
  v_add_u32 v10, 0x2000, v10
  global_store_dwordx2 v10, v[4:5], s[42:43] sc1
L_clr_87:
  s_cmp_lt_u32 s5, 2
  s_cselect_b32 s44, s28, s30
  s_cselect_b32 s45, s29, s31
  s_mov_b32 s46, 1409024
  s_mov_b32 s47, 0x20000
  s_mov_b32 s60, 2
  s_waitcnt lgkmcnt(0)
  s_mul_i32 s74, s74, 0x9e3779b1
  s_add_u32 s74, s74, 0x7f4a7c15
  s_add_u32 s76, s76, s74
  s_cmp_lg_u32 s5, 3
  s_cbranch_scc1 L_sig_88
  s_and_b32 s56, s2, 7
  s_lshl_b32 s56, s56, 5
  s_lshr_b32 s57, s2, 3
  s_add_u32 s56, s56, s57
  s_lshl_b32 s56, s56, 2
  v_mov_b32 v8, s56
  v_mov_b32 v9, s76
  s_waitcnt vmcnt(0)
  s_mov_b64 exec, 1
  global_store_dword v8, v9, s[42:43] offset:1024 sc1
  s_mov_b64 exec, -1
L_sig_88:
  s_sub_u32 s53, s5, 1
  s_cmp_gt_u32 s53, 1
  s_cbranch_scc1 L_svc1
  s_and_b32 s54, s61, 1
  v_lshrrev_b32 v2, 2, v1
  v_mul_u32_u24 v2, 5504, v2
  s_and_b32 s49, s5, 2
  s_or_b32 s49, s49, s54
  v_xor_b32 v3, s49, v1
  v_and_b32 v3, 3, v3
  v_lshl_add_u32 v2, v3, 4, v2
  s_mul_i32 s49, s54, 2752
  s_add_u32 s49, s49, s48
  s_lshl_b32 s50, s53, 15
  s_lshl_b32 s54, s54, 14
  s_add_u32 s50, s50, s54
  s_add_u32 s50, s50, 16384
  s_add_u32 s51, s50, 16384
L_dma_89:
  s_mov_b32 m0, s50
  s_add_u32 s50, s50, 1024
  buffer_load_dwordx4 v2, s[44:47], s49 offen  lds
  s_add_u32 s49, s49, 88064
  s_waitcnt vmcnt(1)
  s_cmp_lt_u32 s50, s51
  s_cbranch_scc1 L_dma_89
L_dmae_90:
  s_branch L_svc1
L_r_f2:
  s_mov_b32 s44, s32
  s_mov_b32 s45, s33
  s_mov_b32 s46, 1409024
  s_mov_b32 s47, 0x20000
  s_waitcnt lgkmcnt(0)
  s_mul_i32 s74, s74, 0x9e3779b1
  s_add_u32 s74, s74, 0x7f4a7c15
  s_add_u32 s76, s76, s74
  s_cmp_lg_u32 s5, 3
  s_cbranch_scc1 L_sig_91
  s_and_b32 s56, s2, 7
  s_lshl_b32 s56, s56, 5
  s_lshr_b32 s57, s2, 3
  s_add_u32 s56, s56, s57
  s_lshl_b32 s56, s56, 2
  v_mov_b32 v8, s56
  v_mov_b32 v9, s76
  s_waitcnt vmcnt(0)
  s_mov_b64 exec, 1
  global_store_dword v8, v9, s[42:43] offset:1024 sc1
  s_mov_b64 exec, -1
L_sig_91:
  s_mov_b32 s60, 3
  s_lshl_b32 s48, s61, 5
  global_load_dword v167, v38, s[38:39]
  s_cmp_lg_u32 s5, 3
  s_cbranch_scc1 L_tch_92
  s_and_b32 s49, s61, 3
  s_lshl_b32 s49, s49, 7
  v_add_u32 v8, s49, v1
  s_bfe_u32 s50, s14, 0x50003
  s_cmp_eq_u32 s50, 0
  s_cbranch_scc1 L_tchm_93
  s_lshl_b32 s50, s50, 10
  s_sub_u32 s50, s50, 640
  v_mul_u32_u24 v9, 6144, v8
  v_add_u32 v9, s50, v9
  v_add_u32 v10, 393216, v9
  global_load_dword v167, v9, s[36:37]
  global_load_dword v167, v10, s[36:37]
L_tchm_93:
  s_lshl_b32 s50, s8, 10
  s_add_u32 s50, s50, 384
  v_mul_u32_u24 v9, 8192, v8
  v_add_u32 v9, s50, v9
  v_add_u32 v10, 524288, v9
  global_load_dword v167, v9, s[22:23]
  global_load_dword v167, v10, s[22:23]
L_tch_92:
  s_sub_u32 s53, s5, 1
  s_cmp_gt_u32 s53, 1
  s_cbranch_scc1 L_svc1
  v_lshrrev_b32 v2, 1, v1
  v_lshlrev_b32 v2, 10, v2
  v_and_b32 v3, 1, v1
  v_lshl_add_u32 v2, v3, 4, v2
  s_mul_i32 s49, s53, 720896
  s_add_u32 s49, s49, s48
  s_add_u32 s49, s49, 0
  s_mul_i32 s50, s53, 22528
  s_add_u32 s50, s50, 16384
  s_add_u32 s51, s50, s59
  s_cmp_lt_u32 s50, s51
  s_cbranch_scc0 L_dmae_95
L_dma_94:
  s_mov_b32 m0, s50
  s_add_u32 s50, s50, 1024
  buffer_load_dwordx4 v2, s[44:47], s49 offen nt lds
  s_add_u32 s49, s49, 32768
  s_waitcnt vmcnt(0)
  s_cmp_lt_u32 s50, s51
  s_cbranch_scc1 L_dma_94
L_dmae_95:
  s_mul_i32 s49, s53, 720896
  s_add_u32 s49, s49, s48
  s_add_u32 s49, s49, 360448
  s_mul_i32 s50, s53, 22528
  s_add_u32 s50, s50, 27648
  s_add_u32 s51, s50, s59
  s_cmp_lt_u32 s50, s51
  s_cbranch_scc0 L_dmae_97
L_dma_96:
  s_mov_b32 m0, s50
  s_add_u32 s50, s50, 1024
  buffer_load_dwordx4 v2, s[44:47], s49 offen nt lds
  s_add_u32 s49, s49, 32768
  s_waitcnt vmcnt(0)
  s_cmp_lt_u32 s50, s51
  s_cbranch_scc1 L_dma_96
L_dmae_97:
  s_branch L_svc1
L_r_none:
  s_mov_b32 s60, 0
L_uni:
  s_waitcnt lgkmcnt(0)
  s_mul_i32 s74, s74, 0x9e3779b1
  s_add_u32 s74, s74, 0x7f4a7c15
  s_add_u32 s76, s76, s74
  s_cmp_lg_u32 s5, 3
  s_cbranch_scc1 L_sig_98
  s_and_b32 s56, s2, 7
  s_lshl_b32 s56, s56, 5
  s_lshr_b32 s57, s2, 3
  s_add_u32 s56, s56, s57
  s_lshl_b32 s56, s56, 2
  v_mov_b32 v8, s56
  v_mov_b32 v9, s76
  s_waitcnt vmcnt(0)
  s_mov_b64 exec, 1
  global_store_dword v8, v9, s[42:43] offset:1024 sc1
  s_mov_b64 exec, -1
L_sig_98:
  s_branch L_svc1
L_sig:
  s_waitcnt vmcnt(0) lgkmcnt(0)
  v_mov_b32 v9, 1
  s_mov_b64 exec, 1
  ds_add_u32 v38, v9 offset:6720
  s_mov_b64 exec, -1
L_svc1:
  s_cmp_lg_u32 s5, 0
  s_cbranch_scc1 L_disp2
  s_lshl_b32 s64, s6, 9
  s_add_u32 s64, s64, 32768
  v_and_b32 v17, 31, v1
  v_lshl_add_u32 v16, v17, 4, s64
  v_lshlrev_b32 v17, 3, v17
  s_mov_b32 s70, 0
L_pl_99:
  ds_read_b32 v8, v38 offset:6664
  s_waitcnt lgkmcnt(0)
  v_cmp_eq_u32 vcc, -1, v8
  s_cmp_eq_u64 vcc, 0
  s_cbranch_scc1 L_pld_100
  s_sleep 8
  s_add_u32 s70, s70, 1
  s_cmp_lt_u32 s70, 1048576
  s_cbranch_scc1 L_pl_99
L_pld_100:
  s_and_b32 s71, s2, 7
  s_lshl_b32 s71, s71, 7
  s_add_u32 s71, s71, 1024
  v_and_b32 v8, 31, v1
  v_lshl_add_u32 v8, v8, 2, s71
  s_mov_b32 s70, 0
L_polt_101:
  global_load_dwordx4 v[20:23], v16, s[42:43] sc1
  global_load_dword v9, v8, s[42:43] sc1
  s_waitcnt vmcnt(0)
  v_cmp_ne_u32 vcc, s74, v21
  v_cmp_ne_u32 s[68:69], s74, v23
  s_or_b64 vcc, vcc, s[68:69]
  s_cmp_eq_u64 vcc, 0
  s_cbranch_scc1 L_poltd_102
  s_add_u32 s70, s70, 1
  s_cmp_lt_u32 s70, 262144
  s_cbranch_scc1 L_polt_101
L_poltd_102:
  v_cmp_ne_u32 vcc, s76, v9
  s_cmp_eq_u64 vcc, 0
  s_cselect_b32 s75, 1, 0
  v_mov_b32 v21, v22
  ds_write_b64 v17, v[20:21] offset:6400
L_disp2:
L_svc2:
  s_lshl_b32 s64, s6, 9
  s_add_u32 s64, s64, 98304
  s_cmp_eq_u32 s5, 3
  s_cbranch_scc1 L_svc3
  s_cmp_lg_u32 s5, 0
  s_cbranch_scc1 L_disp3
  s_lshl_b32 s65, s7, 7
  s_add_u32 s65, s65, s64
  v_mov_b32 v18, s65
  s_mov_b32 s70, 0
L_sn_103:
  ds_read_b32 v8, v38 offset:6672
  s_waitcnt lgkmcnt(0)
  v_and_b32 v8, 0xffff, v8
  v_cmp_gt_u32 vcc, 0x200, v8
  s_cmp_eq_u64 vcc, 0
  s_cbranch_scc1 L_snd_104
  s_sleep 1
  s_add_u32 s70, s70, 1
  s_cmp_lt_u32 s70, 2097152
  s_cbranch_scc1 L_sn_103
L_snd_104:
  v_and_b32 v9, 7, v1
  v_lshlrev_b32 v9, 3, v9
  ds_read_b64 v[10:11], v9 offset:6912
  s_waitcnt lgkmcnt(0)
  v_max_f32_dpp v8, v10, v10 quad_perm:[1,0,3,2] row_mask:0xf bank_mask:0xf
  s_nop 1
  v_max_f32_dpp v8, v8, v8 quad_perm:[2,3,0,1] row_mask:0xf bank_mask:0xf
  s_nop 1
  v_max_f32_dpp v8, v8, v8 row_half_mirror row_mask:0xf bank_mask:0xf
  v_sub_f32 v10, v10, v8
  v_mul_f32 v10, 0x3fb8aa3b, v10
  v_exp_f32 v10, v10
  s_nop 0
  v_mul_f32 v10, v10, v11
  s_nop 1
  v_add_f32_dpp v10, v10, v10 quad_perm:[1,0,3,2] row_mask:0xf bank_mask:0xf
  s_nop 1
  v_add_f32_dpp v10, v10, v10 quad_perm:[2,3,0,1] row_mask:0xf bank_mask:0xf
  s_nop 1
  v_add_f32_dpp v10, v10, v10 row_half_mirror row_mask:0xf bank_mask:0xf
  v_mov_b32 v9, s74
  v_mov_b32 v11, s74
  s_mov_b64 exec, 1
  global_store_dwordx4 v18, v[8:11], s[42:43] sc1
  s_mov_b64 exec, -1
  s_mov_b32 s70, 0
L_sn_105:
  ds_read_b32 v8, v38 offset:6672
  s_waitcnt lgkmcnt(0)
  v_cmp_gt_u32 vcc, 0x10000, v8
  s_cmp_eq_u64 vcc, 0
  s_cbranch_scc1 L_snd_106
  s_sleep 2
  s_add_u32 s70, s70, 1
  s_cmp_lt_u32 s70, 2097152
  s_cbranch_scc1 L_sn_105
L_snd_106:
  v_and_b32 v9, 15, v1
  v_lshlrev_b32 v9, 3, v9
  ds_read_b64 v[10:11], v9 offset:6912
  s_waitcnt lgkmcnt(0)
  v_max_f32_dpp v8, v10, v10 quad_perm:[1,0,3,2] row_mask:0xf bank_mask:0xf
  s_nop 1
  v_max_f32_dpp v8, v8, v8 quad_perm:[2,3,0,1] row_mask:0xf bank_mask:0xf
  s_nop 1
  v_max_f32_dpp v8, v8, v8 row_half_mirror row_mask:0xf bank_mask:0xf
  s_nop 1
  v_max_f32_dpp v8, v8, v8 row_mirror row_mask:0xf bank_mask:0xf
  v_sub_f32 v10, v10, v8
  v_mul_f32 v10, 0x3fb8aa3b, v10
  v_exp_f32 v10, v10
  s_nop 0
  v_mul_f32 v10, v10, v11
  s_nop 1
  v_add_f32_dpp v10, v10, v10 quad_perm:[1,0,3,2] row_mask:0xf bank_mask:0xf
  s_nop 1
  v_add_f32_dpp v10, v10, v10 quad_perm:[2,3,0,1] row_mask:0xf bank_mask:0xf
  s_nop 1
  v_add_f32_dpp v10, v10, v10 row_half_mirror row_mask:0xf bank_mask:0xf
  s_nop 1
  v_add_f32_dpp v10, v10, v10 row_mirror row_mask:0xf bank_mask:0xf
  v_rcp_f32 v10, v10
  s_nop 0
  v_readfirstlane_b32 s67, v10
  ds_write_b32 v38, v38 offset:6656
  s_branch L_disp3
L_svc3:
  s_and_b32 s49, s60, 6
  s_cmp_lg_u32 s49, 2
  s_cbranch_scc1 L_e3_107
  s_mov_b32 s70, 0
L_pl_108:
  ds_read_b32 v8, v38 offset:6664
  s_waitcnt lgkmcnt(0)
  v_cmp_eq_u32 vcc, -1, v8
  s_cmp_eq_u64 vcc, 0
  s_cbranch_scc1 L_pld_109
  s_sleep 32
  s_add_u32 s70, s70, 1
  s_cmp_lt_u32 s70, 1048576
  s_cbranch_scc1 L_pl_108
L_pld_109:
  v_lshlrev_b32 v10, 4, v1
  v_lshlrev_b32 v110, 2, v1
  s_mov_b32 s70, 0
L_ah_110:
  global_load_dwordx4 v[104:107], v10, s[42:43] offset:1024 sc1
  global_load_dword v109, v110, s[42:43] offset:2048 sc1
  s_waitcnt vmcnt(0)
  v_subrev_u32 v104, s74, v104
  v_subrev_u32 v105, s74, v105
  v_subrev_u32 v106, s74, v106
  v_subrev_u32 v107, s74, v107
  v_max3_u32 v108, v104, v105, v106
  v_max_u32 v108, v108, v107
  v_cmp_lt_u32 vcc, 15, v108
  s_cmp_eq_u64 vcc, 0
  s_cbranch_scc1 L_ahd_111
  s_sleep 8
  s_add_u32 s70, s70, 1
  s_cmp_lt_u32 s70, 262144
  s_cbranch_scc1 L_ah_110
L_ahd_111:
  v_subrev_u32 v109, s74, v109
  v_cmp_eq_u32 vcc, 1, v109
  s_bcnt1_i32_b64 s70, vcc
  v_cmp_eq_u32 vcc, 0, v109
  s_bcnt1_i32_b64 s71, vcc
  s_cmp_gt_u32 s70, s71
  s_cselect_b32 s71, 4, 0
  s_sub_u32 s68, s76, s74
  s_xor_b32 s71, s71, s68
  s_and_b32 s71, s71, 4
  s_lshl_b32 s71, s71, 11
  v_mov_b32 v104, s71
  ds_write_b32 v38, v104 offset:6668
  s_cmp_lg_u32 s60, 3
  s_cbranch_scc1 L_e3_107
  s_mov_b32 s70, 0
L_pl_113:
  ds_read_b32 v8, v38 offset:6400
  s_waitcnt lgkmcnt(0)
  v_cmp_eq_u32 vcc, -1, v8
  s_cmp_eq_u64 vcc, 0
  s_cbranch_scc1 L_pld_114
  s_sleep 16
  s_add_u32 s70, s70, 1
  s_cmp_lt_u32 s70, 1048576
  s_cbranch_scc1 L_pl_113
L_pld_114:
  s_and_b32 s49, s61, 3
  s_mul_i32 s49, s49, 352256
  s_add_u32 s49, s49, s48
  s_add_u32 s50, s49, 131072
  v_lshlrev_b32 v8, 10, v1
  s_mov_b32 exec_lo, 0xffffffff
  s_mov_b32 exec_hi, 0xffffffff
L_pf2l_112:
  buffer_load_dword v167, v8, s[44:47], s49 offen
  s_add_u32 s49, s49, 65536
  s_cmp_lt_u32 s49, s50
  s_cbranch_scc1 L_pf2l_112
  s_mov_b64 exec, -1
L_e3_107:
  s_xor_b32 s54, s7, 1
  s_lshl_b32 s54, s54, 7
  s_add_u32 s54, s54, s64
  s_xor_b32 s55, s7, 2
  s_lshl_b32 s55, s55, 7
  s_add_u32 s55, s55, s64
  s_xor_b32 s56, s7, 3
  s_lshl_b32 s56, s56, 7
  s_add_u32 s56, s56, s64
  s_mov_b32 s70, 0
L_sn_115:
  ds_read_b32 v8, v38 offset:6672
  s_waitcnt lgkmcnt(0)
  v_cmp_eq_u32 vcc, 0, v8
  s_cmp_eq_u64 vcc, 0
  s_cbranch_scc1 L_snd_116
  s_sleep 4
  s_add_u32 s70, s70, 1
  s_cmp_lt_u32 s70, 2097152
  s_cbranch_scc1 L_sn_115
L_snd_116:
  s_mov_b32 s70, 0
L_s3p:
  s_load_dwordx4 s[20:23], s[42:43], s54 glc
  s_load_dwordx4 s[24:27], s[42:43], s55 glc
  s_load_dwordx4 s[28:31], s[42:43], s56 glc
  s_waitcnt lgkmcnt(0)
  s_xor_b32 s68, s21, s74
  s_xor_b32 s69, s23, s74
  s_or_b32 s68, s68, s69
  s_xor_b32 s69, s25, s74
  s_or_b32 s68, s68, s69
  s_xor_b32 s69, s27, s74
  s_or_b32 s68, s68, s69
  s_xor_b32 s69, s29, s74
  s_or_b32 s68, s68, s69
  s_xor_b32 s69, s31, s74
  s_or_b32 s68, s68, s69
  s_cbranch_scc0 L_s3d
  s_add_u32 s70, s70, 1
  s_cmp_lt_u32 s70, 262144
  s_cbranch_scc1 L_s3p
L_s3d:
  v_mov_b32 v8, s20
  v_mov_b32 v9, s22
  v_mov_b32 v10, s24
  v_mov_b32 v11, s26
  v_mov_b32 v16, s28
  v_mov_b32 v17, s30
  v_max3_f32 v18, v8, v10, v16
  v_mov_b32 v19, 0x10000
  s_mov_b64 exec, 1
  ds_max_f32 v38, v18 offset:6676
  ds_write_b128 v38, v[8:11] offset:6976
  ds_write_b64 v38, v[16:17] offset:6992
  ds_add_u32 v38, v19 offset:6672
  s_mov_b64 exec, -1
L_disp3:
  s_cmp_lg_u32 s60, 4
  s_cbranch_scc1 L_nomb
  s_mov_b32 s70, 0
L_pl_117:
  ds_read_b32 v8, v38 offset:6656
  s_waitcnt lgkmcnt(0)
  v_cmp_eq_u32 vcc, -1, v8
  s_cmp_eq_u64 vcc, 0
  s_cbranch_scc1 L_pld_118
  s_sleep 16
  s_add_u32 s70, s70, 1
  s_cmp_lt_u32 s70, 1048576
  s_cbranch_scc1 L_pl_117
L_pld_118:
  v_and_b32 v13, 1, v1
  v_lshlrev_b32 v13, 6, v13
  v_lshrrev_b32 v3, 4, v1
  v_lshl_add_u32 v13, v3, 4, v13
  s_lshl_b32 s49, s5, 7
  s_add_u32 s49, s49, s58
  v_add_u32 v13, s49, v13
  v_and_b32 v14, 1, v1
  v_mul_u32_u24 v14, 1056, v14
  v_lshrrev_b32 v3, 4, v1
  v_lshl_add_u32 v14, v3, 4, v14
  v_lshrrev_b32 v2, 2, v1
  v_bfe_u32 v3, v1, 1, 1
  s_lshl_b32 s49, s5, 1
  v_or_b32 v3, s49, v3
  v_and_b32 v10, 6, v2
  v_xor_b32 v3, v3, v10
  v_lshlrev_b32 v2, 7, v2
  v_lshl_add_u32 v2, v3, 4, v2
  v_and_b32 v3, 1, v1
  v_lshl_add_u32 v2, v3, 3, v2
  v_add_u32 v2, 16384, v2
  s_mov_b32 s70, 0
L_hs_119:
  ds_read_b32 v9, v38 offset:6720
  s_waitcnt lgkmcnt(0)
  v_cmp_gt_u32 vcc, 4, v9
  s_cmp_eq_u64 vcc, 0
  s_cbranch_scc1 L_hsd_120
  s_sleep 8
  s_add_u32 s70, s70, 1
  s_cmp_lt_u32 s70, 2097152
  s_cbranch_scc1 L_hs_119
L_hsd_120:
  ds_read_b64_tr_b16 v[40:41], v2 offset:0
  ds_read_b64_tr_b16 v[42:43], v2 offset:2048
  ds_read_b128 v[104:107], v14 offset:0
  ds_read_b64_tr_b16 v[44:45], v2 offset:4096
  ds_read_b64_tr_b16 v[46:47], v2 offset:6144
  ds_read_b128 v[108:111], v14 offset:64
  ds_read_b64_tr_b16 v[48:49], v2 offset:8192
  ds_read_b64_tr_b16 v[50:51], v2 offset:10240
  ds_read_b128 v[112:115], v14 offset:128
  ds_read_b64_tr_b16 v[52:53], v2 offset:12288
  ds_read_b64_tr_b16 v[54:55], v2 offset:14336
  ds_read_b128 v[116:119], v14 offset:192
  ds_read_b64_tr_b16 v[56:57], v2 offset:16384
  ds_read_b64_tr_b16 v[58:59], v2 offset:18432
  ds_read_b128 v[120:123], v14 offset:256
  s_waitcnt lgkmcnt(12)
  v_mfma_f32_16x16x32_bf16 v[8:11], v[40:43], v[104:107], 0
  ds_read_b64_tr_b16 v[60:61], v2 offset:20480
  ds_read_b64_tr_b16 v[62:63], v2 offset:22528
  ds_read_b128 v[124:127], v14 offset:320
  s_waitcnt lgkmcnt(12)
  v_mfma_f32_16x16x32_bf16 v[8:11], v[44:47], v[108:111], v[8:11]
  ds_read_b64_tr_b16 v[64:65], v2 offset:24576
  ds_read_b64_tr_b16 v[66:67], v2 offset:26624
  ds_read_b128 v[128:131], v14 offset:384
  s_waitcnt lgkmcnt(12)
  v_mfma_f32_16x16x32_bf16 v[8:11], v[48:51], v[112:115], v[8:11]
  ds_read_b64_tr_b16 v[68:69], v2 offset:28672
  ds_read_b64_tr_b16 v[70:71], v2 offset:30720
  ds_read_b128 v[132:135], v14 offset:448
  s_waitcnt lgkmcnt(12)
  v_mfma_f32_16x16x32_bf16 v[8:11], v[52:55], v[116:119], v[8:11]
  ds_read_b64_tr_b16 v[72:73], v2 offset:32768
  ds_read_b64_tr_b16 v[74:75], v2 offset:34816
  ds_read_b128 v[136:139], v14 offset:512
  s_waitcnt lgkmcnt(12)
  v_mfma_f32_16x16x32_bf16 v[8:11], v[56:59], v[120:123], v[8:11]
  ds_read_b64_tr_b16 v[76:77], v2 offset:36864
  ds_read_b64_tr_b16 v[78:79], v2 offset:38912
  ds_read_b128 v[140:143], v14 offset:576
  s_waitcnt lgkmcnt(12)
  v_mfma_f32_16x16x32_bf16 v[8:11], v[60:63], v[124:127], v[8:11]
  ds_read_b64_tr_b16 v[80:81], v2 offset:40960
  ds_read_b64_tr_b16 v[82:83], v2 offset:43008
  ds_read_b128 v[144:147], v14 offset:640
  s_waitcnt lgkmcnt(12)
  v_mfma_f32_16x16x32_bf16 v[8:11], v[64:67], v[128:131], v[8:11]
  ds_read_b64_tr_b16 v[84:85], v2 offset:45056
  ds_read_b64_tr_b16 v[86:87], v2 offset:47104
  ds_read_b128 v[148:151], v14 offset:704
  s_waitcnt lgkmcnt(12)
  v_mfma_f32_16x16x32_bf16 v[8:11], v[68:71], v[132:135], v[8:11]
  ds_read_b64_tr_b16 v[88:89], v2 offset:49152
  ds_read_b64_tr_b16 v[90:91], v2 offset:51200
  ds_read_b128 v[152:155], v14 offset:768
  s_waitcnt lgkmcnt(12)
  v_mfma_f32_16x16x32_bf16 v[8:11], v[72:75], v[136:139], v[8:11]
  ds_read_b64_tr_b16 v[92:93], v2 offset:53248
  ds_read_b64_tr_b16 v[94:95], v2 offset:55296
  ds_read_b128 v[156:159], v14 offset:832
  s_waitcnt lgkmcnt(12)
  v_mfma_f32_16x16x32_bf16 v[8:11], v[76:79], v[140:143], v[8:11]
  ds_read_b64_tr_b16 v[96:97], v2 offset:57344
  ds_read_b64_tr_b16 v[98:99], v2 offset:59392
  ds_read_b128 v[160:163], v14 offset:896
  s_waitcnt lgkmcnt(12)
  v_mfma_f32_16x16x32_bf16 v[8:11], v[80:83], v[144:147], v[8:11]
  ds_read_b64_tr_b16 v[100:101], v2 offset:61440
  ds_read_b64_tr_b16 v[102:103], v2 offset:63488
  ds_read_b128 v[164:167], v14 offset:960
  s_waitcnt lgkmcnt(12)
  v_mfma_f32_16x16x32_bf16 v[8:11], v[84:87], v[148:151], v[8:11]
  s_waitcnt lgkmcnt(9)
  v_mfma_f32_16x16x32_bf16 v[8:11], v[88:91], v[152:155], v[8:11]
  s_waitcnt lgkmcnt(6)
  v_mfma_f32_16x16x32_bf16 v[8:11], v[92:95], v[156:159], v[8:11]
  s_waitcnt lgkmcnt(3)
  v_mfma_f32_16x16x32_bf16 v[8:11], v[96:99], v[160:163], v[8:11]
  s_waitcnt lgkmcnt(0)
  v_mfma_f32_16x16x32_bf16 v[8:11], v[100:103], v[164:167], v[8:11]
  s_nop 7
  v_cvt_pk_bf16_f32 v8, v8, v9
  v_cvt_pk_bf16_f32 v10, v10, v11
  v_mov_b32 v9, s74
  v_mov_b32 v11, s74
  s_mov_b32 exec_lo, 0x00030003
  s_mov_b32 exec_hi, 0x00030003
  global_store_dwordx4 v13, v[8:11], s[42:43] sc1
  s_mov_b64 exec, -1
L_nomb:
  s_mov_b32 s77, 0
  s_bfe_u32 s62, s74, 0x80000
  s_bfe_u32 s63, s74, 0x80008
  s_bfe_u32 s64, s74, 0x80010
  s_bfe_u32 s65, s74, 0x80018
  s_cmp_lg_u32 s5, 1
  s_cbranch_scc1 L_dry_ret
  s_mov_b32 s77, 1
  v_mov_b32 v5, 15104
  v_mov_b32 v6, 15104
  v_mov_b32 v7, 15104
  v_mov_b32 v14, 15104
  v_mov_b32 v30, 15104
  v_mov_b32 v2, 0
  v_mov_b32 v7, 0
  s_mov_b64 s[50:51], -1
  s_branch L_dry_op
L_dry_1:
  s_cmp_eq_u32 s60, 1
  s_cbranch_scc1 L_wo_ok
  s_cmp_eq_u32 s60, 2
  s_cbranch_scc1 L_f1_ok
  s_cmp_eq_u32 s60, 3
  s_cbranch_scc1 L_f2_ok
L_dry_end:
  s_mov_b64 exec, -1
  s_mov_b32 s77, 0
L_dry_ret:
  s_cmp_lg_u32 s5, 2
  s_cbranch_scc1 L_opt_121
  s_mov_b32 s70, 0
L_pl_122:
  ds_read_b32 v8, v38 offset:6656
  s_waitcnt lgkmcnt(0)
  v_cmp_eq_u32 vcc, -1, v8
  s_cmp_eq_u64 vcc, 0
  s_cbranch_scc1 L_pld_123
  s_sleep 32
  s_add_u32 s70, s70, 1
  s_cmp_lt_u32 s70, 1048576
  s_cbranch_scc1 L_pl_122
L_pld_123:
  s_lshl_b32 s56, s6, 2
  s_add_u32 s56, s56, s7
  s_lshl_b32 s57, s56, 9
  s_add_u32 s57, s57, 131072
  v_lshl_add_u32 v3, v1, 3, s57
  global_load_dword v167, v3, s[42:43] sc1
L_opt_121:
  s_cmp_eq_u32 s60, 2
  s_cbranch_scc1 L_pre_f1
  s_cmp_eq_u32 s60, 3
  s_cbranch_scc1 L_pre_f2
  s_cmp_lg_u32 s60, 1
  s_cbranch_scc1 L_join
  s_mov_b32 s70, 0
L_hs_124:
  ds_read_b32 v9, v38 offset:6720
  s_waitcnt lgkmcnt(0)
  v_cmp_gt_u32 vcc, 4, v9
  s_cmp_eq_u64 vcc, 0
  s_cbranch_scc1 L_hsd_125
  s_sleep 8
  s_add_u32 s70, s70, 1
  s_cmp_lt_u32 s70, 2097152
  s_cbranch_scc1 L_hs_124
L_hsd_125:
  v_lshrrev_b32 v2, 2, v1
  v_bfe_u32 v3, v1, 1, 1
  s_lshl_b32 s49, s5, 1
  v_or_b32 v3, s49, v3
  v_and_b32 v10, 6, v2
  v_xor_b32 v3, v3, v10
  v_lshlrev_b32 v2, 7, v2
  v_lshl_add_u32 v2, v3, 4, v2
  v_and_b32 v3, 1, v1
  v_lshl_add_u32 v2, v3, 3, v2
  v_add_u32 v2, 16384, v2
  ds_read_b64_tr_b16 v[40:41], v2 offset:0
  ds_read_b64_tr_b16 v[42:43], v2 offset:2048
  ds_read_b64_tr_b16 v[44:45], v2 offset:4096
  ds_read_b64_tr_b16 v[46:47], v2 offset:6144
  ds_read_b64_tr_b16 v[48:49], v2 offset:8192
  ds_read_b64_tr_b16 v[50:51], v2 offset:10240
  ds_read_b64_tr_b16 v[52:53], v2 offset:12288
  ds_read_b64_tr_b16 v[54:55], v2 offset:14336
  ds_read_b64_tr_b16 v[56:57], v2 offset:16384
  ds_read_b64_tr_b16 v[58:59], v2 offset:18432
  ds_read_b64_tr_b16 v[60:61], v2 offset:20480
  ds_read_b64_tr_b16 v[62:63], v2 offset:22528
  s_waitcnt lgkmcnt(10)
  ds_read_b64_tr_b16 v[64:65], v2 offset:24576
  ds_read_b64_tr_b16 v[66:67], v2 offset:26624
  s_waitcnt lgkmcnt(10)
  ds_read_b64_tr_b16 v[68:69], v2 offset:28672
  ds_read_b64_tr_b16 v[70:71], v2 offset:30720
  s_waitcnt lgkmcnt(10)
  ds_read_b64_tr_b16 v[72:73], v2 offset:32768
  ds_read_b64_tr_b16 v[74:75], v2 offset:34816
  s_waitcnt lgkmcnt(10)
  ds_read_b64_tr_b16 v[76:77], v2 offset:36864
  ds_read_b64_tr_b16 v[78:79], v2 offset:38912
  s_waitcnt lgkmcnt(10)
  ds_read_b64_tr_b16 v[80:81], v2 offset:40960
  ds_read_b64_tr_b16 v[82:83], v2 offset:43008
  s_waitcnt lgkmcnt(10)
  ds_read_b64_tr_b16 v[84:85], v2 offset:45056
  ds_read_b64_tr_b16 v[86:87], v2 offset:47104
  s_waitcnt lgkmcnt(10)
  ds_read_b64_tr_b16 v[88:89], v2 offset:49152
  ds_read_b64_tr_b16 v[90:91], v2 offset:51200
  s_waitcnt lgkmcnt(10)
  ds_read_b64_tr_b16 v[92:93], v2 offset:53248
  ds_read_b64_tr_b16 v[94:95], v2 offset:55296
  s_waitcnt lgkmcnt(10)
  ds_read_b64_tr_b16 v[96:97], v2 offset:57344
  ds_read_b64_tr_b16 v[98:99], v2 offset:59392
  s_waitcnt lgkmcnt(10)
  ds_read_b64_tr_b16 v[100:101], v2 offset:61440
  ds_read_b64_tr_b16 v[102:103], v2 offset:63488
  s_waitcnt lgkmcnt(10)
  s_waitcnt lgkmcnt(0)
  s_lshl_b32 s49, s66, 2
  s_add_u32 s49, s49, s5
  s_lshl_b32 s49, s49, 11
  s_add_u32 s49, s49, 131072
  v_lshrrev_b32 v12, 5, v1
  v_and_b32 v16, 31, v1
  v_lshlrev_b32 v15, 16, v12
  v_lshl_add_u32 v15, v16, 4, v15
  v_add_u32 v15, s49, v15
  v_mul_u32_u24 v12, 1056, v12
  v_bfe_u32 v16, v1, 3, 2
  v_lshl_add_u32 v12, v16, 6, v12
  v_and_b32 v16, 3, v1
  v_lshl_add_u32 v12, v16, 4, v12
  v_bfe_u32 v16, v1, 2, 1
  v_lshl_add_u32 v12, v16, 3, v12
  s_lshl_b32 s49, s5, 8
  v_add_u32 v12, s49, v12
  v_and_b32 v14, 1, v1
  v_mul_u32_u24 v14, 1056, v14
  v_lshrrev_b32 v3, 4, v1
  v_lshl_add_u32 v14, v3, 4, v14
  v_and_b32 v13, 1, v1
  v_lshlrev_b32 v13, 6, v13
  v_lshrrev_b32 v3, 4, v1
  v_lshl_add_u32 v13, v3, 4, v13
  s_lshl_b32 s49, s5, 7
  s_add_u32 s49, s49, s58
  v_add_u32 v13, s49, v13
  v_add_u32 v37, 0x2000, v13
  v_mov_b32 v36, 0xff
  s_branch L_join
L_pre_f1:
  v_mov_b32 v31, v13
  v_lshlrev_b32 v15, 4, v0
  v_add_u32 v24, 12288, v15
  v_add_u32 v25, 16384, v15
  v_add_u32 v26, 20480, v15
  s_mov_b32 s70, 0
L_pl_126:
  ds_read_b32 v11, v38 offset:6668
  s_waitcnt lgkmcnt(0)
  v_cmp_eq_u32 vcc, -1, v11
  s_cmp_eq_u64 vcc, 0
  s_cbranch_scc1 L_pld_127
  s_sleep 8
  s_add_u32 s70, s70, 1
  s_cmp_lt_u32 s70, 1048576
  s_cbranch_scc1 L_pl_126
L_pld_127:
  v_add_u32 v15, 327680, v15
  v_add_u32 v15, v11, v15
  v_add_u32 v35, 4096, v15
  v_add_u32 v32, 16384, v15
  v_add_u32 v36, 20480, v15
  v_add_u32 v33, 32768, v15
  v_add_u32 v37, 36864, v15
  v_add_u32 v34, 49152, v15
  v_add_u32 v39, 53248, v15
  v_bfe_u32 v6, v1, 2, 1
  v_lshlrev_b32 v6, 5, v6
  v_add_u32 v6, 15104, v6
  s_lshl_b32 s49, s5, 3
  v_add_u32 v5, s49, v6
  v_and_b32 v14, 7, v1
  v_mul_u32_u24 v14, 1056, v14
  v_lshrrev_b32 v3, 4, v1
  v_lshl_add_u32 v14, v3, 4, v14
  v_and_b32 v7, 1, v1
  v_lshlrev_b32 v7, 5, v7
  v_and_b32 v13, 1, v1
  v_lshlrev_b32 v13, 4, v13
  v_bfe_u32 v3, v1, 4, 1
  v_lshl_add_u32 v13, v3, 3, v13
  s_lshl_b32 s49, s5, 7
  s_add_u32 s49, s49, s58
  v_add_u32 v13, s49, v13
  v_lshrrev_b32 v3, 5, v1
  v_lshl_add_u32 v13, v3, 2, v13
  v_add_u32 v4, 0x2000, v13
  s_andn2_b32 s54, 1, s61
  v_lshrrev_b32 v2, 2, v1
  v_mul_u32_u24 v2, 5504, v2
  s_and_b32 s49, s5, 2
  s_or_b32 s49, s49, s54
  v_xor_b32 v3, s49, v1
  v_and_b32 v3, 3, v3
  v_lshl_add_u32 v2, v3, 4, v2
  v_mov_b32 v29, v2
  v_lshrrev_b32 v6, 3, v1
  v_lshlrev_b32 v6, 6, v6
  v_bfe_u32 v3, v1, 2, 1
  v_lshl_add_u32 v6, v3, 14, v6
  v_and_b32 v8, 2, v1
  v_or_b32 v3, v3, v8
  v_xor_b32 v3, s5, v3
  v_lshl_add_u32 v6, v3, 4, v6
  v_lshl_add_u32 v6, v8, 14, v6
  v_and_b32 v3, 1, v1
  v_lshl_add_u32 v6, v3, 3, v6
  v_add_u32 v6, 16384, v6
  s_and_b32 s55, s5, 1
  s_mul_i32 s49, s55, 704512
  s_add_u32 s49, s49, s48
  s_mul_i32 s50, s54, 2752
  s_add_u32 s49, s49, s50
  s_lshr_b32 s50, s5, 1
  s_lshl_b32 s50, s50, 15
  s_lshl_b32 s54, s54, 14
  s_add_u32 s50, s50, s54
  s_lshl_b32 s55, s55, 13
  s_add_u32 s50, s50, s55
  s_add_u32 s50, s50, 16384
  s_branch L_join
L_pre_f2:
  v_and_b32 v12, 1, v1
  v_lshrrev_b32 v14, 4, v1
  s_lshl_b32 s49, s61, 5
  v_lshl_add_u32 v3, v14, 3, s49
  v_lshl_add_u32 v13, v12, 10, v3
  v_mov_b32 v31, v13
  v_lshlrev_b32 v15, 6, v12
  v_lshl_add_u32 v15, v14, 4, v15
  s_lshl_b32 s49, s61, 7
  v_add_u32 v15, s49, v15
  v_add_u32 v24, 12288, v15
  v_add_u32 v25, 24576, v15
  s_mov_b32 s70, 0
L_pl_128:
  ds_read_b32 v11, v38 offset:6668
  s_waitcnt lgkmcnt(0)
  v_cmp_eq_u32 vcc, -1, v11
  s_cmp_eq_u64 vcc, 0
  s_cbranch_scc1 L_pld_129
  s_sleep 8
  s_add_u32 s70, s70, 1
  s_cmp_lt_u32 s70, 1048576
  s_cbranch_scc1 L_pl_128
L_pld_129:
  v_add_u32 v15, 327680, v15
  v_add_u32 v15, v11, v15
  v_add_u32 v35, 4096, v15
  v_add_u32 v32, 16384, v15
  v_add_u32 v36, 20480, v15
  v_add_u32 v33, 32768, v15
  v_add_u32 v37, 36864, v15
  v_add_u32 v34, 49152, v15
  v_add_u32 v39, 53248, v15
  s_lshl_b32 s49, s5, 14
  s_add_u32 s49, s49, 264192
  v_lshl_add_u32 v28, v14, 7, s49
  v_add_u32 v28, v11, v28
  v_lshl_add_u32 v28, v12, 4, v28
  v_bfe_u32 v3, v1, 2, 2
  v_lshl_add_u32 v28, v3, 9, v28
  v_lshl_add_u32 v12, v14, 1, v12
  v_lshlrev_b32 v12, 4, v12
  v_add_u32 v12, 15104, v12
  s_lshl_b32 s49, s5, 7
  v_add_u32 v30, s49, v12
  v_lshrrev_b32 v2, 1, v1
  v_lshlrev_b32 v2, 10, v2
  v_and_b32 v3, 1, v1
  v_lshl_add_u32 v2, v3, 4, v2
  v_mov_b32 v29, v2
  v_lshlrev_b32 v6, 8, v14
  v_bfe_u32 v3, v1, 2, 2
  v_lshl_add_u32 v6, v3, 5, v6
  v_and_b32 v3, 3, v1
  v_lshl_add_u32 v6, v3, 3, v6
  s_mul_i32 s49, s5, 11264
  s_add_u32 s49, s49, 16384
  v_add_u32 v6, s49, v6
L_join:
  v_lshlrev_b32 v2, 3, v1
  s_lshl_b32 s56, s6, 2
  s_add_u32 s56, s56, s7
  s_lshl_b32 s57, s56, 9
  s_add_u32 s57, s57, 131072
  v_lshl_add_u32 v3, v1, 3, s57
  v_and_b32 v8, 1, v1
  v_lshlrev_b32 v8, 4, v8
  v_lshrrev_b32 v8, v8, s74
  v_lshrrev_b32 v9, 8, v8
  s_movk_i32 s56, 0xff
  s_waitcnt vmcnt(0) lgkmcnt(0)
  s_barrier
  s_cmp_lg_u32 s5, 0
  s_cbranch_scc1 L_tail
L_dry_op:
  ds_read_b64 v[104:105], v2 offset:11008
  ds_read_b64 v[106:107], v2 offset:11520
  ds_read_b64 v[108:109], v2 offset:12032
  ds_read_b64 v[110:111], v2 offset:12544
  ds_read_b64 v[112:113], v2 offset:13056
  ds_read_b64 v[114:115], v2 offset:13568
  ds_read_b64 v[116:117], v2 offset:14080
  ds_read_b64 v[118:119], v2 offset:14592
  s_waitcnt lgkmcnt(6)
  v_pk_add_f32 v[104:105], v[104:105], v[106:107]
  s_waitcnt lgkmcnt(4)
  v_pk_add_f32 v[108:109], v[108:109], v[110:111]
  s_waitcnt lgkmcnt(2)
  v_pk_add_f32 v[112:113], v[112:113], v[114:115]
  s_waitcnt lgkmcnt(0)
  v_pk_add_f32 v[116:117], v[116:117], v[118:119]
  v_pk_add_f32 v[104:105], v[104:105], v[108:109]
  v_pk_add_f32 v[112:113], v[112:113], v[116:117]
  v_pk_add_f32 v[104:105], v[104:105], v[112:113]
  v_mul_f32 v104, s67, v104
  v_mul_f32 v105, s67, v105
  v_bfi_b32 v10, s56, v8, v104
  v_bfi_b32 v11, s56, v9, v105
  s_cmp_eq_u32 s77, 1
  s_cbranch_scc1 L_dry_1
  s_cmp_eq_u32 s75, 1
  s_cbranch_scc0 L_pf_130
  global_store_dwordx2 v3, v[10:11], s[42:43]
  s_branch L_pe_131
L_pf_130:
  global_store_dwordx2 v3, v[10:11], s[42:43] sc1
L_pe_131:
L_tail:
  s_cmp_eq_u32 s60, 1
  s_cbranch_scc1 L_t_wo
  s_cmp_eq_u32 s60, 2
  s_cbranch_scc1 L_t_f1
  s_cmp_eq_u32 s60, 3
  s_cbranch_scc1 L_t_f2
  s_branch L_fin
L_t_wo:
  s_mov_b32 s70, 0
L_wo_p:
  global_load_dwordx4 v[104:107], v15, s[42:43] offset:0 sc1
  global_load_dwordx4 v[108:111], v15, s[42:43] offset:512 sc1
  global_load_dwordx4 v[112:115], v15, s[42:43] offset:1024 sc1
  global_load_dwordx4 v[116:119], v15, s[42:43] offset:1536 sc1
  s_waitcnt vmcnt(3)
  v_xor_b32 v104, s62, v104
  v_xor_b32 v105, s63, v105
  v_xor_b32 v106, s64, v106
  v_xor_b32 v107, s65, v107
  s_waitcnt vmcnt(2)
  v_xor_b32 v108, s62, v108
  v_xor_b32 v109, s63, v109
  v_xor_b32 v110, s64, v110
  v_xor_b32 v111, s65, v111
  s_waitcnt vmcnt(1)
  v_xor_b32 v112, s62, v112
  v_xor_b32 v113, s63, v113
  v_xor_b32 v114, s64, v114
  v_xor_b32 v115, s65, v115
  s_waitcnt vmcnt(0)
  v_xor_b32 v116, s62, v116
  v_xor_b32 v117, s63, v117
  v_xor_b32 v118, s64, v118
  v_xor_b32 v119, s65, v119
  v_or3_b32 v28, v104, v105, v106
  v_or3_b32 v29, v107, v108, v109
  v_or3_b32 v30, v110, v111, v112
  v_or3_b32 v31, v113, v114, v115
  v_or3_b32 v32, v116, v117, v118
  v_or3_b32 v28, v28, v29, v30
  v_or3_b32 v31, v31, v32, v119
  v_or_b32 v28, v28, v31
  v_lshlrev_b32 v28, 24, v28
  v_cmp_ne_u32 vcc, 0, v28
  v_pk_add_f32 v[16:17], v[104:105], v[112:113]
  v_pk_add_f32 v[18:19], v[106:107], v[114:115]
  v_pk_add_f32 v[20:21], v[108:109], v[116:117]
  v_pk_add_f32 v[22:23], v[110:111], v[118:119]
  v_pk_add_f32 v[16:17], v[16:17], v[20:21]
  v_pk_add_f32 v[18:19], v[18:19], v[22:23]
  s_cmp_eq_u64 vcc, 0
  s_cbranch_scc1 L_wo_ok
  s_add_u32 s70, s70, 1
  s_cmp_lt_u32 s70, 262144
  s_cbranch_scc1 L_wo_p
L_wo_ok:
  v_cvt_pk_bf16_f32 v8, v16, v17
  v_cvt_pk_bf16_f32 v9, v18, v19
  ds_write_b64 v12, v[8:9] offset:0
  s_waitcnt lgkmcnt(0)
  s_cmp_eq_u32 s77, 1
  s_cbranch_scc1 L_nb_132
  s_barrier
L_nb_132:
  ds_read_b128 v[104:107], v14 offset:0
  ds_read_b128 v[108:111], v14 offset:64
  ds_read_b128 v[112:115], v14 offset:128
  ds_read_b128 v[116:119], v14 offset:192
  ds_read_b128 v[120:123], v14 offset:256
  ds_read_b128 v[124:127], v14 offset:320
  ds_read_b128 v[128:131], v14 offset:384
  ds_read_b128 v[132:135], v14 offset:448
  ds_read_b128 v[136:139], v14 offset:512
  ds_read_b128 v[140:143], v14 offset:576
  ds_read_b128 v[144:147], v14 offset:640
  ds_read_b128 v[148:151], v14 offset:704
  s_waitcnt lgkmcnt(11)
  v_mfma_f32_16x16x32_bf16 v[8:11], v[40:43], v[104:107], 0
  ds_read_b128 v[152:155], v14 offset:768
  s_waitcnt lgkmcnt(11)
  v_mfma_f32_16x16x32_bf16 v[8:11], v[44:47], v[108:111], v[8:11]
  ds_read_b128 v[156:159], v14 offset:832
  s_waitcnt lgkmcnt(11)
  v_mfma_f32_16x16x32_bf16 v[8:11], v[48:51], v[112:115], v[8:11]
  ds_read_b128 v[160:163], v14 offset:896
  s_waitcnt lgkmcnt(11)
  v_mfma_f32_16x16x32_bf16 v[8:11], v[52:55], v[116:119], v[8:11]
  ds_read_b128 v[164:167], v14 offset:960
  s_waitcnt lgkmcnt(11)
  v_mfma_f32_16x16x32_bf16 v[8:11], v[56:59], v[120:123], v[8:11]
  s_waitcnt lgkmcnt(10)
  v_mfma_f32_16x16x32_bf16 v[8:11], v[60:63], v[124:127], v[8:11]
  s_waitcnt lgkmcnt(9)
  v_mfma_f32_16x16x32_bf16 v[8:11], v[64:67], v[128:131], v[8:11]
  s_waitcnt lgkmcnt(8)
  v_mfma_f32_16x16x32_bf16 v[8:11], v[68:71], v[132:135], v[8:11]
  s_waitcnt lgkmcnt(7)
  v_mfma_f32_16x16x32_bf16 v[8:11], v[72:75], v[136:139], v[8:11]
  s_waitcnt lgkmcnt(6)
  v_mfma_f32_16x16x32_bf16 v[8:11], v[76:79], v[140:143], v[8:11]
  s_waitcnt lgkmcnt(5)
  v_mfma_f32_16x16x32_bf16 v[8:11], v[80:83], v[144:147], v[8:11]
  s_waitcnt lgkmcnt(4)
  v_mfma_f32_16x16x32_bf16 v[8:11], v[84:87], v[148:151], v[8:11]
  s_waitcnt lgkmcnt(3)
  v_mfma_f32_16x16x32_bf16 v[8:11], v[88:91], v[152:155], v[8:11]
  s_waitcnt lgkmcnt(2)
  v_mfma_f32_16x16x32_bf16 v[8:11], v[92:95], v[156:159], v[8:11]
  s_waitcnt lgkmcnt(1)
  v_mfma_f32_16x16x32_bf16 v[8:11], v[96:99], v[160:163], v[8:11]
  s_waitcnt lgkmcnt(0)
  v_mfma_f32_16x16x32_bf16 v[8:11], v[100:103], v[164:167], v[8:11]
  s_nop 7
  v_bfi_b32 v8, v36, s62, v8
  v_bfi_b32 v9, v36, s63, v9
  v_bfi_b32 v10, v36, s64, v10
  v_bfi_b32 v11, v36, s65, v11
  s_mov_b32 exec_lo, 0x00030003
  s_mov_b32 exec_hi, 0x00030003
  s_cmp_eq_u32 s77, 1
  s_cbranch_scc1 L_dry_end
  global_store_dwordx4 v13, v[8:11], s[42:43] sc1
  global_store_dwordx4 v37, v[8:11], s[42:43] sc1
  s_branch L_fin
L_t_f1:
  s_barrier
  global_load_dwordx2 v[8:9], v31, s[16:17]
  global_load_dwordx4 v[136:139], v24, s[42:43] sc1
  global_load_dwordx4 v[140:143], v25, s[42:43] sc1
  global_load_dwordx4 v[144:147], v26, s[42:43] sc1
  v_mov_b32 v2, v29
  s_add_u32 s51, s50, 8192
L_dma_136:
  s_mov_b32 m0, s50
  s_add_u32 s50, s50, 1024
  buffer_load_dwordx4 v2, s[44:47], s49 offen nt lds
  s_add_u32 s49, s49, 88064
  s_cmp_lt_u32 s50, s51
  s_cbranch_scc1 L_dma_136
L_dmae_137:
  global_load_dwordx4 v[104:107], v15, s[42:43] sc1
  global_load_dwordx4 v[108:111], v35, s[42:43] sc1
  global_load_dwordx4 v[112:115], v32, s[42:43] sc1
  global_load_dwordx4 v[116:119], v36, s[42:43] sc1
  global_load_dwordx4 v[120:123], v33, s[42:43] sc1
  global_load_dwordx4 v[124:127], v37, s[42:43] sc1
  global_load_dwordx4 v[128:131], v34, s[42:43] sc1
  global_load_dwordx4 v[132:135], v39, s[42:43] sc1
  s_mov_b32 s70, 0
  s_waitcnt vmcnt(16)
  s_branch L_pgc_134
L_pg_133:
  global_load_dwordx4 v[136:139], v24, s[42:43] sc1
  global_load_dwordx4 v[140:143], v25, s[42:43] sc1
  global_load_dwordx4 v[144:147], v26, s[42:43] sc1
  s_waitcnt vmcnt(0)
L_pgc_134:
  s_mov_b64 vcc, 0
  v_cmp_ne_u32 s[68:69], s74, v137
  s_or_b64 vcc, vcc, s[68:69]
  v_cmp_ne_u32 s[68:69], s74, v139
  s_or_b64 vcc, vcc, s[68:69]
  v_cmp_ne_u32 s[68:69], s74, v141
  s_or_b64 vcc, vcc, s[68:69]
  v_cmp_ne_u32 s[68:69], s74, v143
  s_or_b64 vcc, vcc, s[68:69]
  v_cmp_ne_u32 s[68:69], s74, v145
  s_or_b64 vcc, vcc, s[68:69]
  v_cmp_ne_u32 s[68:69], s74, v147
  s_or_b64 vcc, vcc, s[68:69]
  s_cmp_eq_u64 vcc, 0
  s_cbranch_scc1 L_pge_135
  s_sleep 4
  s_add_u32 s70, s70, 1
  s_cmp_lt_u32 s70, 262144
  s_cbranch_scc1 L_pg_133
L_pge_135:
  v_lshlrev_b32 v16, 16, v8
  v_and_b32 v17, s73, v8
  v_lshlrev_b32 v18, 16, v9
  v_and_b32 v19, s73, v9
  v_lshlrev_b32 v20, 16, v136
  v_and_b32 v21, s73, v136
  v_lshlrev_b32 v22, 16, v138
  v_and_b32 v23, s73, v138
  v_lshlrev_b32 v28, 16, v144
  v_and_b32 v29, s73, v144
  v_lshlrev_b32 v30, 16, v146
  v_and_b32 v31, s73, v146
  v_add_f32 v28, 1.0, v28
  v_add_f32 v29, 1.0, v29
  v_add_f32 v30, 1.0, v30
  v_add_f32 v31, 1.0, v31
  v_cvt_pk_bf16_f32 v8, v28, v29
  v_cvt_pk_bf16_f32 v9, v30, v31
  v_mov_b32 v141, v142
  ds_write_b64 v12, v[8:9] offset:2112
  ds_write_b64 v12, v[140:141] offset:4224
  v_cvt_pk_bf16_f32 v28, 0, v28
  v_cvt_pk_bf16_f32 v29, 0, v29
  v_cvt_pk_bf16_f32 v30, 0, v30
  v_cvt_pk_bf16_f32 v31, 0, v31
  v_mul_f32 v24, v20, v28
  v_mul_f32 v25, v21, v29
  v_mul_f32 v26, v22, v30
  v_mul_f32 v27, v23, v31
  v_mul_f32 v28, v16, v28
  v_mul_f32 v29, v17, v29
  v_mul_f32 v30, v18, v30
  v_mul_f32 v31, v19, v31
  v_mov_b32 v2, v6
  s_waitcnt vmcnt(8)
  s_barrier
  ds_read_b64_tr_b16 v[40:41], v2 offset:0
  ds_read_b64_tr_b16 v[42:43], v2 offset:512
  ds_read_b64_tr_b16 v[44:45], v2 offset:1024
  ds_read_b64_tr_b16 v[46:47], v2 offset:1536
  ds_read_b64_tr_b16 v[48:49], v2 offset:2048
  ds_read_b64_tr_b16 v[50:51], v2 offset:2560
  ds_read_b64_tr_b16 v[52:53], v2 offset:3072
  ds_read_b64_tr_b16 v[54:55], v2 offset:3584
  ds_read_b64_tr_b16 v[56:57], v2 offset:4096
  ds_read_b64_tr_b16 v[58:59], v2 offset:4608
  ds_read_b64_tr_b16 v[60:61], v2 offset:5120
  ds_read_b64_tr_b16 v[62:63], v2 offset:5632
  s_waitcnt lgkmcnt(10)
  ds_read_b64_tr_b16 v[64:65], v2 offset:6144
  ds_read_b64_tr_b16 v[66:67], v2 offset:6656
  s_waitcnt lgkmcnt(10)
  ds_read_b64_tr_b16 v[68:69], v2 offset:7168
  ds_read_b64_tr_b16 v[70:71], v2 offset:7680
  s_waitcnt lgkmcnt(10)
  ds_read_b64_tr_b16 v[72:73], v2 offset:8192
  ds_read_b64_tr_b16 v[74:75], v2 offset:8704
  s_waitcnt lgkmcnt(10)
  ds_read_b64_tr_b16 v[76:77], v2 offset:9216
  ds_read_b64_tr_b16 v[78:79], v2 offset:9728
  s_waitcnt lgkmcnt(10)
  ds_read_b64_tr_b16 v[80:81], v2 offset:10240
  ds_read_b64_tr_b16 v[82:83], v2 offset:10752
  s_waitcnt lgkmcnt(10)
  ds_read_b64_tr_b16 v[84:85], v2 offset:11264
  ds_read_b64_tr_b16 v[86:87], v2 offset:11776
  s_waitcnt lgkmcnt(10)
  ds_read_b64_tr_b16 v[88:89], v2 offset:12288
  ds_read_b64_tr_b16 v[90:91], v2 offset:12800
  s_waitcnt lgkmcnt(10)
  ds_read_b64_tr_b16 v[92:93], v2 offset:13312
  ds_read_b64_tr_b16 v[94:95], v2 offset:13824
  s_waitcnt lgkmcnt(10)
  ds_read_b64_tr_b16 v[96:97], v2 offset:14336
  ds_read_b64_tr_b16 v[98:99], v2 offset:14848
  s_waitcnt lgkmcnt(10)
  ds_read_b64_tr_b16 v[100:101], v2 offset:15360
  ds_read_b64_tr_b16 v[102:103], v2 offset:15872
  s_waitcnt lgkmcnt(10)
  s_waitcnt lgkmcnt(0)
  s_mov_b32 s70, 0
  s_mov_b32 s71, 15
  s_branch L_f1_c
L_f1_p:
  s_add_u32 s70, s70, 1
  s_cmp_ge_u32 s70, 262144
  s_cbranch_scc1 L_f1_ok
  s_bitcmp1_b32 s71, 0
  s_cbranch_scc0 L_fl_138
  global_load_dwordx4 v[104:107], v15, s[42:43] sc1
  global_load_dwordx4 v[108:111], v35, s[42:43] sc1
L_fl_138:
  s_bitcmp1_b32 s71, 1
  s_cbranch_scc0 L_fl_139
  global_load_dwordx4 v[112:115], v32, s[42:43] sc1
  global_load_dwordx4 v[116:119], v36, s[42:43] sc1
L_fl_139:
  s_bitcmp1_b32 s71, 2
  s_cbranch_scc0 L_fl_140
  global_load_dwordx4 v[120:123], v33, s[42:43] sc1
  global_load_dwordx4 v[124:127], v37, s[42:43] sc1
L_fl_140:
  s_bitcmp1_b32 s71, 3
  s_cbranch_scc0 L_fl_141
  global_load_dwordx4 v[128:131], v34, s[42:43] sc1
  global_load_dwordx4 v[132:135], v39, s[42:43] sc1
L_fl_141:
L_f1_c:
  s_waitcnt vmcnt(0)
  s_bitcmp1_b32 s71, 0
  s_cbranch_scc0 L_fc_142
  v_xor_b32 v104, s62, v104
  v_xor_b32 v105, s63, v105
  v_xor_b32 v106, s64, v106
  v_xor_b32 v107, s65, v107
  v_xor_b32 v108, s62, v108
  v_xor_b32 v109, s63, v109
  v_xor_b32 v110, s64, v110
  v_xor_b32 v111, s65, v111
  v_or3_b32 v8, v104, v105, v106
  v_or3_b32 v9, v107, v108, v109
  v_or3_b32 v8, v8, v110, v111
  v_pk_add_f32 v[136:137], v[104:105], v[108:109]
  v_pk_add_f32 v[138:139], v[106:107], v[110:111]
  v_or_b32 v8, v8, v9
  v_lshlrev_b32 v8, 24, v8
  v_cmp_ne_u32 vcc, 0, v8
  s_cmp_lg_u64 vcc, 0
  s_cbranch_scc1 L_fc_142
  s_bitset0_b32 s71, 0
L_fc_142:
  s_bitcmp1_b32 s71, 1
  s_cbranch_scc0 L_fc_143
  v_xor_b32 v112, s62, v112
  v_xor_b32 v113, s63, v113
  v_xor_b32 v114, s64, v114
  v_xor_b32 v115, s65, v115
  v_xor_b32 v116, s62, v116
  v_xor_b32 v117, s63, v117
  v_xor_b32 v118, s64, v118
  v_xor_b32 v119, s65, v119
  v_or3_b32 v8, v112, v113, v114
  v_or3_b32 v9, v115, v116, v117
  v_or3_b32 v8, v8, v118, v119
  v_pk_add_f32 v[144:145], v[112:113], v[116:117]
  v_pk_add_f32 v[146:147], v[114:115], v[118:119]
  v_or_b32 v8, v8, v9
  v_lshlrev_b32 v8, 24, v8
  v_cmp_ne_u32 vcc, 0, v8
  s_cmp_lg_u64 vcc, 0
  s_cbranch_scc1 L_fc_143
  s_bitset0_b32 s71, 1
L_fc_143:
  s_bitcmp1_b32 s71, 2
  s_cbranch_scc0 L_fc_144
  v_xor_b32 v120, s62, v120
  v_xor_b32 v121, s63, v121
  v_xor_b32 v122, s64, v122
  v_xor_b32 v123, s65, v123
  v_xor_b32 v124, s62, v124
  v_xor_b32 v125, s63, v125
  v_xor_b32 v126, s64, v126
  v_xor_b32 v127, s65, v127
  v_or3_b32 v8, v120, v121, v122
  v_or3_b32 v9, v123, v124, v125
  v_or3_b32 v8, v8, v126, v127
  v_pk_add_f32 v[152:153], v[120:121], v[124:125]
  v_pk_add_f32 v[154:155], v[122:123], v[126:127]
  v_or_b32 v8, v8, v9
  v_lshlrev_b32 v8, 24, v8
  v_cmp_ne_u32 vcc, 0, v8
  s_cmp_lg_u64 vcc, 0
  s_cbranch_scc1 L_fc_144
  s_bitset0_b32 s71, 2
L_fc_144:
  s_bitcmp1_b32 s71, 3
  s_cbranch_scc0 L_fc_145
  v_xor_b32 v128, s62, v128
  v_xor_b32 v129, s63, v129
  v_xor_b32 v130, s64, v130
  v_xor_b32 v131, s65, v131
  v_xor_b32 v132, s62, v132
  v_xor_b32 v133, s63, v133
  v_xor_b32 v134, s64, v134
  v_xor_b32 v135, s65, v135
  v_or3_b32 v8, v128, v129, v130
  v_or3_b32 v9, v131, v132, v133
  v_or3_b32 v8, v8, v134, v135
  v_pk_add_f32 v[160:161], v[128:129], v[132:133]
  v_pk_add_f32 v[162:163], v[130:131], v[134:135]
  v_or_b32 v8, v8, v9
  v_lshlrev_b32 v8, 24, v8
  v_cmp_ne_u32 vcc, 0, v8
  s_cmp_lg_u64 vcc, 0
  s_cbranch_scc1 L_fc_145
  s_bitset0_b32 s71, 3
L_fc_145:
  s_cmp_lg_u32 s71, 0
  s_cbranch_scc1 L_f1_p
L_f1_ok:
  v_pk_add_f32 v[136:137], v[136:137], v[144:145]
  v_pk_add_f32 v[138:139], v[138:139], v[146:147]
  v_pk_add_f32 v[152:153], v[152:153], v[160:161]
  v_pk_add_f32 v[154:155], v[154:155], v[162:163]
  v_pk_add_f32 v[136:137], v[136:137], v[152:153]
  v_pk_add_f32 v[138:139], v[138:139], v[154:155]
  v_pk_fma_f32 v[8:9], v[136:137], v[24:25], v[28:29]
  v_pk_fma_f32 v[10:11], v[138:139], v[26:27], v[30:31]
  v_cvt_pk_bf16_f32 v8, v8, v9
  v_cvt_pk_bf16_f32 v9, v10, v11
  ds_write_b64 v12, v[8:9] offset:0
  v_pk_fma_f32 v[16:17], v[136:137], v[20:21], v[16:17]
  v_pk_fma_f32 v[18:19], v[138:139], v[22:23], v[18:19]
  s_waitcnt lgkmcnt(0)
  s_cmp_eq_u32 s77, 1
  s_cbranch_scc1 L_nb_146
  s_barrier
L_nb_146:
  ds_read_b128 v[104:107], v14 offset:0
  ds_read_b128 v[108:111], v14 offset:64
  ds_read_b128 v[112:115], v14 offset:128
  ds_read_b128 v[116:119], v14 offset:192
  ds_read_b128 v[120:123], v14 offset:256
  ds_read_b128 v[124:127], v14 offset:320
  ds_read_b128 v[128:131], v14 offset:384
  ds_read_b128 v[132:135], v14 offset:448
  ds_read_b128 v[136:139], v14 offset:512
  ds_read_b128 v[140:143], v14 offset:576
  ds_read_b128 v[144:147], v14 offset:640
  ds_read_b128 v[148:151], v14 offset:704
  v_add_f32 v8, v16, v17
  v_mul_f32 v9, v16, v16
  v_add_f32 v10, v18, v19
  v_mul_f32 v11, v18, v18
  v_fmac_f32 v9, v17, v17
  v_fmac_f32 v11, v19, v19
  v_add_f32 v8, v8, v10
  v_add_f32 v9, v9, v11
  s_nop 0
  v_add_f32_dpp v8, v8, v8 quad_perm:[1,0,3,2] row_mask:0xf bank_mask:0xf
  v_add_f32_dpp v9, v9, v9 quad_perm:[1,0,3,2] row_mask:0xf bank_mask:0xf
  s_waitcnt lgkmcnt(11)
  v_mfma_f32_16x16x32_bf16 v[32:35], v[40:43], v[104:107], 0
  ds_read_b128 v[152:155], v14 offset:768
  v_add_f32_dpp v8, v8, v8 quad_perm:[2,3,0,1] row_mask:0xf bank_mask:0xf
  v_add_f32_dpp v9, v9, v9 quad_perm:[2,3,0,1] row_mask:0xf bank_mask:0xf
  s_waitcnt lgkmcnt(11)
  v_mfma_f32_16x16x32_bf16 v[32:35], v[44:47], v[108:111], v[32:35]
  ds_read_b128 v[156:159], v14 offset:832
  v_add_f32_dpp v8, v8, v8 row_ror:8 row_mask:0xf bank_mask:0xf
  v_add_f32_dpp v9, v9, v9 row_ror:8 row_mask:0xf bank_mask:0xf
  s_waitcnt lgkmcnt(11)
  v_mfma_f32_16x16x32_bf16 v[32:35], v[48:51], v[112:115], v[32:35]
  ds_read_b128 v[160:163], v14 offset:896
  v_mov_b32 v10, v8
  v_mov_b32 v11, v9
  s_waitcnt lgkmcnt(11)
  v_mfma_f32_16x16x32_bf16 v[32:35], v[52:55], v[116:119], v[32:35]
  ds_read_b128 v[164:167], v14 offset:960
  v_permlane16_swap_b32 v10, v8
  v_permlane16_swap_b32 v11, v9
  s_waitcnt lgkmcnt(11)
  v_mfma_f32_16x16x32_bf16 v[32:35], v[56:59], v[120:123], v[32:35]
  v_add_f32 v8, v8, v10
  v_add_f32 v9, v9, v11
  v_mov_b32 v10, v8
  v_mov_b32 v11, v9
  s_waitcnt lgkmcnt(10)
  v_mfma_f32_16x16x32_bf16 v[32:35], v[60:63], v[124:127], v[32:35]
  v_permlane32_swap_b32 v10, v8
  v_permlane32_swap_b32 v11, v9
  s_waitcnt lgkmcnt(9)
  v_mfma_f32_16x16x32_bf16 v[32:35], v[64:67], v[128:131], v[32:35]
  v_add_f32 v8, v8, v10
  v_add_f32 v9, v9, v11
  ds_write_b64 v5, v[8:9]
  s_waitcnt lgkmcnt(9)
  v_mfma_f32_16x16x32_bf16 v[32:35], v[68:71], v[132:135], v[32:35]
  s_waitcnt lgkmcnt(8)
  v_mfma_f32_16x16x32_bf16 v[32:35], v[72:75], v[136:139], v[32:35]
  s_waitcnt lgkmcnt(7)
  v_mfma_f32_16x16x32_bf16 v[32:35], v[76:79], v[140:143], v[32:35]
  s_waitcnt lgkmcnt(0)
  s_cmp_eq_u32 s77, 1
  s_cbranch_scc1 L_nb_147
  s_barrier
L_nb_147:
  ds_read_b128 v[20:23], v7 offset:15104
  ds_read_b128 v[24:27], v7 offset:15120
  v_mfma_f32_16x16x32_bf16 v[32:35], v[80:83], v[144:147], v[32:35]
  v_mfma_f32_16x16x32_bf16 v[32:35], v[84:87], v[148:151], v[32:35]
  v_mfma_f32_16x16x32_bf16 v[32:35], v[88:91], v[152:155], v[32:35]
  v_mfma_f32_16x16x32_bf16 v[32:35], v[92:95], v[156:159], v[32:35]
  v_mfma_f32_16x16x32_bf16 v[32:35], v[96:99], v[160:163], v[32:35]
  s_waitcnt lgkmcnt(0)
  v_pk_add_f32 v[20:21], v[20:21], v[22:23]
  v_pk_add_f32 v[24:25], v[24:25], v[26:27]
  v_mfma_f32_16x16x32_bf16 v[32:35], v[100:103], v[164:167], v[32:35]
  v_pk_add_f32 v[20:21], v[20:21], v[24:25]
  v_mul_f32 v20, 0xbb000000, v20
  v_mul_f32 v21, 0x3b000000, v21
  v_fma_f32 v21, -v20, v20, v21
  v_max_f32 v21, 0, v21
  v_add_f32 v21, 0x3727c5ac, v21
  v_rsq_f32 v21, v21
  s_nop 0
  v_fmac_f32_dpp v32, v32, v20 row_shl:2 row_mask:0xf bank_mask:0x1
  v_fmac_f32_dpp v33, v33, v20 row_shl:2 row_mask:0xf bank_mask:0x1
  v_fmac_f32_dpp v34, v34, v20 row_shl:2 row_mask:0xf bank_mask:0x1
  v_fmac_f32_dpp v35, v35, v20 row_shl:2 row_mask:0xf bank_mask:0x1
  v_mul_f32 v8, v32, v21
  v_mul_f32 v9, v33, v21
  v_mul_f32 v10, v34, v21
  v_mul_f32 v11, v35, v21
  v_add_f32_dpp v8, v32, v8 row_shl:4 row_mask:0xf bank_mask:0xf
  v_add_f32_dpp v9, v33, v9 row_shl:4 row_mask:0xf bank_mask:0xf
  v_add_f32_dpp v10, v34, v10 row_shl:4 row_mask:0xf bank_mask:0xf
  v_add_f32_dpp v11, v35, v11 row_shl:4 row_mask:0xf bank_mask:0xf
  s_mov_b32 s50, 0x00030003
  s_mov_b32 s51, 0x00030003
  v_permlane32_swap_b32 v8, v10
  v_permlane32_swap_b32 v9, v11
  v_mul_f32 v20, 0xbfb8aa3b, v8
  v_mul_f32 v21, 0xbfb8aa3b, v9
  v_exp_f32 v20, v20
  v_exp_f32 v21, v21
  v_mul_f32 v8, v8, v10
  v_mul_f32 v9, v9, v11
  v_add_f32 v20, 1.0, v20
  v_add_f32 v21, 1.0, v21
  v_rcp_f32 v20, v20
  v_rcp_f32 v21, v21
  s_mov_b64 exec, s[50:51]
  v_mul_f32 v8, v8, v20
  v_mul_f32 v9, v9, v21
  v_cvt_pk_bf16_f32 v8, v8, v9
  v_min_u32 v8, s72, v8
  s_cmp_eq_u32 s77, 1
  s_cbranch_scc1 L_dry_end
  global_store_dword v13, v8, s[42:43] sc1
  global_store_dword v4, v8, s[42:43] sc1
  s_branch L_fin
L_t_f2:
  s_barrier
  global_load_dwordx2 v[8:9], v31, s[16:17]
  global_load_dwordx4 v[136:139], v24, s[42:43] sc1
  global_load_dwordx4 v[140:143], v25, s[42:43] sc1
  v_mov_b32 v2, v29
  s_and_b32 s59, s61, 3
  s_mul_i32 s59, s59, 3072
  s_mul_i32 s49, s5, 360448
  s_add_u32 s49, s49, s48
  s_mul_i32 s50, s5, 11264
  s_add_u32 s50, s50, 16384
  s_lshl_b32 s52, s59, 5
  s_add_u32 s49, s49, s52
  s_add_u32 s50, s50, s59
  s_sub_u32 s52, 11264, s59
  s_add_u32 s51, s50, s52
  s_cmp_lt_u32 s50, s51
  s_cbranch_scc0 L_dmae_152
L_dma_151:
  s_mov_b32 m0, s50
  s_add_u32 s50, s50, 1024
  buffer_load_dwordx4 v2, s[44:47], s49 offen nt lds
  s_add_u32 s49, s49, 32768
  s_cmp_lt_u32 s50, s51
  s_cbranch_scc1 L_dma_151
L_dmae_152:
  s_mul_i32 s49, s5, 360448
  s_add_u32 s49, s49, s48
  s_mul_i32 s50, s5, 11264
  s_add_u32 s50, s50, 16384
  s_add_u32 s51, s50, s59
  s_cmp_lt_u32 s50, s51
  s_cbranch_scc0 L_dmae_154
L_dma_153:
  s_mov_b32 m0, s50
  s_add_u32 s50, s50, 1024
  buffer_load_dwordx4 v2, s[44:47], s49 offen nt lds
  s_add_u32 s49, s49, 32768
  s_cmp_lt_u32 s50, s51
  s_cbranch_scc1 L_dma_153
L_dmae_154:
  s_mov_b32 s70, 0
  s_waitcnt vmcnt(11)
  s_branch L_pgc_149
L_pg_148:
  global_load_dwordx4 v[136:139], v24, s[42:43] sc1
  global_load_dwordx4 v[140:143], v25, s[42:43] sc1
  s_waitcnt vmcnt(0)
L_pgc_149:
  s_mov_b64 vcc, 0
  v_cmp_ne_u32 s[68:69], s74, v137
  s_or_b64 vcc, vcc, s[68:69]
  v_cmp_ne_u32 s[68:69], s74, v139
  s_or_b64 vcc, vcc, s[68:69]
  v_cmp_ne_u32 s[68:69], s74, v141
  s_or_b64 vcc, vcc, s[68:69]
  v_cmp_ne_u32 s[68:69], s74, v143
  s_or_b64 vcc, vcc, s[68:69]
  s_cmp_eq_u64 vcc, 0
  s_cbranch_scc1 L_pge_150
  s_sleep 4
  s_add_u32 s70, s70, 1
  s_cmp_lt_u32 s70, 262144
  s_cbranch_scc1 L_pg_148
L_pge_150:
  v_lshlrev_b32 v16, 16, v8
  v_and_b32 v17, s73, v8
  v_lshlrev_b32 v18, 16, v9
  v_and_b32 v19, s73, v9
  v_lshlrev_b32 v20, 16, v136
  v_and_b32 v21, s73, v136
  v_lshlrev_b32 v22, 16, v138
  v_and_b32 v23, s73, v138
  v_lshlrev_b32 v24, 16, v140
  v_and_b32 v25, s73, v140
  v_lshlrev_b32 v26, 16, v142
  v_and_b32 v27, s73, v142
  v_mov_b32 v2, v6
  s_mov_b32 s50, 0x00030003
  s_mov_b32 s51, 0x00030003
  s_mov_b32 s53, 0x0fff0fff
  s_cmp_eq_u32 s5, 3
  s_cselect_b32 s52, 0x00ff00ff, s53
  s_mov_b32 s53, s52
  s_cmp_lg_u32 s5, 0
  s_cbranch_scc1 L_f2_w
  s_mov_b64 exec, s[50:51]
  global_load_dwordx4 v[104:107], v15, s[42:43] sc1
  global_load_dwordx4 v[108:111], v35, s[42:43] sc1
  global_load_dwordx4 v[112:115], v32, s[42:43] sc1
  global_load_dwordx4 v[116:119], v36, s[42:43] sc1
  global_load_dwordx4 v[120:123], v33, s[42:43] sc1
  global_load_dwordx4 v[124:127], v37, s[42:43] sc1
  global_load_dwordx4 v[128:131], v34, s[42:43] sc1
  global_load_dwordx4 v[132:135], v39, s[42:43] sc1
  s_mov_b64 exec, -1
  s_waitcnt vmcnt(8)
  s_branch L_f2_w2
L_f2_w:
  s_waitcnt vmcnt(0)
L_f2_w2:
  ds_read_b64_tr_b16 v[40:41], v2 offset:0
  ds_read_b64_tr_b16 v[42:43], v2 offset:128
  ds_read_b64_tr_b16 v[44:45], v2 offset:1024
  ds_read_b64_tr_b16 v[46:47], v2 offset:1152
  ds_read_b64_tr_b16 v[48:49], v2 offset:2048
  ds_read_b64_tr_b16 v[50:51], v2 offset:2176
  ds_read_b64_tr_b16 v[52:53], v2 offset:3072
  ds_read_b64_tr_b16 v[54:55], v2 offset:3200
  ds_read_b64_tr_b16 v[56:57], v2 offset:4096
  ds_read_b64_tr_b16 v[58:59], v2 offset:4224
  ds_read_b64_tr_b16 v[60:61], v2 offset:5120
  ds_read_b64_tr_b16 v[62:63], v2 offset:5248
  s_waitcnt lgkmcnt(10)
  ds_read_b64_tr_b16 v[64:65], v2 offset:6144
  ds_read_b64_tr_b16 v[66:67], v2 offset:6272
  s_waitcnt lgkmcnt(10)
  ds_read_b64_tr_b16 v[68:69], v2 offset:7168
  ds_read_b64_tr_b16 v[70:71], v2 offset:7296
  s_waitcnt lgkmcnt(10)
  ds_read_b64_tr_b16 v[72:73], v2 offset:8192
  ds_read_b64_tr_b16 v[74:75], v2 offset:8320
  s_waitcnt lgkmcnt(10)
  ds_read_b64_tr_b16 v[76:77], v2 offset:9216
  ds_read_b64_tr_b16 v[78:79], v2 offset:9344
  s_waitcnt lgkmcnt(10)
  ds_read_b64_tr_b16 v[80:81], v2 offset:10240
  ds_read_b64_tr_b16 v[82:83], v2 offset:10368
  s_waitcnt lgkmcnt(10)
  s_waitcnt lgkmcnt(0)
  s_cmp_lg_u32 s5, 0
  s_cbranch_scc1 L_f2x_155
  s_mov_b32 s70, 0
  s_mov_b64 exec, s[50:51]
  s_branch L_f2_ac
L_f2_a:
  s_mov_b64 exec, s[50:51]
  global_load_dwordx4 v[104:107], v15, s[42:43] sc1
  global_load_dwordx4 v[108:111], v35, s[42:43] sc1
  global_load_dwordx4 v[112:115], v32, s[42:43] sc1
  global_load_dwordx4 v[116:119], v36, s[42:43] sc1
  global_load_dwordx4 v[120:123], v33, s[42:43] sc1
  global_load_dwordx4 v[124:127], v37, s[42:43] sc1
  global_load_dwordx4 v[128:131], v34, s[42:43] sc1
  global_load_dwordx4 v[132:135], v39, s[42:43] sc1
L_f2_ac:
  s_waitcnt vmcnt(0)
  v_xor_b32 v136, s62, v104
  v_xor_b32 v137, s63, v105
  v_xor_b32 v138, s64, v106
  v_xor_b32 v139, s65, v107
  v_xor_b32 v140, s62, v108
  v_xor_b32 v141, s63, v109
  v_xor_b32 v142, s64, v110
  v_xor_b32 v143, s65, v111
  v_xor_b32 v144, s62, v112
  v_xor_b32 v145, s63, v113
  v_xor_b32 v146, s64, v114
  v_xor_b32 v147, s65, v115
  v_xor_b32 v148, s62, v116
  v_xor_b32 v149, s63, v117
  v_xor_b32 v150, s64, v118
  v_xor_b32 v151, s65, v119
  v_xor_b32 v152, s62, v120
  v_xor_b32 v153, s63, v121
  v_xor_b32 v154, s64, v122
  v_xor_b32 v155, s65, v123
  v_xor_b32 v156, s62, v124
  v_xor_b32 v157, s63, v125
  v_xor_b32 v158, s64, v126
  v_xor_b32 v159, s65, v127
  v_xor_b32 v160, s62, v128
  v_xor_b32 v161, s63, v129
  v_xor_b32 v162, s64, v130
  v_xor_b32 v163, s65, v131
  v_xor_b32 v164, s62, v132
  v_xor_b32 v165, s63, v133
  v_xor_b32 v166, s64, v134
  v_xor_b32 v167, s65, v135
  v_or3_b32 v8, v136, v137, v138
  v_or3_b32 v9, v144, v145, v146
  v_or3_b32 v10, v152, v153, v154
  v_or3_b32 v11, v160, v161, v162
  v_or3_b32 v8, v8, v139, v140
  v_or3_b32 v9, v9, v147, v148
  v_or3_b32 v10, v10, v155, v156
  v_or3_b32 v11, v11, v163, v164
  v_or3_b32 v8, v8, v141, v142
  v_or3_b32 v9, v9, v149, v150
  v_or3_b32 v10, v10, v157, v158
  v_or3_b32 v11, v11, v165, v166
  v_or_b32 v8, v8, v143
  v_or_b32 v9, v9, v151
  v_or_b32 v10, v10, v159
  v_or_b32 v11, v11, v167
  v_or3_b32 v3, v8, v9, v10
  v_or_b32 v3, v3, v11
  v_lshlrev_b32 v3, 24, v3
  v_cmp_ne_u32 vcc, 0, v3
  s_cmp_eq_u64 vcc, 0
  s_cbranch_scc1 L_f2_ad
  s_sleep 2
  s_add_u32 s70, s70, 1
  s_cmp_lt_u32 s70, 262144
  s_cbranch_scc1 L_f2_a
L_f2_ad:
  s_mov_b64 exec, -1
  v_pk_add_f32 v[136:137], v[136:137], v[140:141]
  v_pk_add_f32 v[138:139], v[138:139], v[142:143]
  v_pk_add_f32 v[144:145], v[144:145], v[148:149]
  v_pk_add_f32 v[146:147], v[146:147], v[150:151]
  v_pk_add_f32 v[152:153], v[152:153], v[156:157]
  v_pk_add_f32 v[154:155], v[154:155], v[158:159]
  v_pk_add_f32 v[160:161], v[160:161], v[164:165]
  v_pk_add_f32 v[162:163], v[162:163], v[166:167]
  v_pk_add_f32 v[136:137], v[136:137], v[144:145]
  v_pk_add_f32 v[138:139], v[138:139], v[146:147]
  v_pk_add_f32 v[152:153], v[152:153], v[160:161]
  v_pk_add_f32 v[154:155], v[154:155], v[162:163]
  v_pk_add_f32 v[136:137], v[136:137], v[152:153]
  v_pk_add_f32 v[138:139], v[138:139], v[154:155]
  v_cvt_pk_bf16_f32 v136, 0, v136
  v_cvt_pk_bf16_f32 v137, 0, v137
  v_cvt_pk_bf16_f32 v138, 0, v138
  v_cvt_pk_bf16_f32 v139, 0, v139
  v_mul_f32 v136, v136, v20
  v_mul_f32 v137, v137, v21
  v_mul_f32 v138, v138, v22
  v_mul_f32 v139, v139, v23
  v_cvt_pk_bf16_f32 v136, 0, v136
  v_cvt_pk_bf16_f32 v137, 0, v137
  v_cvt_pk_bf16_f32 v138, 0, v138
  v_cvt_pk_bf16_f32 v139, 0, v139
  v_add_f32 v16, v16, v136
  v_add_f32 v17, v17, v137
  v_add_f32 v18, v18, v138
  v_add_f32 v19, v19, v139
  v_cvt_pk_bf16_f32 v16, 0, v16
  v_cvt_pk_bf16_f32 v17, 0, v17
  v_cvt_pk_bf16_f32 v18, 0, v18
  v_cvt_pk_bf16_f32 v19, 0, v19
L_f2x_155:
  v_mov_b32 v112, 0
  v_mov_b32 v113, 0
  v_mov_b32 v114, 0
  v_mov_b32 v115, 0
  s_mov_b32 s70, 0
L_f2_p:
  global_load_dwordx4 v[104:107], v28, s[42:43] offset:-2048 sc1
  global_load_dwordx4 v[108:111], v28, s[42:43] sc1
  s_mov_b64 exec, s[52:53]
  global_load_dwordx4 v[112:115], v28, s[42:43] offset:2048 sc1
  s_mov_b64 exec, -1
  s_waitcnt vmcnt(0)
  v_mfma_f32_16x16x32_bf16 v[120:123], v[40:43], v[104:107], 0
  v_max3_u32 v31, v104, v105, v106
  v_max3_u32 v3, v107, v108, v109
  v_mfma_f32_16x16x32_bf16 v[124:127], v[44:47], v[104:107], 0
  v_max3_u32 v31, v31, v110, v111
  v_max3_u32 v3, v3, v112, v113
  v_mfma_f32_16x16x32_bf16 v[128:131], v[48:51], v[104:107], 0
  v_max3_u32 v31, v31, v114, v115
  v_max_u32 v31, v31, v3
  v_mfma_f32_16x16x32_bf16 v[132:135], v[52:55], v[104:107], 0
  v_cmp_eq_u32 vcc, -1, v31
  s_cmp_eq_u64 vcc, 0
  s_cbranch_scc1 L_f2_ok
  s_add_u32 s70, s70, 1
  s_cmp_lt_u32 s70, 262144
  s_cbranch_scc1 L_f2_p
L_f2_ok:
  v_mfma_f32_16x16x32_bf16 v[120:123], v[56:59], v[108:111], v[120:123]
  v_mfma_f32_16x16x32_bf16 v[124:127], v[60:63], v[108:111], v[124:127]
  v_mfma_f32_16x16x32_bf16 v[128:131], v[64:67], v[108:111], v[128:131]
  v_mfma_f32_16x16x32_bf16 v[132:135], v[68:71], v[108:111], v[132:135]
  v_mfma_f32_16x16x32_bf16 v[120:123], v[72:75], v[112:115], v[120:123]
  v_mfma_f32_16x16x32_bf16 v[124:127], v[76:79], v[112:115], v[124:127]
  v_mfma_f32_16x16x32_bf16 v[128:131], v[80:83], v[112:115], v[128:131]
  s_nop 6
  v_add_f32_dpp v8, v124, v120 row_shl:4 row_mask:0xf bank_mask:0xf
  v_add_f32_dpp v9, v125, v121 row_shl:4 row_mask:0xf bank_mask:0xf
  v_add_f32_dpp v10, v126, v122 row_shl:4 row_mask:0xf bank_mask:0xf
  v_add_f32_dpp v11, v127, v123 row_shl:4 row_mask:0xf bank_mask:0xf
  v_add_f32_dpp v128, v132, v128 row_shl:4 row_mask:0xf bank_mask:0xf
  v_add_f32_dpp v129, v133, v129 row_shl:4 row_mask:0xf bank_mask:0xf
  v_add_f32_dpp v130, v134, v130 row_shl:4 row_mask:0xf bank_mask:0xf
  v_add_f32_dpp v131, v135, v131 row_shl:4 row_mask:0xf bank_mask:0xf
  v_add_f32_dpp v8, v128, v8 row_shl:8 row_mask:0xf bank_mask:0xf
  v_add_f32_dpp v9, v129, v9 row_shl:8 row_mask:0xf bank_mask:0xf
  v_add_f32_dpp v10, v130, v10 row_shl:8 row_mask:0xf bank_mask:0xf
  v_add_f32_dpp v11, v131, v11 row_shl:8 row_mask:0xf bank_mask:0xf
  s_mov_b64 exec, s[50:51]
  ds_write_b128 v30, v[8:11]
  s_waitcnt lgkmcnt(0)
  s_cmp_eq_u32 s77, 1
  s_cbranch_scc1 L_nb_156
  s_barrier
L_nb_156:
  s_cmp_lg_u32 s5, s77
  s_cbranch_scc1 L_fin
  ds_read_b128 v[104:107], v12 offset:128
  ds_read_b128 v[108:111], v12 offset:256
  ds_read_b128 v[112:115], v12 offset:384
  s_waitcnt lgkmcnt(2)
  v_pk_add_f32 v[8:9], v[8:9], v[104:105]
  v_pk_add_f32 v[10:11], v[10:11], v[106:107]
  s_waitcnt lgkmcnt(0)
  v_pk_add_f32 v[108:109], v[108:109], v[112:113]
  v_pk_add_f32 v[110:111], v[110:111], v[114:115]
  v_pk_add_f32 v[8:9], v[8:9], v[108:109]
  v_pk_add_f32 v[10:11], v[10:11], v[110:111]
  v_pk_fma_f32 v[8:9], v[8:9], v[24:25], v[16:17]
  v_pk_fma_f32 v[10:11], v[10:11], v[26:27], v[18:19]
  v_cvt_pk_bf16_f32 v8, v8, v9
  v_cvt_pk_bf16_f32 v9, v10, v11
  s_cmp_eq_u32 s77, 1
  s_cbranch_scc1 L_dry_end
  global_store_dwordx2 v13, v[8:9], s[38:39]
  s_mov_b64 exec, 1
  s_cmp_lg_u32 s61, 0
  s_cbranch_scc1 L_noep
  v_mov_b32 v10, s74
  global_store_dword v38, v10, s[42:43] offset:0
L_noep:
L_fin:
L_end:
  s_endpgm
.p2align 7
L_table:
  .long 0x0007000e, 0x00070806, 0x00071016, 0x00071806, 0x00072006, 0x00072806, 0x00073006, 0x00073806
  .long 0x0007010e, 0x00070906, 0x00071116, 0x00071906, 0x00072106, 0x00072906, 0x00073106, 0x00073906
  .long 0x0007020e, 0x00070a06, 0x00071216, 0x00071a06, 0x00072206, 0x00072a06, 0x00073206, 0x00073a06
  .long 0x0000030e, 0x00000b06, 0x00001316, 0x00001b06, 0x00002306, 0x00002b06, 0x00003306, 0x00003b06
  .long 0x0007040e, 0x00070c06, 0x00071416, 0x00071c06, 0x00072406, 0x00072c06, 0x00073406, 0x00073c06
  .long 0x0007050e, 0x00070d06, 0x00071516, 0x00071d06, 0x00072506, 0x00072d06, 0x00073506, 0x00073d06
  .long 0x0007060e, 0x00070e06, 0x00071616, 0x00071e06, 0x00072606, 0x00072e06, 0x00073606, 0x00073e06
  .long 0x0007070e, 0x00070f06, 0x00071716, 0x00071f06, 0x00072706, 0x00072f06, 0x00073706, 0x00073f06
  .long 0x00120009, 0x00120001, 0x00120011, 0x00120001, 0x00120001, 0x00120001, 0x00120001, 0x00120001
  .long 0x00120109, 0x00120101, 0x00120111, 0x00120101, 0x00120101, 0x00120101, 0x00120101, 0x00120101
  .long 0x00120209, 0x00120201, 0x00120211, 0x00120201, 0x00120201, 0x00120201, 0x00120201, 0x00120201
  .long 0x00010309, 0x00010301, 0x00010311, 0x00010301, 0x00010301, 0x00010301, 0x00010301, 0x00010301
  .long 0x00120409, 0x00120401, 0x00120411, 0x00120401, 0x00120401, 0x00120401, 0x00120401, 0x00120401
  .long 0x00120509, 0x00120501, 0x00120511, 0x00120501, 0x00120501, 0x00120501, 0x00120501, 0x00120501
  .long 0x00120609, 0x00120601, 0x00120611, 0x00120601, 0x00120601, 0x00120601, 0x00120601, 0x00120601
  .long 0x00120709, 0x00120701, 0x00120711, 0x00120701, 0x00120701, 0x00120701, 0x00120701, 0x00120701
  .long 0x0000030d, 0x00040405, 0x00040515, 0x00040605, 0x00040705, 0x00040005, 0x00040105, 0x00040205
  .long 0x0004090d, 0x00040a05, 0x00000b15, 0x00040c05, 0x00040d05, 0x00040e05, 0x00040f05, 0x00040805
  .long 0x0011150c, 0x00111604, 0x00111714, 0x00111004, 0x00111104, 0x00111204, 0x00001304, 0x00111404
  .long 0x00111f0c, 0x00111804, 0x00111914, 0x00111a04, 0x00001b04, 0x00111c04, 0x00111d04, 0x00111e04
  .long 0x0011220c, 0x00002304, 0x00112414, 0x00112504, 0x00112604, 0x00112704, 0x00112004, 0x00112104
  .long 0x00112c0c, 0x00112d04, 0x00112e14, 0x00112f04, 0x00112804, 0x00112904, 0x00112a04, 0x00002b04
  .long 0x0811000a, 0x08110602, 0x08110c12, 0x08111202, 0x08111702, 0x08111c02, 0x08112102, 0x08112602
  .long 0x0811010a, 0x08110702, 0x08110d12, 0x08111302, 0x08111802, 0x08111d02, 0x08112202, 0x08112702
  .long 0x0811020a, 0x08110802, 0x08110e12, 0x08111402, 0x08111902, 0x08111e02, 0x08112302, 0x08112802
  .long 0x0811030a, 0x08110902, 0x08110f12, 0x08111502, 0x08111a02, 0x08111f02, 0x08112402, 0x08112902
  .long 0x0811040a, 0x08110a02, 0x08111012, 0x08111602, 0x08111b02, 0x08112002, 0x08112502, 0x08112a02
  .long 0x0811050a, 0x08110b02, 0x08111112, 0x00100003, 0x00100403, 0x00100803, 0x00000c03, 0x00101003
  .long 0x0009140b, 0x00101803, 0x00091c13, 0x00100103, 0x00100503, 0x00100903, 0x00000d03, 0x00101103
  .long 0x0009150b, 0x00101903, 0x00091d13, 0x00100203, 0x00100603, 0x00100a03, 0x00000e03, 0x00101203
  .long 0x0009160b, 0x00101a03, 0x00091e13, 0x00100303, 0x00100703, 0x00100b03, 0x00000f03, 0x00101303
  .long 0x0009170b, 0x00101b03, 0x00091f13, 0x00150000, 0x00150000, 0x00150000, 0x00150000, 0x00150000
.section .rodata,"a"
.p2align 6
.amdhsa_kernel adaLN_cond__sliding_block_cached__glu_gated_swiglu__decode_kernel
  .amdhsa_next_free_vgpr 168
  .amdhsa_next_free_sgpr 102
  .amdhsa_accum_offset 168
  .amdhsa_group_segment_fixed_size 0
  .amdhsa_kernarg_size 112
  .amdhsa_user_sgpr_count 2
  .amdhsa_user_sgpr_kernarg_segment_ptr 1
  .amdhsa_system_sgpr_workgroup_id_x 1
.end_amdhsa_kernel
```

```asm
; @launch grid=(256,1,1) block=(768,1,1) lds=132096
.amdgcn_target "amdgcn-amd-amdhsa--gfx950"
.text
.globl adaLN_cond__sliding_block_cached__glu_gated_swiglu__decode_kernel
.p2align 8
.type adaLN_cond__sliding_block_cached__glu_gated_swiglu__decode_kernel,@function
adaLN_cond__sliding_block_cached__glu_gated_swiglu__decode_kernel:
  s_cmp_ge_u32 s2, 256
  s_cbranch_scc1 L_end
  s_load_dwordx16 s[16:31], s[0:1], 0
  s_load_dwordx8 s[32:39], s[0:1], 64
  s_load_dwordx4 s[40:43], s[0:1], 96
  s_getpc_b64 s[56:57]
L_pc:
  s_lshl_b32 s3, s2, 3
  s_add_u32 s3, s3, L_table-L_pc
  s_lshr_b32 s13, s2, 4
  s_cmp_eq_u32 s13, 14
  s_cselect_b32 s13, 4, 0
  s_cmp_lt_u32 s2, 144
  s_cselect_b32 s13, 1, s13
  s_cmp_lt_u32 s2, 128
  s_cselect_b32 s13, 0, s13
  s_cmp_lt_u32 s2, 64
  s_cselect_b32 s13, 2, s13
  v_lshrrev_b32 v2, 6, v0
  v_and_b32 v1, 63, v0
  v_readfirstlane_b32 s5, v2
  s_bfe_u32 s7, s2, 0x20003
  s_bfe_u32 s6, s2, 0x20005
  s_and_b32 s8, s2, 7
  s_lshl_b32 s9, s8, 2
  s_add_u32 s6, s6, s9
  s_lshr_b32 s9, s2, 7
  s_lshl_b32 s9, s9, 5
  s_add_u32 s6, s6, s9
  s_mov_b32 s72, 0xfffffffe
  s_mov_b32 s73, 0xffff0000
  s_cmp_lt_u32 s5, 4
  s_cbranch_scc1 L_helper
  s_sub_u32 s9, s5, 4
  s_lshl_b32 s10, s6, 22
  s_lshl_b32 s11, s7, 18
  s_add_u32 s10, s10, s11
  s_add_u32 s10, s10, 0x300000
  s_lshl_b32 s11, s9, 10
  v_lshl_add_u32 v0, v1, 4, s11
  s_lshr_b32 s12, s2, 3
  s_mul_i32 s12, s12, 5
  s_mul_i32 s15, s8, 3
  s_add_u32 s12, s12, s15
  s_lshl_b32 s12, s12, 13
  s_and_b32 s12, s12, 0x3ffff
  s_waitcnt lgkmcnt(0)
  s_add_u32 s44, s18, s10
  s_addc_u32 s45, s19, 0
  s_mov_b32 s46, 0x40000
  s_mov_b32 s47, 0x20000
  s_cmp_eq_u32 s13, 0
  s_cbranch_scc1 L_nb1
  s_barrier
L_nb1:
  buffer_load_dwordx4 v[40:43], v0, s[44:47], s12 offen nt
  s_add_u32 s12, s12, 0x2000
  s_and_b32 s12, s12, 0x3ffff
  buffer_load_dwordx4 v[44:47], v0, s[44:47], s12 offen nt
  s_add_u32 s12, s12, 0x2000
  s_and_b32 s12, s12, 0x3ffff
  buffer_load_dwordx4 v[48:51], v0, s[44:47], s12 offen nt
  s_add_u32 s12, s12, 0x2000
  s_and_b32 s12, s12, 0x3ffff
  buffer_load_dwordx4 v[52:55], v0, s[44:47], s12 offen nt
  s_add_u32 s12, s12, 0x2000
  s_and_b32 s12, s12, 0x3ffff
  s_load_dwordx2 s[14:15], s[56:57], s3
  s_load_dword s74, s[42:43], 0
  s_add_u32 s48, s20, s10
  s_addc_u32 s49, s21, 0
  s_mov_b32 s50, 0x40000
  s_mov_b32 s51, 0x20000
  s_mov_b32 s52, 0xcccccccc
  s_mov_b32 s53, 0xcccccccc
  s_mov_b32 s54, 0xaaaaaaaa
  s_mov_b32 s55, 0xaaaaaaaa
  v_and_b32 v38, 15, v1
  v_lshlrev_b32 v38, 4, v38
  s_lshl_b32 s10, s9, 11
  s_add_u32 s10, s10, 81920
  v_lshl_add_u32 v3, v1, 3, s10
  v_mov_b32 v4, 0x7fff0000
  v_mov_b32 v5, 0xff800000
  ds_write_b64 v3, v[4:5] offset:0
  ds_write_b64 v3, v[4:5] offset:512
  ds_write_b64 v3, v[4:5] offset:1024
  v_lshrrev_b32 v3, 4, v1
  v_lshl_add_u32 v39, v38, 1, s10
  v_lshl_add_u32 v39, v3, 3, v39
  s_sub_u32 s68, s12, 32768
  v_bfrev_b32 v24, v1
  v_lshrrev_b32 v24, 15, v24
  v_and_b32 v24, 0x1e000, v24
  v_add_u32 v24, s68, v24
  v_and_b32 v24, 0x3e000, v24
  v_lshl_add_u32 v24, v3, 8, v24
  v_add_u32 v24, s11, v24
  v_xor_b32 v26, 0x20000, v24
  s_lshl_b32 s11, s9, 9
  v_lshl_add_u32 v22, v38, 1, s11
  v_lshl_add_u32 v22, v3, 3, v22
  s_mov_b32 s32, 4
  s_mul_i32 s33, s9, 0x5e000000
  s_mov_b64 s[64:65], 0
  s_mov_b64 s[66:67], 0
  s_mov_b32 s38, 0
  s_mov_b32 s39, 0
  s_mov_b32 s75, 0
  s_mov_b32 s61, 0
  s_lshl_b32 s40, s6, 9
  s_lshl_b32 s68, s9, 6
  s_add_u32 s40, s40, s68
  s_add_u32 s40, s40, 32768
  s_cmp_eq_u32 s13, 0
  s_cbranch_scc0 L_nb2
  s_barrier
L_nb2:
  s_waitcnt lgkmcnt(0)
  s_mov_b32 s56, s10
  s_mul_i32 s74, s74, 0x9e3779b1
  s_add_u32 s74, s74, 0x7f4a7c15
  s_and_b32 s57, s15, 0xff
  s_bfe_u32 s34, s15, 0xc0008
  s_lshr_b32 s58, s15, 20
  s_mov_b32 s35, 28
  s_mov_b32 s59, 0
  v_mov_b32 v20, 1248
  v_mov_b32 v21, 1280
  v_mov_b32 v23, 0
  s_call_b64 s[62:63], L_ks
  buffer_load_dwordx4 v[56:59], v0, s[44:47], s12 offen nt
  s_add_u32 s12, s12, 0x2000
  s_and_b32 s12, s12, 0x3ffff
  s_call_b64 s[62:63], L_ks
  buffer_load_dwordx4 v[60:63], v0, s[44:47], s12 offen nt
  s_add_u32 s12, s12, 0x2000
  s_and_b32 s12, s12, 0x3ffff
  s_call_b64 s[62:63], L_ks
  buffer_load_dwordx4 v[64:67], v0, s[44:47], s12 offen nt
  s_add_u32 s12, s12, 0x2000
  s_and_b32 s12, s12, 0x3ffff
  s_call_b64 s[62:63], L_ks
  buffer_load_dwordx4 v[68:71], v0, s[44:47], s12 offen nt
  s_add_u32 s12, s12, 0x2000
  s_and_b32 s12, s12, 0x3ffff
  s_call_b64 s[62:63], L_ks
  buffer_load_dwordx4 v[72:75], v0, s[44:47], s12 offen nt
  s_add_u32 s12, s12, 0x2000
  s_and_b32 s12, s12, 0x3ffff
  s_call_b64 s[62:63], L_ks
  buffer_load_dwordx4 v[76:79], v0, s[44:47], s12 offen nt
  s_add_u32 s12, s12, 0x2000
  s_and_b32 s12, s12, 0x3ffff
  s_call_b64 s[62:63], L_ks
  buffer_load_dwordx4 v[80:83], v0, s[44:47], s12 offen nt
  s_add_u32 s12, s12, 0x2000
  s_and_b32 s12, s12, 0x3ffff
  s_call_b64 s[62:63], L_ks
  buffer_load_dwordx4 v[84:87], v0, s[44:47], s12 offen nt
  s_add_u32 s12, s12, 0x2000
  s_and_b32 s12, s12, 0x3ffff
  s_call_b64 s[62:63], L_ks
  buffer_load_dwordx4 v[88:91], v0, s[44:47], s12 offen nt
  s_add_u32 s12, s12, 0x2000
  s_and_b32 s12, s12, 0x3ffff
  s_call_b64 s[62:63], L_ks
  buffer_load_dwordx4 v[92:95], v0, s[44:47], s12 offen nt
  s_add_u32 s12, s12, 0x2000
  s_and_b32 s12, s12, 0x3ffff
  s_call_b64 s[62:63], L_ks
  buffer_load_dwordx4 v[96:99], v0, s[44:47], s12 offen nt
  s_add_u32 s12, s12, 0x2000
  s_and_b32 s12, s12, 0x3ffff
  s_call_b64 s[62:63], L_ks
  buffer_load_dwordx4 v[100:103], v0, s[44:47], s12 offen nt
  s_add_u32 s12, s12, 0x2000
  s_and_b32 s12, s12, 0x3ffff
  s_call_b64 s[62:63], L_ks
  buffer_load_dwordx4 v[104:107], v0, s[44:47], s12 offen nt
  s_add_u32 s12, s12, 0x2000
  s_and_b32 s12, s12, 0x3ffff
  s_call_b64 s[62:63], L_ks
  buffer_load_dwordx4 v[108:111], v0, s[44:47], s12 offen nt
  s_add_u32 s12, s12, 0x2000
  s_and_b32 s12, s12, 0x3ffff
  s_call_b64 s[62:63], L_ks
  buffer_load_dwordx4 v[112:115], v0, s[44:47], s12 offen nt
  s_add_u32 s12, s12, 0x2000
  s_and_b32 s12, s12, 0x3ffff
  s_call_b64 s[62:63], L_ks
  buffer_load_dwordx4 v[116:119], v0, s[44:47], s12 offen nt
  s_add_u32 s12, s12, 0x2000
  s_and_b32 s12, s12, 0x3ffff
  s_call_b64 s[62:63], L_ks
  buffer_load_dwordx4 v[120:123], v0, s[44:47], s12 offen nt
  s_add_u32 s12, s12, 0x2000
  s_and_b32 s12, s12, 0x3ffff
  s_call_b64 s[62:63], L_ks
  buffer_load_dwordx4 v[124:127], v0, s[44:47], s12 offen nt
  s_add_u32 s12, s12, 0x2000
  s_and_b32 s12, s12, 0x3ffff
  s_call_b64 s[62:63], L_ks
  buffer_load_dwordx4 v[128:131], v0, s[44:47], s12 offen nt
  s_add_u32 s12, s12, 0x2000
  s_and_b32 s12, s12, 0x3ffff
  s_call_b64 s[62:63], L_ks
  buffer_load_dwordx4 v[132:135], v0, s[44:47], s12 offen nt
  s_add_u32 s12, s12, 0x2000
  s_and_b32 s12, s12, 0x3ffff
  s_call_b64 s[62:63], L_ks
  buffer_load_dwordx4 v[136:139], v0, s[44:47], s12 offen nt
  s_add_u32 s12, s12, 0x2000
  s_and_b32 s12, s12, 0x3ffff
  s_call_b64 s[62:63], L_ks
  buffer_load_dwordx4 v[140:143], v0, s[44:47], s12 offen nt
  s_add_u32 s12, s12, 0x2000
  s_and_b32 s12, s12, 0x3ffff
  s_call_b64 s[62:63], L_ks
  buffer_load_dwordx4 v[144:147], v0, s[44:47], s12 offen nt
  s_add_u32 s12, s12, 0x2000
  s_and_b32 s12, s12, 0x3ffff
  s_call_b64 s[62:63], L_ks
  buffer_load_dwordx4 v[148:151], v0, s[44:47], s12 offen nt
  s_add_u32 s12, s12, 0x2000
  s_and_b32 s12, s12, 0x3ffff
  s_call_b64 s[62:63], L_ks
  buffer_load_dwordx4 v[152:155], v0, s[44:47], s12 offen nt
  s_add_u32 s12, s12, 0x2000
  s_and_b32 s12, s12, 0x3ffff
  s_call_b64 s[62:63], L_ks
  buffer_load_dwordx4 v[156:159], v0, s[44:47], s12 offen nt
  s_add_u32 s12, s12, 0x2000
  s_and_b32 s12, s12, 0x3ffff
  s_call_b64 s[62:63], L_ks
  buffer_load_dwordx4 v[160:163], v0, s[44:47], s12 offen nt
  s_add_u32 s12, s12, 0x2000
  s_and_b32 s12, s12, 0x3ffff
  s_call_b64 s[62:63], L_ks
  buffer_load_dwordx4 v[164:167], v0, s[44:47], s12 offen nt
  s_add_u32 s12, s12, 0x2000
  s_and_b32 s12, s12, 0x3ffff
  s_mov_b32 s10, 0
L_kw:
  s_cmp_ge_u32 s39, 4
  s_cbranch_scc1 L_v0
  s_call_b64 s[100:101], L_work
  s_sleep 1
  s_add_u32 s10, s10, 1
  s_cmp_lt_u32 s10, 262144
  s_cbranch_scc1 L_kw
L_v0:
  s_mov_b32 s32, 0
  s_mov_b32 s37, 255
  v_mov_b32 v23, 8
  s_mov_b32 s35, s59
  ds_read_b64 v[20:21], v23 offset:6688
  s_ashr_i32 s14, s14, 16
  s_waitcnt lgkmcnt(0)
  v_readfirstlane_b32 s34, v20
  s_mul_i32 s34, s34, 96
  s_ashr_i32 s34, s34, 4
  s_add_i32 s34, s34, -6093
  s_add_i32 s34, s34, s14
  s_call_b64 s[62:63], L_vs
  s_cbranch_scc1 L_nl0
  v_add_u32_dpp v3, v28, v38 row_newbcast:0 row_mask:0xf bank_mask:0xf
  buffer_load_dwordx4 v[40:43], v3, s[48:51], 0 offen nt
L_nl0:
  v_dot2_f32_bf16 v8, v104, v4, 0
  v_dot2_f32_bf16 v9, v108, v4, 0
  v_dot2_f32_bf16 v10, v112, v4, 0
  v_dot2_f32_bf16 v11, v116, v4, 0
  v_dot2_f32_bf16 v12, v120, v4, 0
  v_dot2_f32_bf16 v13, v124, v4, 0
  v_dot2_f32_bf16 v14, v128, v4, 0
  v_dot2_f32_bf16 v15, v132, v4, 0
  v_dot2_f32_bf16 v8, v105, v5, v8
  v_dot2_f32_bf16 v9, v109, v5, v9
  v_dot2_f32_bf16 v10, v113, v5, v10
  v_dot2_f32_bf16 v11, v117, v5, v11
  v_dot2_f32_bf16 v12, v121, v5, v12
  v_dot2_f32_bf16 v13, v125, v5, v13
  v_dot2_f32_bf16 v14, v129, v5, v14
  v_dot2_f32_bf16 v15, v133, v5, v15
  v_dot2_f32_bf16 v8, v106, v6, v8
  v_dot2_f32_bf16 v9, v110, v6, v9
  v_dot2_f32_bf16 v10, v114, v6, v10
  v_dot2_f32_bf16 v11, v118, v6, v11
  v_dot2_f32_bf16 v12, v122, v6, v12
  v_dot2_f32_bf16 v13, v126, v6, v13
  v_dot2_f32_bf16 v14, v130, v6, v14
  v_dot2_f32_bf16 v15, v134, v6, v15
  v_dot2_f32_bf16 v8, v107, v7, v8
  v_dot2_f32_bf16 v9, v111, v7, v9
  v_dot2_f32_bf16 v10, v115, v7, v10
  v_dot2_f32_bf16 v11, v119, v7, v11
  v_dot2_f32_bf16 v12, v123, v7, v12
  v_dot2_f32_bf16 v13, v127, v7, v13
  v_dot2_f32_bf16 v14, v131, v7, v14
  v_dot2_f32_bf16 v15, v135, v7, v15
  v_add_f32_dpp v8, v8, v8 row_ror:8 row_mask:0xf bank_mask:0x3
  v_add_f32_dpp v8, v9, v9 row_ror:8 row_mask:0xf bank_mask:0xc
  v_add_f32_dpp v10, v10, v10 row_ror:8 row_mask:0xf bank_mask:0x3
  v_add_f32_dpp v10, v11, v11 row_ror:8 row_mask:0xf bank_mask:0xc
  v_add_f32_dpp v12, v12, v12 row_ror:8 row_mask:0xf bank_mask:0x3
  v_add_f32_dpp v12, v13, v13 row_ror:8 row_mask:0xf bank_mask:0xc
  v_add_f32_dpp v14, v14, v14 row_ror:8 row_mask:0xf bank_mask:0x3
  v_add_f32_dpp v14, v15, v15 row_ror:8 row_mask:0xf bank_mask:0xc
  v_add_f32_dpp v16, v8, v8 row_shl:4 row_mask:0xf bank_mask:0x5
  v_add_f32_dpp v16, v10, v10 row_shr:4 row_mask:0xf bank_mask:0xa
  v_add_f32_dpp v17, v12, v12 row_shl:4 row_mask:0xf bank_mask:0x5
  v_add_f32_dpp v17, v14, v14 row_shr:4 row_mask:0xf bank_mask:0xa
  s_call_b64 s[62:63], L_vs
  s_cbranch_scc1 L_nl1
  v_add_u32_dpp v3, v28, v38 row_newbcast:1 row_mask:0xf bank_mask:0xf
  buffer_load_dwordx4 v[44:47], v3, s[48:51], 0 offen nt
L_nl1:
  s_call_b64 s[62:63], L_vs
  s_cbranch_scc1 L_nl2
  v_add_u32_dpp v3, v28, v38 row_newbcast:2 row_mask:0xf bank_mask:0xf
  buffer_load_dwordx4 v[48:51], v3, s[48:51], 0 offen nt
L_nl2:
  s_call_b64 s[62:63], L_vs
  s_cbranch_scc1 L_nl3
  v_add_u32_dpp v3, v28, v38 row_newbcast:3 row_mask:0xf bank_mask:0xf
  buffer_load_dwordx4 v[52:55], v3, s[48:51], 0 offen nt
L_nl3:
  s_call_b64 s[62:63], L_vs
  s_cbranch_scc1 L_nl4
  v_add_u32_dpp v3, v28, v38 row_newbcast:4 row_mask:0xf bank_mask:0xf
  buffer_load_dwordx4 v[56:59], v3, s[48:51], 0 offen nt
L_nl4:
  s_call_b64 s[62:63], L_vs
  s_cbranch_scc1 L_nl5
  v_add_u32_dpp v3, v28, v38 row_newbcast:5 row_mask:0xf bank_mask:0xf
  buffer_load_dwordx4 v[60:63], v3, s[48:51], 0 offen nt
L_nl5:
  v_dot2c_f32_bf16_dpp v8, v29, v40 row_newbcast:0 row_mask:0xf bank_mask:0xf
  v_dot2c_f32_bf16_dpp v9, v34, v40 row_newbcast:0 row_mask:0xf bank_mask:0xf
  v_dot2c_f32_bf16_dpp v10, v29, v41 row_newbcast:0 row_mask:0xf bank_mask:0xf
  v_dot2c_f32_bf16_dpp v11, v34, v41 row_newbcast:0 row_mask:0xf bank_mask:0xf
  v_dot2c_f32_bf16_dpp v12, v29, v42 row_newbcast:0 row_mask:0xf bank_mask:0xf
  v_dot2c_f32_bf16_dpp v13, v34, v42 row_newbcast:0 row_mask:0xf bank_mask:0xf
  v_dot2c_f32_bf16_dpp v14, v29, v43 row_newbcast:0 row_mask:0xf bank_mask:0xf
  v_dot2c_f32_bf16_dpp v15, v34, v43 row_newbcast:0 row_mask:0xf bank_mask:0xf
  s_cmp_eq_u32 s75, 6
  s_cbranch_scc1 L_epi
  s_call_b64 s[62:63], L_vs
  s_cbranch_scc1 L_nl6
  v_add_u32_dpp v3, v28, v38 row_newbcast:6 row_mask:0xf bank_mask:0xf
  buffer_load_dwordx4 v[64:67], v3, s[48:51], 0 offen nt
L_nl6:
  v_dot2c_f32_bf16_dpp v8, v29, v44 row_newbcast:1 row_mask:0xf bank_mask:0xf
  v_dot2c_f32_bf16_dpp v9, v34, v44 row_newbcast:1 row_mask:0xf bank_mask:0xf
  v_dot2c_f32_bf16_dpp v10, v29, v45 row_newbcast:1 row_mask:0xf bank_mask:0xf
  v_dot2c_f32_bf16_dpp v11, v34, v45 row_newbcast:1 row_mask:0xf bank_mask:0xf
  v_dot2c_f32_bf16_dpp v12, v29, v46 row_newbcast:1 row_mask:0xf bank_mask:0xf
  v_dot2c_f32_bf16_dpp v13, v34, v46 row_newbcast:1 row_mask:0xf bank_mask:0xf
  v_dot2c_f32_bf16_dpp v14, v29, v47 row_newbcast:1 row_mask:0xf bank_mask:0xf
  v_dot2c_f32_bf16_dpp v15, v34, v47 row_newbcast:1 row_mask:0xf bank_mask:0xf
  s_cmp_eq_u32 s75, 7
  s_cbranch_scc1 L_epi
  s_call_b64 s[62:63], L_vs
  s_cbranch_scc1 L_nl7
  v_add_u32_dpp v3, v28, v38 row_newbcast:7 row_mask:0xf bank_mask:0xf
  buffer_load_dwordx4 v[68:71], v3, s[48:51], 0 offen nt
L_nl7:
  v_dot2c_f32_bf16_dpp v8, v29, v48 row_newbcast:2 row_mask:0xf bank_mask:0xf
  v_dot2c_f32_bf16_dpp v9, v34, v48 row_newbcast:2 row_mask:0xf bank_mask:0xf
  v_dot2c_f32_bf16_dpp v10, v29, v49 row_newbcast:2 row_mask:0xf bank_mask:0xf
  v_dot2c_f32_bf16_dpp v11, v34, v49 row_newbcast:2 row_mask:0xf bank_mask:0xf
  v_dot2c_f32_bf16_dpp v12, v29, v50 row_newbcast:2 row_mask:0xf bank_mask:0xf
  v_dot2c_f32_bf16_dpp v13, v34, v50 row_newbcast:2 row_mask:0xf bank_mask:0xf
  v_dot2c_f32_bf16_dpp v14, v29, v51 row_newbcast:2 row_mask:0xf bank_mask:0xf
  v_dot2c_f32_bf16_dpp v15, v34, v51 row_newbcast:2 row_mask:0xf bank_mask:0xf
  s_cmp_eq_u32 s75, 8
  s_cbranch_scc1 L_epi
  s_call_b64 s[62:63], L_vs
  s_cbranch_scc1 L_nl8
  v_add_u32_dpp v3, v28, v38 row_newbcast:8 row_mask:0xf bank_mask:0xf
  buffer_load_dwordx4 v[72:75], v3, s[48:51], 0 offen nt
L_nl8:
  v_dot2c_f32_bf16_dpp v8, v29, v52 row_newbcast:3 row_mask:0xf bank_mask:0xf
  v_dot2c_f32_bf16_dpp v9, v34, v52 row_newbcast:3 row_mask:0xf bank_mask:0xf
  v_dot2c_f32_bf16_dpp v10, v29, v53 row_newbcast:3 row_mask:0xf bank_mask:0xf
  v_dot2c_f32_bf16_dpp v11, v34, v53 row_newbcast:3 row_mask:0xf bank_mask:0xf
  v_dot2c_f32_bf16_dpp v12, v29, v54 row_newbcast:3 row_mask:0xf bank_mask:0xf
  v_dot2c_f32_bf16_dpp v13, v34, v54 row_newbcast:3 row_mask:0xf bank_mask:0xf
  v_dot2c_f32_bf16_dpp v14, v29, v55 row_newbcast:3 row_mask:0xf bank_mask:0xf
  v_dot2c_f32_bf16_dpp v15, v34, v55 row_newbcast:3 row_mask:0xf bank_mask:0xf
  s_cmp_eq_u32 s75, 9
  s_cbranch_scc1 L_epi
  s_call_b64 s[62:63], L_vs
  s_cbranch_scc1 L_nl9
  v_add_u32_dpp v3, v28, v38 row_newbcast:9 row_mask:0xf bank_mask:0xf
  buffer_load_dwordx4 v[76:79], v3, s[48:51], 0 offen nt
L_nl9:
  v_dot2c_f32_bf16_dpp v8, v29, v56 row_newbcast:4 row_mask:0xf bank_mask:0xf
  v_dot2c_f32_bf16_dpp v9, v34, v56 row_newbcast:4 row_mask:0xf bank_mask:0xf
  v_dot2c_f32_bf16_dpp v10, v29, v57 row_newbcast:4 row_mask:0xf bank_mask:0xf
  v_dot2c_f32_bf16_dpp v11, v34, v57 row_newbcast:4 row_mask:0xf bank_mask:0xf
  v_dot2c_f32_bf16_dpp v12, v29, v58 row_newbcast:4 row_mask:0xf bank_mask:0xf
  v_dot2c_f32_bf16_dpp v13, v34, v58 row_newbcast:4 row_mask:0xf bank_mask:0xf
  v_dot2c_f32_bf16_dpp v14, v29, v59 row_newbcast:4 row_mask:0xf bank_mask:0xf
  v_dot2c_f32_bf16_dpp v15, v34, v59 row_newbcast:4 row_mask:0xf bank_mask:0xf
  s_cmp_eq_u32 s75, 10
  s_cbranch_scc1 L_epi
  s_call_b64 s[62:63], L_vs
  s_cbranch_scc1 L_nl10
  v_add_u32_dpp v3, v28, v38 row_newbcast:10 row_mask:0xf bank_mask:0xf
  buffer_load_dwordx4 v[80:83], v3, s[48:51], 0 offen nt
L_nl10:
  v_dot2c_f32_bf16_dpp v8, v29, v60 row_newbcast:5 row_mask:0xf bank_mask:0xf
  v_dot2c_f32_bf16_dpp v9, v34, v60 row_newbcast:5 row_mask:0xf bank_mask:0xf
  v_dot2c_f32_bf16_dpp v10, v29, v61 row_newbcast:5 row_mask:0xf bank_mask:0xf
  v_dot2c_f32_bf16_dpp v11, v34, v61 row_newbcast:5 row_mask:0xf bank_mask:0xf
  v_dot2c_f32_bf16_dpp v12, v29, v62 row_newbcast:5 row_mask:0xf bank_mask:0xf
  v_dot2c_f32_bf16_dpp v13, v34, v62 row_newbcast:5 row_mask:0xf bank_mask:0xf
  v_dot2c_f32_bf16_dpp v14, v29, v63 row_newbcast:5 row_mask:0xf bank_mask:0xf
  v_dot2c_f32_bf16_dpp v15, v34, v63 row_newbcast:5 row_mask:0xf bank_mask:0xf
  s_cmp_eq_u32 s75, 11
  s_cbranch_scc1 L_epi
  s_call_b64 s[62:63], L_vs
  s_cbranch_scc1 L_nl11
  v_add_u32_dpp v3, v28, v38 row_newbcast:11 row_mask:0xf bank_mask:0xf
  buffer_load_dwordx4 v[84:87], v3, s[48:51], 0 offen nt
L_nl11:
  v_dot2c_f32_bf16_dpp v8, v29, v64 row_newbcast:6 row_mask:0xf bank_mask:0xf
  v_dot2c_f32_bf16_dpp v9, v34, v64 row_newbcast:6 row_mask:0xf bank_mask:0xf
  v_dot2c_f32_bf16_dpp v10, v29, v65 row_newbcast:6 row_mask:0xf bank_mask:0xf
  v_dot2c_f32_bf16_dpp v11, v34, v65 row_newbcast:6 row_mask:0xf bank_mask:0xf
  v_dot2c_f32_bf16_dpp v12, v29, v66 row_newbcast:6 row_mask:0xf bank_mask:0xf
  v_dot2c_f32_bf16_dpp v13, v34, v66 row_newbcast:6 row_mask:0xf bank_mask:0xf
  v_dot2c_f32_bf16_dpp v14, v29, v67 row_newbcast:6 row_mask:0xf bank_mask:0xf
  v_dot2c_f32_bf16_dpp v15, v34, v67 row_newbcast:6 row_mask:0xf bank_mask:0xf
  s_cmp_eq_u32 s75, 12
  s_cbranch_scc1 L_epi
  s_call_b64 s[62:63], L_vs
  s_cbranch_scc1 L_nl12
  v_add_u32_dpp v3, v28, v38 row_newbcast:12 row_mask:0xf bank_mask:0xf
  buffer_load_dwordx4 v[88:91], v3, s[48:51], 0 offen nt
L_nl12:
  v_dot2c_f32_bf16_dpp v8, v29, v68 row_newbcast:7 row_mask:0xf bank_mask:0xf
  v_dot2c_f32_bf16_dpp v9, v34, v68 row_newbcast:7 row_mask:0xf bank_mask:0xf
  v_dot2c_f32_bf16_dpp v10, v29, v69 row_newbcast:7 row_mask:0xf bank_mask:0xf
  v_dot2c_f32_bf16_dpp v11, v34, v69 row_newbcast:7 row_mask:0xf bank_mask:0xf
  v_dot2c_f32_bf16_dpp v12, v29, v70 row_newbcast:7 row_mask:0xf bank_mask:0xf
  v_dot2c_f32_bf16_dpp v13, v34, v70 row_newbcast:7 row_mask:0xf bank_mask:0xf
  v_dot2c_f32_bf16_dpp v14, v29, v71 row_newbcast:7 row_mask:0xf bank_mask:0xf
  v_dot2c_f32_bf16_dpp v15, v34, v71 row_newbcast:7 row_mask:0xf bank_mask:0xf
  s_cmp_eq_u32 s75, 13
  s_cbranch_scc1 L_epi
  s_call_b64 s[62:63], L_vs
  s_cbranch_scc1 L_nl13
  v_add_u32_dpp v3, v28, v38 row_newbcast:13 row_mask:0xf bank_mask:0xf
  buffer_load_dwordx4 v[92:95], v3, s[48:51], 0 offen nt
L_nl13:
  v_dot2c_f32_bf16_dpp v8, v29, v72 row_newbcast:8 row_mask:0xf bank_mask:0xf
  v_dot2c_f32_bf16_dpp v9, v34, v72 row_newbcast:8 row_mask:0xf bank_mask:0xf
  v_dot2c_f32_bf16_dpp v10, v29, v73 row_newbcast:8 row_mask:0xf bank_mask:0xf
  v_dot2c_f32_bf16_dpp v11, v34, v73 row_newbcast:8 row_mask:0xf bank_mask:0xf
  v_dot2c_f32_bf16_dpp v12, v29, v74 row_newbcast:8 row_mask:0xf bank_mask:0xf
  v_dot2c_f32_bf16_dpp v13, v34, v74 row_newbcast:8 row_mask:0xf bank_mask:0xf
  v_dot2c_f32_bf16_dpp v14, v29, v75 row_newbcast:8 row_mask:0xf bank_mask:0xf
  v_dot2c_f32_bf16_dpp v15, v34, v75 row_newbcast:8 row_mask:0xf bank_mask:0xf
  s_cmp_eq_u32 s75, 14
  s_cbranch_scc1 L_epi
  s_call_b64 s[62:63], L_vs
  s_cbranch_scc1 L_nl14
  v_add_u32_dpp v3, v28, v38 row_newbcast:14 row_mask:0xf bank_mask:0xf
  buffer_load_dwordx4 v[96:99], v3, s[48:51], 0 offen nt
L_nl14:
  v_dot2c_f32_bf16_dpp v8, v29, v76 row_newbcast:9 row_mask:0xf bank_mask:0xf
  v_dot2c_f32_bf16_dpp v9, v34, v76 row_newbcast:9 row_mask:0xf bank_mask:0xf
  v_dot2c_f32_bf16_dpp v10, v29, v77 row_newbcast:9 row_mask:0xf bank_mask:0xf
  v_dot2c_f32_bf16_dpp v11, v34, v77 row_newbcast:9 row_mask:0xf bank_mask:0xf
  v_dot2c_f32_bf16_dpp v12, v29, v78 row_newbcast:9 row_mask:0xf bank_mask:0xf
  v_dot2c_f32_bf16_dpp v13, v34, v78 row_newbcast:9 row_mask:0xf bank_mask:0xf
  v_dot2c_f32_bf16_dpp v14, v29, v79 row_newbcast:9 row_mask:0xf bank_mask:0xf
  v_dot2c_f32_bf16_dpp v15, v34, v79 row_newbcast:9 row_mask:0xf bank_mask:0xf
  s_cmp_eq_u32 s75, 15
  s_cbranch_scc1 L_epi
  s_call_b64 s[62:63], L_vs
  s_cbranch_scc1 L_nl15
  v_add_u32_dpp v3, v28, v38 row_newbcast:15 row_mask:0xf bank_mask:0xf
  buffer_load_dwordx4 v[100:103], v3, s[48:51], 0 offen nt
L_nl15:
  v_dot2c_f32_bf16_dpp v8, v29, v80 row_newbcast:10 row_mask:0xf bank_mask:0xf
  v_dot2c_f32_bf16_dpp v9, v34, v80 row_newbcast:10 row_mask:0xf bank_mask:0xf
  v_dot2c_f32_bf16_dpp v10, v29, v81 row_newbcast:10 row_mask:0xf bank_mask:0xf
  v_dot2c_f32_bf16_dpp v11, v34, v81 row_newbcast:10 row_mask:0xf bank_mask:0xf
  v_dot2c_f32_bf16_dpp v12, v29, v82 row_newbcast:10 row_mask:0xf bank_mask:0xf
  v_dot2c_f32_bf16_dpp v13, v34, v82 row_newbcast:10 row_mask:0xf bank_mask:0xf
  v_dot2c_f32_bf16_dpp v14, v29, v83 row_newbcast:10 row_mask:0xf bank_mask:0xf
  v_dot2c_f32_bf16_dpp v15, v34, v83 row_newbcast:10 row_mask:0xf bank_mask:0xf
  s_cmp_eq_u32 s75, 16
  s_cbranch_scc1 L_epi
  s_call_b64 s[62:63], L_vs
  s_cbranch_scc1 L_nl16
  v_add_u32_dpp v3, v30, v38 row_newbcast:0 row_mask:0xf bank_mask:0xf
  buffer_load_dwordx4 v[104:107], v3, s[48:51], 0 offen nt
L_nl16:
  v_dot2c_f32_bf16_dpp v8, v29, v84 row_newbcast:11 row_mask:0xf bank_mask:0xf
  v_dot2c_f32_bf16_dpp v9, v34, v84 row_newbcast:11 row_mask:0xf bank_mask:0xf
  v_dot2c_f32_bf16_dpp v10, v29, v85 row_newbcast:11 row_mask:0xf bank_mask:0xf
  v_dot2c_f32_bf16_dpp v11, v34, v85 row_newbcast:11 row_mask:0xf bank_mask:0xf
  v_dot2c_f32_bf16_dpp v12, v29, v86 row_newbcast:11 row_mask:0xf bank_mask:0xf
  v_dot2c_f32_bf16_dpp v13, v34, v86 row_newbcast:11 row_mask:0xf bank_mask:0xf
  v_dot2c_f32_bf16_dpp v14, v29, v87 row_newbcast:11 row_mask:0xf bank_mask:0xf
  v_dot2c_f32_bf16_dpp v15, v34, v87 row_newbcast:11 row_mask:0xf bank_mask:0xf
  s_cmp_eq_u32 s75, 17
  s_cbranch_scc1 L_epi
  s_call_b64 s[62:63], L_vs
  s_cbranch_scc1 L_nl17
  v_add_u32_dpp v3, v30, v38 row_newbcast:1 row_mask:0xf bank_mask:0xf
  buffer_load_dwordx4 v[108:111], v3, s[48:51], 0 offen nt
L_nl17:
  v_dot2c_f32_bf16_dpp v8, v29, v88 row_newbcast:12 row_mask:0xf bank_mask:0xf
  v_dot2c_f32_bf16_dpp v9, v34, v88 row_newbcast:12 row_mask:0xf bank_mask:0xf
  v_dot2c_f32_bf16_dpp v10, v29, v89 row_newbcast:12 row_mask:0xf bank_mask:0xf
  v_dot2c_f32_bf16_dpp v11, v34, v89 row_newbcast:12 row_mask:0xf bank_mask:0xf
  v_dot2c_f32_bf16_dpp v12, v29, v90 row_newbcast:12 row_mask:0xf bank_mask:0xf
  v_dot2c_f32_bf16_dpp v13, v34, v90 row_newbcast:12 row_mask:0xf bank_mask:0xf
  v_dot2c_f32_bf16_dpp v14, v29, v91 row_newbcast:12 row_mask:0xf bank_mask:0xf
  v_dot2c_f32_bf16_dpp v15, v34, v91 row_newbcast:12 row_mask:0xf bank_mask:0xf
  s_cmp_eq_u32 s75, 18
  s_cbranch_scc1 L_epi
  s_call_b64 s[62:63], L_vs
  s_cbranch_scc1 L_nl18
  v_add_u32_dpp v3, v30, v38 row_newbcast:2 row_mask:0xf bank_mask:0xf
  buffer_load_dwordx4 v[112:115], v3, s[48:51], 0 offen nt
L_nl18:
  v_dot2c_f32_bf16_dpp v8, v29, v92 row_newbcast:13 row_mask:0xf bank_mask:0xf
  v_dot2c_f32_bf16_dpp v9, v34, v92 row_newbcast:13 row_mask:0xf bank_mask:0xf
  v_dot2c_f32_bf16_dpp v10, v29, v93 row_newbcast:13 row_mask:0xf bank_mask:0xf
  v_dot2c_f32_bf16_dpp v11, v34, v93 row_newbcast:13 row_mask:0xf bank_mask:0xf
  v_dot2c_f32_bf16_dpp v12, v29, v94 row_newbcast:13 row_mask:0xf bank_mask:0xf
  v_dot2c_f32_bf16_dpp v13, v34, v94 row_newbcast:13 row_mask:0xf bank_mask:0xf
  v_dot2c_f32_bf16_dpp v14, v29, v95 row_newbcast:13 row_mask:0xf bank_mask:0xf
  v_dot2c_f32_bf16_dpp v15, v34, v95 row_newbcast:13 row_mask:0xf bank_mask:0xf
  s_cmp_eq_u32 s75, 19
  s_cbranch_scc1 L_epi
  s_call_b64 s[62:63], L_vs
  s_cbranch_scc1 L_nl19
  v_add_u32_dpp v3, v30, v38 row_newbcast:3 row_mask:0xf bank_mask:0xf
  buffer_load_dwordx4 v[116:119], v3, s[48:51], 0 offen nt
L_nl19:
  v_dot2c_f32_bf16_dpp v8, v29, v96 row_newbcast:14 row_mask:0xf bank_mask:0xf
  v_dot2c_f32_bf16_dpp v9, v34, v96 row_newbcast:14 row_mask:0xf bank_mask:0xf
  v_dot2c_f32_bf16_dpp v10, v29, v97 row_newbcast:14 row_mask:0xf bank_mask:0xf
  v_dot2c_f32_bf16_dpp v11, v34, v97 row_newbcast:14 row_mask:0xf bank_mask:0xf
  v_dot2c_f32_bf16_dpp v12, v29, v98 row_newbcast:14 row_mask:0xf bank_mask:0xf
  v_dot2c_f32_bf16_dpp v13, v34, v98 row_newbcast:14 row_mask:0xf bank_mask:0xf
  v_dot2c_f32_bf16_dpp v14, v29, v99 row_newbcast:14 row_mask:0xf bank_mask:0xf
  v_dot2c_f32_bf16_dpp v15, v34, v99 row_newbcast:14 row_mask:0xf bank_mask:0xf
  s_cmp_eq_u32 s75, 20
  s_cbranch_scc1 L_epi
  s_call_b64 s[62:63], L_vs
  s_cbranch_scc1 L_nl20
  v_add_u32_dpp v3, v30, v38 row_newbcast:4 row_mask:0xf bank_mask:0xf
  buffer_load_dwordx4 v[120:123], v3, s[48:51], 0 offen nt
L_nl20:
  v_dot2c_f32_bf16_dpp v8, v29, v100 row_newbcast:15 row_mask:0xf bank_mask:0xf
  v_dot2c_f32_bf16_dpp v9, v34, v100 row_newbcast:15 row_mask:0xf bank_mask:0xf
  v_dot2c_f32_bf16_dpp v10, v29, v101 row_newbcast:15 row_mask:0xf bank_mask:0xf
  v_dot2c_f32_bf16_dpp v11, v34, v101 row_newbcast:15 row_mask:0xf bank_mask:0xf
  v_dot2c_f32_bf16_dpp v12, v29, v102 row_newbcast:15 row_mask:0xf bank_mask:0xf
  v_dot2c_f32_bf16_dpp v13, v34, v102 row_newbcast:15 row_mask:0xf bank_mask:0xf
  v_dot2c_f32_bf16_dpp v14, v29, v103 row_newbcast:15 row_mask:0xf bank_mask:0xf
  v_dot2c_f32_bf16_dpp v15, v34, v103 row_newbcast:15 row_mask:0xf bank_mask:0xf
  s_cmp_eq_u32 s75, 21
  s_cbranch_scc1 L_epi
  s_call_b64 s[62:63], L_vs
  s_cbranch_scc1 L_nl21
  v_add_u32_dpp v3, v30, v38 row_newbcast:5 row_mask:0xf bank_mask:0xf
  buffer_load_dwordx4 v[124:127], v3, s[48:51], 0 offen nt
L_nl21:
  v_dot2c_f32_bf16_dpp v8, v31, v104 row_newbcast:0 row_mask:0xf bank_mask:0xf
  v_dot2c_f32_bf16_dpp v9, v35, v104 row_newbcast:0 row_mask:0xf bank_mask:0xf
  v_dot2c_f32_bf16_dpp v10, v31, v105 row_newbcast:0 row_mask:0xf bank_mask:0xf
  v_dot2c_f32_bf16_dpp v11, v35, v105 row_newbcast:0 row_mask:0xf bank_mask:0xf
  v_dot2c_f32_bf16_dpp v12, v31, v106 row_newbcast:0 row_mask:0xf bank_mask:0xf
  v_dot2c_f32_bf16_dpp v13, v35, v106 row_newbcast:0 row_mask:0xf bank_mask:0xf
  v_dot2c_f32_bf16_dpp v14, v31, v107 row_newbcast:0 row_mask:0xf bank_mask:0xf
  v_dot2c_f32_bf16_dpp v15, v35, v107 row_newbcast:0 row_mask:0xf bank_mask:0xf
  s_cmp_eq_u32 s75, 22
  s_cbranch_scc1 L_epi
  s_call_b64 s[62:63], L_vs
  s_cbranch_scc1 L_nl22
  v_add_u32_dpp v3, v30, v38 row_newbcast:6 row_mask:0xf bank_mask:0xf
  buffer_load_dwordx4 v[128:131], v3, s[48:51], 0 offen nt
L_nl22:
  v_dot2c_f32_bf16_dpp v8, v31, v108 row_newbcast:1 row_mask:0xf bank_mask:0xf
  v_dot2c_f32_bf16_dpp v9, v35, v108 row_newbcast:1 row_mask:0xf bank_mask:0xf
  v_dot2c_f32_bf16_dpp v10, v31, v109 row_newbcast:1 row_mask:0xf bank_mask:0xf
  v_dot2c_f32_bf16_dpp v11, v35, v109 row_newbcast:1 row_mask:0xf bank_mask:0xf
  v_dot2c_f32_bf16_dpp v12, v31, v110 row_newbcast:1 row_mask:0xf bank_mask:0xf
  v_dot2c_f32_bf16_dpp v13, v35, v110 row_newbcast:1 row_mask:0xf bank_mask:0xf
  v_dot2c_f32_bf16_dpp v14, v31, v111 row_newbcast:1 row_mask:0xf bank_mask:0xf
  v_dot2c_f32_bf16_dpp v15, v35, v111 row_newbcast:1 row_mask:0xf bank_mask:0xf
  s_cmp_eq_u32 s75, 23
  s_cbranch_scc1 L_epi
  s_call_b64 s[62:63], L_vs
  s_cbranch_scc1 L_nl23
  v_add_u32_dpp v3, v30, v38 row_newbcast:7 row_mask:0xf bank_mask:0xf
  buffer_load_dwordx4 v[132:135], v3, s[48:51], 0 offen nt
L_nl23:
  v_dot2c_f32_bf16_dpp v8, v31, v112 row_newbcast:2 row_mask:0xf bank_mask:0xf
  v_dot2c_f32_bf16_dpp v9, v35, v112 row_newbcast:2 row_mask:0xf bank_mask:0xf
  v_dot2c_f32_bf16_dpp v10, v31, v113 row_newbcast:2 row_mask:0xf bank_mask:0xf
  v_dot2c_f32_bf16_dpp v11, v35, v113 row_newbcast:2 row_mask:0xf bank_mask:0xf
  v_dot2c_f32_bf16_dpp v12, v31, v114 row_newbcast:2 row_mask:0xf bank_mask:0xf
  v_dot2c_f32_bf16_dpp v13, v35, v114 row_newbcast:2 row_mask:0xf bank_mask:0xf
  v_dot2c_f32_bf16_dpp v14, v31, v115 row_newbcast:2 row_mask:0xf bank_mask:0xf
  v_dot2c_f32_bf16_dpp v15, v35, v115 row_newbcast:2 row_mask:0xf bank_mask:0xf
  s_cmp_eq_u32 s75, 24
  s_cbranch_scc1 L_epi
  s_call_b64 s[62:63], L_vs
  s_cbranch_scc1 L_nl24
  v_add_u32_dpp v3, v30, v38 row_newbcast:8 row_mask:0xf bank_mask:0xf
  buffer_load_dwordx4 v[136:139], v3, s[48:51], 0 offen nt
L_nl24:
  v_dot2c_f32_bf16_dpp v8, v31, v116 row_newbcast:3 row_mask:0xf bank_mask:0xf
  v_dot2c_f32_bf16_dpp v9, v35, v116 row_newbcast:3 row_mask:0xf bank_mask:0xf
  v_dot2c_f32_bf16_dpp v10, v31, v117 row_newbcast:3 row_mask:0xf bank_mask:0xf
  v_dot2c_f32_bf16_dpp v11, v35, v117 row_newbcast:3 row_mask:0xf bank_mask:0xf
  v_dot2c_f32_bf16_dpp v12, v31, v118 row_newbcast:3 row_mask:0xf bank_mask:0xf
  v_dot2c_f32_bf16_dpp v13, v35, v118 row_newbcast:3 row_mask:0xf bank_mask:0xf
  v_dot2c_f32_bf16_dpp v14, v31, v119 row_newbcast:3 row_mask:0xf bank_mask:0xf
  v_dot2c_f32_bf16_dpp v15, v35, v119 row_newbcast:3 row_mask:0xf bank_mask:0xf
  s_cmp_eq_u32 s75, 25
  s_cbranch_scc1 L_epi
  s_call_b64 s[62:63], L_vs
  s_cbranch_scc1 L_nl25
  v_add_u32_dpp v3, v30, v38 row_newbcast:9 row_mask:0xf bank_mask:0xf
  buffer_load_dwordx4 v[140:143], v3, s[48:51], 0 offen nt
L_nl25:
  v_dot2c_f32_bf16_dpp v8, v31, v120 row_newbcast:4 row_mask:0xf bank_mask:0xf
  v_dot2c_f32_bf16_dpp v9, v35, v120 row_newbcast:4 row_mask:0xf bank_mask:0xf
  v_dot2c_f32_bf16_dpp v10, v31, v121 row_newbcast:4 row_mask:0xf bank_mask:0xf
  v_dot2c_f32_bf16_dpp v11, v35, v121 row_newbcast:4 row_mask:0xf bank_mask:0xf
  v_dot2c_f32_bf16_dpp v12, v31, v122 row_newbcast:4 row_mask:0xf bank_mask:0xf
  v_dot2c_f32_bf16_dpp v13, v35, v122 row_newbcast:4 row_mask:0xf bank_mask:0xf
  v_dot2c_f32_bf16_dpp v14, v31, v123 row_newbcast:4 row_mask:0xf bank_mask:0xf
  v_dot2c_f32_bf16_dpp v15, v35, v123 row_newbcast:4 row_mask:0xf bank_mask:0xf
  s_cmp_eq_u32 s75, 26
  s_cbranch_scc1 L_epi
  s_call_b64 s[62:63], L_vs
  s_cbranch_scc1 L_nl26
  v_add_u32_dpp v3, v30, v38 row_newbcast:10 row_mask:0xf bank_mask:0xf
  buffer_load_dwordx4 v[144:147], v3, s[48:51], 0 offen nt
L_nl26:
  v_dot2c_f32_bf16_dpp v8, v31, v124 row_newbcast:5 row_mask:0xf bank_mask:0xf
  v_dot2c_f32_bf16_dpp v9, v35, v124 row_newbcast:5 row_mask:0xf bank_mask:0xf
  v_dot2c_f32_bf16_dpp v10, v31, v125 row_newbcast:5 row_mask:0xf bank_mask:0xf
  v_dot2c_f32_bf16_dpp v11, v35, v125 row_newbcast:5 row_mask:0xf bank_mask:0xf
  v_dot2c_f32_bf16_dpp v12, v31, v126 row_newbcast:5 row_mask:0xf bank_mask:0xf
  v_dot2c_f32_bf16_dpp v13, v35, v126 row_newbcast:5 row_mask:0xf bank_mask:0xf
  v_dot2c_f32_bf16_dpp v14, v31, v127 row_newbcast:5 row_mask:0xf bank_mask:0xf
  v_dot2c_f32_bf16_dpp v15, v35, v127 row_newbcast:5 row_mask:0xf bank_mask:0xf
  s_cmp_eq_u32 s75, 27
  s_cbranch_scc1 L_epi
  s_call_b64 s[62:63], L_vs
  s_cbranch_scc1 L_nl27
  v_add_u32_dpp v3, v30, v38 row_newbcast:11 row_mask:0xf bank_mask:0xf
  buffer_load_dwordx4 v[148:151], v3, s[48:51], 0 offen nt
L_nl27:
  v_dot2c_f32_bf16_dpp v8, v31, v128 row_newbcast:6 row_mask:0xf bank_mask:0xf
  v_dot2c_f32_bf16_dpp v9, v35, v128 row_newbcast:6 row_mask:0xf bank_mask:0xf
  v_dot2c_f32_bf16_dpp v10, v31, v129 row_newbcast:6 row_mask:0xf bank_mask:0xf
  v_dot2c_f32_bf16_dpp v11, v35, v129 row_newbcast:6 row_mask:0xf bank_mask:0xf
  v_dot2c_f32_bf16_dpp v12, v31, v130 row_newbcast:6 row_mask:0xf bank_mask:0xf
  v_dot2c_f32_bf16_dpp v13, v35, v130 row_newbcast:6 row_mask:0xf bank_mask:0xf
  v_dot2c_f32_bf16_dpp v14, v31, v131 row_newbcast:6 row_mask:0xf bank_mask:0xf
  v_dot2c_f32_bf16_dpp v15, v35, v131 row_newbcast:6 row_mask:0xf bank_mask:0xf
  s_cmp_eq_u32 s75, 28
  s_cbranch_scc1 L_epi
  s_call_b64 s[62:63], L_vs
  s_cbranch_scc1 L_nl28
  v_add_u32_dpp v3, v30, v38 row_newbcast:12 row_mask:0xf bank_mask:0xf
  buffer_load_dwordx4 v[152:155], v3, s[48:51], 0 offen nt
L_nl28:
  v_dot2c_f32_bf16_dpp v8, v31, v132 row_newbcast:7 row_mask:0xf bank_mask:0xf
  v_dot2c_f32_bf16_dpp v9, v35, v132 row_newbcast:7 row_mask:0xf bank_mask:0xf
  v_dot2c_f32_bf16_dpp v10, v31, v133 row_newbcast:7 row_mask:0xf bank_mask:0xf
  v_dot2c_f32_bf16_dpp v11, v35, v133 row_newbcast:7 row_mask:0xf bank_mask:0xf
  v_dot2c_f32_bf16_dpp v12, v31, v134 row_newbcast:7 row_mask:0xf bank_mask:0xf
  v_dot2c_f32_bf16_dpp v13, v35, v134 row_newbcast:7 row_mask:0xf bank_mask:0xf
  v_dot2c_f32_bf16_dpp v14, v31, v135 row_newbcast:7 row_mask:0xf bank_mask:0xf
  v_dot2c_f32_bf16_dpp v15, v35, v135 row_newbcast:7 row_mask:0xf bank_mask:0xf
  s_cmp_eq_u32 s75, 29
  s_cbranch_scc1 L_epi
  s_call_b64 s[62:63], L_vs
  s_cbranch_scc1 L_nl29
  v_add_u32_dpp v3, v30, v38 row_newbcast:13 row_mask:0xf bank_mask:0xf
  buffer_load_dwordx4 v[156:159], v3, s[48:51], 0 offen nt
L_nl29:
  v_dot2c_f32_bf16_dpp v8, v31, v136 row_newbcast:8 row_mask:0xf bank_mask:0xf
  v_dot2c_f32_bf16_dpp v9, v35, v136 row_newbcast:8 row_mask:0xf bank_mask:0xf
  v_dot2c_f32_bf16_dpp v10, v31, v137 row_newbcast:8 row_mask:0xf bank_mask:0xf
  v_dot2c_f32_bf16_dpp v11, v35, v137 row_newbcast:8 row_mask:0xf bank_mask:0xf
  v_dot2c_f32_bf16_dpp v12, v31, v138 row_newbcast:8 row_mask:0xf bank_mask:0xf
  v_dot2c_f32_bf16_dpp v13, v35, v138 row_newbcast:8 row_mask:0xf bank_mask:0xf
  v_dot2c_f32_bf16_dpp v14, v31, v139 row_newbcast:8 row_mask:0xf bank_mask:0xf
  v_dot2c_f32_bf16_dpp v15, v35, v139 row_newbcast:8 row_mask:0xf bank_mask:0xf
  s_cmp_eq_u32 s75, 30
  s_cbranch_scc1 L_epi
  s_call_b64 s[62:63], L_vs
  s_cbranch_scc1 L_nl30
  v_add_u32_dpp v3, v30, v38 row_newbcast:14 row_mask:0xf bank_mask:0xf
  buffer_load_dwordx4 v[160:163], v3, s[48:51], 0 offen nt
L_nl30:
  v_dot2c_f32_bf16_dpp v8, v31, v140 row_newbcast:9 row_mask:0xf bank_mask:0xf
  v_dot2c_f32_bf16_dpp v9, v35, v140 row_newbcast:9 row_mask:0xf bank_mask:0xf
  v_dot2c_f32_bf16_dpp v10, v31, v141 row_newbcast:9 row_mask:0xf bank_mask:0xf
  v_dot2c_f32_bf16_dpp v11, v35, v141 row_newbcast:9 row_mask:0xf bank_mask:0xf
  v_dot2c_f32_bf16_dpp v12, v31, v142 row_newbcast:9 row_mask:0xf bank_mask:0xf
  v_dot2c_f32_bf16_dpp v13, v35, v142 row_newbcast:9 row_mask:0xf bank_mask:0xf
  v_dot2c_f32_bf16_dpp v14, v31, v143 row_newbcast:9 row_mask:0xf bank_mask:0xf
  v_dot2c_f32_bf16_dpp v15, v35, v143 row_newbcast:9 row_mask:0xf bank_mask:0xf
  s_cmp_eq_u32 s75, 31
  s_cbranch_scc1 L_epi
  s_call_b64 s[62:63], L_vs
  s_cbranch_scc1 L_nl31
  v_add_u32_dpp v3, v30, v38 row_newbcast:15 row_mask:0xf bank_mask:0xf
  buffer_load_dwordx4 v[164:167], v3, s[48:51], 0 offen nt
L_nl31:
  v_dot2c_f32_bf16_dpp v8, v31, v144 row_newbcast:10 row_mask:0xf bank_mask:0xf
  v_dot2c_f32_bf16_dpp v9, v35, v144 row_newbcast:10 row_mask:0xf bank_mask:0xf
  v_dot2c_f32_bf16_dpp v10, v31, v145 row_newbcast:10 row_mask:0xf bank_mask:0xf
  v_dot2c_f32_bf16_dpp v11, v35, v145 row_newbcast:10 row_mask:0xf bank_mask:0xf
  v_dot2c_f32_bf16_dpp v12, v31, v146 row_newbcast:10 row_mask:0xf bank_mask:0xf
  v_dot2c_f32_bf16_dpp v13, v35, v146 row_newbcast:10 row_mask:0xf bank_mask:0xf
  v_dot2c_f32_bf16_dpp v14, v31, v147 row_newbcast:10 row_mask:0xf bank_mask:0xf
  v_dot2c_f32_bf16_dpp v15, v35, v147 row_newbcast:10 row_mask:0xf bank_mask:0xf
  s_cmp_eq_u32 s75, 32
  s_cbranch_scc1 L_epi
  s_call_b64 s[62:63], L_vs
  s_cbranch_scc1 L_nl32
  v_add_u32_dpp v3, v32, v38 row_newbcast:0 row_mask:0xf bank_mask:0xf
  buffer_load_dwordx4 v[40:43], v3, s[48:51], 0 offen nt
L_nl32:
  v_dot2c_f32_bf16_dpp v8, v31, v148 row_newbcast:11 row_mask:0xf bank_mask:0xf
  v_dot2c_f32_bf16_dpp v9, v35, v148 row_newbcast:11 row_mask:0xf bank_mask:0xf
  v_dot2c_f32_bf16_dpp v10, v31, v149 row_newbcast:11 row_mask:0xf bank_mask:0xf
  v_dot2c_f32_bf16_dpp v11, v35, v149 row_newbcast:11 row_mask:0xf bank_mask:0xf
  v_dot2c_f32_bf16_dpp v12, v31, v150 row_newbcast:11 row_mask:0xf bank_mask:0xf
  v_dot2c_f32_bf16_dpp v13, v35, v150 row_newbcast:11 row_mask:0xf bank_mask:0xf
  v_dot2c_f32_bf16_dpp v14, v31, v151 row_newbcast:11 row_mask:0xf bank_mask:0xf
  v_dot2c_f32_bf16_dpp v15, v35, v151 row_newbcast:11 row_mask:0xf bank_mask:0xf
  s_cmp_eq_u32 s75, 33
  s_cbranch_scc1 L_epi
  s_call_b64 s[62:63], L_vs
  s_cbranch_scc1 L_nl33
  v_add_u32_dpp v3, v32, v38 row_newbcast:1 row_mask:0xf bank_mask:0xf
  buffer_load_dwordx4 v[44:47], v3, s[48:51], 0 offen nt
L_nl33:
  v_dot2c_f32_bf16_dpp v8, v31, v152 row_newbcast:12 row_mask:0xf bank_mask:0xf
  v_dot2c_f32_bf16_dpp v9, v35, v152 row_newbcast:12 row_mask:0xf bank_mask:0xf
  v_dot2c_f32_bf16_dpp v10, v31, v153 row_newbcast:12 row_mask:0xf bank_mask:0xf
  v_dot2c_f32_bf16_dpp v11, v35, v153 row_newbcast:12 row_mask:0xf bank_mask:0xf
  v_dot2c_f32_bf16_dpp v12, v31, v154 row_newbcast:12 row_mask:0xf bank_mask:0xf
  v_dot2c_f32_bf16_dpp v13, v35, v154 row_newbcast:12 row_mask:0xf bank_mask:0xf
  v_dot2c_f32_bf16_dpp v14, v31, v155 row_newbcast:12 row_mask:0xf bank_mask:0xf
  v_dot2c_f32_bf16_dpp v15, v35, v155 row_newbcast:12 row_mask:0xf bank_mask:0xf
  s_cmp_eq_u32 s75, 34
  s_cbranch_scc1 L_epi
  s_call_b64 s[62:63], L_vs
  s_cbranch_scc1 L_nl34
  v_add_u32_dpp v3, v32, v38 row_newbcast:2 row_mask:0xf bank_mask:0xf
  buffer_load_dwordx4 v[48:51], v3, s[48:51], 0 offen nt
L_nl34:
  v_dot2c_f32_bf16_dpp v8, v31, v156 row_newbcast:13 row_mask:0xf bank_mask:0xf
  v_dot2c_f32_bf16_dpp v9, v35, v156 row_newbcast:13 row_mask:0xf bank_mask:0xf
  v_dot2c_f32_bf16_dpp v10, v31, v157 row_newbcast:13 row_mask:0xf bank_mask:0xf
  v_dot2c_f32_bf16_dpp v11, v35, v157 row_newbcast:13 row_mask:0xf bank_mask:0xf
  v_dot2c_f32_bf16_dpp v12, v31, v158 row_newbcast:13 row_mask:0xf bank_mask:0xf
  v_dot2c_f32_bf16_dpp v13, v35, v158 row_newbcast:13 row_mask:0xf bank_mask:0xf
  v_dot2c_f32_bf16_dpp v14, v31, v159 row_newbcast:13 row_mask:0xf bank_mask:0xf
  v_dot2c_f32_bf16_dpp v15, v35, v159 row_newbcast:13 row_mask:0xf bank_mask:0xf
  s_cmp_eq_u32 s75, 35
  s_cbranch_scc1 L_epi
  s_call_b64 s[62:63], L_vs
  s_cbranch_scc1 L_nl35
  v_add_u32_dpp v3, v32, v38 row_newbcast:3 row_mask:0xf bank_mask:0xf
  buffer_load_dwordx4 v[52:55], v3, s[48:51], 0 offen nt
L_nl35:
  v_dot2c_f32_bf16_dpp v8, v31, v160 row_newbcast:14 row_mask:0xf bank_mask:0xf
  v_dot2c_f32_bf16_dpp v9, v35, v160 row_newbcast:14 row_mask:0xf bank_mask:0xf
  v_dot2c_f32_bf16_dpp v10, v31, v161 row_newbcast:14 row_mask:0xf bank_mask:0xf
  v_dot2c_f32_bf16_dpp v11, v35, v161 row_newbcast:14 row_mask:0xf bank_mask:0xf
  v_dot2c_f32_bf16_dpp v12, v31, v162 row_newbcast:14 row_mask:0xf bank_mask:0xf
  v_dot2c_f32_bf16_dpp v13, v35, v162 row_newbcast:14 row_mask:0xf bank_mask:0xf
  v_dot2c_f32_bf16_dpp v14, v31, v163 row_newbcast:14 row_mask:0xf bank_mask:0xf
  v_dot2c_f32_bf16_dpp v15, v35, v163 row_newbcast:14 row_mask:0xf bank_mask:0xf
  s_cmp_eq_u32 s75, 36
  s_cbranch_scc1 L_epi
  s_call_b64 s[62:63], L_vs
  s_cbranch_scc1 L_nl36
  v_add_u32_dpp v3, v32, v38 row_newbcast:4 row_mask:0xf bank_mask:0xf
  buffer_load_dwordx4 v[56:59], v3, s[48:51], 0 offen nt
L_nl36:
  v_dot2c_f32_bf16_dpp v8, v31, v164 row_newbcast:15 row_mask:0xf bank_mask:0xf
  v_dot2c_f32_bf16_dpp v9, v35, v164 row_newbcast:15 row_mask:0xf bank_mask:0xf
  v_dot2c_f32_bf16_dpp v10, v31, v165 row_newbcast:15 row_mask:0xf bank_mask:0xf
  v_dot2c_f32_bf16_dpp v11, v35, v165 row_newbcast:15 row_mask:0xf bank_mask:0xf
  v_dot2c_f32_bf16_dpp v12, v31, v166 row_newbcast:15 row_mask:0xf bank_mask:0xf
  v_dot2c_f32_bf16_dpp v13, v35, v166 row_newbcast:15 row_mask:0xf bank_mask:0xf
  v_dot2c_f32_bf16_dpp v14, v31, v167 row_newbcast:15 row_mask:0xf bank_mask:0xf
  v_dot2c_f32_bf16_dpp v15, v35, v167 row_newbcast:15 row_mask:0xf bank_mask:0xf
  s_cmp_eq_u32 s75, 37
  s_cbranch_scc1 L_epi
  s_call_b64 s[62:63], L_vs
  s_cbranch_scc1 L_nl37
  v_add_u32_dpp v3, v32, v38 row_newbcast:5 row_mask:0xf bank_mask:0xf
  buffer_load_dwordx4 v[60:63], v3, s[48:51], 0 offen nt
L_nl37:
  v_dot2c_f32_bf16_dpp v8, v33, v40 row_newbcast:0 row_mask:0xf bank_mask:0xf
  v_dot2c_f32_bf16_dpp v9, v36, v40 row_newbcast:0 row_mask:0xf bank_mask:0xf
  v_dot2c_f32_bf16_dpp v10, v33, v41 row_newbcast:0 row_mask:0xf bank_mask:0xf
  v_dot2c_f32_bf16_dpp v11, v36, v41 row_newbcast:0 row_mask:0xf bank_mask:0xf
  v_dot2c_f32_bf16_dpp v12, v33, v42 row_newbcast:0 row_mask:0xf bank_mask:0xf
  v_dot2c_f32_bf16_dpp v13, v36, v42 row_newbcast:0 row_mask:0xf bank_mask:0xf
  v_dot2c_f32_bf16_dpp v14, v33, v43 row_newbcast:0 row_mask:0xf bank_mask:0xf
  v_dot2c_f32_bf16_dpp v15, v36, v43 row_newbcast:0 row_mask:0xf bank_mask:0xf
  s_cmp_eq_u32 s75, 38
  s_cbranch_scc1 L_epi
  s_call_b64 s[62:63], L_vs
  v_dot2c_f32_bf16_dpp v8, v33, v44 row_newbcast:1 row_mask:0xf bank_mask:0xf
  v_dot2c_f32_bf16_dpp v9, v36, v44 row_newbcast:1 row_mask:0xf bank_mask:0xf
  v_dot2c_f32_bf16_dpp v10, v33, v45 row_newbcast:1 row_mask:0xf bank_mask:0xf
  v_dot2c_f32_bf16_dpp v11, v36, v45 row_newbcast:1 row_mask:0xf bank_mask:0xf
  v_dot2c_f32_bf16_dpp v12, v33, v46 row_newbcast:1 row_mask:0xf bank_mask:0xf
  v_dot2c_f32_bf16_dpp v13, v36, v46 row_newbcast:1 row_mask:0xf bank_mask:0xf
  v_dot2c_f32_bf16_dpp v14, v33, v47 row_newbcast:1 row_mask:0xf bank_mask:0xf
  v_dot2c_f32_bf16_dpp v15, v36, v47 row_newbcast:1 row_mask:0xf bank_mask:0xf
  s_cmp_eq_u32 s75, 39
  s_cbranch_scc1 L_epi
  s_call_b64 s[62:63], L_vs
  v_dot2c_f32_bf16_dpp v8, v33, v48 row_newbcast:2 row_mask:0xf bank_mask:0xf
  v_dot2c_f32_bf16_dpp v9, v36, v48 row_newbcast:2 row_mask:0xf bank_mask:0xf
  v_dot2c_f32_bf16_dpp v10, v33, v49 row_newbcast:2 row_mask:0xf bank_mask:0xf
  v_dot2c_f32_bf16_dpp v11, v36, v49 row_newbcast:2 row_mask:0xf bank_mask:0xf
  v_dot2c_f32_bf16_dpp v12, v33, v50 row_newbcast:2 row_mask:0xf bank_mask:0xf
  v_dot2c_f32_bf16_dpp v13, v36, v50 row_newbcast:2 row_mask:0xf bank_mask:0xf
  v_dot2c_f32_bf16_dpp v14, v33, v51 row_newbcast:2 row_mask:0xf bank_mask:0xf
  v_dot2c_f32_bf16_dpp v15, v36, v51 row_newbcast:2 row_mask:0xf bank_mask:0xf
  s_cmp_eq_u32 s75, 40
  s_cbranch_scc1 L_epi
  s_call_b64 s[62:63], L_vs
  v_dot2c_f32_bf16_dpp v8, v33, v52 row_newbcast:3 row_mask:0xf bank_mask:0xf
  v_dot2c_f32_bf16_dpp v9, v36, v52 row_newbcast:3 row_mask:0xf bank_mask:0xf
  v_dot2c_f32_bf16_dpp v10, v33, v53 row_newbcast:3 row_mask:0xf bank_mask:0xf
  v_dot2c_f32_bf16_dpp v11, v36, v53 row_newbcast:3 row_mask:0xf bank_mask:0xf
  v_dot2c_f32_bf16_dpp v12, v33, v54 row_newbcast:3 row_mask:0xf bank_mask:0xf
  v_dot2c_f32_bf16_dpp v13, v36, v54 row_newbcast:3 row_mask:0xf bank_mask:0xf
  v_dot2c_f32_bf16_dpp v14, v33, v55 row_newbcast:3 row_mask:0xf bank_mask:0xf
  v_dot2c_f32_bf16_dpp v15, v36, v55 row_newbcast:3 row_mask:0xf bank_mask:0xf
  s_cmp_eq_u32 s75, 41
  s_cbranch_scc1 L_epi
  s_call_b64 s[62:63], L_vs
  v_dot2c_f32_bf16_dpp v8, v33, v56 row_newbcast:4 row_mask:0xf bank_mask:0xf
  v_dot2c_f32_bf16_dpp v9, v36, v56 row_newbcast:4 row_mask:0xf bank_mask:0xf
  v_dot2c_f32_bf16_dpp v10, v33, v57 row_newbcast:4 row_mask:0xf bank_mask:0xf
  v_dot2c_f32_bf16_dpp v11, v36, v57 row_newbcast:4 row_mask:0xf bank_mask:0xf
  v_dot2c_f32_bf16_dpp v12, v33, v58 row_newbcast:4 row_mask:0xf bank_mask:0xf
  v_dot2c_f32_bf16_dpp v13, v36, v58 row_newbcast:4 row_mask:0xf bank_mask:0xf
  v_dot2c_f32_bf16_dpp v14, v33, v59 row_newbcast:4 row_mask:0xf bank_mask:0xf
  v_dot2c_f32_bf16_dpp v15, v36, v59 row_newbcast:4 row_mask:0xf bank_mask:0xf
  s_cmp_eq_u32 s75, 42
  s_cbranch_scc1 L_epi
  s_call_b64 s[62:63], L_vs
  v_dot2c_f32_bf16_dpp v8, v33, v60 row_newbcast:5 row_mask:0xf bank_mask:0xf
  v_dot2c_f32_bf16_dpp v9, v36, v60 row_newbcast:5 row_mask:0xf bank_mask:0xf
  v_dot2c_f32_bf16_dpp v10, v33, v61 row_newbcast:5 row_mask:0xf bank_mask:0xf
  v_dot2c_f32_bf16_dpp v11, v36, v61 row_newbcast:5 row_mask:0xf bank_mask:0xf
  v_dot2c_f32_bf16_dpp v12, v33, v62 row_newbcast:5 row_mask:0xf bank_mask:0xf
  v_dot2c_f32_bf16_dpp v13, v36, v62 row_newbcast:5 row_mask:0xf bank_mask:0xf
  v_dot2c_f32_bf16_dpp v14, v33, v63 row_newbcast:5 row_mask:0xf bank_mask:0xf
  v_dot2c_f32_bf16_dpp v15, v36, v63 row_newbcast:5 row_mask:0xf bank_mask:0xf
  s_nop 1
L_epi:
  s_nop 0
  s_nop 0
  v_permlane32_swap_b32 v8, v12
  v_permlane32_swap_b32 v9, v13
  v_permlane32_swap_b32 v10, v14
  v_permlane32_swap_b32 v11, v15
  v_add_f32 v8, v8, v12
  v_add_f32 v9, v9, v13
  v_add_f32 v10, v10, v14
  v_add_f32 v11, v11, v15
  v_mov_b32 v3, 1
  v_permlane16_swap_b32 v8, v10
  v_permlane16_swap_b32 v9, v11
  v_add_f32 v8, v8, v10
  v_add_f32 v9, v9, v11
  v_pk_add_f32 v[8:9], v[8:9], v[4:5]
  ds_write_b64 v22, v[8:9] offset:7296
  s_cmp_eq_u32 s21, 0
  s_cbranch_scc1 L_ep2
  ds_write_b64 v22, v[8:9] offset:11904
  s_mov_b64 exec, 1
  ds_add_u32 v1, v3 offset:6704
  s_mov_b64 exec, -1
L_ep2:
  s_mov_b64 exec, 1
  ds_add_rtn_u32 v3, v1, v3 offset:6708
  s_mov_b64 exec, -1
  v_mov_b32 v4, 0
  s_lshl_b32 s10, s6, 11
  s_add_u32 s10, s10, 131072
  v_lshl_add_u32 v2, v1, 3, s10
  v_add_u32 v0, 393216, v2
  s_waitcnt lgkmcnt(0)
  v_readfirstlane_b32 s68, v3
  s_cmp_lg_u32 s68, 7
  s_cbranch_scc1 L_send
  s_cmp_lg_u32 s7, 0
  s_cbranch_scc1 L_nolook
  global_load_dwordx2 v[42:43], v0, s[42:43] offset:512 sc1
  global_load_dwordx2 v[44:45], v0, s[42:43] offset:1024 sc1
  global_load_dwordx2 v[46:47], v0, s[42:43] offset:1536 sc1
  global_load_dwordx2 v[48:49], v2, s[42:43] offset:0 sc1
  global_load_dwordx2 v[50:51], v2, s[42:43] offset:512 sc1
  global_load_dwordx2 v[52:53], v2, s[42:43] offset:1024 sc1
  global_load_dwordx2 v[54:55], v2, s[42:43] offset:1536 sc1
L_nolook:
  s_mov_b32 s70, 0
L_pl_1:
  ds_read_b32 v5, v4 offset:6656
  s_waitcnt lgkmcnt(0)
  v_cmp_eq_u32 vcc, -1, v5
  s_cmp_eq_u64 vcc, 0
  s_cbranch_scc1 L_pld_2
  s_sleep 1
  s_add_u32 s70, s70, 1
  s_cmp_lt_u32 s70, 1048576
  s_cbranch_scc1 L_pl_1
L_pld_2:
  v_lshlrev_b32 v30, 3, v1
  ds_read_b128 v[22:25], v4 offset:6752
  ds_read_b128 v[26:29], v4 offset:6768
  ds_read_b64 v[6:7], v30 offset:7296
  ds_read_b64 v[8:9], v30 offset:7808
  ds_read_b64 v[10:11], v30 offset:8320
  ds_read_b64 v[12:13], v30 offset:8832
  ds_read_b64 v[14:15], v30 offset:9344
  ds_read_b64 v[16:17], v30 offset:9856
  ds_read_b64 v[18:19], v30 offset:10368
  ds_read_b64 v[20:21], v30 offset:10880
  ds_read_b32 v34, v4 offset:6712
  s_lshl_b32 s68, s6, 2
  s_add_u32 s68, s68, s7
  s_lshl_b32 s68, s68, 9
  s_add_u32 s68, s68, 524288
  v_add_u32 v30, s68, v30
  v_and_b32 v31, 1, v1
  v_lshlrev_b32 v31, 4, v31
  v_lshrrev_b32 v31, v31, s74
  v_lshrrev_b32 v32, 8, v31
  s_movk_i32 s69, 0xff
  s_waitcnt lgkmcnt(8)
  v_pk_mul_f32 v[6:7], v[6:7], v[22:23] op_sel:[0,0] op_sel_hi:[1,0]
  s_waitcnt lgkmcnt(7)
  v_pk_mul_f32 v[8:9], v[8:9], v[22:23] op_sel:[0,1] op_sel_hi:[1,1]
  s_waitcnt lgkmcnt(6)
  v_pk_fma_f32 v[6:7], v[10:11], v[24:25], v[6:7] op_sel:[0,0,0] op_sel_hi:[1,0,1]
  s_waitcnt lgkmcnt(5)
  v_pk_fma_f32 v[8:9], v[12:13], v[24:25], v[8:9] op_sel:[0,1,0] op_sel_hi:[1,1,1]
  s_waitcnt lgkmcnt(4)
  v_pk_fma_f32 v[6:7], v[14:15], v[26:27], v[6:7] op_sel:[0,0,0] op_sel_hi:[1,0,1]
  s_waitcnt lgkmcnt(3)
  v_pk_fma_f32 v[8:9], v[16:17], v[26:27], v[8:9] op_sel:[0,1,0] op_sel_hi:[1,1,1]
  s_waitcnt lgkmcnt(2)
  v_pk_fma_f32 v[6:7], v[18:19], v[28:29], v[6:7] op_sel:[0,0,0] op_sel_hi:[1,0,1]
  s_waitcnt lgkmcnt(1)
  v_pk_fma_f32 v[8:9], v[20:21], v[28:29], v[8:9] op_sel:[0,1,0] op_sel_hi:[1,1,1]
  s_waitcnt lgkmcnt(0)
  v_readfirstlane_b32 s75, v34
  v_pk_add_f32 v[6:7], v[6:7], v[8:9]
  v_bfi_b32 v6, s69, v31, v6
  v_bfi_b32 v7, s69, v32, v7
  s_cmp_eq_u32 s75, 2
  s_cbranch_scc0 L_pf_3
  global_store_dwordx2 v30, v[6:7], s[42:43]
  s_branch L_pe_4
L_pf_3:
  global_store_dwordx2 v30, v[6:7], s[42:43] sc1
L_pe_4:
  v_add_u32 v30, 131072, v30
  global_store_dwordx2 v30, v[6:7], s[42:43] sc1
  s_cmp_lg_u32 s7, 0
  s_cbranch_scc1 L_send
  v_and_b32 v31, 0xff, v31
  v_and_b32 v32, 0xff, v32
  s_mov_b32 s70, 0
  s_waitcnt vmcnt(2)
  s_branch L_cp1
L_cp0:
  global_load_dwordx2 v[42:43], v0, s[42:43] offset:512 sc1
  global_load_dwordx2 v[44:45], v0, s[42:43] offset:1024 sc1
  global_load_dwordx2 v[46:47], v0, s[42:43] offset:1536 sc1
  global_load_dwordx2 v[48:49], v2, s[42:43] offset:0 sc1
  global_load_dwordx2 v[50:51], v2, s[42:43] offset:512 sc1
  global_load_dwordx2 v[52:53], v2, s[42:43] offset:1024 sc1
  global_load_dwordx2 v[54:55], v2, s[42:43] offset:1536 sc1
  s_waitcnt vmcnt(0)
L_cp1:
  v_xor_b32 v48, v48, v31
  v_xor_b32 v49, v49, v32
  v_xor_b32 v50, v50, v31
  v_xor_b32 v51, v51, v32
  v_xor_b32 v52, v52, v31
  v_xor_b32 v53, v53, v32
  v_xor_b32 v54, v54, v31
  v_xor_b32 v55, v55, v32
  v_or3_b32 v56, v48, v49, v50
  v_or3_b32 v57, v51, v52, v53
  v_or3_b32 v56, v56, v54, v55
  v_or_b32 v48, 0x80, v48
  v_or_b32 v49, 0x80, v49
  v_or_b32 v50, 0x80, v50
  v_or_b32 v51, 0x80, v51
  v_or_b32 v52, 0x80, v52
  v_or_b32 v53, 0x80, v53
  v_or_b32 v54, 0x80, v54
  v_or_b32 v55, 0x80, v55
  v_or_b32 v56, v56, v57
  v_pk_add_f32 v[48:49], v[48:49], v[52:53]
  v_pk_add_f32 v[50:51], v[50:51], v[54:55]
  v_lshlrev_b32 v56, 24, v56
  v_pk_add_f32 v[48:49], v[48:49], v[50:51]
  v_cmp_ne_u32 vcc, 0, v56
  v_cvt_pk_bf16_f32 v48, v48, v49
  s_cmp_eq_u64 vcc, 0
  s_cbranch_scc1 L_cp2
  s_sleep 4
  s_add_u32 s70, s70, 1
  s_cmp_lt_u32 s70, 262144
  s_cbranch_scc1 L_cp0
L_cp2:
  s_mov_b32 s70, 0
  s_branch L_cp4
L_cp3:
  global_load_dwordx2 v[42:43], v0, s[42:43] offset:512 sc1
  global_load_dwordx2 v[44:45], v0, s[42:43] offset:1024 sc1
  global_load_dwordx2 v[46:47], v0, s[42:43] offset:1536 sc1
  s_waitcnt vmcnt(0)
L_cp4:
  v_mov_b32 v40, v6
  v_mov_b32 v41, v7
  v_xor_b32 v40, v40, v31
  v_xor_b32 v41, v41, v32
  v_xor_b32 v42, v42, v31
  v_xor_b32 v43, v43, v32
  v_xor_b32 v44, v44, v31
  v_xor_b32 v45, v45, v32
  v_xor_b32 v46, v46, v31
  v_xor_b32 v47, v47, v32
  v_or3_b32 v56, v40, v41, v42
  v_or3_b32 v57, v43, v44, v45
  v_or3_b32 v56, v56, v46, v47
  v_or_b32 v40, 0x80, v40
  v_or_b32 v41, 0x80, v41
  v_or_b32 v42, 0x80, v42
  v_or_b32 v43, 0x80, v43
  v_or_b32 v44, 0x80, v44
  v_or_b32 v45, 0x80, v45
  v_or_b32 v46, 0x80, v46
  v_or_b32 v47, 0x80, v47
  v_or_b32 v56, v56, v57
  v_pk_add_f32 v[40:41], v[40:41], v[44:45]
  v_pk_add_f32 v[42:43], v[42:43], v[46:47]
  v_lshlrev_b32 v56, 24, v56
  v_pk_add_f32 v[40:41], v[40:41], v[42:43]
  v_cmp_ne_u32 vcc, 0, v56
  v_cvt_pk_bf16_f32 v40, v40, v41
  s_cmp_eq_u64 vcc, 0
  s_cbranch_scc1 L_cp5
  s_add_u32 s70, s70, 1
  s_cmp_lt_u32 s70, 262144
  s_cbranch_scc1 L_cp3
L_cp5:
  v_cmp_ne_u32 vcc, v40, v48
  s_cmp_lg_u64 vcc, 0
  s_cbranch_scc1 L_slow
L_send:
  s_endpgm
L_slow:
  s_load_dwordx16 s[16:31], s[0:1], 0
  s_load_dwordx8 s[32:39], s[0:1], 64
  v_and_b32 v2, 31, v1
  v_lshlrev_b32 v2, 7, v2
  v_add_u32 v2, 28672, v2
  s_mov_b32 s70, 0
L_sl_d:
  global_load_dword v3, v2, s[42:43] sc1
  s_waitcnt vmcnt(0) lgkmcnt(0)
  v_cmp_ne_u32 vcc, s74, v3
  s_cmp_eq_u64 vcc, 0
  s_cbranch_scc1 L_sl_dd
  s_sleep 8
  s_add_u32 s70, s70, 1
  s_cmp_lt_u32 s70, 262144
  s_cbranch_scc1 L_sl_d
L_sl_dd:
  v_lshlrev_b32 v2, 3, v1
  v_add_u32 v2, 655360, v2
  v_lshlrev_b32 v0, 2, v1
  v_add_u32 v0, 81920, v0
  s_mov_b32 s10, 0
L_sl_h:
  s_mov_b32 s70, 0
L_sl_hp:
  global_load_dwordx2 v[40:41], v2, s[42:43] offset:0 sc1
  global_load_dwordx2 v[42:43], v2, s[42:43] offset:512 sc1
  global_load_dwordx2 v[44:45], v2, s[42:43] offset:1024 sc1
  global_load_dwordx2 v[46:47], v2, s[42:43] offset:1536 sc1
  s_waitcnt vmcnt(0)
  v_xor_b32 v40, v40, v31
  v_xor_b32 v41, v41, v32
  v_xor_b32 v42, v42, v31
  v_xor_b32 v43, v43, v32
  v_xor_b32 v44, v44, v31
  v_xor_b32 v45, v45, v32
  v_xor_b32 v46, v46, v31
  v_xor_b32 v47, v47, v32
  v_or3_b32 v48, v40, v41, v42
  v_or3_b32 v49, v43, v44, v45
  v_or3_b32 v48, v48, v46, v47
  v_or_b32 v40, 0x80, v40
  v_or_b32 v41, 0x80, v41
  v_or_b32 v42, 0x80, v42
  v_or_b32 v43, 0x80, v43
  v_or_b32 v44, 0x80, v44
  v_or_b32 v45, 0x80, v45
  v_or_b32 v46, 0x80, v46
  v_or_b32 v47, 0x80, v47
  v_or_b32 v48, v48, v49
  v_pk_add_f32 v[40:41], v[40:41], v[44:45]
  v_pk_add_f32 v[42:43], v[42:43], v[46:47]
  v_lshlrev_b32 v48, 24, v48
  v_pk_add_f32 v[40:41], v[40:41], v[42:43]
  v_cmp_ne_u32 vcc, 0, v48
  v_cvt_pk_bf16_f32 v40, v40, v41
  s_cmp_eq_u64 vcc, 0
  s_cbranch_scc1 L_sl_hd
  s_sleep 8
  s_add_u32 s70, s70, 1
  s_cmp_lt_u32 s70, 262144
  s_cbranch_scc1 L_sl_hp
L_sl_hd:
  ds_write_b32 v0, v40
  v_add_u32 v2, 2048, v2
  v_add_u32 v0, 256, v0
  s_add_u32 s10, s10, 1
  s_cmp_lt_u32 s10, 64
  s_cbranch_scc1 L_sl_h
  s_mov_b32 s44, s24
  s_mov_b32 s45, s25
  s_mov_b32 s46, 4194304
  s_mov_b32 s11, 1024
  s_mov_b32 s12, 4194304
  v_mov_b32 v4, 81920
  v_mov_b32 v5, 90112
  v_lshlrev_b32 v2, 4, v1
  s_call_b64 s[62:63], L_gv
  v_lshlrev_b32 v0, 4, v1
  global_load_dwordx4 v[40:43], v0, s[16:17] offset:0
  global_load_dwordx4 v[44:47], v0, s[16:17] offset:1024
  s_waitcnt vmcnt(0)
  v_lshlrev_b32 v104, 16, v40
  v_and_b32 v105, s73, v40
  v_lshlrev_b32 v106, 16, v41
  v_and_b32 v107, s73, v41
  v_lshlrev_b32 v108, 16, v42
  v_and_b32 v109, s73, v42
  v_lshlrev_b32 v110, 16, v43
  v_and_b32 v111, s73, v43
  v_lshlrev_b32 v112, 16, v44
  v_and_b32 v113, s73, v44
  v_lshlrev_b32 v114, 16, v45
  v_and_b32 v115, s73, v45
  v_lshlrev_b32 v116, 16, v46
  v_and_b32 v117, s73, v46
  v_lshlrev_b32 v118, 16, v47
  v_and_b32 v119, s73, v47
  v_lshrrev_b32 v2, 1, v1
  v_lshlrev_b32 v2, 7, v2
  v_and_b32 v3, 1, v1
  v_lshl_add_u32 v2, v3, 5, v2
  v_add_u32 v2, 12288, v2
  global_load_dwordx4 v[40:43], v2, s[42:43] offset:0 sc1
  global_load_dwordx4 v[44:47], v2, s[42:43] offset:16 sc1
  global_load_dwordx4 v[48:51], v2, s[42:43] offset:64 sc1
  global_load_dwordx4 v[52:55], v2, s[42:43] offset:80 sc1
  s_waitcnt vmcnt(0)
  v_lshlrev_b32 v88, 16, v40
  v_and_b32 v89, s73, v40
  v_lshlrev_b32 v90, 16, v42
  v_and_b32 v91, s73, v42
  v_lshlrev_b32 v92, 16, v44
  v_and_b32 v93, s73, v44
  v_lshlrev_b32 v94, 16, v46
  v_and_b32 v95, s73, v46
  v_lshlrev_b32 v96, 16, v48
  v_and_b32 v97, s73, v48
  v_lshlrev_b32 v98, 16, v50
  v_and_b32 v99, s73, v50
  v_lshlrev_b32 v100, 16, v52
  v_and_b32 v101, s73, v52
  v_lshlrev_b32 v102, 16, v54
  v_and_b32 v103, s73, v54
  v_cvt_pk_bf16_f32 v72, 0, v72
  v_cvt_pk_bf16_f32 v73, 0, v73
  v_cvt_pk_bf16_f32 v74, 0, v74
  v_cvt_pk_bf16_f32 v75, 0, v75
  v_cvt_pk_bf16_f32 v76, 0, v76
  v_cvt_pk_bf16_f32 v77, 0, v77
  v_cvt_pk_bf16_f32 v78, 0, v78
  v_cvt_pk_bf16_f32 v79, 0, v79
  v_cvt_pk_bf16_f32 v80, 0, v80
  v_cvt_pk_bf16_f32 v81, 0, v81
  v_cvt_pk_bf16_f32 v82, 0, v82
  v_cvt_pk_bf16_f32 v83, 0, v83
  v_cvt_pk_bf16_f32 v84, 0, v84
  v_cvt_pk_bf16_f32 v85, 0, v85
  v_cvt_pk_bf16_f32 v86, 0, v86
  v_cvt_pk_bf16_f32 v87, 0, v87
  v_mul_f32 v72, v72, v88
  v_mul_f32 v73, v73, v89
  v_mul_f32 v74, v74, v90
  v_mul_f32 v75, v75, v91
  v_mul_f32 v76, v76, v92
  v_mul_f32 v77, v77, v93
  v_mul_f32 v78, v78, v94
  v_mul_f32 v79, v79, v95
  v_mul_f32 v80, v80, v96
  v_mul_f32 v81, v81, v97
  v_mul_f32 v82, v82, v98
  v_mul_f32 v83, v83, v99
  v_mul_f32 v84, v84, v100
  v_mul_f32 v85, v85, v101
  v_mul_f32 v86, v86, v102
  v_mul_f32 v87, v87, v103
  v_cvt_pk_bf16_f32 v72, 0, v72
  v_cvt_pk_bf16_f32 v73, 0, v73
  v_cvt_pk_bf16_f32 v74, 0, v74
  v_cvt_pk_bf16_f32 v75, 0, v75
  v_cvt_pk_bf16_f32 v76, 0, v76
  v_cvt_pk_bf16_f32 v77, 0, v77
  v_cvt_pk_bf16_f32 v78, 0, v78
  v_cvt_pk_bf16_f32 v79, 0, v79
  v_cvt_pk_bf16_f32 v80, 0, v80
  v_cvt_pk_bf16_f32 v81, 0, v81
  v_cvt_pk_bf16_f32 v82, 0, v82
  v_cvt_pk_bf16_f32 v83, 0, v83
  v_cvt_pk_bf16_f32 v84, 0, v84
  v_cvt_pk_bf16_f32 v85, 0, v85
  v_cvt_pk_bf16_f32 v86, 0, v86
  v_cvt_pk_bf16_f32 v87, 0, v87
  v_add_f32 v104, v104, v72
  v_add_f32 v105, v105, v73
  v_add_f32 v106, v106, v74
  v_add_f32 v107, v107, v75
  v_add_f32 v108, v108, v76
  v_add_f32 v109, v109, v77
  v_add_f32 v110, v110, v78
  v_add_f32 v111, v111, v79
  v_add_f32 v112, v112, v80
  v_add_f32 v113, v113, v81
  v_add_f32 v114, v114, v82
  v_add_f32 v115, v115, v83
  v_add_f32 v116, v116, v84
  v_add_f32 v117, v117, v85
  v_add_f32 v118, v118, v86
  v_add_f32 v119, v119, v87
  v_cvt_pk_bf16_f32 v104, 0, v104
  v_cvt_pk_bf16_f32 v105, 0, v105
  v_cvt_pk_bf16_f32 v106, 0, v106
  v_cvt_pk_bf16_f32 v107, 0, v107
  v_cvt_pk_bf16_f32 v108, 0, v108
  v_cvt_pk_bf16_f32 v109, 0, v109
  v_cvt_pk_bf16_f32 v110, 0, v110
  v_cvt_pk_bf16_f32 v111, 0, v111
  v_cvt_pk_bf16_f32 v112, 0, v112
  v_cvt_pk_bf16_f32 v113, 0, v113
  v_cvt_pk_bf16_f32 v114, 0, v114
  v_cvt_pk_bf16_f32 v115, 0, v115
  v_cvt_pk_bf16_f32 v116, 0, v116
  v_cvt_pk_bf16_f32 v117, 0, v117
  v_cvt_pk_bf16_f32 v118, 0, v118
  v_cvt_pk_bf16_f32 v119, 0, v119
  v_add_f32 v8, v104, v105
  v_add_f32 v8, v8, v106
  v_add_f32 v8, v8, v107
  v_add_f32 v8, v8, v108
  v_add_f32 v8, v8, v109
  v_add_f32 v8, v8, v110
  v_add_f32 v8, v8, v111
  s_nop 1
  v_add_f32_dpp v8, v8, v8 row_ror:8 row_mask:0xf bank_mask:0xf
  s_nop 1
  v_add_f32_dpp v8, v8, v8 row_ror:4 row_mask:0xf bank_mask:0xf
  s_nop 1
  v_add_f32_dpp v8, v8, v8 row_ror:2 row_mask:0xf bank_mask:0xf
  s_nop 1
  v_add_f32_dpp v8, v8, v8 row_ror:1 row_mask:0xf bank_mask:0xf
  v_mov_b32 v9, v8
  s_nop 1
  v_permlane16_swap_b32 v9, v8
  v_add_f32 v8, v8, v9
  v_mov_b32 v9, v8
  s_nop 1
  v_permlane32_swap_b32 v9, v8
  v_add_f32 v8, v8, v9
  v_mul_f32 v8, 0x3b000000, v8
  v_sub_f32 v72, v104, v8
  v_sub_f32 v73, v105, v8
  v_sub_f32 v74, v106, v8
  v_sub_f32 v75, v107, v8
  v_sub_f32 v76, v108, v8
  v_sub_f32 v77, v109, v8
  v_sub_f32 v78, v110, v8
  v_sub_f32 v79, v111, v8
  v_mul_f32 v10, v72, v72
  v_fmac_f32 v10, v73, v73
  v_fmac_f32 v10, v74, v74
  v_fmac_f32 v10, v75, v75
  v_fmac_f32 v10, v76, v76
  v_fmac_f32 v10, v77, v77
  v_fmac_f32 v10, v78, v78
  v_fmac_f32 v10, v79, v79
  s_nop 1
  v_add_f32_dpp v10, v10, v10 row_ror:8 row_mask:0xf bank_mask:0xf
  s_nop 1
  v_add_f32_dpp v10, v10, v10 row_ror:4 row_mask:0xf bank_mask:0xf
  s_nop 1
  v_add_f32_dpp v10, v10, v10 row_ror:2 row_mask:0xf bank_mask:0xf
  s_nop 1
  v_add_f32_dpp v10, v10, v10 row_ror:1 row_mask:0xf bank_mask:0xf
  v_mov_b32 v9, v10
  s_nop 1
  v_permlane16_swap_b32 v9, v10
  v_add_f32 v10, v10, v9
  v_mov_b32 v9, v10
  s_nop 1
  v_permlane32_swap_b32 v9, v10
  v_add_f32 v10, v10, v9
  v_mul_f32 v10, 0x3b000000, v10
  v_cvt_pk_bf16_f32 v8, 0, v8
  v_cvt_pk_bf16_f32 v10, 0, v10
  v_add_f32 v10, 0x3727c5ac, v10
  v_cvt_pk_bf16_f32 v10, 0, v10
  v_sqrt_f32 v10, v10
  v_sub_f32 v72, v104, v8
  v_sub_f32 v73, v105, v8
  v_sub_f32 v74, v106, v8
  v_sub_f32 v75, v107, v8
  v_sub_f32 v76, v108, v8
  v_sub_f32 v77, v109, v8
  v_sub_f32 v78, v110, v8
  v_sub_f32 v79, v111, v8
  v_cvt_pk_bf16_f32 v10, 0, v10
  v_cvt_pk_bf16_f32 v72, 0, v72
  v_cvt_pk_bf16_f32 v73, 0, v73
  v_cvt_pk_bf16_f32 v74, 0, v74
  v_cvt_pk_bf16_f32 v75, 0, v75
  v_cvt_pk_bf16_f32 v76, 0, v76
  v_cvt_pk_bf16_f32 v77, 0, v77
  v_cvt_pk_bf16_f32 v78, 0, v78
  v_cvt_pk_bf16_f32 v79, 0, v79
  v_rcp_f32 v10, v10
  s_nop 0
  v_mul_f32 v72, v72, v10
  v_mul_f32 v73, v73, v10
  v_mul_f32 v74, v74, v10
  v_mul_f32 v75, v75, v10
  v_mul_f32 v76, v76, v10
  v_mul_f32 v77, v77, v10
  v_mul_f32 v78, v78, v10
  v_mul_f32 v79, v79, v10
  v_cvt_pk_bf16_f32 v72, 0, v72
  v_cvt_pk_bf16_f32 v73, 0, v73
  v_cvt_pk_bf16_f32 v74, 0, v74
  v_cvt_pk_bf16_f32 v75, 0, v75
  v_cvt_pk_bf16_f32 v76, 0, v76
  v_cvt_pk_bf16_f32 v77, 0, v77
  v_cvt_pk_bf16_f32 v78, 0, v78
  v_cvt_pk_bf16_f32 v79, 0, v79
  v_add_f32 v8, v112, v113
  v_add_f32 v8, v8, v114
  v_add_f32 v8, v8, v115
  v_add_f32 v8, v8, v116
  v_add_f32 v8, v8, v117
  v_add_f32 v8, v8, v118
  v_add_f32 v8, v8, v119
  s_nop 1
  v_add_f32_dpp v8, v8, v8 row_ror:8 row_mask:0xf bank_mask:0xf
  s_nop 1
  v_add_f32_dpp v8, v8, v8 row_ror:4 row_mask:0xf bank_mask:0xf
  s_nop 1
  v_add_f32_dpp v8, v8, v8 row_ror:2 row_mask:0xf bank_mask:0xf
  s_nop 1
  v_add_f32_dpp v8, v8, v8 row_ror:1 row_mask:0xf bank_mask:0xf
  v_mov_b32 v9, v8
  s_nop 1
  v_permlane16_swap_b32 v9, v8
  v_add_f32 v8, v8, v9
  v_mov_b32 v9, v8
  s_nop 1
  v_permlane32_swap_b32 v9, v8
  v_add_f32 v8, v8, v9
  v_mul_f32 v8, 0x3b000000, v8
  v_sub_f32 v80, v112, v8
  v_sub_f32 v81, v113, v8
  v_sub_f32 v82, v114, v8
  v_sub_f32 v83, v115, v8
  v_sub_f32 v84, v116, v8
  v_sub_f32 v85, v117, v8
  v_sub_f32 v86, v118, v8
  v_sub_f32 v87, v119, v8
  v_mul_f32 v10, v80, v80
  v_fmac_f32 v10, v81, v81
  v_fmac_f32 v10, v82, v82
  v_fmac_f32 v10, v83, v83
  v_fmac_f32 v10, v84, v84
  v_fmac_f32 v10, v85, v85
  v_fmac_f32 v10, v86, v86
  v_fmac_f32 v10, v87, v87
  s_nop 1
  v_add_f32_dpp v10, v10, v10 row_ror:8 row_mask:0xf bank_mask:0xf
  s_nop 1
  v_add_f32_dpp v10, v10, v10 row_ror:4 row_mask:0xf bank_mask:0xf
  s_nop 1
  v_add_f32_dpp v10, v10, v10 row_ror:2 row_mask:0xf bank_mask:0xf
  s_nop 1
  v_add_f32_dpp v10, v10, v10 row_ror:1 row_mask:0xf bank_mask:0xf
  v_mov_b32 v9, v10
  s_nop 1
  v_permlane16_swap_b32 v9, v10
  v_add_f32 v10, v10, v9
  v_mov_b32 v9, v10
  s_nop 1
  v_permlane32_swap_b32 v9, v10
  v_add_f32 v10, v10, v9
  v_mul_f32 v10, 0x3b000000, v10
  v_cvt_pk_bf16_f32 v8, 0, v8
  v_cvt_pk_bf16_f32 v10, 0, v10
  v_add_f32 v10, 0x3727c5ac, v10
  v_cvt_pk_bf16_f32 v10, 0, v10
  v_sqrt_f32 v10, v10
  v_sub_f32 v80, v112, v8
  v_sub_f32 v81, v113, v8
  v_sub_f32 v82, v114, v8
  v_sub_f32 v83, v115, v8
  v_sub_f32 v84, v116, v8
  v_sub_f32 v85, v117, v8
  v_sub_f32 v86, v118, v8
  v_sub_f32 v87, v119, v8
  v_cvt_pk_bf16_f32 v10, 0, v10
  v_cvt_pk_bf16_f32 v80, 0, v80
  v_cvt_pk_bf16_f32 v81, 0, v81
  v_cvt_pk_bf16_f32 v82, 0, v82
  v_cvt_pk_bf16_f32 v83, 0, v83
  v_cvt_pk_bf16_f32 v84, 0, v84
  v_cvt_pk_bf16_f32 v85, 0, v85
  v_cvt_pk_bf16_f32 v86, 0, v86
  v_cvt_pk_bf16_f32 v87, 0, v87
  v_rcp_f32 v10, v10
  s_nop 0
  v_mul_f32 v80, v80, v10
  v_mul_f32 v81, v81, v10
  v_mul_f32 v82, v82, v10
  v_mul_f32 v83, v83, v10
  v_mul_f32 v84, v84, v10
  v_mul_f32 v85, v85, v10
  v_mul_f32 v86, v86, v10
  v_mul_f32 v87, v87, v10
  v_cvt_pk_bf16_f32 v80, 0, v80
  v_cvt_pk_bf16_f32 v81, 0, v81
  v_cvt_pk_bf16_f32 v82, 0, v82
  v_cvt_pk_bf16_f32 v83, 0, v83
  v_cvt_pk_bf16_f32 v84, 0, v84
  v_cvt_pk_bf16_f32 v85, 0, v85
  v_cvt_pk_bf16_f32 v86, 0, v86
  v_cvt_pk_bf16_f32 v87, 0, v87
  v_lshrrev_b32 v2, 1, v1
  v_lshlrev_b32 v2, 7, v2
  v_and_b32 v3, 1, v1
  v_lshl_add_u32 v2, v3, 5, v2
  v_add_u32 v2, 20480, v2
  global_load_dwordx4 v[40:43], v2, s[42:43] offset:0 sc1
  global_load_dwordx4 v[44:47], v2, s[42:43] offset:16 sc1
  global_load_dwordx4 v[48:51], v2, s[42:43] offset:64 sc1
  global_load_dwordx4 v[52:55], v2, s[42:43] offset:80 sc1
  s_waitcnt vmcnt(0)
  v_lshlrev_b32 v88, 16, v40
  v_and_b32 v89, s73, v40
  v_lshlrev_b32 v90, 16, v42
  v_and_b32 v91, s73, v42
  v_lshlrev_b32 v92, 16, v44
  v_and_b32 v93, s73, v44
  v_lshlrev_b32 v94, 16, v46
  v_and_b32 v95, s73, v46
  v_lshlrev_b32 v96, 16, v48
  v_and_b32 v97, s73, v48
  v_lshlrev_b32 v98, 16, v50
  v_and_b32 v99, s73, v50
  v_lshlrev_b32 v100, 16, v52
  v_and_b32 v101, s73, v52
  v_lshlrev_b32 v102, 16, v54
  v_and_b32 v103, s73, v54
  v_add_f32 v88, 1.0, v88
  v_add_f32 v89, 1.0, v89
  v_add_f32 v90, 1.0, v90
  v_add_f32 v91, 1.0, v91
  v_add_f32 v92, 1.0, v92
  v_add_f32 v93, 1.0, v93
  v_add_f32 v94, 1.0, v94
  v_add_f32 v95, 1.0, v95
  v_add_f32 v96, 1.0, v96
  v_add_f32 v97, 1.0, v97
  v_add_f32 v98, 1.0, v98
  v_add_f32 v99, 1.0, v99
  v_add_f32 v100, 1.0, v100
  v_add_f32 v101, 1.0, v101
  v_add_f32 v102, 1.0, v102
  v_add_f32 v103, 1.0, v103
  v_cvt_pk_bf16_f32 v88, 0, v88
  v_cvt_pk_bf16_f32 v89, 0, v89
  v_cvt_pk_bf16_f32 v90, 0, v90
  v_cvt_pk_bf16_f32 v91, 0, v91
  v_cvt_pk_bf16_f32 v92, 0, v92
  v_cvt_pk_bf16_f32 v93, 0, v93
  v_cvt_pk_bf16_f32 v94, 0, v94
  v_cvt_pk_bf16_f32 v95, 0, v95
  v_cvt_pk_bf16_f32 v96, 0, v96
  v_cvt_pk_bf16_f32 v97, 0, v97
  v_cvt_pk_bf16_f32 v98, 0, v98
  v_cvt_pk_bf16_f32 v99, 0, v99
  v_cvt_pk_bf16_f32 v100, 0, v100
  v_cvt_pk_bf16_f32 v101, 0, v101
  v_cvt_pk_bf16_f32 v102, 0, v102
  v_cvt_pk_bf16_f32 v103, 0, v103
  v_mul_f32 v72, v72, v88
  v_mul_f32 v73, v73, v89
  v_mul_f32 v74, v74, v90
  v_mul_f32 v75, v75, v91
  v_mul_f32 v76, v76, v92
  v_mul_f32 v77, v77, v93
  v_mul_f32 v78, v78, v94
  v_mul_f32 v79, v79, v95
  v_mul_f32 v80, v80, v96
  v_mul_f32 v81, v81, v97
  v_mul_f32 v82, v82, v98
  v_mul_f32 v83, v83, v99
  v_mul_f32 v84, v84, v100
  v_mul_f32 v85, v85, v101
  v_mul_f32 v86, v86, v102
  v_mul_f32 v87, v87, v103
  v_cvt_pk_bf16_f32 v72, 0, v72
  v_cvt_pk_bf16_f32 v73, 0, v73
  v_cvt_pk_bf16_f32 v74, 0, v74
  v_cvt_pk_bf16_f32 v75, 0, v75
  v_cvt_pk_bf16_f32 v76, 0, v76
  v_cvt_pk_bf16_f32 v77, 0, v77
  v_cvt_pk_bf16_f32 v78, 0, v78
  v_cvt_pk_bf16_f32 v79, 0, v79
  v_cvt_pk_bf16_f32 v80, 0, v80
  v_cvt_pk_bf16_f32 v81, 0, v81
  v_cvt_pk_bf16_f32 v82, 0, v82
  v_cvt_pk_bf16_f32 v83, 0, v83
  v_cvt_pk_bf16_f32 v84, 0, v84
  v_cvt_pk_bf16_f32 v85, 0, v85
  v_cvt_pk_bf16_f32 v86, 0, v86
  v_cvt_pk_bf16_f32 v87, 0, v87
  v_lshrrev_b32 v2, 1, v1
  v_lshlrev_b32 v2, 7, v2
  v_and_b32 v3, 1, v1
  v_lshl_add_u32 v2, v3, 5, v2
  v_add_u32 v2, 16384, v2
  global_load_dwordx4 v[40:43], v2, s[42:43] offset:0 sc1
  global_load_dwordx4 v[44:47], v2, s[42:43] offset:16 sc1
  global_load_dwordx4 v[48:51], v2, s[42:43] offset:64 sc1
  global_load_dwordx4 v[52:55], v2, s[42:43] offset:80 sc1
  s_waitcnt vmcnt(0)
  v_lshlrev_b32 v88, 16, v40
  v_and_b32 v89, s73, v40
  v_lshlrev_b32 v90, 16, v42
  v_and_b32 v91, s73, v42
  v_lshlrev_b32 v92, 16, v44
  v_and_b32 v93, s73, v44
  v_lshlrev_b32 v94, 16, v46
  v_and_b32 v95, s73, v46
  v_lshlrev_b32 v96, 16, v48
  v_and_b32 v97, s73, v48
  v_lshlrev_b32 v98, 16, v50
  v_and_b32 v99, s73, v50
  v_lshlrev_b32 v100, 16, v52
  v_and_b32 v101, s73, v52
  v_lshlrev_b32 v102, 16, v54
  v_and_b32 v103, s73, v54
  v_add_f32 v72, v72, v88
  v_add_f32 v73, v73, v89
  v_add_f32 v74, v74, v90
  v_add_f32 v75, v75, v91
  v_add_f32 v76, v76, v92
  v_add_f32 v77, v77, v93
  v_add_f32 v78, v78, v94
  v_add_f32 v79, v79, v95
  v_add_f32 v80, v80, v96
  v_add_f32 v81, v81, v97
  v_add_f32 v82, v82, v98
  v_add_f32 v83, v83, v99
  v_add_f32 v84, v84, v100
  v_add_f32 v85, v85, v101
  v_add_f32 v86, v86, v102
  v_add_f32 v87, v87, v103
  v_cvt_pk_bf16_f32 v40, v72, v73
  v_cvt_pk_bf16_f32 v41, v74, v75
  v_cvt_pk_bf16_f32 v42, v76, v77
  v_cvt_pk_bf16_f32 v43, v78, v79
  v_cvt_pk_bf16_f32 v44, v80, v81
  v_cvt_pk_bf16_f32 v45, v82, v83
  v_cvt_pk_bf16_f32 v46, v84, v85
  v_cvt_pk_bf16_f32 v47, v86, v87
  v_add_u32 v3, 81920, v0
  ds_write_b128 v3, v[40:43] offset:0
  ds_write_b128 v3, v[44:47] offset:1024
  s_mov_b32 s44, s28
  s_mov_b32 s45, s29
  s_mov_b32 s46, 1409024
  s_mov_b32 s11, 2752
  s_mov_b32 s12, 1409024
  v_mov_b32 v4, 81920
  v_mov_b32 v5, 82944
  v_lshlrev_b32 v2, 4, v1
  s_call_b64 s[62:63], L_gv
  v_cvt_pk_bf16_f32 v120, 0, v72
  v_cvt_pk_bf16_f32 v121, 0, v73
  v_cvt_pk_bf16_f32 v122, 0, v74
  v_cvt_pk_bf16_f32 v123, 0, v75
  v_cvt_pk_bf16_f32 v124, 0, v76
  v_cvt_pk_bf16_f32 v125, 0, v77
  v_cvt_pk_bf16_f32 v126, 0, v78
  v_cvt_pk_bf16_f32 v127, 0, v79
  v_cvt_pk_bf16_f32 v128, 0, v80
  v_cvt_pk_bf16_f32 v129, 0, v81
  v_cvt_pk_bf16_f32 v130, 0, v82
  v_cvt_pk_bf16_f32 v131, 0, v83
  v_cvt_pk_bf16_f32 v132, 0, v84
  v_cvt_pk_bf16_f32 v133, 0, v85
  v_cvt_pk_bf16_f32 v134, 0, v86
  v_cvt_pk_bf16_f32 v135, 0, v87
  s_mov_b32 s44, s30
  s_mov_b32 s45, s31
  s_mov_b32 s46, 1409024
  s_mov_b32 s11, 2752
  s_mov_b32 s12, 1409024
  v_mov_b32 v4, 81920
  v_mov_b32 v5, 82944
  v_lshlrev_b32 v2, 4, v1
  s_call_b64 s[62:63], L_gv
  v_mul_f32 v88, 0xbfb8aa3b, v120
  v_mul_f32 v89, 0xbfb8aa3b, v121
  v_mul_f32 v90, 0xbfb8aa3b, v122
  v_mul_f32 v91, 0xbfb8aa3b, v123
  v_exp_f32 v88, v88
  v_exp_f32 v89, v89
  v_exp_f32 v90, v90
  v_exp_f32 v91, v91
  s_nop 0
  v_add_f32 v88, 1.0, v88
  v_add_f32 v89, 1.0, v89
  v_add_f32 v90, 1.0, v90
  v_add_f32 v91, 1.0, v91
  v_rcp_f32 v88, v88
  v_rcp_f32 v89, v89
  v_rcp_f32 v90, v90
  v_rcp_f32 v91, v91
  s_nop 0
  v_mul_f32 v120, v120, v88
  v_mul_f32 v121, v121, v89
  v_mul_f32 v122, v122, v90
  v_mul_f32 v123, v123, v91
  v_mul_f32 v88, 0xbfb8aa3b, v124
  v_mul_f32 v89, 0xbfb8aa3b, v125
  v_mul_f32 v90, 0xbfb8aa3b, v126
  v_mul_f32 v91, 0xbfb8aa3b, v127
  v_exp_f32 v88, v88
  v_exp_f32 v89, v89
  v_exp_f32 v90, v90
  v_exp_f32 v91, v91
  s_nop 0
  v_add_f32 v88, 1.0, v88
  v_add_f32 v89, 1.0, v89
  v_add_f32 v90, 1.0, v90
  v_add_f32 v91, 1.0, v91
  v_rcp_f32 v88, v88
  v_rcp_f32 v89, v89
  v_rcp_f32 v90, v90
  v_rcp_f32 v91, v91
  s_nop 0
  v_mul_f32 v124, v124, v88
  v_mul_f32 v125, v125, v89
  v_mul_f32 v126, v126, v90
  v_mul_f32 v127, v127, v91
  v_mul_f32 v88, 0xbfb8aa3b, v128
  v_mul_f32 v89, 0xbfb8aa3b, v129
  v_mul_f32 v90, 0xbfb8aa3b, v130
  v_mul_f32 v91, 0xbfb8aa3b, v131
  v_exp_f32 v88, v88
  v_exp_f32 v89, v89
  v_exp_f32 v90, v90
  v_exp_f32 v91, v91
  s_nop 0
  v_add_f32 v88, 1.0, v88
  v_add_f32 v89, 1.0, v89
  v_add_f32 v90, 1.0, v90
  v_add_f32 v91, 1.0, v91
  v_rcp_f32 v88, v88
  v_rcp_f32 v89, v89
  v_rcp_f32 v90, v90
  v_rcp_f32 v91, v91
  s_nop 0
  v_mul_f32 v128, v128, v88
  v_mul_f32 v129, v129, v89
  v_mul_f32 v130, v130, v90
  v_mul_f32 v131, v131, v91
  v_mul_f32 v88, 0xbfb8aa3b, v132
  v_mul_f32 v89, 0xbfb8aa3b, v133
  v_mul_f32 v90, 0xbfb8aa3b, v134
  v_mul_f32 v91, 0xbfb8aa3b, v135
  v_exp_f32 v88, v88
  v_exp_f32 v89, v89
  v_exp_f32 v90, v90
  v_exp_f32 v91, v91
  s_nop 0
  v_add_f32 v88, 1.0, v88
  v_add_f32 v89, 1.0, v89
  v_add_f32 v90, 1.0, v90
  v_add_f32 v91, 1.0, v91
  v_rcp_f32 v88, v88
  v_rcp_f32 v89, v89
  v_rcp_f32 v90, v90
  v_rcp_f32 v91, v91
  s_nop 0
  v_mul_f32 v132, v132, v88
  v_mul_f32 v133, v133, v89
  v_mul_f32 v134, v134, v90
  v_mul_f32 v135, v135, v91
  v_cvt_pk_bf16_f32 v120, 0, v120
  v_cvt_pk_bf16_f32 v121, 0, v121
  v_cvt_pk_bf16_f32 v122, 0, v122
  v_cvt_pk_bf16_f32 v123, 0, v123
  v_cvt_pk_bf16_f32 v124, 0, v124
  v_cvt_pk_bf16_f32 v125, 0, v125
  v_cvt_pk_bf16_f32 v126, 0, v126
  v_cvt_pk_bf16_f32 v127, 0, v127
  v_cvt_pk_bf16_f32 v128, 0, v128
  v_cvt_pk_bf16_f32 v129, 0, v129
  v_cvt_pk_bf16_f32 v130, 0, v130
  v_cvt_pk_bf16_f32 v131, 0, v131
  v_cvt_pk_bf16_f32 v132, 0, v132
  v_cvt_pk_bf16_f32 v133, 0, v133
  v_cvt_pk_bf16_f32 v134, 0, v134
  v_cvt_pk_bf16_f32 v135, 0, v135
  v_cvt_pk_bf16_f32 v72, 0, v72
  v_cvt_pk_bf16_f32 v73, 0, v73
  v_cvt_pk_bf16_f32 v74, 0, v74
  v_cvt_pk_bf16_f32 v75, 0, v75
  v_cvt_pk_bf16_f32 v76, 0, v76
  v_cvt_pk_bf16_f32 v77, 0, v77
  v_cvt_pk_bf16_f32 v78, 0, v78
  v_cvt_pk_bf16_f32 v79, 0, v79
  v_cvt_pk_bf16_f32 v80, 0, v80
  v_cvt_pk_bf16_f32 v81, 0, v81
  v_cvt_pk_bf16_f32 v82, 0, v82
  v_cvt_pk_bf16_f32 v83, 0, v83
  v_cvt_pk_bf16_f32 v84, 0, v84
  v_cvt_pk_bf16_f32 v85, 0, v85
  v_cvt_pk_bf16_f32 v86, 0, v86
  v_cvt_pk_bf16_f32 v87, 0, v87
  v_mul_f32 v72, v72, v120
  v_mul_f32 v73, v73, v121
  v_mul_f32 v74, v74, v122
  v_mul_f32 v75, v75, v123
  v_mul_f32 v76, v76, v124
  v_mul_f32 v77, v77, v125
  v_mul_f32 v78, v78, v126
  v_mul_f32 v79, v79, v127
  v_mul_f32 v80, v80, v128
  v_mul_f32 v81, v81, v129
  v_mul_f32 v82, v82, v130
  v_mul_f32 v83, v83, v131
  v_mul_f32 v84, v84, v132
  v_mul_f32 v85, v85, v133
  v_mul_f32 v86, v86, v134
  v_mul_f32 v87, v87, v135
  v_cvt_pk_bf16_f32 v40, v72, v73
  v_cvt_pk_bf16_f32 v41, v74, v75
  v_cvt_pk_bf16_f32 v42, v76, v77
  v_cvt_pk_bf16_f32 v43, v78, v79
  v_cvt_pk_bf16_f32 v44, v80, v81
  v_cvt_pk_bf16_f32 v45, v82, v83
  v_cvt_pk_bf16_f32 v46, v84, v85
  v_cvt_pk_bf16_f32 v47, v86, v87
  v_add_u32 v3, 83968, v0
  ds_write_b128 v3, v[40:43] offset:0
  ds_write_b128 v3, v[44:47] offset:3072
  s_mov_b32 s44, s28
  s_mov_b32 s45, s29
  s_mov_b32 s46, 1409024
  s_mov_b32 s11, 2752
  s_mov_b32 s12, 1409024
  v_mov_b32 v4, 81920
  v_mov_b32 v5, 82944
  v_lshlrev_b32 v2, 4, v1
  v_add_u32 v2, 1024, v2
  s_call_b64 s[62:63], L_gv
  v_cvt_pk_bf16_f32 v120, 0, v72
  v_cvt_pk_bf16_f32 v121, 0, v73
  v_cvt_pk_bf16_f32 v122, 0, v74
  v_cvt_pk_bf16_f32 v123, 0, v75
  v_cvt_pk_bf16_f32 v124, 0, v76
  v_cvt_pk_bf16_f32 v125, 0, v77
  v_cvt_pk_bf16_f32 v126, 0, v78
  v_cvt_pk_bf16_f32 v127, 0, v79
  v_cvt_pk_bf16_f32 v128, 0, v80
  v_cvt_pk_bf16_f32 v129, 0, v81
  v_cvt_pk_bf16_f32 v130, 0, v82
  v_cvt_pk_bf16_f32 v131, 0, v83
  v_cvt_pk_bf16_f32 v132, 0, v84
  v_cvt_pk_bf16_f32 v133, 0, v85
  v_cvt_pk_bf16_f32 v134, 0, v86
  v_cvt_pk_bf16_f32 v135, 0, v87
  s_mov_b32 s44, s30
  s_mov_b32 s45, s31
  s_mov_b32 s46, 1409024
  s_mov_b32 s11, 2752
  s_mov_b32 s12, 1409024
  v_mov_b32 v4, 81920
  v_mov_b32 v5, 82944
  v_lshlrev_b32 v2, 4, v1
  v_add_u32 v2, 1024, v2
  s_call_b64 s[62:63], L_gv
  v_mul_f32 v88, 0xbfb8aa3b, v120
  v_mul_f32 v89, 0xbfb8aa3b, v121
  v_mul_f32 v90, 0xbfb8aa3b, v122
  v_mul_f32 v91, 0xbfb8aa3b, v123
  v_exp_f32 v88, v88
  v_exp_f32 v89, v89
  v_exp_f32 v90, v90
  v_exp_f32 v91, v91
  s_nop 0
  v_add_f32 v88, 1.0, v88
  v_add_f32 v89, 1.0, v89
  v_add_f32 v90, 1.0, v90
  v_add_f32 v91, 1.0, v91
  v_rcp_f32 v88, v88
  v_rcp_f32 v89, v89
  v_rcp_f32 v90, v90
  v_rcp_f32 v91, v91
  s_nop 0
  v_mul_f32 v120, v120, v88
  v_mul_f32 v121, v121, v89
  v_mul_f32 v122, v122, v90
  v_mul_f32 v123, v123, v91
  v_mul_f32 v88, 0xbfb8aa3b, v124
  v_mul_f32 v89, 0xbfb8aa3b, v125
  v_mul_f32 v90, 0xbfb8aa3b, v126
  v_mul_f32 v91, 0xbfb8aa3b, v127
  v_exp_f32 v88, v88
  v_exp_f32 v89, v89
  v_exp_f32 v90, v90
  v_exp_f32 v91, v91
  s_nop 0
  v_add_f32 v88, 1.0, v88
  v_add_f32 v89, 1.0, v89
  v_add_f32 v90, 1.0, v90
  v_add_f32 v91, 1.0, v91
  v_rcp_f32 v88, v88
  v_rcp_f32 v89, v89
  v_rcp_f32 v90, v90
  v_rcp_f32 v91, v91
  s_nop 0
  v_mul_f32 v124, v124, v88
  v_mul_f32 v125, v125, v89
  v_mul_f32 v126, v126, v90
  v_mul_f32 v127, v127, v91
  v_mul_f32 v88, 0xbfb8aa3b, v128
  v_mul_f32 v89, 0xbfb8aa3b, v129
  v_mul_f32 v90, 0xbfb8aa3b, v130
  v_mul_f32 v91, 0xbfb8aa3b, v131
  v_exp_f32 v88, v88
  v_exp_f32 v89, v89
  v_exp_f32 v90, v90
  v_exp_f32 v91, v91
  s_nop 0
  v_add_f32 v88, 1.0, v88
  v_add_f32 v89, 1.0, v89
  v_add_f32 v90, 1.0, v90
  v_add_f32 v91, 1.0, v91
  v_rcp_f32 v88, v88
  v_rcp_f32 v89, v89
  v_rcp_f32 v90, v90
  v_rcp_f32 v91, v91
  s_nop 0
  v_mul_f32 v128, v128, v88
  v_mul_f32 v129, v129, v89
  v_mul_f32 v130, v130, v90
  v_mul_f32 v131, v131, v91
  v_mul_f32 v88, 0xbfb8aa3b, v132
  v_mul_f32 v89, 0xbfb8aa3b, v133
  v_mul_f32 v90, 0xbfb8aa3b, v134
  v_mul_f32 v91, 0xbfb8aa3b, v135
  v_exp_f32 v88, v88
  v_exp_f32 v89, v89
  v_exp_f32 v90, v90
  v_exp_f32 v91, v91
  s_nop 0
  v_add_f32 v88, 1.0, v88
  v_add_f32 v89, 1.0, v89
  v_add_f32 v90, 1.0, v90
  v_add_f32 v91, 1.0, v91
  v_rcp_f32 v88, v88
  v_rcp_f32 v89, v89
  v_rcp_f32 v90, v90
  v_rcp_f32 v91, v91
  s_nop 0
  v_mul_f32 v132, v132, v88
  v_mul_f32 v133, v133, v89
  v_mul_f32 v134, v134, v90
  v_mul_f32 v135, v135, v91
  v_cvt_pk_bf16_f32 v120, 0, v120
  v_cvt_pk_bf16_f32 v121, 0, v121
  v_cvt_pk_bf16_f32 v122, 0, v122
  v_cvt_pk_bf16_f32 v123, 0, v123
  v_cvt_pk_bf16_f32 v124, 0, v124
  v_cvt_pk_bf16_f32 v125, 0, v125
  v_cvt_pk_bf16_f32 v126, 0, v126
  v_cvt_pk_bf16_f32 v127, 0, v127
  v_cvt_pk_bf16_f32 v128, 0, v128
  v_cvt_pk_bf16_f32 v129, 0, v129
  v_cvt_pk_bf16_f32 v130, 0, v130
  v_cvt_pk_bf16_f32 v131, 0, v131
  v_cvt_pk_bf16_f32 v132, 0, v132
  v_cvt_pk_bf16_f32 v133, 0, v133
  v_cvt_pk_bf16_f32 v134, 0, v134
  v_cvt_pk_bf16_f32 v135, 0, v135
  v_cvt_pk_bf16_f32 v72, 0, v72
  v_cvt_pk_bf16_f32 v73, 0, v73
  v_cvt_pk_bf16_f32 v74, 0, v74
  v_cvt_pk_bf16_f32 v75, 0, v75
  v_cvt_pk_bf16_f32 v76, 0, v76
  v_cvt_pk_bf16_f32 v77, 0, v77
  v_cvt_pk_bf16_f32 v78, 0, v78
  v_cvt_pk_bf16_f32 v79, 0, v79
  v_cvt_pk_bf16_f32 v80, 0, v80
  v_cvt_pk_bf16_f32 v81, 0, v81
  v_cvt_pk_bf16_f32 v82, 0, v82
  v_cvt_pk_bf16_f32 v83, 0, v83
  v_cvt_pk_bf16_f32 v84, 0, v84
  v_cvt_pk_bf16_f32 v85, 0, v85
  v_cvt_pk_bf16_f32 v86, 0, v86
  v_cvt_pk_bf16_f32 v87, 0, v87
  v_mul_f32 v72, v72, v120
  v_mul_f32 v73, v73, v121
  v_mul_f32 v74, v74, v122
  v_mul_f32 v75, v75, v123
  v_mul_f32 v76, v76, v124
  v_mul_f32 v77, v77, v125
  v_mul_f32 v78, v78, v126
  v_mul_f32 v79, v79, v127
  v_mul_f32 v80, v80, v128
  v_mul_f32 v81, v81, v129
  v_mul_f32 v82, v82, v130
  v_mul_f32 v83, v83, v131
  v_mul_f32 v84, v84, v132
  v_mul_f32 v85, v85, v133
  v_mul_f32 v86, v86, v134
  v_mul_f32 v87, v87, v135
  v_cvt_pk_bf16_f32 v40, v72, v73
  v_cvt_pk_bf16_f32 v41, v74, v75
  v_cvt_pk_bf16_f32 v42, v76, v77
  v_cvt_pk_bf16_f32 v43, v78, v79
  v_cvt_pk_bf16_f32 v44, v80, v81
  v_cvt_pk_bf16_f32 v45, v82, v83
  v_cvt_pk_bf16_f32 v46, v84, v85
  v_cvt_pk_bf16_f32 v47, v86, v87
  v_add_u32 v3, 84992, v0
  ds_write_b128 v3, v[40:43] offset:0
  ds_write_b128 v3, v[44:47] offset:3072
  s_mov_b32 s44, s28
  s_mov_b32 s45, s29
  s_mov_b32 s46, 1409024
  s_mov_b32 s11, 2752
  s_mov_b32 s12, 1409024
  v_mov_b32 v4, 81920
  v_mov_b32 v5, 82944
  v_lshlrev_b32 v2, 4, v1
  v_add_u32 v2, 2048, v2
  s_call_b64 s[62:63], L_gv
  v_cvt_pk_bf16_f32 v120, 0, v72
  v_cvt_pk_bf16_f32 v121, 0, v73
  v_cvt_pk_bf16_f32 v122, 0, v74
  v_cvt_pk_bf16_f32 v123, 0, v75
  v_cvt_pk_bf16_f32 v124, 0, v76
  v_cvt_pk_bf16_f32 v125, 0, v77
  v_cvt_pk_bf16_f32 v126, 0, v78
  v_cvt_pk_bf16_f32 v127, 0, v79
  v_cvt_pk_bf16_f32 v128, 0, v80
  v_cvt_pk_bf16_f32 v129, 0, v81
  v_cvt_pk_bf16_f32 v130, 0, v82
  v_cvt_pk_bf16_f32 v131, 0, v83
  v_cvt_pk_bf16_f32 v132, 0, v84
  v_cvt_pk_bf16_f32 v133, 0, v85
  v_cvt_pk_bf16_f32 v134, 0, v86
  v_cvt_pk_bf16_f32 v135, 0, v87
  s_mov_b32 s44, s30
  s_mov_b32 s45, s31
  s_mov_b32 s46, 1409024
  s_mov_b32 s11, 2752
  s_mov_b32 s12, 1409024
  v_mov_b32 v4, 81920
  v_mov_b32 v5, 82944
  v_lshlrev_b32 v2, 4, v1
  v_add_u32 v2, 2048, v2
  s_call_b64 s[62:63], L_gv
  v_mul_f32 v88, 0xbfb8aa3b, v120
  v_mul_f32 v89, 0xbfb8aa3b, v121
  v_mul_f32 v90, 0xbfb8aa3b, v122
  v_mul_f32 v91, 0xbfb8aa3b, v123
  v_exp_f32 v88, v88
  v_exp_f32 v89, v89
  v_exp_f32 v90, v90
  v_exp_f32 v91, v91
  s_nop 0
  v_add_f32 v88, 1.0, v88
  v_add_f32 v89, 1.0, v89
  v_add_f32 v90, 1.0, v90
  v_add_f32 v91, 1.0, v91
  v_rcp_f32 v88, v88
  v_rcp_f32 v89, v89
  v_rcp_f32 v90, v90
  v_rcp_f32 v91, v91
  s_nop 0
  v_mul_f32 v120, v120, v88
  v_mul_f32 v121, v121, v89
  v_mul_f32 v122, v122, v90
  v_mul_f32 v123, v123, v91
  v_mul_f32 v88, 0xbfb8aa3b, v124
  v_mul_f32 v89, 0xbfb8aa3b, v125
  v_mul_f32 v90, 0xbfb8aa3b, v126
  v_mul_f32 v91, 0xbfb8aa3b, v127
  v_exp_f32 v88, v88
  v_exp_f32 v89, v89
  v_exp_f32 v90, v90
  v_exp_f32 v91, v91
  s_nop 0
  v_add_f32 v88, 1.0, v88
  v_add_f32 v89, 1.0, v89
  v_add_f32 v90, 1.0, v90
  v_add_f32 v91, 1.0, v91
  v_rcp_f32 v88, v88
  v_rcp_f32 v89, v89
  v_rcp_f32 v90, v90
  v_rcp_f32 v91, v91
  s_nop 0
  v_mul_f32 v124, v124, v88
  v_mul_f32 v125, v125, v89
  v_mul_f32 v126, v126, v90
  v_mul_f32 v127, v127, v91
  v_mul_f32 v88, 0xbfb8aa3b, v128
  v_mul_f32 v89, 0xbfb8aa3b, v129
  v_mul_f32 v90, 0xbfb8aa3b, v130
  v_mul_f32 v91, 0xbfb8aa3b, v131
  v_exp_f32 v88, v88
  v_exp_f32 v89, v89
  v_exp_f32 v90, v90
  v_exp_f32 v91, v91
  s_nop 0
  v_add_f32 v88, 1.0, v88
  v_add_f32 v89, 1.0, v89
  v_add_f32 v90, 1.0, v90
  v_add_f32 v91, 1.0, v91
  v_rcp_f32 v88, v88
  v_rcp_f32 v89, v89
  v_rcp_f32 v90, v90
  v_rcp_f32 v91, v91
  s_nop 0
  v_mul_f32 v128, v128, v88
  v_mul_f32 v129, v129, v89
  v_mul_f32 v130, v130, v90
  v_mul_f32 v131, v131, v91
  v_mul_f32 v88, 0xbfb8aa3b, v132
  v_mul_f32 v89, 0xbfb8aa3b, v133
  v_mul_f32 v90, 0xbfb8aa3b, v134
  v_mul_f32 v91, 0xbfb8aa3b, v135
  v_exp_f32 v88, v88
  v_exp_f32 v89, v89
  v_exp_f32 v90, v90
  v_exp_f32 v91, v91
  s_nop 0
  v_add_f32 v88, 1.0, v88
  v_add_f32 v89, 1.0, v89
  v_add_f32 v90, 1.0, v90
  v_add_f32 v91, 1.0, v91
  v_rcp_f32 v88, v88
  v_rcp_f32 v89, v89
  v_rcp_f32 v90, v90
  v_rcp_f32 v91, v91
  s_nop 0
  v_mul_f32 v132, v132, v88
  v_mul_f32 v133, v133, v89
  v_mul_f32 v134, v134, v90
  v_mul_f32 v135, v135, v91
  v_cvt_pk_bf16_f32 v120, 0, v120
  v_cvt_pk_bf16_f32 v121, 0, v121
  v_cvt_pk_bf16_f32 v122, 0, v122
  v_cvt_pk_bf16_f32 v123, 0, v123
  v_cvt_pk_bf16_f32 v124, 0, v124
  v_cvt_pk_bf16_f32 v125, 0, v125
  v_cvt_pk_bf16_f32 v126, 0, v126
  v_cvt_pk_bf16_f32 v127, 0, v127
  v_cvt_pk_bf16_f32 v128, 0, v128
  v_cvt_pk_bf16_f32 v129, 0, v129
  v_cvt_pk_bf16_f32 v130, 0, v130
  v_cvt_pk_bf16_f32 v131, 0, v131
  v_cvt_pk_bf16_f32 v132, 0, v132
  v_cvt_pk_bf16_f32 v133, 0, v133
  v_cvt_pk_bf16_f32 v134, 0, v134
  v_cvt_pk_bf16_f32 v135, 0, v135
  v_cvt_pk_bf16_f32 v72, 0, v72
  v_cvt_pk_bf16_f32 v73, 0, v73
  v_cvt_pk_bf16_f32 v74, 0, v74
  v_cvt_pk_bf16_f32 v75, 0, v75
  v_cvt_pk_bf16_f32 v76, 0, v76
  v_cvt_pk_bf16_f32 v77, 0, v77
  v_cvt_pk_bf16_f32 v78, 0, v78
  v_cvt_pk_bf16_f32 v79, 0, v79
  v_cvt_pk_bf16_f32 v80, 0, v80
  v_cvt_pk_bf16_f32 v81, 0, v81
  v_cvt_pk_bf16_f32 v82, 0, v82
  v_cvt_pk_bf16_f32 v83, 0, v83
  v_cvt_pk_bf16_f32 v84, 0, v84
  v_cvt_pk_bf16_f32 v85, 0, v85
  v_cvt_pk_bf16_f32 v86, 0, v86
  v_cvt_pk_bf16_f32 v87, 0, v87
  v_mul_f32 v72, v72, v120
  v_mul_f32 v73, v73, v121
  v_mul_f32 v74, v74, v122
  v_mul_f32 v75, v75, v123
  v_mul_f32 v76, v76, v124
  v_mul_f32 v77, v77, v125
  v_mul_f32 v78, v78, v126
  v_mul_f32 v79, v79, v127
  v_mul_f32 v80, v80, v128
  v_mul_f32 v81, v81, v129
  v_mul_f32 v82, v82, v130
  v_mul_f32 v83, v83, v131
  v_mul_f32 v84, v84, v132
  v_mul_f32 v85, v85, v133
  v_mul_f32 v86, v86, v134
  v_mul_f32 v87, v87, v135
  v_cvt_pk_bf16_f32 v40, v72, v73
  v_cvt_pk_bf16_f32 v41, v74, v75
  v_cvt_pk_bf16_f32 v42, v76, v77
  v_cvt_pk_bf16_f32 v43, v78, v79
  v_cvt_pk_bf16_f32 v44, v80, v81
  v_cvt_pk_bf16_f32 v45, v82, v83
  v_cvt_pk_bf16_f32 v46, v84, v85
  v_cvt_pk_bf16_f32 v47, v86, v87
  v_add_u32 v3, 86016, v0
  ds_write_b128 v3, v[40:43] offset:0
  ds_write_b128 v3, v[44:47] offset:3072
  s_mov_b32 s44, s32
  s_mov_b32 s45, s33
  s_mov_b32 s46, 1409024
  s_mov_b32 s11, 1024
  s_mov_b32 s12, 1409024
  v_mov_b32 v4, 83968
  v_mov_b32 v5, 87040
  v_lshlrev_b32 v2, 4, v1
  s_call_b64 s[62:63], L_gv
  v_lshrrev_b32 v2, 1, v1
  v_lshlrev_b32 v2, 7, v2
  v_and_b32 v3, 1, v1
  v_lshl_add_u32 v2, v3, 5, v2
  v_add_u32 v2, 24576, v2
  global_load_dwordx4 v[40:43], v2, s[42:43] offset:0 sc1
  global_load_dwordx4 v[44:47], v2, s[42:43] offset:16 sc1
  global_load_dwordx4 v[48:51], v2, s[42:43] offset:64 sc1
  global_load_dwordx4 v[52:55], v2, s[42:43] offset:80 sc1
  s_waitcnt vmcnt(0)
  v_lshlrev_b32 v88, 16, v40
  v_and_b32 v89, s73, v40
  v_lshlrev_b32 v90, 16, v42
  v_and_b32 v91, s73, v42
  v_lshlrev_b32 v92, 16, v44
  v_and_b32 v93, s73, v44
  v_lshlrev_b32 v94, 16, v46
  v_and_b32 v95, s73, v46
  v_lshlrev_b32 v96, 16, v48
  v_and_b32 v97, s73, v48
  v_lshlrev_b32 v98, 16, v50
  v_and_b32 v99, s73, v50
  v_lshlrev_b32 v100, 16, v52
  v_and_b32 v101, s73, v52
  v_lshlrev_b32 v102, 16, v54
  v_and_b32 v103, s73, v54
  v_cvt_pk_bf16_f32 v72, 0, v72
  v_cvt_pk_bf16_f32 v73, 0, v73
  v_cvt_pk_bf16_f32 v74, 0, v74
  v_cvt_pk_bf16_f32 v75, 0, v75
  v_cvt_pk_bf16_f32 v76, 0, v76
  v_cvt_pk_bf16_f32 v77, 0, v77
  v_cvt_pk_bf16_f32 v78, 0, v78
  v_cvt_pk_bf16_f32 v79, 0, v79
  v_cvt_pk_bf16_f32 v80, 0, v80
  v_cvt_pk_bf16_f32 v81, 0, v81
  v_cvt_pk_bf16_f32 v82, 0, v82
  v_cvt_pk_bf16_f32 v83, 0, v83
  v_cvt_pk_bf16_f32 v84, 0, v84
  v_cvt_pk_bf16_f32 v85, 0, v85
  v_cvt_pk_bf16_f32 v86, 0, v86
  v_cvt_pk_bf16_f32 v87, 0, v87
  v_mul_f32 v72, v72, v88
  v_mul_f32 v73, v73, v89
  v_mul_f32 v74, v74, v90
  v_mul_f32 v75, v75, v91
  v_mul_f32 v76, v76, v92
  v_mul_f32 v77, v77, v93
  v_mul_f32 v78, v78, v94
  v_mul_f32 v79, v79, v95
  v_mul_f32 v80, v80, v96
  v_mul_f32 v81, v81, v97
  v_mul_f32 v82, v82, v98
  v_mul_f32 v83, v83, v99
  v_mul_f32 v84, v84, v100
  v_mul_f32 v85, v85, v101
  v_mul_f32 v86, v86, v102
  v_mul_f32 v87, v87, v103
  v_cvt_pk_bf16_f32 v72, 0, v72
  v_cvt_pk_bf16_f32 v73, 0, v73
  v_cvt_pk_bf16_f32 v74, 0, v74
  v_cvt_pk_bf16_f32 v75, 0, v75
  v_cvt_pk_bf16_f32 v76, 0, v76
  v_cvt_pk_bf16_f32 v77, 0, v77
  v_cvt_pk_bf16_f32 v78, 0, v78
  v_cvt_pk_bf16_f32 v79, 0, v79
  v_cvt_pk_bf16_f32 v80, 0, v80
  v_cvt_pk_bf16_f32 v81, 0, v81
  v_cvt_pk_bf16_f32 v82, 0, v82
  v_cvt_pk_bf16_f32 v83, 0, v83
  v_cvt_pk_bf16_f32 v84, 0, v84
  v_cvt_pk_bf16_f32 v85, 0, v85
  v_cvt_pk_bf16_f32 v86, 0, v86
  v_cvt_pk_bf16_f32 v87, 0, v87
  v_add_f32 v104, v104, v72
  v_add_f32 v105, v105, v73
  v_add_f32 v106, v106, v74
  v_add_f32 v107, v107, v75
  v_add_f32 v108, v108, v76
  v_add_f32 v109, v109, v77
  v_add_f32 v110, v110, v78
  v_add_f32 v111, v111, v79
  v_add_f32 v112, v112, v80
  v_add_f32 v113, v113, v81
  v_add_f32 v114, v114, v82
  v_add_f32 v115, v115, v83
  v_add_f32 v116, v116, v84
  v_add_f32 v117, v117, v85
  v_add_f32 v118, v118, v86
  v_add_f32 v119, v119, v87
  v_cvt_pk_bf16_f32 v104, 0, v104
  v_cvt_pk_bf16_f32 v105, 0, v105
  v_cvt_pk_bf16_f32 v106, 0, v106
  v_cvt_pk_bf16_f32 v107, 0, v107
  v_cvt_pk_bf16_f32 v108, 0, v108
  v_cvt_pk_bf16_f32 v109, 0, v109
  v_cvt_pk_bf16_f32 v110, 0, v110
  v_cvt_pk_bf16_f32 v111, 0, v111
  v_cvt_pk_bf16_f32 v112, 0, v112
  v_cvt_pk_bf16_f32 v113, 0, v113
  v_cvt_pk_bf16_f32 v114, 0, v114
  v_cvt_pk_bf16_f32 v115, 0, v115
  v_cvt_pk_bf16_f32 v116, 0, v116
  v_cvt_pk_bf16_f32 v117, 0, v117
  v_cvt_pk_bf16_f32 v118, 0, v118
  v_cvt_pk_bf16_f32 v119, 0, v119
  v_cvt_pk_bf16_f32 v40, v104, v105
  v_cvt_pk_bf16_f32 v41, v106, v107
  v_cvt_pk_bf16_f32 v42, v108, v109
  v_cvt_pk_bf16_f32 v43, v110, v111
  v_cvt_pk_bf16_f32 v44, v112, v113
  v_cvt_pk_bf16_f32 v45, v114, v115
  v_cvt_pk_bf16_f32 v46, v116, v117
  v_cvt_pk_bf16_f32 v47, v118, v119
  global_store_dwordx4 v0, v[40:43], s[38:39] offset:0 sc1
  global_store_dwordx4 v0, v[44:47], s[38:39] offset:1024 sc1
  s_endpgm
L_gv:
  v_mov_b32 v72, 0
  v_mov_b32 v73, 0
  v_mov_b32 v74, 0
  v_mov_b32 v75, 0
  v_mov_b32 v76, 0
  v_mov_b32 v77, 0
  v_mov_b32 v78, 0
  v_mov_b32 v79, 0
  v_mov_b32 v80, 0
  v_mov_b32 v81, 0
  v_mov_b32 v82, 0
  v_mov_b32 v83, 0
  v_mov_b32 v84, 0
  v_mov_b32 v85, 0
  v_mov_b32 v86, 0
  v_mov_b32 v87, 0
  s_mov_b32 s10, 0
L_gvl:
  buffer_load_dwordx4 v[40:43], v2, s[44:47], s10 offen
  s_add_u32 s10, s10, s11
  buffer_load_dwordx4 v[44:47], v2, s[44:47], s10 offen
  s_add_u32 s10, s10, s11
  buffer_load_dwordx4 v[48:51], v2, s[44:47], s10 offen
  s_add_u32 s10, s10, s11
  buffer_load_dwordx4 v[52:55], v2, s[44:47], s10 offen
  s_add_u32 s10, s10, s11
  buffer_load_dwordx4 v[56:59], v2, s[44:47], s10 offen
  s_add_u32 s10, s10, s11
  buffer_load_dwordx4 v[60:63], v2, s[44:47], s10 offen
  s_add_u32 s10, s10, s11
  buffer_load_dwordx4 v[64:67], v2, s[44:47], s10 offen
  s_add_u32 s10, s10, s11
  buffer_load_dwordx4 v[68:71], v2, s[44:47], s10 offen
  s_add_u32 s10, s10, s11
  ds_read_b128 v[88:91], v4
  ds_read_b128 v[92:95], v5
  v_add_u32 v4, 16, v4
  v_add_u32 v5, 16, v5
  s_waitcnt lgkmcnt(0)
  v_and_b32 v8, 0xffff, v88
  v_lshlrev_b32 v9, 16, v88
  v_and_b32 v10, 0xffff, v92
  v_lshlrev_b32 v11, 16, v92
  s_waitcnt vmcnt(7)
  v_dot2c_f32_bf16 v72, v8, v40
  v_dot2c_f32_bf16 v73, v9, v40
  v_dot2c_f32_bf16 v74, v8, v41
  v_dot2c_f32_bf16 v75, v9, v41
  v_dot2c_f32_bf16 v76, v8, v42
  v_dot2c_f32_bf16 v77, v9, v42
  v_dot2c_f32_bf16 v78, v8, v43
  v_dot2c_f32_bf16 v79, v9, v43
  v_dot2c_f32_bf16 v80, v10, v40
  v_dot2c_f32_bf16 v81, v11, v40
  v_dot2c_f32_bf16 v82, v10, v41
  v_dot2c_f32_bf16 v83, v11, v41
  v_dot2c_f32_bf16 v84, v10, v42
  v_dot2c_f32_bf16 v85, v11, v42
  v_dot2c_f32_bf16 v86, v10, v43
  v_dot2c_f32_bf16 v87, v11, v43
  v_lshrrev_b32 v8, 16, v88
  v_and_b32 v9, s73, v88
  v_lshrrev_b32 v10, 16, v92
  v_and_b32 v11, s73, v92
  s_waitcnt vmcnt(6)
  v_dot2c_f32_bf16 v72, v8, v44
  v_dot2c_f32_bf16 v73, v9, v44
  v_dot2c_f32_bf16 v74, v8, v45
  v_dot2c_f32_bf16 v75, v9, v45
  v_dot2c_f32_bf16 v76, v8, v46
  v_dot2c_f32_bf16 v77, v9, v46
  v_dot2c_f32_bf16 v78, v8, v47
  v_dot2c_f32_bf16 v79, v9, v47
  v_dot2c_f32_bf16 v80, v10, v44
  v_dot2c_f32_bf16 v81, v11, v44
  v_dot2c_f32_bf16 v82, v10, v45
  v_dot2c_f32_bf16 v83, v11, v45
  v_dot2c_f32_bf16 v84, v10, v46
  v_dot2c_f32_bf16 v85, v11, v46
  v_dot2c_f32_bf16 v86, v10, v47
  v_dot2c_f32_bf16 v87, v11, v47
  v_and_b32 v8, 0xffff, v89
  v_lshlrev_b32 v9, 16, v89
  v_and_b32 v10, 0xffff, v93
  v_lshlrev_b32 v11, 16, v93
  s_waitcnt vmcnt(5)
  v_dot2c_f32_bf16 v72, v8, v48
  v_dot2c_f32_bf16 v73, v9, v48
  v_dot2c_f32_bf16 v74, v8, v49
  v_dot2c_f32_bf16 v75, v9, v49
  v_dot2c_f32_bf16 v76, v8, v50
  v_dot2c_f32_bf16 v77, v9, v50
  v_dot2c_f32_bf16 v78, v8, v51
  v_dot2c_f32_bf16 v79, v9, v51
  v_dot2c_f32_bf16 v80, v10, v48
  v_dot2c_f32_bf16 v81, v11, v48
  v_dot2c_f32_bf16 v82, v10, v49
  v_dot2c_f32_bf16 v83, v11, v49
  v_dot2c_f32_bf16 v84, v10, v50
  v_dot2c_f32_bf16 v85, v11, v50
  v_dot2c_f32_bf16 v86, v10, v51
  v_dot2c_f32_bf16 v87, v11, v51
  v_lshrrev_b32 v8, 16, v89
  v_and_b32 v9, s73, v89
  v_lshrrev_b32 v10, 16, v93
  v_and_b32 v11, s73, v93
  s_waitcnt vmcnt(4)
  v_dot2c_f32_bf16 v72, v8, v52
  v_dot2c_f32_bf16 v73, v9, v52
  v_dot2c_f32_bf16 v74, v8, v53
  v_dot2c_f32_bf16 v75, v9, v53
  v_dot2c_f32_bf16 v76, v8, v54
  v_dot2c_f32_bf16 v77, v9, v54
  v_dot2c_f32_bf16 v78, v8, v55
  v_dot2c_f32_bf16 v79, v9, v55
  v_dot2c_f32_bf16 v80, v10, v52
  v_dot2c_f32_bf16 v81, v11, v52
  v_dot2c_f32_bf16 v82, v10, v53
  v_dot2c_f32_bf16 v83, v11, v53
  v_dot2c_f32_bf16 v84, v10, v54
  v_dot2c_f32_bf16 v85, v11, v54
  v_dot2c_f32_bf16 v86, v10, v55
  v_dot2c_f32_bf16 v87, v11, v55
  v_and_b32 v8, 0xffff, v90
  v_lshlrev_b32 v9, 16, v90
  v_and_b32 v10, 0xffff, v94
  v_lshlrev_b32 v11, 16, v94
  s_waitcnt vmcnt(3)
  v_dot2c_f32_bf16 v72, v8, v56
  v_dot2c_f32_bf16 v73, v9, v56
  v_dot2c_f32_bf16 v74, v8, v57
  v_dot2c_f32_bf16 v75, v9, v57
  v_dot2c_f32_bf16 v76, v8, v58
  v_dot2c_f32_bf16 v77, v9, v58
  v_dot2c_f32_bf16 v78, v8, v59
  v_dot2c_f32_bf16 v79, v9, v59
  v_dot2c_f32_bf16 v80, v10, v56
  v_dot2c_f32_bf16 v81, v11, v56
  v_dot2c_f32_bf16 v82, v10, v57
  v_dot2c_f32_bf16 v83, v11, v57
  v_dot2c_f32_bf16 v84, v10, v58
  v_dot2c_f32_bf16 v85, v11, v58
  v_dot2c_f32_bf16 v86, v10, v59
  v_dot2c_f32_bf16 v87, v11, v59
  v_lshrrev_b32 v8, 16, v90
  v_and_b32 v9, s73, v90
  v_lshrrev_b32 v10, 16, v94
  v_and_b32 v11, s73, v94
  s_waitcnt vmcnt(2)
  v_dot2c_f32_bf16 v72, v8, v60
  v_dot2c_f32_bf16 v73, v9, v60
  v_dot2c_f32_bf16 v74, v8, v61
  v_dot2c_f32_bf16 v75, v9, v61
  v_dot2c_f32_bf16 v76, v8, v62
  v_dot2c_f32_bf16 v77, v9, v62
  v_dot2c_f32_bf16 v78, v8, v63
  v_dot2c_f32_bf16 v79, v9, v63
  v_dot2c_f32_bf16 v80, v10, v60
  v_dot2c_f32_bf16 v81, v11, v60
  v_dot2c_f32_bf16 v82, v10, v61
  v_dot2c_f32_bf16 v83, v11, v61
  v_dot2c_f32_bf16 v84, v10, v62
  v_dot2c_f32_bf16 v85, v11, v62
  v_dot2c_f32_bf16 v86, v10, v63
  v_dot2c_f32_bf16 v87, v11, v63
  v_and_b32 v8, 0xffff, v91
  v_lshlrev_b32 v9, 16, v91
  v_and_b32 v10, 0xffff, v95
  v_lshlrev_b32 v11, 16, v95
  s_waitcnt vmcnt(1)
  v_dot2c_f32_bf16 v72, v8, v64
  v_dot2c_f32_bf16 v73, v9, v64
  v_dot2c_f32_bf16 v74, v8, v65
  v_dot2c_f32_bf16 v75, v9, v65
  v_dot2c_f32_bf16 v76, v8, v66
  v_dot2c_f32_bf16 v77, v9, v66
  v_dot2c_f32_bf16 v78, v8, v67
  v_dot2c_f32_bf16 v79, v9, v67
  v_dot2c_f32_bf16 v80, v10, v64
  v_dot2c_f32_bf16 v81, v11, v64
  v_dot2c_f32_bf16 v82, v10, v65
  v_dot2c_f32_bf16 v83, v11, v65
  v_dot2c_f32_bf16 v84, v10, v66
  v_dot2c_f32_bf16 v85, v11, v66
  v_dot2c_f32_bf16 v86, v10, v67
  v_dot2c_f32_bf16 v87, v11, v67
  v_lshrrev_b32 v8, 16, v91
  v_and_b32 v9, s73, v91
  v_lshrrev_b32 v10, 16, v95
  v_and_b32 v11, s73, v95
  s_waitcnt vmcnt(0)
  v_dot2c_f32_bf16 v72, v8, v68
  v_dot2c_f32_bf16 v73, v9, v68
  v_dot2c_f32_bf16 v74, v8, v69
  v_dot2c_f32_bf16 v75, v9, v69
  v_dot2c_f32_bf16 v76, v8, v70
  v_dot2c_f32_bf16 v77, v9, v70
  v_dot2c_f32_bf16 v78, v8, v71
  v_dot2c_f32_bf16 v79, v9, v71
  v_dot2c_f32_bf16 v80, v10, v68
  v_dot2c_f32_bf16 v81, v11, v68
  v_dot2c_f32_bf16 v82, v10, v69
  v_dot2c_f32_bf16 v83, v11, v69
  v_dot2c_f32_bf16 v84, v10, v70
  v_dot2c_f32_bf16 v85, v11, v70
  v_dot2c_f32_bf16 v86, v10, v71
  v_dot2c_f32_bf16 v87, v11, v71
  s_cmp_lt_u32 s10, s12
  s_cbranch_scc1 L_gvl
  s_nop 1
  s_setpc_b64 s[62:63]
L_ks:
  s_waitcnt lgkmcnt(0)
  v_readfirstlane_b32 s78, v20
  v_readfirstlane_b32 s79, v21
  s_cmp_eq_u32 s32, s57
  s_cselect_b32 s34, s58, s34
  s_cmp_ge_u32 s39, 4
  s_cbranch_scc1 L_ks2
  s_call_b64 s[100:101], L_work
L_ks2:
  s_add_u32 s32, s32, 1
  s_lshl3_add_u32 s68, s35, 1024
  s_sub_i32 s68, s68, s78
  s_sub_u32 s35, s35, 1
  s_mul_i32 s68, s68, 14
  s_add_i32 s68, s68, s34
  s_max_i32 s68, s68, 384
  s_min_i32 s68, s68, s79
  s_lshl_b32 s69, s68, 24
  s_lshr_b32 s68, s68, 8
  s_add_u32 s33, s33, s69
  s_addc_u32 s41, s68, 0
L_wait:
  s_waitcnt vmcnt(4)
  s_cmp_ge_u32 s41, 5
  s_cbranch_scc1 L_ret
  s_waitcnt vmcnt(3)
  s_cmp_ge_u32 s41, 4
  s_cbranch_scc1 L_ret
  s_waitcnt vmcnt(2)
  s_cmp_ge_u32 s41, 3
  s_cbranch_scc1 L_ret
  s_waitcnt vmcnt(1)
  s_cmp_ge_u32 s41, 2
  s_cbranch_scc1 L_ret
  s_waitcnt vmcnt(0)
L_ret:
  s_mov_b64 exec, 1
  ds_dec_u32 v23, v39 offset:6688
  ds_read_b64 v[20:21], v23 offset:6688
  s_mov_b64 exec, -1
  s_cmp_lg_u32 s32, s32
  s_setpc_b64 s[62:63]
L_vs:
  s_waitcnt lgkmcnt(0)
  v_readfirstlane_b32 s78, v20
  v_readfirstlane_b32 s79, v21
  s_cmp_lg_u32 s61, 0
  s_cbranch_scc1 L_vs1
  s_cmp_gt_u32 s41, s32
  s_cbranch_scc1 L_ks2
L_x1:
  v_dot2_f32_bf16 v8, v136, v4, 0
  v_dot2_f32_bf16 v9, v140, v4, 0
  v_dot2_f32_bf16 v10, v144, v4, 0
  v_dot2_f32_bf16 v11, v148, v4, 0
  v_dot2_f32_bf16 v12, v152, v4, 0
  v_dot2_f32_bf16 v13, v156, v4, 0
  v_dot2_f32_bf16 v14, v160, v4, 0
  v_dot2_f32_bf16 v15, v164, v4, 0
  v_dot2_f32_bf16 v8, v137, v5, v8
  v_dot2_f32_bf16 v9, v141, v5, v9
  v_dot2_f32_bf16 v10, v145, v5, v10
  v_dot2_f32_bf16 v11, v149, v5, v11
  v_dot2_f32_bf16 v12, v153, v5, v12
  v_dot2_f32_bf16 v13, v157, v5, v13
  v_dot2_f32_bf16 v14, v161, v5, v14
  v_dot2_f32_bf16 v15, v165, v5, v15
  v_dot2_f32_bf16 v8, v138, v6, v8
  v_dot2_f32_bf16 v9, v142, v6, v9
  v_dot2_f32_bf16 v10, v146, v6, v10
  v_dot2_f32_bf16 v11, v150, v6, v11
  v_dot2_f32_bf16 v12, v154, v6, v12
  v_dot2_f32_bf16 v13, v158, v6, v13
  v_dot2_f32_bf16 v14, v162, v6, v14
  v_dot2_f32_bf16 v15, v166, v6, v15
  v_dot2_f32_bf16 v8, v139, v7, v8
  v_dot2_f32_bf16 v9, v143, v7, v9
  v_dot2_f32_bf16 v10, v147, v7, v10
  v_dot2_f32_bf16 v11, v151, v7, v11
  v_dot2_f32_bf16 v12, v155, v7, v12
  v_dot2_f32_bf16 v13, v159, v7, v13
  v_dot2_f32_bf16 v14, v163, v7, v14
  v_dot2_f32_bf16 v15, v167, v7, v15
  v_add_f32_dpp v8, v8, v8 row_ror:8 row_mask:0xf bank_mask:0x3
  v_add_f32_dpp v8, v9, v9 row_ror:8 row_mask:0xf bank_mask:0xc
  v_add_f32_dpp v10, v10, v10 row_ror:8 row_mask:0xf bank_mask:0x3
  v_add_f32_dpp v10, v11, v11 row_ror:8 row_mask:0xf bank_mask:0xc
  v_add_f32_dpp v12, v12, v12 row_ror:8 row_mask:0xf bank_mask:0x3
  v_add_f32_dpp v12, v13, v13 row_ror:8 row_mask:0xf bank_mask:0xc
  v_add_f32_dpp v14, v14, v14 row_ror:8 row_mask:0xf bank_mask:0x3
  v_add_f32_dpp v14, v15, v15 row_ror:8 row_mask:0xf bank_mask:0xc
  v_add_f32_dpp v18, v8, v8 row_shl:4 row_mask:0xf bank_mask:0x5
  v_add_f32_dpp v18, v10, v10 row_shr:4 row_mask:0xf bank_mask:0xa
  v_add_f32_dpp v19, v12, v12 row_shl:4 row_mask:0xf bank_mask:0x5
  v_add_f32_dpp v19, v14, v14 row_shr:4 row_mask:0xf bank_mask:0xa
  v_mov_b32 v3, 0
  v_mov_b32 v20, 64
  v_add_f32_dpp v16, v16, v16 quad_perm:[2,3,0,1] row_mask:0xf bank_mask:0xf
  v_add_f32_dpp v17, v17, v17 quad_perm:[2,3,0,1] row_mask:0xf bank_mask:0xf
  v_add_f32_dpp v18, v18, v18 quad_perm:[2,3,0,1] row_mask:0xf bank_mask:0xf
  v_add_f32_dpp v19, v19, v19 quad_perm:[2,3,0,1] row_mask:0xf bank_mask:0xf
  v_cndmask_b32 v8, v16, v17, s[52:53]
  v_cndmask_b32 v9, v18, v19, s[52:53]
  s_nop 0
  v_lshlrev_b32 v21, 3, s9
  v_add_f32_dpp v8, v8, v8 quad_perm:[1,0,3,2] row_mask:0xf bank_mask:0xf
  v_add_f32_dpp v9, v9, v9 quad_perm:[1,0,3,2] row_mask:0xf bank_mask:0xf
  v_cndmask_b32 v27, v8, v9, s[54:55]
  v_cvt_pk_bf16_f32 v27, 0, v27
  v_mul_f32 v27, 0x3db504f3, v27
  v_cvt_pk_bf16_f32 v27, 0, v27
  v_max_f32 v37, v37, v27
  s_nop 1
  v_max_f32_dpp v37, v37, v37 row_ror:8 row_mask:0xf bank_mask:0xf
  s_nop 1
  v_max_f32_dpp v37, v37, v37 row_ror:4 row_mask:0xf bank_mask:0xf
  s_nop 1
  v_max_f32_dpp v37, v37, v37 row_ror:2 row_mask:0xf bank_mask:0xf
  s_nop 1
  v_max_f32_dpp v37, v37, v37 row_ror:1 row_mask:0xf bank_mask:0xf
  v_mov_b32 v8, v37
  s_nop 1
  v_permlane16_swap_b32 v8, v37
  v_max_f32 v37, v37, v8
  v_mov_b32 v8, v37
  s_nop 1
  v_permlane32_swap_b32 v8, v37
  v_max_f32 v37, v37, v8
  v_sub_f32 v17, v25, v37
  v_sub_f32 v18, v27, v37
  v_mul_f32 v17, 0x3fb8aa3b, v17
  v_mul_f32 v18, 0x3fb8aa3b, v18
  v_exp_f32 v17, v17
  v_exp_f32 v18, v18
  v_mov_b32 v16, v37
  v_add_f32 v17, v17, v18
  s_nop 1
  v_add_f32_dpp v17, v17, v17 row_ror:8 row_mask:0xf bank_mask:0xf
  s_nop 1
  v_add_f32_dpp v17, v17, v17 row_ror:4 row_mask:0xf bank_mask:0xf
  s_nop 1
  v_add_f32_dpp v17, v17, v17 row_ror:2 row_mask:0xf bank_mask:0xf
  s_nop 1
  v_add_f32_dpp v17, v17, v17 row_ror:1 row_mask:0xf bank_mask:0xf
  v_mov_b32 v8, v17
  s_nop 1
  v_permlane16_swap_b32 v8, v17
  v_add_f32 v17, v17, v8
  v_mov_b32 v8, v17
  s_nop 1
  v_permlane32_swap_b32 v8, v17
  v_add_f32 v17, v17, v8
  s_mov_b64 exec, 1
  ds_max_f32 v3, v37 offset:6676
  ds_write_b64 v21, v[16:17] offset:6784
  ds_add_u32 v3, v20 offset:6672
  s_mov_b64 exec, -1
  v_max_f32 v20, v2, v37
  v_mov_b32 v21, s22
  s_add_u32 s38, s38, 3
  s_lshr_b32 s38, s38, 2
  s_max_u32 s38, s38, s32
  s_lshl_b32 s38, s38, 2
  v_cmp_nlt_f32 vcc, v25, v21
  v_cmp_nlt_f32 s[70:71], v27, v21
  s_bcnt1_i32_b64 s68, vcc
  s_bcnt1_i32_b64 s69, s[70:71]
  s_add_u32 s20, s68, s69
  s_cmp_gt_u32 s20, 32
  s_cselect_b32 s21, 1, s21
  v_mov_b32 v4, 0
  v_mov_b32 v5, 0
  s_cmp_lg_u32 s21, 0
  s_cbranch_scc1 L_x2
  s_mov_b32 s18, s38
  s_mov_b32 s38, 160
  v_cmp_nlt_f32 vcc, v25, v21
  s_lshl_b32 s68, s38, 3
  s_add_u32 s68, s68, s56
  s_andn2_b64 s[70:71], vcc, s[64:65]
  v_mbcnt_lo_u32_b32 v3, s70, 0
  v_mbcnt_hi_u32_b32 v3, s71, v3
  s_bcnt1_i32_b64 s69, s[70:71]
  v_lshl_add_u32 v3, v3, 3, s68
  s_mov_b64 exec, s[70:71]
  ds_write_b64 v3, v[24:25]
  s_mov_b64 exec, -1
  s_or_b64 s[64:65], s[64:65], s[70:71]
  s_add_u32 s38, s38, s69
  v_cmp_nlt_f32 vcc, v27, v21
  s_lshl_b32 s68, s38, 3
  s_add_u32 s68, s68, s56
  s_andn2_b64 s[70:71], vcc, s[66:67]
  v_mbcnt_lo_u32_b32 v3, s70, 0
  v_mbcnt_hi_u32_b32 v3, s71, v3
  s_bcnt1_i32_b64 s69, s[70:71]
  v_lshl_add_u32 v3, v3, 3, s68
  s_mov_b64 exec, s[70:71]
  ds_write_b64 v3, v[26:27]
  s_mov_b64 exec, -1
  s_or_b64 s[66:67], s[66:67], s[70:71]
  s_add_u32 s38, s38, s69
  ds_read_b32 v32, v39 offset:1024
  s_mov_b32 s38, s18
  s_mov_b32 s18, s32
  s_mov_b32 s19, 1
  s_waitcnt lgkmcnt(0)
  s_cmp_le_u32 s20, 0
  s_cbranch_scc1 L_x2
  v_add_u32_dpp v3, v32, v38 row_newbcast:8 row_mask:0xf bank_mask:0xf
  buffer_load_dwordx4 v[136:139], v3, s[48:51], 0 offen nt
  s_cmp_le_u32 s20, 4
  s_cbranch_scc1 L_x2
  v_add_u32_dpp v3, v32, v38 row_newbcast:9 row_mask:0xf bank_mask:0xf
  buffer_load_dwordx4 v[140:143], v3, s[48:51], 0 offen nt
  s_cmp_le_u32 s20, 8
  s_cbranch_scc1 L_x2
  v_add_u32_dpp v3, v32, v38 row_newbcast:10 row_mask:0xf bank_mask:0xf
  buffer_load_dwordx4 v[144:147], v3, s[48:51], 0 offen nt
  s_cmp_le_u32 s20, 12
  s_cbranch_scc1 L_x2
  v_add_u32_dpp v3, v32, v38 row_newbcast:11 row_mask:0xf bank_mask:0xf
  buffer_load_dwordx4 v[148:151], v3, s[48:51], 0 offen nt
  s_cmp_le_u32 s20, 16
  s_cbranch_scc1 L_x2
  v_add_u32_dpp v3, v32, v38 row_newbcast:12 row_mask:0xf bank_mask:0xf
  buffer_load_dwordx4 v[152:155], v3, s[48:51], 0 offen nt
  s_cmp_le_u32 s20, 20
  s_cbranch_scc1 L_x2
  v_add_u32_dpp v3, v32, v38 row_newbcast:13 row_mask:0xf bank_mask:0xf
  buffer_load_dwordx4 v[156:159], v3, s[48:51], 0 offen nt
  s_cmp_le_u32 s20, 24
  s_cbranch_scc1 L_x2
  v_add_u32_dpp v3, v32, v38 row_newbcast:14 row_mask:0xf bank_mask:0xf
  buffer_load_dwordx4 v[160:163], v3, s[48:51], 0 offen nt
  s_cmp_le_u32 s20, 28
  s_cbranch_scc1 L_x2
  v_add_u32_dpp v3, v32, v38 row_newbcast:15 row_mask:0xf bank_mask:0xf
  buffer_load_dwordx4 v[164:167], v3, s[48:51], 0 offen nt
L_x2:
  v_add_f32 v21, 0xc2ac0000, v20
  v_cmp_nlt_f32 vcc, v25, v21
  s_lshl_b32 s68, s38, 3
  s_add_u32 s68, s68, s56
  s_andn2_b64 s[70:71], vcc, s[64:65]
  v_mbcnt_lo_u32_b32 v3, s70, 0
  v_mbcnt_hi_u32_b32 v3, s71, v3
  s_bcnt1_i32_b64 s69, s[70:71]
  v_lshl_add_u32 v3, v3, 3, s68
  s_mov_b64 exec, s[70:71]
  ds_write_b64 v3, v[24:25]
  s_mov_b64 exec, -1
  s_or_b64 s[64:65], s[64:65], s[70:71]
  s_add_u32 s38, s38, s69
  v_cmp_nlt_f32 vcc, v27, v21
  s_lshl_b32 s68, s38, 3
  s_add_u32 s68, s68, s56
  s_andn2_b64 s[70:71], vcc, s[66:67]
  v_mbcnt_lo_u32_b32 v3, s70, 0
  v_mbcnt_hi_u32_b32 v3, s71, v3
  s_bcnt1_i32_b64 s69, s[70:71]
  v_lshl_add_u32 v3, v3, 3, s68
  s_mov_b64 exec, s[70:71]
  ds_write_b64 v3, v[26:27]
  s_mov_b64 exec, -1
  s_or_b64 s[66:67], s[66:67], s[70:71]
  s_add_u32 s38, s38, s69
  v_mov_b32 v8, 0
  v_mov_b32 v9, 0
  v_mov_b32 v10, 0
  v_mov_b32 v11, 0
  v_mov_b32 v12, 0
  v_mov_b32 v13, 0
  v_mov_b32 v14, 0
  v_mov_b32 v15, 0
  s_lshr_b32 s36, s38, 2
  s_mov_b32 s61, 1
  s_add_u32 s68, s38, 8
  s_lshr_b32 s68, s68, 2
  s_sub_u32 s69, s68, s59
  s_mov_b32 s59, s68
  s_add_u32 s35, s35, s69
  s_add_u32 s78, s78, s69
  v_mov_b32 v3, s69
  s_mov_b64 exec, 1
  ds_add_u32 v1, v3 offset:6696
  s_mov_b64 exec, -1
  ds_read_b64 v[28:29], v39 offset:0
  ds_read_b64 v[30:31], v39 offset:512
  ds_read_b64 v[32:33], v39 offset:1024
  s_waitcnt lgkmcnt(0)
  v_sub_f32 v29, v29, v37
  v_sub_f32 v31, v31, v37
  v_sub_f32 v33, v33, v37
  v_mul_f32 v29, 0x3fb8aa3b, v29
  v_mul_f32 v31, 0x3fb8aa3b, v31
  v_mul_f32 v33, 0x3fb8aa3b, v33
  v_exp_f32 v29, v29
  v_exp_f32 v31, v31
  v_exp_f32 v33, v33
  s_nop 0
  v_cvt_pk_bf16_f32 v34, 0, v29
  v_cvt_pk_bf16_f32 v35, 0, v31
  v_cvt_pk_bf16_f32 v36, 0, v33
  v_cvt_pk_bf16_f32 v29, v29, 0
  v_cvt_pk_bf16_f32 v31, v31, 0
  v_cvt_pk_bf16_f32 v33, v33, 0
  s_cmp_eq_u32 s20, 0
  s_cselect_b32 s41, 0, s41
L_vs1:
  s_cmp_eq_u32 s19, 0
  s_cbranch_scc1 L_vs1b
  s_sub_u32 s68, s32, s18
  s_cmp_le_u32 s41, s68
  s_cbranch_scc1 L_snap
  s_cmp_lg_u32 s36, s32
  s_cbranch_scc1 L_vs2
  s_waitcnt vmcnt(0)
L_snap:
  v_mov_b32 v6, 0
  v_mov_b32 v7, 0
  v_mov_b32 v16, 0
  v_mov_b32 v17, 0
  v_mov_b32 v18, 0
  v_mov_b32 v19, 0
  s_cmp_le_u32 s20, 0
  s_cbranch_scc1 L_snp2
  v_dot2c_f32_bf16_dpp v4, v33, v136 row_newbcast:8 row_mask:0xf bank_mask:0xf
  v_dot2c_f32_bf16_dpp v5, v36, v136 row_newbcast:8 row_mask:0xf bank_mask:0xf
  v_dot2c_f32_bf16_dpp v6, v33, v137 row_newbcast:8 row_mask:0xf bank_mask:0xf
  v_dot2c_f32_bf16_dpp v7, v36, v137 row_newbcast:8 row_mask:0xf bank_mask:0xf
  v_dot2c_f32_bf16_dpp v16, v33, v138 row_newbcast:8 row_mask:0xf bank_mask:0xf
  v_dot2c_f32_bf16_dpp v17, v36, v138 row_newbcast:8 row_mask:0xf bank_mask:0xf
  v_dot2c_f32_bf16_dpp v18, v33, v139 row_newbcast:8 row_mask:0xf bank_mask:0xf
  v_dot2c_f32_bf16_dpp v19, v36, v139 row_newbcast:8 row_mask:0xf bank_mask:0xf
  s_cmp_le_u32 s20, 4
  s_cbranch_scc1 L_snp2
  v_dot2c_f32_bf16_dpp v4, v33, v140 row_newbcast:9 row_mask:0xf bank_mask:0xf
  v_dot2c_f32_bf16_dpp v5, v36, v140 row_newbcast:9 row_mask:0xf bank_mask:0xf
  v_dot2c_f32_bf16_dpp v6, v33, v141 row_newbcast:9 row_mask:0xf bank_mask:0xf
  v_dot2c_f32_bf16_dpp v7, v36, v141 row_newbcast:9 row_mask:0xf bank_mask:0xf
  v_dot2c_f32_bf16_dpp v16, v33, v142 row_newbcast:9 row_mask:0xf bank_mask:0xf
  v_dot2c_f32_bf16_dpp v17, v36, v142 row_newbcast:9 row_mask:0xf bank_mask:0xf
  v_dot2c_f32_bf16_dpp v18, v33, v143 row_newbcast:9 row_mask:0xf bank_mask:0xf
  v_dot2c_f32_bf16_dpp v19, v36, v143 row_newbcast:9 row_mask:0xf bank_mask:0xf
  s_cmp_le_u32 s20, 8
  s_cbranch_scc1 L_snp2
  v_dot2c_f32_bf16_dpp v4, v33, v144 row_newbcast:10 row_mask:0xf bank_mask:0xf
  v_dot2c_f32_bf16_dpp v5, v36, v144 row_newbcast:10 row_mask:0xf bank_mask:0xf
  v_dot2c_f32_bf16_dpp v6, v33, v145 row_newbcast:10 row_mask:0xf bank_mask:0xf
  v_dot2c_f32_bf16_dpp v7, v36, v145 row_newbcast:10 row_mask:0xf bank_mask:0xf
  v_dot2c_f32_bf16_dpp v16, v33, v146 row_newbcast:10 row_mask:0xf bank_mask:0xf
  v_dot2c_f32_bf16_dpp v17, v36, v146 row_newbcast:10 row_mask:0xf bank_mask:0xf
  v_dot2c_f32_bf16_dpp v18, v33, v147 row_newbcast:10 row_mask:0xf bank_mask:0xf
  v_dot2c_f32_bf16_dpp v19, v36, v147 row_newbcast:10 row_mask:0xf bank_mask:0xf
  s_cmp_le_u32 s20, 12
  s_cbranch_scc1 L_snp2
  v_dot2c_f32_bf16_dpp v4, v33, v148 row_newbcast:11 row_mask:0xf bank_mask:0xf
  v_dot2c_f32_bf16_dpp v5, v36, v148 row_newbcast:11 row_mask:0xf bank_mask:0xf
  v_dot2c_f32_bf16_dpp v6, v33, v149 row_newbcast:11 row_mask:0xf bank_mask:0xf
  v_dot2c_f32_bf16_dpp v7, v36, v149 row_newbcast:11 row_mask:0xf bank_mask:0xf
  v_dot2c_f32_bf16_dpp v16, v33, v150 row_newbcast:11 row_mask:0xf bank_mask:0xf
  v_dot2c_f32_bf16_dpp v17, v36, v150 row_newbcast:11 row_mask:0xf bank_mask:0xf
  v_dot2c_f32_bf16_dpp v18, v33, v151 row_newbcast:11 row_mask:0xf bank_mask:0xf
  v_dot2c_f32_bf16_dpp v19, v36, v151 row_newbcast:11 row_mask:0xf bank_mask:0xf
  s_cmp_le_u32 s20, 16
  s_cbranch_scc1 L_snp2
  v_dot2c_f32_bf16_dpp v4, v33, v152 row_newbcast:12 row_mask:0xf bank_mask:0xf
  v_dot2c_f32_bf16_dpp v5, v36, v152 row_newbcast:12 row_mask:0xf bank_mask:0xf
  v_dot2c_f32_bf16_dpp v6, v33, v153 row_newbcast:12 row_mask:0xf bank_mask:0xf
  v_dot2c_f32_bf16_dpp v7, v36, v153 row_newbcast:12 row_mask:0xf bank_mask:0xf
  v_dot2c_f32_bf16_dpp v16, v33, v154 row_newbcast:12 row_mask:0xf bank_mask:0xf
  v_dot2c_f32_bf16_dpp v17, v36, v154 row_newbcast:12 row_mask:0xf bank_mask:0xf
  v_dot2c_f32_bf16_dpp v18, v33, v155 row_newbcast:12 row_mask:0xf bank_mask:0xf
  v_dot2c_f32_bf16_dpp v19, v36, v155 row_newbcast:12 row_mask:0xf bank_mask:0xf
  s_cmp_le_u32 s20, 20
  s_cbranch_scc1 L_snp2
  v_dot2c_f32_bf16_dpp v4, v33, v156 row_newbcast:13 row_mask:0xf bank_mask:0xf
  v_dot2c_f32_bf16_dpp v5, v36, v156 row_newbcast:13 row_mask:0xf bank_mask:0xf
  v_dot2c_f32_bf16_dpp v6, v33, v157 row_newbcast:13 row_mask:0xf bank_mask:0xf
  v_dot2c_f32_bf16_dpp v7, v36, v157 row_newbcast:13 row_mask:0xf bank_mask:0xf
  v_dot2c_f32_bf16_dpp v16, v33, v158 row_newbcast:13 row_mask:0xf bank_mask:0xf
  v_dot2c_f32_bf16_dpp v17, v36, v158 row_newbcast:13 row_mask:0xf bank_mask:0xf
  v_dot2c_f32_bf16_dpp v18, v33, v159 row_newbcast:13 row_mask:0xf bank_mask:0xf
  v_dot2c_f32_bf16_dpp v19, v36, v159 row_newbcast:13 row_mask:0xf bank_mask:0xf
  s_cmp_le_u32 s20, 24
  s_cbranch_scc1 L_snp2
  v_dot2c_f32_bf16_dpp v4, v33, v160 row_newbcast:14 row_mask:0xf bank_mask:0xf
  v_dot2c_f32_bf16_dpp v5, v36, v160 row_newbcast:14 row_mask:0xf bank_mask:0xf
  v_dot2c_f32_bf16_dpp v6, v33, v161 row_newbcast:14 row_mask:0xf bank_mask:0xf
  v_dot2c_f32_bf16_dpp v7, v36, v161 row_newbcast:14 row_mask:0xf bank_mask:0xf
  v_dot2c_f32_bf16_dpp v16, v33, v162 row_newbcast:14 row_mask:0xf bank_mask:0xf
  v_dot2c_f32_bf16_dpp v17, v36, v162 row_newbcast:14 row_mask:0xf bank_mask:0xf
  v_dot2c_f32_bf16_dpp v18, v33, v163 row_newbcast:14 row_mask:0xf bank_mask:0xf
  v_dot2c_f32_bf16_dpp v19, v36, v163 row_newbcast:14 row_mask:0xf bank_mask:0xf
  s_cmp_le_u32 s20, 28
  s_cbranch_scc1 L_snp2
  v_dot2c_f32_bf16_dpp v4, v33, v164 row_newbcast:15 row_mask:0xf bank_mask:0xf
  v_dot2c_f32_bf16_dpp v5, v36, v164 row_newbcast:15 row_mask:0xf bank_mask:0xf
  v_dot2c_f32_bf16_dpp v6, v33, v165 row_newbcast:15 row_mask:0xf bank_mask:0xf
  v_dot2c_f32_bf16_dpp v7, v36, v165 row_newbcast:15 row_mask:0xf bank_mask:0xf
  v_dot2c_f32_bf16_dpp v16, v33, v166 row_newbcast:15 row_mask:0xf bank_mask:0xf
  v_dot2c_f32_bf16_dpp v17, v36, v166 row_newbcast:15 row_mask:0xf bank_mask:0xf
  v_dot2c_f32_bf16_dpp v18, v33, v167 row_newbcast:15 row_mask:0xf bank_mask:0xf
  v_dot2c_f32_bf16_dpp v19, v36, v167 row_newbcast:15 row_mask:0xf bank_mask:0xf
L_snp2:
  s_nop 1
  s_nop 0
  v_permlane32_swap_b32 v4, v16
  v_permlane32_swap_b32 v5, v17
  v_permlane32_swap_b32 v6, v18
  v_permlane32_swap_b32 v7, v19
  v_add_f32 v4, v4, v16
  v_add_f32 v5, v5, v17
  v_add_f32 v6, v6, v18
  v_add_f32 v7, v7, v19
  v_mov_b32 v3, 1
  v_permlane16_swap_b32 v4, v6
  v_permlane16_swap_b32 v5, v7
  v_add_f32 v4, v4, v6
  v_add_f32 v5, v5, v7
  ds_write_b64 v22, v[4:5] offset:11904
  s_mov_b64 exec, 1
  ds_add_u32 v1, v3 offset:6704
  s_mov_b64 exec, -1
  s_mov_b32 s19, 0
L_vs1b:
  s_cmp_eq_u32 s36, s32
  s_cbranch_scc1 L_hand
L_vs2:
  s_cmp_lt_u32 s32, s37
  s_cbranch_scc1 L_ks2
  s_sub_u32 s41, s36, s32
  s_add_u32 s32, s32, 1
  s_cmp_gt_u32 s41, 5
  s_cbranch_scc1 L_wait
  s_waitcnt vmcnt(4)
  s_cmp_ge_u32 s41, 5
  s_cbranch_scc1 L_ret2
  s_waitcnt vmcnt(3)
  s_cmp_ge_u32 s41, 4
  s_cbranch_scc1 L_ret2
  s_waitcnt vmcnt(2)
  s_cmp_ge_u32 s41, 3
  s_cbranch_scc1 L_ret2
  s_waitcnt vmcnt(1)
  s_cmp_ge_u32 s41, 2
  s_cbranch_scc1 L_ret2
  s_waitcnt vmcnt(0)
L_ret2:
  s_cmp_eq_u32 s32, s32
  s_setpc_b64 s[62:63]
L_hand:
  v_mov_b32 v3, 0
  s_mov_b32 s70, 0
L_sn_5:
  ds_read_b64 v[18:19], v3 offset:6672
  s_waitcnt lgkmcnt(0)
  v_cmp_gt_u32 vcc, 0x10200, v18
  s_cmp_eq_u64 vcc, 0
  s_cbranch_scc1 L_snd_6
  s_sleep 1
  s_add_u32 s70, s70, 1
  s_cmp_lt_u32 s70, 2097152
  s_cbranch_scc1 L_sn_5
L_snd_6:
  v_add_f32 v21, 0xc2ba0000, v19
  v_cmp_nlt_f32 vcc, v25, v21
  s_lshl_b32 s68, s38, 3
  s_add_u32 s68, s68, s56
  s_andn2_b64 s[70:71], vcc, s[64:65]
  v_mbcnt_lo_u32_b32 v3, s70, 0
  v_mbcnt_hi_u32_b32 v3, s71, v3
  s_bcnt1_i32_b64 s69, s[70:71]
  v_lshl_add_u32 v3, v3, 3, s68
  s_mov_b64 exec, s[70:71]
  ds_write_b64 v3, v[24:25]
  s_mov_b64 exec, -1
  s_or_b64 s[64:65], s[64:65], s[70:71]
  s_add_u32 s38, s38, s69
  v_cmp_nlt_f32 vcc, v27, v21
  s_lshl_b32 s68, s38, 3
  s_add_u32 s68, s68, s56
  s_andn2_b64 s[70:71], vcc, s[66:67]
  v_mbcnt_lo_u32_b32 v3, s70, 0
  v_mbcnt_hi_u32_b32 v3, s71, v3
  s_bcnt1_i32_b64 s69, s[70:71]
  v_lshl_add_u32 v3, v3, 3, s68
  s_mov_b64 exec, s[70:71]
  ds_write_b64 v3, v[26:27]
  s_mov_b64 exec, -1
  s_or_b64 s[66:67], s[66:67], s[70:71]
  s_add_u32 s38, s38, s69
  s_add_u32 s36, s38, 23
  s_lshr_b32 s36, s36, 2
  s_sub_u32 s37, s36, 9
  s_max_i32 s37, s37, 0
  s_mov_b32 s75, s36
  s_add_u32 s68, s38, 3
  s_lshr_b32 s68, s68, 2
  s_sub_u32 s69, s68, s59
  s_mov_b32 s59, s68
  s_add_u32 s35, s35, s69
  s_add_u32 s78, s78, s69
  v_mov_b32 v3, s69
  s_mov_b64 exec, 1
  ds_add_u32 v1, v3 offset:6696
  s_mov_b64 exec, -1
  ds_read_b64 v[28:29], v39 offset:0
  ds_read_b64 v[30:31], v39 offset:512
  ds_read_b64 v[32:33], v39 offset:1024
  s_waitcnt lgkmcnt(0)
  v_sub_f32 v29, v29, v37
  v_sub_f32 v31, v31, v37
  v_sub_f32 v33, v33, v37
  v_mul_f32 v29, 0x3fb8aa3b, v29
  v_mul_f32 v31, 0x3fb8aa3b, v31
  v_mul_f32 v33, 0x3fb8aa3b, v33
  v_exp_f32 v29, v29
  v_exp_f32 v31, v31
  v_exp_f32 v33, v33
  s_nop 0
  v_cvt_pk_bf16_f32 v34, 0, v29
  v_cvt_pk_bf16_f32 v35, 0, v31
  v_cvt_pk_bf16_f32 v36, 0, v33
  v_cvt_pk_bf16_f32 v29, v29, 0
  v_cvt_pk_bf16_f32 v31, v31, 0
  v_cvt_pk_bf16_f32 v33, v33, 0
  s_branch L_vs2
L_work:
  s_cmp_eq_u32 s39, 1
  s_cbranch_scc1 L_w1
  s_cmp_eq_u32 s39, 2
  s_cbranch_scc1 L_w2
  s_cmp_eq_u32 s39, 3
  s_cbranch_scc1 L_w3
  s_cmp_lt_u32 s32, 16
  s_cbranch_scc1 L_wr
L_w0:
  s_load_dwordx16 s[16:31], s[42:43], s40 glc
  s_mov_b32 s39, 1
L_wr:
  s_setpc_b64 s[100:101]
L_w1:
  s_waitcnt lgkmcnt(0)
  s_xor_b32 s68, s17, s74
  s_xor_b32 s69, s19, s74
  s_or_b32 s68, s68, s69
  s_xor_b32 s69, s21, s74
  s_or_b32 s68, s68, s69
  s_xor_b32 s69, s23, s74
  s_or_b32 s68, s68, s69
  s_xor_b32 s69, s25, s74
  s_or_b32 s68, s68, s69
  s_xor_b32 s69, s27, s74
  s_or_b32 s68, s68, s69
  s_xor_b32 s69, s29, s74
  s_or_b32 s68, s68, s69
  s_xor_b32 s69, s31, s74
  s_or_b32 s68, s68, s69
  s_cbranch_scc1 L_w0
  v_mov_b32 v8, s16
  v_mov_b32 v9, s18
  v_mov_b32 v10, s20
  v_mov_b32 v11, s22
  v_mov_b32 v12, s24
  v_mov_b32 v13, s26
  v_mov_b32 v14, s28
  v_mov_b32 v15, s30
  v_lshlrev_b32 v3, 5, s9
  s_mov_b64 exec, 1
  ds_write_b128 v3, v[8:11] offset:6400
  ds_write_b128 v3, v[12:15] offset:6416
  s_mov_b64 exec, -1
  s_mov_b32 s39, 2
L_w2:
  s_cmp_lt_u32 s32, 21
  s_cbranch_scc1 L_wr
  ds_read_b128 v[4:7], v38 offset:6400
  s_waitcnt lgkmcnt(0)
  v_max3_u32 v8, v4, v5, v6
  v_max_u32 v8, v8, v7
  v_cmp_eq_u32 vcc, -1, v8
  s_cmp_lg_u64 vcc, 0
  s_cbranch_scc1 L_wr
  v_dot2_f32_bf16 v8, v40, v4, 0
  v_dot2_f32_bf16 v9, v44, v4, 0
  v_dot2_f32_bf16 v10, v48, v4, 0
  v_dot2_f32_bf16 v11, v52, v4, 0
  v_dot2_f32_bf16 v12, v56, v4, 0
  v_dot2_f32_bf16 v13, v60, v4, 0
  v_dot2_f32_bf16 v14, v64, v4, 0
  v_dot2_f32_bf16 v15, v68, v4, 0
  v_dot2_f32_bf16 v8, v41, v5, v8
  v_dot2_f32_bf16 v9, v45, v5, v9
  v_dot2_f32_bf16 v10, v49, v5, v10
  v_dot2_f32_bf16 v11, v53, v5, v11
  v_dot2_f32_bf16 v12, v57, v5, v12
  v_dot2_f32_bf16 v13, v61, v5, v13
  v_dot2_f32_bf16 v14, v65, v5, v14
  v_dot2_f32_bf16 v15, v69, v5, v15
  v_dot2_f32_bf16 v8, v42, v6, v8
  v_dot2_f32_bf16 v9, v46, v6, v9
  v_dot2_f32_bf16 v10, v50, v6, v10
  v_dot2_f32_bf16 v11, v54, v6, v11
  v_dot2_f32_bf16 v12, v58, v6, v12
  v_dot2_f32_bf16 v13, v62, v6, v13
  v_dot2_f32_bf16 v14, v66, v6, v14
  v_dot2_f32_bf16 v15, v70, v6, v15
  v_dot2_f32_bf16 v8, v43, v7, v8
  v_dot2_f32_bf16 v9, v47, v7, v9
  v_dot2_f32_bf16 v10, v51, v7, v10
  v_dot2_f32_bf16 v11, v55, v7, v11
  v_dot2_f32_bf16 v12, v59, v7, v12
  v_dot2_f32_bf16 v13, v63, v7, v13
  v_dot2_f32_bf16 v14, v67, v7, v14
  v_dot2_f32_bf16 v15, v71, v7, v15
  v_add_f32_dpp v8, v8, v8 row_ror:8 row_mask:0xf bank_mask:0x3
  v_add_f32_dpp v8, v9, v9 row_ror:8 row_mask:0xf bank_mask:0xc
  v_add_f32_dpp v10, v10, v10 row_ror:8 row_mask:0xf bank_mask:0x3
  v_add_f32_dpp v10, v11, v11 row_ror:8 row_mask:0xf bank_mask:0xc
  v_add_f32_dpp v12, v12, v12 row_ror:8 row_mask:0xf bank_mask:0x3
  v_add_f32_dpp v12, v13, v13 row_ror:8 row_mask:0xf bank_mask:0xc
  v_add_f32_dpp v14, v14, v14 row_ror:8 row_mask:0xf bank_mask:0x3
  v_add_f32_dpp v14, v15, v15 row_ror:8 row_mask:0xf bank_mask:0xc
  v_add_f32_dpp v16, v8, v8 row_shl:4 row_mask:0xf bank_mask:0x5
  v_add_f32_dpp v16, v10, v10 row_shr:4 row_mask:0xf bank_mask:0xa
  v_add_f32_dpp v17, v12, v12 row_shl:4 row_mask:0xf bank_mask:0x5
  v_add_f32_dpp v17, v14, v14 row_shr:4 row_mask:0xf bank_mask:0xa
  v_dot2_f32_bf16 v8, v72, v4, 0
  v_dot2_f32_bf16 v9, v76, v4, 0
  v_dot2_f32_bf16 v10, v80, v4, 0
  v_dot2_f32_bf16 v11, v84, v4, 0
  v_dot2_f32_bf16 v12, v88, v4, 0
  v_dot2_f32_bf16 v13, v92, v4, 0
  v_dot2_f32_bf16 v14, v96, v4, 0
  v_dot2_f32_bf16 v15, v100, v4, 0
  v_dot2_f32_bf16 v8, v73, v5, v8
  v_dot2_f32_bf16 v9, v77, v5, v9
  v_dot2_f32_bf16 v10, v81, v5, v10
  v_dot2_f32_bf16 v11, v85, v5, v11
  v_dot2_f32_bf16 v12, v89, v5, v12
  v_dot2_f32_bf16 v13, v93, v5, v13
  v_dot2_f32_bf16 v14, v97, v5, v14
  v_dot2_f32_bf16 v15, v101, v5, v15
  v_dot2_f32_bf16 v8, v74, v6, v8
  v_dot2_f32_bf16 v9, v78, v6, v9
  v_dot2_f32_bf16 v10, v82, v6, v10
  v_dot2_f32_bf16 v11, v86, v6, v11
  v_dot2_f32_bf16 v12, v90, v6, v12
  v_dot2_f32_bf16 v13, v94, v6, v13
  v_dot2_f32_bf16 v14, v98, v6, v14
  v_dot2_f32_bf16 v15, v102, v6, v15
  v_dot2_f32_bf16 v8, v75, v7, v8
  v_dot2_f32_bf16 v9, v79, v7, v9
  v_dot2_f32_bf16 v10, v83, v7, v10
  v_dot2_f32_bf16 v11, v87, v7, v11
  v_dot2_f32_bf16 v12, v91, v7, v12
  v_dot2_f32_bf16 v13, v95, v7, v13
  v_dot2_f32_bf16 v14, v99, v7, v14
  v_dot2_f32_bf16 v15, v103, v7, v15
  v_add_f32_dpp v8, v8, v8 row_ror:8 row_mask:0xf bank_mask:0x3
  v_add_f32_dpp v8, v9, v9 row_ror:8 row_mask:0xf bank_mask:0xc
  v_add_f32_dpp v10, v10, v10 row_ror:8 row_mask:0xf bank_mask:0x3
  v_add_f32_dpp v10, v11, v11 row_ror:8 row_mask:0xf bank_mask:0xc
  v_add_f32_dpp v12, v12, v12 row_ror:8 row_mask:0xf bank_mask:0x3
  v_add_f32_dpp v12, v13, v13 row_ror:8 row_mask:0xf bank_mask:0xc
  v_add_f32_dpp v14, v14, v14 row_ror:8 row_mask:0xf bank_mask:0x3
  v_add_f32_dpp v14, v15, v15 row_ror:8 row_mask:0xf bank_mask:0xc
  v_add_f32_dpp v18, v8, v8 row_shl:4 row_mask:0xf bank_mask:0x5
  v_add_f32_dpp v18, v10, v10 row_shr:4 row_mask:0xf bank_mask:0xa
  v_add_f32_dpp v19, v12, v12 row_shl:4 row_mask:0xf bank_mask:0x5
  v_add_f32_dpp v19, v14, v14 row_shr:4 row_mask:0xf bank_mask:0xa
  v_mov_b32 v3, 0
  v_mov_b32 v20, 64
  v_add_f32_dpp v16, v16, v16 quad_perm:[2,3,0,1] row_mask:0xf bank_mask:0xf
  v_add_f32_dpp v17, v17, v17 quad_perm:[2,3,0,1] row_mask:0xf bank_mask:0xf
  v_add_f32_dpp v18, v18, v18 quad_perm:[2,3,0,1] row_mask:0xf bank_mask:0xf
  v_add_f32_dpp v19, v19, v19 quad_perm:[2,3,0,1] row_mask:0xf bank_mask:0xf
  v_cndmask_b32 v8, v16, v17, s[52:53]
  v_cndmask_b32 v9, v18, v19, s[52:53]
  s_nop 0
  v_lshlrev_b32 v21, 3, s9
  v_add_f32_dpp v8, v8, v8 quad_perm:[1,0,3,2] row_mask:0xf bank_mask:0xf
  v_add_f32_dpp v9, v9, v9 quad_perm:[1,0,3,2] row_mask:0xf bank_mask:0xf
  v_cndmask_b32 v25, v8, v9, s[54:55]
  v_cvt_pk_bf16_f32 v25, 0, v25
  v_mul_f32 v25, 0x3db504f3, v25
  v_cvt_pk_bf16_f32 v25, 0, v25
  v_mov_b32 v37, v25
  s_nop 1
  v_max_f32_dpp v37, v37, v37 row_ror:8 row_mask:0xf bank_mask:0xf
  s_nop 1
  v_max_f32_dpp v37, v37, v37 row_ror:4 row_mask:0xf bank_mask:0xf
  s_nop 1
  v_max_f32_dpp v37, v37, v37 row_ror:2 row_mask:0xf bank_mask:0xf
  s_nop 1
  v_max_f32_dpp v37, v37, v37 row_ror:1 row_mask:0xf bank_mask:0xf
  v_mov_b32 v8, v37
  s_nop 1
  v_permlane16_swap_b32 v8, v37
  v_max_f32 v37, v37, v8
  v_mov_b32 v8, v37
  s_nop 1
  v_permlane32_swap_b32 v8, v37
  v_max_f32 v37, v37, v8
  s_mov_b64 exec, 1
  ds_max_f32 v3, v37 offset:6684
  ds_add_u32 v3, v20 offset:6680
  s_mov_b64 exec, -1
  s_mov_b32 s39, 3
  s_mov_b32 s19, 0
  s_setpc_b64 s[100:101]
L_w3:
  v_mov_b32 v3, 0
  ds_read_b64 v[18:19], v3 offset:6680
  s_waitcnt lgkmcnt(0)
  v_cmp_gt_u32 vcc, 0x10200, v18
  s_cmp_lg_u64 vcc, 0
  s_cbranch_scc1 L_wr
  ds_read_b64 v[16:17], v3 offset:6728
  s_waitcnt lgkmcnt(0)
  v_max_f32 v2, v19, v16
  v_med3_f32 v21, v19, v16, v17
  v_add_f32 v21, 0xc1e00000, v21
  v_cmp_nlt_f32 vcc, v25, v21
  v_readfirstlane_b32 s22, v21
  v_add_f32 v21, 0xc2ac0000, v2
  s_bcnt1_i32_b64 s68, vcc
  s_cmp_gt_u32 s68, 32
  s_cselect_b32 s21, 1, 0
  s_cselect_b64 s[16:17], 0, vcc
  s_mov_b64 s[64:65], s[16:17]
  v_cmp_nlt_f32 vcc, v25, v21
  s_lshl_b32 s68, s38, 3
  s_add_u32 s68, s68, s56
  s_andn2_b64 s[70:71], vcc, s[64:65]
  v_mbcnt_lo_u32_b32 v3, s70, 0
  v_mbcnt_hi_u32_b32 v3, s71, v3
  s_bcnt1_i32_b64 s69, s[70:71]
  v_lshl_add_u32 v3, v3, 3, s68
  s_mov_b64 exec, s[70:71]
  ds_write_b64 v3, v[24:25]
  s_mov_b64 exec, -1
  s_or_b64 s[64:65], s[64:65], s[70:71]
  s_add_u32 s38, s38, s69
  s_andn2_b64 s[64:65], s[64:65], s[16:17]
  s_add_u32 s68, s38, 4
  s_lshr_b32 s68, s68, 1
  s_sub_u32 s69, s68, s59
  s_mov_b32 s59, s68
  v_mov_b32 v3, s69
  s_mov_b64 exec, 1
  ds_add_u32 v1, v3 offset:6696
  s_mov_b64 exec, -1
  s_mov_b32 s39, 4
  ds_read_b64 v[28:29], v39 offset:0
  s_waitcnt lgkmcnt(0)
  s_setpc_b64 s[100:101]
L_helper:
  s_bfe_u32 s61, s2, 0x30003
  s_lshl_b32 s48, s8, 3
  s_add_u32 s61, s61, s48
  s_bfe_u32 s48, s2, 0x10003
  s_lshl_b32 s49, s48, 1
  s_add_u32 s50, s2, 3
  s_sub_u32 s50, s50, s49
  s_and_b32 s50, s50, 7
  s_lshl_b32 s48, s48, 3
  s_or_b32 s50, s50, s48
  s_cmp_lt_u32 s2, 128
  s_cselect_b32 s61, s61, s50
  v_mov_b32 v4, -1
  v_mov_b32 v5, -1
  v_mov_b32 v6, -1
  v_mov_b32 v7, -1
  v_mov_b32 v8, 0xff800000
  v_mov_b32 v9, 0
  v_mov_b32 v10, 0xff800000
  v_lshlrev_b32 v2, 3, v1
  ds_write_b64 v2, v[8:9] offset:6784
  v_lshlrev_b32 v2, 2, v1
  ds_write_b32 v2, v4 offset:6400
  v_mov_b32 v38, 0
  v_mov_b32 v39, 0xff800000
  ds_write_b128 v38, v[4:7] offset:6656
  ds_write_b32 v38, v38 offset:6720
  ds_write_b64 v38, v[38:39] offset:6672
  ds_write_b64 v38, v[38:39] offset:6680
  v_mov_b32 v8, 1248
  v_mov_b32 v9, 1280
  v_mov_b32 v10, 1024
  v_mov_b32 v11, 1280
  ds_write_b128 v38, v[8:11] offset:6688
  v_mov_b32 v8, 0
  v_mov_b32 v9, 0
  v_mov_b32 v10, 0
  v_mov_b32 v11, 0
  ds_write_b128 v38, v[8:11] offset:6704
  s_mov_b32 s77, 4
  s_getreg_b32 s76, hwreg(HW_REG_XCC_ID, 0, 4)
  v_lshrrev_b32 v12, 3, v0
  v_lshlrev_b32 v12, 5, v12
  v_bfe_u32 v3, v1, 2, 1
  v_lshl_add_u32 v12, v3, 10, v12
  v_and_b32 v8, 3, v1
  v_lshl_add_u32 v13, v8, 3, v12
  v_and_b32 v12, 0xffffffdf, v12
  v_lshl_add_u32 v12, v8, 4, v12
  v_bfe_u32 v8, v1, 3, 1
  v_lshl_add_u32 v12, v8, 3, v12
  v_lshl_add_u32 v12, v3, 5, v12
  s_lshl_b32 s48, s61, 7
  s_lshl_b32 s49, s5, 7
  s_add_u32 s49, s49, 64
  v_add_u32 v8, s49, v1
  s_waitcnt lgkmcnt(0)
  s_load_dword s74, s[42:43], 0
  s_cmp_eq_u32 s13, 2
  s_cbranch_scc1 L_r_q
  s_cmp_eq_u32 s13, 1
  s_cbranch_scc1 L_r_moda
  s_load_dword s14, s[56:57], s3
  s_cmp_lg_u32 s13, 4
  s_cbranch_scc1 L_np4
  v_mul_u32_u24 v8, 6144, v8
  v_add_u32 v8, s48, v8
  global_load_dword v167, v8, s[36:37]
L_np4:
  s_barrier
  s_waitcnt lgkmcnt(0)
  s_and_b32 s13, s14, 7
  s_bfe_u32 s61, s14, 0x80008
  s_cmp_eq_u32 s13, 1
  s_cbranch_scc1 L_r_wo
  s_cmp_eq_u32 s13, 4
  s_cbranch_scc1 L_r_modb
  s_cmp_eq_u32 s13, 2
  s_cbranch_scc1 L_r_f1
  s_cmp_eq_u32 s13, 3
  s_cbranch_scc1 L_r_f2
  s_branch L_r_none
L_r_moda:
  s_lshl_b32 s48, s61, 7
  s_lshl_b32 s58, s61, 9
  s_add_u32 s58, s58, 4096
  s_mov_b32 s44, s36
  s_mov_b32 s45, s37
  s_mov_b32 s46, 3145728
  s_mov_b32 s47, 0x20000
  global_load_dwordx2 v[14:15], v13, s[34:35]
  v_lshrrev_b32 v2, 3, v1
  v_and_b32 v3, 6, v2
  v_xor_b32 v3, v3, v1
  v_mul_u32_u24 v2, 6144, v2
  v_and_b32 v3, 7, v3
  v_lshl_add_u32 v2, v3, 4, v2
  s_mul_i32 s49, s5, 786432
  s_lshl_b32 s50, s5, 14
  s_add_u32 s49, s49, s48
  s_add_u32 s50, s50, 16384
  s_add_u32 s51, s50, 16384
L_dma_7:
  s_mov_b32 m0, s50
  s_add_u32 s50, s50, 1024
  buffer_load_dwordx4 v2, s[44:47], s49 offen nt lds
  s_add_u32 s49, s49, 49152
  s_cmp_lt_u32 s50, s51
  s_cbranch_scc1 L_dma_7
L_dmae_8:
  s_barrier
  s_waitcnt lgkmcnt(0)
  s_mul_i32 s74, s74, 0x9e3779b1
  s_add_u32 s74, s74, 0x7f4a7c15
  s_add_u32 s76, s76, s74
  s_waitcnt vmcnt(16)
  v_lshlrev_b32 v16, 16, v14
  v_and_b32 v17, s73, v14
  v_lshlrev_b32 v18, 16, v15
  v_and_b32 v19, s73, v15
  v_mul_f32 v20, 0xbfb8aa3b, v16
  v_mul_f32 v21, 0xbfb8aa3b, v17
  v_mul_f32 v22, 0xbfb8aa3b, v18
  v_mul_f32 v23, 0xbfb8aa3b, v19
  v_exp_f32 v20, v20
  v_exp_f32 v21, v21
  v_exp_f32 v22, v22
  v_exp_f32 v23, v23
  s_nop 0
  v_add_f32 v20, 1.0, v20
  v_add_f32 v21, 1.0, v21
  v_add_f32 v22, 1.0, v22
  v_add_f32 v23, 1.0, v23
  v_rcp_f32 v20, v20
  v_rcp_f32 v21, v21
  v_rcp_f32 v22, v22
  v_rcp_f32 v23, v23
  s_nop 0
  v_mul_f32 v16, v16, v20
  v_mul_f32 v17, v17, v21
  v_mul_f32 v18, v18, v22
  v_mul_f32 v19, v19, v23
  v_cvt_pk_bf16_f32 v14, v16, v17
  v_cvt_pk_bf16_f32 v15, v18, v19
  ds_write_b64 v12, v[14:15] offset:0
  v_and_b32 v13, 1, v1
  v_lshlrev_b32 v13, 6, v13
  v_lshrrev_b32 v3, 4, v1
  v_lshl_add_u32 v13, v3, 4, v13
  s_lshl_b32 s49, s5, 7
  s_add_u32 s49, s49, s58
  v_add_u32 v13, s49, v13
  v_bfe_u32 v3, v1, 1, 3
  v_lshl_add_u32 v13, v3, 13, v13
  v_add_u32 v13, 913408, v13
  v_and_b32 v14, 1, v1
  v_mul_u32_u24 v14, 1056, v14
  v_lshrrev_b32 v3, 4, v1
  v_lshl_add_u32 v14, v3, 4, v14
  v_lshrrev_b32 v2, 2, v1
  v_bfe_u32 v3, v1, 1, 1
  s_lshl_b32 s49, s5, 1
  v_or_b32 v3, s49, v3
  v_and_b32 v10, 6, v2
  v_xor_b32 v3, v3, v10
  v_lshlrev_b32 v2, 7, v2
  v_lshl_add_u32 v2, v3, 4, v2
  v_and_b32 v3, 1, v1
  v_lshl_add_u32 v2, v3, 3, v2
  v_add_u32 v2, 16384, v2
  s_waitcnt vmcnt(0) lgkmcnt(0)
  v_mov_b32 v9, 1
  s_mov_b64 exec, 1
  ds_add_u32 v38, v9 offset:6720
  s_mov_b64 exec, -1
  s_mov_b32 s70, 0
L_sn_9:
  ds_read_b32 v9, v38 offset:6720
  s_waitcnt lgkmcnt(0)
  v_cmp_gt_u32 vcc, 0x4, v9
  s_cmp_eq_u64 vcc, 0
  s_cbranch_scc1 L_snd_10
  s_add_u32 s70, s70, 1
  s_cmp_lt_u32 s70, 2097152
  s_cbranch_scc1 L_sn_9
L_snd_10:
  ds_read_b64_tr_b16 v[40:41], v2 offset:0
  ds_read_b64_tr_b16 v[42:43], v2 offset:2048
  ds_read_b128 v[104:107], v14 offset:0
  ds_read_b64_tr_b16 v[44:45], v2 offset:4096
  ds_read_b64_tr_b16 v[46:47], v2 offset:6144
  ds_read_b128 v[108:111], v14 offset:64
  ds_read_b64_tr_b16 v[48:49], v2 offset:8192
  ds_read_b64_tr_b16 v[50:51], v2 offset:10240
  ds_read_b128 v[112:115], v14 offset:128
  ds_read_b64_tr_b16 v[52:53], v2 offset:12288
  ds_read_b64_tr_b16 v[54:55], v2 offset:14336
  ds_read_b128 v[116:119], v14 offset:192
  ds_read_b64_tr_b16 v[56:57], v2 offset:16384
  ds_read_b64_tr_b16 v[58:59], v2 offset:18432
  ds_read_b128 v[120:123], v14 offset:256
  s_waitcnt lgkmcnt(12)
  v_mfma_f32_16x16x32_bf16 v[8:11], v[40:43], v[104:107], 0
  ds_read_b64_tr_b16 v[60:61], v2 offset:20480
  ds_read_b64_tr_b16 v[62:63], v2 offset:22528
  ds_read_b128 v[124:127], v14 offset:320
  s_waitcnt lgkmcnt(12)
  v_mfma_f32_16x16x32_bf16 v[8:11], v[44:47], v[108:111], v[8:11]
  ds_read_b64_tr_b16 v[64:65], v2 offset:24576
  ds_read_b64_tr_b16 v[66:67], v2 offset:26624
  ds_read_b128 v[128:131], v14 offset:384
  s_waitcnt lgkmcnt(12)
  v_mfma_f32_16x16x32_bf16 v[8:11], v[48:51], v[112:115], v[8:11]
  ds_read_b64_tr_b16 v[68:69], v2 offset:28672
  ds_read_b64_tr_b16 v[70:71], v2 offset:30720
  ds_read_b128 v[132:135], v14 offset:448
  s_waitcnt lgkmcnt(12)
  v_mfma_f32_16x16x32_bf16 v[8:11], v[52:55], v[116:119], v[8:11]
  ds_read_b64_tr_b16 v[72:73], v2 offset:32768
  ds_read_b64_tr_b16 v[74:75], v2 offset:34816
  ds_read_b128 v[136:139], v14 offset:512
  s_waitcnt lgkmcnt(12)
  v_mfma_f32_16x16x32_bf16 v[8:11], v[56:59], v[120:123], v[8:11]
  ds_read_b64_tr_b16 v[76:77], v2 offset:36864
  ds_read_b64_tr_b16 v[78:79], v2 offset:38912
  ds_read_b128 v[140:143], v14 offset:576
  s_waitcnt lgkmcnt(12)
  v_mfma_f32_16x16x32_bf16 v[8:11], v[60:63], v[124:127], v[8:11]
  ds_read_b64_tr_b16 v[80:81], v2 offset:40960
  ds_read_b64_tr_b16 v[82:83], v2 offset:43008
  ds_read_b128 v[144:147], v14 offset:640
  s_waitcnt lgkmcnt(12)
  v_mfma_f32_16x16x32_bf16 v[8:11], v[64:67], v[128:131], v[8:11]
  ds_read_b64_tr_b16 v[84:85], v2 offset:45056
  ds_read_b64_tr_b16 v[86:87], v2 offset:47104
  ds_read_b128 v[148:151], v14 offset:704
  s_waitcnt lgkmcnt(12)
  v_mfma_f32_16x16x32_bf16 v[8:11], v[68:71], v[132:135], v[8:11]
  ds_read_b64_tr_b16 v[88:89], v2 offset:49152
  ds_read_b64_tr_b16 v[90:91], v2 offset:51200
  ds_read_b128 v[152:155], v14 offset:768
  s_waitcnt lgkmcnt(12)
  v_mfma_f32_16x16x32_bf16 v[8:11], v[72:75], v[136:139], v[8:11]
  ds_read_b64_tr_b16 v[92:93], v2 offset:53248
  ds_read_b64_tr_b16 v[94:95], v2 offset:55296
  ds_read_b128 v[156:159], v14 offset:832
  s_waitcnt lgkmcnt(12)
  v_mfma_f32_16x16x32_bf16 v[8:11], v[76:79], v[140:143], v[8:11]
  ds_read_b64_tr_b16 v[96:97], v2 offset:57344
  ds_read_b64_tr_b16 v[98:99], v2 offset:59392
  ds_read_b128 v[160:163], v14 offset:896
  s_waitcnt lgkmcnt(12)
  v_mfma_f32_16x16x32_bf16 v[8:11], v[80:83], v[144:147], v[8:11]
  ds_read_b64_tr_b16 v[100:101], v2 offset:61440
  ds_read_b64_tr_b16 v[102:103], v2 offset:63488
  ds_read_b128 v[164:167], v14 offset:960
  s_waitcnt lgkmcnt(12)
  v_mfma_f32_16x16x32_bf16 v[8:11], v[84:87], v[148:151], v[8:11]
  s_waitcnt lgkmcnt(9)
  v_mfma_f32_16x16x32_bf16 v[8:11], v[88:91], v[152:155], v[8:11]
  s_waitcnt lgkmcnt(6)
  v_mfma_f32_16x16x32_bf16 v[8:11], v[92:95], v[156:159], v[8:11]
  s_waitcnt lgkmcnt(3)
  v_mfma_f32_16x16x32_bf16 v[8:11], v[96:99], v[160:163], v[8:11]
  s_waitcnt lgkmcnt(0)
  v_mfma_f32_16x16x32_bf16 v[8:11], v[100:103], v[164:167], v[8:11]
  s_nop 7
  v_cvt_pk_bf16_f32 v8, v8, v9
  v_cvt_pk_bf16_f32 v10, v10, v11
  v_mov_b32 v9, s74
  v_mov_b32 v11, s74
  s_mov_b32 exec_lo, 0xffffffff
  s_mov_b32 exec_hi, exec_lo
  global_store_dwordx4 v13, v[8:11], s[42:43] sc1
  s_mov_b64 exec, -1
  ds_write_b32 v38, v38 offset:6660
  s_mov_b32 s60, 0
  s_branch L_svc
L_r_q:
  s_lshl_b32 s58, s61, 8
  s_add_u32 s58, s58, 32768
  global_load_dwordx2 v[14:15], v13, s[16:17]
  s_mov_b32 s44, s22
  s_mov_b32 s45, s23
  s_mov_b32 s46, 4194304
  s_mov_b32 s47, 0x20000
  v_lshrrev_b32 v2, 3, v1
  v_and_b32 v3, 6, v2
  v_xor_b32 v3, v3, v1
  v_mul_u32_u24 v2, 8192, v2
  v_and_b32 v3, 7, v3
  v_lshl_add_u32 v2, v3, 4, v2
  s_mul_i32 s49, s5, 1048576
  s_lshl_b32 s50, s5, 14
  s_add_u32 s49, s49, s48
  s_add_u32 s50, s50, 16384
  s_add_u32 s51, s50, 16384
L_dma_11:
  s_mov_b32 m0, s50
  s_add_u32 s50, s50, 1024
  buffer_load_dwordx4 v2, s[44:47], s49 offen nt lds
  s_add_u32 s49, s49, 65536
  s_cmp_lt_u32 s50, s51
  s_cbranch_scc1 L_dma_11
L_dmae_12:
  s_barrier
  s_waitcnt lgkmcnt(0)
  s_mul_i32 s74, s74, 0x9e3779b1
  s_add_u32 s74, s74, 0x7f4a7c15
  s_add_u32 s76, s76, s74
  s_waitcnt vmcnt(16)
  v_bfe_u32 v6, v1, 2, 1
  v_lshlrev_b32 v6, 5, v6
  v_add_u32 v6, 11392, v6
  s_lshl_b32 s49, s5, 3
  v_add_u32 v5, s49, v6
  v_lshlrev_b32 v20, 16, v14
  v_and_b32 v21, s73, v14
  v_lshlrev_b32 v22, 16, v15
  v_and_b32 v23, s73, v15
  v_add_f32 v8, v20, v21
  v_mul_f32 v9, v20, v20
  v_add_f32 v10, v22, v23
  v_mul_f32 v11, v22, v22
  v_fmac_f32 v9, v21, v21
  v_fmac_f32 v11, v23, v23
  v_add_f32 v8, v8, v10
  v_add_f32 v9, v9, v11
  s_nop 0
  v_add_f32_dpp v8, v8, v8 quad_perm:[1,0,3,2] row_mask:0xf bank_mask:0xf
  v_add_f32_dpp v9, v9, v9 quad_perm:[1,0,3,2] row_mask:0xf bank_mask:0xf
  s_nop 0
  v_add_f32_dpp v8, v8, v8 quad_perm:[2,3,0,1] row_mask:0xf bank_mask:0xf
  v_add_f32_dpp v9, v9, v9 quad_perm:[2,3,0,1] row_mask:0xf bank_mask:0xf
  s_nop 0
  v_add_f32_dpp v8, v8, v8 row_ror:8 row_mask:0xf bank_mask:0xf
  v_add_f32_dpp v9, v9, v9 row_ror:8 row_mask:0xf bank_mask:0xf
  s_nop 0
  v_mov_b32 v10, v8
  v_mov_b32 v11, v9
  s_nop 0
  v_permlane16_swap_b32 v10, v8
  v_permlane16_swap_b32 v11, v9
  v_add_f32 v8, v8, v10
  v_add_f32 v9, v9, v11
  v_mov_b32 v10, v8
  v_mov_b32 v11, v9
  s_nop 0
  v_permlane32_swap_b32 v10, v8
  v_permlane32_swap_b32 v11, v9
  v_add_f32 v8, v8, v10
  v_add_f32 v9, v9, v11
  ds_write_b64 v5, v[8:9]
  s_waitcnt vmcnt(0) lgkmcnt(0)
  v_mov_b32 v9, 1
  s_mov_b64 exec, 1
  ds_add_u32 v38, v9 offset:6720
  s_mov_b64 exec, -1
  s_mov_b32 s70, 0
L_sn_13:
  ds_read_b32 v9, v38 offset:6720
  s_waitcnt lgkmcnt(0)
  v_cmp_gt_u32 vcc, 0x4, v9
  s_cmp_eq_u64 vcc, 0
  s_cbranch_scc1 L_snd_14
  s_sleep 1
  s_add_u32 s70, s70, 1
  s_cmp_lt_u32 s70, 2097152
  s_cbranch_scc1 L_sn_13
L_snd_14:
  ds_read_b128 v[24:27], v6
  ds_read_b128 v[28:31], v6 offset:16
  s_waitcnt lgkmcnt(0)
  v_pk_add_f32 v[24:25], v[24:25], v[26:27]
  v_pk_add_f32 v[28:29], v[28:29], v[30:31]
  v_pk_add_f32 v[24:25], v[24:25], v[28:29]
  v_mul_f32 v8, 0x3b000000, v24
  v_mul_f32 v9, 0x3b000000, v25
  v_fma_f32 v9, -v8, v8, v9
  v_cvt_pk_bf16_f32 v8, 0, v8
  v_max_f32 v9, 0, v9
  v_cvt_pk_bf16_f32 v9, 0, v9
  v_sub_f32 v20, v20, v8
  v_sub_f32 v21, v21, v8
  v_add_f32 v9, 0x3727c5ac, v9
  v_sub_f32 v22, v22, v8
  v_sub_f32 v23, v23, v8
  v_cvt_pk_bf16_f32 v9, 0, v9
  v_cvt_pk_bf16_f32 v20, 0, v20
  v_sqrt_f32 v9, v9
  v_cvt_pk_bf16_f32 v21, 0, v21
  v_cvt_pk_bf16_f32 v9, 0, v9
  v_cvt_pk_bf16_f32 v22, 0, v22
  v_rcp_f32 v9, v9
  v_cvt_pk_bf16_f32 v23, 0, v23
  v_mul_f32 v20, v20, v9
  v_mul_f32 v21, v21, v9
  v_mul_f32 v22, v22, v9
  v_mul_f32 v23, v23, v9
  v_cvt_pk_bf16_f32 v20, 0, v20
  v_cvt_pk_bf16_f32 v21, 0, v21
  v_cvt_pk_bf16_f32 v22, 0, v22
  v_cvt_pk_bf16_f32 v23, 0, v23
  v_lshlrev_b32 v15, 4, v0
  s_and_b32 s49, s2, 7
  s_lshl_b32 s49, s49, 13
  s_add_u32 s49, s49, 917504
  v_add_u32 v15, s49, v15
  v_add_u32 v36, 0x1000, v15
  s_mov_b64 s[64:65], -1
  s_mov_b64 s[66:67], -1
  s_mov_b64 exec, s[64:65]
  global_load_dwordx4 v[16:19], v15, s[42:43] sc1
  s_mov_b64 exec, s[66:67]
  global_load_dwordx4 v[32:35], v36, s[42:43] sc1
  s_mov_b64 exec, -1
  v_lshrrev_b32 v2, 2, v1
  v_bfe_u32 v3, v1, 1, 1
  s_lshl_b32 s49, s5, 1
  v_or_b32 v3, s49, v3
  v_and_b32 v10, 6, v2
  v_xor_b32 v3, v3, v10
  v_lshlrev_b32 v2, 7, v2
  v_lshl_add_u32 v2, v3, 4, v2
  v_and_b32 v3, 1, v1
  v_lshl_add_u32 v2, v3, 3, v2
  v_add_u32 v2, 16384, v2
  ds_read_b64_tr_b16 v[40:41], v2 offset:0
  ds_read_b64_tr_b16 v[42:43], v2 offset:2048
  ds_read_b64_tr_b16 v[44:45], v2 offset:4096
  ds_read_b64_tr_b16 v[46:47], v2 offset:6144
  ds_read_b64_tr_b16 v[48:49], v2 offset:8192
  ds_read_b64_tr_b16 v[50:51], v2 offset:10240
  ds_read_b64_tr_b16 v[52:53], v2 offset:12288
  ds_read_b64_tr_b16 v[54:55], v2 offset:14336
  ds_read_b64_tr_b16 v[56:57], v2 offset:16384
  ds_read_b64_tr_b16 v[58:59], v2 offset:18432
  ds_read_b64_tr_b16 v[60:61], v2 offset:20480
  ds_read_b64_tr_b16 v[62:63], v2 offset:22528
  s_waitcnt lgkmcnt(10)
  ds_read_b64_tr_b16 v[64:65], v2 offset:24576
  ds_read_b64_tr_b16 v[66:67], v2 offset:26624
  s_waitcnt lgkmcnt(10)
  ds_read_b64_tr_b16 v[68:69], v2 offset:28672
  ds_read_b64_tr_b16 v[70:71], v2 offset:30720
  s_waitcnt lgkmcnt(10)
  ds_read_b64_tr_b16 v[72:73], v2 offset:32768
  ds_read_b64_tr_b16 v[74:75], v2 offset:34816
  s_waitcnt lgkmcnt(10)
  ds_read_b64_tr_b16 v[76:77], v2 offset:36864
  ds_read_b64_tr_b16 v[78:79], v2 offset:38912
  s_waitcnt lgkmcnt(10)
  ds_read_b64_tr_b16 v[80:81], v2 offset:40960
  ds_read_b64_tr_b16 v[82:83], v2 offset:43008
  s_waitcnt lgkmcnt(10)
  ds_read_b64_tr_b16 v[84:85], v2 offset:45056
  ds_read_b64_tr_b16 v[86:87], v2 offset:47104
  s_waitcnt lgkmcnt(10)
  ds_read_b64_tr_b16 v[88:89], v2 offset:49152
  ds_read_b64_tr_b16 v[90:91], v2 offset:51200
  s_waitcnt lgkmcnt(10)
  ds_read_b64_tr_b16 v[92:93], v2 offset:53248
  ds_read_b64_tr_b16 v[94:95], v2 offset:55296
  s_waitcnt lgkmcnt(10)
  ds_read_b64_tr_b16 v[96:97], v2 offset:57344
  ds_read_b64_tr_b16 v[98:99], v2 offset:59392
  s_waitcnt lgkmcnt(10)
  ds_read_b64_tr_b16 v[100:101], v2 offset:61440
  ds_read_b64_tr_b16 v[102:103], v2 offset:63488
  s_waitcnt lgkmcnt(10)
  s_waitcnt lgkmcnt(0)
  v_and_b32 v13, 1, v1
  v_lshlrev_b32 v13, 14, v13
  v_lshrrev_b32 v3, 4, v1
  v_lshl_add_u32 v13, v3, 4, v13
  s_lshl_b32 s49, s5, 6
  s_add_u32 s49, s49, s58
  v_add_u32 v13, s49, v13
  v_and_b32 v14, 1, v1
  v_mul_u32_u24 v14, 1056, v14
  v_lshrrev_b32 v3, 4, v1
  v_lshl_add_u32 v14, v3, 4, v14
  s_mov_b32 s70, 0
  s_branch L_q_c
L_q_p:
  s_mov_b64 exec, s[64:65]
  global_load_dwordx4 v[16:19], v15, s[42:43] sc1
  s_mov_b64 exec, s[66:67]
  global_load_dwordx4 v[32:35], v36, s[42:43] sc1
  s_mov_b64 exec, -1
L_q_c:
  s_waitcnt vmcnt(0)
  v_cmp_ne_u32 s[64:65], s74, v17
  v_cmp_ne_u32 s[68:69], s74, v19
  s_or_b64 s[64:65], s[64:65], s[68:69]
  v_cmp_ne_u32 s[66:67], s74, v33
  v_cmp_ne_u32 s[68:69], s74, v35
  s_or_b64 s[66:67], s[66:67], s[68:69]
  s_or_b64 vcc, s[64:65], s[66:67]
  s_cmp_eq_u64 vcc, 0
  s_cbranch_scc1 L_q_ok
  s_add_u32 s70, s70, 1
  s_cmp_lt_u32 s70, 262144
  s_cbranch_scc1 L_q_p
L_q_ok:
  v_lshlrev_b32 v28, 16, v32
  v_and_b32 v29, s73, v32
  v_lshlrev_b32 v30, 16, v34
  v_and_b32 v31, s73, v34
  v_lshlrev_b32 v24, 16, v16
  v_and_b32 v25, s73, v16
  v_lshlrev_b32 v26, 16, v18
  v_and_b32 v27, s73, v18
  v_add_f32 v28, 1.0, v28
  v_add_f32 v29, 1.0, v29
  v_add_f32 v30, 1.0, v30
  v_add_f32 v31, 1.0, v31
  v_cvt_pk_bf16_f32 v28, 0, v28
  v_cvt_pk_bf16_f32 v29, 0, v29
  v_cvt_pk_bf16_f32 v30, 0, v30
  v_cvt_pk_bf16_f32 v31, 0, v31
  v_mul_f32 v20, v20, v28
  v_mul_f32 v21, v21, v29
  v_mul_f32 v22, v22, v30
  v_mul_f32 v23, v23, v31
  v_cvt_pk_bf16_f32 v20, 0, v20
  v_cvt_pk_bf16_f32 v21, 0, v21
  v_cvt_pk_bf16_f32 v22, 0, v22
  v_cvt_pk_bf16_f32 v23, 0, v23
  v_add_f32 v20, v20, v24
  v_add_f32 v21, v21, v25
  v_add_f32 v22, v22, v26
  v_add_f32 v23, v23, v27
  v_cvt_pk_bf16_f32 v16, v20, v21
  v_cvt_pk_bf16_f32 v17, v22, v23
  ds_write_b64 v12, v[16:17] offset:0
  v_mov_b32 v9, 1
  s_mov_b64 exec, 1
  ds_add_u32 v38, v9 offset:6720
  s_mov_b64 exec, -1
  s_mov_b32 s70, 0
L_sn_15:
  ds_read_b32 v9, v38 offset:6720
  s_waitcnt lgkmcnt(0)
  v_cmp_gt_u32 vcc, 0x8, v9
  s_cmp_eq_u64 vcc, 0
  s_cbranch_scc1 L_snd_16
  s_add_u32 s70, s70, 1
  s_cmp_lt_u32 s70, 2097152
  s_cbranch_scc1 L_sn_15
L_snd_16:
  ds_write_b32 v38, v38 offset:6660
  ds_read_b128 v[104:107], v14 offset:0
  ds_read_b128 v[108:111], v14 offset:64
  ds_read_b128 v[112:115], v14 offset:128
  ds_read_b128 v[116:119], v14 offset:192
  ds_read_b128 v[120:123], v14 offset:256
  ds_read_b128 v[124:127], v14 offset:320
  ds_read_b128 v[128:131], v14 offset:384
  ds_read_b128 v[132:135], v14 offset:448
  ds_read_b128 v[136:139], v14 offset:512
  ds_read_b128 v[140:143], v14 offset:576
  ds_read_b128 v[144:147], v14 offset:640
  ds_read_b128 v[148:151], v14 offset:704
  s_waitcnt lgkmcnt(11)
  v_mfma_f32_16x16x32_bf16 v[8:11], v[40:43], v[104:107], 0
  ds_read_b128 v[152:155], v14 offset:768
  s_waitcnt lgkmcnt(11)
  v_mfma_f32_16x16x32_bf16 v[8:11], v[44:47], v[108:111], v[8:11]
  ds_read_b128 v[156:159], v14 offset:832
  s_waitcnt lgkmcnt(11)
  v_mfma_f32_16x16x32_bf16 v[8:11], v[48:51], v[112:115], v[8:11]
  ds_read_b128 v[160:163], v14 offset:896
  s_waitcnt lgkmcnt(11)
  v_mfma_f32_16x16x32_bf16 v[8:11], v[52:55], v[116:119], v[8:11]
  ds_read_b128 v[164:167], v14 offset:960
  s_waitcnt lgkmcnt(11)
  v_mfma_f32_16x16x32_bf16 v[8:11], v[56:59], v[120:123], v[8:11]
  s_waitcnt lgkmcnt(10)
  v_mfma_f32_16x16x32_bf16 v[8:11], v[60:63], v[124:127], v[8:11]
  s_waitcnt lgkmcnt(9)
  v_mfma_f32_16x16x32_bf16 v[8:11], v[64:67], v[128:131], v[8:11]
  s_waitcnt lgkmcnt(8)
  v_mfma_f32_16x16x32_bf16 v[8:11], v[68:71], v[132:135], v[8:11]
  s_waitcnt lgkmcnt(7)
  v_mfma_f32_16x16x32_bf16 v[8:11], v[72:75], v[136:139], v[8:11]
  s_waitcnt lgkmcnt(6)
  v_mfma_f32_16x16x32_bf16 v[8:11], v[76:79], v[140:143], v[8:11]
  s_waitcnt lgkmcnt(5)
  v_mfma_f32_16x16x32_bf16 v[8:11], v[80:83], v[144:147], v[8:11]
  s_waitcnt lgkmcnt(4)
  v_mfma_f32_16x16x32_bf16 v[8:11], v[84:87], v[148:151], v[8:11]
  s_waitcnt lgkmcnt(3)
  v_mfma_f32_16x16x32_bf16 v[8:11], v[88:91], v[152:155], v[8:11]
  s_waitcnt lgkmcnt(2)
  v_mfma_f32_16x16x32_bf16 v[8:11], v[92:95], v[156:159], v[8:11]
  s_waitcnt lgkmcnt(1)
  v_mfma_f32_16x16x32_bf16 v[8:11], v[96:99], v[160:163], v[8:11]
  s_waitcnt lgkmcnt(0)
  v_mfma_f32_16x16x32_bf16 v[8:11], v[100:103], v[164:167], v[8:11]
  s_nop 7
  v_cvt_pk_bf16_f32 v8, v8, v9
  v_cvt_pk_bf16_f32 v10, v10, v11
  v_mov_b32 v9, s74
  v_mov_b32 v11, s74
  v_min_u32 v8, s72, v8
  v_min_u32 v10, s72, v10
  s_mov_b32 exec_lo, 0x00030003
  s_mov_b32 exec_hi, 0x00030003
  global_store_dwordx4 v13, v[8:11], s[42:43] sc1
  s_mov_b64 exec, -1
  s_mov_b32 s60, 0
  s_branch L_svc
L_r_modb:
  s_lshl_b32 s48, s61, 7
  s_lshl_b32 s58, s61, 9
  s_add_u32 s58, s58, 4096
  s_mov_b32 s44, s36
  s_mov_b32 s45, s37
  s_mov_b32 s46, 3145728
  s_mov_b32 s47, 0x20000
  global_load_dwordx2 v[14:15], v13, s[34:35]
  s_waitcnt lgkmcnt(0)
  s_mul_i32 s74, s74, 0x9e3779b1
  s_add_u32 s74, s74, 0x7f4a7c15
  s_add_u32 s76, s76, s74
  s_waitcnt vmcnt(0)
  v_lshlrev_b32 v16, 16, v14
  v_and_b32 v17, s73, v14
  v_lshlrev_b32 v18, 16, v15
  v_and_b32 v19, s73, v15
  v_mul_f32 v20, 0xbfb8aa3b, v16
  v_mul_f32 v21, 0xbfb8aa3b, v17
  v_mul_f32 v22, 0xbfb8aa3b, v18
  v_mul_f32 v23, 0xbfb8aa3b, v19
  v_exp_f32 v20, v20
  v_exp_f32 v21, v21
  v_exp_f32 v22, v22
  v_exp_f32 v23, v23
  s_nop 0
  v_add_f32 v20, 1.0, v20
  v_add_f32 v21, 1.0, v21
  v_add_f32 v22, 1.0, v22
  v_add_f32 v23, 1.0, v23
  v_rcp_f32 v20, v20
  v_rcp_f32 v21, v21
  v_rcp_f32 v22, v22
  v_rcp_f32 v23, v23
  s_nop 0
  v_mul_f32 v16, v16, v20
  v_mul_f32 v17, v17, v21
  v_mul_f32 v18, v18, v22
  v_mul_f32 v19, v19, v23
  v_cvt_pk_bf16_f32 v14, v16, v17
  v_cvt_pk_bf16_f32 v15, v18, v19
  ds_write_b64 v12, v[14:15] offset:0
  s_mov_b32 s60, 4
  s_sub_u32 s53, s5, 1
  s_cmp_gt_u32 s53, 1
  s_cbranch_scc1 L_sig
  v_lshrrev_b32 v2, 3, v1
  v_and_b32 v3, 6, v2
  v_xor_b32 v3, v3, v1
  v_mul_u32_u24 v2, 6144, v2
  v_and_b32 v3, 7, v3
  v_lshl_add_u32 v2, v3, 4, v2
  s_mul_i32 s49, s53, 1572864
  s_lshl_b32 s50, s53, 15
  s_add_u32 s49, s49, s48
  s_add_u32 s50, s50, 16384
  s_add_u32 s51, s50, 32768
L_dma_17:
  s_mov_b32 m0, s50
  s_add_u32 s50, s50, 1024
  buffer_load_dwordx4 v2, s[44:47], s49 offen nt lds
  s_add_u32 s49, s49, 49152
  s_waitcnt vmcnt(3)
  s_cmp_lt_u32 s50, s51
  s_cbranch_scc1 L_dma_17
L_dmae_18:
  s_branch L_sig
L_r_wo:
  s_lshl_b32 s48, s8, 19
  s_lshl_b32 s49, s61, 7
  s_add_u32 s48, s48, s49
  s_lshl_b32 s58, s8, 12
  s_lshl_b32 s49, s61, 9
  s_add_u32 s58, s58, s49
  s_add_u32 s58, s58, 262144
  s_mov_b32 s44, s24
  s_mov_b32 s45, s25
  s_mov_b32 s46, 4194304
  s_mov_b32 s47, 0x20000
  s_waitcnt lgkmcnt(0)
  s_mul_i32 s74, s74, 0x9e3779b1
  s_add_u32 s74, s74, 0x7f4a7c15
  s_add_u32 s76, s76, s74
  s_cmp_lg_u32 s5, 3
  s_cbranch_scc1 L_sig_19
  s_lshl_b32 s56, s8, 5
  s_add_u32 s56, s56, s61
  s_lshl_b32 s56, s56, 2
  v_mov_b32 v8, s56
  v_mov_b32 v9, s76
  s_mov_b64 exec, 1
  global_store_dword v8, v9, s[42:43] offset:1024 sc1
  s_mov_b64 exec, -1
L_sig_19:
  s_mov_b32 s60, 1
  s_sub_u32 s53, s5, 1
  s_cmp_gt_u32 s53, 1
  s_cbranch_scc1 L_sig
  v_lshrrev_b32 v2, 3, v1
  v_and_b32 v3, 6, v2
  v_xor_b32 v3, v3, v1
  v_mul_u32_u24 v2, 1024, v2
  v_and_b32 v3, 7, v3
  v_lshl_add_u32 v2, v3, 4, v2
  s_mul_i32 s49, s53, 262144
  s_lshl_b32 s50, s53, 15
  s_add_u32 s49, s49, s48
  s_add_u32 s50, s50, 16384
  s_add_u32 s51, s50, 32768
L_dma_20:
  s_mov_b32 m0, s50
  s_add_u32 s50, s50, 1024
  buffer_load_dwordx4 v2, s[44:47], s49 offen nt lds
  s_add_u32 s49, s49, 8192
  s_waitcnt vmcnt(3)
  s_cmp_lt_u32 s50, s51
  s_cbranch_scc1 L_dma_20
L_dmae_21:
  s_branch L_sig
L_r_f1:
  s_lshl_b32 s48, s61, 6
  s_lshl_b32 s58, s61, 12
  s_add_u32 s58, s58, 294912
  s_waitcnt lgkmcnt(0)
  s_mul_i32 s74, s74, 0x9e3779b1
  s_add_u32 s74, s74, 0x7f4a7c15
  s_add_u32 s76, s76, s74
  s_cmp_lt_u32 s5, 2
  s_cselect_b32 s44, s28, s30
  s_cselect_b32 s45, s29, s31
  s_mov_b32 s46, 1409024
  s_mov_b32 s47, 0x20000
  s_mov_b32 s60, 2
  s_sub_u32 s53, s5, 1
  s_cmp_gt_u32 s53, 1
  s_cbranch_scc1 L_sig
  s_and_b32 s54, s61, 1
  v_lshrrev_b32 v2, 2, v1
  v_mul_u32_u24 v2, 5504, v2
  s_and_b32 s49, s5, 2
  s_or_b32 s49, s49, s54
  v_xor_b32 v3, s49, v1
  v_and_b32 v3, 3, v3
  v_lshl_add_u32 v2, v3, 4, v2
  s_mul_i32 s49, s54, 2752
  s_add_u32 s49, s49, s48
  s_lshl_b32 s50, s53, 15
  s_lshl_b32 s54, s54, 14
  s_add_u32 s50, s50, s54
  s_add_u32 s50, s50, 16384
  s_add_u32 s51, s50, 16384
L_dma_22:
  s_mov_b32 m0, s50
  s_add_u32 s50, s50, 1024
  buffer_load_dwordx4 v2, s[44:47], s49 offen  lds
  s_add_u32 s49, s49, 88064
  s_waitcnt vmcnt(2)
  s_cmp_lt_u32 s50, s51
  s_cbranch_scc1 L_dma_22
L_dmae_23:
  s_andn2_b32 s54, 1, s61
  v_lshrrev_b32 v2, 2, v1
  v_mul_u32_u24 v2, 5504, v2
  s_and_b32 s49, s5, 2
  s_or_b32 s49, s49, s54
  v_xor_b32 v3, s49, v1
  v_and_b32 v3, 3, v3
  v_lshl_add_u32 v2, v3, 4, v2
  s_mul_i32 s49, s54, 2752
  s_add_u32 s49, s49, s48
  s_lshl_b32 s50, s53, 15
  s_lshl_b32 s54, s54, 14
  s_add_u32 s50, s50, s54
  s_add_u32 s50, s50, 16384
  s_add_u32 s51, s50, 16384
L_dma_24:
  s_mov_b32 m0, s50
  s_add_u32 s50, s50, 1024
  buffer_load_dwordx4 v2, s[44:47], s49 offen nt lds
  s_add_u32 s49, s49, 88064
  s_waitcnt vmcnt(2)
  s_cmp_lt_u32 s50, s51
  s_cbranch_scc1 L_dma_24
L_dmae_25:
  s_mov_b32 s44, s32
  s_mov_b32 s45, s33
  s_mov_b32 s46, 1409024
  s_mov_b32 s47, 0x20000
  v_lshlrev_b32 v2, 4, v1
  s_lshl_b32 s49, s61, 1
  s_add_u32 s49, s49, s53
  s_lshl_b32 s49, s49, 14
  s_mul_i32 s50, s53, 16896
  s_add_u32 s50, s50, 98304
  s_add_u32 s51, s50, 16896
L_dma_26:
  s_mov_b32 m0, s50
  s_add_u32 s50, s50, 1056
  buffer_load_dwordx4 v2, s[44:47], s49 offen nt lds
  s_add_u32 s49, s49, 1024
  s_waitcnt vmcnt(5)
  s_cmp_lt_u32 s50, s51
  s_cbranch_scc1 L_dma_26
L_dmae_27:
  s_branch L_sig
L_r_f2:
  s_mov_b32 s60, 3
  s_cmp_lg_u32 s5, 3
  s_cbranch_scc1 L_tch_28
  s_and_b32 s49, s61, 3
  s_lshl_b32 s49, s49, 7
  v_add_u32 v8, s49, v1
  s_bfe_u32 s50, s14, 0x50003
  s_cmp_eq_u32 s50, 0
  s_cbranch_scc1 L_tchm_29
  s_lshl_b32 s50, s50, 10
  s_sub_u32 s50, s50, 640
  v_mul_u32_u24 v9, 6144, v8
  v_add_u32 v9, s50, v9
  global_load_dword v167, v9, s[36:37]
  v_add_u32 v10, 393216, v9
  global_load_dword v167, v10, s[36:37]
L_tchm_29:
  s_lshl_b32 s50, s8, 10
  s_add_u32 s50, s50, 384
  v_mul_u32_u24 v9, 8192, v8
  v_add_u32 v9, s50, v9
  global_load_dword v167, v9, s[22:23]
  v_add_u32 v10, 524288, v9
  global_load_dword v167, v10, s[22:23]
L_tch_28:
  s_waitcnt lgkmcnt(0)
  s_mul_i32 s74, s74, 0x9e3779b1
  s_add_u32 s74, s74, 0x7f4a7c15
  s_add_u32 s76, s76, s74
  s_branch L_svc
L_r_none:
  s_mov_b32 s60, 0
  s_waitcnt lgkmcnt(0)
  s_mul_i32 s74, s74, 0x9e3779b1
  s_add_u32 s74, s74, 0x7f4a7c15
  s_add_u32 s76, s76, s74
  s_branch L_svc
L_sig:
  s_waitcnt vmcnt(0) lgkmcnt(0)
  v_mov_b32 v9, 1
  s_mov_b64 exec, 1
  ds_add_u32 v38, v9 offset:6720
  s_mov_b64 exec, -1
L_svc:
  s_cmp_eq_u32 s5, 3
  s_cbranch_scc1 L_svc3
  s_cmp_lg_u32 s5, 0
  s_cbranch_scc1 L_mid
  s_lshl_b32 s64, s6, 2
  s_add_u32 s64, s64, s7
  s_lshl_b32 s64, s64, 7
  s_add_u32 s64, s64, 65536
  v_mov_b32 v18, s64
  s_mov_b32 s70, 0
L_sn_30:
  ds_read_b64 v[8:9], v38 offset:6680
  s_waitcnt lgkmcnt(0)
  v_and_b32 v8, 0xffff, v8
  v_cmp_gt_u32 vcc, 0x200, v8
  s_cmp_eq_u64 vcc, 0
  s_cbranch_scc1 L_snd_31
  s_sleep 2
  s_add_u32 s70, s70, 1
  s_cmp_lt_u32 s70, 2097152
  s_cbranch_scc1 L_sn_30
L_snd_31:
  v_mov_b32 v8, v9
  v_mov_b32 v9, s74
  s_mov_b64 exec, 1
  global_store_dwordx2 v18, v[8:9], s[42:43] sc1
  s_mov_b64 exec, -1
  s_lshl_b32 s64, s8, 7
  s_load_dwordx8 s[20:27], s[42:43], s64 offset:1024 glc
  s_waitcnt lgkmcnt(0)
  s_xor_b32 s68, s20, s76
  s_xor_b32 s69, s21, s76
  s_or_b32 s68, s68, s69
  s_xor_b32 s69, s22, s76
  s_or_b32 s68, s68, s69
  s_xor_b32 s69, s23, s76
  s_or_b32 s68, s68, s69
  s_xor_b32 s69, s24, s76
  s_or_b32 s68, s68, s69
  s_xor_b32 s69, s25, s76
  s_or_b32 s68, s68, s69
  s_xor_b32 s69, s26, s76
  s_or_b32 s68, s68, s69
  s_xor_b32 s69, s27, s76
  s_or_b32 s68, s68, s69
  s_cselect_b32 s68, 0, 1
  v_mov_b32 v8, s68
  s_mov_b64 exec, 1
  ds_add_u32 v38, v8 offset:6712
  s_mov_b64 exec, -1
  s_branch L_mid
L_svc3:
  s_mov_b32 s70, 0
L_sn_32:
  ds_read_b32 v8, v38 offset:6680
  s_waitcnt lgkmcnt(0)
  v_cmp_gt_u32 vcc, 0x100, v8
  s_cmp_eq_u64 vcc, 0
  s_cbranch_scc1 L_snd_33
  s_sleep 4
  s_add_u32 s70, s70, 1
  s_cmp_lt_u32 s70, 2097152
  s_cbranch_scc1 L_sn_32
L_snd_33:
  s_lshl_b32 s64, s6, 9
  s_xor_b32 s54, s7, 1
  s_lshl_b32 s54, s54, 7
  s_add_u32 s54, s54, s64
  s_xor_b32 s55, s7, 2
  s_lshl_b32 s55, s55, 7
  s_add_u32 s55, s55, s64
  s_xor_b32 s56, s7, 3
  s_lshl_b32 s56, s56, 7
  s_add_u32 s56, s56, s64
  s_mov_b32 s70, 0
L_s3e:
  s_load_dwordx2 s[20:21], s[42:43], s54 offset:65536 glc
  s_load_dwordx2 s[24:25], s[42:43], s55 offset:65536 glc
  s_load_dwordx2 s[28:29], s[42:43], s56 offset:65536 glc
  s_waitcnt lgkmcnt(0)
  s_xor_b32 s68, s21, s74
  s_xor_b32 s69, s25, s74
  s_or_b32 s68, s68, s69
  s_xor_b32 s69, s29, s74
  s_or_b32 s68, s68, s69
  s_cbranch_scc0 L_s3ed
  s_sleep 2
  s_add_u32 s70, s70, 1
  s_cmp_lt_u32 s70, 262144
  s_cbranch_scc1 L_s3e
L_s3ed:
  v_mov_b32 v8, s20
  v_mov_b32 v10, s24
  v_mov_b32 v16, s28
  v_max3_f32 v18, v8, v10, v16
  v_mov_b32 v19, 0x10000
  v_med3_f32 v17, v8, v10, v16
  v_mov_b32 v16, v18
  s_mov_b64 exec, 1
  ds_write_b64 v38, v[16:17] offset:6728
  ds_add_u32 v38, v19 offset:6680
  s_mov_b64 exec, -1
L_mid:
  s_bfe_u32 s32, s74, 0x80000
  s_bfe_u32 s33, s74, 0x80008
  s_bfe_u32 s34, s74, 0x80010
  s_bfe_u32 s35, s74, 0x80018
  s_cmp_eq_u32 s60, 2
  s_cbranch_scc1 L_pre_f1
  s_cmp_eq_u32 s60, 3
  s_cbranch_scc1 L_pre_f2
  s_cmp_eq_u32 s60, 1
  s_cbranch_scc1 L_pre_wo
  s_cmp_lg_u32 s60, 4
  s_cbranch_scc1 L_svd
  v_and_b32 v13, 1, v1
  v_lshlrev_b32 v13, 6, v13
  v_lshrrev_b32 v3, 4, v1
  v_lshl_add_u32 v13, v3, 4, v13
  s_lshl_b32 s49, s5, 7
  s_add_u32 s49, s49, s58
  v_add_u32 v13, s49, v13
  v_and_b32 v14, 1, v1
  v_mul_u32_u24 v14, 1056, v14
  v_lshrrev_b32 v3, 4, v1
  v_lshl_add_u32 v14, v3, 4, v14
  v_lshrrev_b32 v2, 2, v1
  v_bfe_u32 v3, v1, 1, 1
  s_lshl_b32 s49, s5, 1
  v_or_b32 v3, s49, v3
  v_and_b32 v10, 6, v2
  v_xor_b32 v3, v3, v10
  v_lshlrev_b32 v2, 7, v2
  v_lshl_add_u32 v2, v3, 4, v2
  v_and_b32 v3, 1, v1
  v_lshl_add_u32 v2, v3, 3, v2
  v_add_u32 v2, 16384, v2
  s_mov_b32 s70, 0
L_sn_34:
  ds_read_b32 v9, v38 offset:6720
  s_waitcnt lgkmcnt(0)
  v_cmp_gt_u32 vcc, 0x4, v9
  s_cmp_eq_u64 vcc, 0
  s_cbranch_scc1 L_snd_35
  s_sleep 8
  s_add_u32 s70, s70, 1
  s_cmp_lt_u32 s70, 2097152
  s_cbranch_scc1 L_sn_34
L_snd_35:
  ds_read_b64_tr_b16 v[40:41], v2 offset:0
  ds_read_b64_tr_b16 v[42:43], v2 offset:2048
  ds_read_b128 v[104:107], v14 offset:0
  ds_read_b64_tr_b16 v[44:45], v2 offset:4096
  ds_read_b64_tr_b16 v[46:47], v2 offset:6144
  ds_read_b128 v[108:111], v14 offset:64
  ds_read_b64_tr_b16 v[48:49], v2 offset:8192
  ds_read_b64_tr_b16 v[50:51], v2 offset:10240
  ds_read_b128 v[112:115], v14 offset:128
  ds_read_b64_tr_b16 v[52:53], v2 offset:12288
  ds_read_b64_tr_b16 v[54:55], v2 offset:14336
  ds_read_b128 v[116:119], v14 offset:192
  ds_read_b64_tr_b16 v[56:57], v2 offset:16384
  ds_read_b64_tr_b16 v[58:59], v2 offset:18432
  ds_read_b128 v[120:123], v14 offset:256
  s_waitcnt lgkmcnt(12)
  v_mfma_f32_16x16x32_bf16 v[8:11], v[40:43], v[104:107], 0
  ds_read_b64_tr_b16 v[60:61], v2 offset:20480
  ds_read_b64_tr_b16 v[62:63], v2 offset:22528
  ds_read_b128 v[124:127], v14 offset:320
  s_waitcnt lgkmcnt(12)
  v_mfma_f32_16x16x32_bf16 v[8:11], v[44:47], v[108:111], v[8:11]
  ds_read_b64_tr_b16 v[64:65], v2 offset:24576
  ds_read_b64_tr_b16 v[66:67], v2 offset:26624
  ds_read_b128 v[128:131], v14 offset:384
  s_waitcnt lgkmcnt(12)
  v_mfma_f32_16x16x32_bf16 v[8:11], v[48:51], v[112:115], v[8:11]
  ds_read_b64_tr_b16 v[68:69], v2 offset:28672
  ds_read_b64_tr_b16 v[70:71], v2 offset:30720
  ds_read_b128 v[132:135], v14 offset:448
  s_waitcnt lgkmcnt(12)
  v_mfma_f32_16x16x32_bf16 v[8:11], v[52:55], v[116:119], v[8:11]
  ds_read_b64_tr_b16 v[72:73], v2 offset:32768
  ds_read_b64_tr_b16 v[74:75], v2 offset:34816
  ds_read_b128 v[136:139], v14 offset:512
  s_waitcnt lgkmcnt(12)
  v_mfma_f32_16x16x32_bf16 v[8:11], v[56:59], v[120:123], v[8:11]
  ds_read_b64_tr_b16 v[76:77], v2 offset:36864
  ds_read_b64_tr_b16 v[78:79], v2 offset:38912
  ds_read_b128 v[140:143], v14 offset:576
  s_waitcnt lgkmcnt(12)
  v_mfma_f32_16x16x32_bf16 v[8:11], v[60:63], v[124:127], v[8:11]
  ds_read_b64_tr_b16 v[80:81], v2 offset:40960
  ds_read_b64_tr_b16 v[82:83], v2 offset:43008
  ds_read_b128 v[144:147], v14 offset:640
  s_waitcnt lgkmcnt(12)
  v_mfma_f32_16x16x32_bf16 v[8:11], v[64:67], v[128:131], v[8:11]
  ds_read_b64_tr_b16 v[84:85], v2 offset:45056
  ds_read_b64_tr_b16 v[86:87], v2 offset:47104
  ds_read_b128 v[148:151], v14 offset:704
  s_waitcnt lgkmcnt(12)
  v_mfma_f32_16x16x32_bf16 v[8:11], v[68:71], v[132:135], v[8:11]
  ds_read_b64_tr_b16 v[88:89], v2 offset:49152
  ds_read_b64_tr_b16 v[90:91], v2 offset:51200
  ds_read_b128 v[152:155], v14 offset:768
  s_waitcnt lgkmcnt(12)
  v_mfma_f32_16x16x32_bf16 v[8:11], v[72:75], v[136:139], v[8:11]
  ds_read_b64_tr_b16 v[92:93], v2 offset:53248
  ds_read_b64_tr_b16 v[94:95], v2 offset:55296
  ds_read_b128 v[156:159], v14 offset:832
  s_waitcnt lgkmcnt(12)
  v_mfma_f32_16x16x32_bf16 v[8:11], v[76:79], v[140:143], v[8:11]
  ds_read_b64_tr_b16 v[96:97], v2 offset:57344
  ds_read_b64_tr_b16 v[98:99], v2 offset:59392
  ds_read_b128 v[160:163], v14 offset:896
  s_waitcnt lgkmcnt(12)
  v_mfma_f32_16x16x32_bf16 v[8:11], v[80:83], v[144:147], v[8:11]
  ds_read_b64_tr_b16 v[100:101], v2 offset:61440
  ds_read_b64_tr_b16 v[102:103], v2 offset:63488
  ds_read_b128 v[164:167], v14 offset:960
  s_waitcnt lgkmcnt(12)
  v_mfma_f32_16x16x32_bf16 v[8:11], v[84:87], v[148:151], v[8:11]
  s_waitcnt lgkmcnt(9)
  v_mfma_f32_16x16x32_bf16 v[8:11], v[88:91], v[152:155], v[8:11]
  s_waitcnt lgkmcnt(6)
  v_mfma_f32_16x16x32_bf16 v[8:11], v[92:95], v[156:159], v[8:11]
  s_waitcnt lgkmcnt(3)
  v_mfma_f32_16x16x32_bf16 v[8:11], v[96:99], v[160:163], v[8:11]
  s_waitcnt lgkmcnt(0)
  v_mfma_f32_16x16x32_bf16 v[8:11], v[100:103], v[164:167], v[8:11]
  s_nop 7
  v_cvt_pk_bf16_f32 v8, v8, v9
  v_cvt_pk_bf16_f32 v10, v10, v11
  v_mov_b32 v9, s74
  v_mov_b32 v11, s74
  s_mov_b32 exec_lo, 0x00030003
  s_mov_b32 exec_hi, 0x00030003
  global_store_dwordx4 v13, v[8:11], s[42:43] sc1
  s_mov_b64 exec, -1
  s_branch L_svd
L_pre_wo:
  s_mov_b32 s70, 0
L_sn_36:
  ds_read_b32 v9, v38 offset:6720
  s_waitcnt lgkmcnt(0)
  v_cmp_gt_u32 vcc, 0x4, v9
  s_cmp_eq_u64 vcc, 0
  s_cbranch_scc1 L_snd_37
  s_sleep 8
  s_add_u32 s70, s70, 1
  s_cmp_lt_u32 s70, 2097152
  s_cbranch_scc1 L_sn_36
L_snd_37:
  v_lshrrev_b32 v2, 2, v1
  v_bfe_u32 v3, v1, 1, 1
  s_lshl_b32 s49, s5, 1
  v_or_b32 v3, s49, v3
  v_and_b32 v10, 6, v2
  v_xor_b32 v3, v3, v10
  v_lshlrev_b32 v2, 7, v2
  v_lshl_add_u32 v2, v3, 4, v2
  v_and_b32 v3, 1, v1
  v_lshl_add_u32 v2, v3, 3, v2
  v_add_u32 v2, 16384, v2
  ds_read_b64_tr_b16 v[40:41], v2 offset:0
  ds_read_b64_tr_b16 v[42:43], v2 offset:2048
  ds_read_b64_tr_b16 v[44:45], v2 offset:4096
  ds_read_b64_tr_b16 v[46:47], v2 offset:6144
  ds_read_b64_tr_b16 v[48:49], v2 offset:8192
  ds_read_b64_tr_b16 v[50:51], v2 offset:10240
  ds_read_b64_tr_b16 v[52:53], v2 offset:12288
  ds_read_b64_tr_b16 v[54:55], v2 offset:14336
  ds_read_b64_tr_b16 v[56:57], v2 offset:16384
  ds_read_b64_tr_b16 v[58:59], v2 offset:18432
  ds_read_b64_tr_b16 v[60:61], v2 offset:20480
  ds_read_b64_tr_b16 v[62:63], v2 offset:22528
  s_waitcnt lgkmcnt(10)
  ds_read_b64_tr_b16 v[64:65], v2 offset:24576
  ds_read_b64_tr_b16 v[66:67], v2 offset:26624
  s_waitcnt lgkmcnt(10)
  ds_read_b64_tr_b16 v[68:69], v2 offset:28672
  ds_read_b64_tr_b16 v[70:71], v2 offset:30720
  s_waitcnt lgkmcnt(10)
  ds_read_b64_tr_b16 v[72:73], v2 offset:32768
  ds_read_b64_tr_b16 v[74:75], v2 offset:34816
  s_waitcnt lgkmcnt(10)
  ds_read_b64_tr_b16 v[76:77], v2 offset:36864
  ds_read_b64_tr_b16 v[78:79], v2 offset:38912
  s_waitcnt lgkmcnt(10)
  ds_read_b64_tr_b16 v[80:81], v2 offset:40960
  ds_read_b64_tr_b16 v[82:83], v2 offset:43008
  s_waitcnt lgkmcnt(10)
  ds_read_b64_tr_b16 v[84:85], v2 offset:45056
  ds_read_b64_tr_b16 v[86:87], v2 offset:47104
  s_waitcnt lgkmcnt(10)
  ds_read_b64_tr_b16 v[88:89], v2 offset:49152
  ds_read_b64_tr_b16 v[90:91], v2 offset:51200
  s_waitcnt lgkmcnt(10)
  ds_read_b64_tr_b16 v[92:93], v2 offset:53248
  ds_read_b64_tr_b16 v[94:95], v2 offset:55296
  s_waitcnt lgkmcnt(10)
  ds_read_b64_tr_b16 v[96:97], v2 offset:57344
  ds_read_b64_tr_b16 v[98:99], v2 offset:59392
  s_waitcnt lgkmcnt(10)
  ds_read_b64_tr_b16 v[100:101], v2 offset:61440
  ds_read_b64_tr_b16 v[102:103], v2 offset:63488
  s_waitcnt lgkmcnt(10)
  s_waitcnt lgkmcnt(0)
  s_lshl_b32 s49, s8, 2
  s_add_u32 s49, s49, s5
  s_lshl_b32 s49, s49, 11
  s_add_u32 s49, s49, 131072
  v_lshrrev_b32 v12, 5, v1
  v_and_b32 v16, 31, v1
  v_lshlrev_b32 v15, 16, v12
  v_lshl_add_u32 v15, v16, 4, v15
  v_add_u32 v15, s49, v15
  v_mul_u32_u24 v12, 1056, v12
  v_bfe_u32 v16, v1, 3, 2
  v_lshl_add_u32 v12, v16, 6, v12
  v_and_b32 v16, 3, v1
  v_lshl_add_u32 v12, v16, 4, v12
  v_bfe_u32 v16, v1, 2, 1
  v_lshl_add_u32 v12, v16, 3, v12
  s_lshl_b32 s49, s5, 8
  v_add_u32 v12, s49, v12
  v_and_b32 v14, 1, v1
  v_mul_u32_u24 v14, 1056, v14
  v_lshrrev_b32 v3, 4, v1
  v_lshl_add_u32 v14, v3, 4, v14
  v_and_b32 v13, 1, v1
  v_lshlrev_b32 v13, 6, v13
  v_lshrrev_b32 v3, 4, v1
  v_lshl_add_u32 v13, v3, 4, v13
  s_lshl_b32 s49, s5, 7
  s_add_u32 s49, s49, s58
  v_add_u32 v13, s49, v13
  v_mov_b32 v36, 0xff
  s_branch L_svd
L_pre_f1:
  v_mov_b32 v37, v13
  v_lshlrev_b32 v15, 4, v0
  v_add_u32 v39, 16384, v15
  v_add_u32 v15, 266240, v15
  v_bfe_u32 v6, v1, 2, 1
  v_lshlrev_b32 v6, 5, v6
  v_add_u32 v6, 11392, v6
  s_lshl_b32 s49, s5, 3
  v_add_u32 v5, s49, v6
  v_and_b32 v14, 7, v1
  v_mul_u32_u24 v14, 1056, v14
  v_lshrrev_b32 v3, 4, v1
  v_lshl_add_u32 v14, v3, 4, v14
  v_and_b32 v7, 1, v1
  v_lshlrev_b32 v7, 5, v7
  v_and_b32 v13, 1, v1
  v_lshlrev_b32 v13, 6, v13
  v_lshrrev_b32 v3, 4, v1
  v_lshl_add_u32 v13, v3, 4, v13
  s_lshl_b32 s49, s5, 10
  s_add_u32 s49, s49, s58
  v_add_u32 v13, s49, v13
  v_bfe_u32 v3, v1, 1, 3
  v_lshl_add_u32 v13, v3, 7, v13
  v_lshrrev_b32 v2, 3, v1
  v_lshlrev_b32 v2, 6, v2
  v_bfe_u32 v3, v1, 2, 1
  v_lshl_add_u32 v2, v3, 14, v2
  v_and_b32 v8, 2, v1
  v_or_b32 v3, v3, v8
  v_xor_b32 v3, s5, v3
  v_lshl_add_u32 v2, v3, 4, v2
  v_lshl_add_u32 v2, v8, 14, v2
  v_and_b32 v3, 1, v1
  v_lshl_add_u32 v2, v3, 3, v2
  v_add_u32 v2, 16384, v2
  s_branch L_svd
L_pre_f2:
  v_bfe_u32 v12, v1, 2, 1
  v_and_b32 v14, 3, v1
  s_lshl_b32 s49, s61, 5
  v_lshl_add_u32 v3, v14, 3, s49
  v_lshl_add_u32 v37, v12, 10, v3
  v_and_b32 v15, 7, v1
  s_lshl_b32 s49, s61, 7
  v_lshl_add_u32 v15, v15, 4, s49
  v_add_u32 v39, 16384, v15
  v_lshrrev_b32 v3, 3, v1
  v_lshl_add_u32 v15, v3, 12, v15
  v_add_u32 v15, 262144, v15
L_svd:
  s_cmp_eq_u32 s5, 3
  s_cbranch_scc1 L_svd3
  s_cmp_eq_u32 s5, 2
  s_cbranch_scc1 L_svd2
  s_cmp_lg_u32 s5, 0
  s_cbranch_scc1 L_tail
  s_lshl_b32 s64, s6, 2
  s_add_u32 s64, s64, s7
  s_lshl_b32 s64, s64, 7
  s_add_u32 s64, s64, 98304
  v_mov_b32 v18, s64
  s_mov_b32 s70, 0
L_sn_38:
  ds_read_b32 v8, v38 offset:6672
  s_waitcnt lgkmcnt(0)
  v_and_b32 v8, 0xffff, v8
  v_cmp_gt_u32 vcc, 0x200, v8
  s_cmp_eq_u64 vcc, 0
  s_cbranch_scc1 L_snd_39
  s_sleep 1
  s_add_u32 s70, s70, 1
  s_cmp_lt_u32 s70, 2097152
  s_cbranch_scc1 L_sn_38
L_snd_39:
  v_and_b32 v9, 7, v1
  v_lshlrev_b32 v9, 3, v9
  ds_read_b64 v[10:11], v9 offset:6784
  s_waitcnt lgkmcnt(0)
  v_max_f32_dpp v8, v10, v10 quad_perm:[1,0,3,2] row_mask:0xf bank_mask:0xf
  s_nop 1
  v_max_f32_dpp v8, v8, v8 quad_perm:[2,3,0,1] row_mask:0xf bank_mask:0xf
  s_nop 1
  v_max_f32_dpp v8, v8, v8 row_half_mirror row_mask:0xf bank_mask:0xf
  v_sub_f32 v9, v10, v8
  v_mul_f32 v9, 0x3fb8aa3b, v9
  v_exp_f32 v9, v9
  s_nop 0
  v_mul_f32 v10, v9, v11
  s_nop 1
  v_add_f32_dpp v10, v10, v10 quad_perm:[1,0,3,2] row_mask:0xf bank_mask:0xf
  s_nop 1
  v_add_f32_dpp v10, v10, v10 quad_perm:[2,3,0,1] row_mask:0xf bank_mask:0xf
  s_nop 1
  v_add_f32_dpp v10, v10, v10 row_half_mirror row_mask:0xf bank_mask:0xf
  v_mov_b32 v9, s74
  v_mov_b32 v11, s76
  s_mov_b64 exec, 1
  global_store_dwordx4 v18, v[8:11], s[42:43] sc1
  s_mov_b64 exec, -1
  s_mov_b32 s70, 0
L_sn_40:
  ds_read_b32 v8, v38 offset:6672
  s_waitcnt lgkmcnt(0)
  v_cmp_gt_u32 vcc, 0x10000, v8
  s_cmp_eq_u64 vcc, 0
  s_cbranch_scc1 L_snd_41
  s_sleep 1
  s_add_u32 s70, s70, 1
  s_cmp_lt_u32 s70, 2097152
  s_cbranch_scc1 L_sn_40
L_snd_41:
  v_and_b32 v9, 15, v1
  v_lshlrev_b32 v9, 3, v9
  ds_read_b64 v[10:11], v9 offset:6784
  s_waitcnt lgkmcnt(0)
  v_max_f32_dpp v8, v10, v10 quad_perm:[1,0,3,2] row_mask:0xf bank_mask:0xf
  s_nop 1
  v_max_f32_dpp v8, v8, v8 quad_perm:[2,3,0,1] row_mask:0xf bank_mask:0xf
  s_nop 1
  v_max_f32_dpp v8, v8, v8 row_half_mirror row_mask:0xf bank_mask:0xf
  s_nop 1
  v_max_f32_dpp v8, v8, v8 row_mirror row_mask:0xf bank_mask:0xf
  v_sub_f32 v9, v10, v8
  v_mul_f32 v9, 0x3fb8aa3b, v9
  v_exp_f32 v9, v9
  s_nop 0
  v_mul_f32 v10, v9, v11
  s_nop 1
  v_add_f32_dpp v10, v10, v10 quad_perm:[1,0,3,2] row_mask:0xf bank_mask:0xf
  s_nop 1
  v_add_f32_dpp v10, v10, v10 quad_perm:[2,3,0,1] row_mask:0xf bank_mask:0xf
  s_nop 1
  v_add_f32_dpp v10, v10, v10 row_half_mirror row_mask:0xf bank_mask:0xf
  s_nop 1
  v_add_f32_dpp v10, v10, v10 row_mirror row_mask:0xf bank_mask:0xf
  v_rcp_f32 v10, v10
  v_lshlrev_b32 v8, 2, v1
  v_mul_f32 v9, v9, v10
  s_mov_b64 exec, 0xff
  ds_write_b32 v8, v9 offset:6752
  s_mov_b64 exec, -1
  ds_write_b32 v38, v38 offset:6656
  s_mov_b32 s70, 0
L_sn_42:
  ds_read_b32 v8, v38 offset:6704
  s_waitcnt lgkmcnt(0)
  v_cmp_gt_u32 vcc, 0x8, v8
  s_cmp_eq_u64 vcc, 0
  s_cbranch_scc1 L_snd_43
  s_sleep 1
  s_add_u32 s70, s70, 1
  s_cmp_lt_u32 s70, 2097152
  s_cbranch_scc1 L_sn_42
L_snd_43:
  v_lshlrev_b32 v128, 3, v1
  ds_read_b128 v[120:123], v38 offset:6752
  ds_read_b128 v[124:127], v38 offset:6768
  ds_read_b64 v[104:105], v128 offset:11904
  ds_read_b64 v[106:107], v128 offset:12416
  ds_read_b64 v[108:109], v128 offset:12928
  ds_read_b64 v[110:111], v128 offset:13440
  ds_read_b64 v[112:113], v128 offset:13952
  ds_read_b64 v[114:115], v128 offset:14464
  ds_read_b64 v[116:117], v128 offset:14976
  ds_read_b64 v[118:119], v128 offset:15488
  ds_read_b32 v132, v38 offset:6712
  s_lshl_b32 s68, s6, 2
  s_add_u32 s68, s68, s7
  s_lshl_b32 s68, s68, 9
  s_add_u32 s68, s68, 131072
  v_add_u32 v128, s68, v128
  v_and_b32 v129, 1, v1
  v_lshlrev_b32 v129, 4, v129
  v_lshrrev_b32 v129, v129, s74
  v_lshrrev_b32 v130, 8, v129
  s_movk_i32 s69, 0xff
  s_waitcnt lgkmcnt(8)
  v_pk_mul_f32 v[104:105], v[104:105], v[120:121] op_sel:[0,0] op_sel_hi:[1,0]
  s_waitcnt lgkmcnt(7)
  v_pk_mul_f32 v[106:107], v[106:107], v[120:121] op_sel:[0,1] op_sel_hi:[1,1]
  s_waitcnt lgkmcnt(6)
  v_pk_fma_f32 v[104:105], v[108:109], v[122:123], v[104:105] op_sel:[0,0,0] op_sel_hi:[1,0,1]
  s_waitcnt lgkmcnt(5)
  v_pk_fma_f32 v[106:107], v[110:111], v[122:123], v[106:107] op_sel:[0,1,0] op_sel_hi:[1,1,1]
  s_waitcnt lgkmcnt(4)
  v_pk_fma_f32 v[104:105], v[112:113], v[124:125], v[104:105] op_sel:[0,0,0] op_sel_hi:[1,0,1]
  s_waitcnt lgkmcnt(3)
  v_pk_fma_f32 v[106:107], v[114:115], v[124:125], v[106:107] op_sel:[0,1,0] op_sel_hi:[1,1,1]
  s_waitcnt lgkmcnt(2)
  v_pk_fma_f32 v[104:105], v[116:117], v[126:127], v[104:105] op_sel:[0,0,0] op_sel_hi:[1,0,1]
  s_waitcnt lgkmcnt(1)
  v_pk_fma_f32 v[106:107], v[118:119], v[126:127], v[106:107] op_sel:[0,1,0] op_sel_hi:[1,1,1]
  s_waitcnt lgkmcnt(0)
  v_readfirstlane_b32 s75, v132
  v_pk_add_f32 v[104:105], v[104:105], v[106:107]
  v_bfi_b32 v104, s69, v129, v104
  v_bfi_b32 v105, s69, v130, v105
  s_cmp_eq_u32 s75, 2
  s_cbranch_scc0 L_pf_44
  global_store_dwordx2 v128, v[104:105], s[42:43]
  s_branch L_pe_45
L_pf_44:
  global_store_dwordx2 v128, v[104:105], s[42:43] sc1
L_pe_45:
  s_branch L_tail
L_svd2:
  s_mov_b32 s70, 0
L_pl_46:
  ds_read_b32 v8, v38 offset:6656
  s_waitcnt lgkmcnt(0)
  v_cmp_eq_u32 vcc, -1, v8
  s_cmp_eq_u64 vcc, 0
  s_cbranch_scc1 L_pld_47
  s_sleep 32
  s_add_u32 s70, s70, 1
  s_cmp_lt_u32 s70, 1048576
  s_cbranch_scc1 L_pl_46
L_pld_47:
  s_lshl_b32 s56, s6, 2
  s_add_u32 s56, s56, s7
  s_lshl_b32 s57, s56, 9
  s_add_u32 s57, s57, 524288
  v_lshl_add_u32 v3, v1, 3, s57
  global_load_dword v167, v3, s[42:43] sc1
  s_waitcnt vmcnt(0)
  s_branch L_tail
L_svd3:
  s_mov_b32 s70, 0
L_sn_48:
  ds_read_b32 v8, v38 offset:6672
  s_waitcnt lgkmcnt(0)
  v_cmp_gt_u32 vcc, 0x100, v8
  s_cmp_eq_u64 vcc, 0
  s_cbranch_scc1 L_snd_49
  s_sleep 4
  s_add_u32 s70, s70, 1
  s_cmp_lt_u32 s70, 2097152
  s_cbranch_scc1 L_sn_48
L_snd_49:
  s_lshl_b32 s64, s6, 9
  s_xor_b32 s54, s7, 1
  s_lshl_b32 s54, s54, 7
  s_add_u32 s54, s54, s64
  s_xor_b32 s55, s7, 2
  s_lshl_b32 s55, s55, 7
  s_add_u32 s55, s55, s64
  s_xor_b32 s56, s7, 3
  s_lshl_b32 s56, s56, 7
  s_add_u32 s56, s56, s64
  s_mov_b32 s70, 0
L_s3p:
  s_load_dwordx4 s[20:23], s[42:43], s54 offset:98304 glc
  s_load_dwordx4 s[24:27], s[42:43], s55 offset:98304 glc
  s_load_dwordx4 s[28:31], s[42:43], s56 offset:98304 glc
  s_waitcnt lgkmcnt(0)
  s_xor_b32 s68, s21, s74
  s_sub_u32 s69, s23, s74
  s_lshr_b32 s69, s69, 4
  s_or_b32 s68, s68, s69
  s_xor_b32 s69, s25, s74
  s_or_b32 s68, s68, s69
  s_sub_u32 s69, s27, s74
  s_lshr_b32 s69, s69, 4
  s_or_b32 s68, s68, s69
  s_xor_b32 s69, s29, s74
  s_or_b32 s68, s68, s69
  s_sub_u32 s69, s31, s74
  s_lshr_b32 s69, s69, 4
  s_or_b32 s68, s68, s69
  s_cbranch_scc0 L_s3pd
  s_sleep 2
  s_add_u32 s70, s70, 1
  s_cmp_lt_u32 s70, 262144
  s_cbranch_scc1 L_s3p
L_s3pd:
  v_mov_b32 v8, s20
  v_mov_b32 v10, s24
  v_mov_b32 v16, s28
  v_max3_f32 v18, v8, v10, v16
  v_mov_b32 v19, 0x10000
  v_mov_b32 v9, s22
  v_mov_b32 v11, s26
  v_mov_b32 v17, s30
  s_xor_b32 s68, s23, s76
  s_xor_b32 s69, s27, s76
  s_or_b32 s68, s68, s69
  s_xor_b32 s69, s31, s76
  s_or_b32 s68, s68, s69
  s_cselect_b32 s68, 0, 1
  v_mov_b32 v3, s68
  s_mov_b64 exec, 1
  ds_add_u32 v38, v3 offset:6712
  ds_max_f32 v38, v18 offset:6676
  ds_write_b128 v38, v[8:11] offset:6848
  ds_write_b64 v38, v[16:17] offset:6864
  ds_add_u32 v38, v19 offset:6672
  s_mov_b64 exec, -1
L_tail:
  s_cmp_eq_u32 s60, 0
  s_cbranch_scc1 L_fin
  s_cmp_lg_u32 s60, 4
  s_cbranch_scc1 L_tl2
  s_branch L_fin
L_tl2:
  s_mov_b32 s70, 0
L_sn_50:
  ds_read_b32 v8, v38 offset:6704
  s_waitcnt lgkmcnt(0)
  v_cmp_gt_u32 vcc, 0x8, v8
  s_cmp_eq_u64 vcc, 0
  s_cbranch_scc1 L_snd_51
  s_sleep 8
  s_add_u32 s70, s70, 1
  s_cmp_lt_u32 s70, 2097152
  s_cbranch_scc1 L_sn_50
L_snd_51:
  s_cmp_eq_u32 s60, 1
  s_cbranch_scc1 L_t_wo0
  s_cmp_eq_u32 s60, 3
  s_cbranch_scc1 L_t_f2
  s_mov_b32 s70, 0
L_sn_52:
  ds_read_b32 v9, v38 offset:6720
  s_waitcnt lgkmcnt(0)
  v_cmp_gt_u32 vcc, 0x4, v9
  s_cmp_eq_u64 vcc, 0
  s_cbranch_scc1 L_snd_53
  s_sleep 8
  s_add_u32 s70, s70, 1
  s_cmp_lt_u32 s70, 2097152
  s_cbranch_scc1 L_sn_52
L_snd_53:
  s_branch L_t_f1
L_t_wo0:
  ds_read_b32 v8, v38 offset:6696
  s_waitcnt lgkmcnt(0)
  v_subrev_u32 v8, 1024, v8
  v_mul_i32_i24 v8, 13, v8
  v_ashrrev_i32 v8, 4, v8
  v_add_u32 v9, 1032, v8
  s_mov_b32 s70, 0
L_af_54:
  ds_read_b32 v8, v38 offset:6696
  s_waitcnt lgkmcnt(0)
  v_cmp_lt_u32 vcc, v9, v8
  s_cmp_eq_u64 vcc, 0
  s_cbranch_scc1 L_afd_55
  s_sleep 4
  s_add_u32 s70, s70, 1
  s_cmp_lt_u32 s70, 2097152
  s_cbranch_scc1 L_af_54
L_afd_55:
L_t_wo:
  s_mov_b32 s70, 0
L_wo_p:
  global_load_dwordx4 v[104:107], v15, s[42:43] offset:0 sc1
  global_load_dwordx4 v[108:111], v15, s[42:43] offset:512 sc1
  global_load_dwordx4 v[112:115], v15, s[42:43] offset:1024 sc1
  global_load_dwordx4 v[116:119], v15, s[42:43] offset:1536 sc1
  s_waitcnt vmcnt(3)
  v_xor_b32 v104, s32, v104
  v_xor_b32 v105, s33, v105
  v_xor_b32 v106, s34, v106
  v_xor_b32 v107, s35, v107
  s_waitcnt vmcnt(2)
  v_xor_b32 v108, s32, v108
  v_xor_b32 v109, s33, v109
  v_xor_b32 v110, s34, v110
  v_xor_b32 v111, s35, v111
  s_waitcnt vmcnt(1)
  v_xor_b32 v112, s32, v112
  v_xor_b32 v113, s33, v113
  v_xor_b32 v114, s34, v114
  v_xor_b32 v115, s35, v115
  s_waitcnt vmcnt(0)
  v_xor_b32 v116, s32, v116
  v_xor_b32 v117, s33, v117
  v_xor_b32 v118, s34, v118
  v_xor_b32 v119, s35, v119
  v_or3_b32 v28, v104, v105, v106
  v_or3_b32 v29, v107, v108, v109
  v_or3_b32 v30, v110, v111, v112
  v_or3_b32 v31, v113, v114, v115
  v_or3_b32 v32, v116, v117, v118
  v_or3_b32 v28, v28, v29, v30
  v_or3_b32 v31, v31, v32, v119
  v_or_b32 v28, v28, v31
  v_lshlrev_b32 v28, 24, v28
  v_cmp_ne_u32 vcc, 0, v28
  v_or_b32 v104, 0x80, v104
  v_or_b32 v105, 0x80, v105
  v_or_b32 v106, 0x80, v106
  v_or_b32 v107, 0x80, v107
  v_or_b32 v108, 0x80, v108
  v_or_b32 v109, 0x80, v109
  v_or_b32 v110, 0x80, v110
  v_or_b32 v111, 0x80, v111
  v_or_b32 v112, 0x80, v112
  v_or_b32 v113, 0x80, v113
  v_or_b32 v114, 0x80, v114
  v_or_b32 v115, 0x80, v115
  v_or_b32 v116, 0x80, v116
  v_or_b32 v117, 0x80, v117
  v_or_b32 v118, 0x80, v118
  v_or_b32 v119, 0x80, v119
  v_pk_add_f32 v[16:17], v[104:105], v[112:113]
  v_pk_add_f32 v[18:19], v[106:107], v[114:115]
  v_pk_add_f32 v[20:21], v[108:109], v[116:117]
  v_pk_add_f32 v[22:23], v[110:111], v[118:119]
  v_pk_add_f32 v[16:17], v[16:17], v[20:21]
  v_pk_add_f32 v[18:19], v[18:19], v[22:23]
  s_cmp_eq_u64 vcc, 0
  s_cbranch_scc1 L_wo_ok
  s_add_u32 s70, s70, 1
  s_cmp_lt_u32 s70, 262144
  s_cbranch_scc1 L_wo_p
L_wo_ok:
  v_cvt_pk_bf16_f32 v8, v16, v17
  v_cvt_pk_bf16_f32 v9, v18, v19
  ds_write_b64 v12, v[8:9] offset:0
  s_add_u32 s77, s77, 4
  v_mov_b32 v10, 1
  s_mov_b64 exec, 1
  ds_add_u32 v38, v10 offset:6720
  s_mov_b64 exec, -1
  s_mov_b32 s70, 0
L_hy_56:
  ds_read_b32 v10, v38 offset:6720
  s_waitcnt lgkmcnt(0)
  v_cmp_gt_u32 vcc, s77, v10
  s_cmp_eq_u64 vcc, 0
  s_cbranch_scc1 L_hyd_57
  s_add_u32 s70, s70, 1
  s_cmp_lt_u32 s70, 2097152
  s_cbranch_scc1 L_hy_56
L_hyd_57:
  ds_read_b128 v[104:107], v14 offset:0
  ds_read_b128 v[108:111], v14 offset:64
  ds_read_b128 v[112:115], v14 offset:128
  ds_read_b128 v[116:119], v14 offset:192
  ds_read_b128 v[120:123], v14 offset:256
  ds_read_b128 v[124:127], v14 offset:320
  ds_read_b128 v[128:131], v14 offset:384
  ds_read_b128 v[132:135], v14 offset:448
  ds_read_b128 v[136:139], v14 offset:512
  ds_read_b128 v[140:143], v14 offset:576
  ds_read_b128 v[144:147], v14 offset:640
  ds_read_b128 v[148:151], v14 offset:704
  s_waitcnt lgkmcnt(11)
  v_mfma_f32_16x16x32_bf16 v[8:11], v[40:43], v[104:107], 0
  ds_read_b128 v[152:155], v14 offset:768
  s_waitcnt lgkmcnt(11)
  v_mfma_f32_16x16x32_bf16 v[8:11], v[44:47], v[108:111], v[8:11]
  ds_read_b128 v[156:159], v14 offset:832
  s_waitcnt lgkmcnt(11)
  v_mfma_f32_16x16x32_bf16 v[8:11], v[48:51], v[112:115], v[8:11]
  ds_read_b128 v[160:163], v14 offset:896
  s_waitcnt lgkmcnt(11)
  v_mfma_f32_16x16x32_bf16 v[8:11], v[52:55], v[116:119], v[8:11]
  ds_read_b128 v[164:167], v14 offset:960
  s_waitcnt lgkmcnt(11)
  v_mfma_f32_16x16x32_bf16 v[8:11], v[56:59], v[120:123], v[8:11]
  s_waitcnt lgkmcnt(10)
  v_mfma_f32_16x16x32_bf16 v[8:11], v[60:63], v[124:127], v[8:11]
  s_waitcnt lgkmcnt(9)
  v_mfma_f32_16x16x32_bf16 v[8:11], v[64:67], v[128:131], v[8:11]
  s_waitcnt lgkmcnt(8)
  v_mfma_f32_16x16x32_bf16 v[8:11], v[68:71], v[132:135], v[8:11]
  s_waitcnt lgkmcnt(7)
  v_mfma_f32_16x16x32_bf16 v[8:11], v[72:75], v[136:139], v[8:11]
  s_waitcnt lgkmcnt(6)
  v_mfma_f32_16x16x32_bf16 v[8:11], v[76:79], v[140:143], v[8:11]
  s_waitcnt lgkmcnt(5)
  v_mfma_f32_16x16x32_bf16 v[8:11], v[80:83], v[144:147], v[8:11]
  s_waitcnt lgkmcnt(4)
  v_mfma_f32_16x16x32_bf16 v[8:11], v[84:87], v[148:151], v[8:11]
  s_waitcnt lgkmcnt(3)
  v_mfma_f32_16x16x32_bf16 v[8:11], v[88:91], v[152:155], v[8:11]
  s_waitcnt lgkmcnt(2)
  v_mfma_f32_16x16x32_bf16 v[8:11], v[92:95], v[156:159], v[8:11]
  s_waitcnt lgkmcnt(1)
  v_mfma_f32_16x16x32_bf16 v[8:11], v[96:99], v[160:163], v[8:11]
  s_waitcnt lgkmcnt(0)
  v_mfma_f32_16x16x32_bf16 v[8:11], v[100:103], v[164:167], v[8:11]
  s_nop 7
  v_bfi_b32 v8, v36, s32, v8
  v_bfi_b32 v9, v36, s33, v9
  v_bfi_b32 v10, v36, s34, v10
  v_bfi_b32 v11, v36, s35, v11
  s_mov_b32 exec_lo, 0x00030003
  s_mov_b32 exec_hi, 0x00030003
  global_store_dwordx4 v13, v[8:11], s[42:43] sc1
  s_mov_b64 exec, -1
  s_branch L_fin
L_t_f1:
  ds_read_b64_tr_b16 v[40:41], v2 offset:0
  ds_read_b64_tr_b16 v[42:43], v2 offset:512
  ds_read_b64_tr_b16 v[44:45], v2 offset:1024
  ds_read_b64_tr_b16 v[46:47], v2 offset:1536
  ds_read_b64_tr_b16 v[48:49], v2 offset:2048
  ds_read_b64_tr_b16 v[50:51], v2 offset:2560
  ds_read_b64_tr_b16 v[52:53], v2 offset:3072
  ds_read_b64_tr_b16 v[54:55], v2 offset:3584
  ds_read_b64_tr_b16 v[56:57], v2 offset:4096
  ds_read_b64_tr_b16 v[58:59], v2 offset:4608
  ds_read_b64_tr_b16 v[60:61], v2 offset:5120
  ds_read_b64_tr_b16 v[62:63], v2 offset:5632
  s_waitcnt lgkmcnt(10)
  ds_read_b64_tr_b16 v[64:65], v2 offset:6144
  ds_read_b64_tr_b16 v[66:67], v2 offset:6656
  s_waitcnt lgkmcnt(10)
  ds_read_b64_tr_b16 v[68:69], v2 offset:7168
  ds_read_b64_tr_b16 v[70:71], v2 offset:7680
  s_waitcnt lgkmcnt(10)
  ds_read_b64_tr_b16 v[72:73], v2 offset:8192
  ds_read_b64_tr_b16 v[74:75], v2 offset:8704
  s_waitcnt lgkmcnt(10)
  ds_read_b64_tr_b16 v[76:77], v2 offset:9216
  ds_read_b64_tr_b16 v[78:79], v2 offset:9728
  s_waitcnt lgkmcnt(10)
  ds_read_b64_tr_b16 v[80:81], v2 offset:10240
  ds_read_b64_tr_b16 v[82:83], v2 offset:10752
  s_waitcnt lgkmcnt(10)
  ds_read_b64_tr_b16 v[84:85], v2 offset:11264
  ds_read_b64_tr_b16 v[86:87], v2 offset:11776
  s_waitcnt lgkmcnt(10)
  ds_read_b64_tr_b16 v[88:89], v2 offset:12288
  ds_read_b64_tr_b16 v[90:91], v2 offset:12800
  s_waitcnt lgkmcnt(10)
  ds_read_b64_tr_b16 v[92:93], v2 offset:13312
  ds_read_b64_tr_b16 v[94:95], v2 offset:13824
  s_waitcnt lgkmcnt(10)
  ds_read_b64_tr_b16 v[96:97], v2 offset:14336
  ds_read_b64_tr_b16 v[98:99], v2 offset:14848
  s_waitcnt lgkmcnt(10)
  ds_read_b64_tr_b16 v[100:101], v2 offset:15360
  ds_read_b64_tr_b16 v[102:103], v2 offset:15872
  s_waitcnt lgkmcnt(10)
  s_waitcnt lgkmcnt(0)
  v_add_u32 v4, 8192, v15
  v_add_u32 v6, 16384, v15
  v_add_u32 v36, 24576, v15
  global_load_dwordx2 v[8:9], v37, s[16:17]
  s_mov_b32 s70, 0
L_pg_58:
  global_load_dwordx4 v[136:139], v39, s[42:43] offset:-4096 sc1
  global_load_dwordx4 v[140:143], v39, s[42:43] offset:0 sc1
  v_add_u32 v3, 4096, v39
  global_load_dwordx4 v[144:147], v3, s[42:43] sc1
  s_waitcnt vmcnt(0)
  s_mov_b64 vcc, 0
  v_cmp_ne_u32 s[68:69], s74, v137
  s_or_b64 vcc, vcc, s[68:69]
  v_cmp_ne_u32 s[68:69], s74, v139
  s_or_b64 vcc, vcc, s[68:69]
  v_cmp_ne_u32 s[68:69], s74, v141
  s_or_b64 vcc, vcc, s[68:69]
  v_cmp_ne_u32 s[68:69], s74, v143
  s_or_b64 vcc, vcc, s[68:69]
  v_cmp_ne_u32 s[68:69], s74, v145
  s_or_b64 vcc, vcc, s[68:69]
  v_cmp_ne_u32 s[68:69], s74, v147
  s_or_b64 vcc, vcc, s[68:69]
  s_cmp_eq_u64 vcc, 0
  s_cbranch_scc1 L_pge_59
  s_sleep 8
  s_add_u32 s70, s70, 1
  s_cmp_lt_u32 s70, 262144
  s_cbranch_scc1 L_pg_58
L_pge_59:
  v_lshlrev_b32 v16, 16, v8
  v_and_b32 v17, s73, v8
  v_lshlrev_b32 v18, 16, v9
  v_and_b32 v19, s73, v9
  v_lshlrev_b32 v20, 16, v136
  v_and_b32 v21, s73, v136
  v_lshlrev_b32 v22, 16, v138
  v_and_b32 v23, s73, v138
  v_lshlrev_b32 v28, 16, v144
  v_and_b32 v29, s73, v144
  v_lshlrev_b32 v30, 16, v146
  v_and_b32 v31, s73, v146
  v_add_f32 v28, 1.0, v28
  v_add_f32 v29, 1.0, v29
  v_add_f32 v30, 1.0, v30
  v_add_f32 v31, 1.0, v31
  v_cvt_pk_bf16_f32 v8, v28, v29
  v_cvt_pk_bf16_f32 v9, v30, v31
  v_mov_b32 v141, v142
  ds_write_b64 v12, v[8:9] offset:2112
  ds_write_b64 v12, v[140:141] offset:4224
  v_cvt_pk_bf16_f32 v28, 0, v28
  v_cvt_pk_bf16_f32 v29, 0, v29
  v_cvt_pk_bf16_f32 v30, 0, v30
  v_cvt_pk_bf16_f32 v31, 0, v31
  v_mul_f32 v24, v20, v28
  v_mul_f32 v25, v21, v29
  v_mul_f32 v26, v22, v30
  v_mul_f32 v27, v23, v31
  v_mul_f32 v28, v16, v28
  v_mul_f32 v29, v17, v29
  v_mul_f32 v30, v18, v30
  v_mul_f32 v31, v19, v31
  s_waitcnt lgkmcnt(0)
  ds_read_b32 v8, v38 offset:6696
  s_waitcnt lgkmcnt(0)
  v_subrev_u32 v8, 1024, v8
  v_mul_i32_i24 v8, 8, v8
  v_ashrrev_i32 v8, 4, v8
  v_add_u32 v9, 1032, v8
  s_mov_b32 s70, 0
L_af_60:
  ds_read_b32 v8, v38 offset:6696
  s_waitcnt lgkmcnt(0)
  v_cmp_lt_u32 vcc, v9, v8
  s_cmp_eq_u64 vcc, 0
  s_cbranch_scc1 L_afd_61
  s_sleep 4
  s_add_u32 s70, s70, 1
  s_cmp_lt_u32 s70, 2097152
  s_cbranch_scc1 L_af_60
L_afd_61:
  s_mov_b32 s70, 0
  s_mov_b32 s71, 15
L_f1_p:
  s_add_u32 s70, s70, 1
  s_cmp_ge_u32 s70, 262144
  s_cbranch_scc1 L_f1_ok
  s_bitcmp1_b32 s71, 0
  s_cbranch_scc0 L_fl_62
  global_load_dwordx4 v[104:107], v15, s[42:43] offset:-4096 sc1
  global_load_dwordx4 v[108:111], v15, s[42:43] offset:0 sc1
L_fl_62:
  s_bitcmp1_b32 s71, 1
  s_cbranch_scc0 L_fl_63
  global_load_dwordx4 v[112:115], v4, s[42:43] offset:-4096 sc1
  global_load_dwordx4 v[116:119], v4, s[42:43] offset:0 sc1
L_fl_63:
  s_bitcmp1_b32 s71, 2
  s_cbranch_scc0 L_fl_64
  global_load_dwordx4 v[120:123], v6, s[42:43] offset:-4096 sc1
  global_load_dwordx4 v[124:127], v6, s[42:43] offset:0 sc1
L_fl_64:
  s_bitcmp1_b32 s71, 3
  s_cbranch_scc0 L_fl_65
  global_load_dwordx4 v[128:131], v36, s[42:43] offset:-4096 sc1
  global_load_dwordx4 v[132:135], v36, s[42:43] offset:0 sc1
L_fl_65:
  s_waitcnt vmcnt(0)
  s_bitcmp1_b32 s71, 0
  s_cbranch_scc0 L_fc_66
  v_xor_b32 v104, s32, v104
  v_xor_b32 v105, s33, v105
  v_xor_b32 v106, s34, v106
  v_xor_b32 v107, s35, v107
  v_xor_b32 v108, s32, v108
  v_xor_b32 v109, s33, v109
  v_xor_b32 v110, s34, v110
  v_xor_b32 v111, s35, v111
  v_or3_b32 v8, v104, v105, v106
  v_or3_b32 v9, v107, v108, v109
  v_or3_b32 v8, v8, v110, v111
  v_pk_add_f32 v[136:137], v[104:105], v[108:109]
  v_pk_add_f32 v[138:139], v[106:107], v[110:111]
  v_or_b32 v8, v8, v9
  v_lshlrev_b32 v8, 24, v8
  v_cmp_ne_u32 vcc, 0, v8
  s_cmp_lg_u64 vcc, 0
  s_cbranch_scc1 L_fc_66
  s_bitset0_b32 s71, 0
L_fc_66:
  s_bitcmp1_b32 s71, 1
  s_cbranch_scc0 L_fc_67
  v_xor_b32 v112, s32, v112
  v_xor_b32 v113, s33, v113
  v_xor_b32 v114, s34, v114
  v_xor_b32 v115, s35, v115
  v_xor_b32 v116, s32, v116
  v_xor_b32 v117, s33, v117
  v_xor_b32 v118, s34, v118
  v_xor_b32 v119, s35, v119
  v_or3_b32 v8, v112, v113, v114
  v_or3_b32 v9, v115, v116, v117
  v_or3_b32 v8, v8, v118, v119
  v_pk_add_f32 v[144:145], v[112:113], v[116:117]
  v_pk_add_f32 v[146:147], v[114:115], v[118:119]
  v_or_b32 v8, v8, v9
  v_lshlrev_b32 v8, 24, v8
  v_cmp_ne_u32 vcc, 0, v8
  s_cmp_lg_u64 vcc, 0
  s_cbranch_scc1 L_fc_67
  s_bitset0_b32 s71, 1
L_fc_67:
  s_bitcmp1_b32 s71, 2
  s_cbranch_scc0 L_fc_68
  v_xor_b32 v120, s32, v120
  v_xor_b32 v121, s33, v121
  v_xor_b32 v122, s34, v122
  v_xor_b32 v123, s35, v123
  v_xor_b32 v124, s32, v124
  v_xor_b32 v125, s33, v125
  v_xor_b32 v126, s34, v126
  v_xor_b32 v127, s35, v127
  v_or3_b32 v8, v120, v121, v122
  v_or3_b32 v9, v123, v124, v125
  v_or3_b32 v8, v8, v126, v127
  v_pk_add_f32 v[152:153], v[120:121], v[124:125]
  v_pk_add_f32 v[154:155], v[122:123], v[126:127]
  v_or_b32 v8, v8, v9
  v_lshlrev_b32 v8, 24, v8
  v_cmp_ne_u32 vcc, 0, v8
  s_cmp_lg_u64 vcc, 0
  s_cbranch_scc1 L_fc_68
  s_bitset0_b32 s71, 2
L_fc_68:
  s_bitcmp1_b32 s71, 3
  s_cbranch_scc0 L_fc_69
  v_xor_b32 v128, s32, v128
  v_xor_b32 v129, s33, v129
  v_xor_b32 v130, s34, v130
  v_xor_b32 v131, s35, v131
  v_xor_b32 v132, s32, v132
  v_xor_b32 v133, s33, v133
  v_xor_b32 v134, s34, v134
  v_xor_b32 v135, s35, v135
  v_or3_b32 v8, v128, v129, v130
  v_or3_b32 v9, v131, v132, v133
  v_or3_b32 v8, v8, v134, v135
  v_pk_add_f32 v[160:161], v[128:129], v[132:133]
  v_pk_add_f32 v[162:163], v[130:131], v[134:135]
  v_or_b32 v8, v8, v9
  v_lshlrev_b32 v8, 24, v8
  v_cmp_ne_u32 vcc, 0, v8
  s_cmp_lg_u64 vcc, 0
  s_cbranch_scc1 L_fc_69
  s_bitset0_b32 s71, 3
L_fc_69:
  s_cmp_lg_u32 s71, 0
  s_cbranch_scc1 L_f1_p
L_f1_ok:
  v_pk_add_f32 v[136:137], v[136:137], v[144:145]
  v_pk_add_f32 v[138:139], v[138:139], v[146:147]
  v_pk_add_f32 v[152:153], v[152:153], v[160:161]
  v_pk_add_f32 v[154:155], v[154:155], v[162:163]
  v_pk_add_f32 v[136:137], v[136:137], v[152:153]
  v_pk_add_f32 v[138:139], v[138:139], v[154:155]
  v_pk_fma_f32 v[8:9], v[136:137], v[24:25], v[28:29]
  v_pk_fma_f32 v[10:11], v[138:139], v[26:27], v[30:31]
  v_cvt_pk_bf16_f32 v8, v8, v9
  v_cvt_pk_bf16_f32 v9, v10, v11
  ds_write_b64 v12, v[8:9] offset:0
  v_pk_fma_f32 v[16:17], v[136:137], v[20:21], v[16:17]
  v_pk_fma_f32 v[18:19], v[138:139], v[22:23], v[18:19]
  v_add_f32 v8, v16, v17
  v_mul_f32 v9, v16, v16
  v_add_f32 v10, v18, v19
  v_mul_f32 v11, v18, v18
  v_fmac_f32 v9, v17, v17
  v_fmac_f32 v11, v19, v19
  v_add_f32 v8, v8, v10
  v_add_f32 v9, v9, v11
  s_nop 0
  v_add_f32_dpp v8, v8, v8 quad_perm:[1,0,3,2] row_mask:0xf bank_mask:0xf
  v_add_f32_dpp v9, v9, v9 quad_perm:[1,0,3,2] row_mask:0xf bank_mask:0xf
  s_nop 0
  v_add_f32_dpp v8, v8, v8 quad_perm:[2,3,0,1] row_mask:0xf bank_mask:0xf
  v_add_f32_dpp v9, v9, v9 quad_perm:[2,3,0,1] row_mask:0xf bank_mask:0xf
  s_nop 0
  v_add_f32_dpp v8, v8, v8 row_ror:8 row_mask:0xf bank_mask:0xf
  v_add_f32_dpp v9, v9, v9 row_ror:8 row_mask:0xf bank_mask:0xf
  s_nop 0
  v_mov_b32 v10, v8
  v_mov_b32 v11, v9
  s_nop 0
  v_permlane16_swap_b32 v10, v8
  v_permlane16_swap_b32 v11, v9
  v_add_f32 v8, v8, v10
  v_add_f32 v9, v9, v11
  v_mov_b32 v10, v8
  v_mov_b32 v11, v9
  s_nop 0
  v_permlane32_swap_b32 v10, v8
  v_permlane32_swap_b32 v11, v9
  v_add_f32 v8, v8, v10
  v_add_f32 v9, v9, v11
  ds_write_b64 v5, v[8:9]
  s_add_u32 s77, s77, 4
  v_mov_b32 v10, 1
  s_mov_b64 exec, 1
  ds_add_u32 v38, v10 offset:6720
  s_mov_b64 exec, -1
  s_mov_b32 s70, 0
L_hy_70:
  ds_read_b32 v10, v38 offset:6720
  s_waitcnt lgkmcnt(0)
  v_cmp_gt_u32 vcc, s77, v10
  s_cmp_eq_u64 vcc, 0
  s_cbranch_scc1 L_hyd_71
  s_add_u32 s70, s70, 1
  s_cmp_lt_u32 s70, 2097152
  s_cbranch_scc1 L_hy_70
L_hyd_71:
  ds_read_b128 v[20:23], v7 offset:11392
  ds_read_b128 v[24:27], v7 offset:11408
  ds_read_b128 v[104:107], v14 offset:0
  ds_read_b128 v[108:111], v14 offset:64
  ds_read_b128 v[112:115], v14 offset:128
  ds_read_b128 v[116:119], v14 offset:192
  ds_read_b128 v[120:123], v14 offset:256
  ds_read_b128 v[124:127], v14 offset:320
  ds_read_b128 v[128:131], v14 offset:384
  ds_read_b128 v[132:135], v14 offset:448
  ds_read_b128 v[136:139], v14 offset:512
  ds_read_b128 v[140:143], v14 offset:576
  ds_read_b128 v[144:147], v14 offset:640
  ds_read_b128 v[148:151], v14 offset:704
  s_waitcnt lgkmcnt(11)
  v_mfma_f32_16x16x32_bf16 v[32:35], v[40:43], v[104:107], 0
  ds_read_b128 v[152:155], v14 offset:768
  s_waitcnt lgkmcnt(11)
  v_mfma_f32_16x16x32_bf16 v[32:35], v[44:47], v[108:111], v[32:35]
  ds_read_b128 v[156:159], v14 offset:832
  s_waitcnt lgkmcnt(11)
  v_mfma_f32_16x16x32_bf16 v[32:35], v[48:51], v[112:115], v[32:35]
  ds_read_b128 v[160:163], v14 offset:896
  s_waitcnt lgkmcnt(11)
  v_mfma_f32_16x16x32_bf16 v[32:35], v[52:55], v[116:119], v[32:35]
  ds_read_b128 v[164:167], v14 offset:960
  s_waitcnt lgkmcnt(11)
  v_mfma_f32_16x16x32_bf16 v[32:35], v[56:59], v[120:123], v[32:35]
  s_waitcnt lgkmcnt(10)
  v_mfma_f32_16x16x32_bf16 v[32:35], v[60:63], v[124:127], v[32:35]
  s_waitcnt lgkmcnt(9)
  v_mfma_f32_16x16x32_bf16 v[32:35], v[64:67], v[128:131], v[32:35]
  s_waitcnt lgkmcnt(8)
  v_mfma_f32_16x16x32_bf16 v[32:35], v[68:71], v[132:135], v[32:35]
  s_waitcnt lgkmcnt(7)
  v_mfma_f32_16x16x32_bf16 v[32:35], v[72:75], v[136:139], v[32:35]
  s_waitcnt lgkmcnt(6)
  v_mfma_f32_16x16x32_bf16 v[32:35], v[76:79], v[140:143], v[32:35]
  s_waitcnt lgkmcnt(5)
  v_mfma_f32_16x16x32_bf16 v[32:35], v[80:83], v[144:147], v[32:35]
  s_waitcnt lgkmcnt(4)
  v_mfma_f32_16x16x32_bf16 v[32:35], v[84:87], v[148:151], v[32:35]
  s_waitcnt lgkmcnt(3)
  v_mfma_f32_16x16x32_bf16 v[32:35], v[88:91], v[152:155], v[32:35]
  s_waitcnt lgkmcnt(2)
  v_mfma_f32_16x16x32_bf16 v[32:35], v[92:95], v[156:159], v[32:35]
  s_waitcnt lgkmcnt(1)
  v_mfma_f32_16x16x32_bf16 v[32:35], v[96:99], v[160:163], v[32:35]
  s_waitcnt lgkmcnt(0)
  v_mfma_f32_16x16x32_bf16 v[32:35], v[100:103], v[164:167], v[32:35]
  s_nop 7
  v_lshrrev_b32 v3, 4, v1
  v_bfe_u32 v28, v1, 2, 2
  v_lshl_add_u32 v28, v3, 3, v28
  v_mul_u32_u24 v28, 1056, v28
  v_and_b32 v29, 3, v1
  v_lshl_add_u32 v28, v29, 3, v28
  s_lshl_b32 s49, s5, 8
  s_add_u32 s49, s49, 98304
  v_add_u32 v28, s49, v28
  ds_read_b64_tr_b16 v[136:137], v28 offset:0
  ds_read_b64_tr_b16 v[138:139], v28 offset:4224
  ds_read_b64_tr_b16 v[140:141], v28 offset:32
  ds_read_b64_tr_b16 v[142:143], v28 offset:4256
  ds_read_b64_tr_b16 v[144:145], v28 offset:64
  ds_read_b64_tr_b16 v[146:147], v28 offset:4288
  ds_read_b64_tr_b16 v[148:149], v28 offset:96
  ds_read_b64_tr_b16 v[150:151], v28 offset:4320
  ds_read_b64_tr_b16 v[152:153], v28 offset:128
  ds_read_b64_tr_b16 v[154:155], v28 offset:4352
  ds_read_b64_tr_b16 v[156:157], v28 offset:160
  ds_read_b64_tr_b16 v[158:159], v28 offset:4384
  ds_read_b64_tr_b16 v[160:161], v28 offset:192
  ds_read_b64_tr_b16 v[162:163], v28 offset:4416
  v_and_b32 v29, 1, v1
  v_lshlrev_b32 v29, 6, v29
  v_lshl_add_u32 v30, v3, 4, v29
  v_bfe_u32 v3, v1, 4, 1
  v_lshl_add_u32 v29, v3, 3, v29
  v_lshrrev_b32 v3, 5, v1
  v_lshl_add_u32 v29, v3, 2, v29
  s_lshl_b32 s49, s5, 4
  v_add_u32 v29, s49, v29
  v_pk_add_f32 v[20:21], v[20:21], v[22:23]
  v_pk_add_f32 v[24:25], v[24:25], v[26:27]
  v_pk_add_f32 v[20:21], v[20:21], v[24:25]
  v_mul_f32 v20, 0xbb000000, v20
  v_mul_f32 v21, 0x3b000000, v21
  v_fma_f32 v21, -v20, v20, v21
  v_max_f32 v21, 0, v21
  v_add_f32 v21, 0x3727c5ac, v21
  v_rsq_f32 v21, v21
  v_fmac_f32_dpp v32, v32, v20 row_shl:2 row_mask:0xf bank_mask:0x1
  v_fmac_f32_dpp v33, v33, v20 row_shl:2 row_mask:0xf bank_mask:0x1
  v_fmac_f32_dpp v34, v34, v20 row_shl:2 row_mask:0xf bank_mask:0x1
  v_fmac_f32_dpp v35, v35, v20 row_shl:2 row_mask:0xf bank_mask:0x1
  v_mul_f32 v8, v32, v21
  v_mul_f32 v9, v33, v21
  v_mul_f32 v10, v34, v21
  v_mul_f32 v11, v35, v21
  v_add_f32_dpp v8, v32, v8 row_shl:4 row_mask:0xf bank_mask:0xf
  v_add_f32_dpp v9, v33, v9 row_shl:4 row_mask:0xf bank_mask:0xf
  v_add_f32_dpp v10, v34, v10 row_shl:4 row_mask:0xf bank_mask:0xf
  v_add_f32_dpp v11, v35, v11 row_shl:4 row_mask:0xf bank_mask:0xf
  s_nop 1
  v_permlane32_swap_b32 v8, v10
  v_permlane32_swap_b32 v9, v11
  v_mul_f32 v20, 0xbfb8aa3b, v8
  v_mul_f32 v21, 0xbfb8aa3b, v9
  v_exp_f32 v20, v20
  v_exp_f32 v21, v21
  v_mul_f32 v8, v8, v10
  v_mul_f32 v9, v9, v11
  v_add_f32 v20, 1.0, v20
  v_add_f32 v21, 1.0, v21
  v_rcp_f32 v20, v20
  v_rcp_f32 v21, v21
  s_mov_b32 exec_lo, 0x00030003
  s_mov_b32 exec_hi, 0x00030003
  v_mul_f32 v8, v8, v20
  v_mul_f32 v9, v9, v21
  v_cvt_pk_bf16_f32 v8, v8, v9
  ds_write_b32 v29, v8 offset:11520
  s_mov_b64 exec, -1
  s_waitcnt lgkmcnt(0)
  ds_read_b64_tr_b16 v[164:165], v28 offset:224
  ds_read_b64_tr_b16 v[166:167], v28 offset:4448
  s_add_u32 s77, s77, 4
  v_mov_b32 v10, 1
  s_mov_b64 exec, 1
  ds_add_u32 v38, v10 offset:6720
  s_mov_b64 exec, -1
  s_mov_b32 s70, 0
L_hy_72:
  ds_read_b32 v10, v38 offset:6720
  s_waitcnt lgkmcnt(0)
  v_cmp_gt_u32 vcc, s77, v10
  s_cmp_eq_u64 vcc, 0
  s_cbranch_scc1 L_hyd_73
  s_add_u32 s70, s70, 1
  s_cmp_lt_u32 s70, 2097152
  s_cbranch_scc1 L_hy_72
L_hyd_73:
  ds_read_b128 v[20:23], v30 offset:11520
  v_mov_b32 v3, 0xff
  s_waitcnt lgkmcnt(0)
  v_mfma_f32_16x16x32_bf16 v[104:107], v[136:139], v[20:23], 0
  v_mfma_f32_16x16x32_bf16 v[108:111], v[140:143], v[20:23], 0
  v_mfma_f32_16x16x32_bf16 v[112:115], v[144:147], v[20:23], 0
  v_mfma_f32_16x16x32_bf16 v[116:119], v[148:151], v[20:23], 0
  v_mfma_f32_16x16x32_bf16 v[120:123], v[152:155], v[20:23], 0
  v_mfma_f32_16x16x32_bf16 v[124:127], v[156:159], v[20:23], 0
  v_mfma_f32_16x16x32_bf16 v[128:131], v[160:163], v[20:23], 0
  v_mfma_f32_16x16x32_bf16 v[132:135], v[164:167], v[20:23], 0
  s_nop 0
  s_mov_b32 exec_lo, 0x00030003
  s_mov_b32 exec_hi, exec_lo
  v_bfi_b32 v8, v3, s32, v104
  v_bfi_b32 v9, v3, s33, v105
  v_bfi_b32 v10, v3, s34, v106
  v_bfi_b32 v11, v3, s35, v107
  s_mov_b32 exec_lo, 0x000c000c
  s_mov_b32 exec_hi, exec_lo
  v_bfi_b32 v8, v3, s32, v108
  v_bfi_b32 v9, v3, s33, v109
  v_bfi_b32 v10, v3, s34, v110
  v_bfi_b32 v11, v3, s35, v111
  s_mov_b32 exec_lo, 0x00300030
  s_mov_b32 exec_hi, exec_lo
  v_bfi_b32 v8, v3, s32, v112
  v_bfi_b32 v9, v3, s33, v113
  v_bfi_b32 v10, v3, s34, v114
  v_bfi_b32 v11, v3, s35, v115
  s_mov_b32 exec_lo, 0x00c000c0
  s_mov_b32 exec_hi, exec_lo
  v_bfi_b32 v8, v3, s32, v116
  v_bfi_b32 v9, v3, s33, v117
  v_bfi_b32 v10, v3, s34, v118
  v_bfi_b32 v11, v3, s35, v119
  s_mov_b32 exec_lo, 0x03000300
  s_mov_b32 exec_hi, exec_lo
  v_bfi_b32 v8, v3, s32, v120
  v_bfi_b32 v9, v3, s33, v121
  v_bfi_b32 v10, v3, s34, v122
  v_bfi_b32 v11, v3, s35, v123
  s_mov_b32 exec_lo, 0x0c000c00
  s_mov_b32 exec_hi, exec_lo
  v_bfi_b32 v8, v3, s32, v124
  v_bfi_b32 v9, v3, s33, v125
  v_bfi_b32 v10, v3, s34, v126
  v_bfi_b32 v11, v3, s35, v127
  s_mov_b32 exec_lo, 0x30003000
  s_mov_b32 exec_hi, exec_lo
  v_bfi_b32 v8, v3, s32, v128
  v_bfi_b32 v9, v3, s33, v129
  v_bfi_b32 v10, v3, s34, v130
  v_bfi_b32 v11, v3, s35, v131
  s_mov_b32 exec_lo, 0xc000c000
  s_mov_b32 exec_hi, exec_lo
  v_bfi_b32 v8, v3, s32, v132
  v_bfi_b32 v9, v3, s33, v133
  v_bfi_b32 v10, v3, s34, v134
  v_bfi_b32 v11, v3, s35, v135
  s_mov_b64 exec, -1
  global_store_dwordx4 v13, v[8:11], s[42:43] sc1
  s_branch L_fin
L_t_f2:
  s_cmp_lg_u32 s5, 1
  s_cbranch_scc1 L_fin
  global_load_dwordx2 v[8:9], v37, s[16:17]
  s_mov_b32 s70, 0
L_pg_74:
  global_load_dwordx4 v[136:139], v39, s[42:43] offset:-4096 sc1
  v_add_u32 v3, 8192, v39
  global_load_dwordx4 v[140:143], v3, s[42:43] sc1
  s_waitcnt vmcnt(0)
  s_mov_b64 vcc, 0
  v_cmp_ne_u32 s[68:69], s74, v137
  s_or_b64 vcc, vcc, s[68:69]
  v_cmp_ne_u32 s[68:69], s74, v139
  s_or_b64 vcc, vcc, s[68:69]
  v_cmp_ne_u32 s[68:69], s74, v141
  s_or_b64 vcc, vcc, s[68:69]
  v_cmp_ne_u32 s[68:69], s74, v143
  s_or_b64 vcc, vcc, s[68:69]
  s_cmp_eq_u64 vcc, 0
  s_cbranch_scc1 L_pge_75
  s_sleep 8
  s_add_u32 s70, s70, 1
  s_cmp_lt_u32 s70, 262144
  s_cbranch_scc1 L_pg_74
L_pge_75:
  v_lshlrev_b32 v16, 16, v8
  v_and_b32 v17, s73, v8
  v_lshlrev_b32 v18, 16, v9
  v_and_b32 v19, s73, v9
  v_lshlrev_b32 v20, 16, v136
  v_and_b32 v21, s73, v136
  v_lshlrev_b32 v22, 16, v138
  v_and_b32 v23, s73, v138
  v_lshlrev_b32 v24, 16, v140
  v_and_b32 v25, s73, v140
  v_lshlrev_b32 v26, 16, v142
  v_and_b32 v27, s73, v142
  s_mov_b32 s70, 0
L_f2_a:
  global_load_dwordx4 v[136:139], v15, s[42:43] sc1
  s_waitcnt vmcnt(0)
  v_xor_b32 v136, s32, v136
  v_xor_b32 v137, s33, v137
  v_xor_b32 v138, s34, v138
  v_xor_b32 v139, s35, v139
  v_or3_b32 v3, v136, v137, v138
  v_or_b32 v3, v3, v139
  v_lshlrev_b32 v3, 24, v3
  v_cmp_ne_u32 vcc, 0, v3
  s_cmp_eq_u64 vcc, 0
  s_cbranch_scc1 L_f2_ad
  s_sleep 8
  s_add_u32 s70, s70, 1
  s_cmp_lt_u32 s70, 262144
  s_cbranch_scc1 L_f2_a
L_f2_ad:
  s_nop 1
  v_add_f32_dpp v136, v136, v136 row_ror:8 row_mask:0xf bank_mask:0xf
  v_add_f32_dpp v137, v137, v137 row_ror:8 row_mask:0xf bank_mask:0xf
  v_add_f32_dpp v138, v138, v138 row_ror:8 row_mask:0xf bank_mask:0xf
  v_add_f32_dpp v139, v139, v139 row_ror:8 row_mask:0xf bank_mask:0xf
  v_mov_b32 v140, v136
  v_mov_b32 v141, v137
  v_mov_b32 v142, v138
  v_mov_b32 v143, v139
  v_permlane16_swap_b32 v140, v136
  v_permlane16_swap_b32 v141, v137
  v_permlane16_swap_b32 v142, v138
  v_permlane16_swap_b32 v143, v139
  v_add_f32 v136, v136, v140
  v_add_f32 v137, v137, v141
  v_add_f32 v138, v138, v142
  v_add_f32 v139, v139, v143
  v_mov_b32 v140, v136
  v_mov_b32 v141, v137
  v_mov_b32 v142, v138
  v_mov_b32 v143, v139
  v_permlane32_swap_b32 v140, v136
  v_permlane32_swap_b32 v141, v137
  v_permlane32_swap_b32 v142, v138
  v_permlane32_swap_b32 v143, v139
  v_add_f32 v136, v136, v140
  v_add_f32 v137, v137, v141
  v_add_f32 v138, v138, v142
  v_add_f32 v139, v139, v143
  v_cvt_pk_bf16_f32 v136, 0, v136
  v_cvt_pk_bf16_f32 v137, 0, v137
  v_cvt_pk_bf16_f32 v138, 0, v138
  v_cvt_pk_bf16_f32 v139, 0, v139
  v_mul_f32 v136, v136, v20
  v_mul_f32 v137, v137, v21
  v_mul_f32 v138, v138, v22
  v_mul_f32 v139, v139, v23
  v_cvt_pk_bf16_f32 v136, 0, v136
  v_cvt_pk_bf16_f32 v137, 0, v137
  v_cvt_pk_bf16_f32 v138, 0, v138
  v_cvt_pk_bf16_f32 v139, 0, v139
  v_add_f32 v16, v16, v136
  v_add_f32 v17, v17, v137
  v_add_f32 v18, v18, v138
  v_add_f32 v19, v19, v139
  v_cvt_pk_bf16_f32 v16, 0, v16
  v_cvt_pk_bf16_f32 v17, 0, v17
  v_cvt_pk_bf16_f32 v18, 0, v18
  v_cvt_pk_bf16_f32 v19, 0, v19
  v_add_u32 v28, 32768, v15
  v_add_u32 v29, 65536, v15
  v_add_u32 v30, 98304, v15
  v_add_u32 v31, 131072, v15
  v_add_u32 v32, 163840, v15
  v_add_u32 v33, 196608, v15
  s_mov_b32 s70, 0
L_f2_p:
  v_mov_b32 v124, s32
  v_mov_b32 v125, s33
  v_mov_b32 v126, s34
  v_mov_b32 v127, s35
  global_load_dwordx4 v[104:107], v28, s[42:43] sc1
  global_load_dwordx4 v[108:111], v29, s[42:43] sc1
  global_load_dwordx4 v[112:115], v30, s[42:43] sc1
  global_load_dwordx4 v[116:119], v31, s[42:43] sc1
  global_load_dwordx4 v[120:123], v32, s[42:43] sc1
  s_mov_b64 exec, 0xffffff
  global_load_dwordx4 v[124:127], v33, s[42:43] sc1
  s_mov_b64 exec, -1
  s_waitcnt vmcnt(5)
  v_xor_b32 v104, s32, v104
  v_xor_b32 v105, s33, v105
  v_xor_b32 v106, s34, v106
  v_xor_b32 v107, s35, v107
  s_waitcnt vmcnt(4)
  v_xor_b32 v108, s32, v108
  v_xor_b32 v109, s33, v109
  v_xor_b32 v110, s34, v110
  v_xor_b32 v111, s35, v111
  s_waitcnt vmcnt(3)
  v_xor_b32 v112, s32, v112
  v_xor_b32 v113, s33, v113
  v_xor_b32 v114, s34, v114
  v_xor_b32 v115, s35, v115
  s_waitcnt vmcnt(2)
  v_xor_b32 v116, s32, v116
  v_xor_b32 v117, s33, v117
  v_xor_b32 v118, s34, v118
  v_xor_b32 v119, s35, v119
  s_waitcnt vmcnt(1)
  v_xor_b32 v120, s32, v120
  v_xor_b32 v121, s33, v121
  v_xor_b32 v122, s34, v122
  v_xor_b32 v123, s35, v123
  s_waitcnt vmcnt(0)
  v_xor_b32 v124, s32, v124
  v_xor_b32 v125, s33, v125
  v_xor_b32 v126, s34, v126
  v_xor_b32 v127, s35, v127
  v_or3_b32 v8, v104, v105, v106
  v_or3_b32 v9, v110, v111, v112
  v_or3_b32 v10, v116, v117, v118
  v_or3_b32 v11, v122, v123, v124
  v_or3_b32 v8, v8, v107, v108
  v_or3_b32 v9, v9, v113, v114
  v_or3_b32 v10, v10, v119, v120
  v_or3_b32 v11, v11, v125, v126
  v_or_b32 v8, v8, v109
  v_or_b32 v9, v9, v115
  v_or_b32 v10, v10, v121
  v_or_b32 v11, v11, v127
  v_or3_b32 v3, v8, v9, v10
  v_or_b32 v3, v3, v11
  v_lshlrev_b32 v3, 24, v3
  v_cmp_ne_u32 vcc, 0, v3
  s_cmp_eq_u64 vcc, 0
  s_cbranch_scc1 L_f2_ok
  s_add_u32 s70, s70, 1
  s_cmp_lt_u32 s70, 262144
  s_cbranch_scc1 L_f2_p
L_f2_ok:
  v_pk_add_f32 v[104:105], v[104:105], v[108:109]
  v_pk_add_f32 v[106:107], v[106:107], v[110:111]
  v_pk_add_f32 v[112:113], v[112:113], v[116:117]
  v_pk_add_f32 v[114:115], v[114:115], v[118:119]
  v_pk_add_f32 v[120:121], v[120:121], v[124:125]
  v_pk_add_f32 v[122:123], v[122:123], v[126:127]
  v_pk_add_f32 v[104:105], v[104:105], v[112:113]
  v_pk_add_f32 v[106:107], v[106:107], v[114:115]
  v_pk_add_f32 v[104:105], v[104:105], v[120:121]
  v_pk_add_f32 v[106:107], v[106:107], v[122:123]
  s_nop 1
  v_add_f32_dpp v104, v104, v104 row_ror:8 row_mask:0xf bank_mask:0xf
  v_add_f32_dpp v105, v105, v105 row_ror:8 row_mask:0xf bank_mask:0xf
  v_add_f32_dpp v106, v106, v106 row_ror:8 row_mask:0xf bank_mask:0xf
  v_add_f32_dpp v107, v107, v107 row_ror:8 row_mask:0xf bank_mask:0xf
  v_mov_b32 v108, v104
  v_mov_b32 v109, v105
  v_mov_b32 v110, v106
  v_mov_b32 v111, v107
  v_permlane16_swap_b32 v108, v104
  v_permlane16_swap_b32 v109, v105
  v_permlane16_swap_b32 v110, v106
  v_permlane16_swap_b32 v111, v107
  v_add_f32 v104, v104, v108
  v_add_f32 v105, v105, v109
  v_add_f32 v106, v106, v110
  v_add_f32 v107, v107, v111
  v_mov_b32 v108, v104
  v_mov_b32 v109, v105
  v_mov_b32 v110, v106
  v_mov_b32 v111, v107
  v_permlane32_swap_b32 v108, v104
  v_permlane32_swap_b32 v109, v105
  v_permlane32_swap_b32 v110, v106
  v_permlane32_swap_b32 v111, v107
  v_add_f32 v104, v104, v108
  v_add_f32 v105, v105, v109
  v_add_f32 v106, v106, v110
  v_add_f32 v107, v107, v111
  v_cvt_pk_bf16_f32 v104, 0, v104
  v_cvt_pk_bf16_f32 v105, 0, v105
  v_cvt_pk_bf16_f32 v106, 0, v106
  v_cvt_pk_bf16_f32 v107, 0, v107
  v_mul_f32 v104, v104, v24
  v_mul_f32 v105, v105, v25
  v_mul_f32 v106, v106, v26
  v_mul_f32 v107, v107, v27
  v_cvt_pk_bf16_f32 v104, 0, v104
  v_cvt_pk_bf16_f32 v105, 0, v105
  v_cvt_pk_bf16_f32 v106, 0, v106
  v_cvt_pk_bf16_f32 v107, 0, v107
  v_add_f32 v8, v104, v16
  v_add_f32 v9, v105, v17
  v_add_f32 v10, v106, v18
  v_add_f32 v11, v107, v19
  v_cvt_pk_bf16_f32 v8, v8, v9
  v_cvt_pk_bf16_f32 v9, v10, v11
  s_mov_b64 exec, 0xff
  global_store_dwordx2 v37, v[8:9], s[38:39] sc1
  s_mov_b64 exec, 1
  v_mov_b32 v10, s74
  s_lshl_b32 s49, s61, 7
  s_add_u32 s49, s49, 28672
  v_mov_b32 v11, s49
  global_store_dword v11, v10, s[42:43] sc1
  s_cmp_lg_u32 s61, 0
  s_cbranch_scc1 L_f2_e
  global_store_dword v38, v10, s[42:43] offset:0
L_f2_e:
L_fin:
L_end:
  s_endpgm
.p2align 7
L_table:
  .long 0xffda000e, 0x33333310, 0xffda0806, 0x33333310, 0xffda1016, 0x33333310, 0xffda1806, 0x33333310
  .long 0xffda2006, 0x33333310, 0xffda2806, 0x33333310, 0xffda3006, 0x33333310, 0xffda3806, 0x33333310
  .long 0xffda010e, 0x33333310, 0xffda0906, 0x33333310, 0xffda1116, 0x33333310, 0xffda1906, 0x33333310
  .long 0xffda2106, 0x33333310, 0xffda2906, 0x33333310, 0xffda3106, 0x33333310, 0xffda3906, 0x33333310
  .long 0xffda020e, 0x33333310, 0xffda0a06, 0x33333310, 0xffda1216, 0x33333310, 0xffda1a06, 0x33333310
  .long 0xffda2206, 0x33333310, 0xffda2a06, 0x33333310, 0xffda3206, 0x33333310, 0xffda3a06, 0x33333310
  .long 0xffda030e, 0x40040010, 0xffda0b06, 0x40040010, 0xffda1316, 0x40040010, 0xffda1b06, 0x40040010
  .long 0xffda2306, 0x40040010, 0xffda2b06, 0x40040010, 0xffda3306, 0x40040010, 0xffda3b06, 0x40040010
  .long 0xffda040e, 0x33333310, 0xffda0c06, 0x33333310, 0xffda1416, 0x33333310, 0xffda1c06, 0x33333310
  .long 0xffda2406, 0x33333310, 0xffda2c06, 0x33333310, 0xffda3406, 0x33333310, 0xffda3c06, 0x33333310
  .long 0xffda050e, 0x33333310, 0xffda0d06, 0x33333310, 0xffda1516, 0x33333310, 0xffda1d06, 0x33333310
  .long 0xffda2506, 0x33333310, 0xffda2d06, 0x33333310, 0xffda3506, 0x33333310, 0xffda3d06, 0x33333310
  .long 0xffda060e, 0x33333310, 0xffda0e06, 0x33333310, 0xffda1616, 0x33333310, 0xffda1e06, 0x33333310
  .long 0xffda2606, 0x33333310, 0xffda2e06, 0x33333310, 0xffda3606, 0x33333310, 0xffda3e06, 0x33333310
  .long 0xffda070e, 0x33333310, 0xffda0f06, 0x33333310, 0xffda1716, 0x33333310, 0xffda1f06, 0x33333310
  .long 0xffda2706, 0x33333310, 0xffda2f06, 0x33333310, 0xffda3706, 0x33333310, 0xffda3f06, 0x33333310
  .long 0x00330009, 0x32423d10, 0x00330001, 0x32423d10, 0x00330011, 0x32423d10, 0x00330001, 0x32423d10
  .long 0x00330001, 0x32423d10, 0x00330001, 0x32423d10, 0x00330001, 0x32423d10, 0x00330001, 0x32423d10
  .long 0x00330109, 0x32423d10, 0x00330101, 0x32423d10, 0x00330111, 0x32423d10, 0x00330101, 0x32423d10
  .long 0x00330101, 0x32423d10, 0x00330101, 0x32423d10, 0x00330101, 0x32423d10, 0x00330101, 0x32423d10
  .long 0x00330209, 0x32423d10, 0x00330201, 0x32423d10, 0x00330211, 0x32423d10, 0x00330201, 0x32423d10
  .long 0x00330201, 0x32423d10, 0x00330201, 0x32423d10, 0x00330201, 0x32423d10, 0x00330201, 0x32423d10
  .long 0x001a0309, 0x34025a10, 0x001a0301, 0x34025a10, 0x001a0311, 0x34025a10, 0x001a0301, 0x34025a10
  .long 0x001a0301, 0x34025a10, 0x001a0301, 0x34025a10, 0x001a0301, 0x34025a10, 0x001a0301, 0x34025a10
  .long 0x00330409, 0x32423d10, 0x00330401, 0x32423d10, 0x00330411, 0x32423d10, 0x00330401, 0x32423d10
  .long 0x00330401, 0x32423d10, 0x00330401, 0x32423d10, 0x00330401, 0x32423d10, 0x00330401, 0x32423d10
  .long 0x00330509, 0x32423d10, 0x00330501, 0x32423d10, 0x00330511, 0x32423d10, 0x00330501, 0x32423d10
  .long 0x00330501, 0x32423d10, 0x00330501, 0x32423d10, 0x00330501, 0x32423d10, 0x00330501, 0x32423d10
  .long 0x00330609, 0x32423d10, 0x00330601, 0x32423d10, 0x00330611, 0x32423d10, 0x00330601, 0x32423d10
  .long 0x00330601, 0x32423d10, 0x00330601, 0x32423d10, 0x00330601, 0x32423d10, 0x00330601, 0x32423d10
  .long 0x00330709, 0x32423d10, 0x00330701, 0x32423d10, 0x00330711, 0x32423d10, 0x00330701, 0x32423d10
  .long 0x00330701, 0x32423d10, 0x00330701, 0x32423d10, 0x00330701, 0x32423d10, 0x00330701, 0x32423d10
  .long 0x0000030d, 0x36636610, 0x00000405, 0x35435410, 0x00000515, 0x35435410, 0x00000605, 0x35435410
  .long 0x00000705, 0x35435410, 0x00000005, 0x35435410, 0x00000105, 0x35435410, 0x00000205, 0x35435410
  .long 0x0000090d, 0x35435410, 0x00000a05, 0x35435410, 0x00000b15, 0x36636610, 0x00000c05, 0x35435410
  .long 0x00000d05, 0x35435410, 0x00000e05, 0x35435410, 0x00000f05, 0x35435410, 0x00000805, 0x35435410
  .long 0x0000150c, 0x32123b10, 0x00001604, 0x32123b10, 0x00001714, 0x32123b10, 0x00001004, 0x32123b10
  .long 0x00001104, 0x32123b10, 0x00001204, 0x32123b10, 0x00001304, 0x36127b10, 0x00001404, 0x32123b10
  .long 0x00001f0c, 0x32123b10, 0x00001804, 0x32123b10, 0x00001914, 0x32123b10, 0x00001a04, 0x32123b10
  .long 0x00001b04, 0x36127b10, 0x00001c04, 0x32123b10, 0x00001d04, 0x32123b10, 0x00001e04, 0x32123b10
  .long 0x0000220c, 0x32123b10, 0x00002304, 0x36127b10, 0x00002414, 0x32123b10, 0x00002504, 0x32123b10
  .long 0x00002604, 0x32123b10, 0x00002704, 0x32123b10, 0x00002004, 0x32123b10, 0x00002104, 0x32123b10
  .long 0x00002c0c, 0x32123b10, 0x00002d04, 0x32123b10, 0x00002e14, 0x32123b10, 0x00002f04, 0x32123b10
  .long 0x00002804, 0x32123b10, 0x00002904, 0x32123b10, 0x00002a04, 0x32123b10, 0x00002b04, 0x36127b10
  .long 0x00a6000a, 0x35f27810, 0x00a60602, 0x35f27810, 0x00a60c12, 0x35f27810, 0x00a61202, 0x35f27810
  .long 0x00a61702, 0x35f27810, 0x00a61c02, 0x35f27810, 0x00a62102, 0x35f27810, 0x00a62602, 0x35f27810
  .long 0x00a6010a, 0x35f27810, 0x00a60702, 0x35f27810, 0x00a60d12, 0x35f27810, 0x00a61302, 0x35f27810
  .long 0x00a61802, 0x35f27810, 0x00a61d02, 0x35f27810, 0x00a62202, 0x35f27810, 0x00a62702, 0x35f27810
  .long 0x00a6020a, 0x35f27810, 0x00a60802, 0x35f27810, 0x00a60e12, 0x35f27810, 0x00a61402, 0x35f27810
  .long 0x00a61902, 0x35f27810, 0x00a61e02, 0x35f27810, 0x00a62302, 0x35f27810, 0x00a62802, 0x35f27810
  .long 0x00a6030a, 0x35f27810, 0x00a60902, 0x35f27810, 0x00a60f12, 0x35f27810, 0x00a61502, 0x35f27810
  .long 0x00a61a02, 0x35f27810, 0x00a61f02, 0x35f27810, 0x00a62402, 0x35f27810, 0x00a62902, 0x35f27810
  .long 0x00a6040a, 0x35f27810, 0x00a60a02, 0x35f27810, 0x00a61012, 0x35f27810, 0x00a61602, 0x35f27810
  .long 0x00a61b02, 0x35f27810, 0x00a62002, 0x35f27810, 0x00a62502, 0x35f27810, 0x00a62a02, 0x35f27810
  .long 0x00a6050a, 0x35f27810, 0x00a60b02, 0x35f27810, 0x00a61112, 0x35f27810, 0xffe60003, 0x33124a10
  .long 0xffe60403, 0x33124a10, 0xffe60803, 0x33124a10, 0xffe60c03, 0x33124a10, 0xffe61003, 0x33124a10
  .long 0x0000140b, 0x3da2f310, 0x00001803, 0x3da2f310, 0x00001c13, 0x3da2f310, 0x00000103, 0x3da2f310
  .long 0x00000503, 0x3da2f310, 0x00000903, 0x3da2f310, 0x00000d03, 0x3da2f310, 0x00001103, 0x3da2f310
  .long 0x0000150b, 0x3da2f310, 0x00001903, 0x3da2f310, 0x00001d13, 0x3da2f310, 0x00000203, 0x3da2f310
  .long 0x00000603, 0x3da2f310, 0x00000a03, 0x3da2f310, 0x00000e03, 0x3da2f310, 0x00001203, 0x3da2f310
  .long 0xffe6160b, 0x33124a10, 0xffe61a03, 0x33124a10, 0xffe61e13, 0x33124a10, 0xffe60303, 0x33124a10
  .long 0xffe60703, 0x33124a10, 0xffe60b03, 0x33124a10, 0xffe60f03, 0x33124a10, 0xffe61303, 0x33124a10
  .long 0xffe6170b, 0x33124a10, 0xffe61b03, 0x33124a10, 0xffe61f13, 0x33124a10, 0xffcd0000, 0x30a22410
  .long 0xffcd0000, 0x30a22410, 0xffcd0000, 0x30a22410, 0xffcd0000, 0x30a22410, 0xffcd0000, 0x30a22410
.section .rodata,"a"
.p2align 6
.amdhsa_kernel adaLN_cond__sliding_block_cached__glu_gated_swiglu__decode_kernel
  .amdhsa_next_free_vgpr 168
  .amdhsa_next_free_sgpr 102
  .amdhsa_accum_offset 168
  .amdhsa_group_segment_fixed_size 0
  .amdhsa_kernarg_size 112
  .amdhsa_user_sgpr_count 2
  .amdhsa_user_sgpr_kernarg_segment_ptr 1
  .amdhsa_system_sgpr_workgroup_id_x 1
.end_amdhsa_kernel
```

```asm
; @launch grid=(256,1,1) block=(768,1,1) lds=140288
.amdgcn_target "amdgcn-amd-amdhsa--gfx950"
.text
.globl adaLN_cond__sliding_block_cached__glu_gated_swiglu__decode_kernel
.p2align 8
.type adaLN_cond__sliding_block_cached__glu_gated_swiglu__decode_kernel,@function
adaLN_cond__sliding_block_cached__glu_gated_swiglu__decode_kernel:
  s_cmp_ge_u32 s2, 256
  s_cbranch_scc1 L_end
  s_load_dwordx16 s[16:31], s[0:1], 0
  s_load_dwordx8 s[32:39], s[0:1], 64
  s_load_dwordx4 s[40:43], s[0:1], 96
  s_getpc_b64 s[56:57]
L_pc:
  s_lshl_b32 s3, s2, 4
  s_add_u32 s3, s3, L_table-L_pc
  s_and_b32 s13, s2, 0xe8
  s_cmp_eq_u32 s13, 0xc8
  s_cselect_b32 s13, 0, 0
  s_cmp_lt_u32 s2, 144
  s_cselect_b32 s13, 1, s13
  s_cmp_lt_u32 s2, 128
  s_cselect_b32 s13, 0, s13
  s_cmp_lt_u32 s2, 64
  s_cselect_b32 s13, 2, s13
  v_lshrrev_b32 v2, 6, v0
  v_and_b32 v1, 63, v0
  v_readfirstlane_b32 s5, v2
  s_bfe_u32 s7, s2, 0x20003
  s_bfe_u32 s6, s2, 0x20005
  s_and_b32 s8, s2, 7
  s_lshl_b32 s9, s8, 2
  s_add_u32 s6, s6, s9
  s_lshr_b32 s9, s2, 7
  s_lshl_b32 s9, s9, 5
  s_add_u32 s6, s6, s9
  s_mov_b32 s72, 0xfffffffe
  s_mov_b32 s73, 0xffff0000
  s_cmp_lt_u32 s5, 4
  s_cbranch_scc1 L_helper
  s_sub_u32 s9, s5, 4
  s_lshl_b32 s4, s7, 18
  s_lshl_b32 s11, s9, 10
L_stream:
  s_lshl_b32 s10, s6, 22
  s_add_u32 s10, s10, s4
  s_add_u32 s10, s10, 0x300000
  v_lshl_add_u32 v0, v1, 4, s11
  s_lshr_b32 s12, s2, 3
  s_mul_i32 s12, s12, 5
  s_mul_i32 s15, s8, 3
  s_add_u32 s12, s12, s15
  s_lshl_b32 s12, s12, 13
  s_and_b32 s12, s12, 0x3ffff
  s_waitcnt lgkmcnt(0)
  s_add_u32 s44, s18, s10
  s_addc_u32 s45, s19, 0
  s_mov_b32 s46, 0x40000
  s_mov_b32 s47, 0x20000
  s_cmp_le_i32 s13, 0
  s_cbranch_scc1 L_nb1
  s_barrier
L_nb1:
  buffer_load_dwordx4 v[40:43], v0, s[44:47], s12 offen nt
  s_add_u32 s12, s12, 0x2000
  s_and_b32 s12, s12, 0x3ffff
  buffer_load_dwordx4 v[44:47], v0, s[44:47], s12 offen nt
  s_add_u32 s12, s12, 0x2000
  s_and_b32 s12, s12, 0x3ffff
  buffer_load_dwordx4 v[48:51], v0, s[44:47], s12 offen nt
  s_add_u32 s12, s12, 0x2000
  s_and_b32 s12, s12, 0x3ffff
  buffer_load_dwordx4 v[52:55], v0, s[44:47], s12 offen nt
  s_add_u32 s12, s12, 0x2000
  s_and_b32 s12, s12, 0x3ffff
  s_load_dwordx2 s[14:15], s[56:57], s3
  s_load_dword s77, s[56:57], s3 offset:8
  s_load_dword s74, s[42:43], 0
  s_add_u32 s48, s20, s10
  s_addc_u32 s49, s21, 0
  s_mov_b32 s50, 0x40000
  s_mov_b32 s51, 0x20000
  s_mov_b32 s52, 0xcccccccc
  s_mov_b32 s53, 0xcccccccc
  s_mov_b32 s54, 0xaaaaaaaa
  s_mov_b32 s55, 0xaaaaaaaa
  v_and_b32 v38, 15, v1
  v_lshlrev_b32 v38, 4, v38
  s_lshl_b32 s10, s9, 11
  s_add_u32 s10, s10, 83968
  v_lshl_add_u32 v3, v1, 3, s10
  v_mov_b32 v4, 0x7fff0000
  v_mov_b32 v5, 0xff800000
  ds_write_b64 v3, v[4:5] offset:0
  ds_write_b64 v3, v[4:5] offset:512
  ds_write_b64 v3, v[4:5] offset:1024
  v_lshrrev_b32 v3, 4, v1
  v_lshl_add_u32 v39, v38, 1, s10
  v_lshl_add_u32 v39, v3, 3, v39
  s_sub_u32 s68, s12, 32768
  v_bfrev_b32 v24, v1
  v_lshrrev_b32 v24, 15, v24
  v_and_b32 v24, 0x1e000, v24
  v_add_u32 v24, s68, v24
  v_and_b32 v24, 0x3e000, v24
  v_lshl_add_u32 v24, v3, 8, v24
  v_add_u32 v24, s11, v24
  v_xor_b32 v26, 0x20000, v24
  s_lshl_b32 s11, s9, 9
  v_lshl_add_u32 v22, v38, 1, s11
  v_lshl_add_u32 v22, v3, 3, v22
  s_mov_b32 s32, 4
  s_mul_i32 s33, s9, 0x5e000000
  s_mov_b64 s[64:65], 0
  s_mov_b64 s[66:67], 0
  s_mov_b32 s38, 0
  s_mov_b32 s39, 0
  s_mov_b32 s75, 0
  s_mov_b32 s61, 0
  s_lshl_b32 s40, s6, 9
  s_lshl_b32 s68, s9, 6
  s_add_u32 s40, s40, s68
  s_add_u32 s40, s40, 32768
  s_cmp_eq_u32 s13, 0
  s_cbranch_scc0 L_nb2
  s_barrier
L_nb2:
  s_waitcnt lgkmcnt(0)
  s_mov_b32 s56, s10
  s_mul_i32 s74, s74, 0x9e3779b1
  s_add_u32 s74, s74, 0x7f4a7c15
  s_and_b32 s57, s77, 0xff
  s_bfe_u32 s34, s77, 0xc0008
  s_lshr_b32 s58, s77, 20
  s_and_b32 s76, s15, 15
  s_mov_b32 s35, 28
  s_mov_b32 s59, 0
  s_mul_i32 s68, s76, 28
  s_add_u32 s68, s68, 1024
  v_mov_b32 v20, s68
  v_mov_b32 v21, 0
  v_mov_b32 v23, 0
  s_cmp_ge_u32 s9, 8
  s_cselect_b32 s39, 2, 0
  s_bfe_u32 s68, s15, 0x20004
  s_add_u32 s68, s68, s9
  s_lshr_b32 s69, s9, 3
  s_lshr_b32 s68, s68, 3
  s_cmp_lg_u32 s68, s69
  s_cbranch_scc1 L_away
  s_call_b64 s[62:63], L_ks
  buffer_load_dwordx4 v[56:59], v0, s[44:47], s12 offen nt
  s_add_u32 s12, s12, 0x2000
  s_and_b32 s12, s12, 0x3ffff
  s_call_b64 s[62:63], L_ks
  buffer_load_dwordx4 v[60:63], v0, s[44:47], s12 offen nt
  s_add_u32 s12, s12, 0x2000
  s_and_b32 s12, s12, 0x3ffff
  s_call_b64 s[62:63], L_ks
  buffer_load_dwordx4 v[64:67], v0, s[44:47], s12 offen nt
  s_add_u32 s12, s12, 0x2000
  s_and_b32 s12, s12, 0x3ffff
  s_call_b64 s[62:63], L_ks
  buffer_load_dwordx4 v[68:71], v0, s[44:47], s12 offen nt
  s_add_u32 s12, s12, 0x2000
  s_and_b32 s12, s12, 0x3ffff
  s_call_b64 s[62:63], L_ks
  buffer_load_dwordx4 v[72:75], v0, s[44:47], s12 offen nt
  s_add_u32 s12, s12, 0x2000
  s_and_b32 s12, s12, 0x3ffff
  s_call_b64 s[62:63], L_ks
  buffer_load_dwordx4 v[76:79], v0, s[44:47], s12 offen nt
  s_add_u32 s12, s12, 0x2000
  s_and_b32 s12, s12, 0x3ffff
  s_call_b64 s[62:63], L_ks
  buffer_load_dwordx4 v[80:83], v0, s[44:47], s12 offen nt
  s_add_u32 s12, s12, 0x2000
  s_and_b32 s12, s12, 0x3ffff
  s_call_b64 s[62:63], L_ks
  buffer_load_dwordx4 v[84:87], v0, s[44:47], s12 offen nt
  s_add_u32 s12, s12, 0x2000
  s_and_b32 s12, s12, 0x3ffff
  s_call_b64 s[62:63], L_ks
  buffer_load_dwordx4 v[88:91], v0, s[44:47], s12 offen nt
  s_add_u32 s12, s12, 0x2000
  s_and_b32 s12, s12, 0x3ffff
  s_call_b64 s[62:63], L_ks
  buffer_load_dwordx4 v[92:95], v0, s[44:47], s12 offen nt
  s_add_u32 s12, s12, 0x2000
  s_and_b32 s12, s12, 0x3ffff
  s_call_b64 s[62:63], L_ks
  buffer_load_dwordx4 v[96:99], v0, s[44:47], s12 offen nt
  s_add_u32 s12, s12, 0x2000
  s_and_b32 s12, s12, 0x3ffff
  s_call_b64 s[62:63], L_ks
  buffer_load_dwordx4 v[100:103], v0, s[44:47], s12 offen nt
  s_add_u32 s12, s12, 0x2000
  s_and_b32 s12, s12, 0x3ffff
  s_call_b64 s[62:63], L_ks
  buffer_load_dwordx4 v[104:107], v0, s[44:47], s12 offen nt
  s_add_u32 s12, s12, 0x2000
  s_and_b32 s12, s12, 0x3ffff
  s_call_b64 s[62:63], L_ks
  buffer_load_dwordx4 v[108:111], v0, s[44:47], s12 offen nt
  s_add_u32 s12, s12, 0x2000
  s_and_b32 s12, s12, 0x3ffff
  s_call_b64 s[62:63], L_ks
  buffer_load_dwordx4 v[112:115], v0, s[44:47], s12 offen nt
  s_add_u32 s12, s12, 0x2000
  s_and_b32 s12, s12, 0x3ffff
  s_call_b64 s[62:63], L_ks
  buffer_load_dwordx4 v[116:119], v0, s[44:47], s12 offen nt
  s_add_u32 s12, s12, 0x2000
  s_and_b32 s12, s12, 0x3ffff
  s_call_b64 s[62:63], L_ks
  buffer_load_dwordx4 v[120:123], v0, s[44:47], s12 offen nt
  s_add_u32 s12, s12, 0x2000
  s_and_b32 s12, s12, 0x3ffff
  s_call_b64 s[62:63], L_ks
  buffer_load_dwordx4 v[124:127], v0, s[44:47], s12 offen nt
  s_add_u32 s12, s12, 0x2000
  s_and_b32 s12, s12, 0x3ffff
  s_call_b64 s[62:63], L_ks
  buffer_load_dwordx4 v[128:131], v0, s[44:47], s12 offen nt
  s_add_u32 s12, s12, 0x2000
  s_and_b32 s12, s12, 0x3ffff
  s_call_b64 s[62:63], L_ks
  buffer_load_dwordx4 v[132:135], v0, s[44:47], s12 offen nt
  s_add_u32 s12, s12, 0x2000
  s_and_b32 s12, s12, 0x3ffff
  s_call_b64 s[62:63], L_ks
  buffer_load_dwordx4 v[136:139], v0, s[44:47], s12 offen nt
  s_add_u32 s12, s12, 0x2000
  s_and_b32 s12, s12, 0x3ffff
  s_call_b64 s[62:63], L_ks
  buffer_load_dwordx4 v[140:143], v0, s[44:47], s12 offen nt
  s_add_u32 s12, s12, 0x2000
  s_and_b32 s12, s12, 0x3ffff
  s_call_b64 s[62:63], L_ks
  buffer_load_dwordx4 v[144:147], v0, s[44:47], s12 offen nt
  s_add_u32 s12, s12, 0x2000
  s_and_b32 s12, s12, 0x3ffff
  s_call_b64 s[62:63], L_ks
  buffer_load_dwordx4 v[148:151], v0, s[44:47], s12 offen nt
  s_add_u32 s12, s12, 0x2000
  s_and_b32 s12, s12, 0x3ffff
  s_call_b64 s[62:63], L_ks
  buffer_load_dwordx4 v[152:155], v0, s[44:47], s12 offen nt
  s_add_u32 s12, s12, 0x2000
  s_and_b32 s12, s12, 0x3ffff
  s_call_b64 s[62:63], L_ks
  buffer_load_dwordx4 v[156:159], v0, s[44:47], s12 offen nt
  s_add_u32 s12, s12, 0x2000
  s_and_b32 s12, s12, 0x3ffff
  s_call_b64 s[62:63], L_ks
  buffer_load_dwordx4 v[160:163], v0, s[44:47], s12 offen nt
  s_add_u32 s12, s12, 0x2000
  s_and_b32 s12, s12, 0x3ffff
  s_call_b64 s[62:63], L_ks
  buffer_load_dwordx4 v[164:167], v0, s[44:47], s12 offen nt
  s_add_u32 s12, s12, 0x2000
  s_and_b32 s12, s12, 0x3ffff
  s_mov_b32 s10, 0
L_kw:
  s_cmp_ge_u32 s39, 4
  s_cbranch_scc1 L_v0
  s_call_b64 s[100:101], L_work
  s_sleep 1
  s_add_u32 s10, s10, 1
  s_cmp_lt_u32 s10, 262144
  s_cbranch_scc1 L_kw
L_v0:
  s_mov_b32 s32, 0
  s_mov_b32 s37, 255
  v_mov_b32 v23, 8
  s_mov_b32 s35, s59
  ds_read_b64 v[20:21], v23 offset:6688
  s_ashr_i32 s14, s14, 16
  s_waitcnt lgkmcnt(0)
  v_readfirstlane_b32 s34, v20
  s_mul_i32 s34, s34, 96
  s_ashr_i32 s34, s34, 4
  s_add_i32 s34, s34, -6093
  s_add_i32 s34, s34, s14
  s_lshr_b32 s68, s15, 20
  s_mul_i32 s34, s34, s68
  s_ashr_i32 s34, s34, 8
  s_call_b64 s[62:63], L_vs
  s_cbranch_scc1 L_nl0
  v_add_u32_dpp v3, v28, v38 row_newbcast:0 row_mask:0xf bank_mask:0xf
  buffer_load_dwordx4 v[40:43], v3, s[48:51], 0 offen nt
L_nl0:
  v_dot2_f32_bf16 v8, v104, v4, 0
  v_dot2_f32_bf16 v9, v108, v4, 0
  v_dot2_f32_bf16 v10, v112, v4, 0
  v_dot2_f32_bf16 v11, v116, v4, 0
  v_dot2_f32_bf16 v12, v120, v4, 0
  v_dot2_f32_bf16 v13, v124, v4, 0
  v_dot2_f32_bf16 v14, v128, v4, 0
  v_dot2_f32_bf16 v15, v132, v4, 0
  v_dot2_f32_bf16 v8, v105, v5, v8
  v_dot2_f32_bf16 v9, v109, v5, v9
  v_dot2_f32_bf16 v10, v113, v5, v10
  v_dot2_f32_bf16 v11, v117, v5, v11
  v_dot2_f32_bf16 v12, v121, v5, v12
  v_dot2_f32_bf16 v13, v125, v5, v13
  v_dot2_f32_bf16 v14, v129, v5, v14
  v_dot2_f32_bf16 v15, v133, v5, v15
  v_dot2_f32_bf16 v8, v106, v6, v8
  v_dot2_f32_bf16 v9, v110, v6, v9
  v_dot2_f32_bf16 v10, v114, v6, v10
  v_dot2_f32_bf16 v11, v118, v6, v11
  v_dot2_f32_bf16 v12, v122, v6, v12
  v_dot2_f32_bf16 v13, v126, v6, v13
  v_dot2_f32_bf16 v14, v130, v6, v14
  v_dot2_f32_bf16 v15, v134, v6, v15
  v_dot2_f32_bf16 v8, v107, v7, v8
  v_dot2_f32_bf16 v9, v111, v7, v9
  v_dot2_f32_bf16 v10, v115, v7, v10
  v_dot2_f32_bf16 v11, v119, v7, v11
  v_dot2_f32_bf16 v12, v123, v7, v12
  v_dot2_f32_bf16 v13, v127, v7, v13
  v_dot2_f32_bf16 v14, v131, v7, v14
  v_dot2_f32_bf16 v15, v135, v7, v15
  v_add_f32_dpp v8, v8, v8 row_ror:8 row_mask:0xf bank_mask:0x3
  v_add_f32_dpp v8, v9, v9 row_ror:8 row_mask:0xf bank_mask:0xc
  v_add_f32_dpp v10, v10, v10 row_ror:8 row_mask:0xf bank_mask:0x3
  v_add_f32_dpp v10, v11, v11 row_ror:8 row_mask:0xf bank_mask:0xc
  v_add_f32_dpp v12, v12, v12 row_ror:8 row_mask:0xf bank_mask:0x3
  v_add_f32_dpp v12, v13, v13 row_ror:8 row_mask:0xf bank_mask:0xc
  v_add_f32_dpp v14, v14, v14 row_ror:8 row_mask:0xf bank_mask:0x3
  v_add_f32_dpp v14, v15, v15 row_ror:8 row_mask:0xf bank_mask:0xc
  v_add_f32_dpp v16, v8, v8 row_shl:4 row_mask:0xf bank_mask:0x5
  v_add_f32_dpp v16, v10, v10 row_shr:4 row_mask:0xf bank_mask:0xa
  v_add_f32_dpp v17, v12, v12 row_shl:4 row_mask:0xf bank_mask:0x5
  v_add_f32_dpp v17, v14, v14 row_shr:4 row_mask:0xf bank_mask:0xa
  s_call_b64 s[62:63], L_vs
  s_cbranch_scc1 L_nl1
  v_add_u32_dpp v3, v28, v38 row_newbcast:1 row_mask:0xf bank_mask:0xf
  buffer_load_dwordx4 v[44:47], v3, s[48:51], 0 offen nt
L_nl1:
  s_call_b64 s[62:63], L_vs
  s_cbranch_scc1 L_nl2
  v_add_u32_dpp v3, v28, v38 row_newbcast:2 row_mask:0xf bank_mask:0xf
  buffer_load_dwordx4 v[48:51], v3, s[48:51], 0 offen nt
L_nl2:
  s_call_b64 s[62:63], L_vs
  s_cbranch_scc1 L_nl3
  v_add_u32_dpp v3, v28, v38 row_newbcast:3 row_mask:0xf bank_mask:0xf
  buffer_load_dwordx4 v[52:55], v3, s[48:51], 0 offen nt
L_nl3:
  s_call_b64 s[62:63], L_vs
  s_cbranch_scc1 L_nl4
  v_add_u32_dpp v3, v28, v38 row_newbcast:4 row_mask:0xf bank_mask:0xf
  buffer_load_dwordx4 v[56:59], v3, s[48:51], 0 offen nt
L_nl4:
  s_call_b64 s[62:63], L_vs
  s_cbranch_scc1 L_nl5
  v_add_u32_dpp v3, v28, v38 row_newbcast:5 row_mask:0xf bank_mask:0xf
  buffer_load_dwordx4 v[60:63], v3, s[48:51], 0 offen nt
L_nl5:
  v_dot2c_f32_bf16_dpp v8, v29, v40 row_newbcast:0 row_mask:0xf bank_mask:0xf
  v_dot2c_f32_bf16_dpp v9, v34, v40 row_newbcast:0 row_mask:0xf bank_mask:0xf
  v_dot2c_f32_bf16_dpp v10, v29, v41 row_newbcast:0 row_mask:0xf bank_mask:0xf
  v_dot2c_f32_bf16_dpp v11, v34, v41 row_newbcast:0 row_mask:0xf bank_mask:0xf
  v_dot2c_f32_bf16_dpp v12, v29, v42 row_newbcast:0 row_mask:0xf bank_mask:0xf
  v_dot2c_f32_bf16_dpp v13, v34, v42 row_newbcast:0 row_mask:0xf bank_mask:0xf
  v_dot2c_f32_bf16_dpp v14, v29, v43 row_newbcast:0 row_mask:0xf bank_mask:0xf
  v_dot2c_f32_bf16_dpp v15, v34, v43 row_newbcast:0 row_mask:0xf bank_mask:0xf
  s_cmp_eq_u32 s75, 6
  s_cbranch_scc1 L_epi
  s_call_b64 s[62:63], L_vs
  s_cbranch_scc1 L_nl6
  v_add_u32_dpp v3, v28, v38 row_newbcast:6 row_mask:0xf bank_mask:0xf
  buffer_load_dwordx4 v[64:67], v3, s[48:51], 0 offen nt
L_nl6:
  v_dot2c_f32_bf16_dpp v8, v29, v44 row_newbcast:1 row_mask:0xf bank_mask:0xf
  v_dot2c_f32_bf16_dpp v9, v34, v44 row_newbcast:1 row_mask:0xf bank_mask:0xf
  v_dot2c_f32_bf16_dpp v10, v29, v45 row_newbcast:1 row_mask:0xf bank_mask:0xf
  v_dot2c_f32_bf16_dpp v11, v34, v45 row_newbcast:1 row_mask:0xf bank_mask:0xf
  v_dot2c_f32_bf16_dpp v12, v29, v46 row_newbcast:1 row_mask:0xf bank_mask:0xf
  v_dot2c_f32_bf16_dpp v13, v34, v46 row_newbcast:1 row_mask:0xf bank_mask:0xf
  v_dot2c_f32_bf16_dpp v14, v29, v47 row_newbcast:1 row_mask:0xf bank_mask:0xf
  v_dot2c_f32_bf16_dpp v15, v34, v47 row_newbcast:1 row_mask:0xf bank_mask:0xf
  s_cmp_eq_u32 s75, 7
  s_cbranch_scc1 L_epi
  s_call_b64 s[62:63], L_vs
  s_cbranch_scc1 L_nl7
  v_add_u32_dpp v3, v28, v38 row_newbcast:7 row_mask:0xf bank_mask:0xf
  buffer_load_dwordx4 v[68:71], v3, s[48:51], 0 offen nt
L_nl7:
  v_dot2c_f32_bf16_dpp v8, v29, v48 row_newbcast:2 row_mask:0xf bank_mask:0xf
  v_dot2c_f32_bf16_dpp v9, v34, v48 row_newbcast:2 row_mask:0xf bank_mask:0xf
  v_dot2c_f32_bf16_dpp v10, v29, v49 row_newbcast:2 row_mask:0xf bank_mask:0xf
  v_dot2c_f32_bf16_dpp v11, v34, v49 row_newbcast:2 row_mask:0xf bank_mask:0xf
  v_dot2c_f32_bf16_dpp v12, v29, v50 row_newbcast:2 row_mask:0xf bank_mask:0xf
  v_dot2c_f32_bf16_dpp v13, v34, v50 row_newbcast:2 row_mask:0xf bank_mask:0xf
  v_dot2c_f32_bf16_dpp v14, v29, v51 row_newbcast:2 row_mask:0xf bank_mask:0xf
  v_dot2c_f32_bf16_dpp v15, v34, v51 row_newbcast:2 row_mask:0xf bank_mask:0xf
  s_cmp_eq_u32 s75, 8
  s_cbranch_scc1 L_epi
  s_call_b64 s[62:63], L_vs
  s_cbranch_scc1 L_nl8
  v_add_u32_dpp v3, v28, v38 row_newbcast:8 row_mask:0xf bank_mask:0xf
  buffer_load_dwordx4 v[72:75], v3, s[48:51], 0 offen nt
L_nl8:
  v_dot2c_f32_bf16_dpp v8, v29, v52 row_newbcast:3 row_mask:0xf bank_mask:0xf
  v_dot2c_f32_bf16_dpp v9, v34, v52 row_newbcast:3 row_mask:0xf bank_mask:0xf
  v_dot2c_f32_bf16_dpp v10, v29, v53 row_newbcast:3 row_mask:0xf bank_mask:0xf
  v_dot2c_f32_bf16_dpp v11, v34, v53 row_newbcast:3 row_mask:0xf bank_mask:0xf
  v_dot2c_f32_bf16_dpp v12, v29, v54 row_newbcast:3 row_mask:0xf bank_mask:0xf
  v_dot2c_f32_bf16_dpp v13, v34, v54 row_newbcast:3 row_mask:0xf bank_mask:0xf
  v_dot2c_f32_bf16_dpp v14, v29, v55 row_newbcast:3 row_mask:0xf bank_mask:0xf
  v_dot2c_f32_bf16_dpp v15, v34, v55 row_newbcast:3 row_mask:0xf bank_mask:0xf
  s_cmp_eq_u32 s75, 9
  s_cbranch_scc1 L_epi
  s_call_b64 s[62:63], L_vs
  s_cbranch_scc1 L_nl9
  v_add_u32_dpp v3, v28, v38 row_newbcast:9 row_mask:0xf bank_mask:0xf
  buffer_load_dwordx4 v[76:79], v3, s[48:51], 0 offen nt
L_nl9:
  v_dot2c_f32_bf16_dpp v8, v29, v56 row_newbcast:4 row_mask:0xf bank_mask:0xf
  v_dot2c_f32_bf16_dpp v9, v34, v56 row_newbcast:4 row_mask:0xf bank_mask:0xf
  v_dot2c_f32_bf16_dpp v10, v29, v57 row_newbcast:4 row_mask:0xf bank_mask:0xf
  v_dot2c_f32_bf16_dpp v11, v34, v57 row_newbcast:4 row_mask:0xf bank_mask:0xf
  v_dot2c_f32_bf16_dpp v12, v29, v58 row_newbcast:4 row_mask:0xf bank_mask:0xf
  v_dot2c_f32_bf16_dpp v13, v34, v58 row_newbcast:4 row_mask:0xf bank_mask:0xf
  v_dot2c_f32_bf16_dpp v14, v29, v59 row_newbcast:4 row_mask:0xf bank_mask:0xf
  v_dot2c_f32_bf16_dpp v15, v34, v59 row_newbcast:4 row_mask:0xf bank_mask:0xf
  s_cmp_eq_u32 s75, 10
  s_cbranch_scc1 L_epi
  s_call_b64 s[62:63], L_vs
  s_cbranch_scc1 L_nl10
  v_add_u32_dpp v3, v28, v38 row_newbcast:10 row_mask:0xf bank_mask:0xf
  buffer_load_dwordx4 v[80:83], v3, s[48:51], 0 offen nt
L_nl10:
  v_dot2c_f32_bf16_dpp v8, v29, v60 row_newbcast:5 row_mask:0xf bank_mask:0xf
  v_dot2c_f32_bf16_dpp v9, v34, v60 row_newbcast:5 row_mask:0xf bank_mask:0xf
  v_dot2c_f32_bf16_dpp v10, v29, v61 row_newbcast:5 row_mask:0xf bank_mask:0xf
  v_dot2c_f32_bf16_dpp v11, v34, v61 row_newbcast:5 row_mask:0xf bank_mask:0xf
  v_dot2c_f32_bf16_dpp v12, v29, v62 row_newbcast:5 row_mask:0xf bank_mask:0xf
  v_dot2c_f32_bf16_dpp v13, v34, v62 row_newbcast:5 row_mask:0xf bank_mask:0xf
  v_dot2c_f32_bf16_dpp v14, v29, v63 row_newbcast:5 row_mask:0xf bank_mask:0xf
  v_dot2c_f32_bf16_dpp v15, v34, v63 row_newbcast:5 row_mask:0xf bank_mask:0xf
  s_cmp_eq_u32 s75, 11
  s_cbranch_scc1 L_epi
  s_call_b64 s[62:63], L_vs
  s_cbranch_scc1 L_nl11
  v_add_u32_dpp v3, v28, v38 row_newbcast:11 row_mask:0xf bank_mask:0xf
  buffer_load_dwordx4 v[84:87], v3, s[48:51], 0 offen nt
L_nl11:
  v_dot2c_f32_bf16_dpp v8, v29, v64 row_newbcast:6 row_mask:0xf bank_mask:0xf
  v_dot2c_f32_bf16_dpp v9, v34, v64 row_newbcast:6 row_mask:0xf bank_mask:0xf
  v_dot2c_f32_bf16_dpp v10, v29, v65 row_newbcast:6 row_mask:0xf bank_mask:0xf
  v_dot2c_f32_bf16_dpp v11, v34, v65 row_newbcast:6 row_mask:0xf bank_mask:0xf
  v_dot2c_f32_bf16_dpp v12, v29, v66 row_newbcast:6 row_mask:0xf bank_mask:0xf
  v_dot2c_f32_bf16_dpp v13, v34, v66 row_newbcast:6 row_mask:0xf bank_mask:0xf
  v_dot2c_f32_bf16_dpp v14, v29, v67 row_newbcast:6 row_mask:0xf bank_mask:0xf
  v_dot2c_f32_bf16_dpp v15, v34, v67 row_newbcast:6 row_mask:0xf bank_mask:0xf
  s_cmp_eq_u32 s75, 12
  s_cbranch_scc1 L_epi
  s_call_b64 s[62:63], L_vs
  s_cbranch_scc1 L_nl12
  v_add_u32_dpp v3, v28, v38 row_newbcast:12 row_mask:0xf bank_mask:0xf
  buffer_load_dwordx4 v[88:91], v3, s[48:51], 0 offen nt
L_nl12:
  v_dot2c_f32_bf16_dpp v8, v29, v68 row_newbcast:7 row_mask:0xf bank_mask:0xf
  v_dot2c_f32_bf16_dpp v9, v34, v68 row_newbcast:7 row_mask:0xf bank_mask:0xf
  v_dot2c_f32_bf16_dpp v10, v29, v69 row_newbcast:7 row_mask:0xf bank_mask:0xf
  v_dot2c_f32_bf16_dpp v11, v34, v69 row_newbcast:7 row_mask:0xf bank_mask:0xf
  v_dot2c_f32_bf16_dpp v12, v29, v70 row_newbcast:7 row_mask:0xf bank_mask:0xf
  v_dot2c_f32_bf16_dpp v13, v34, v70 row_newbcast:7 row_mask:0xf bank_mask:0xf
  v_dot2c_f32_bf16_dpp v14, v29, v71 row_newbcast:7 row_mask:0xf bank_mask:0xf
  v_dot2c_f32_bf16_dpp v15, v34, v71 row_newbcast:7 row_mask:0xf bank_mask:0xf
  s_cmp_eq_u32 s75, 13
  s_cbranch_scc1 L_epi
  s_call_b64 s[62:63], L_vs
  s_cbranch_scc1 L_nl13
  v_add_u32_dpp v3, v28, v38 row_newbcast:13 row_mask:0xf bank_mask:0xf
  buffer_load_dwordx4 v[92:95], v3, s[48:51], 0 offen nt
L_nl13:
  v_dot2c_f32_bf16_dpp v8, v29, v72 row_newbcast:8 row_mask:0xf bank_mask:0xf
  v_dot2c_f32_bf16_dpp v9, v34, v72 row_newbcast:8 row_mask:0xf bank_mask:0xf
  v_dot2c_f32_bf16_dpp v10, v29, v73 row_newbcast:8 row_mask:0xf bank_mask:0xf
  v_dot2c_f32_bf16_dpp v11, v34, v73 row_newbcast:8 row_mask:0xf bank_mask:0xf
  v_dot2c_f32_bf16_dpp v12, v29, v74 row_newbcast:8 row_mask:0xf bank_mask:0xf
  v_dot2c_f32_bf16_dpp v13, v34, v74 row_newbcast:8 row_mask:0xf bank_mask:0xf
  v_dot2c_f32_bf16_dpp v14, v29, v75 row_newbcast:8 row_mask:0xf bank_mask:0xf
  v_dot2c_f32_bf16_dpp v15, v34, v75 row_newbcast:8 row_mask:0xf bank_mask:0xf
  s_cmp_eq_u32 s75, 14
  s_cbranch_scc1 L_epi
  s_call_b64 s[62:63], L_vs
  s_cbranch_scc1 L_nl14
  v_add_u32_dpp v3, v28, v38 row_newbcast:14 row_mask:0xf bank_mask:0xf
  buffer_load_dwordx4 v[96:99], v3, s[48:51], 0 offen nt
L_nl14:
  v_dot2c_f32_bf16_dpp v8, v29, v76 row_newbcast:9 row_mask:0xf bank_mask:0xf
  v_dot2c_f32_bf16_dpp v9, v34, v76 row_newbcast:9 row_mask:0xf bank_mask:0xf
  v_dot2c_f32_bf16_dpp v10, v29, v77 row_newbcast:9 row_mask:0xf bank_mask:0xf
  v_dot2c_f32_bf16_dpp v11, v34, v77 row_newbcast:9 row_mask:0xf bank_mask:0xf
  v_dot2c_f32_bf16_dpp v12, v29, v78 row_newbcast:9 row_mask:0xf bank_mask:0xf
  v_dot2c_f32_bf16_dpp v13, v34, v78 row_newbcast:9 row_mask:0xf bank_mask:0xf
  v_dot2c_f32_bf16_dpp v14, v29, v79 row_newbcast:9 row_mask:0xf bank_mask:0xf
  v_dot2c_f32_bf16_dpp v15, v34, v79 row_newbcast:9 row_mask:0xf bank_mask:0xf
  s_cmp_eq_u32 s75, 15
  s_cbranch_scc1 L_epi
  s_call_b64 s[62:63], L_vs
  s_cbranch_scc1 L_nl15
  v_add_u32_dpp v3, v28, v38 row_newbcast:15 row_mask:0xf bank_mask:0xf
  buffer_load_dwordx4 v[100:103], v3, s[48:51], 0 offen nt
L_nl15:
  v_dot2c_f32_bf16_dpp v8, v29, v80 row_newbcast:10 row_mask:0xf bank_mask:0xf
  v_dot2c_f32_bf16_dpp v9, v34, v80 row_newbcast:10 row_mask:0xf bank_mask:0xf
  v_dot2c_f32_bf16_dpp v10, v29, v81 row_newbcast:10 row_mask:0xf bank_mask:0xf
  v_dot2c_f32_bf16_dpp v11, v34, v81 row_newbcast:10 row_mask:0xf bank_mask:0xf
  v_dot2c_f32_bf16_dpp v12, v29, v82 row_newbcast:10 row_mask:0xf bank_mask:0xf
  v_dot2c_f32_bf16_dpp v13, v34, v82 row_newbcast:10 row_mask:0xf bank_mask:0xf
  v_dot2c_f32_bf16_dpp v14, v29, v83 row_newbcast:10 row_mask:0xf bank_mask:0xf
  v_dot2c_f32_bf16_dpp v15, v34, v83 row_newbcast:10 row_mask:0xf bank_mask:0xf
  s_cmp_eq_u32 s75, 16
  s_cbranch_scc1 L_epi
  s_call_b64 s[62:63], L_vs
  s_cbranch_scc1 L_nl16
  v_add_u32_dpp v3, v30, v38 row_newbcast:0 row_mask:0xf bank_mask:0xf
  buffer_load_dwordx4 v[104:107], v3, s[48:51], 0 offen nt
L_nl16:
  v_dot2c_f32_bf16_dpp v8, v29, v84 row_newbcast:11 row_mask:0xf bank_mask:0xf
  v_dot2c_f32_bf16_dpp v9, v34, v84 row_newbcast:11 row_mask:0xf bank_mask:0xf
  v_dot2c_f32_bf16_dpp v10, v29, v85 row_newbcast:11 row_mask:0xf bank_mask:0xf
  v_dot2c_f32_bf16_dpp v11, v34, v85 row_newbcast:11 row_mask:0xf bank_mask:0xf
  v_dot2c_f32_bf16_dpp v12, v29, v86 row_newbcast:11 row_mask:0xf bank_mask:0xf
  v_dot2c_f32_bf16_dpp v13, v34, v86 row_newbcast:11 row_mask:0xf bank_mask:0xf
  v_dot2c_f32_bf16_dpp v14, v29, v87 row_newbcast:11 row_mask:0xf bank_mask:0xf
  v_dot2c_f32_bf16_dpp v15, v34, v87 row_newbcast:11 row_mask:0xf bank_mask:0xf
  s_cmp_eq_u32 s75, 17
  s_cbranch_scc1 L_epi
  s_call_b64 s[62:63], L_vs
  s_cbranch_scc1 L_nl17
  v_add_u32_dpp v3, v30, v38 row_newbcast:1 row_mask:0xf bank_mask:0xf
  buffer_load_dwordx4 v[108:111], v3, s[48:51], 0 offen nt
L_nl17:
  v_dot2c_f32_bf16_dpp v8, v29, v88 row_newbcast:12 row_mask:0xf bank_mask:0xf
  v_dot2c_f32_bf16_dpp v9, v34, v88 row_newbcast:12 row_mask:0xf bank_mask:0xf
  v_dot2c_f32_bf16_dpp v10, v29, v89 row_newbcast:12 row_mask:0xf bank_mask:0xf
  v_dot2c_f32_bf16_dpp v11, v34, v89 row_newbcast:12 row_mask:0xf bank_mask:0xf
  v_dot2c_f32_bf16_dpp v12, v29, v90 row_newbcast:12 row_mask:0xf bank_mask:0xf
  v_dot2c_f32_bf16_dpp v13, v34, v90 row_newbcast:12 row_mask:0xf bank_mask:0xf
  v_dot2c_f32_bf16_dpp v14, v29, v91 row_newbcast:12 row_mask:0xf bank_mask:0xf
  v_dot2c_f32_bf16_dpp v15, v34, v91 row_newbcast:12 row_mask:0xf bank_mask:0xf
  s_cmp_eq_u32 s75, 18
  s_cbranch_scc1 L_epi
  s_call_b64 s[62:63], L_vs
  s_cbranch_scc1 L_nl18
  v_add_u32_dpp v3, v30, v38 row_newbcast:2 row_mask:0xf bank_mask:0xf
  buffer_load_dwordx4 v[112:115], v3, s[48:51], 0 offen nt
L_nl18:
  v_dot2c_f32_bf16_dpp v8, v29, v92 row_newbcast:13 row_mask:0xf bank_mask:0xf
  v_dot2c_f32_bf16_dpp v9, v34, v92 row_newbcast:13 row_mask:0xf bank_mask:0xf
  v_dot2c_f32_bf16_dpp v10, v29, v93 row_newbcast:13 row_mask:0xf bank_mask:0xf
  v_dot2c_f32_bf16_dpp v11, v34, v93 row_newbcast:13 row_mask:0xf bank_mask:0xf
  v_dot2c_f32_bf16_dpp v12, v29, v94 row_newbcast:13 row_mask:0xf bank_mask:0xf
  v_dot2c_f32_bf16_dpp v13, v34, v94 row_newbcast:13 row_mask:0xf bank_mask:0xf
  v_dot2c_f32_bf16_dpp v14, v29, v95 row_newbcast:13 row_mask:0xf bank_mask:0xf
  v_dot2c_f32_bf16_dpp v15, v34, v95 row_newbcast:13 row_mask:0xf bank_mask:0xf
  s_cmp_eq_u32 s75, 19
  s_cbranch_scc1 L_epi
  s_call_b64 s[62:63], L_vs
  s_cbranch_scc1 L_nl19
  v_add_u32_dpp v3, v30, v38 row_newbcast:3 row_mask:0xf bank_mask:0xf
  buffer_load_dwordx4 v[116:119], v3, s[48:51], 0 offen nt
L_nl19:
  v_dot2c_f32_bf16_dpp v8, v29, v96 row_newbcast:14 row_mask:0xf bank_mask:0xf
  v_dot2c_f32_bf16_dpp v9, v34, v96 row_newbcast:14 row_mask:0xf bank_mask:0xf
  v_dot2c_f32_bf16_dpp v10, v29, v97 row_newbcast:14 row_mask:0xf bank_mask:0xf
  v_dot2c_f32_bf16_dpp v11, v34, v97 row_newbcast:14 row_mask:0xf bank_mask:0xf
  v_dot2c_f32_bf16_dpp v12, v29, v98 row_newbcast:14 row_mask:0xf bank_mask:0xf
  v_dot2c_f32_bf16_dpp v13, v34, v98 row_newbcast:14 row_mask:0xf bank_mask:0xf
  v_dot2c_f32_bf16_dpp v14, v29, v99 row_newbcast:14 row_mask:0xf bank_mask:0xf
  v_dot2c_f32_bf16_dpp v15, v34, v99 row_newbcast:14 row_mask:0xf bank_mask:0xf
  s_cmp_eq_u32 s75, 20
  s_cbranch_scc1 L_epi
  s_call_b64 s[62:63], L_vs
  s_cbranch_scc1 L_nl20
  v_add_u32_dpp v3, v30, v38 row_newbcast:4 row_mask:0xf bank_mask:0xf
  buffer_load_dwordx4 v[120:123], v3, s[48:51], 0 offen nt
L_nl20:
  v_dot2c_f32_bf16_dpp v8, v29, v100 row_newbcast:15 row_mask:0xf bank_mask:0xf
  v_dot2c_f32_bf16_dpp v9, v34, v100 row_newbcast:15 row_mask:0xf bank_mask:0xf
  v_dot2c_f32_bf16_dpp v10, v29, v101 row_newbcast:15 row_mask:0xf bank_mask:0xf
  v_dot2c_f32_bf16_dpp v11, v34, v101 row_newbcast:15 row_mask:0xf bank_mask:0xf
  v_dot2c_f32_bf16_dpp v12, v29, v102 row_newbcast:15 row_mask:0xf bank_mask:0xf
  v_dot2c_f32_bf16_dpp v13, v34, v102 row_newbcast:15 row_mask:0xf bank_mask:0xf
  v_dot2c_f32_bf16_dpp v14, v29, v103 row_newbcast:15 row_mask:0xf bank_mask:0xf
  v_dot2c_f32_bf16_dpp v15, v34, v103 row_newbcast:15 row_mask:0xf bank_mask:0xf
  s_cmp_eq_u32 s75, 21
  s_cbranch_scc1 L_epi
  s_call_b64 s[62:63], L_vs
  s_cbranch_scc1 L_nl21
  v_add_u32_dpp v3, v30, v38 row_newbcast:5 row_mask:0xf bank_mask:0xf
  buffer_load_dwordx4 v[124:127], v3, s[48:51], 0 offen nt
L_nl21:
  v_dot2c_f32_bf16_dpp v8, v31, v104 row_newbcast:0 row_mask:0xf bank_mask:0xf
  v_dot2c_f32_bf16_dpp v9, v35, v104 row_newbcast:0 row_mask:0xf bank_mask:0xf
  v_dot2c_f32_bf16_dpp v10, v31, v105 row_newbcast:0 row_mask:0xf bank_mask:0xf
  v_dot2c_f32_bf16_dpp v11, v35, v105 row_newbcast:0 row_mask:0xf bank_mask:0xf
  v_dot2c_f32_bf16_dpp v12, v31, v106 row_newbcast:0 row_mask:0xf bank_mask:0xf
  v_dot2c_f32_bf16_dpp v13, v35, v106 row_newbcast:0 row_mask:0xf bank_mask:0xf
  v_dot2c_f32_bf16_dpp v14, v31, v107 row_newbcast:0 row_mask:0xf bank_mask:0xf
  v_dot2c_f32_bf16_dpp v15, v35, v107 row_newbcast:0 row_mask:0xf bank_mask:0xf
  s_cmp_eq_u32 s75, 22
  s_cbranch_scc1 L_epi
  s_call_b64 s[62:63], L_vs
  s_cbranch_scc1 L_nl22
  v_add_u32_dpp v3, v30, v38 row_newbcast:6 row_mask:0xf bank_mask:0xf
  buffer_load_dwordx4 v[128:131], v3, s[48:51], 0 offen nt
L_nl22:
  v_dot2c_f32_bf16_dpp v8, v31, v108 row_newbcast:1 row_mask:0xf bank_mask:0xf
  v_dot2c_f32_bf16_dpp v9, v35, v108 row_newbcast:1 row_mask:0xf bank_mask:0xf
  v_dot2c_f32_bf16_dpp v10, v31, v109 row_newbcast:1 row_mask:0xf bank_mask:0xf
  v_dot2c_f32_bf16_dpp v11, v35, v109 row_newbcast:1 row_mask:0xf bank_mask:0xf
  v_dot2c_f32_bf16_dpp v12, v31, v110 row_newbcast:1 row_mask:0xf bank_mask:0xf
  v_dot2c_f32_bf16_dpp v13, v35, v110 row_newbcast:1 row_mask:0xf bank_mask:0xf
  v_dot2c_f32_bf16_dpp v14, v31, v111 row_newbcast:1 row_mask:0xf bank_mask:0xf
  v_dot2c_f32_bf16_dpp v15, v35, v111 row_newbcast:1 row_mask:0xf bank_mask:0xf
  s_cmp_eq_u32 s75, 23
  s_cbranch_scc1 L_epi
  s_call_b64 s[62:63], L_vs
  s_cbranch_scc1 L_nl23
  v_add_u32_dpp v3, v30, v38 row_newbcast:7 row_mask:0xf bank_mask:0xf
  buffer_load_dwordx4 v[132:135], v3, s[48:51], 0 offen nt
L_nl23:
  v_dot2c_f32_bf16_dpp v8, v31, v112 row_newbcast:2 row_mask:0xf bank_mask:0xf
  v_dot2c_f32_bf16_dpp v9, v35, v112 row_newbcast:2 row_mask:0xf bank_mask:0xf
  v_dot2c_f32_bf16_dpp v10, v31, v113 row_newbcast:2 row_mask:0xf bank_mask:0xf
  v_dot2c_f32_bf16_dpp v11, v35, v113 row_newbcast:2 row_mask:0xf bank_mask:0xf
  v_dot2c_f32_bf16_dpp v12, v31, v114 row_newbcast:2 row_mask:0xf bank_mask:0xf
  v_dot2c_f32_bf16_dpp v13, v35, v114 row_newbcast:2 row_mask:0xf bank_mask:0xf
  v_dot2c_f32_bf16_dpp v14, v31, v115 row_newbcast:2 row_mask:0xf bank_mask:0xf
  v_dot2c_f32_bf16_dpp v15, v35, v115 row_newbcast:2 row_mask:0xf bank_mask:0xf
  s_cmp_eq_u32 s75, 24
  s_cbranch_scc1 L_epi
  s_call_b64 s[62:63], L_vs
  s_cbranch_scc1 L_nl24
  v_add_u32_dpp v3, v30, v38 row_newbcast:8 row_mask:0xf bank_mask:0xf
  buffer_load_dwordx4 v[136:139], v3, s[48:51], 0 offen nt
L_nl24:
  v_dot2c_f32_bf16_dpp v8, v31, v116 row_newbcast:3 row_mask:0xf bank_mask:0xf
  v_dot2c_f32_bf16_dpp v9, v35, v116 row_newbcast:3 row_mask:0xf bank_mask:0xf
  v_dot2c_f32_bf16_dpp v10, v31, v117 row_newbcast:3 row_mask:0xf bank_mask:0xf
  v_dot2c_f32_bf16_dpp v11, v35, v117 row_newbcast:3 row_mask:0xf bank_mask:0xf
  v_dot2c_f32_bf16_dpp v12, v31, v118 row_newbcast:3 row_mask:0xf bank_mask:0xf
  v_dot2c_f32_bf16_dpp v13, v35, v118 row_newbcast:3 row_mask:0xf bank_mask:0xf
  v_dot2c_f32_bf16_dpp v14, v31, v119 row_newbcast:3 row_mask:0xf bank_mask:0xf
  v_dot2c_f32_bf16_dpp v15, v35, v119 row_newbcast:3 row_mask:0xf bank_mask:0xf
  s_cmp_eq_u32 s75, 25
  s_cbranch_scc1 L_epi
  s_call_b64 s[62:63], L_vs
  s_cbranch_scc1 L_nl25
  v_add_u32_dpp v3, v30, v38 row_newbcast:9 row_mask:0xf bank_mask:0xf
  buffer_load_dwordx4 v[140:143], v3, s[48:51], 0 offen nt
L_nl25:
  v_dot2c_f32_bf16_dpp v8, v31, v120 row_newbcast:4 row_mask:0xf bank_mask:0xf
  v_dot2c_f32_bf16_dpp v9, v35, v120 row_newbcast:4 row_mask:0xf bank_mask:0xf
  v_dot2c_f32_bf16_dpp v10, v31, v121 row_newbcast:4 row_mask:0xf bank_mask:0xf
  v_dot2c_f32_bf16_dpp v11, v35, v121 row_newbcast:4 row_mask:0xf bank_mask:0xf
  v_dot2c_f32_bf16_dpp v12, v31, v122 row_newbcast:4 row_mask:0xf bank_mask:0xf
  v_dot2c_f32_bf16_dpp v13, v35, v122 row_newbcast:4 row_mask:0xf bank_mask:0xf
  v_dot2c_f32_bf16_dpp v14, v31, v123 row_newbcast:4 row_mask:0xf bank_mask:0xf
  v_dot2c_f32_bf16_dpp v15, v35, v123 row_newbcast:4 row_mask:0xf bank_mask:0xf
  s_cmp_eq_u32 s75, 26
  s_cbranch_scc1 L_epi
  s_call_b64 s[62:63], L_vs
  s_cbranch_scc1 L_nl26
  v_add_u32_dpp v3, v30, v38 row_newbcast:10 row_mask:0xf bank_mask:0xf
  buffer_load_dwordx4 v[144:147], v3, s[48:51], 0 offen nt
L_nl26:
  v_dot2c_f32_bf16_dpp v8, v31, v124 row_newbcast:5 row_mask:0xf bank_mask:0xf
  v_dot2c_f32_bf16_dpp v9, v35, v124 row_newbcast:5 row_mask:0xf bank_mask:0xf
  v_dot2c_f32_bf16_dpp v10, v31, v125 row_newbcast:5 row_mask:0xf bank_mask:0xf
  v_dot2c_f32_bf16_dpp v11, v35, v125 row_newbcast:5 row_mask:0xf bank_mask:0xf
  v_dot2c_f32_bf16_dpp v12, v31, v126 row_newbcast:5 row_mask:0xf bank_mask:0xf
  v_dot2c_f32_bf16_dpp v13, v35, v126 row_newbcast:5 row_mask:0xf bank_mask:0xf
  v_dot2c_f32_bf16_dpp v14, v31, v127 row_newbcast:5 row_mask:0xf bank_mask:0xf
  v_dot2c_f32_bf16_dpp v15, v35, v127 row_newbcast:5 row_mask:0xf bank_mask:0xf
  s_cmp_eq_u32 s75, 27
  s_cbranch_scc1 L_epi
  s_call_b64 s[62:63], L_vs
  s_cbranch_scc1 L_nl27
  v_add_u32_dpp v3, v30, v38 row_newbcast:11 row_mask:0xf bank_mask:0xf
  buffer_load_dwordx4 v[148:151], v3, s[48:51], 0 offen nt
L_nl27:
  v_dot2c_f32_bf16_dpp v8, v31, v128 row_newbcast:6 row_mask:0xf bank_mask:0xf
  v_dot2c_f32_bf16_dpp v9, v35, v128 row_newbcast:6 row_mask:0xf bank_mask:0xf
  v_dot2c_f32_bf16_dpp v10, v31, v129 row_newbcast:6 row_mask:0xf bank_mask:0xf
  v_dot2c_f32_bf16_dpp v11, v35, v129 row_newbcast:6 row_mask:0xf bank_mask:0xf
  v_dot2c_f32_bf16_dpp v12, v31, v130 row_newbcast:6 row_mask:0xf bank_mask:0xf
  v_dot2c_f32_bf16_dpp v13, v35, v130 row_newbcast:6 row_mask:0xf bank_mask:0xf
  v_dot2c_f32_bf16_dpp v14, v31, v131 row_newbcast:6 row_mask:0xf bank_mask:0xf
  v_dot2c_f32_bf16_dpp v15, v35, v131 row_newbcast:6 row_mask:0xf bank_mask:0xf
  s_cmp_eq_u32 s75, 28
  s_cbranch_scc1 L_epi
  s_call_b64 s[62:63], L_vs
  s_cbranch_scc1 L_nl28
  v_add_u32_dpp v3, v30, v38 row_newbcast:12 row_mask:0xf bank_mask:0xf
  buffer_load_dwordx4 v[152:155], v3, s[48:51], 0 offen nt
L_nl28:
  v_dot2c_f32_bf16_dpp v8, v31, v132 row_newbcast:7 row_mask:0xf bank_mask:0xf
  v_dot2c_f32_bf16_dpp v9, v35, v132 row_newbcast:7 row_mask:0xf bank_mask:0xf
  v_dot2c_f32_bf16_dpp v10, v31, v133 row_newbcast:7 row_mask:0xf bank_mask:0xf
  v_dot2c_f32_bf16_dpp v11, v35, v133 row_newbcast:7 row_mask:0xf bank_mask:0xf
  v_dot2c_f32_bf16_dpp v12, v31, v134 row_newbcast:7 row_mask:0xf bank_mask:0xf
  v_dot2c_f32_bf16_dpp v13, v35, v134 row_newbcast:7 row_mask:0xf bank_mask:0xf
  v_dot2c_f32_bf16_dpp v14, v31, v135 row_newbcast:7 row_mask:0xf bank_mask:0xf
  v_dot2c_f32_bf16_dpp v15, v35, v135 row_newbcast:7 row_mask:0xf bank_mask:0xf
  s_cmp_eq_u32 s75, 29
  s_cbranch_scc1 L_epi
  s_call_b64 s[62:63], L_vs
  s_cbranch_scc1 L_nl29
  v_add_u32_dpp v3, v30, v38 row_newbcast:13 row_mask:0xf bank_mask:0xf
  buffer_load_dwordx4 v[156:159], v3, s[48:51], 0 offen nt
L_nl29:
  v_dot2c_f32_bf16_dpp v8, v31, v136 row_newbcast:8 row_mask:0xf bank_mask:0xf
  v_dot2c_f32_bf16_dpp v9, v35, v136 row_newbcast:8 row_mask:0xf bank_mask:0xf
  v_dot2c_f32_bf16_dpp v10, v31, v137 row_newbcast:8 row_mask:0xf bank_mask:0xf
  v_dot2c_f32_bf16_dpp v11, v35, v137 row_newbcast:8 row_mask:0xf bank_mask:0xf
  v_dot2c_f32_bf16_dpp v12, v31, v138 row_newbcast:8 row_mask:0xf bank_mask:0xf
  v_dot2c_f32_bf16_dpp v13, v35, v138 row_newbcast:8 row_mask:0xf bank_mask:0xf
  v_dot2c_f32_bf16_dpp v14, v31, v139 row_newbcast:8 row_mask:0xf bank_mask:0xf
  v_dot2c_f32_bf16_dpp v15, v35, v139 row_newbcast:8 row_mask:0xf bank_mask:0xf
  s_cmp_eq_u32 s75, 30
  s_cbranch_scc1 L_epi
  s_call_b64 s[62:63], L_vs
  s_cbranch_scc1 L_nl30
  v_add_u32_dpp v3, v30, v38 row_newbcast:14 row_mask:0xf bank_mask:0xf
  buffer_load_dwordx4 v[160:163], v3, s[48:51], 0 offen nt
L_nl30:
  v_dot2c_f32_bf16_dpp v8, v31, v140 row_newbcast:9 row_mask:0xf bank_mask:0xf
  v_dot2c_f32_bf16_dpp v9, v35, v140 row_newbcast:9 row_mask:0xf bank_mask:0xf
  v_dot2c_f32_bf16_dpp v10, v31, v141 row_newbcast:9 row_mask:0xf bank_mask:0xf
  v_dot2c_f32_bf16_dpp v11, v35, v141 row_newbcast:9 row_mask:0xf bank_mask:0xf
  v_dot2c_f32_bf16_dpp v12, v31, v142 row_newbcast:9 row_mask:0xf bank_mask:0xf
  v_dot2c_f32_bf16_dpp v13, v35, v142 row_newbcast:9 row_mask:0xf bank_mask:0xf
  v_dot2c_f32_bf16_dpp v14, v31, v143 row_newbcast:9 row_mask:0xf bank_mask:0xf
  v_dot2c_f32_bf16_dpp v15, v35, v143 row_newbcast:9 row_mask:0xf bank_mask:0xf
  s_cmp_eq_u32 s75, 31
  s_cbranch_scc1 L_epi
  s_call_b64 s[62:63], L_vs
  s_cbranch_scc1 L_nl31
  v_add_u32_dpp v3, v30, v38 row_newbcast:15 row_mask:0xf bank_mask:0xf
  buffer_load_dwordx4 v[164:167], v3, s[48:51], 0 offen nt
L_nl31:
  v_dot2c_f32_bf16_dpp v8, v31, v144 row_newbcast:10 row_mask:0xf bank_mask:0xf
  v_dot2c_f32_bf16_dpp v9, v35, v144 row_newbcast:10 row_mask:0xf bank_mask:0xf
  v_dot2c_f32_bf16_dpp v10, v31, v145 row_newbcast:10 row_mask:0xf bank_mask:0xf
  v_dot2c_f32_bf16_dpp v11, v35, v145 row_newbcast:10 row_mask:0xf bank_mask:0xf
  v_dot2c_f32_bf16_dpp v12, v31, v146 row_newbcast:10 row_mask:0xf bank_mask:0xf
  v_dot2c_f32_bf16_dpp v13, v35, v146 row_newbcast:10 row_mask:0xf bank_mask:0xf
  v_dot2c_f32_bf16_dpp v14, v31, v147 row_newbcast:10 row_mask:0xf bank_mask:0xf
  v_dot2c_f32_bf16_dpp v15, v35, v147 row_newbcast:10 row_mask:0xf bank_mask:0xf
  s_cmp_eq_u32 s75, 32
  s_cbranch_scc1 L_epi
  s_call_b64 s[62:63], L_vs
  s_cbranch_scc1 L_nl32
  v_add_u32_dpp v3, v32, v38 row_newbcast:0 row_mask:0xf bank_mask:0xf
  buffer_load_dwordx4 v[40:43], v3, s[48:51], 0 offen nt
L_nl32:
  v_dot2c_f32_bf16_dpp v8, v31, v148 row_newbcast:11 row_mask:0xf bank_mask:0xf
  v_dot2c_f32_bf16_dpp v9, v35, v148 row_newbcast:11 row_mask:0xf bank_mask:0xf
  v_dot2c_f32_bf16_dpp v10, v31, v149 row_newbcast:11 row_mask:0xf bank_mask:0xf
  v_dot2c_f32_bf16_dpp v11, v35, v149 row_newbcast:11 row_mask:0xf bank_mask:0xf
  v_dot2c_f32_bf16_dpp v12, v31, v150 row_newbcast:11 row_mask:0xf bank_mask:0xf
  v_dot2c_f32_bf16_dpp v13, v35, v150 row_newbcast:11 row_mask:0xf bank_mask:0xf
  v_dot2c_f32_bf16_dpp v14, v31, v151 row_newbcast:11 row_mask:0xf bank_mask:0xf
  v_dot2c_f32_bf16_dpp v15, v35, v151 row_newbcast:11 row_mask:0xf bank_mask:0xf
  s_cmp_eq_u32 s75, 33
  s_cbranch_scc1 L_epi
  s_call_b64 s[62:63], L_vs
  s_cbranch_scc1 L_nl33
  v_add_u32_dpp v3, v32, v38 row_newbcast:1 row_mask:0xf bank_mask:0xf
  buffer_load_dwordx4 v[44:47], v3, s[48:51], 0 offen nt
L_nl33:
  v_dot2c_f32_bf16_dpp v8, v31, v152 row_newbcast:12 row_mask:0xf bank_mask:0xf
  v_dot2c_f32_bf16_dpp v9, v35, v152 row_newbcast:12 row_mask:0xf bank_mask:0xf
  v_dot2c_f32_bf16_dpp v10, v31, v153 row_newbcast:12 row_mask:0xf bank_mask:0xf
  v_dot2c_f32_bf16_dpp v11, v35, v153 row_newbcast:12 row_mask:0xf bank_mask:0xf
  v_dot2c_f32_bf16_dpp v12, v31, v154 row_newbcast:12 row_mask:0xf bank_mask:0xf
  v_dot2c_f32_bf16_dpp v13, v35, v154 row_newbcast:12 row_mask:0xf bank_mask:0xf
  v_dot2c_f32_bf16_dpp v14, v31, v155 row_newbcast:12 row_mask:0xf bank_mask:0xf
  v_dot2c_f32_bf16_dpp v15, v35, v155 row_newbcast:12 row_mask:0xf bank_mask:0xf
  s_cmp_eq_u32 s75, 34
  s_cbranch_scc1 L_epi
  s_call_b64 s[62:63], L_vs
  s_cbranch_scc1 L_nl34
  v_add_u32_dpp v3, v32, v38 row_newbcast:2 row_mask:0xf bank_mask:0xf
  buffer_load_dwordx4 v[48:51], v3, s[48:51], 0 offen nt
L_nl34:
  v_dot2c_f32_bf16_dpp v8, v31, v156 row_newbcast:13 row_mask:0xf bank_mask:0xf
  v_dot2c_f32_bf16_dpp v9, v35, v156 row_newbcast:13 row_mask:0xf bank_mask:0xf
  v_dot2c_f32_bf16_dpp v10, v31, v157 row_newbcast:13 row_mask:0xf bank_mask:0xf
  v_dot2c_f32_bf16_dpp v11, v35, v157 row_newbcast:13 row_mask:0xf bank_mask:0xf
  v_dot2c_f32_bf16_dpp v12, v31, v158 row_newbcast:13 row_mask:0xf bank_mask:0xf
  v_dot2c_f32_bf16_dpp v13, v35, v158 row_newbcast:13 row_mask:0xf bank_mask:0xf
  v_dot2c_f32_bf16_dpp v14, v31, v159 row_newbcast:13 row_mask:0xf bank_mask:0xf
  v_dot2c_f32_bf16_dpp v15, v35, v159 row_newbcast:13 row_mask:0xf bank_mask:0xf
  s_cmp_eq_u32 s75, 35
  s_cbranch_scc1 L_epi
  s_call_b64 s[62:63], L_vs
  s_cbranch_scc1 L_nl35
  v_add_u32_dpp v3, v32, v38 row_newbcast:3 row_mask:0xf bank_mask:0xf
  buffer_load_dwordx4 v[52:55], v3, s[48:51], 0 offen nt
L_nl35:
  v_dot2c_f32_bf16_dpp v8, v31, v160 row_newbcast:14 row_mask:0xf bank_mask:0xf
  v_dot2c_f32_bf16_dpp v9, v35, v160 row_newbcast:14 row_mask:0xf bank_mask:0xf
  v_dot2c_f32_bf16_dpp v10, v31, v161 row_newbcast:14 row_mask:0xf bank_mask:0xf
  v_dot2c_f32_bf16_dpp v11, v35, v161 row_newbcast:14 row_mask:0xf bank_mask:0xf
  v_dot2c_f32_bf16_dpp v12, v31, v162 row_newbcast:14 row_mask:0xf bank_mask:0xf
  v_dot2c_f32_bf16_dpp v13, v35, v162 row_newbcast:14 row_mask:0xf bank_mask:0xf
  v_dot2c_f32_bf16_dpp v14, v31, v163 row_newbcast:14 row_mask:0xf bank_mask:0xf
  v_dot2c_f32_bf16_dpp v15, v35, v163 row_newbcast:14 row_mask:0xf bank_mask:0xf
  s_cmp_eq_u32 s75, 36
  s_cbranch_scc1 L_epi
  s_call_b64 s[62:63], L_vs
  s_cbranch_scc1 L_nl36
  v_add_u32_dpp v3, v32, v38 row_newbcast:4 row_mask:0xf bank_mask:0xf
  buffer_load_dwordx4 v[56:59], v3, s[48:51], 0 offen nt
L_nl36:
  v_dot2c_f32_bf16_dpp v8, v31, v164 row_newbcast:15 row_mask:0xf bank_mask:0xf
  v_dot2c_f32_bf16_dpp v9, v35, v164 row_newbcast:15 row_mask:0xf bank_mask:0xf
  v_dot2c_f32_bf16_dpp v10, v31, v165 row_newbcast:15 row_mask:0xf bank_mask:0xf
  v_dot2c_f32_bf16_dpp v11, v35, v165 row_newbcast:15 row_mask:0xf bank_mask:0xf
  v_dot2c_f32_bf16_dpp v12, v31, v166 row_newbcast:15 row_mask:0xf bank_mask:0xf
  v_dot2c_f32_bf16_dpp v13, v35, v166 row_newbcast:15 row_mask:0xf bank_mask:0xf
  v_dot2c_f32_bf16_dpp v14, v31, v167 row_newbcast:15 row_mask:0xf bank_mask:0xf
  v_dot2c_f32_bf16_dpp v15, v35, v167 row_newbcast:15 row_mask:0xf bank_mask:0xf
  s_cmp_eq_u32 s75, 37
  s_cbranch_scc1 L_epi
  s_call_b64 s[62:63], L_vs
  s_cbranch_scc1 L_nl37
  v_add_u32_dpp v3, v32, v38 row_newbcast:5 row_mask:0xf bank_mask:0xf
  buffer_load_dwordx4 v[60:63], v3, s[48:51], 0 offen nt
L_nl37:
  v_dot2c_f32_bf16_dpp v8, v33, v40 row_newbcast:0 row_mask:0xf bank_mask:0xf
  v_dot2c_f32_bf16_dpp v9, v36, v40 row_newbcast:0 row_mask:0xf bank_mask:0xf
  v_dot2c_f32_bf16_dpp v10, v33, v41 row_newbcast:0 row_mask:0xf bank_mask:0xf
  v_dot2c_f32_bf16_dpp v11, v36, v41 row_newbcast:0 row_mask:0xf bank_mask:0xf
  v_dot2c_f32_bf16_dpp v12, v33, v42 row_newbcast:0 row_mask:0xf bank_mask:0xf
  v_dot2c_f32_bf16_dpp v13, v36, v42 row_newbcast:0 row_mask:0xf bank_mask:0xf
  v_dot2c_f32_bf16_dpp v14, v33, v43 row_newbcast:0 row_mask:0xf bank_mask:0xf
  v_dot2c_f32_bf16_dpp v15, v36, v43 row_newbcast:0 row_mask:0xf bank_mask:0xf
  s_cmp_eq_u32 s75, 38
  s_cbranch_scc1 L_epi
  s_call_b64 s[62:63], L_vs
  v_dot2c_f32_bf16_dpp v8, v33, v44 row_newbcast:1 row_mask:0xf bank_mask:0xf
  v_dot2c_f32_bf16_dpp v9, v36, v44 row_newbcast:1 row_mask:0xf bank_mask:0xf
  v_dot2c_f32_bf16_dpp v10, v33, v45 row_newbcast:1 row_mask:0xf bank_mask:0xf
  v_dot2c_f32_bf16_dpp v11, v36, v45 row_newbcast:1 row_mask:0xf bank_mask:0xf
  v_dot2c_f32_bf16_dpp v12, v33, v46 row_newbcast:1 row_mask:0xf bank_mask:0xf
  v_dot2c_f32_bf16_dpp v13, v36, v46 row_newbcast:1 row_mask:0xf bank_mask:0xf
  v_dot2c_f32_bf16_dpp v14, v33, v47 row_newbcast:1 row_mask:0xf bank_mask:0xf
  v_dot2c_f32_bf16_dpp v15, v36, v47 row_newbcast:1 row_mask:0xf bank_mask:0xf
  s_cmp_eq_u32 s75, 39
  s_cbranch_scc1 L_epi
  s_call_b64 s[62:63], L_vs
  v_dot2c_f32_bf16_dpp v8, v33, v48 row_newbcast:2 row_mask:0xf bank_mask:0xf
  v_dot2c_f32_bf16_dpp v9, v36, v48 row_newbcast:2 row_mask:0xf bank_mask:0xf
  v_dot2c_f32_bf16_dpp v10, v33, v49 row_newbcast:2 row_mask:0xf bank_mask:0xf
  v_dot2c_f32_bf16_dpp v11, v36, v49 row_newbcast:2 row_mask:0xf bank_mask:0xf
  v_dot2c_f32_bf16_dpp v12, v33, v50 row_newbcast:2 row_mask:0xf bank_mask:0xf
  v_dot2c_f32_bf16_dpp v13, v36, v50 row_newbcast:2 row_mask:0xf bank_mask:0xf
  v_dot2c_f32_bf16_dpp v14, v33, v51 row_newbcast:2 row_mask:0xf bank_mask:0xf
  v_dot2c_f32_bf16_dpp v15, v36, v51 row_newbcast:2 row_mask:0xf bank_mask:0xf
  s_cmp_eq_u32 s75, 40
  s_cbranch_scc1 L_epi
  s_call_b64 s[62:63], L_vs
  v_dot2c_f32_bf16_dpp v8, v33, v52 row_newbcast:3 row_mask:0xf bank_mask:0xf
  v_dot2c_f32_bf16_dpp v9, v36, v52 row_newbcast:3 row_mask:0xf bank_mask:0xf
  v_dot2c_f32_bf16_dpp v10, v33, v53 row_newbcast:3 row_mask:0xf bank_mask:0xf
  v_dot2c_f32_bf16_dpp v11, v36, v53 row_newbcast:3 row_mask:0xf bank_mask:0xf
  v_dot2c_f32_bf16_dpp v12, v33, v54 row_newbcast:3 row_mask:0xf bank_mask:0xf
  v_dot2c_f32_bf16_dpp v13, v36, v54 row_newbcast:3 row_mask:0xf bank_mask:0xf
  v_dot2c_f32_bf16_dpp v14, v33, v55 row_newbcast:3 row_mask:0xf bank_mask:0xf
  v_dot2c_f32_bf16_dpp v15, v36, v55 row_newbcast:3 row_mask:0xf bank_mask:0xf
  s_cmp_eq_u32 s75, 41
  s_cbranch_scc1 L_epi
  s_call_b64 s[62:63], L_vs
  v_dot2c_f32_bf16_dpp v8, v33, v56 row_newbcast:4 row_mask:0xf bank_mask:0xf
  v_dot2c_f32_bf16_dpp v9, v36, v56 row_newbcast:4 row_mask:0xf bank_mask:0xf
  v_dot2c_f32_bf16_dpp v10, v33, v57 row_newbcast:4 row_mask:0xf bank_mask:0xf
  v_dot2c_f32_bf16_dpp v11, v36, v57 row_newbcast:4 row_mask:0xf bank_mask:0xf
  v_dot2c_f32_bf16_dpp v12, v33, v58 row_newbcast:4 row_mask:0xf bank_mask:0xf
  v_dot2c_f32_bf16_dpp v13, v36, v58 row_newbcast:4 row_mask:0xf bank_mask:0xf
  v_dot2c_f32_bf16_dpp v14, v33, v59 row_newbcast:4 row_mask:0xf bank_mask:0xf
  v_dot2c_f32_bf16_dpp v15, v36, v59 row_newbcast:4 row_mask:0xf bank_mask:0xf
  s_cmp_eq_u32 s75, 42
  s_cbranch_scc1 L_epi
  s_call_b64 s[62:63], L_vs
  v_dot2c_f32_bf16_dpp v8, v33, v60 row_newbcast:5 row_mask:0xf bank_mask:0xf
  v_dot2c_f32_bf16_dpp v9, v36, v60 row_newbcast:5 row_mask:0xf bank_mask:0xf
  v_dot2c_f32_bf16_dpp v10, v33, v61 row_newbcast:5 row_mask:0xf bank_mask:0xf
  v_dot2c_f32_bf16_dpp v11, v36, v61 row_newbcast:5 row_mask:0xf bank_mask:0xf
  v_dot2c_f32_bf16_dpp v12, v33, v62 row_newbcast:5 row_mask:0xf bank_mask:0xf
  v_dot2c_f32_bf16_dpp v13, v36, v62 row_newbcast:5 row_mask:0xf bank_mask:0xf
  v_dot2c_f32_bf16_dpp v14, v33, v63 row_newbcast:5 row_mask:0xf bank_mask:0xf
  v_dot2c_f32_bf16_dpp v15, v36, v63 row_newbcast:5 row_mask:0xf bank_mask:0xf
  s_nop 1
L_epi:
  s_nop 0
  s_nop 0
  v_permlane32_swap_b32 v8, v12
  v_permlane32_swap_b32 v9, v13
  v_permlane32_swap_b32 v10, v14
  v_permlane32_swap_b32 v11, v15
  v_add_f32 v8, v8, v12
  v_add_f32 v9, v9, v13
  v_add_f32 v10, v10, v14
  v_add_f32 v11, v11, v15
  v_mov_b32 v3, 1
  v_permlane16_swap_b32 v8, v10
  v_permlane16_swap_b32 v9, v11
  v_add_f32 v8, v8, v10
  v_add_f32 v9, v9, v11
  v_pk_add_f32 v[8:9], v[8:9], v[4:5]
  ds_write_b64 v22, v[8:9] offset:7936
  s_cmp_eq_u32 s21, 0
  s_cbranch_scc1 L_ep2
  ds_write_b64 v22, v[8:9] offset:13056
  s_mov_b64 exec, 1
  ds_add_u32 v1, v3 offset:6704
  s_mov_b64 exec, -1
L_ep2:
  s_mov_b64 exec, 1
  ds_add_rtn_u32 v3, v1, v3 offset:6708
  s_mov_b64 exec, -1
  v_mov_b32 v4, 0
  s_lshl_b32 s10, s6, 11
  s_add_u32 s10, s10, 131072
  v_lshl_add_u32 v2, v1, 3, s10
  v_add_u32 v0, 393216, v2
  s_waitcnt lgkmcnt(0)
  v_readfirstlane_b32 s68, v3
  s_cmp_lg_u32 s68, 9
  s_cbranch_scc1 L_send
  s_cmp_lg_u32 s7, 0
  s_cbranch_scc1 L_nolook
  global_load_dwordx2 v[42:43], v0, s[42:43] offset:512 sc1
  global_load_dwordx2 v[44:45], v0, s[42:43] offset:1024 sc1
  global_load_dwordx2 v[46:47], v0, s[42:43] offset:1536 sc1
  global_load_dwordx2 v[48:49], v2, s[42:43] offset:0 sc1
  global_load_dwordx2 v[50:51], v2, s[42:43] offset:512 sc1
  global_load_dwordx2 v[52:53], v2, s[42:43] offset:1024 sc1
  global_load_dwordx2 v[54:55], v2, s[42:43] offset:1536 sc1
L_nolook:
  s_mov_b32 s70, 0
L_pl_1:
  ds_read_b32 v5, v4 offset:6656
  s_waitcnt lgkmcnt(0)
  v_cmp_eq_u32 vcc, -1, v5
  s_cmp_eq_u64 vcc, 0
  s_cbranch_scc1 L_pld_2
  s_sleep 1
  s_add_u32 s70, s70, 1
  s_cmp_lt_u32 s70, 1048576
  s_cbranch_scc1 L_pl_1
L_pld_2:
  v_lshlrev_b32 v160, 3, v1
  ds_read_b128 v[148:151], v4 offset:6784
  ds_read_b128 v[152:155], v4 offset:6800
  ds_read_b128 v[156:159], v4 offset:6816
  ds_read_b64 v[128:129], v160 offset:7936
  ds_read_b64 v[130:131], v160 offset:8448
  ds_read_b64 v[132:133], v160 offset:8960
  ds_read_b64 v[134:135], v160 offset:9472
  ds_read_b64 v[136:137], v160 offset:9984
  ds_read_b64 v[138:139], v160 offset:10496
  ds_read_b64 v[140:141], v160 offset:11008
  ds_read_b64 v[142:143], v160 offset:11520
  ds_read_b64 v[144:145], v160 offset:12032
  ds_read_b64 v[146:147], v160 offset:12544
  s_lshl_b32 s68, s6, 2
  s_add_u32 s68, s68, s7
  s_lshl_b32 s68, s68, 9
  s_add_u32 s68, s68, 524288
  v_add_u32 v160, s68, v160
  v_and_b32 v161, 1, v1
  v_lshlrev_b32 v161, 4, v161
  v_lshrrev_b32 v161, v161, s74
  v_lshrrev_b32 v162, 8, v161
  s_movk_i32 s69, 0xff
  s_waitcnt lgkmcnt(9)
  v_pk_mul_f32 v[128:129], v[128:129], v[148:149] op_sel:[0,0] op_sel_hi:[1,0]
  s_waitcnt lgkmcnt(8)
  v_pk_mul_f32 v[130:131], v[130:131], v[148:149] op_sel:[0,1] op_sel_hi:[1,1]
  s_waitcnt lgkmcnt(7)
  v_pk_fma_f32 v[128:129], v[132:133], v[150:151], v[128:129] op_sel:[0,0,0] op_sel_hi:[1,0,1]
  s_waitcnt lgkmcnt(6)
  v_pk_fma_f32 v[130:131], v[134:135], v[150:151], v[130:131] op_sel:[0,1,0] op_sel_hi:[1,1,1]
  s_waitcnt lgkmcnt(5)
  v_pk_fma_f32 v[128:129], v[136:137], v[152:153], v[128:129] op_sel:[0,0,0] op_sel_hi:[1,0,1]
  s_waitcnt lgkmcnt(4)
  v_pk_fma_f32 v[130:131], v[138:139], v[152:153], v[130:131] op_sel:[0,1,0] op_sel_hi:[1,1,1]
  s_waitcnt lgkmcnt(3)
  v_pk_fma_f32 v[128:129], v[140:141], v[154:155], v[128:129] op_sel:[0,0,0] op_sel_hi:[1,0,1]
  s_waitcnt lgkmcnt(2)
  v_pk_fma_f32 v[130:131], v[142:143], v[154:155], v[130:131] op_sel:[0,1,0] op_sel_hi:[1,1,1]
  s_waitcnt lgkmcnt(1)
  v_pk_fma_f32 v[128:129], v[144:145], v[156:157], v[128:129] op_sel:[0,0,0] op_sel_hi:[1,0,1]
  s_waitcnt lgkmcnt(0)
  v_pk_fma_f32 v[130:131], v[146:147], v[156:157], v[130:131] op_sel:[0,1,0] op_sel_hi:[1,1,1]
  v_pk_add_f32 v[128:129], v[128:129], v[130:131]
  v_bfi_b32 v128, s69, v161, v128
  v_bfi_b32 v129, s69, v162, v129
  global_store_dwordx2 v160, v[128:129], s[42:43] sc1
  s_cmp_lg_u32 s7, 0
  s_cbranch_scc1 L_send
  v_and_b32 v161, 0xff, v161
  v_and_b32 v162, 0xff, v162
  s_mov_b32 s70, 0
  s_waitcnt vmcnt(1)
  s_branch L_cp1
L_cp0:
  global_load_dwordx2 v[42:43], v0, s[42:43] offset:512 sc1
  global_load_dwordx2 v[44:45], v0, s[42:43] offset:1024 sc1
  global_load_dwordx2 v[46:47], v0, s[42:43] offset:1536 sc1
  global_load_dwordx2 v[48:49], v2, s[42:43] offset:0 sc1
  global_load_dwordx2 v[50:51], v2, s[42:43] offset:512 sc1
  global_load_dwordx2 v[52:53], v2, s[42:43] offset:1024 sc1
  global_load_dwordx2 v[54:55], v2, s[42:43] offset:1536 sc1
  s_waitcnt vmcnt(0)
L_cp1:
  v_xor_b32 v48, v48, v161
  v_xor_b32 v49, v49, v162
  v_xor_b32 v50, v50, v161
  v_xor_b32 v51, v51, v162
  v_xor_b32 v52, v52, v161
  v_xor_b32 v53, v53, v162
  v_xor_b32 v54, v54, v161
  v_xor_b32 v55, v55, v162
  v_or3_b32 v56, v48, v49, v50
  v_or3_b32 v57, v51, v52, v53
  v_or3_b32 v56, v56, v54, v55
  v_or_b32 v48, 0x80, v48
  v_or_b32 v49, 0x80, v49
  v_or_b32 v50, 0x80, v50
  v_or_b32 v51, 0x80, v51
  v_or_b32 v52, 0x80, v52
  v_or_b32 v53, 0x80, v53
  v_or_b32 v54, 0x80, v54
  v_or_b32 v55, 0x80, v55
  v_or_b32 v56, v56, v57
  v_pk_add_f32 v[48:49], v[48:49], v[52:53]
  v_pk_add_f32 v[50:51], v[50:51], v[54:55]
  v_lshlrev_b32 v56, 24, v56
  v_pk_add_f32 v[48:49], v[48:49], v[50:51]
  v_cmp_ne_u32 vcc, 0, v56
  v_cvt_pk_bf16_f32 v48, v48, v49
  s_cmp_eq_u64 vcc, 0
  s_cbranch_scc1 L_cp2
  s_sleep 4
  s_add_u32 s70, s70, 1
  s_cmp_lt_u32 s70, 262144
  s_cbranch_scc1 L_cp0
L_cp2:
  s_mov_b32 s70, 0
  s_branch L_cp4
L_cp3:
  global_load_dwordx2 v[42:43], v0, s[42:43] offset:512 sc1
  global_load_dwordx2 v[44:45], v0, s[42:43] offset:1024 sc1
  global_load_dwordx2 v[46:47], v0, s[42:43] offset:1536 sc1
  s_waitcnt vmcnt(0)
L_cp4:
  v_mov_b32 v40, v128
  v_mov_b32 v41, v129
  v_xor_b32 v40, v40, v161
  v_xor_b32 v41, v41, v162
  v_xor_b32 v42, v42, v161
  v_xor_b32 v43, v43, v162
  v_xor_b32 v44, v44, v161
  v_xor_b32 v45, v45, v162
  v_xor_b32 v46, v46, v161
  v_xor_b32 v47, v47, v162
  v_or3_b32 v56, v40, v41, v42
  v_or3_b32 v57, v43, v44, v45
  v_or3_b32 v56, v56, v46, v47
  v_or_b32 v40, 0x80, v40
  v_or_b32 v41, 0x80, v41
  v_or_b32 v42, 0x80, v42
  v_or_b32 v43, 0x80, v43
  v_or_b32 v44, 0x80, v44
  v_or_b32 v45, 0x80, v45
  v_or_b32 v46, 0x80, v46
  v_or_b32 v47, 0x80, v47
  v_or_b32 v56, v56, v57
  v_pk_add_f32 v[40:41], v[40:41], v[44:45]
  v_pk_add_f32 v[42:43], v[42:43], v[46:47]
  v_lshlrev_b32 v56, 24, v56
  v_pk_add_f32 v[40:41], v[40:41], v[42:43]
  v_cmp_ne_u32 vcc, 0, v56
  v_cvt_pk_bf16_f32 v40, v40, v41
  s_cmp_eq_u64 vcc, 0
  s_cbranch_scc1 L_cp5
  s_add_u32 s70, s70, 1
  s_cmp_lt_u32 s70, 262144
  s_cbranch_scc1 L_cp3
L_cp5:
  v_cmp_ne_u32 vcc, v40, v48
  s_cmp_lg_u64 vcc, 0
  s_cbranch_scc1 L_slow
L_send:
  s_endpgm
L_away:
  v_mov_b32 v4, 1
  v_lshlrev_b32 v5, 6, v4
  v_mul_i32_i24 v6, -28, v4
  s_mov_b64 exec, 1
  ds_add_u32 v1, v5 offset:6680
  ds_add_u32 v1, v5 offset:6672
  ds_add_u32 v1, v4 offset:6704
  ds_add_u32 v1, v4 offset:6708
  ds_add_u32 v1, v6 offset:6688
  s_mov_b64 exec, -1
  v_mov_b32 v3, 0
  s_mov_b32 s70, 0
L_aw_3:
  ds_read_b32 v4, v3 offset:6688
  s_waitcnt lgkmcnt(0)
  v_cmp_lt_u32 vcc, 1120, v4
  s_cmp_eq_u64 vcc, 0
  s_cbranch_scc1 L_aw_3d
  s_sleep 8
  s_add_u32 s70, s70, 1
  s_cmp_lt_u32 s70, 2097152
  s_cbranch_scc1 L_aw_3
L_aw_3d:
  s_mov_b32 s32, 16
  s_mov_b32 s10, 0
L_aw2:
  s_call_b64 s[100:101], L_work
  s_sleep 4
  s_add_u32 s10, s10, 1
  s_cmp_ge_u32 s10, 262144
  s_cbranch_scc1 L_end
  s_cmp_lt_u32 s39, 2
  s_cbranch_scc1 L_aw2
  s_bfe_u32 s61, s15, 0x60008
  s_cmp_lg_u32 s9, 7
  s_cbranch_scc1 L_end
  s_cmp_ge_u32 s61, 32
  s_cbranch_scc1 L_end
  s_waitcnt lgkmcnt(0)
  s_load_dwordx2 s[16:17], s[0:1], 0
  s_load_dwordx2 s[38:39], s[0:1], 88
  v_mov_b32 v38, 0
  s_mov_b32 s60, 3
  s_waitcnt vmcnt(0) lgkmcnt(0)
  s_branch L_mid
L_slow:
  s_load_dwordx16 s[16:31], s[0:1], 0
  s_load_dwordx8 s[32:39], s[0:1], 64
  v_and_b32 v2, 31, v1
  v_lshlrev_b32 v2, 7, v2
  v_add_u32 v2, 28672, v2
  s_mov_b32 s70, 0
L_sl_d:
  global_load_dword v3, v2, s[42:43] sc1
  s_waitcnt vmcnt(0) lgkmcnt(0)
  v_cmp_ne_u32 vcc, s74, v3
  s_cmp_eq_u64 vcc, 0
  s_cbranch_scc1 L_sl_dd
  s_sleep 8
  s_add_u32 s70, s70, 1
  s_cmp_lt_u32 s70, 262144
  s_cbranch_scc1 L_sl_d
L_sl_dd:
  v_lshlrev_b32 v2, 3, v1
  v_add_u32 v2, 524288, v2
  v_lshlrev_b32 v0, 2, v1
  v_add_u32 v0, 83968, v0
  s_mov_b32 s10, 0
L_sl_h:
  s_mov_b32 s70, 0
L_sl_hp:
  global_load_dwordx2 v[40:41], v2, s[42:43] offset:0 sc1
  global_load_dwordx2 v[42:43], v2, s[42:43] offset:512 sc1
  global_load_dwordx2 v[44:45], v2, s[42:43] offset:1024 sc1
  global_load_dwordx2 v[46:47], v2, s[42:43] offset:1536 sc1
  s_waitcnt vmcnt(0)
  v_xor_b32 v40, v40, v161
  v_xor_b32 v41, v41, v162
  v_xor_b32 v42, v42, v161
  v_xor_b32 v43, v43, v162
  v_xor_b32 v44, v44, v161
  v_xor_b32 v45, v45, v162
  v_xor_b32 v46, v46, v161
  v_xor_b32 v47, v47, v162
  v_or3_b32 v48, v40, v41, v42
  v_or3_b32 v49, v43, v44, v45
  v_or3_b32 v48, v48, v46, v47
  v_or_b32 v40, 0x80, v40
  v_or_b32 v41, 0x80, v41
  v_or_b32 v42, 0x80, v42
  v_or_b32 v43, 0x80, v43
  v_or_b32 v44, 0x80, v44
  v_or_b32 v45, 0x80, v45
  v_or_b32 v46, 0x80, v46
  v_or_b32 v47, 0x80, v47
  v_or_b32 v48, v48, v49
  v_pk_add_f32 v[40:41], v[40:41], v[44:45]
  v_pk_add_f32 v[42:43], v[42:43], v[46:47]
  v_lshlrev_b32 v48, 24, v48
  v_pk_add_f32 v[40:41], v[40:41], v[42:43]
  v_cmp_ne_u32 vcc, 0, v48
  v_cvt_pk_bf16_f32 v40, v40, v41
  s_cmp_eq_u64 vcc, 0
  s_cbranch_scc1 L_sl_hd
  s_sleep 8
  s_add_u32 s70, s70, 1
  s_cmp_lt_u32 s70, 262144
  s_cbranch_scc1 L_sl_hp
L_sl_hd:
  ds_write_b32 v0, v40
  v_add_u32 v2, 2048, v2
  v_add_u32 v0, 256, v0
  s_add_u32 s10, s10, 1
  s_cmp_lt_u32 s10, 64
  s_cbranch_scc1 L_sl_h
  s_mov_b32 s44, s24
  s_mov_b32 s45, s25
  s_mov_b32 s46, 4194304
  s_mov_b32 s11, 1024
  s_mov_b32 s12, 4194304
  v_mov_b32 v4, 83968
  v_mov_b32 v5, 92160
  v_lshlrev_b32 v2, 4, v1
  s_call_b64 s[62:63], L_gv
  v_lshlrev_b32 v0, 4, v1
  global_load_dwordx4 v[40:43], v0, s[16:17] offset:0
  global_load_dwordx4 v[44:47], v0, s[16:17] offset:1024
  s_waitcnt vmcnt(0)
  v_lshlrev_b32 v104, 16, v40
  v_and_b32 v105, s73, v40
  v_lshlrev_b32 v106, 16, v41
  v_and_b32 v107, s73, v41
  v_lshlrev_b32 v108, 16, v42
  v_and_b32 v109, s73, v42
  v_lshlrev_b32 v110, 16, v43
  v_and_b32 v111, s73, v43
  v_lshlrev_b32 v112, 16, v44
  v_and_b32 v113, s73, v44
  v_lshlrev_b32 v114, 16, v45
  v_and_b32 v115, s73, v45
  v_lshlrev_b32 v116, 16, v46
  v_and_b32 v117, s73, v46
  v_lshlrev_b32 v118, 16, v47
  v_and_b32 v119, s73, v47
  v_lshrrev_b32 v2, 1, v1
  v_lshlrev_b32 v2, 7, v2
  v_and_b32 v3, 1, v1
  v_lshl_add_u32 v2, v3, 5, v2
  v_add_u32 v2, 12288, v2
  global_load_dwordx4 v[40:43], v2, s[42:43] offset:0 sc1
  global_load_dwordx4 v[44:47], v2, s[42:43] offset:16 sc1
  global_load_dwordx4 v[48:51], v2, s[42:43] offset:64 sc1
  global_load_dwordx4 v[52:55], v2, s[42:43] offset:80 sc1
  s_waitcnt vmcnt(0)
  v_lshlrev_b32 v88, 16, v40
  v_and_b32 v89, s73, v40
  v_lshlrev_b32 v90, 16, v42
  v_and_b32 v91, s73, v42
  v_lshlrev_b32 v92, 16, v44
  v_and_b32 v93, s73, v44
  v_lshlrev_b32 v94, 16, v46
  v_and_b32 v95, s73, v46
  v_lshlrev_b32 v96, 16, v48
  v_and_b32 v97, s73, v48
  v_lshlrev_b32 v98, 16, v50
  v_and_b32 v99, s73, v50
  v_lshlrev_b32 v100, 16, v52
  v_and_b32 v101, s73, v52
  v_lshlrev_b32 v102, 16, v54
  v_and_b32 v103, s73, v54
  v_cvt_pk_bf16_f32 v72, 0, v72
  v_cvt_pk_bf16_f32 v73, 0, v73
  v_cvt_pk_bf16_f32 v74, 0, v74
  v_cvt_pk_bf16_f32 v75, 0, v75
  v_cvt_pk_bf16_f32 v76, 0, v76
  v_cvt_pk_bf16_f32 v77, 0, v77
  v_cvt_pk_bf16_f32 v78, 0, v78
  v_cvt_pk_bf16_f32 v79, 0, v79
  v_cvt_pk_bf16_f32 v80, 0, v80
  v_cvt_pk_bf16_f32 v81, 0, v81
  v_cvt_pk_bf16_f32 v82, 0, v82
  v_cvt_pk_bf16_f32 v83, 0, v83
  v_cvt_pk_bf16_f32 v84, 0, v84
  v_cvt_pk_bf16_f32 v85, 0, v85
  v_cvt_pk_bf16_f32 v86, 0, v86
  v_cvt_pk_bf16_f32 v87, 0, v87
  v_mul_f32 v72, v72, v88
  v_mul_f32 v73, v73, v89
  v_mul_f32 v74, v74, v90
  v_mul_f32 v75, v75, v91
  v_mul_f32 v76, v76, v92
  v_mul_f32 v77, v77, v93
  v_mul_f32 v78, v78, v94
  v_mul_f32 v79, v79, v95
  v_mul_f32 v80, v80, v96
  v_mul_f32 v81, v81, v97
  v_mul_f32 v82, v82, v98
  v_mul_f32 v83, v83, v99
  v_mul_f32 v84, v84, v100
  v_mul_f32 v85, v85, v101
  v_mul_f32 v86, v86, v102
  v_mul_f32 v87, v87, v103
  v_cvt_pk_bf16_f32 v72, 0, v72
  v_cvt_pk_bf16_f32 v73, 0, v73
  v_cvt_pk_bf16_f32 v74, 0, v74
  v_cvt_pk_bf16_f32 v75, 0, v75
  v_cvt_pk_bf16_f32 v76, 0, v76
  v_cvt_pk_bf16_f32 v77, 0, v77
  v_cvt_pk_bf16_f32 v78, 0, v78
  v_cvt_pk_bf16_f32 v79, 0, v79
  v_cvt_pk_bf16_f32 v80, 0, v80
  v_cvt_pk_bf16_f32 v81, 0, v81
  v_cvt_pk_bf16_f32 v82, 0, v82
  v_cvt_pk_bf16_f32 v83, 0, v83
  v_cvt_pk_bf16_f32 v84, 0, v84
  v_cvt_pk_bf16_f32 v85, 0, v85
  v_cvt_pk_bf16_f32 v86, 0, v86
  v_cvt_pk_bf16_f32 v87, 0, v87
  v_add_f32 v104, v104, v72
  v_add_f32 v105, v105, v73
  v_add_f32 v106, v106, v74
  v_add_f32 v107, v107, v75
  v_add_f32 v108, v108, v76
  v_add_f32 v109, v109, v77
  v_add_f32 v110, v110, v78
  v_add_f32 v111, v111, v79
  v_add_f32 v112, v112, v80
  v_add_f32 v113, v113, v81
  v_add_f32 v114, v114, v82
  v_add_f32 v115, v115, v83
  v_add_f32 v116, v116, v84
  v_add_f32 v117, v117, v85
  v_add_f32 v118, v118, v86
  v_add_f32 v119, v119, v87
  v_cvt_pk_bf16_f32 v104, 0, v104
  v_cvt_pk_bf16_f32 v105, 0, v105
  v_cvt_pk_bf16_f32 v106, 0, v106
  v_cvt_pk_bf16_f32 v107, 0, v107
  v_cvt_pk_bf16_f32 v108, 0, v108
  v_cvt_pk_bf16_f32 v109, 0, v109
  v_cvt_pk_bf16_f32 v110, 0, v110
  v_cvt_pk_bf16_f32 v111, 0, v111
  v_cvt_pk_bf16_f32 v112, 0, v112
  v_cvt_pk_bf16_f32 v113, 0, v113
  v_cvt_pk_bf16_f32 v114, 0, v114
  v_cvt_pk_bf16_f32 v115, 0, v115
  v_cvt_pk_bf16_f32 v116, 0, v116
  v_cvt_pk_bf16_f32 v117, 0, v117
  v_cvt_pk_bf16_f32 v118, 0, v118
  v_cvt_pk_bf16_f32 v119, 0, v119
  v_add_f32 v8, v104, v105
  v_add_f32 v8, v8, v106
  v_add_f32 v8, v8, v107
  v_add_f32 v8, v8, v108
  v_add_f32 v8, v8, v109
  v_add_f32 v8, v8, v110
  v_add_f32 v8, v8, v111
  s_nop 1
  v_add_f32_dpp v8, v8, v8 row_ror:8 row_mask:0xf bank_mask:0xf
  s_nop 1
  v_add_f32_dpp v8, v8, v8 row_ror:4 row_mask:0xf bank_mask:0xf
  s_nop 1
  v_add_f32_dpp v8, v8, v8 row_ror:2 row_mask:0xf bank_mask:0xf
  s_nop 1
  v_add_f32_dpp v8, v8, v8 row_ror:1 row_mask:0xf bank_mask:0xf
  v_mov_b32 v9, v8
  s_nop 1
  v_permlane16_swap_b32 v9, v8
  v_add_f32 v8, v8, v9
  v_mov_b32 v9, v8
  s_nop 1
  v_permlane32_swap_b32 v9, v8
  v_add_f32 v8, v8, v9
  v_mul_f32 v8, 0x3b000000, v8
  v_sub_f32 v72, v104, v8
  v_sub_f32 v73, v105, v8
  v_sub_f32 v74, v106, v8
  v_sub_f32 v75, v107, v8
  v_sub_f32 v76, v108, v8
  v_sub_f32 v77, v109, v8
  v_sub_f32 v78, v110, v8
  v_sub_f32 v79, v111, v8
  v_mul_f32 v10, v72, v72
  v_fmac_f32 v10, v73, v73
  v_fmac_f32 v10, v74, v74
  v_fmac_f32 v10, v75, v75
  v_fmac_f32 v10, v76, v76
  v_fmac_f32 v10, v77, v77
  v_fmac_f32 v10, v78, v78
  v_fmac_f32 v10, v79, v79
  s_nop 1
  v_add_f32_dpp v10, v10, v10 row_ror:8 row_mask:0xf bank_mask:0xf
  s_nop 1
  v_add_f32_dpp v10, v10, v10 row_ror:4 row_mask:0xf bank_mask:0xf
  s_nop 1
  v_add_f32_dpp v10, v10, v10 row_ror:2 row_mask:0xf bank_mask:0xf
  s_nop 1
  v_add_f32_dpp v10, v10, v10 row_ror:1 row_mask:0xf bank_mask:0xf
  v_mov_b32 v9, v10
  s_nop 1
  v_permlane16_swap_b32 v9, v10
  v_add_f32 v10, v10, v9
  v_mov_b32 v9, v10
  s_nop 1
  v_permlane32_swap_b32 v9, v10
  v_add_f32 v10, v10, v9
  v_mul_f32 v10, 0x3b000000, v10
  v_cvt_pk_bf16_f32 v8, 0, v8
  v_cvt_pk_bf16_f32 v10, 0, v10
  v_add_f32 v10, 0x3727c5ac, v10
  v_cvt_pk_bf16_f32 v10, 0, v10
  v_sqrt_f32 v10, v10
  v_sub_f32 v72, v104, v8
  v_sub_f32 v73, v105, v8
  v_sub_f32 v74, v106, v8
  v_sub_f32 v75, v107, v8
  v_sub_f32 v76, v108, v8
  v_sub_f32 v77, v109, v8
  v_sub_f32 v78, v110, v8
  v_sub_f32 v79, v111, v8
  v_cvt_pk_bf16_f32 v10, 0, v10
  v_cvt_pk_bf16_f32 v72, 0, v72
  v_cvt_pk_bf16_f32 v73, 0, v73
  v_cvt_pk_bf16_f32 v74, 0, v74
  v_cvt_pk_bf16_f32 v75, 0, v75
  v_cvt_pk_bf16_f32 v76, 0, v76
  v_cvt_pk_bf16_f32 v77, 0, v77
  v_cvt_pk_bf16_f32 v78, 0, v78
  v_cvt_pk_bf16_f32 v79, 0, v79
  v_rcp_f32 v10, v10
  s_nop 0
  v_mul_f32 v72, v72, v10
  v_mul_f32 v73, v73, v10
  v_mul_f32 v74, v74, v10
  v_mul_f32 v75, v75, v10
  v_mul_f32 v76, v76, v10
  v_mul_f32 v77, v77, v10
  v_mul_f32 v78, v78, v10
  v_mul_f32 v79, v79, v10
  v_cvt_pk_bf16_f32 v72, 0, v72
  v_cvt_pk_bf16_f32 v73, 0, v73
  v_cvt_pk_bf16_f32 v74, 0, v74
  v_cvt_pk_bf16_f32 v75, 0, v75
  v_cvt_pk_bf16_f32 v76, 0, v76
  v_cvt_pk_bf16_f32 v77, 0, v77
  v_cvt_pk_bf16_f32 v78, 0, v78
  v_cvt_pk_bf16_f32 v79, 0, v79
  v_add_f32 v8, v112, v113
  v_add_f32 v8, v8, v114
  v_add_f32 v8, v8, v115
  v_add_f32 v8, v8, v116
  v_add_f32 v8, v8, v117
  v_add_f32 v8, v8, v118
  v_add_f32 v8, v8, v119
  s_nop 1
  v_add_f32_dpp v8, v8, v8 row_ror:8 row_mask:0xf bank_mask:0xf
  s_nop 1
  v_add_f32_dpp v8, v8, v8 row_ror:4 row_mask:0xf bank_mask:0xf
  s_nop 1
  v_add_f32_dpp v8, v8, v8 row_ror:2 row_mask:0xf bank_mask:0xf
  s_nop 1
  v_add_f32_dpp v8, v8, v8 row_ror:1 row_mask:0xf bank_mask:0xf
  v_mov_b32 v9, v8
  s_nop 1
  v_permlane16_swap_b32 v9, v8
  v_add_f32 v8, v8, v9
  v_mov_b32 v9, v8
  s_nop 1
  v_permlane32_swap_b32 v9, v8
  v_add_f32 v8, v8, v9
  v_mul_f32 v8, 0x3b000000, v8
  v_sub_f32 v80, v112, v8
  v_sub_f32 v81, v113, v8
  v_sub_f32 v82, v114, v8
  v_sub_f32 v83, v115, v8
  v_sub_f32 v84, v116, v8
  v_sub_f32 v85, v117, v8
  v_sub_f32 v86, v118, v8
  v_sub_f32 v87, v119, v8
  v_mul_f32 v10, v80, v80
  v_fmac_f32 v10, v81, v81
  v_fmac_f32 v10, v82, v82
  v_fmac_f32 v10, v83, v83
  v_fmac_f32 v10, v84, v84
  v_fmac_f32 v10, v85, v85
  v_fmac_f32 v10, v86, v86
  v_fmac_f32 v10, v87, v87
  s_nop 1
  v_add_f32_dpp v10, v10, v10 row_ror:8 row_mask:0xf bank_mask:0xf
  s_nop 1
  v_add_f32_dpp v10, v10, v10 row_ror:4 row_mask:0xf bank_mask:0xf
  s_nop 1
  v_add_f32_dpp v10, v10, v10 row_ror:2 row_mask:0xf bank_mask:0xf
  s_nop 1
  v_add_f32_dpp v10, v10, v10 row_ror:1 row_mask:0xf bank_mask:0xf
  v_mov_b32 v9, v10
  s_nop 1
  v_permlane16_swap_b32 v9, v10
  v_add_f32 v10, v10, v9
  v_mov_b32 v9, v10
  s_nop 1
  v_permlane32_swap_b32 v9, v10
  v_add_f32 v10, v10, v9
  v_mul_f32 v10, 0x3b000000, v10
  v_cvt_pk_bf16_f32 v8, 0, v8
  v_cvt_pk_bf16_f32 v10, 0, v10
  v_add_f32 v10, 0x3727c5ac, v10
  v_cvt_pk_bf16_f32 v10, 0, v10
  v_sqrt_f32 v10, v10
  v_sub_f32 v80, v112, v8
  v_sub_f32 v81, v113, v8
  v_sub_f32 v82, v114, v8
  v_sub_f32 v83, v115, v8
  v_sub_f32 v84, v116, v8
  v_sub_f32 v85, v117, v8
  v_sub_f32 v86, v118, v8
  v_sub_f32 v87, v119, v8
  v_cvt_pk_bf16_f32 v10, 0, v10
  v_cvt_pk_bf16_f32 v80, 0, v80
  v_cvt_pk_bf16_f32 v81, 0, v81
  v_cvt_pk_bf16_f32 v82, 0, v82
  v_cvt_pk_bf16_f32 v83, 0, v83
  v_cvt_pk_bf16_f32 v84, 0, v84
  v_cvt_pk_bf16_f32 v85, 0, v85
  v_cvt_pk_bf16_f32 v86, 0, v86
  v_cvt_pk_bf16_f32 v87, 0, v87
  v_rcp_f32 v10, v10
  s_nop 0
  v_mul_f32 v80, v80, v10
  v_mul_f32 v81, v81, v10
  v_mul_f32 v82, v82, v10
  v_mul_f32 v83, v83, v10
  v_mul_f32 v84, v84, v10
  v_mul_f32 v85, v85, v10
  v_mul_f32 v86, v86, v10
  v_mul_f32 v87, v87, v10
  v_cvt_pk_bf16_f32 v80, 0, v80
  v_cvt_pk_bf16_f32 v81, 0, v81
  v_cvt_pk_bf16_f32 v82, 0, v82
  v_cvt_pk_bf16_f32 v83, 0, v83
  v_cvt_pk_bf16_f32 v84, 0, v84
  v_cvt_pk_bf16_f32 v85, 0, v85
  v_cvt_pk_bf16_f32 v86, 0, v86
  v_cvt_pk_bf16_f32 v87, 0, v87
  v_lshrrev_b32 v2, 1, v1
  v_lshlrev_b32 v2, 7, v2
  v_and_b32 v3, 1, v1
  v_lshl_add_u32 v2, v3, 5, v2
  v_add_u32 v2, 20480, v2
  global_load_dwordx4 v[40:43], v2, s[42:43] offset:0 sc1
  global_load_dwordx4 v[44:47], v2, s[42:43] offset:16 sc1
  global_load_dwordx4 v[48:51], v2, s[42:43] offset:64 sc1
  global_load_dwordx4 v[52:55], v2, s[42:43] offset:80 sc1
  s_waitcnt vmcnt(0)
  v_lshlrev_b32 v88, 16, v40
  v_and_b32 v89, s73, v40
  v_lshlrev_b32 v90, 16, v42
  v_and_b32 v91, s73, v42
  v_lshlrev_b32 v92, 16, v44
  v_and_b32 v93, s73, v44
  v_lshlrev_b32 v94, 16, v46
  v_and_b32 v95, s73, v46
  v_lshlrev_b32 v96, 16, v48
  v_and_b32 v97, s73, v48
  v_lshlrev_b32 v98, 16, v50
  v_and_b32 v99, s73, v50
  v_lshlrev_b32 v100, 16, v52
  v_and_b32 v101, s73, v52
  v_lshlrev_b32 v102, 16, v54
  v_and_b32 v103, s73, v54
  v_add_f32 v88, 1.0, v88
  v_add_f32 v89, 1.0, v89
  v_add_f32 v90, 1.0, v90
  v_add_f32 v91, 1.0, v91
  v_add_f32 v92, 1.0, v92
  v_add_f32 v93, 1.0, v93
  v_add_f32 v94, 1.0, v94
  v_add_f32 v95, 1.0, v95
  v_add_f32 v96, 1.0, v96
  v_add_f32 v97, 1.0, v97
  v_add_f32 v98, 1.0, v98
  v_add_f32 v99, 1.0, v99
  v_add_f32 v100, 1.0, v100
  v_add_f32 v101, 1.0, v101
  v_add_f32 v102, 1.0, v102
  v_add_f32 v103, 1.0, v103
  v_cvt_pk_bf16_f32 v88, 0, v88
  v_cvt_pk_bf16_f32 v89, 0, v89
  v_cvt_pk_bf16_f32 v90, 0, v90
  v_cvt_pk_bf16_f32 v91, 0, v91
  v_cvt_pk_bf16_f32 v92, 0, v92
  v_cvt_pk_bf16_f32 v93, 0, v93
  v_cvt_pk_bf16_f32 v94, 0, v94
  v_cvt_pk_bf16_f32 v95, 0, v95
  v_cvt_pk_bf16_f32 v96, 0, v96
  v_cvt_pk_bf16_f32 v97, 0, v97
  v_cvt_pk_bf16_f32 v98, 0, v98
  v_cvt_pk_bf16_f32 v99, 0, v99
  v_cvt_pk_bf16_f32 v100, 0, v100
  v_cvt_pk_bf16_f32 v101, 0, v101
  v_cvt_pk_bf16_f32 v102, 0, v102
  v_cvt_pk_bf16_f32 v103, 0, v103
  v_mul_f32 v72, v72, v88
  v_mul_f32 v73, v73, v89
  v_mul_f32 v74, v74, v90
  v_mul_f32 v75, v75, v91
  v_mul_f32 v76, v76, v92
  v_mul_f32 v77, v77, v93
  v_mul_f32 v78, v78, v94
  v_mul_f32 v79, v79, v95
  v_mul_f32 v80, v80, v96
  v_mul_f32 v81, v81, v97
  v_mul_f32 v82, v82, v98
  v_mul_f32 v83, v83, v99
  v_mul_f32 v84, v84, v100
  v_mul_f32 v85, v85, v101
  v_mul_f32 v86, v86, v102
  v_mul_f32 v87, v87, v103
  v_cvt_pk_bf16_f32 v72, 0, v72
  v_cvt_pk_bf16_f32 v73, 0, v73
  v_cvt_pk_bf16_f32 v74, 0, v74
  v_cvt_pk_bf16_f32 v75, 0, v75
  v_cvt_pk_bf16_f32 v76, 0, v76
  v_cvt_pk_bf16_f32 v77, 0, v77
  v_cvt_pk_bf16_f32 v78, 0, v78
  v_cvt_pk_bf16_f32 v79, 0, v79
  v_cvt_pk_bf16_f32 v80, 0, v80
  v_cvt_pk_bf16_f32 v81, 0, v81
  v_cvt_pk_bf16_f32 v82, 0, v82
  v_cvt_pk_bf16_f32 v83, 0, v83
  v_cvt_pk_bf16_f32 v84, 0, v84
  v_cvt_pk_bf16_f32 v85, 0, v85
  v_cvt_pk_bf16_f32 v86, 0, v86
  v_cvt_pk_bf16_f32 v87, 0, v87
  v_lshrrev_b32 v2, 1, v1
  v_lshlrev_b32 v2, 7, v2
  v_and_b32 v3, 1, v1
  v_lshl_add_u32 v2, v3, 5, v2
  v_add_u32 v2, 16384, v2
  global_load_dwordx4 v[40:43], v2, s[42:43] offset:0 sc1
  global_load_dwordx4 v[44:47], v2, s[42:43] offset:16 sc1
  global_load_dwordx4 v[48:51], v2, s[42:43] offset:64 sc1
  global_load_dwordx4 v[52:55], v2, s[42:43] offset:80 sc1
  s_waitcnt vmcnt(0)
  v_lshlrev_b32 v88, 16, v40
  v_and_b32 v89, s73, v40
  v_lshlrev_b32 v90, 16, v42
  v_and_b32 v91, s73, v42
  v_lshlrev_b32 v92, 16, v44
  v_and_b32 v93, s73, v44
  v_lshlrev_b32 v94, 16, v46
  v_and_b32 v95, s73, v46
  v_lshlrev_b32 v96, 16, v48
  v_and_b32 v97, s73, v48
  v_lshlrev_b32 v98, 16, v50
  v_and_b32 v99, s73, v50
  v_lshlrev_b32 v100, 16, v52
  v_and_b32 v101, s73, v52
  v_lshlrev_b32 v102, 16, v54
  v_and_b32 v103, s73, v54
  v_add_f32 v72, v72, v88
  v_add_f32 v73, v73, v89
  v_add_f32 v74, v74, v90
  v_add_f32 v75, v75, v91
  v_add_f32 v76, v76, v92
  v_add_f32 v77, v77, v93
  v_add_f32 v78, v78, v94
  v_add_f32 v79, v79, v95
  v_add_f32 v80, v80, v96
  v_add_f32 v81, v81, v97
  v_add_f32 v82, v82, v98
  v_add_f32 v83, v83, v99
  v_add_f32 v84, v84, v100
  v_add_f32 v85, v85, v101
  v_add_f32 v86, v86, v102
  v_add_f32 v87, v87, v103
  v_cvt_pk_bf16_f32 v40, v72, v73
  v_cvt_pk_bf16_f32 v41, v74, v75
  v_cvt_pk_bf16_f32 v42, v76, v77
  v_cvt_pk_bf16_f32 v43, v78, v79
  v_cvt_pk_bf16_f32 v44, v80, v81
  v_cvt_pk_bf16_f32 v45, v82, v83
  v_cvt_pk_bf16_f32 v46, v84, v85
  v_cvt_pk_bf16_f32 v47, v86, v87
  v_add_u32 v3, 83968, v0
  ds_write_b128 v3, v[40:43] offset:0
  ds_write_b128 v3, v[44:47] offset:1024
  s_mov_b32 s44, s28
  s_mov_b32 s45, s29
  s_mov_b32 s46, 1409024
  s_mov_b32 s11, 2752
  s_mov_b32 s12, 1409024
  v_mov_b32 v4, 83968
  v_mov_b32 v5, 84992
  v_lshlrev_b32 v2, 4, v1
  s_call_b64 s[62:63], L_gv
  v_cvt_pk_bf16_f32 v120, 0, v72
  v_cvt_pk_bf16_f32 v121, 0, v73
  v_cvt_pk_bf16_f32 v122, 0, v74
  v_cvt_pk_bf16_f32 v123, 0, v75
  v_cvt_pk_bf16_f32 v124, 0, v76
  v_cvt_pk_bf16_f32 v125, 0, v77
  v_cvt_pk_bf16_f32 v126, 0, v78
  v_cvt_pk_bf16_f32 v127, 0, v79
  v_cvt_pk_bf16_f32 v128, 0, v80
  v_cvt_pk_bf16_f32 v129, 0, v81
  v_cvt_pk_bf16_f32 v130, 0, v82
  v_cvt_pk_bf16_f32 v131, 0, v83
  v_cvt_pk_bf16_f32 v132, 0, v84
  v_cvt_pk_bf16_f32 v133, 0, v85
  v_cvt_pk_bf16_f32 v134, 0, v86
  v_cvt_pk_bf16_f32 v135, 0, v87
  s_mov_b32 s44, s30
  s_mov_b32 s45, s31
  s_mov_b32 s46, 1409024
  s_mov_b32 s11, 2752
  s_mov_b32 s12, 1409024
  v_mov_b32 v4, 83968
  v_mov_b32 v5, 84992
  v_lshlrev_b32 v2, 4, v1
  s_call_b64 s[62:63], L_gv
  v_mul_f32 v88, 0xbfb8aa3b, v120
  v_mul_f32 v89, 0xbfb8aa3b, v121
  v_mul_f32 v90, 0xbfb8aa3b, v122
  v_mul_f32 v91, 0xbfb8aa3b, v123
  v_exp_f32 v88, v88
  v_exp_f32 v89, v89
  v_exp_f32 v90, v90
  v_exp_f32 v91, v91
  s_nop 0
  v_add_f32 v88, 1.0, v88
  v_add_f32 v89, 1.0, v89
  v_add_f32 v90, 1.0, v90
  v_add_f32 v91, 1.0, v91
  v_rcp_f32 v88, v88
  v_rcp_f32 v89, v89
  v_rcp_f32 v90, v90
  v_rcp_f32 v91, v91
  s_nop 0
  v_mul_f32 v120, v120, v88
  v_mul_f32 v121, v121, v89
  v_mul_f32 v122, v122, v90
  v_mul_f32 v123, v123, v91
  v_mul_f32 v88, 0xbfb8aa3b, v124
  v_mul_f32 v89, 0xbfb8aa3b, v125
  v_mul_f32 v90, 0xbfb8aa3b, v126
  v_mul_f32 v91, 0xbfb8aa3b, v127
  v_exp_f32 v88, v88
  v_exp_f32 v89, v89
  v_exp_f32 v90, v90
  v_exp_f32 v91, v91
  s_nop 0
  v_add_f32 v88, 1.0, v88
  v_add_f32 v89, 1.0, v89
  v_add_f32 v90, 1.0, v90
  v_add_f32 v91, 1.0, v91
  v_rcp_f32 v88, v88
  v_rcp_f32 v89, v89
  v_rcp_f32 v90, v90
  v_rcp_f32 v91, v91
  s_nop 0
  v_mul_f32 v124, v124, v88
  v_mul_f32 v125, v125, v89
  v_mul_f32 v126, v126, v90
  v_mul_f32 v127, v127, v91
  v_mul_f32 v88, 0xbfb8aa3b, v128
  v_mul_f32 v89, 0xbfb8aa3b, v129
  v_mul_f32 v90, 0xbfb8aa3b, v130
  v_mul_f32 v91, 0xbfb8aa3b, v131
  v_exp_f32 v88, v88
  v_exp_f32 v89, v89
  v_exp_f32 v90, v90
  v_exp_f32 v91, v91
  s_nop 0
  v_add_f32 v88, 1.0, v88
  v_add_f32 v89, 1.0, v89
  v_add_f32 v90, 1.0, v90
  v_add_f32 v91, 1.0, v91
  v_rcp_f32 v88, v88
  v_rcp_f32 v89, v89
  v_rcp_f32 v90, v90
  v_rcp_f32 v91, v91
  s_nop 0
  v_mul_f32 v128, v128, v88
  v_mul_f32 v129, v129, v89
  v_mul_f32 v130, v130, v90
  v_mul_f32 v131, v131, v91
  v_mul_f32 v88, 0xbfb8aa3b, v132
  v_mul_f32 v89, 0xbfb8aa3b, v133
  v_mul_f32 v90, 0xbfb8aa3b, v134
  v_mul_f32 v91, 0xbfb8aa3b, v135
  v_exp_f32 v88, v88
  v_exp_f32 v89, v89
  v_exp_f32 v90, v90
  v_exp_f32 v91, v91
  s_nop 0
  v_add_f32 v88, 1.0, v88
  v_add_f32 v89, 1.0, v89
  v_add_f32 v90, 1.0, v90
  v_add_f32 v91, 1.0, v91
  v_rcp_f32 v88, v88
  v_rcp_f32 v89, v89
  v_rcp_f32 v90, v90
  v_rcp_f32 v91, v91
  s_nop 0
  v_mul_f32 v132, v132, v88
  v_mul_f32 v133, v133, v89
  v_mul_f32 v134, v134, v90
  v_mul_f32 v135, v135, v91
  v_cvt_pk_bf16_f32 v120, 0, v120
  v_cvt_pk_bf16_f32 v121, 0, v121
  v_cvt_pk_bf16_f32 v122, 0, v122
  v_cvt_pk_bf16_f32 v123, 0, v123
  v_cvt_pk_bf16_f32 v124, 0, v124
  v_cvt_pk_bf16_f32 v125, 0, v125
  v_cvt_pk_bf16_f32 v126, 0, v126
  v_cvt_pk_bf16_f32 v127, 0, v127
  v_cvt_pk_bf16_f32 v128, 0, v128
  v_cvt_pk_bf16_f32 v129, 0, v129
  v_cvt_pk_bf16_f32 v130, 0, v130
  v_cvt_pk_bf16_f32 v131, 0, v131
  v_cvt_pk_bf16_f32 v132, 0, v132
  v_cvt_pk_bf16_f32 v133, 0, v133
  v_cvt_pk_bf16_f32 v134, 0, v134
  v_cvt_pk_bf16_f32 v135, 0, v135
  v_cvt_pk_bf16_f32 v72, 0, v72
  v_cvt_pk_bf16_f32 v73, 0, v73
  v_cvt_pk_bf16_f32 v74, 0, v74
  v_cvt_pk_bf16_f32 v75, 0, v75
  v_cvt_pk_bf16_f32 v76, 0, v76
  v_cvt_pk_bf16_f32 v77, 0, v77
  v_cvt_pk_bf16_f32 v78, 0, v78
  v_cvt_pk_bf16_f32 v79, 0, v79
  v_cvt_pk_bf16_f32 v80, 0, v80
  v_cvt_pk_bf16_f32 v81, 0, v81
  v_cvt_pk_bf16_f32 v82, 0, v82
  v_cvt_pk_bf16_f32 v83, 0, v83
  v_cvt_pk_bf16_f32 v84, 0, v84
  v_cvt_pk_bf16_f32 v85, 0, v85
  v_cvt_pk_bf16_f32 v86, 0, v86
  v_cvt_pk_bf16_f32 v87, 0, v87
  v_mul_f32 v72, v72, v120
  v_mul_f32 v73, v73, v121
  v_mul_f32 v74, v74, v122
  v_mul_f32 v75, v75, v123
  v_mul_f32 v76, v76, v124
  v_mul_f32 v77, v77, v125
  v_mul_f32 v78, v78, v126
  v_mul_f32 v79, v79, v127
  v_mul_f32 v80, v80, v128
  v_mul_f32 v81, v81, v129
  v_mul_f32 v82, v82, v130
  v_mul_f32 v83, v83, v131
  v_mul_f32 v84, v84, v132
  v_mul_f32 v85, v85, v133
  v_mul_f32 v86, v86, v134
  v_mul_f32 v87, v87, v135
  v_cvt_pk_bf16_f32 v40, v72, v73
  v_cvt_pk_bf16_f32 v41, v74, v75
  v_cvt_pk_bf16_f32 v42, v76, v77
  v_cvt_pk_bf16_f32 v43, v78, v79
  v_cvt_pk_bf16_f32 v44, v80, v81
  v_cvt_pk_bf16_f32 v45, v82, v83
  v_cvt_pk_bf16_f32 v46, v84, v85
  v_cvt_pk_bf16_f32 v47, v86, v87
  v_add_u32 v3, 86016, v0
  ds_write_b128 v3, v[40:43] offset:0
  ds_write_b128 v3, v[44:47] offset:3072
  s_mov_b32 s44, s28
  s_mov_b32 s45, s29
  s_mov_b32 s46, 1409024
  s_mov_b32 s11, 2752
  s_mov_b32 s12, 1409024
  v_mov_b32 v4, 83968
  v_mov_b32 v5, 84992
  v_lshlrev_b32 v2, 4, v1
  v_add_u32 v2, 1024, v2
  s_call_b64 s[62:63], L_gv
  v_cvt_pk_bf16_f32 v120, 0, v72
  v_cvt_pk_bf16_f32 v121, 0, v73
  v_cvt_pk_bf16_f32 v122, 0, v74
  v_cvt_pk_bf16_f32 v123, 0, v75
  v_cvt_pk_bf16_f32 v124, 0, v76
  v_cvt_pk_bf16_f32 v125, 0, v77
  v_cvt_pk_bf16_f32 v126, 0, v78
  v_cvt_pk_bf16_f32 v127, 0, v79
  v_cvt_pk_bf16_f32 v128, 0, v80
  v_cvt_pk_bf16_f32 v129, 0, v81
  v_cvt_pk_bf16_f32 v130, 0, v82
  v_cvt_pk_bf16_f32 v131, 0, v83
  v_cvt_pk_bf16_f32 v132, 0, v84
  v_cvt_pk_bf16_f32 v133, 0, v85
  v_cvt_pk_bf16_f32 v134, 0, v86
  v_cvt_pk_bf16_f32 v135, 0, v87
  s_mov_b32 s44, s30
  s_mov_b32 s45, s31
  s_mov_b32 s46, 1409024
  s_mov_b32 s11, 2752
  s_mov_b32 s12, 1409024
  v_mov_b32 v4, 83968
  v_mov_b32 v5, 84992
  v_lshlrev_b32 v2, 4, v1
  v_add_u32 v2, 1024, v2
  s_call_b64 s[62:63], L_gv
  v_mul_f32 v88, 0xbfb8aa3b, v120
  v_mul_f32 v89, 0xbfb8aa3b, v121
  v_mul_f32 v90, 0xbfb8aa3b, v122
  v_mul_f32 v91, 0xbfb8aa3b, v123
  v_exp_f32 v88, v88
  v_exp_f32 v89, v89
  v_exp_f32 v90, v90
  v_exp_f32 v91, v91
  s_nop 0
  v_add_f32 v88, 1.0, v88
  v_add_f32 v89, 1.0, v89
  v_add_f32 v90, 1.0, v90
  v_add_f32 v91, 1.0, v91
  v_rcp_f32 v88, v88
  v_rcp_f32 v89, v89
  v_rcp_f32 v90, v90
  v_rcp_f32 v91, v91
  s_nop 0
  v_mul_f32 v120, v120, v88
  v_mul_f32 v121, v121, v89
  v_mul_f32 v122, v122, v90
  v_mul_f32 v123, v123, v91
  v_mul_f32 v88, 0xbfb8aa3b, v124
  v_mul_f32 v89, 0xbfb8aa3b, v125
  v_mul_f32 v90, 0xbfb8aa3b, v126
  v_mul_f32 v91, 0xbfb8aa3b, v127
  v_exp_f32 v88, v88
  v_exp_f32 v89, v89
  v_exp_f32 v90, v90
  v_exp_f32 v91, v91
  s_nop 0
  v_add_f32 v88, 1.0, v88
  v_add_f32 v89, 1.0, v89
  v_add_f32 v90, 1.0, v90
  v_add_f32 v91, 1.0, v91
  v_rcp_f32 v88, v88
  v_rcp_f32 v89, v89
  v_rcp_f32 v90, v90
  v_rcp_f32 v91, v91
  s_nop 0
  v_mul_f32 v124, v124, v88
  v_mul_f32 v125, v125, v89
  v_mul_f32 v126, v126, v90
  v_mul_f32 v127, v127, v91
  v_mul_f32 v88, 0xbfb8aa3b, v128
  v_mul_f32 v89, 0xbfb8aa3b, v129
  v_mul_f32 v90, 0xbfb8aa3b, v130
  v_mul_f32 v91, 0xbfb8aa3b, v131
  v_exp_f32 v88, v88
  v_exp_f32 v89, v89
  v_exp_f32 v90, v90
  v_exp_f32 v91, v91
  s_nop 0
  v_add_f32 v88, 1.0, v88
  v_add_f32 v89, 1.0, v89
  v_add_f32 v90, 1.0, v90
  v_add_f32 v91, 1.0, v91
  v_rcp_f32 v88, v88
  v_rcp_f32 v89, v89
  v_rcp_f32 v90, v90
  v_rcp_f32 v91, v91
  s_nop 0
  v_mul_f32 v128, v128, v88
  v_mul_f32 v129, v129, v89
  v_mul_f32 v130, v130, v90
  v_mul_f32 v131, v131, v91
  v_mul_f32 v88, 0xbfb8aa3b, v132
  v_mul_f32 v89, 0xbfb8aa3b, v133
  v_mul_f32 v90, 0xbfb8aa3b, v134
  v_mul_f32 v91, 0xbfb8aa3b, v135
  v_exp_f32 v88, v88
  v_exp_f32 v89, v89
  v_exp_f32 v90, v90
  v_exp_f32 v91, v91
  s_nop 0
  v_add_f32 v88, 1.0, v88
  v_add_f32 v89, 1.0, v89
  v_add_f32 v90, 1.0, v90
  v_add_f32 v91, 1.0, v91
  v_rcp_f32 v88, v88
  v_rcp_f32 v89, v89
  v_rcp_f32 v90, v90
  v_rcp_f32 v91, v91
  s_nop 0
  v_mul_f32 v132, v132, v88
  v_mul_f32 v133, v133, v89
  v_mul_f32 v134, v134, v90
  v_mul_f32 v135, v135, v91
  v_cvt_pk_bf16_f32 v120, 0, v120
  v_cvt_pk_bf16_f32 v121, 0, v121
  v_cvt_pk_bf16_f32 v122, 0, v122
  v_cvt_pk_bf16_f32 v123, 0, v123
  v_cvt_pk_bf16_f32 v124, 0, v124
  v_cvt_pk_bf16_f32 v125, 0, v125
  v_cvt_pk_bf16_f32 v126, 0, v126
  v_cvt_pk_bf16_f32 v127, 0, v127
  v_cvt_pk_bf16_f32 v128, 0, v128
  v_cvt_pk_bf16_f32 v129, 0, v129
  v_cvt_pk_bf16_f32 v130, 0, v130
  v_cvt_pk_bf16_f32 v131, 0, v131
  v_cvt_pk_bf16_f32 v132, 0, v132
  v_cvt_pk_bf16_f32 v133, 0, v133
  v_cvt_pk_bf16_f32 v134, 0, v134
  v_cvt_pk_bf16_f32 v135, 0, v135
  v_cvt_pk_bf16_f32 v72, 0, v72
  v_cvt_pk_bf16_f32 v73, 0, v73
  v_cvt_pk_bf16_f32 v74, 0, v74
  v_cvt_pk_bf16_f32 v75, 0, v75
  v_cvt_pk_bf16_f32 v76, 0, v76
  v_cvt_pk_bf16_f32 v77, 0, v77
  v_cvt_pk_bf16_f32 v78, 0, v78
  v_cvt_pk_bf16_f32 v79, 0, v79
  v_cvt_pk_bf16_f32 v80, 0, v80
  v_cvt_pk_bf16_f32 v81, 0, v81
  v_cvt_pk_bf16_f32 v82, 0, v82
  v_cvt_pk_bf16_f32 v83, 0, v83
  v_cvt_pk_bf16_f32 v84, 0, v84
  v_cvt_pk_bf16_f32 v85, 0, v85
  v_cvt_pk_bf16_f32 v86, 0, v86
  v_cvt_pk_bf16_f32 v87, 0, v87
  v_mul_f32 v72, v72, v120
  v_mul_f32 v73, v73, v121
  v_mul_f32 v74, v74, v122
  v_mul_f32 v75, v75, v123
  v_mul_f32 v76, v76, v124
  v_mul_f32 v77, v77, v125
  v_mul_f32 v78, v78, v126
  v_mul_f32 v79, v79, v127
  v_mul_f32 v80, v80, v128
  v_mul_f32 v81, v81, v129
  v_mul_f32 v82, v82, v130
  v_mul_f32 v83, v83, v131
  v_mul_f32 v84, v84, v132
  v_mul_f32 v85, v85, v133
  v_mul_f32 v86, v86, v134
  v_mul_f32 v87, v87, v135
  v_cvt_pk_bf16_f32 v40, v72, v73
  v_cvt_pk_bf16_f32 v41, v74, v75
  v_cvt_pk_bf16_f32 v42, v76, v77
  v_cvt_pk_bf16_f32 v43, v78, v79
  v_cvt_pk_bf16_f32 v44, v80, v81
  v_cvt_pk_bf16_f32 v45, v82, v83
  v_cvt_pk_bf16_f32 v46, v84, v85
  v_cvt_pk_bf16_f32 v47, v86, v87
  v_add_u32 v3, 87040, v0
  ds_write_b128 v3, v[40:43] offset:0
  ds_write_b128 v3, v[44:47] offset:3072
  s_mov_b32 s44, s28
  s_mov_b32 s45, s29
  s_mov_b32 s46, 1409024
  s_mov_b32 s11, 2752
  s_mov_b32 s12, 1409024
  v_mov_b32 v4, 83968
  v_mov_b32 v5, 84992
  v_lshlrev_b32 v2, 4, v1
  v_add_u32 v2, 2048, v2
  s_call_b64 s[62:63], L_gv
  v_cvt_pk_bf16_f32 v120, 0, v72
  v_cvt_pk_bf16_f32 v121, 0, v73
  v_cvt_pk_bf16_f32 v122, 0, v74
  v_cvt_pk_bf16_f32 v123, 0, v75
  v_cvt_pk_bf16_f32 v124, 0, v76
  v_cvt_pk_bf16_f32 v125, 0, v77
  v_cvt_pk_bf16_f32 v126, 0, v78
  v_cvt_pk_bf16_f32 v127, 0, v79
  v_cvt_pk_bf16_f32 v128, 0, v80
  v_cvt_pk_bf16_f32 v129, 0, v81
  v_cvt_pk_bf16_f32 v130, 0, v82
  v_cvt_pk_bf16_f32 v131, 0, v83
  v_cvt_pk_bf16_f32 v132, 0, v84
  v_cvt_pk_bf16_f32 v133, 0, v85
  v_cvt_pk_bf16_f32 v134, 0, v86
  v_cvt_pk_bf16_f32 v135, 0, v87
  s_mov_b32 s44, s30
  s_mov_b32 s45, s31
  s_mov_b32 s46, 1409024
  s_mov_b32 s11, 2752
  s_mov_b32 s12, 1409024
  v_mov_b32 v4, 83968
  v_mov_b32 v5, 84992
  v_lshlrev_b32 v2, 4, v1
  v_add_u32 v2, 2048, v2
  s_call_b64 s[62:63], L_gv
  v_mul_f32 v88, 0xbfb8aa3b, v120
  v_mul_f32 v89, 0xbfb8aa3b, v121
  v_mul_f32 v90, 0xbfb8aa3b, v122
  v_mul_f32 v91, 0xbfb8aa3b, v123
  v_exp_f32 v88, v88
  v_exp_f32 v89, v89
  v_exp_f32 v90, v90
  v_exp_f32 v91, v91
  s_nop 0
  v_add_f32 v88, 1.0, v88
  v_add_f32 v89, 1.0, v89
  v_add_f32 v90, 1.0, v90
  v_add_f32 v91, 1.0, v91
  v_rcp_f32 v88, v88
  v_rcp_f32 v89, v89
  v_rcp_f32 v90, v90
  v_rcp_f32 v91, v91
  s_nop 0
  v_mul_f32 v120, v120, v88
  v_mul_f32 v121, v121, v89
  v_mul_f32 v122, v122, v90
  v_mul_f32 v123, v123, v91
  v_mul_f32 v88, 0xbfb8aa3b, v124
  v_mul_f32 v89, 0xbfb8aa3b, v125
  v_mul_f32 v90, 0xbfb8aa3b, v126
  v_mul_f32 v91, 0xbfb8aa3b, v127
  v_exp_f32 v88, v88
  v_exp_f32 v89, v89
  v_exp_f32 v90, v90
  v_exp_f32 v91, v91
  s_nop 0
  v_add_f32 v88, 1.0, v88
  v_add_f32 v89, 1.0, v89
  v_add_f32 v90, 1.0, v90
  v_add_f32 v91, 1.0, v91
  v_rcp_f32 v88, v88
  v_rcp_f32 v89, v89
  v_rcp_f32 v90, v90
  v_rcp_f32 v91, v91
  s_nop 0
  v_mul_f32 v124, v124, v88
  v_mul_f32 v125, v125, v89
  v_mul_f32 v126, v126, v90
  v_mul_f32 v127, v127, v91
  v_mul_f32 v88, 0xbfb8aa3b, v128
  v_mul_f32 v89, 0xbfb8aa3b, v129
  v_mul_f32 v90, 0xbfb8aa3b, v130
  v_mul_f32 v91, 0xbfb8aa3b, v131
  v_exp_f32 v88, v88
  v_exp_f32 v89, v89
  v_exp_f32 v90, v90
  v_exp_f32 v91, v91
  s_nop 0
  v_add_f32 v88, 1.0, v88
  v_add_f32 v89, 1.0, v89
  v_add_f32 v90, 1.0, v90
  v_add_f32 v91, 1.0, v91
  v_rcp_f32 v88, v88
  v_rcp_f32 v89, v89
  v_rcp_f32 v90, v90
  v_rcp_f32 v91, v91
  s_nop 0
  v_mul_f32 v128, v128, v88
  v_mul_f32 v129, v129, v89
  v_mul_f32 v130, v130, v90
  v_mul_f32 v131, v131, v91
  v_mul_f32 v88, 0xbfb8aa3b, v132
  v_mul_f32 v89, 0xbfb8aa3b, v133
  v_mul_f32 v90, 0xbfb8aa3b, v134
  v_mul_f32 v91, 0xbfb8aa3b, v135
  v_exp_f32 v88, v88
  v_exp_f32 v89, v89
  v_exp_f32 v90, v90
  v_exp_f32 v91, v91
  s_nop 0
  v_add_f32 v88, 1.0, v88
  v_add_f32 v89, 1.0, v89
  v_add_f32 v90, 1.0, v90
  v_add_f32 v91, 1.0, v91
  v_rcp_f32 v88, v88
  v_rcp_f32 v89, v89
  v_rcp_f32 v90, v90
  v_rcp_f32 v91, v91
  s_nop 0
  v_mul_f32 v132, v132, v88
  v_mul_f32 v133, v133, v89
  v_mul_f32 v134, v134, v90
  v_mul_f32 v135, v135, v91
  v_cvt_pk_bf16_f32 v120, 0, v120
  v_cvt_pk_bf16_f32 v121, 0, v121
  v_cvt_pk_bf16_f32 v122, 0, v122
  v_cvt_pk_bf16_f32 v123, 0, v123
  v_cvt_pk_bf16_f32 v124, 0, v124
  v_cvt_pk_bf16_f32 v125, 0, v125
  v_cvt_pk_bf16_f32 v126, 0, v126
  v_cvt_pk_bf16_f32 v127, 0, v127
  v_cvt_pk_bf16_f32 v128, 0, v128
  v_cvt_pk_bf16_f32 v129, 0, v129
  v_cvt_pk_bf16_f32 v130, 0, v130
  v_cvt_pk_bf16_f32 v131, 0, v131
  v_cvt_pk_bf16_f32 v132, 0, v132
  v_cvt_pk_bf16_f32 v133, 0, v133
  v_cvt_pk_bf16_f32 v134, 0, v134
  v_cvt_pk_bf16_f32 v135, 0, v135
  v_cvt_pk_bf16_f32 v72, 0, v72
  v_cvt_pk_bf16_f32 v73, 0, v73
  v_cvt_pk_bf16_f32 v74, 0, v74
  v_cvt_pk_bf16_f32 v75, 0, v75
  v_cvt_pk_bf16_f32 v76, 0, v76
  v_cvt_pk_bf16_f32 v77, 0, v77
  v_cvt_pk_bf16_f32 v78, 0, v78
  v_cvt_pk_bf16_f32 v79, 0, v79
  v_cvt_pk_bf16_f32 v80, 0, v80
  v_cvt_pk_bf16_f32 v81, 0, v81
  v_cvt_pk_bf16_f32 v82, 0, v82
  v_cvt_pk_bf16_f32 v83, 0, v83
  v_cvt_pk_bf16_f32 v84, 0, v84
  v_cvt_pk_bf16_f32 v85, 0, v85
  v_cvt_pk_bf16_f32 v86, 0, v86
  v_cvt_pk_bf16_f32 v87, 0, v87
  v_mul_f32 v72, v72, v120
  v_mul_f32 v73, v73, v121
  v_mul_f32 v74, v74, v122
  v_mul_f32 v75, v75, v123
  v_mul_f32 v76, v76, v124
  v_mul_f32 v77, v77, v125
  v_mul_f32 v78, v78, v126
  v_mul_f32 v79, v79, v127
  v_mul_f32 v80, v80, v128
  v_mul_f32 v81, v81, v129
  v_mul_f32 v82, v82, v130
  v_mul_f32 v83, v83, v131
  v_mul_f32 v84, v84, v132
  v_mul_f32 v85, v85, v133
  v_mul_f32 v86, v86, v134
  v_mul_f32 v87, v87, v135
  v_cvt_pk_bf16_f32 v40, v72, v73
  v_cvt_pk_bf16_f32 v41, v74, v75
  v_cvt_pk_bf16_f32 v42, v76, v77
  v_cvt_pk_bf16_f32 v43, v78, v79
  v_cvt_pk_bf16_f32 v44, v80, v81
  v_cvt_pk_bf16_f32 v45, v82, v83
  v_cvt_pk_bf16_f32 v46, v84, v85
  v_cvt_pk_bf16_f32 v47, v86, v87
  v_add_u32 v3, 88064, v0
  ds_write_b128 v3, v[40:43] offset:0
  ds_write_b128 v3, v[44:47] offset:3072
  s_mov_b32 s44, s32
  s_mov_b32 s45, s33
  s_mov_b32 s46, 1409024
  s_mov_b32 s11, 1024
  s_mov_b32 s12, 1409024
  v_mov_b32 v4, 86016
  v_mov_b32 v5, 89088
  v_lshlrev_b32 v2, 4, v1
  s_call_b64 s[62:63], L_gv
  v_lshrrev_b32 v2, 1, v1
  v_lshlrev_b32 v2, 7, v2
  v_and_b32 v3, 1, v1
  v_lshl_add_u32 v2, v3, 5, v2
  v_add_u32 v2, 24576, v2
  global_load_dwordx4 v[40:43], v2, s[42:43] offset:0 sc1
  global_load_dwordx4 v[44:47], v2, s[42:43] offset:16 sc1
  global_load_dwordx4 v[48:51], v2, s[42:43] offset:64 sc1
  global_load_dwordx4 v[52:55], v2, s[42:43] offset:80 sc1
  s_waitcnt vmcnt(0)
  v_lshlrev_b32 v88, 16, v40
  v_and_b32 v89, s73, v40
  v_lshlrev_b32 v90, 16, v42
  v_and_b32 v91, s73, v42
  v_lshlrev_b32 v92, 16, v44
  v_and_b32 v93, s73, v44
  v_lshlrev_b32 v94, 16, v46
  v_and_b32 v95, s73, v46
  v_lshlrev_b32 v96, 16, v48
  v_and_b32 v97, s73, v48
  v_lshlrev_b32 v98, 16, v50
  v_and_b32 v99, s73, v50
  v_lshlrev_b32 v100, 16, v52
  v_and_b32 v101, s73, v52
  v_lshlrev_b32 v102, 16, v54
  v_and_b32 v103, s73, v54
  v_cvt_pk_bf16_f32 v72, 0, v72
  v_cvt_pk_bf16_f32 v73, 0, v73
  v_cvt_pk_bf16_f32 v74, 0, v74
  v_cvt_pk_bf16_f32 v75, 0, v75
  v_cvt_pk_bf16_f32 v76, 0, v76
  v_cvt_pk_bf16_f32 v77, 0, v77
  v_cvt_pk_bf16_f32 v78, 0, v78
  v_cvt_pk_bf16_f32 v79, 0, v79
  v_cvt_pk_bf16_f32 v80, 0, v80
  v_cvt_pk_bf16_f32 v81, 0, v81
  v_cvt_pk_bf16_f32 v82, 0, v82
  v_cvt_pk_bf16_f32 v83, 0, v83
  v_cvt_pk_bf16_f32 v84, 0, v84
  v_cvt_pk_bf16_f32 v85, 0, v85
  v_cvt_pk_bf16_f32 v86, 0, v86
  v_cvt_pk_bf16_f32 v87, 0, v87
  v_mul_f32 v72, v72, v88
  v_mul_f32 v73, v73, v89
  v_mul_f32 v74, v74, v90
  v_mul_f32 v75, v75, v91
  v_mul_f32 v76, v76, v92
  v_mul_f32 v77, v77, v93
  v_mul_f32 v78, v78, v94
  v_mul_f32 v79, v79, v95
  v_mul_f32 v80, v80, v96
  v_mul_f32 v81, v81, v97
  v_mul_f32 v82, v82, v98
  v_mul_f32 v83, v83, v99
  v_mul_f32 v84, v84, v100
  v_mul_f32 v85, v85, v101
  v_mul_f32 v86, v86, v102
  v_mul_f32 v87, v87, v103
  v_cvt_pk_bf16_f32 v72, 0, v72
  v_cvt_pk_bf16_f32 v73, 0, v73
  v_cvt_pk_bf16_f32 v74, 0, v74
  v_cvt_pk_bf16_f32 v75, 0, v75
  v_cvt_pk_bf16_f32 v76, 0, v76
  v_cvt_pk_bf16_f32 v77, 0, v77
  v_cvt_pk_bf16_f32 v78, 0, v78
  v_cvt_pk_bf16_f32 v79, 0, v79
  v_cvt_pk_bf16_f32 v80, 0, v80
  v_cvt_pk_bf16_f32 v81, 0, v81
  v_cvt_pk_bf16_f32 v82, 0, v82
  v_cvt_pk_bf16_f32 v83, 0, v83
  v_cvt_pk_bf16_f32 v84, 0, v84
  v_cvt_pk_bf16_f32 v85, 0, v85
  v_cvt_pk_bf16_f32 v86, 0, v86
  v_cvt_pk_bf16_f32 v87, 0, v87
  v_add_f32 v104, v104, v72
  v_add_f32 v105, v105, v73
  v_add_f32 v106, v106, v74
  v_add_f32 v107, v107, v75
  v_add_f32 v108, v108, v76
  v_add_f32 v109, v109, v77
  v_add_f32 v110, v110, v78
  v_add_f32 v111, v111, v79
  v_add_f32 v112, v112, v80
  v_add_f32 v113, v113, v81
  v_add_f32 v114, v114, v82
  v_add_f32 v115, v115, v83
  v_add_f32 v116, v116, v84
  v_add_f32 v117, v117, v85
  v_add_f32 v118, v118, v86
  v_add_f32 v119, v119, v87
  v_cvt_pk_bf16_f32 v104, 0, v104
  v_cvt_pk_bf16_f32 v105, 0, v105
  v_cvt_pk_bf16_f32 v106, 0, v106
  v_cvt_pk_bf16_f32 v107, 0, v107
  v_cvt_pk_bf16_f32 v108, 0, v108
  v_cvt_pk_bf16_f32 v109, 0, v109
  v_cvt_pk_bf16_f32 v110, 0, v110
  v_cvt_pk_bf16_f32 v111, 0, v111
  v_cvt_pk_bf16_f32 v112, 0, v112
  v_cvt_pk_bf16_f32 v113, 0, v113
  v_cvt_pk_bf16_f32 v114, 0, v114
  v_cvt_pk_bf16_f32 v115, 0, v115
  v_cvt_pk_bf16_f32 v116, 0, v116
  v_cvt_pk_bf16_f32 v117, 0, v117
  v_cvt_pk_bf16_f32 v118, 0, v118
  v_cvt_pk_bf16_f32 v119, 0, v119
  v_cvt_pk_bf16_f32 v40, v104, v105
  v_cvt_pk_bf16_f32 v41, v106, v107
  v_cvt_pk_bf16_f32 v42, v108, v109
  v_cvt_pk_bf16_f32 v43, v110, v111
  v_cvt_pk_bf16_f32 v44, v112, v113
  v_cvt_pk_bf16_f32 v45, v114, v115
  v_cvt_pk_bf16_f32 v46, v116, v117
  v_cvt_pk_bf16_f32 v47, v118, v119
  global_store_dwordx4 v0, v[40:43], s[38:39] offset:0 sc1
  global_store_dwordx4 v0, v[44:47], s[38:39] offset:1024 sc1
  s_endpgm
L_gv:
  v_mov_b32 v72, 0
  v_mov_b32 v73, 0
  v_mov_b32 v74, 0
  v_mov_b32 v75, 0
  v_mov_b32 v76, 0
  v_mov_b32 v77, 0
  v_mov_b32 v78, 0
  v_mov_b32 v79, 0
  v_mov_b32 v80, 0
  v_mov_b32 v81, 0
  v_mov_b32 v82, 0
  v_mov_b32 v83, 0
  v_mov_b32 v84, 0
  v_mov_b32 v85, 0
  v_mov_b32 v86, 0
  v_mov_b32 v87, 0
  s_mov_b32 s10, 0
L_gvl:
  buffer_load_dwordx4 v[40:43], v2, s[44:47], s10 offen
  s_add_u32 s10, s10, s11
  buffer_load_dwordx4 v[44:47], v2, s[44:47], s10 offen
  s_add_u32 s10, s10, s11
  buffer_load_dwordx4 v[48:51], v2, s[44:47], s10 offen
  s_add_u32 s10, s10, s11
  buffer_load_dwordx4 v[52:55], v2, s[44:47], s10 offen
  s_add_u32 s10, s10, s11
  buffer_load_dwordx4 v[56:59], v2, s[44:47], s10 offen
  s_add_u32 s10, s10, s11
  buffer_load_dwordx4 v[60:63], v2, s[44:47], s10 offen
  s_add_u32 s10, s10, s11
  buffer_load_dwordx4 v[64:67], v2, s[44:47], s10 offen
  s_add_u32 s10, s10, s11
  buffer_load_dwordx4 v[68:71], v2, s[44:47], s10 offen
  s_add_u32 s10, s10, s11
  ds_read_b128 v[88:91], v4
  ds_read_b128 v[92:95], v5
  v_add_u32 v4, 16, v4
  v_add_u32 v5, 16, v5
  s_waitcnt lgkmcnt(0)
  v_and_b32 v8, 0xffff, v88
  v_lshlrev_b32 v9, 16, v88
  v_and_b32 v10, 0xffff, v92
  v_lshlrev_b32 v11, 16, v92
  s_waitcnt vmcnt(7)
  v_dot2c_f32_bf16 v72, v8, v40
  v_dot2c_f32_bf16 v73, v9, v40
  v_dot2c_f32_bf16 v74, v8, v41
  v_dot2c_f32_bf16 v75, v9, v41
  v_dot2c_f32_bf16 v76, v8, v42
  v_dot2c_f32_bf16 v77, v9, v42
  v_dot2c_f32_bf16 v78, v8, v43
  v_dot2c_f32_bf16 v79, v9, v43
  v_dot2c_f32_bf16 v80, v10, v40
  v_dot2c_f32_bf16 v81, v11, v40
  v_dot2c_f32_bf16 v82, v10, v41
  v_dot2c_f32_bf16 v83, v11, v41
  v_dot2c_f32_bf16 v84, v10, v42
  v_dot2c_f32_bf16 v85, v11, v42
  v_dot2c_f32_bf16 v86, v10, v43
  v_dot2c_f32_bf16 v87, v11, v43
  v_lshrrev_b32 v8, 16, v88
  v_and_b32 v9, s73, v88
  v_lshrrev_b32 v10, 16, v92
  v_and_b32 v11, s73, v92
  s_waitcnt vmcnt(6)
  v_dot2c_f32_bf16 v72, v8, v44
  v_dot2c_f32_bf16 v73, v9, v44
  v_dot2c_f32_bf16 v74, v8, v45
  v_dot2c_f32_bf16 v75, v9, v45
  v_dot2c_f32_bf16 v76, v8, v46
  v_dot2c_f32_bf16 v77, v9, v46
  v_dot2c_f32_bf16 v78, v8, v47
  v_dot2c_f32_bf16 v79, v9, v47
  v_dot2c_f32_bf16 v80, v10, v44
  v_dot2c_f32_bf16 v81, v11, v44
  v_dot2c_f32_bf16 v82, v10, v45
  v_dot2c_f32_bf16 v83, v11, v45
  v_dot2c_f32_bf16 v84, v10, v46
  v_dot2c_f32_bf16 v85, v11, v46
  v_dot2c_f32_bf16 v86, v10, v47
  v_dot2c_f32_bf16 v87, v11, v47
  v_and_b32 v8, 0xffff, v89
  v_lshlrev_b32 v9, 16, v89
  v_and_b32 v10, 0xffff, v93
  v_lshlrev_b32 v11, 16, v93
  s_waitcnt vmcnt(5)
  v_dot2c_f32_bf16 v72, v8, v48
  v_dot2c_f32_bf16 v73, v9, v48
  v_dot2c_f32_bf16 v74, v8, v49
  v_dot2c_f32_bf16 v75, v9, v49
  v_dot2c_f32_bf16 v76, v8, v50
  v_dot2c_f32_bf16 v77, v9, v50
  v_dot2c_f32_bf16 v78, v8, v51
  v_dot2c_f32_bf16 v79, v9, v51
  v_dot2c_f32_bf16 v80, v10, v48
  v_dot2c_f32_bf16 v81, v11, v48
  v_dot2c_f32_bf16 v82, v10, v49
  v_dot2c_f32_bf16 v83, v11, v49
  v_dot2c_f32_bf16 v84, v10, v50
  v_dot2c_f32_bf16 v85, v11, v50
  v_dot2c_f32_bf16 v86, v10, v51
  v_dot2c_f32_bf16 v87, v11, v51
  v_lshrrev_b32 v8, 16, v89
  v_and_b32 v9, s73, v89
  v_lshrrev_b32 v10, 16, v93
  v_and_b32 v11, s73, v93
  s_waitcnt vmcnt(4)
  v_dot2c_f32_bf16 v72, v8, v52
  v_dot2c_f32_bf16 v73, v9, v52
  v_dot2c_f32_bf16 v74, v8, v53
  v_dot2c_f32_bf16 v75, v9, v53
  v_dot2c_f32_bf16 v76, v8, v54
  v_dot2c_f32_bf16 v77, v9, v54
  v_dot2c_f32_bf16 v78, v8, v55
  v_dot2c_f32_bf16 v79, v9, v55
  v_dot2c_f32_bf16 v80, v10, v52
  v_dot2c_f32_bf16 v81, v11, v52
  v_dot2c_f32_bf16 v82, v10, v53
  v_dot2c_f32_bf16 v83, v11, v53
  v_dot2c_f32_bf16 v84, v10, v54
  v_dot2c_f32_bf16 v85, v11, v54
  v_dot2c_f32_bf16 v86, v10, v55
  v_dot2c_f32_bf16 v87, v11, v55
  v_and_b32 v8, 0xffff, v90
  v_lshlrev_b32 v9, 16, v90
  v_and_b32 v10, 0xffff, v94
  v_lshlrev_b32 v11, 16, v94
  s_waitcnt vmcnt(3)
  v_dot2c_f32_bf16 v72, v8, v56
  v_dot2c_f32_bf16 v73, v9, v56
  v_dot2c_f32_bf16 v74, v8, v57
  v_dot2c_f32_bf16 v75, v9, v57
  v_dot2c_f32_bf16 v76, v8, v58
  v_dot2c_f32_bf16 v77, v9, v58
  v_dot2c_f32_bf16 v78, v8, v59
  v_dot2c_f32_bf16 v79, v9, v59
  v_dot2c_f32_bf16 v80, v10, v56
  v_dot2c_f32_bf16 v81, v11, v56
  v_dot2c_f32_bf16 v82, v10, v57
  v_dot2c_f32_bf16 v83, v11, v57
  v_dot2c_f32_bf16 v84, v10, v58
  v_dot2c_f32_bf16 v85, v11, v58
  v_dot2c_f32_bf16 v86, v10, v59
  v_dot2c_f32_bf16 v87, v11, v59
  v_lshrrev_b32 v8, 16, v90
  v_and_b32 v9, s73, v90
  v_lshrrev_b32 v10, 16, v94
  v_and_b32 v11, s73, v94
  s_waitcnt vmcnt(2)
  v_dot2c_f32_bf16 v72, v8, v60
  v_dot2c_f32_bf16 v73, v9, v60
  v_dot2c_f32_bf16 v74, v8, v61
  v_dot2c_f32_bf16 v75, v9, v61
  v_dot2c_f32_bf16 v76, v8, v62
  v_dot2c_f32_bf16 v77, v9, v62
  v_dot2c_f32_bf16 v78, v8, v63
  v_dot2c_f32_bf16 v79, v9, v63
  v_dot2c_f32_bf16 v80, v10, v60
  v_dot2c_f32_bf16 v81, v11, v60
  v_dot2c_f32_bf16 v82, v10, v61
  v_dot2c_f32_bf16 v83, v11, v61
  v_dot2c_f32_bf16 v84, v10, v62
  v_dot2c_f32_bf16 v85, v11, v62
  v_dot2c_f32_bf16 v86, v10, v63
  v_dot2c_f32_bf16 v87, v11, v63
  v_and_b32 v8, 0xffff, v91
  v_lshlrev_b32 v9, 16, v91
  v_and_b32 v10, 0xffff, v95
  v_lshlrev_b32 v11, 16, v95
  s_waitcnt vmcnt(1)
  v_dot2c_f32_bf16 v72, v8, v64
  v_dot2c_f32_bf16 v73, v9, v64
  v_dot2c_f32_bf16 v74, v8, v65
  v_dot2c_f32_bf16 v75, v9, v65
  v_dot2c_f32_bf16 v76, v8, v66
  v_dot2c_f32_bf16 v77, v9, v66
  v_dot2c_f32_bf16 v78, v8, v67
  v_dot2c_f32_bf16 v79, v9, v67
  v_dot2c_f32_bf16 v80, v10, v64
  v_dot2c_f32_bf16 v81, v11, v64
  v_dot2c_f32_bf16 v82, v10, v65
  v_dot2c_f32_bf16 v83, v11, v65
  v_dot2c_f32_bf16 v84, v10, v66
  v_dot2c_f32_bf16 v85, v11, v66
  v_dot2c_f32_bf16 v86, v10, v67
  v_dot2c_f32_bf16 v87, v11, v67
  v_lshrrev_b32 v8, 16, v91
  v_and_b32 v9, s73, v91
  v_lshrrev_b32 v10, 16, v95
  v_and_b32 v11, s73, v95
  s_waitcnt vmcnt(0)
  v_dot2c_f32_bf16 v72, v8, v68
  v_dot2c_f32_bf16 v73, v9, v68
  v_dot2c_f32_bf16 v74, v8, v69
  v_dot2c_f32_bf16 v75, v9, v69
  v_dot2c_f32_bf16 v76, v8, v70
  v_dot2c_f32_bf16 v77, v9, v70
  v_dot2c_f32_bf16 v78, v8, v71
  v_dot2c_f32_bf16 v79, v9, v71
  v_dot2c_f32_bf16 v80, v10, v68
  v_dot2c_f32_bf16 v81, v11, v68
  v_dot2c_f32_bf16 v82, v10, v69
  v_dot2c_f32_bf16 v83, v11, v69
  v_dot2c_f32_bf16 v84, v10, v70
  v_dot2c_f32_bf16 v85, v11, v70
  v_dot2c_f32_bf16 v86, v10, v71
  v_dot2c_f32_bf16 v87, v11, v71
  s_cmp_lt_u32 s10, s12
  s_cbranch_scc1 L_gvl
  s_nop 1
  s_setpc_b64 s[62:63]
L_ks:
  s_waitcnt lgkmcnt(0)
  v_readfirstlane_b32 s78, v20
  v_readfirstlane_b32 s79, v21
  s_cmp_eq_u32 s32, s57
  s_cselect_b32 s34, s58, s34
  s_cmp_ge_u32 s39, 4
  s_cbranch_scc1 L_ks2
  s_call_b64 s[100:101], L_work
L_ks2:
  s_add_u32 s32, s32, 1
  s_mul_i32 s68, s35, s76
  s_sub_i32 s68, s68, s78
  s_sub_u32 s35, s35, 1
  s_add_i32 s68, s68, 1024
  s_mul_i32 s68, s68, 14
  s_add_i32 s68, s68, s34
  s_add_i32 s68, s68, s79
  s_max_i32 s68, s68, 384
  s_min_i32 s68, s68, 1280
  s_lshl_b32 s69, s68, 24
  s_lshr_b32 s68, s68, 8
  s_add_u32 s33, s33, s69
  s_addc_u32 s41, s68, 0
L_wait:
  s_waitcnt vmcnt(4)
  s_cmp_ge_u32 s41, 5
  s_cbranch_scc1 L_ret
  s_waitcnt vmcnt(3)
  s_cmp_ge_u32 s41, 4
  s_cbranch_scc1 L_ret
  s_waitcnt vmcnt(2)
  s_cmp_ge_u32 s41, 3
  s_cbranch_scc1 L_ret
  s_waitcnt vmcnt(1)
  s_cmp_ge_u32 s41, 2
  s_cbranch_scc1 L_ret
  s_waitcnt vmcnt(0)
L_ret:
  s_mov_b64 exec, 1
  ds_dec_u32 v23, v39 offset:6688
  ds_read_b64 v[20:21], v23 offset:6688
  s_mov_b64 exec, -1
  s_cmp_lg_u32 s32, s32
  s_setpc_b64 s[62:63]
L_vs:
  s_waitcnt lgkmcnt(0)
  v_readfirstlane_b32 s78, v20
  v_readfirstlane_b32 s79, v21
  s_cmp_lg_u32 s61, 0
  s_cbranch_scc1 L_vs1
  s_cmp_gt_u32 s41, s32
  s_cbranch_scc1 L_ks2
L_x1:
  v_dot2_f32_bf16 v8, v136, v4, 0
  v_dot2_f32_bf16 v9, v140, v4, 0
  v_dot2_f32_bf16 v10, v144, v4, 0
  v_dot2_f32_bf16 v11, v148, v4, 0
  v_dot2_f32_bf16 v12, v152, v4, 0
  v_dot2_f32_bf16 v13, v156, v4, 0
  v_dot2_f32_bf16 v14, v160, v4, 0
  v_dot2_f32_bf16 v15, v164, v4, 0
  v_dot2_f32_bf16 v8, v137, v5, v8
  v_dot2_f32_bf16 v9, v141, v5, v9
  v_dot2_f32_bf16 v10, v145, v5, v10
  v_dot2_f32_bf16 v11, v149, v5, v11
  v_dot2_f32_bf16 v12, v153, v5, v12
  v_dot2_f32_bf16 v13, v157, v5, v13
  v_dot2_f32_bf16 v14, v161, v5, v14
  v_dot2_f32_bf16 v15, v165, v5, v15
  v_dot2_f32_bf16 v8, v138, v6, v8
  v_dot2_f32_bf16 v9, v142, v6, v9
  v_dot2_f32_bf16 v10, v146, v6, v10
  v_dot2_f32_bf16 v11, v150, v6, v11
  v_dot2_f32_bf16 v12, v154, v6, v12
  v_dot2_f32_bf16 v13, v158, v6, v13
  v_dot2_f32_bf16 v14, v162, v6, v14
  v_dot2_f32_bf16 v15, v166, v6, v15
  v_dot2_f32_bf16 v8, v139, v7, v8
  v_dot2_f32_bf16 v9, v143, v7, v9
  v_dot2_f32_bf16 v10, v147, v7, v10
  v_dot2_f32_bf16 v11, v151, v7, v11
  v_dot2_f32_bf16 v12, v155, v7, v12
  v_dot2_f32_bf16 v13, v159, v7, v13
  v_dot2_f32_bf16 v14, v163, v7, v14
  v_dot2_f32_bf16 v15, v167, v7, v15
  v_add_f32_dpp v8, v8, v8 row_ror:8 row_mask:0xf bank_mask:0x3
  v_add_f32_dpp v8, v9, v9 row_ror:8 row_mask:0xf bank_mask:0xc
  v_add_f32_dpp v10, v10, v10 row_ror:8 row_mask:0xf bank_mask:0x3
  v_add_f32_dpp v10, v11, v11 row_ror:8 row_mask:0xf bank_mask:0xc
  v_add_f32_dpp v12, v12, v12 row_ror:8 row_mask:0xf bank_mask:0x3
  v_add_f32_dpp v12, v13, v13 row_ror:8 row_mask:0xf bank_mask:0xc
  v_add_f32_dpp v14, v14, v14 row_ror:8 row_mask:0xf bank_mask:0x3
  v_add_f32_dpp v14, v15, v15 row_ror:8 row_mask:0xf bank_mask:0xc
  v_add_f32_dpp v18, v8, v8 row_shl:4 row_mask:0xf bank_mask:0x5
  v_add_f32_dpp v18, v10, v10 row_shr:4 row_mask:0xf bank_mask:0xa
  v_add_f32_dpp v19, v12, v12 row_shl:4 row_mask:0xf bank_mask:0x5
  v_add_f32_dpp v19, v14, v14 row_shr:4 row_mask:0xf bank_mask:0xa
  v_mov_b32 v3, 0
  v_mov_b32 v20, 64
  v_add_f32_dpp v16, v16, v16 quad_perm:[2,3,0,1] row_mask:0xf bank_mask:0xf
  v_add_f32_dpp v17, v17, v17 quad_perm:[2,3,0,1] row_mask:0xf bank_mask:0xf
  v_add_f32_dpp v18, v18, v18 quad_perm:[2,3,0,1] row_mask:0xf bank_mask:0xf
  v_add_f32_dpp v19, v19, v19 quad_perm:[2,3,0,1] row_mask:0xf bank_mask:0xf
  v_cndmask_b32 v8, v16, v17, s[52:53]
  v_cndmask_b32 v9, v18, v19, s[52:53]
  s_nop 0
  v_lshlrev_b32 v21, 3, s9
  v_add_f32_dpp v8, v8, v8 quad_perm:[1,0,3,2] row_mask:0xf bank_mask:0xf
  v_add_f32_dpp v9, v9, v9 quad_perm:[1,0,3,2] row_mask:0xf bank_mask:0xf
  v_cndmask_b32 v27, v8, v9, s[54:55]
  v_cvt_pk_bf16_f32 v27, 0, v27
  v_mul_f32 v27, 0x3db504f3, v27
  v_cvt_pk_bf16_f32 v27, 0, v27
  v_max_f32 v37, v37, v27
  s_nop 1
  v_max_f32_dpp v37, v37, v37 row_ror:8 row_mask:0xf bank_mask:0xf
  s_nop 1
  v_max_f32_dpp v37, v37, v37 row_ror:4 row_mask:0xf bank_mask:0xf
  s_nop 1
  v_max_f32_dpp v37, v37, v37 row_ror:2 row_mask:0xf bank_mask:0xf
  s_nop 1
  v_max_f32_dpp v37, v37, v37 row_ror:1 row_mask:0xf bank_mask:0xf
  v_mov_b32 v8, v37
  s_nop 1
  v_permlane16_swap_b32 v8, v37
  v_max_f32 v37, v37, v8
  v_mov_b32 v8, v37
  s_nop 1
  v_permlane32_swap_b32 v8, v37
  v_max_f32 v37, v37, v8
  v_sub_f32 v17, v25, v37
  v_sub_f32 v18, v27, v37
  v_mul_f32 v17, 0x3fb8aa3b, v17
  v_mul_f32 v18, 0x3fb8aa3b, v18
  v_exp_f32 v17, v17
  v_exp_f32 v18, v18
  v_mov_b32 v16, v37
  v_add_f32 v17, v17, v18
  s_nop 1
  v_add_f32_dpp v17, v17, v17 row_ror:8 row_mask:0xf bank_mask:0xf
  s_nop 1
  v_add_f32_dpp v17, v17, v17 row_ror:4 row_mask:0xf bank_mask:0xf
  s_nop 1
  v_add_f32_dpp v17, v17, v17 row_ror:2 row_mask:0xf bank_mask:0xf
  s_nop 1
  v_add_f32_dpp v17, v17, v17 row_ror:1 row_mask:0xf bank_mask:0xf
  v_mov_b32 v8, v17
  s_nop 1
  v_permlane16_swap_b32 v8, v17
  v_add_f32 v17, v17, v8
  v_mov_b32 v8, v17
  s_nop 1
  v_permlane32_swap_b32 v8, v17
  v_add_f32 v17, v17, v8
  s_mov_b64 exec, 1
  ds_max_f32 v3, v37 offset:6676
  ds_write_b64 v21, v[16:17] offset:6912
  ds_add_u32 v3, v20 offset:6672
  s_mov_b64 exec, -1
  v_max_f32 v20, v2, v37
  v_mov_b32 v21, s22
  s_add_u32 s38, s38, 3
  s_lshr_b32 s38, s38, 2
  s_max_u32 s38, s38, s32
  s_lshl_b32 s38, s38, 2
  v_cmp_nlt_f32 vcc, v25, v21
  v_cmp_nlt_f32 s[70:71], v27, v21
  s_bcnt1_i32_b64 s68, vcc
  s_bcnt1_i32_b64 s69, s[70:71]
  s_add_u32 s20, s68, s69
  s_cmp_gt_u32 s20, 32
  s_cselect_b32 s21, 1, s21
  v_mov_b32 v4, 0
  v_mov_b32 v5, 0
  s_cmp_lg_u32 s21, 0
  s_cbranch_scc1 L_x2
  s_mov_b32 s18, s38
  s_mov_b32 s38, 160
  v_cmp_nlt_f32 vcc, v25, v21
  s_lshl_b32 s68, s38, 3
  s_add_u32 s68, s68, s56
  s_andn2_b64 s[70:71], vcc, s[64:65]
  v_mbcnt_lo_u32_b32 v3, s70, 0
  v_mbcnt_hi_u32_b32 v3, s71, v3
  s_bcnt1_i32_b64 s69, s[70:71]
  v_lshl_add_u32 v3, v3, 3, s68
  s_mov_b64 exec, s[70:71]
  ds_write_b64 v3, v[24:25]
  s_mov_b64 exec, -1
  s_or_b64 s[64:65], s[64:65], s[70:71]
  s_add_u32 s38, s38, s69
  v_cmp_nlt_f32 vcc, v27, v21
  s_lshl_b32 s68, s38, 3
  s_add_u32 s68, s68, s56
  s_andn2_b64 s[70:71], vcc, s[66:67]
  v_mbcnt_lo_u32_b32 v3, s70, 0
  v_mbcnt_hi_u32_b32 v3, s71, v3
  s_bcnt1_i32_b64 s69, s[70:71]
  v_lshl_add_u32 v3, v3, 3, s68
  s_mov_b64 exec, s[70:71]
  ds_write_b64 v3, v[26:27]
  s_mov_b64 exec, -1
  s_or_b64 s[66:67], s[66:67], s[70:71]
  s_add_u32 s38, s38, s69
  ds_read_b32 v32, v39 offset:1024
  s_mov_b32 s38, s18
  s_mov_b32 s18, s32
  s_mov_b32 s19, 1
  s_waitcnt lgkmcnt(0)
  s_cmp_le_u32 s20, 0
  s_cbranch_scc1 L_x2
  v_add_u32_dpp v3, v32, v38 row_newbcast:8 row_mask:0xf bank_mask:0xf
  buffer_load_dwordx4 v[136:139], v3, s[48:51], 0 offen nt
  s_cmp_le_u32 s20, 4
  s_cbranch_scc1 L_x2
  v_add_u32_dpp v3, v32, v38 row_newbcast:9 row_mask:0xf bank_mask:0xf
  buffer_load_dwordx4 v[140:143], v3, s[48:51], 0 offen nt
  s_cmp_le_u32 s20, 8
  s_cbranch_scc1 L_x2
  v_add_u32_dpp v3, v32, v38 row_newbcast:10 row_mask:0xf bank_mask:0xf
  buffer_load_dwordx4 v[144:147], v3, s[48:51], 0 offen nt
  s_cmp_le_u32 s20, 12
  s_cbranch_scc1 L_x2
  v_add_u32_dpp v3, v32, v38 row_newbcast:11 row_mask:0xf bank_mask:0xf
  buffer_load_dwordx4 v[148:151], v3, s[48:51], 0 offen nt
  s_cmp_le_u32 s20, 16
  s_cbranch_scc1 L_x2
  v_add_u32_dpp v3, v32, v38 row_newbcast:12 row_mask:0xf bank_mask:0xf
  buffer_load_dwordx4 v[152:155], v3, s[48:51], 0 offen nt
  s_cmp_le_u32 s20, 20
  s_cbranch_scc1 L_x2
  v_add_u32_dpp v3, v32, v38 row_newbcast:13 row_mask:0xf bank_mask:0xf
  buffer_load_dwordx4 v[156:159], v3, s[48:51], 0 offen nt
  s_cmp_le_u32 s20, 24
  s_cbranch_scc1 L_x2
  v_add_u32_dpp v3, v32, v38 row_newbcast:14 row_mask:0xf bank_mask:0xf
  buffer_load_dwordx4 v[160:163], v3, s[48:51], 0 offen nt
  s_cmp_le_u32 s20, 28
  s_cbranch_scc1 L_x2
  v_add_u32_dpp v3, v32, v38 row_newbcast:15 row_mask:0xf bank_mask:0xf
  buffer_load_dwordx4 v[164:167], v3, s[48:51], 0 offen nt
L_x2:
  v_add_f32 v21, 0xc2ac0000, v20
  v_cmp_nlt_f32 vcc, v25, v21
  s_lshl_b32 s68, s38, 3
  s_add_u32 s68, s68, s56
  s_andn2_b64 s[70:71], vcc, s[64:65]
  v_mbcnt_lo_u32_b32 v3, s70, 0
  v_mbcnt_hi_u32_b32 v3, s71, v3
  s_bcnt1_i32_b64 s69, s[70:71]
  v_lshl_add_u32 v3, v3, 3, s68
  s_mov_b64 exec, s[70:71]
  ds_write_b64 v3, v[24:25]
  s_mov_b64 exec, -1
  s_or_b64 s[64:65], s[64:65], s[70:71]
  s_add_u32 s38, s38, s69
  v_cmp_nlt_f32 vcc, v27, v21
  s_lshl_b32 s68, s38, 3
  s_add_u32 s68, s68, s56
  s_andn2_b64 s[70:71], vcc, s[66:67]
  v_mbcnt_lo_u32_b32 v3, s70, 0
  v_mbcnt_hi_u32_b32 v3, s71, v3
  s_bcnt1_i32_b64 s69, s[70:71]
  v_lshl_add_u32 v3, v3, 3, s68
  s_mov_b64 exec, s[70:71]
  ds_write_b64 v3, v[26:27]
  s_mov_b64 exec, -1
  s_or_b64 s[66:67], s[66:67], s[70:71]
  s_add_u32 s38, s38, s69
  v_mov_b32 v8, 0
  v_mov_b32 v9, 0
  v_mov_b32 v10, 0
  v_mov_b32 v11, 0
  v_mov_b32 v12, 0
  v_mov_b32 v13, 0
  v_mov_b32 v14, 0
  v_mov_b32 v15, 0
  s_lshr_b32 s36, s38, 2
  s_mov_b32 s61, 1
  s_add_u32 s68, s38, 8
  s_lshr_b32 s68, s68, 2
  s_sub_u32 s69, s68, s59
  s_mov_b32 s59, s68
  s_add_u32 s35, s35, s69
  s_add_u32 s78, s78, s69
  v_mov_b32 v3, s69
  s_mov_b64 exec, 1
  ds_add_u32 v1, v3 offset:6696
  s_mov_b64 exec, -1
  ds_read_b64 v[28:29], v39 offset:0
  ds_read_b64 v[30:31], v39 offset:512
  ds_read_b64 v[32:33], v39 offset:1024
  s_waitcnt lgkmcnt(0)
  v_sub_f32 v29, v29, v37
  v_sub_f32 v31, v31, v37
  v_sub_f32 v33, v33, v37
  v_mul_f32 v29, 0x3fb8aa3b, v29
  v_mul_f32 v31, 0x3fb8aa3b, v31
  v_mul_f32 v33, 0x3fb8aa3b, v33
  v_exp_f32 v29, v29
  v_exp_f32 v31, v31
  v_exp_f32 v33, v33
  s_nop 0
  v_cvt_pk_bf16_f32 v34, 0, v29
  v_cvt_pk_bf16_f32 v35, 0, v31
  v_cvt_pk_bf16_f32 v36, 0, v33
  v_cvt_pk_bf16_f32 v29, v29, 0
  v_cvt_pk_bf16_f32 v31, v31, 0
  v_cvt_pk_bf16_f32 v33, v33, 0
  s_cmp_eq_u32 s20, 0
  s_cselect_b32 s41, 0, s41
L_vs1:
  s_cmp_eq_u32 s19, 0
  s_cbranch_scc1 L_vs1b
  s_sub_u32 s68, s32, s18
  s_cmp_le_u32 s41, s68
  s_cbranch_scc1 L_snap
  s_cmp_lg_u32 s36, s32
  s_cbranch_scc1 L_vs2
  s_waitcnt vmcnt(0)
L_snap:
  v_mov_b32 v6, 0
  v_mov_b32 v7, 0
  v_mov_b32 v16, 0
  v_mov_b32 v17, 0
  v_mov_b32 v18, 0
  v_mov_b32 v19, 0
  s_cmp_le_u32 s20, 0
  s_cbranch_scc1 L_snp2
  v_dot2c_f32_bf16_dpp v4, v33, v136 row_newbcast:8 row_mask:0xf bank_mask:0xf
  v_dot2c_f32_bf16_dpp v5, v36, v136 row_newbcast:8 row_mask:0xf bank_mask:0xf
  v_dot2c_f32_bf16_dpp v6, v33, v137 row_newbcast:8 row_mask:0xf bank_mask:0xf
  v_dot2c_f32_bf16_dpp v7, v36, v137 row_newbcast:8 row_mask:0xf bank_mask:0xf
  v_dot2c_f32_bf16_dpp v16, v33, v138 row_newbcast:8 row_mask:0xf bank_mask:0xf
  v_dot2c_f32_bf16_dpp v17, v36, v138 row_newbcast:8 row_mask:0xf bank_mask:0xf
  v_dot2c_f32_bf16_dpp v18, v33, v139 row_newbcast:8 row_mask:0xf bank_mask:0xf
  v_dot2c_f32_bf16_dpp v19, v36, v139 row_newbcast:8 row_mask:0xf bank_mask:0xf
  s_cmp_le_u32 s20, 4
  s_cbranch_scc1 L_snp2
  v_dot2c_f32_bf16_dpp v4, v33, v140 row_newbcast:9 row_mask:0xf bank_mask:0xf
  v_dot2c_f32_bf16_dpp v5, v36, v140 row_newbcast:9 row_mask:0xf bank_mask:0xf
  v_dot2c_f32_bf16_dpp v6, v33, v141 row_newbcast:9 row_mask:0xf bank_mask:0xf
  v_dot2c_f32_bf16_dpp v7, v36, v141 row_newbcast:9 row_mask:0xf bank_mask:0xf
  v_dot2c_f32_bf16_dpp v16, v33, v142 row_newbcast:9 row_mask:0xf bank_mask:0xf
  v_dot2c_f32_bf16_dpp v17, v36, v142 row_newbcast:9 row_mask:0xf bank_mask:0xf
  v_dot2c_f32_bf16_dpp v18, v33, v143 row_newbcast:9 row_mask:0xf bank_mask:0xf
  v_dot2c_f32_bf16_dpp v19, v36, v143 row_newbcast:9 row_mask:0xf bank_mask:0xf
  s_cmp_le_u32 s20, 8
  s_cbranch_scc1 L_snp2
  v_dot2c_f32_bf16_dpp v4, v33, v144 row_newbcast:10 row_mask:0xf bank_mask:0xf
  v_dot2c_f32_bf16_dpp v5, v36, v144 row_newbcast:10 row_mask:0xf bank_mask:0xf
  v_dot2c_f32_bf16_dpp v6, v33, v145 row_newbcast:10 row_mask:0xf bank_mask:0xf
  v_dot2c_f32_bf16_dpp v7, v36, v145 row_newbcast:10 row_mask:0xf bank_mask:0xf
  v_dot2c_f32_bf16_dpp v16, v33, v146 row_newbcast:10 row_mask:0xf bank_mask:0xf
  v_dot2c_f32_bf16_dpp v17, v36, v146 row_newbcast:10 row_mask:0xf bank_mask:0xf
  v_dot2c_f32_bf16_dpp v18, v33, v147 row_newbcast:10 row_mask:0xf bank_mask:0xf
  v_dot2c_f32_bf16_dpp v19, v36, v147 row_newbcast:10 row_mask:0xf bank_mask:0xf
  s_cmp_le_u32 s20, 12
  s_cbranch_scc1 L_snp2
  v_dot2c_f32_bf16_dpp v4, v33, v148 row_newbcast:11 row_mask:0xf bank_mask:0xf
  v_dot2c_f32_bf16_dpp v5, v36, v148 row_newbcast:11 row_mask:0xf bank_mask:0xf
  v_dot2c_f32_bf16_dpp v6, v33, v149 row_newbcast:11 row_mask:0xf bank_mask:0xf
  v_dot2c_f32_bf16_dpp v7, v36, v149 row_newbcast:11 row_mask:0xf bank_mask:0xf
  v_dot2c_f32_bf16_dpp v16, v33, v150 row_newbcast:11 row_mask:0xf bank_mask:0xf
  v_dot2c_f32_bf16_dpp v17, v36, v150 row_newbcast:11 row_mask:0xf bank_mask:0xf
  v_dot2c_f32_bf16_dpp v18, v33, v151 row_newbcast:11 row_mask:0xf bank_mask:0xf
  v_dot2c_f32_bf16_dpp v19, v36, v151 row_newbcast:11 row_mask:0xf bank_mask:0xf
  s_cmp_le_u32 s20, 16
  s_cbranch_scc1 L_snp2
  v_dot2c_f32_bf16_dpp v4, v33, v152 row_newbcast:12 row_mask:0xf bank_mask:0xf
  v_dot2c_f32_bf16_dpp v5, v36, v152 row_newbcast:12 row_mask:0xf bank_mask:0xf
  v_dot2c_f32_bf16_dpp v6, v33, v153 row_newbcast:12 row_mask:0xf bank_mask:0xf
  v_dot2c_f32_bf16_dpp v7, v36, v153 row_newbcast:12 row_mask:0xf bank_mask:0xf
  v_dot2c_f32_bf16_dpp v16, v33, v154 row_newbcast:12 row_mask:0xf bank_mask:0xf
  v_dot2c_f32_bf16_dpp v17, v36, v154 row_newbcast:12 row_mask:0xf bank_mask:0xf
  v_dot2c_f32_bf16_dpp v18, v33, v155 row_newbcast:12 row_mask:0xf bank_mask:0xf
  v_dot2c_f32_bf16_dpp v19, v36, v155 row_newbcast:12 row_mask:0xf bank_mask:0xf
  s_cmp_le_u32 s20, 20
  s_cbranch_scc1 L_snp2
  v_dot2c_f32_bf16_dpp v4, v33, v156 row_newbcast:13 row_mask:0xf bank_mask:0xf
  v_dot2c_f32_bf16_dpp v5, v36, v156 row_newbcast:13 row_mask:0xf bank_mask:0xf
  v_dot2c_f32_bf16_dpp v6, v33, v157 row_newbcast:13 row_mask:0xf bank_mask:0xf
  v_dot2c_f32_bf16_dpp v7, v36, v157 row_newbcast:13 row_mask:0xf bank_mask:0xf
  v_dot2c_f32_bf16_dpp v16, v33, v158 row_newbcast:13 row_mask:0xf bank_mask:0xf
  v_dot2c_f32_bf16_dpp v17, v36, v158 row_newbcast:13 row_mask:0xf bank_mask:0xf
  v_dot2c_f32_bf16_dpp v18, v33, v159 row_newbcast:13 row_mask:0xf bank_mask:0xf
  v_dot2c_f32_bf16_dpp v19, v36, v159 row_newbcast:13 row_mask:0xf bank_mask:0xf
  s_cmp_le_u32 s20, 24
  s_cbranch_scc1 L_snp2
  v_dot2c_f32_bf16_dpp v4, v33, v160 row_newbcast:14 row_mask:0xf bank_mask:0xf
  v_dot2c_f32_bf16_dpp v5, v36, v160 row_newbcast:14 row_mask:0xf bank_mask:0xf
  v_dot2c_f32_bf16_dpp v6, v33, v161 row_newbcast:14 row_mask:0xf bank_mask:0xf
  v_dot2c_f32_bf16_dpp v7, v36, v161 row_newbcast:14 row_mask:0xf bank_mask:0xf
  v_dot2c_f32_bf16_dpp v16, v33, v162 row_newbcast:14 row_mask:0xf bank_mask:0xf
  v_dot2c_f32_bf16_dpp v17, v36, v162 row_newbcast:14 row_mask:0xf bank_mask:0xf
  v_dot2c_f32_bf16_dpp v18, v33, v163 row_newbcast:14 row_mask:0xf bank_mask:0xf
  v_dot2c_f32_bf16_dpp v19, v36, v163 row_newbcast:14 row_mask:0xf bank_mask:0xf
  s_cmp_le_u32 s20, 28
  s_cbranch_scc1 L_snp2
  v_dot2c_f32_bf16_dpp v4, v33, v164 row_newbcast:15 row_mask:0xf bank_mask:0xf
  v_dot2c_f32_bf16_dpp v5, v36, v164 row_newbcast:15 row_mask:0xf bank_mask:0xf
  v_dot2c_f32_bf16_dpp v6, v33, v165 row_newbcast:15 row_mask:0xf bank_mask:0xf
  v_dot2c_f32_bf16_dpp v7, v36, v165 row_newbcast:15 row_mask:0xf bank_mask:0xf
  v_dot2c_f32_bf16_dpp v16, v33, v166 row_newbcast:15 row_mask:0xf bank_mask:0xf
  v_dot2c_f32_bf16_dpp v17, v36, v166 row_newbcast:15 row_mask:0xf bank_mask:0xf
  v_dot2c_f32_bf16_dpp v18, v33, v167 row_newbcast:15 row_mask:0xf bank_mask:0xf
  v_dot2c_f32_bf16_dpp v19, v36, v167 row_newbcast:15 row_mask:0xf bank_mask:0xf
L_snp2:
  s_nop 1
  s_nop 0
  v_permlane32_swap_b32 v4, v16
  v_permlane32_swap_b32 v5, v17
  v_permlane32_swap_b32 v6, v18
  v_permlane32_swap_b32 v7, v19
  v_add_f32 v4, v4, v16
  v_add_f32 v5, v5, v17
  v_add_f32 v6, v6, v18
  v_add_f32 v7, v7, v19
  v_mov_b32 v3, 1
  v_permlane16_swap_b32 v4, v6
  v_permlane16_swap_b32 v5, v7
  v_add_f32 v4, v4, v6
  v_add_f32 v5, v5, v7
  ds_write_b64 v22, v[4:5] offset:13056
  s_mov_b64 exec, 1
  ds_add_u32 v1, v3 offset:6704
  s_mov_b64 exec, -1
  s_mov_b32 s19, 0
L_vs1b:
  s_cmp_eq_u32 s36, s32
  s_cbranch_scc1 L_hand
L_vs2:
  s_cmp_lt_u32 s32, s37
  s_cbranch_scc1 L_ks2
  s_sub_u32 s41, s36, s32
  s_add_u32 s32, s32, 1
  s_cmp_gt_u32 s41, 5
  s_cbranch_scc1 L_wait
  s_waitcnt vmcnt(4)
  s_cmp_ge_u32 s41, 5
  s_cbranch_scc1 L_ret2
  s_waitcnt vmcnt(3)
  s_cmp_ge_u32 s41, 4
  s_cbranch_scc1 L_ret2
  s_waitcnt vmcnt(2)
  s_cmp_ge_u32 s41, 3
  s_cbranch_scc1 L_ret2
  s_waitcnt vmcnt(1)
  s_cmp_ge_u32 s41, 2
  s_cbranch_scc1 L_ret2
  s_waitcnt vmcnt(0)
L_ret2:
  s_cmp_eq_u32 s32, s32
  s_setpc_b64 s[62:63]
L_hand:
  v_mov_b32 v3, 0
  s_mov_b32 s70, 0
L_sn_4:
  ds_read_b64 v[18:19], v3 offset:6672
  s_waitcnt lgkmcnt(0)
  v_cmp_gt_u32 vcc, 0x10280, v18
  s_cmp_eq_u64 vcc, 0
  s_cbranch_scc1 L_snd_5
  s_sleep 1
  s_add_u32 s70, s70, 1
  s_cmp_lt_u32 s70, 2097152
  s_cbranch_scc1 L_sn_4
L_snd_5:
  v_add_f32 v21, 0xc2ba0000, v19
  v_cmp_nlt_f32 vcc, v25, v21
  s_lshl_b32 s68, s38, 3
  s_add_u32 s68, s68, s56
  s_andn2_b64 s[70:71], vcc, s[64:65]
  v_mbcnt_lo_u32_b32 v3, s70, 0
  v_mbcnt_hi_u32_b32 v3, s71, v3
  s_bcnt1_i32_b64 s69, s[70:71]
  v_lshl_add_u32 v3, v3, 3, s68
  s_mov_b64 exec, s[70:71]
  ds_write_b64 v3, v[24:25]
  s_mov_b64 exec, -1
  s_or_b64 s[64:65], s[64:65], s[70:71]
  s_add_u32 s38, s38, s69
  v_cmp_nlt_f32 vcc, v27, v21
  s_lshl_b32 s68, s38, 3
  s_add_u32 s68, s68, s56
  s_andn2_b64 s[70:71], vcc, s[66:67]
  v_mbcnt_lo_u32_b32 v3, s70, 0
  v_mbcnt_hi_u32_b32 v3, s71, v3
  s_bcnt1_i32_b64 s69, s[70:71]
  v_lshl_add_u32 v3, v3, 3, s68
  s_mov_b64 exec, s[70:71]
  ds_write_b64 v3, v[26:27]
  s_mov_b64 exec, -1
  s_or_b64 s[66:67], s[66:67], s[70:71]
  s_add_u32 s38, s38, s69
  s_add_u32 s36, s38, 23
  s_lshr_b32 s36, s36, 2
  s_sub_u32 s37, s36, 9
  s_max_i32 s37, s37, 0
  s_mov_b32 s75, s36
  s_add_u32 s68, s38, 3
  s_lshr_b32 s68, s68, 2
  s_sub_u32 s69, s68, s59
  s_mov_b32 s59, s68
  s_add_u32 s35, s35, s69
  s_add_u32 s78, s78, s69
  v_mov_b32 v3, s69
  s_mov_b64 exec, 1
  ds_add_u32 v1, v3 offset:6696
  s_mov_b64 exec, -1
  ds_read_b64 v[28:29], v39 offset:0
  ds_read_b64 v[30:31], v39 offset:512
  ds_read_b64 v[32:33], v39 offset:1024
  s_waitcnt lgkmcnt(0)
  v_sub_f32 v29, v29, v37
  v_sub_f32 v31, v31, v37
  v_sub_f32 v33, v33, v37
  v_mul_f32 v29, 0x3fb8aa3b, v29
  v_mul_f32 v31, 0x3fb8aa3b, v31
  v_mul_f32 v33, 0x3fb8aa3b, v33
  v_exp_f32 v29, v29
  v_exp_f32 v31, v31
  v_exp_f32 v33, v33
  s_nop 0
  v_cvt_pk_bf16_f32 v34, 0, v29
  v_cvt_pk_bf16_f32 v35, 0, v31
  v_cvt_pk_bf16_f32 v36, 0, v33
  v_cvt_pk_bf16_f32 v29, v29, 0
  v_cvt_pk_bf16_f32 v31, v31, 0
  v_cvt_pk_bf16_f32 v33, v33, 0
  s_branch L_vs2
L_work:
  s_cmp_eq_u32 s39, 1
  s_cbranch_scc1 L_w1
  s_cmp_eq_u32 s39, 2
  s_cbranch_scc1 L_w2
  s_cmp_eq_u32 s39, 3
  s_cbranch_scc1 L_w3
  s_cmp_lt_u32 s32, 16
  s_cbranch_scc1 L_wr
L_w0:
  s_load_dwordx16 s[16:31], s[42:43], s40 glc
  s_mov_b32 s39, 1
L_wr:
  s_setpc_b64 s[100:101]
L_w1:
  s_waitcnt lgkmcnt(0)
  s_xor_b32 s68, s17, s74
  s_xor_b32 s69, s19, s74
  s_or_b32 s68, s68, s69
  s_xor_b32 s69, s21, s74
  s_or_b32 s68, s68, s69
  s_xor_b32 s69, s23, s74
  s_or_b32 s68, s68, s69
  s_xor_b32 s69, s25, s74
  s_or_b32 s68, s68, s69
  s_xor_b32 s69, s27, s74
  s_or_b32 s68, s68, s69
  s_xor_b32 s69, s29, s74
  s_or_b32 s68, s68, s69
  s_xor_b32 s69, s31, s74
  s_or_b32 s68, s68, s69
  s_cbranch_scc1 L_w0
  v_mov_b32 v8, s16
  v_mov_b32 v9, s18
  v_mov_b32 v10, s20
  v_mov_b32 v11, s22
  v_mov_b32 v12, s24
  v_mov_b32 v13, s26
  v_mov_b32 v14, s28
  v_mov_b32 v15, s30
  v_lshlrev_b32 v3, 5, s9
  s_mov_b64 exec, 1
  ds_write_b128 v3, v[8:11] offset:6400
  ds_write_b128 v3, v[12:15] offset:6416
  s_mov_b64 exec, -1
  s_mov_b32 s39, 2
L_w2:
  s_cmp_lt_u32 s32, 21
  s_cbranch_scc1 L_wr
  ds_read_b128 v[4:7], v38 offset:6400
  s_waitcnt lgkmcnt(0)
  v_max3_u32 v8, v4, v5, v6
  v_max_u32 v8, v8, v7
  v_cmp_eq_u32 vcc, -1, v8
  s_cmp_lg_u64 vcc, 0
  s_cbranch_scc1 L_wr
  v_dot2_f32_bf16 v8, v40, v4, 0
  v_dot2_f32_bf16 v9, v44, v4, 0
  v_dot2_f32_bf16 v10, v48, v4, 0
  v_dot2_f32_bf16 v11, v52, v4, 0
  v_dot2_f32_bf16 v12, v56, v4, 0
  v_dot2_f32_bf16 v13, v60, v4, 0
  v_dot2_f32_bf16 v14, v64, v4, 0
  v_dot2_f32_bf16 v15, v68, v4, 0
  v_dot2_f32_bf16 v8, v41, v5, v8
  v_dot2_f32_bf16 v9, v45, v5, v9
  v_dot2_f32_bf16 v10, v49, v5, v10
  v_dot2_f32_bf16 v11, v53, v5, v11
  v_dot2_f32_bf16 v12, v57, v5, v12
  v_dot2_f32_bf16 v13, v61, v5, v13
  v_dot2_f32_bf16 v14, v65, v5, v14
  v_dot2_f32_bf16 v15, v69, v5, v15
  v_dot2_f32_bf16 v8, v42, v6, v8
  v_dot2_f32_bf16 v9, v46, v6, v9
  v_dot2_f32_bf16 v10, v50, v6, v10
  v_dot2_f32_bf16 v11, v54, v6, v11
  v_dot2_f32_bf16 v12, v58, v6, v12
  v_dot2_f32_bf16 v13, v62, v6, v13
  v_dot2_f32_bf16 v14, v66, v6, v14
  v_dot2_f32_bf16 v15, v70, v6, v15
  v_dot2_f32_bf16 v8, v43, v7, v8
  v_dot2_f32_bf16 v9, v47, v7, v9
  v_dot2_f32_bf16 v10, v51, v7, v10
  v_dot2_f32_bf16 v11, v55, v7, v11
  v_dot2_f32_bf16 v12, v59, v7, v12
  v_dot2_f32_bf16 v13, v63, v7, v13
  v_dot2_f32_bf16 v14, v67, v7, v14
  v_dot2_f32_bf16 v15, v71, v7, v15
  v_add_f32_dpp v8, v8, v8 row_ror:8 row_mask:0xf bank_mask:0x3
  v_add_f32_dpp v8, v9, v9 row_ror:8 row_mask:0xf bank_mask:0xc
  v_add_f32_dpp v10, v10, v10 row_ror:8 row_mask:0xf bank_mask:0x3
  v_add_f32_dpp v10, v11, v11 row_ror:8 row_mask:0xf bank_mask:0xc
  v_add_f32_dpp v12, v12, v12 row_ror:8 row_mask:0xf bank_mask:0x3
  v_add_f32_dpp v12, v13, v13 row_ror:8 row_mask:0xf bank_mask:0xc
  v_add_f32_dpp v14, v14, v14 row_ror:8 row_mask:0xf bank_mask:0x3
  v_add_f32_dpp v14, v15, v15 row_ror:8 row_mask:0xf bank_mask:0xc
  v_add_f32_dpp v16, v8, v8 row_shl:4 row_mask:0xf bank_mask:0x5
  v_add_f32_dpp v16, v10, v10 row_shr:4 row_mask:0xf bank_mask:0xa
  v_add_f32_dpp v17, v12, v12 row_shl:4 row_mask:0xf bank_mask:0x5
  v_add_f32_dpp v17, v14, v14 row_shr:4 row_mask:0xf bank_mask:0xa
  v_dot2_f32_bf16 v8, v72, v4, 0
  v_dot2_f32_bf16 v9, v76, v4, 0
  v_dot2_f32_bf16 v10, v80, v4, 0
  v_dot2_f32_bf16 v11, v84, v4, 0
  v_dot2_f32_bf16 v12, v88, v4, 0
  v_dot2_f32_bf16 v13, v92, v4, 0
  v_dot2_f32_bf16 v14, v96, v4, 0
  v_dot2_f32_bf16 v15, v100, v4, 0
  v_dot2_f32_bf16 v8, v73, v5, v8
  v_dot2_f32_bf16 v9, v77, v5, v9
  v_dot2_f32_bf16 v10, v81, v5, v10
  v_dot2_f32_bf16 v11, v85, v5, v11
  v_dot2_f32_bf16 v12, v89, v5, v12
  v_dot2_f32_bf16 v13, v93, v5, v13
  v_dot2_f32_bf16 v14, v97, v5, v14
  v_dot2_f32_bf16 v15, v101, v5, v15
  v_dot2_f32_bf16 v8, v74, v6, v8
  v_dot2_f32_bf16 v9, v78, v6, v9
  v_dot2_f32_bf16 v10, v82, v6, v10
  v_dot2_f32_bf16 v11, v86, v6, v11
  v_dot2_f32_bf16 v12, v90, v6, v12
  v_dot2_f32_bf16 v13, v94, v6, v13
  v_dot2_f32_bf16 v14, v98, v6, v14
  v_dot2_f32_bf16 v15, v102, v6, v15
  v_dot2_f32_bf16 v8, v75, v7, v8
  v_dot2_f32_bf16 v9, v79, v7, v9
  v_dot2_f32_bf16 v10, v83, v7, v10
  v_dot2_f32_bf16 v11, v87, v7, v11
  v_dot2_f32_bf16 v12, v91, v7, v12
  v_dot2_f32_bf16 v13, v95, v7, v13
  v_dot2_f32_bf16 v14, v99, v7, v14
  v_dot2_f32_bf16 v15, v103, v7, v15
  v_add_f32_dpp v8, v8, v8 row_ror:8 row_mask:0xf bank_mask:0x3
  v_add_f32_dpp v8, v9, v9 row_ror:8 row_mask:0xf bank_mask:0xc
  v_add_f32_dpp v10, v10, v10 row_ror:8 row_mask:0xf bank_mask:0x3
  v_add_f32_dpp v10, v11, v11 row_ror:8 row_mask:0xf bank_mask:0xc
  v_add_f32_dpp v12, v12, v12 row_ror:8 row_mask:0xf bank_mask:0x3
  v_add_f32_dpp v12, v13, v13 row_ror:8 row_mask:0xf bank_mask:0xc
  v_add_f32_dpp v14, v14, v14 row_ror:8 row_mask:0xf bank_mask:0x3
  v_add_f32_dpp v14, v15, v15 row_ror:8 row_mask:0xf bank_mask:0xc
  v_add_f32_dpp v18, v8, v8 row_shl:4 row_mask:0xf bank_mask:0x5
  v_add_f32_dpp v18, v10, v10 row_shr:4 row_mask:0xf bank_mask:0xa
  v_add_f32_dpp v19, v12, v12 row_shl:4 row_mask:0xf bank_mask:0x5
  v_add_f32_dpp v19, v14, v14 row_shr:4 row_mask:0xf bank_mask:0xa
  v_mov_b32 v3, 0
  v_mov_b32 v20, 64
  v_add_f32_dpp v16, v16, v16 quad_perm:[2,3,0,1] row_mask:0xf bank_mask:0xf
  v_add_f32_dpp v17, v17, v17 quad_perm:[2,3,0,1] row_mask:0xf bank_mask:0xf
  v_add_f32_dpp v18, v18, v18 quad_perm:[2,3,0,1] row_mask:0xf bank_mask:0xf
  v_add_f32_dpp v19, v19, v19 quad_perm:[2,3,0,1] row_mask:0xf bank_mask:0xf
  v_cndmask_b32 v8, v16, v17, s[52:53]
  v_cndmask_b32 v9, v18, v19, s[52:53]
  s_nop 0
  v_lshlrev_b32 v21, 3, s9
  v_add_f32_dpp v8, v8, v8 quad_perm:[1,0,3,2] row_mask:0xf bank_mask:0xf
  v_add_f32_dpp v9, v9, v9 quad_perm:[1,0,3,2] row_mask:0xf bank_mask:0xf
  v_cndmask_b32 v25, v8, v9, s[54:55]
  v_cvt_pk_bf16_f32 v25, 0, v25
  v_mul_f32 v25, 0x3db504f3, v25
  v_cvt_pk_bf16_f32 v25, 0, v25
  v_mov_b32 v37, v25
  s_nop 1
  v_max_f32_dpp v37, v37, v37 row_ror:8 row_mask:0xf bank_mask:0xf
  s_nop 1
  v_max_f32_dpp v37, v37, v37 row_ror:4 row_mask:0xf bank_mask:0xf
  s_nop 1
  v_max_f32_dpp v37, v37, v37 row_ror:2 row_mask:0xf bank_mask:0xf
  s_nop 1
  v_max_f32_dpp v37, v37, v37 row_ror:1 row_mask:0xf bank_mask:0xf
  v_mov_b32 v8, v37
  s_nop 1
  v_permlane16_swap_b32 v8, v37
  v_max_f32 v37, v37, v8
  v_mov_b32 v8, v37
  s_nop 1
  v_permlane32_swap_b32 v8, v37
  v_max_f32 v37, v37, v8
  s_mov_b64 exec, 1
  ds_max_f32 v3, v37 offset:6684
  ds_add_u32 v3, v20 offset:6680
  s_mov_b64 exec, -1
  s_mov_b32 s39, 3
  s_mov_b32 s19, 0
  s_setpc_b64 s[100:101]
L_w3:
  v_mov_b32 v3, 0
  ds_read_b64 v[18:19], v3 offset:6680
  s_waitcnt lgkmcnt(0)
  v_cmp_gt_u32 vcc, 0x10280, v18
  s_cmp_lg_u64 vcc, 0
  s_cbranch_scc1 L_wr
  ds_read_b96 v[16:18], v3 offset:6736
  s_waitcnt lgkmcnt(0)
  v_max_f32 v2, v19, v18
  v_med3_f32 v21, v19, v16, v17
  v_add_f32 v21, 0xc1c00000, v21
  v_cmp_nlt_f32 vcc, v25, v21
  v_readfirstlane_b32 s22, v21
  v_add_f32 v21, 0xc2ac0000, v2
  s_bcnt1_i32_b64 s68, vcc
  s_cmp_gt_u32 s68, 32
  s_cselect_b32 s21, 1, 0
  s_cselect_b64 s[16:17], 0, vcc
  s_mov_b64 s[64:65], s[16:17]
  v_cmp_nlt_f32 vcc, v25, v21
  s_lshl_b32 s68, s38, 3
  s_add_u32 s68, s68, s56
  s_andn2_b64 s[70:71], vcc, s[64:65]
  v_mbcnt_lo_u32_b32 v3, s70, 0
  v_mbcnt_hi_u32_b32 v3, s71, v3
  s_bcnt1_i32_b64 s69, s[70:71]
  v_lshl_add_u32 v3, v3, 3, s68
  s_mov_b64 exec, s[70:71]
  ds_write_b64 v3, v[24:25]
  s_mov_b64 exec, -1
  s_or_b64 s[64:65], s[64:65], s[70:71]
  s_add_u32 s38, s38, s69
  s_andn2_b64 s[64:65], s[64:65], s[16:17]
  s_add_u32 s68, s38, 4
  s_lshr_b32 s68, s68, 1
  s_sub_u32 s69, s68, s59
  s_mov_b32 s59, s68
  v_mov_b32 v3, s69
  s_mov_b64 exec, 1
  ds_add_u32 v1, v3 offset:6696
  s_mov_b64 exec, -1
  s_mov_b32 s39, 4
  ds_read_b64 v[28:29], v39 offset:0
  s_waitcnt lgkmcnt(0)
  s_setpc_b64 s[100:101]
L_helper:
  s_bfe_u32 s61, s2, 0x30003
  s_lshl_b32 s48, s8, 3
  s_add_u32 s61, s61, s48
  s_cmp_lt_u32 s2, 144
  s_cselect_b32 s48, 3, 4
  s_lshr_b32 s48, s2, s48
  s_and_b32 s48, s48, 1
  s_lshl_b32 s49, s48, 1
  s_add_u32 s50, s2, 3
  s_sub_u32 s50, s50, s49
  s_and_b32 s50, s50, 7
  s_lshl_b32 s48, s48, 3
  s_or_b32 s50, s50, s48
  s_cmp_lt_u32 s2, 128
  s_cselect_b32 s61, s61, s50
  v_mov_b32 v4, -1
  v_mov_b32 v5, -1
  v_mov_b32 v6, -1
  v_mov_b32 v7, -1
  v_mov_b32 v8, 0xff800000
  v_mov_b32 v9, 0
  v_mov_b32 v10, 0xff800000
  v_lshlrev_b32 v2, 3, v1
  ds_write_b64 v2, v[8:9] offset:6912
  v_lshlrev_b32 v2, 2, v1
  ds_write_b32 v2, v4 offset:6400
  v_mov_b32 v38, 0
  v_mov_b32 v39, 0xff800000
  ds_write_b128 v38, v[4:7] offset:6656
  ds_write_b32 v38, v38 offset:6720
  v_mov_b32 v8, 128
  v_mov_b32 v9, v39
  v_mov_b32 v10, v8
  v_mov_b32 v11, v39
  ds_write_b128 v38, v[8:11] offset:6672
  v_mov_b32 v8, 1248
  v_mov_b32 v9, 0
  v_mov_b32 v10, 1024
  v_mov_b32 v11, -256
  ds_write_b128 v38, v[8:11] offset:6688
  v_mov_b32 v8, 0
  v_mov_b32 v9, 0
  v_mov_b32 v10, 0
  v_mov_b32 v11, 0
  v_lshlrev_b32 v2, 3, v0
  ds_write_b64 v2, v[8:9] offset:11008
  ds_write_b64 v2, v[8:9] offset:16128
  v_mov_b32 v8, 2
  v_mov_b32 v9, 2
  ds_write_b128 v38, v[8:11] offset:6704
  s_mov_b32 s77, 4
  s_getreg_b32 s76, hwreg(HW_REG_XCC_ID, 0, 4)
  v_lshrrev_b32 v12, 3, v0
  v_lshlrev_b32 v12, 5, v12
  v_bfe_u32 v3, v1, 2, 1
  v_lshl_add_u32 v12, v3, 10, v12
  v_and_b32 v8, 3, v1
  v_lshl_add_u32 v13, v8, 3, v12
  v_and_b32 v12, 0xffffffdf, v12
  v_lshl_add_u32 v12, v8, 4, v12
  v_bfe_u32 v8, v1, 3, 1
  v_lshl_add_u32 v12, v8, 3, v12
  v_lshl_add_u32 v12, v3, 5, v12
  s_lshl_b32 s48, s61, 7
  s_lshl_b32 s49, s5, 7
  s_add_u32 s49, s49, 64
  v_add_u32 v8, s49, v1
  s_waitcnt lgkmcnt(0)
  s_load_dword s74, s[42:43], 0
  s_cmp_eq_u32 s13, 2
  s_cbranch_scc1 L_r_q
  s_cmp_eq_u32 s13, 1
  s_cbranch_scc1 L_r_moda
  s_load_dwordx2 s[14:15], s[56:57], s3
  s_barrier
  s_waitcnt lgkmcnt(0)
  s_and_b32 s13, s14, 7
  s_bfe_u32 s61, s14, 0x80008
  s_cmp_eq_u32 s13, 1
  s_cbranch_scc1 L_r_wo
  s_cmp_eq_u32 s13, 4
  s_cbranch_scc1 L_r_modb
  s_cmp_eq_u32 s13, 2
  s_cbranch_scc1 L_r_f1
  s_cmp_eq_u32 s13, 3
  s_cbranch_scc1 L_r_f2
  s_branch L_r_none
L_r_moda:
  s_lshl_b32 s48, s61, 7
  s_lshl_b32 s58, s61, 9
  s_add_u32 s58, s58, 4096
  s_mov_b32 s44, s36
  s_mov_b32 s45, s37
  s_mov_b32 s46, 3145728
  s_mov_b32 s47, 0x20000
  global_load_dwordx2 v[14:15], v13, s[34:35]
  v_lshrrev_b32 v2, 3, v1
  v_and_b32 v3, 6, v2
  v_xor_b32 v3, v3, v1
  v_mul_u32_u24 v2, 6144, v2
  v_and_b32 v3, 7, v3
  v_lshl_add_u32 v2, v3, 4, v2
  s_mul_i32 s49, s5, 786432
  s_lshl_b32 s50, s5, 14
  s_add_u32 s49, s49, s48
  s_add_u32 s50, s50, 18432
  s_add_u32 s51, s50, 16384
L_dma_6:
  s_mov_b32 m0, s50
  s_add_u32 s50, s50, 1024
  buffer_load_dwordx4 v2, s[44:47], s49 offen nt lds
  s_add_u32 s49, s49, 49152
  s_cmp_lt_u32 s50, s51
  s_cbranch_scc1 L_dma_6
L_dmae_7:
  s_barrier
  s_waitcnt lgkmcnt(0)
  s_mul_i32 s74, s74, 0x9e3779b1
  s_add_u32 s74, s74, 0x7f4a7c15
  s_add_u32 s76, s76, s74
  s_waitcnt vmcnt(16)
  v_lshlrev_b32 v16, 16, v14
  v_and_b32 v17, s73, v14
  v_lshlrev_b32 v18, 16, v15
  v_and_b32 v19, s73, v15
  v_mul_f32 v20, 0xbfb8aa3b, v16
  v_mul_f32 v21, 0xbfb8aa3b, v17
  v_mul_f32 v22, 0xbfb8aa3b, v18
  v_mul_f32 v23, 0xbfb8aa3b, v19
  v_exp_f32 v20, v20
  v_exp_f32 v21, v21
  v_exp_f32 v22, v22
  v_exp_f32 v23, v23
  s_nop 0
  v_add_f32 v20, 1.0, v20
  v_add_f32 v21, 1.0, v21
  v_add_f32 v22, 1.0, v22
  v_add_f32 v23, 1.0, v23
  v_rcp_f32 v20, v20
  v_rcp_f32 v21, v21
  v_rcp_f32 v22, v22
  v_rcp_f32 v23, v23
  s_nop 0
  v_mul_f32 v16, v16, v20
  v_mul_f32 v17, v17, v21
  v_mul_f32 v18, v18, v22
  v_mul_f32 v19, v19, v23
  v_cvt_pk_bf16_f32 v14, v16, v17
  v_cvt_pk_bf16_f32 v15, v18, v19
  ds_write_b64 v12, v[14:15] offset:0
  v_and_b32 v13, 1, v1
  v_lshlrev_b32 v13, 6, v13
  v_lshrrev_b32 v3, 4, v1
  v_lshl_add_u32 v13, v3, 4, v13
  s_lshl_b32 s49, s5, 7
  s_add_u32 s49, s49, s58
  v_add_u32 v13, s49, v13
  v_bfe_u32 v3, v1, 1, 3
  v_lshl_add_u32 v13, v3, 13, v13
  v_add_u32 v13, 913408, v13
  v_and_b32 v14, 1, v1
  v_mul_u32_u24 v14, 1056, v14
  v_lshrrev_b32 v3, 4, v1
  v_lshl_add_u32 v14, v3, 4, v14
  v_lshrrev_b32 v2, 2, v1
  v_bfe_u32 v3, v1, 1, 1
  s_lshl_b32 s49, s5, 1
  v_or_b32 v3, s49, v3
  v_and_b32 v10, 6, v2
  v_xor_b32 v3, v3, v10
  v_lshlrev_b32 v2, 7, v2
  v_lshl_add_u32 v2, v3, 4, v2
  v_and_b32 v3, 1, v1
  v_lshl_add_u32 v2, v3, 3, v2
  v_add_u32 v2, 18432, v2
  s_waitcnt vmcnt(0) lgkmcnt(0)
  v_mov_b32 v9, 1
  s_mov_b64 exec, 1
  ds_add_u32 v38, v9 offset:6720
  s_mov_b64 exec, -1
  s_mov_b32 s70, 0
L_sn_8:
  ds_read_b32 v9, v38 offset:6720
  s_waitcnt lgkmcnt(0)
  v_cmp_gt_u32 vcc, 0x4, v9
  s_cmp_eq_u64 vcc, 0
  s_cbranch_scc1 L_snd_9
  s_add_u32 s70, s70, 1
  s_cmp_lt_u32 s70, 2097152
  s_cbranch_scc1 L_sn_8
L_snd_9:
  ds_read_b64_tr_b16 v[40:41], v2 offset:0
  ds_read_b64_tr_b16 v[42:43], v2 offset:2048
  ds_read_b128 v[104:107], v14 offset:0
  ds_read_b64_tr_b16 v[44:45], v2 offset:4096
  ds_read_b64_tr_b16 v[46:47], v2 offset:6144
  ds_read_b128 v[108:111], v14 offset:64
  ds_read_b64_tr_b16 v[48:49], v2 offset:8192
  ds_read_b64_tr_b16 v[50:51], v2 offset:10240
  ds_read_b128 v[112:115], v14 offset:128
  ds_read_b64_tr_b16 v[52:53], v2 offset:12288
  ds_read_b64_tr_b16 v[54:55], v2 offset:14336
  ds_read_b128 v[116:119], v14 offset:192
  ds_read_b64_tr_b16 v[56:57], v2 offset:16384
  ds_read_b64_tr_b16 v[58:59], v2 offset:18432
  ds_read_b128 v[120:123], v14 offset:256
  s_waitcnt lgkmcnt(12)
  v_mfma_f32_16x16x32_bf16 v[8:11], v[40:43], v[104:107], 0
  ds_read_b64_tr_b16 v[60:61], v2 offset:20480
  ds_read_b64_tr_b16 v[62:63], v2 offset:22528
  ds_read_b128 v[124:127], v14 offset:320
  s_waitcnt lgkmcnt(12)
  v_mfma_f32_16x16x32_bf16 v[8:11], v[44:47], v[108:111], v[8:11]
  ds_read_b64_tr_b16 v[64:65], v2 offset:24576
  ds_read_b64_tr_b16 v[66:67], v2 offset:26624
  ds_read_b128 v[128:131], v14 offset:384
  s_waitcnt lgkmcnt(12)
  v_mfma_f32_16x16x32_bf16 v[8:11], v[48:51], v[112:115], v[8:11]
  ds_read_b64_tr_b16 v[68:69], v2 offset:28672
  ds_read_b64_tr_b16 v[70:71], v2 offset:30720
  ds_read_b128 v[132:135], v14 offset:448
  s_waitcnt lgkmcnt(12)
  v_mfma_f32_16x16x32_bf16 v[8:11], v[52:55], v[116:119], v[8:11]
  ds_read_b64_tr_b16 v[72:73], v2 offset:32768
  ds_read_b64_tr_b16 v[74:75], v2 offset:34816
  ds_read_b128 v[136:139], v14 offset:512
  s_waitcnt lgkmcnt(12)
  v_mfma_f32_16x16x32_bf16 v[8:11], v[56:59], v[120:123], v[8:11]
  ds_read_b64_tr_b16 v[76:77], v2 offset:36864
  ds_read_b64_tr_b16 v[78:79], v2 offset:38912
  ds_read_b128 v[140:143], v14 offset:576
  s_waitcnt lgkmcnt(12)
  v_mfma_f32_16x16x32_bf16 v[8:11], v[60:63], v[124:127], v[8:11]
  ds_read_b64_tr_b16 v[80:81], v2 offset:40960
  ds_read_b64_tr_b16 v[82:83], v2 offset:43008
  ds_read_b128 v[144:147], v14 offset:640
  s_waitcnt lgkmcnt(12)
  v_mfma_f32_16x16x32_bf16 v[8:11], v[64:67], v[128:131], v[8:11]
  ds_read_b64_tr_b16 v[84:85], v2 offset:45056
  ds_read_b64_tr_b16 v[86:87], v2 offset:47104
  ds_read_b128 v[148:151], v14 offset:704
  s_waitcnt lgkmcnt(12)
  v_mfma_f32_16x16x32_bf16 v[8:11], v[68:71], v[132:135], v[8:11]
  ds_read_b64_tr_b16 v[88:89], v2 offset:49152
  ds_read_b64_tr_b16 v[90:91], v2 offset:51200
  ds_read_b128 v[152:155], v14 offset:768
  s_waitcnt lgkmcnt(12)
  v_mfma_f32_16x16x32_bf16 v[8:11], v[72:75], v[136:139], v[8:11]
  ds_read_b64_tr_b16 v[92:93], v2 offset:53248
  ds_read_b64_tr_b16 v[94:95], v2 offset:55296
  ds_read_b128 v[156:159], v14 offset:832
  s_waitcnt lgkmcnt(12)
  v_mfma_f32_16x16x32_bf16 v[8:11], v[76:79], v[140:143], v[8:11]
  ds_read_b64_tr_b16 v[96:97], v2 offset:57344
  ds_read_b64_tr_b16 v[98:99], v2 offset:59392
  ds_read_b128 v[160:163], v14 offset:896
  s_waitcnt lgkmcnt(12)
  v_mfma_f32_16x16x32_bf16 v[8:11], v[80:83], v[144:147], v[8:11]
  ds_read_b64_tr_b16 v[100:101], v2 offset:61440
  ds_read_b64_tr_b16 v[102:103], v2 offset:63488
  ds_read_b128 v[164:167], v14 offset:960
  s_waitcnt lgkmcnt(12)
  v_mfma_f32_16x16x32_bf16 v[8:11], v[84:87], v[148:151], v[8:11]
  s_waitcnt lgkmcnt(9)
  v_mfma_f32_16x16x32_bf16 v[8:11], v[88:91], v[152:155], v[8:11]
  s_waitcnt lgkmcnt(6)
  v_mfma_f32_16x16x32_bf16 v[8:11], v[92:95], v[156:159], v[8:11]
  s_waitcnt lgkmcnt(3)
  v_mfma_f32_16x16x32_bf16 v[8:11], v[96:99], v[160:163], v[8:11]
  s_waitcnt lgkmcnt(0)
  v_mfma_f32_16x16x32_bf16 v[8:11], v[100:103], v[164:167], v[8:11]
  s_nop 7
  v_cvt_pk_bf16_f32 v8, v8, v9
  v_cvt_pk_bf16_f32 v10, v10, v11
  v_mov_b32 v9, s74
  v_mov_b32 v11, s74
  s_mov_b32 exec_lo, 0xffffffff
  s_mov_b32 exec_hi, exec_lo
  global_store_dwordx4 v13, v[8:11], s[42:43] sc1
  s_mov_b64 exec, -1
  ds_write_b32 v38, v38 offset:6660
  s_mov_b32 s60, 0
  s_branch L_svc
L_r_q:
  s_lshl_b32 s58, s61, 8
  s_add_u32 s58, s58, 32768
  global_load_dwordx2 v[14:15], v13, s[16:17]
  s_mov_b32 s44, s22
  s_mov_b32 s45, s23
  s_mov_b32 s46, 4194304
  s_mov_b32 s47, 0x20000
  v_lshrrev_b32 v2, 3, v1
  v_and_b32 v3, 6, v2
  v_xor_b32 v3, v3, v1
  v_mul_u32_u24 v2, 8192, v2
  v_and_b32 v3, 7, v3
  v_lshl_add_u32 v2, v3, 4, v2
  s_mul_i32 s49, s5, 1048576
  s_lshl_b32 s50, s5, 14
  s_add_u32 s49, s49, s48
  s_add_u32 s50, s50, 18432
  s_add_u32 s51, s50, 16384
L_dma_10:
  s_mov_b32 m0, s50
  s_add_u32 s50, s50, 1024
  buffer_load_dwordx4 v2, s[44:47], s49 offen nt lds
  s_add_u32 s49, s49, 65536
  s_cmp_lt_u32 s50, s51
  s_cbranch_scc1 L_dma_10
L_dmae_11:
  s_barrier
  s_waitcnt lgkmcnt(0)
  s_mul_i32 s74, s74, 0x9e3779b1
  s_add_u32 s74, s74, 0x7f4a7c15
  s_add_u32 s76, s76, s74
  s_waitcnt vmcnt(16)
  v_bfe_u32 v6, v1, 2, 1
  v_lshlrev_b32 v6, 5, v6
  v_add_u32 v6, 7424, v6
  s_lshl_b32 s49, s5, 3
  v_add_u32 v5, s49, v6
  v_lshlrev_b32 v20, 16, v14
  v_and_b32 v21, s73, v14
  v_lshlrev_b32 v22, 16, v15
  v_and_b32 v23, s73, v15
  v_add_f32 v8, v20, v21
  v_mul_f32 v9, v20, v20
  v_add_f32 v10, v22, v23
  v_mul_f32 v11, v22, v22
  v_fmac_f32 v9, v21, v21
  v_fmac_f32 v11, v23, v23
  v_add_f32 v8, v8, v10
  v_add_f32 v9, v9, v11
  s_nop 0
  v_add_f32_dpp v8, v8, v8 quad_perm:[1,0,3,2] row_mask:0xf bank_mask:0xf
  v_add_f32_dpp v9, v9, v9 quad_perm:[1,0,3,2] row_mask:0xf bank_mask:0xf
  s_nop 0
  v_add_f32_dpp v8, v8, v8 quad_perm:[2,3,0,1] row_mask:0xf bank_mask:0xf
  v_add_f32_dpp v9, v9, v9 quad_perm:[2,3,0,1] row_mask:0xf bank_mask:0xf
  s_nop 0
  v_add_f32_dpp v8, v8, v8 row_ror:8 row_mask:0xf bank_mask:0xf
  v_add_f32_dpp v9, v9, v9 row_ror:8 row_mask:0xf bank_mask:0xf
  s_nop 0
  v_mov_b32 v10, v8
  v_mov_b32 v11, v9
  s_nop 0
  v_permlane16_swap_b32 v10, v8
  v_permlane16_swap_b32 v11, v9
  v_add_f32 v8, v8, v10
  v_add_f32 v9, v9, v11
  v_mov_b32 v10, v8
  v_mov_b32 v11, v9
  s_nop 0
  v_permlane32_swap_b32 v10, v8
  v_permlane32_swap_b32 v11, v9
  v_add_f32 v8, v8, v10
  v_add_f32 v9, v9, v11
  ds_write_b64 v5, v[8:9]
  s_waitcnt vmcnt(0) lgkmcnt(0)
  v_mov_b32 v9, 1
  s_mov_b64 exec, 1
  ds_add_u32 v38, v9 offset:6720
  s_mov_b64 exec, -1
  s_mov_b32 s70, 0
L_sn_12:
  ds_read_b32 v9, v38 offset:6720
  s_waitcnt lgkmcnt(0)
  v_cmp_gt_u32 vcc, 0x4, v9
  s_cmp_eq_u64 vcc, 0
  s_cbranch_scc1 L_snd_13
  s_sleep 1
  s_add_u32 s70, s70, 1
  s_cmp_lt_u32 s70, 2097152
  s_cbranch_scc1 L_sn_12
L_snd_13:
  ds_read_b128 v[24:27], v6
  ds_read_b128 v[28:31], v6 offset:16
  s_waitcnt lgkmcnt(0)
  v_pk_add_f32 v[24:25], v[24:25], v[26:27]
  v_pk_add_f32 v[28:29], v[28:29], v[30:31]
  v_pk_add_f32 v[24:25], v[24:25], v[28:29]
  v_mul_f32 v8, 0x3b000000, v24
  v_mul_f32 v9, 0x3b000000, v25
  v_fma_f32 v9, -v8, v8, v9
  v_cvt_pk_bf16_f32 v8, 0, v8
  v_max_f32 v9, 0, v9
  v_cvt_pk_bf16_f32 v9, 0, v9
  v_sub_f32 v20, v20, v8
  v_sub_f32 v21, v21, v8
  v_add_f32 v9, 0x3727c5ac, v9
  v_sub_f32 v22, v22, v8
  v_sub_f32 v23, v23, v8
  v_cvt_pk_bf16_f32 v9, 0, v9
  v_cvt_pk_bf16_f32 v20, 0, v20
  v_sqrt_f32 v9, v9
  v_cvt_pk_bf16_f32 v21, 0, v21
  v_cvt_pk_bf16_f32 v9, 0, v9
  v_cvt_pk_bf16_f32 v22, 0, v22
  v_rcp_f32 v9, v9
  v_cvt_pk_bf16_f32 v23, 0, v23
  v_mul_f32 v20, v20, v9
  v_mul_f32 v21, v21, v9
  v_mul_f32 v22, v22, v9
  v_mul_f32 v23, v23, v9
  v_cvt_pk_bf16_f32 v20, 0, v20
  v_cvt_pk_bf16_f32 v21, 0, v21
  v_cvt_pk_bf16_f32 v22, 0, v22
  v_cvt_pk_bf16_f32 v23, 0, v23
  v_lshlrev_b32 v15, 4, v0
  s_and_b32 s49, s2, 7
  s_lshl_b32 s49, s49, 13
  s_add_u32 s49, s49, 917504
  v_add_u32 v15, s49, v15
  v_add_u32 v36, 0x1000, v15
  s_mov_b64 s[64:65], -1
  s_mov_b64 s[66:67], -1
  s_mov_b64 exec, s[64:65]
  global_load_dwordx4 v[16:19], v15, s[42:43] sc1
  s_mov_b64 exec, s[66:67]
  global_load_dwordx4 v[32:35], v36, s[42:43] sc1
  s_mov_b64 exec, -1
  v_lshrrev_b32 v2, 2, v1
  v_bfe_u32 v3, v1, 1, 1
  s_lshl_b32 s49, s5, 1
  v_or_b32 v3, s49, v3
  v_and_b32 v10, 6, v2
  v_xor_b32 v3, v3, v10
  v_lshlrev_b32 v2, 7, v2
  v_lshl_add_u32 v2, v3, 4, v2
  v_and_b32 v3, 1, v1
  v_lshl_add_u32 v2, v3, 3, v2
  v_add_u32 v2, 18432, v2
  ds_read_b64_tr_b16 v[40:41], v2 offset:0
  ds_read_b64_tr_b16 v[42:43], v2 offset:2048
  ds_read_b64_tr_b16 v[44:45], v2 offset:4096
  ds_read_b64_tr_b16 v[46:47], v2 offset:6144
  ds_read_b64_tr_b16 v[48:49], v2 offset:8192
  ds_read_b64_tr_b16 v[50:51], v2 offset:10240
  ds_read_b64_tr_b16 v[52:53], v2 offset:12288
  ds_read_b64_tr_b16 v[54:55], v2 offset:14336
  ds_read_b64_tr_b16 v[56:57], v2 offset:16384
  ds_read_b64_tr_b16 v[58:59], v2 offset:18432
  ds_read_b64_tr_b16 v[60:61], v2 offset:20480
  ds_read_b64_tr_b16 v[62:63], v2 offset:22528
  s_waitcnt lgkmcnt(10)
  ds_read_b64_tr_b16 v[64:65], v2 offset:24576
  ds_read_b64_tr_b16 v[66:67], v2 offset:26624
  s_waitcnt lgkmcnt(10)
  ds_read_b64_tr_b16 v[68:69], v2 offset:28672
  ds_read_b64_tr_b16 v[70:71], v2 offset:30720
  s_waitcnt lgkmcnt(10)
  ds_read_b64_tr_b16 v[72:73], v2 offset:32768
  ds_read_b64_tr_b16 v[74:75], v2 offset:34816
  s_waitcnt lgkmcnt(10)
  ds_read_b64_tr_b16 v[76:77], v2 offset:36864
  ds_read_b64_tr_b16 v[78:79], v2 offset:38912
  s_waitcnt lgkmcnt(10)
  ds_read_b64_tr_b16 v[80:81], v2 offset:40960
  ds_read_b64_tr_b16 v[82:83], v2 offset:43008
  s_waitcnt lgkmcnt(10)
  ds_read_b64_tr_b16 v[84:85], v2 offset:45056
  ds_read_b64_tr_b16 v[86:87], v2 offset:47104
  s_waitcnt lgkmcnt(10)
  ds_read_b64_tr_b16 v[88:89], v2 offset:49152
  ds_read_b64_tr_b16 v[90:91], v2 offset:51200
  s_waitcnt lgkmcnt(10)
  ds_read_b64_tr_b16 v[92:93], v2 offset:53248
  ds_read_b64_tr_b16 v[94:95], v2 offset:55296
  s_waitcnt lgkmcnt(10)
  ds_read_b64_tr_b16 v[96:97], v2 offset:57344
  ds_read_b64_tr_b16 v[98:99], v2 offset:59392
  s_waitcnt lgkmcnt(10)
  ds_read_b64_tr_b16 v[100:101], v2 offset:61440
  ds_read_b64_tr_b16 v[102:103], v2 offset:63488
  s_waitcnt lgkmcnt(10)
  s_waitcnt lgkmcnt(0)
  v_and_b32 v13, 1, v1
  v_lshlrev_b32 v13, 14, v13
  v_lshrrev_b32 v3, 4, v1
  v_lshl_add_u32 v13, v3, 4, v13
  s_lshl_b32 s49, s5, 6
  s_add_u32 s49, s49, s58
  v_add_u32 v13, s49, v13
  v_and_b32 v14, 1, v1
  v_mul_u32_u24 v14, 1056, v14
  v_lshrrev_b32 v3, 4, v1
  v_lshl_add_u32 v14, v3, 4, v14
  s_mov_b32 s70, 0
  s_branch L_q_c
L_q_p:
  s_mov_b64 exec, s[64:65]
  global_load_dwordx4 v[16:19], v15, s[42:43] sc1
  s_mov_b64 exec, s[66:67]
  global_load_dwordx4 v[32:35], v36, s[42:43] sc1
  s_mov_b64 exec, -1
L_q_c:
  s_waitcnt vmcnt(0)
  v_cmp_ne_u32 s[64:65], s74, v17
  v_cmp_ne_u32 s[68:69], s74, v19
  s_or_b64 s[64:65], s[64:65], s[68:69]
  v_cmp_ne_u32 s[66:67], s74, v33
  v_cmp_ne_u32 s[68:69], s74, v35
  s_or_b64 s[66:67], s[66:67], s[68:69]
  s_or_b64 vcc, s[64:65], s[66:67]
  s_cmp_eq_u64 vcc, 0
  s_cbranch_scc1 L_q_ok
  s_add_u32 s70, s70, 1
  s_cmp_lt_u32 s70, 262144
  s_cbranch_scc1 L_q_p
L_q_ok:
  v_lshlrev_b32 v28, 16, v32
  v_and_b32 v29, s73, v32
  v_lshlrev_b32 v30, 16, v34
  v_and_b32 v31, s73, v34
  v_lshlrev_b32 v24, 16, v16
  v_and_b32 v25, s73, v16
  v_lshlrev_b32 v26, 16, v18
  v_and_b32 v27, s73, v18
  v_add_f32 v28, 1.0, v28
  v_add_f32 v29, 1.0, v29
  v_add_f32 v30, 1.0, v30
  v_add_f32 v31, 1.0, v31
  v_cvt_pk_bf16_f32 v28, 0, v28
  v_cvt_pk_bf16_f32 v29, 0, v29
  v_cvt_pk_bf16_f32 v30, 0, v30
  v_cvt_pk_bf16_f32 v31, 0, v31
  v_mul_f32 v20, v20, v28
  v_mul_f32 v21, v21, v29
  v_mul_f32 v22, v22, v30
  v_mul_f32 v23, v23, v31
  v_cvt_pk_bf16_f32 v20, 0, v20
  v_cvt_pk_bf16_f32 v21, 0, v21
  v_cvt_pk_bf16_f32 v22, 0, v22
  v_cvt_pk_bf16_f32 v23, 0, v23
  v_add_f32 v20, v20, v24
  v_add_f32 v21, v21, v25
  v_add_f32 v22, v22, v26
  v_add_f32 v23, v23, v27
  v_cvt_pk_bf16_f32 v16, v20, v21
  v_cvt_pk_bf16_f32 v17, v22, v23
  ds_write_b64 v12, v[16:17] offset:0
  v_mov_b32 v9, 1
  s_mov_b64 exec, 1
  ds_add_u32 v38, v9 offset:6720
  s_mov_b64 exec, -1
  s_mov_b32 s70, 0
L_sn_14:
  ds_read_b32 v9, v38 offset:6720
  s_waitcnt lgkmcnt(0)
  v_cmp_gt_u32 vcc, 0x8, v9
  s_cmp_eq_u64 vcc, 0
  s_cbranch_scc1 L_snd_15
  s_add_u32 s70, s70, 1
  s_cmp_lt_u32 s70, 2097152
  s_cbranch_scc1 L_sn_14
L_snd_15:
  ds_write_b32 v38, v38 offset:6660
  ds_read_b128 v[104:107], v14 offset:0
  ds_read_b128 v[108:111], v14 offset:64
  ds_read_b128 v[112:115], v14 offset:128
  ds_read_b128 v[116:119], v14 offset:192
  ds_read_b128 v[120:123], v14 offset:256
  ds_read_b128 v[124:127], v14 offset:320
  ds_read_b128 v[128:131], v14 offset:384
  ds_read_b128 v[132:135], v14 offset:448
  ds_read_b128 v[136:139], v14 offset:512
  ds_read_b128 v[140:143], v14 offset:576
  ds_read_b128 v[144:147], v14 offset:640
  ds_read_b128 v[148:151], v14 offset:704
  s_waitcnt lgkmcnt(11)
  v_mfma_f32_16x16x32_bf16 v[8:11], v[40:43], v[104:107], 0
  ds_read_b128 v[152:155], v14 offset:768
  s_waitcnt lgkmcnt(11)
  v_mfma_f32_16x16x32_bf16 v[8:11], v[44:47], v[108:111], v[8:11]
  ds_read_b128 v[156:159], v14 offset:832
  s_waitcnt lgkmcnt(11)
  v_mfma_f32_16x16x32_bf16 v[8:11], v[48:51], v[112:115], v[8:11]
  ds_read_b128 v[160:163], v14 offset:896
  s_waitcnt lgkmcnt(11)
  v_mfma_f32_16x16x32_bf16 v[8:11], v[52:55], v[116:119], v[8:11]
  ds_read_b128 v[164:167], v14 offset:960
  s_waitcnt lgkmcnt(11)
  v_mfma_f32_16x16x32_bf16 v[8:11], v[56:59], v[120:123], v[8:11]
  s_waitcnt lgkmcnt(10)
  v_mfma_f32_16x16x32_bf16 v[8:11], v[60:63], v[124:127], v[8:11]
  s_waitcnt lgkmcnt(9)
  v_mfma_f32_16x16x32_bf16 v[8:11], v[64:67], v[128:131], v[8:11]
  s_waitcnt lgkmcnt(8)
  v_mfma_f32_16x16x32_bf16 v[8:11], v[68:71], v[132:135], v[8:11]
  s_waitcnt lgkmcnt(7)
  v_mfma_f32_16x16x32_bf16 v[8:11], v[72:75], v[136:139], v[8:11]
  s_waitcnt lgkmcnt(6)
  v_mfma_f32_16x16x32_bf16 v[8:11], v[76:79], v[140:143], v[8:11]
  s_waitcnt lgkmcnt(5)
  v_mfma_f32_16x16x32_bf16 v[8:11], v[80:83], v[144:147], v[8:11]
  s_waitcnt lgkmcnt(4)
  v_mfma_f32_16x16x32_bf16 v[8:11], v[84:87], v[148:151], v[8:11]
  s_waitcnt lgkmcnt(3)
  v_mfma_f32_16x16x32_bf16 v[8:11], v[88:91], v[152:155], v[8:11]
  s_waitcnt lgkmcnt(2)
  v_mfma_f32_16x16x32_bf16 v[8:11], v[92:95], v[156:159], v[8:11]
  s_waitcnt lgkmcnt(1)
  v_mfma_f32_16x16x32_bf16 v[8:11], v[96:99], v[160:163], v[8:11]
  s_waitcnt lgkmcnt(0)
  v_mfma_f32_16x16x32_bf16 v[8:11], v[100:103], v[164:167], v[8:11]
  s_nop 7
  v_cvt_pk_bf16_f32 v8, v8, v9
  v_cvt_pk_bf16_f32 v10, v10, v11
  v_mov_b32 v9, s74
  v_mov_b32 v11, s74
  v_min_u32 v8, s72, v8
  v_min_u32 v10, s72, v10
  s_mov_b32 exec_lo, 0x00030003
  s_mov_b32 exec_hi, 0x00030003
  global_store_dwordx4 v13, v[8:11], s[42:43] sc1
  s_mov_b64 exec, -1
  s_mov_b32 s60, 0
  s_branch L_svc
L_r_modb:
  s_lshl_b32 s48, s61, 7
  s_lshl_b32 s58, s61, 9
  s_add_u32 s58, s58, 4096
  s_mov_b32 s44, s36
  s_mov_b32 s45, s37
  s_mov_b32 s46, 3145728
  s_mov_b32 s47, 0x20000
  global_load_dwordx2 v[14:15], v13, s[34:35]
  s_waitcnt lgkmcnt(0)
  s_mul_i32 s74, s74, 0x9e3779b1
  s_add_u32 s74, s74, 0x7f4a7c15
  s_add_u32 s76, s76, s74
  s_waitcnt vmcnt(0)
  v_lshlrev_b32 v16, 16, v14
  v_and_b32 v17, s73, v14
  v_lshlrev_b32 v18, 16, v15
  v_and_b32 v19, s73, v15
  v_mul_f32 v20, 0xbfb8aa3b, v16
  v_mul_f32 v21, 0xbfb8aa3b, v17
  v_mul_f32 v22, 0xbfb8aa3b, v18
  v_mul_f32 v23, 0xbfb8aa3b, v19
  v_exp_f32 v20, v20
  v_exp_f32 v21, v21
  v_exp_f32 v22, v22
  v_exp_f32 v23, v23
  s_nop 0
  v_add_f32 v20, 1.0, v20
  v_add_f32 v21, 1.0, v21
  v_add_f32 v22, 1.0, v22
  v_add_f32 v23, 1.0, v23
  v_rcp_f32 v20, v20
  v_rcp_f32 v21, v21
  v_rcp_f32 v22, v22
  v_rcp_f32 v23, v23
  s_nop 0
  v_mul_f32 v16, v16, v20
  v_mul_f32 v17, v17, v21
  v_mul_f32 v18, v18, v22
  v_mul_f32 v19, v19, v23
  v_cvt_pk_bf16_f32 v14, v16, v17
  v_cvt_pk_bf16_f32 v15, v18, v19
  ds_write_b64 v12, v[14:15] offset:0
  s_mov_b32 s60, 4
  s_sub_u32 s53, s5, 1
  s_cmp_gt_u32 s53, 1
  s_cbranch_scc1 L_sig
  v_lshrrev_b32 v2, 3, v1
  v_and_b32 v3, 6, v2
  v_xor_b32 v3, v3, v1
  v_mul_u32_u24 v2, 6144, v2
  v_and_b32 v3, 7, v3
  v_lshl_add_u32 v2, v3, 4, v2
  s_mul_i32 s49, s53, 1572864
  s_lshl_b32 s50, s53, 15
  s_add_u32 s49, s49, s48
  s_add_u32 s50, s50, 18432
  s_add_u32 s51, s50, 32768
L_dma_16:
  s_mov_b32 m0, s50
  s_add_u32 s50, s50, 1024
  buffer_load_dwordx4 v2, s[44:47], s49 offen nt lds
  s_add_u32 s49, s49, 49152
  s_waitcnt vmcnt(3)
  s_cmp_lt_u32 s50, s51
  s_cbranch_scc1 L_dma_16
L_dmae_17:
  s_branch L_sig
L_r_wo:
  s_lshl_b32 s48, s8, 19
  s_lshl_b32 s49, s61, 7
  s_add_u32 s48, s48, s49
  s_lshl_b32 s58, s8, 12
  s_lshl_b32 s49, s61, 9
  s_add_u32 s58, s58, s49
  s_add_u32 s58, s58, 262144
  s_mov_b32 s44, s24
  s_mov_b32 s45, s25
  s_mov_b32 s46, 4194304
  s_mov_b32 s47, 0x20000
  s_waitcnt lgkmcnt(0)
  s_mul_i32 s74, s74, 0x9e3779b1
  s_add_u32 s74, s74, 0x7f4a7c15
  s_add_u32 s76, s76, s74
  s_cmp_lg_u32 s5, 3
  s_cbranch_scc1 L_sig_18
  s_lshl_b32 s56, s8, 5
  s_add_u32 s56, s56, s61
  s_lshl_b32 s56, s56, 2
  v_mov_b32 v8, s56
  v_mov_b32 v9, s76
  s_mov_b64 exec, 1
  global_store_dword v8, v9, s[42:43] offset:1024 sc1
  s_mov_b64 exec, -1
L_sig_18:
  s_mov_b32 s60, 1
  s_sub_u32 s53, s5, 1
  s_cmp_gt_u32 s53, 1
  s_cbranch_scc1 L_sig
  v_lshrrev_b32 v2, 3, v1
  v_and_b32 v3, 6, v2
  v_xor_b32 v3, v3, v1
  v_mul_u32_u24 v2, 1024, v2
  v_and_b32 v3, 7, v3
  v_lshl_add_u32 v2, v3, 4, v2
  s_mul_i32 s49, s53, 262144
  s_lshl_b32 s50, s53, 15
  s_add_u32 s49, s49, s48
  s_add_u32 s50, s50, 18432
  s_add_u32 s51, s50, 32768
L_dma_19:
  s_mov_b32 m0, s50
  s_add_u32 s50, s50, 1024
  buffer_load_dwordx4 v2, s[44:47], s49 offen nt lds
  s_add_u32 s49, s49, 8192
  s_waitcnt vmcnt(3)
  s_cmp_lt_u32 s50, s51
  s_cbranch_scc1 L_dma_19
L_dmae_20:
  s_branch L_sig
L_r_f1:
  s_lshl_b32 s48, s61, 6
  s_lshl_b32 s58, s61, 12
  s_add_u32 s58, s58, 294912
  s_waitcnt lgkmcnt(0)
  s_mul_i32 s74, s74, 0x9e3779b1
  s_add_u32 s74, s74, 0x7f4a7c15
  s_add_u32 s76, s76, s74
  s_cmp_lt_u32 s5, 2
  s_cselect_b32 s44, s28, s30
  s_cselect_b32 s45, s29, s31
  s_mov_b32 s46, 1409024
  s_mov_b32 s47, 0x20000
  s_mov_b32 s60, 2
  s_sub_u32 s53, s5, 1
  s_cmp_gt_u32 s53, 1
  s_cbranch_scc1 L_sig
  s_and_b32 s54, s61, 1
  v_lshrrev_b32 v2, 2, v1
  v_mul_u32_u24 v2, 5504, v2
  s_and_b32 s49, s5, 2
  s_or_b32 s49, s49, s54
  v_xor_b32 v3, s49, v1
  v_and_b32 v3, 3, v3
  v_lshl_add_u32 v2, v3, 4, v2
  s_mul_i32 s49, s54, 2752
  s_add_u32 s49, s49, s48
  s_lshl_b32 s50, s53, 15
  s_lshl_b32 s54, s54, 14
  s_add_u32 s50, s50, s54
  s_add_u32 s50, s50, 18432
  s_add_u32 s51, s50, 16384
L_dma_21:
  s_mov_b32 m0, s50
  s_add_u32 s50, s50, 1024
  buffer_load_dwordx4 v2, s[44:47], s49 offen  lds
  s_add_u32 s49, s49, 88064
  s_waitcnt vmcnt(3)
  s_cmp_lt_u32 s50, s51
  s_cbranch_scc1 L_dma_21
L_dmae_22:
  s_andn2_b32 s54, 1, s61
  v_lshrrev_b32 v2, 2, v1
  v_mul_u32_u24 v2, 5504, v2
  s_and_b32 s49, s5, 2
  s_or_b32 s49, s49, s54
  v_xor_b32 v3, s49, v1
  v_and_b32 v3, 3, v3
  v_lshl_add_u32 v2, v3, 4, v2
  s_mul_i32 s49, s54, 2752
  s_add_u32 s49, s49, s48
  s_lshl_b32 s50, s53, 15
  s_lshl_b32 s54, s54, 14
  s_add_u32 s50, s50, s54
  s_add_u32 s50, s50, 18432
  s_add_u32 s51, s50, 16384
L_dma_23:
  s_mov_b32 m0, s50
  s_add_u32 s50, s50, 1024
  buffer_load_dwordx4 v2, s[44:47], s49 offen nt lds
  s_add_u32 s49, s49, 88064
  s_waitcnt vmcnt(3)
  s_cmp_lt_u32 s50, s51
  s_cbranch_scc1 L_dma_23
L_dmae_24:
  s_mov_b32 s44, s32
  s_mov_b32 s45, s33
  s_mov_b32 s46, 1409024
  s_mov_b32 s47, 0x20000
  v_lshlrev_b32 v2, 4, v1
  s_lshl_b32 s49, s61, 1
  s_add_u32 s49, s49, s53
  s_lshl_b32 s49, s49, 14
  s_mul_i32 s50, s53, 16896
  s_add_u32 s50, s50, 104448
  s_add_u32 s51, s50, 16896
L_dma_25:
  s_mov_b32 m0, s50
  s_add_u32 s50, s50, 1056
  buffer_load_dwordx4 v2, s[44:47], s49 offen nt lds
  s_add_u32 s49, s49, 1024
  s_waitcnt vmcnt(5)
  s_cmp_lt_u32 s50, s51
  s_cbranch_scc1 L_dma_25
L_dmae_26:
  s_branch L_sig
L_r_f2:
  s_mov_b32 s60, 3
  s_sub_u32 s53, s5, 1
  s_cmp_gt_u32 s53, 1
  s_cbranch_scc1 L_gs_27
  s_bfe_u32 s49, s15, 0x20006
  s_cmp_ge_u32 s53, s49
  s_cbranch_scc1 L_end
  s_mul_i32 s49, s53, 5
  s_add_u32 s49, s49, 8
  s_lshr_b32 s49, s15, s49
  s_and_b32 s4, s49, 3
  s_lshl_b32 s4, s4, 18
  s_bfe_u32 s11, s49, 0x30002
  s_lshl_b32 s11, s11, 10
  s_add_u32 s9, s53, 8
  s_mov_b32 s13, -1
  s_branch L_stream
L_gs_27:
  s_cmp_lg_u32 s5, 3
  s_cbranch_scc1 L_tch_28
  s_and_b32 s49, s61, 3
  s_lshl_b32 s49, s49, 7
  v_add_u32 v8, s49, v1
  s_bfe_u32 s50, s14, 0x50003
  s_cmp_eq_u32 s50, 0
  s_cbranch_scc1 L_tchm_29
  s_lshl_b32 s50, s50, 10
  s_sub_u32 s50, s50, 640
  v_mul_u32_u24 v9, 6144, v8
  v_add_u32 v9, s50, v9
  global_load_dword v167, v9, s[36:37]
  v_add_u32 v10, 393216, v9
  global_load_dword v167, v10, s[36:37]
L_tchm_29:
  s_lshl_b32 s50, s8, 10
  s_add_u32 s50, s50, 384
  v_mul_u32_u24 v9, 8192, v8
  v_add_u32 v9, s50, v9
  global_load_dword v167, v9, s[22:23]
  v_add_u32 v10, 524288, v9
  global_load_dword v167, v10, s[22:23]
L_tch_28:
L_light:
  s_waitcnt lgkmcnt(0)
  s_mul_i32 s74, s74, 0x9e3779b1
  s_add_u32 s74, s74, 0x7f4a7c15
  s_add_u32 s76, s76, s74
  s_cmp_eq_u32 s5, 3
  s_cbranch_scc1 L_lt3
  s_bfe_u32 s49, s15, 0x20006
  s_sub_u32 s49, 0, s49
  v_mov_b32 v4, s49
  v_lshlrev_b32 v5, 6, v4
  v_mul_i32_i24 v6, -28, v4
  s_mov_b64 exec, 1
  ds_add_u32 v38, v5 offset:6680
  ds_add_u32 v38, v5 offset:6672
  ds_add_u32 v38, v4 offset:6704
  ds_add_u32 v38, v4 offset:6708
  ds_add_u32 v38, v6 offset:6688
  s_mov_b64 exec, -1
  v_mov_b32 v9, 1
  s_mov_b64 exec, 1
  ds_add_u32 v38, v9 offset:6720
  s_mov_b64 exec, -1
  s_branch L_svc
L_lt3:
  s_mov_b32 s70, 0
L_sn_30:
  ds_read_b32 v9, v38 offset:6720
  s_waitcnt lgkmcnt(0)
  v_cmp_gt_u32 vcc, 0x1, v9
  s_cmp_eq_u64 vcc, 0
  s_cbranch_scc1 L_snd_31
  s_sleep 2
  s_add_u32 s70, s70, 1
  s_cmp_lt_u32 s70, 2097152
  s_cbranch_scc1 L_sn_30
L_snd_31:
  s_branch L_svc
L_r_none:
  s_mov_b32 s60, 0
  s_sub_u32 s53, s5, 1
  s_cmp_gt_u32 s53, 1
  s_cbranch_scc1 L_gs_32
  s_bfe_u32 s49, s15, 0x20006
  s_cmp_ge_u32 s53, s49
  s_cbranch_scc1 L_end
  s_mul_i32 s49, s53, 5
  s_add_u32 s49, s49, 8
  s_lshr_b32 s49, s15, s49
  s_and_b32 s4, s49, 3
  s_lshl_b32 s4, s4, 18
  s_bfe_u32 s11, s49, 0x30002
  s_lshl_b32 s11, s11, 10
  s_add_u32 s9, s53, 8
  s_mov_b32 s13, -1
  s_branch L_stream
L_gs_32:
  s_branch L_light
L_sig:
  s_waitcnt vmcnt(0) lgkmcnt(0)
  v_mov_b32 v9, 1
  s_mov_b64 exec, 1
  ds_add_u32 v38, v9 offset:6720
  s_mov_b64 exec, -1
L_svc:
  s_cmp_eq_u32 s5, 3
  s_cbranch_scc1 L_svc3
  s_cmp_lg_u32 s5, 0
  s_cbranch_scc1 L_mid
  s_lshl_b32 s64, s6, 2
  s_add_u32 s64, s64, s7
  s_lshl_b32 s64, s64, 7
  s_add_u32 s64, s64, 65536
  v_mov_b32 v18, s64
  s_mov_b32 s70, 0
L_sn_33:
  ds_read_b64 v[8:9], v38 offset:6680
  s_waitcnt lgkmcnt(0)
  v_and_b32 v8, 0xffff, v8
  v_cmp_gt_u32 vcc, 0x280, v8
  s_cmp_eq_u64 vcc, 0
  s_cbranch_scc1 L_snd_34
  s_sleep 2
  s_add_u32 s70, s70, 1
  s_cmp_lt_u32 s70, 2097152
  s_cbranch_scc1 L_sn_33
L_snd_34:
  v_mov_b32 v8, v9
  v_mov_b32 v9, s74
  s_mov_b64 exec, 1
  global_store_dwordx2 v18, v[8:9], s[42:43] sc1
  s_mov_b64 exec, -1
  s_lshl_b32 s64, s8, 7
  s_load_dwordx8 s[20:27], s[42:43], s64 offset:1024 glc
  s_waitcnt lgkmcnt(0)
  s_xor_b32 s68, s20, s76
  s_xor_b32 s69, s21, s76
  s_or_b32 s68, s68, s69
  s_xor_b32 s69, s22, s76
  s_or_b32 s68, s68, s69
  s_xor_b32 s69, s23, s76
  s_or_b32 s68, s68, s69
  s_xor_b32 s69, s24, s76
  s_or_b32 s68, s68, s69
  s_xor_b32 s69, s25, s76
  s_or_b32 s68, s68, s69
  s_xor_b32 s69, s26, s76
  s_or_b32 s68, s68, s69
  s_xor_b32 s69, s27, s76
  s_or_b32 s68, s68, s69
  s_cselect_b32 s68, 0, 1
  v_mov_b32 v8, s68
  s_mov_b64 exec, 1
  ds_add_u32 v38, v8 offset:6712
  s_mov_b64 exec, -1
  s_branch L_mid
L_svc3:
  s_mov_b32 s70, 0
L_sn_35:
  ds_read_b32 v8, v38 offset:6680
  s_waitcnt lgkmcnt(0)
  v_cmp_gt_u32 vcc, 0x180, v8
  s_cmp_eq_u64 vcc, 0
  s_cbranch_scc1 L_snd_36
  s_sleep 4
  s_add_u32 s70, s70, 1
  s_cmp_lt_u32 s70, 2097152
  s_cbranch_scc1 L_sn_35
L_snd_36:
  s_lshl_b32 s64, s6, 9
  s_xor_b32 s54, s7, 1
  s_lshl_b32 s54, s54, 7
  s_add_u32 s54, s54, s64
  s_xor_b32 s55, s7, 2
  s_lshl_b32 s55, s55, 7
  s_add_u32 s55, s55, s64
  s_xor_b32 s56, s7, 3
  s_lshl_b32 s56, s56, 7
  s_add_u32 s56, s56, s64
  s_mov_b32 s70, 0
L_s3e:
  s_load_dwordx2 s[20:21], s[42:43], s54 offset:65536 glc
  s_load_dwordx2 s[24:25], s[42:43], s55 offset:65536 glc
  s_load_dwordx2 s[28:29], s[42:43], s56 offset:65536 glc
  s_waitcnt lgkmcnt(0)
  s_xor_b32 s68, s21, s74
  s_xor_b32 s69, s25, s74
  s_or_b32 s68, s68, s69
  s_xor_b32 s69, s29, s74
  s_or_b32 s68, s68, s69
  s_cbranch_scc0 L_s3ed
  s_sleep 2
  s_add_u32 s70, s70, 1
  s_cmp_lt_u32 s70, 262144
  s_cbranch_scc1 L_s3e
L_s3ed:
  v_mov_b32 v8, s20
  v_mov_b32 v10, s24
  v_mov_b32 v16, s28
  v_max3_f32 v18, v8, v10, v16
  v_mov_b32 v19, 0x10000
  v_med3_f32 v17, v8, v10, v16
  v_min3_f32 v16, v8, v10, v16
  s_mov_b64 exec, 1
  ds_write_b96 v38, v[16:18] offset:6736
  ds_add_u32 v38, v19 offset:6680
  s_mov_b64 exec, -1
L_mid:
  s_bfe_u32 s32, s74, 0x80000
  s_bfe_u32 s33, s74, 0x80008
  s_bfe_u32 s34, s74, 0x80010
  s_bfe_u32 s35, s74, 0x80018
  s_cmp_eq_u32 s60, 2
  s_cbranch_scc1 L_pre_f1
  s_cmp_eq_u32 s60, 3
  s_cbranch_scc1 L_pre_f2
  s_cmp_eq_u32 s60, 1
  s_cbranch_scc1 L_pre_wo
  s_cmp_lg_u32 s60, 4
  s_cbranch_scc1 L_svd
  v_and_b32 v13, 1, v1
  v_lshlrev_b32 v13, 6, v13
  v_lshrrev_b32 v3, 4, v1
  v_lshl_add_u32 v13, v3, 4, v13
  s_lshl_b32 s49, s5, 7
  s_add_u32 s49, s49, s58
  v_add_u32 v13, s49, v13
  v_and_b32 v14, 1, v1
  v_mul_u32_u24 v14, 1056, v14
  v_lshrrev_b32 v3, 4, v1
  v_lshl_add_u32 v14, v3, 4, v14
  v_lshrrev_b32 v2, 2, v1
  v_bfe_u32 v3, v1, 1, 1
  s_lshl_b32 s49, s5, 1
  v_or_b32 v3, s49, v3
  v_and_b32 v10, 6, v2
  v_xor_b32 v3, v3, v10
  v_lshlrev_b32 v2, 7, v2
  v_lshl_add_u32 v2, v3, 4, v2
  v_and_b32 v3, 1, v1
  v_lshl_add_u32 v2, v3, 3, v2
  v_add_u32 v2, 18432, v2
  s_mov_b32 s70, 0
L_sn_37:
  ds_read_b32 v9, v38 offset:6720
  s_waitcnt lgkmcnt(0)
  v_cmp_gt_u32 vcc, 0x4, v9
  s_cmp_eq_u64 vcc, 0
  s_cbranch_scc1 L_snd_38
  s_sleep 8
  s_add_u32 s70, s70, 1
  s_cmp_lt_u32 s70, 2097152
  s_cbranch_scc1 L_sn_37
L_snd_38:
  ds_read_b64_tr_b16 v[40:41], v2 offset:0
  ds_read_b64_tr_b16 v[42:43], v2 offset:2048
  ds_read_b128 v[104:107], v14 offset:0
  ds_read_b64_tr_b16 v[44:45], v2 offset:4096
  ds_read_b64_tr_b16 v[46:47], v2 offset:6144
  ds_read_b128 v[108:111], v14 offset:64
  ds_read_b64_tr_b16 v[48:49], v2 offset:8192
  ds_read_b64_tr_b16 v[50:51], v2 offset:10240
  ds_read_b128 v[112:115], v14 offset:128
  ds_read_b64_tr_b16 v[52:53], v2 offset:12288
  ds_read_b64_tr_b16 v[54:55], v2 offset:14336
  ds_read_b128 v[116:119], v14 offset:192
  ds_read_b64_tr_b16 v[56:57], v2 offset:16384
  ds_read_b64_tr_b16 v[58:59], v2 offset:18432
  ds_read_b128 v[120:123], v14 offset:256
  s_waitcnt lgkmcnt(12)
  v_mfma_f32_16x16x32_bf16 v[8:11], v[40:43], v[104:107], 0
  ds_read_b64_tr_b16 v[60:61], v2 offset:20480
  ds_read_b64_tr_b16 v[62:63], v2 offset:22528
  ds_read_b128 v[124:127], v14 offset:320
  s_waitcnt lgkmcnt(12)
  v_mfma_f32_16x16x32_bf16 v[8:11], v[44:47], v[108:111], v[8:11]
  ds_read_b64_tr_b16 v[64:65], v2 offset:24576
  ds_read_b64_tr_b16 v[66:67], v2 offset:26624
  ds_read_b128 v[128:131], v14 offset:384
  s_waitcnt lgkmcnt(12)
  v_mfma_f32_16x16x32_bf16 v[8:11], v[48:51], v[112:115], v[8:11]
  ds_read_b64_tr_b16 v[68:69], v2 offset:28672
  ds_read_b64_tr_b16 v[70:71], v2 offset:30720
  ds_read_b128 v[132:135], v14 offset:448
  s_waitcnt lgkmcnt(12)
  v_mfma_f32_16x16x32_bf16 v[8:11], v[52:55], v[116:119], v[8:11]
  ds_read_b64_tr_b16 v[72:73], v2 offset:32768
  ds_read_b64_tr_b16 v[74:75], v2 offset:34816
  ds_read_b128 v[136:139], v14 offset:512
  s_waitcnt lgkmcnt(12)
  v_mfma_f32_16x16x32_bf16 v[8:11], v[56:59], v[120:123], v[8:11]
  ds_read_b64_tr_b16 v[76:77], v2 offset:36864
  ds_read_b64_tr_b16 v[78:79], v2 offset:38912
  ds_read_b128 v[140:143], v14 offset:576
  s_waitcnt lgkmcnt(12)
  v_mfma_f32_16x16x32_bf16 v[8:11], v[60:63], v[124:127], v[8:11]
  ds_read_b64_tr_b16 v[80:81], v2 offset:40960
  ds_read_b64_tr_b16 v[82:83], v2 offset:43008
  ds_read_b128 v[144:147], v14 offset:640
  s_waitcnt lgkmcnt(12)
  v_mfma_f32_16x16x32_bf16 v[8:11], v[64:67], v[128:131], v[8:11]
  ds_read_b64_tr_b16 v[84:85], v2 offset:45056
  ds_read_b64_tr_b16 v[86:87], v2 offset:47104
  ds_read_b128 v[148:151], v14 offset:704
  s_waitcnt lgkmcnt(12)
  v_mfma_f32_16x16x32_bf16 v[8:11], v[68:71], v[132:135], v[8:11]
  ds_read_b64_tr_b16 v[88:89], v2 offset:49152
  ds_read_b64_tr_b16 v[90:91], v2 offset:51200
  ds_read_b128 v[152:155], v14 offset:768
  s_waitcnt lgkmcnt(12)
  v_mfma_f32_16x16x32_bf16 v[8:11], v[72:75], v[136:139], v[8:11]
  ds_read_b64_tr_b16 v[92:93], v2 offset:53248
  ds_read_b64_tr_b16 v[94:95], v2 offset:55296
  ds_read_b128 v[156:159], v14 offset:832
  s_waitcnt lgkmcnt(12)
  v_mfma_f32_16x16x32_bf16 v[8:11], v[76:79], v[140:143], v[8:11]
  ds_read_b64_tr_b16 v[96:97], v2 offset:57344
  ds_read_b64_tr_b16 v[98:99], v2 offset:59392
  ds_read_b128 v[160:163], v14 offset:896
  s_waitcnt lgkmcnt(12)
  v_mfma_f32_16x16x32_bf16 v[8:11], v[80:83], v[144:147], v[8:11]
  ds_read_b64_tr_b16 v[100:101], v2 offset:61440
  ds_read_b64_tr_b16 v[102:103], v2 offset:63488
  ds_read_b128 v[164:167], v14 offset:960
  s_waitcnt lgkmcnt(12)
  v_mfma_f32_16x16x32_bf16 v[8:11], v[84:87], v[148:151], v[8:11]
  s_waitcnt lgkmcnt(9)
  v_mfma_f32_16x16x32_bf16 v[8:11], v[88:91], v[152:155], v[8:11]
  s_waitcnt lgkmcnt(6)
  v_mfma_f32_16x16x32_bf16 v[8:11], v[92:95], v[156:159], v[8:11]
  s_waitcnt lgkmcnt(3)
  v_mfma_f32_16x16x32_bf16 v[8:11], v[96:99], v[160:163], v[8:11]
  s_waitcnt lgkmcnt(0)
  v_mfma_f32_16x16x32_bf16 v[8:11], v[100:103], v[164:167], v[8:11]
  s_nop 7
  v_cvt_pk_bf16_f32 v8, v8, v9
  v_cvt_pk_bf16_f32 v10, v10, v11
  v_mov_b32 v9, s74
  v_mov_b32 v11, s74
  s_mov_b32 exec_lo, 0x00030003
  s_mov_b32 exec_hi, 0x00030003
  global_store_dwordx4 v13, v[8:11], s[42:43] sc1
  s_mov_b64 exec, -1
  s_branch L_svd
L_pre_wo:
  s_mov_b32 s70, 0
L_sn_39:
  ds_read_b32 v9, v38 offset:6720
  s_waitcnt lgkmcnt(0)
  v_cmp_gt_u32 vcc, 0x4, v9
  s_cmp_eq_u64 vcc, 0
  s_cbranch_scc1 L_snd_40
  s_sleep 8
  s_add_u32 s70, s70, 1
  s_cmp_lt_u32 s70, 2097152
  s_cbranch_scc1 L_sn_39
L_snd_40:
  v_lshrrev_b32 v2, 2, v1
  v_bfe_u32 v3, v1, 1, 1
  s_lshl_b32 s49, s5, 1
  v_or_b32 v3, s49, v3
  v_and_b32 v10, 6, v2
  v_xor_b32 v3, v3, v10
  v_lshlrev_b32 v2, 7, v2
  v_lshl_add_u32 v2, v3, 4, v2
  v_and_b32 v3, 1, v1
  v_lshl_add_u32 v2, v3, 3, v2
  v_add_u32 v2, 18432, v2
  ds_read_b64_tr_b16 v[40:41], v2 offset:0
  ds_read_b64_tr_b16 v[42:43], v2 offset:2048
  ds_read_b64_tr_b16 v[44:45], v2 offset:4096
  ds_read_b64_tr_b16 v[46:47], v2 offset:6144
  ds_read_b64_tr_b16 v[48:49], v2 offset:8192
  ds_read_b64_tr_b16 v[50:51], v2 offset:10240
  ds_read_b64_tr_b16 v[52:53], v2 offset:12288
  ds_read_b64_tr_b16 v[54:55], v2 offset:14336
  ds_read_b64_tr_b16 v[56:57], v2 offset:16384
  ds_read_b64_tr_b16 v[58:59], v2 offset:18432
  ds_read_b64_tr_b16 v[60:61], v2 offset:20480
  ds_read_b64_tr_b16 v[62:63], v2 offset:22528
  s_waitcnt lgkmcnt(10)
  ds_read_b64_tr_b16 v[64:65], v2 offset:24576
  ds_read_b64_tr_b16 v[66:67], v2 offset:26624
  s_waitcnt lgkmcnt(10)
  ds_read_b64_tr_b16 v[68:69], v2 offset:28672
  ds_read_b64_tr_b16 v[70:71], v2 offset:30720
  s_waitcnt lgkmcnt(10)
  ds_read_b64_tr_b16 v[72:73], v2 offset:32768
  ds_read_b64_tr_b16 v[74:75], v2 offset:34816
  s_waitcnt lgkmcnt(10)
  ds_read_b64_tr_b16 v[76:77], v2 offset:36864
  ds_read_b64_tr_b16 v[78:79], v2 offset:38912
  s_waitcnt lgkmcnt(10)
  ds_read_b64_tr_b16 v[80:81], v2 offset:40960
  ds_read_b64_tr_b16 v[82:83], v2 offset:43008
  s_waitcnt lgkmcnt(10)
  ds_read_b64_tr_b16 v[84:85], v2 offset:45056
  ds_read_b64_tr_b16 v[86:87], v2 offset:47104
  s_waitcnt lgkmcnt(10)
  ds_read_b64_tr_b16 v[88:89], v2 offset:49152
  ds_read_b64_tr_b16 v[90:91], v2 offset:51200
  s_waitcnt lgkmcnt(10)
  ds_read_b64_tr_b16 v[92:93], v2 offset:53248
  ds_read_b64_tr_b16 v[94:95], v2 offset:55296
  s_waitcnt lgkmcnt(10)
  ds_read_b64_tr_b16 v[96:97], v2 offset:57344
  ds_read_b64_tr_b16 v[98:99], v2 offset:59392
  s_waitcnt lgkmcnt(10)
  ds_read_b64_tr_b16 v[100:101], v2 offset:61440
  ds_read_b64_tr_b16 v[102:103], v2 offset:63488
  s_waitcnt lgkmcnt(10)
  s_waitcnt lgkmcnt(0)
  s_lshl_b32 s49, s8, 2
  s_add_u32 s49, s49, s5
  s_lshl_b32 s49, s49, 11
  s_add_u32 s49, s49, 131072
  v_lshrrev_b32 v12, 5, v1
  v_and_b32 v16, 31, v1
  v_lshlrev_b32 v15, 16, v12
  v_lshl_add_u32 v15, v16, 4, v15
  v_add_u32 v15, s49, v15
  v_mul_u32_u24 v12, 1056, v12
  v_bfe_u32 v16, v1, 3, 2
  v_lshl_add_u32 v12, v16, 6, v12
  v_and_b32 v16, 3, v1
  v_lshl_add_u32 v12, v16, 4, v12
  v_bfe_u32 v16, v1, 2, 1
  v_lshl_add_u32 v12, v16, 3, v12
  s_lshl_b32 s49, s5, 8
  v_add_u32 v12, s49, v12
  v_and_b32 v14, 1, v1
  v_mul_u32_u24 v14, 1056, v14
  v_lshrrev_b32 v3, 4, v1
  v_lshl_add_u32 v14, v3, 4, v14
  v_and_b32 v13, 1, v1
  v_lshlrev_b32 v13, 6, v13
  v_lshrrev_b32 v3, 4, v1
  v_lshl_add_u32 v13, v3, 4, v13
  s_lshl_b32 s49, s5, 7
  s_add_u32 s49, s49, s58
  v_add_u32 v13, s49, v13
  v_mov_b32 v36, 0xff
  s_branch L_svd
L_pre_f1:
  v_mov_b32 v37, v13
  v_lshlrev_b32 v15, 4, v0
  v_add_u32 v39, 16384, v15
  v_add_u32 v15, 266240, v15
  v_lshrrev_b32 v5, 2, v0
  v_lshlrev_b32 v5, 3, v5
  v_add_u32 v5, 7424, v5
  v_lshlrev_b32 v7, 3, v1
  v_add_u32 v7, 7424, v7
  v_and_b32 v14, 7, v1
  v_mul_u32_u24 v14, 1056, v14
  v_lshrrev_b32 v3, 4, v1
  v_lshl_add_u32 v14, v3, 4, v14
  v_bfe_u32 v6, v1, 2, 2
  v_lshl_add_u32 v6, v3, 3, v6
  v_mul_u32_u24 v6, 1056, v6
  v_and_b32 v8, 3, v1
  v_lshl_add_u32 v6, v8, 3, v6
  s_lshl_b32 s49, s5, 8
  s_add_u32 s49, s49, 104448
  v_add_u32 v6, s49, v6
  v_lshlrev_b32 v10, 3, v0
  v_add_u32 v10, 138240, v10
  v_mov_b32 v8, 0
  v_mov_b32 v9, 0
  ds_write_b64 v10, v[8:9]
  v_and_b32 v13, 1, v1
  v_lshlrev_b32 v13, 6, v13
  v_lshrrev_b32 v3, 4, v1
  v_lshl_add_u32 v13, v3, 4, v13
  s_lshl_b32 s49, s5, 10
  s_add_u32 s49, s49, s58
  v_add_u32 v13, s49, v13
  v_bfe_u32 v3, v1, 1, 3
  v_lshl_add_u32 v13, v3, 7, v13
  v_lshrrev_b32 v2, 3, v1
  v_lshlrev_b32 v2, 6, v2
  v_bfe_u32 v3, v1, 2, 1
  v_lshl_add_u32 v2, v3, 14, v2
  v_and_b32 v8, 2, v1
  v_or_b32 v3, v3, v8
  v_xor_b32 v3, s5, v3
  v_lshl_add_u32 v2, v3, 4, v2
  v_lshl_add_u32 v2, v8, 14, v2
  v_and_b32 v3, 1, v1
  v_lshl_add_u32 v2, v3, 3, v2
  v_add_u32 v2, 18432, v2
  s_branch L_svd
L_pre_f2:
  v_bfe_u32 v12, v1, 2, 1
  v_and_b32 v14, 3, v1
  s_lshl_b32 s49, s61, 5
  v_lshl_add_u32 v3, v14, 3, s49
  v_lshl_add_u32 v37, v12, 10, v3
  v_and_b32 v15, 7, v1
  s_lshl_b32 s49, s61, 7
  v_lshl_add_u32 v15, v15, 4, s49
  v_add_u32 v39, 16384, v15
  v_lshrrev_b32 v3, 3, v1
  v_lshl_add_u32 v15, v3, 12, v15
  v_add_u32 v15, 262144, v15
L_svd:
  s_cmp_eq_u32 s5, 3
  s_cbranch_scc1 L_svd3
  s_cmp_lg_u32 s5, 0
  s_cbranch_scc1 L_tail
  s_lshl_b32 s64, s6, 2
  s_add_u32 s64, s64, s7
  s_lshl_b32 s64, s64, 7
  s_add_u32 s64, s64, 98304
  v_mov_b32 v18, s64
  s_mov_b32 s70, 0
L_sn_41:
  ds_read_b32 v8, v38 offset:6672
  s_waitcnt lgkmcnt(0)
  v_and_b32 v8, 0xffff, v8
  v_cmp_gt_u32 vcc, 0x280, v8
  s_cmp_eq_u64 vcc, 0
  s_cbranch_scc1 L_snd_42
  s_sleep 1
  s_add_u32 s70, s70, 1
  s_cmp_lt_u32 s70, 2097152
  s_cbranch_scc1 L_sn_41
L_snd_42:
  v_and_b32 v9, 15, v1
  v_lshlrev_b32 v9, 3, v9
  ds_read_b64 v[10:11], v9 offset:6912
  s_waitcnt lgkmcnt(0)
  v_mov_b32 v16, v10
  v_max_f32_dpp v8, v10, v10 quad_perm:[1,0,3,2] row_mask:0xf bank_mask:0xf
  s_nop 1
  v_max_f32_dpp v8, v8, v8 quad_perm:[2,3,0,1] row_mask:0xf bank_mask:0xf
  s_nop 1
  v_max_f32_dpp v8, v8, v8 row_half_mirror row_mask:0xf bank_mask:0xf
  s_nop 1
  v_max_f32_dpp v8, v8, v8 row_mirror row_mask:0xf bank_mask:0xf
  v_sub_f32 v9, v10, v8
  v_mul_f32 v9, 0x3fb8aa3b, v9
  v_exp_f32 v9, v9
  s_nop 0
  v_mul_f32 v10, v9, v11
  s_nop 1
  v_add_f32_dpp v10, v10, v10 quad_perm:[1,0,3,2] row_mask:0xf bank_mask:0xf
  s_nop 1
  v_add_f32_dpp v10, v10, v10 quad_perm:[2,3,0,1] row_mask:0xf bank_mask:0xf
  s_nop 1
  v_add_f32_dpp v10, v10, v10 row_half_mirror row_mask:0xf bank_mask:0xf
  s_nop 1
  v_add_f32_dpp v10, v10, v10 row_mirror row_mask:0xf bank_mask:0xf
  v_mov_b32 v9, s74
  v_mov_b32 v11, s76
  s_mov_b64 exec, 1
  global_store_dwordx4 v18, v[8:11], s[42:43] sc1
  ds_write_b32 v38, v8 offset:6848
  ds_write_b32 v38, v10 offset:6852
  s_mov_b64 exec, -1
  s_mov_b32 s70, 0
L_sn_43:
  ds_read_b32 v8, v38 offset:6672
  s_waitcnt lgkmcnt(0)
  v_cmp_gt_u32 vcc, 0x10000, v8
  s_cmp_eq_u64 vcc, 0
  s_cbranch_scc1 L_snd_44
  s_sleep 1
  s_add_u32 s70, s70, 1
  s_cmp_lt_u32 s70, 2097152
  s_cbranch_scc1 L_sn_43
L_snd_44:
  v_and_b32 v9, 3, v1
  v_lshlrev_b32 v9, 3, v9
  ds_read_b64 v[10:11], v9 offset:6848
  s_waitcnt lgkmcnt(0)
  v_max_f32_dpp v8, v10, v10 quad_perm:[1,0,3,2] row_mask:0xf bank_mask:0xf
  s_nop 1
  v_max_f32_dpp v8, v8, v8 quad_perm:[2,3,0,1] row_mask:0xf bank_mask:0xf
  v_sub_f32 v9, v10, v8
  v_mul_f32 v9, 0x3fb8aa3b, v9
  v_exp_f32 v9, v9
  s_nop 0
  v_mul_f32 v10, v9, v11
  s_nop 1
  v_add_f32_dpp v10, v10, v10 quad_perm:[1,0,3,2] row_mask:0xf bank_mask:0xf
  s_nop 1
  v_add_f32_dpp v10, v10, v10 quad_perm:[2,3,0,1] row_mask:0xf bank_mask:0xf
  v_sub_f32 v9, v16, v8
  v_rcp_f32 v10, v10
  v_mul_f32 v9, 0x3fb8aa3b, v9
  v_exp_f32 v9, v9
  v_lshlrev_b32 v8, 2, v1
  v_mul_f32 v9, v9, v10
  s_mov_b64 exec, 0xffff
  ds_write_b32 v8, v9 offset:6784
  s_mov_b64 exec, -1
  ds_write_b32 v38, v38 offset:6656
  s_mov_b32 s70, 0
L_sn_45:
  ds_read_b32 v8, v38 offset:6704
  s_waitcnt lgkmcnt(0)
  v_cmp_gt_u32 vcc, 0xa, v8
  s_cmp_eq_u64 vcc, 0
  s_cbranch_scc1 L_snd_46
  s_sleep 1
  s_add_u32 s70, s70, 1
  s_cmp_lt_u32 s70, 2097152
  s_cbranch_scc1 L_sn_45
L_snd_46:
  v_lshlrev_b32 v136, 3, v1
  ds_read_b32 v139, v38 offset:6712
  ds_read_b128 v[124:127], v38 offset:6784
  ds_read_b128 v[128:131], v38 offset:6800
  ds_read_b128 v[132:135], v38 offset:6816
  ds_read_b64 v[104:105], v136 offset:13056
  ds_read_b64 v[106:107], v136 offset:13568
  ds_read_b64 v[108:109], v136 offset:14080
  ds_read_b64 v[110:111], v136 offset:14592
  ds_read_b64 v[112:113], v136 offset:15104
  ds_read_b64 v[114:115], v136 offset:15616
  ds_read_b64 v[116:117], v136 offset:16128
  ds_read_b64 v[118:119], v136 offset:16640
  ds_read_b64 v[120:121], v136 offset:17152
  ds_read_b64 v[122:123], v136 offset:17664
  s_lshl_b32 s68, s6, 2
  s_add_u32 s68, s68, s7
  s_lshl_b32 s68, s68, 9
  s_add_u32 s68, s68, 131072
  v_add_u32 v136, s68, v136
  v_and_b32 v137, 1, v1
  v_lshlrev_b32 v137, 4, v137
  v_lshrrev_b32 v137, v137, s74
  v_lshrrev_b32 v138, 8, v137
  s_movk_i32 s69, 0xff
  s_waitcnt lgkmcnt(9)
  v_pk_mul_f32 v[104:105], v[104:105], v[124:125] op_sel:[0,0] op_sel_hi:[1,0]
  v_readfirstlane_b32 s75, v139
  s_waitcnt lgkmcnt(8)
  v_pk_mul_f32 v[106:107], v[106:107], v[124:125] op_sel:[0,1] op_sel_hi:[1,1]
  s_waitcnt lgkmcnt(7)
  v_pk_fma_f32 v[104:105], v[108:109], v[126:127], v[104:105] op_sel:[0,0,0] op_sel_hi:[1,0,1]
  s_waitcnt lgkmcnt(6)
  v_pk_fma_f32 v[106:107], v[110:111], v[126:127], v[106:107] op_sel:[0,1,0] op_sel_hi:[1,1,1]
  s_waitcnt lgkmcnt(5)
  v_pk_fma_f32 v[104:105], v[112:113], v[128:129], v[104:105] op_sel:[0,0,0] op_sel_hi:[1,0,1]
  s_waitcnt lgkmcnt(4)
  v_pk_fma_f32 v[106:107], v[114:115], v[128:129], v[106:107] op_sel:[0,1,0] op_sel_hi:[1,1,1]
  s_waitcnt lgkmcnt(3)
  v_pk_fma_f32 v[104:105], v[116:117], v[130:131], v[104:105] op_sel:[0,0,0] op_sel_hi:[1,0,1]
  s_waitcnt lgkmcnt(2)
  v_pk_fma_f32 v[106:107], v[118:119], v[130:131], v[106:107] op_sel:[0,1,0] op_sel_hi:[1,1,1]
  s_waitcnt lgkmcnt(1)
  v_pk_fma_f32 v[104:105], v[120:121], v[132:133], v[104:105] op_sel:[0,0,0] op_sel_hi:[1,0,1]
  s_waitcnt lgkmcnt(0)
  v_pk_fma_f32 v[106:107], v[122:123], v[132:133], v[106:107] op_sel:[0,1,0] op_sel_hi:[1,1,1]
  v_pk_add_f32 v[104:105], v[104:105], v[106:107]
  v_bfi_b32 v104, s69, v137, v104
  v_bfi_b32 v105, s69, v138, v105
  s_cmp_eq_u32 s75, 2
  s_cbranch_scc0 L_pf_47
  global_store_dwordx2 v136, v[104:105], s[42:43]
  s_branch L_pe_48
L_pf_47:
  global_store_dwordx2 v136, v[104:105], s[42:43] sc1
L_pe_48:
  s_cmp_eq_u32 s60, 1
  s_cbranch_scc1 L_tail
  s_waitcnt vmcnt(0)
  ds_write_b32 v38, v38 offset:6700
  s_branch L_tail
L_svd3:
  s_mov_b32 s70, 0
L_sn_49:
  ds_read_b32 v8, v38 offset:6672
  s_waitcnt lgkmcnt(0)
  v_cmp_gt_u32 vcc, 0x180, v8
  s_cmp_eq_u64 vcc, 0
  s_cbranch_scc1 L_snd_50
  s_sleep 4
  s_add_u32 s70, s70, 1
  s_cmp_lt_u32 s70, 2097152
  s_cbranch_scc1 L_sn_49
L_snd_50:
  s_lshl_b32 s64, s6, 9
  s_xor_b32 s54, s7, 1
  s_lshl_b32 s54, s54, 7
  s_add_u32 s54, s54, s64
  s_xor_b32 s55, s7, 2
  s_lshl_b32 s55, s55, 7
  s_add_u32 s55, s55, s64
  s_xor_b32 s56, s7, 3
  s_lshl_b32 s56, s56, 7
  s_add_u32 s56, s56, s64
  s_mov_b32 s70, 0
L_s3p:
  s_load_dwordx4 s[20:23], s[42:43], s54 offset:98304 glc
  s_load_dwordx4 s[24:27], s[42:43], s55 offset:98304 glc
  s_load_dwordx4 s[28:31], s[42:43], s56 offset:98304 glc
  s_waitcnt lgkmcnt(0)
  s_xor_b32 s68, s21, s74
  s_sub_u32 s69, s23, s74
  s_lshr_b32 s69, s69, 4
  s_or_b32 s68, s68, s69
  s_xor_b32 s69, s25, s74
  s_or_b32 s68, s68, s69
  s_sub_u32 s69, s27, s74
  s_lshr_b32 s69, s69, 4
  s_or_b32 s68, s68, s69
  s_xor_b32 s69, s29, s74
  s_or_b32 s68, s68, s69
  s_sub_u32 s69, s31, s74
  s_lshr_b32 s69, s69, 4
  s_or_b32 s68, s68, s69
  s_cbranch_scc0 L_s3pd
  s_sleep 2
  s_add_u32 s70, s70, 1
  s_cmp_lt_u32 s70, 262144
  s_cbranch_scc1 L_s3p
L_s3pd:
  v_mov_b32 v8, s20
  v_mov_b32 v10, s24
  v_mov_b32 v16, s28
  v_max3_f32 v18, v8, v10, v16
  v_mov_b32 v19, 0x10000
  v_mov_b32 v9, s22
  v_mov_b32 v11, s26
  v_mov_b32 v17, s30
  s_xor_b32 s68, s23, s76
  s_xor_b32 s69, s27, s76
  s_or_b32 s68, s68, s69
  s_xor_b32 s69, s31, s76
  s_or_b32 s68, s68, s69
  s_cselect_b32 s68, 0, 1
  v_mov_b32 v3, s68
  s_mov_b64 exec, 1
  ds_add_u32 v38, v3 offset:6712
  ds_max_f32 v38, v18 offset:6676
  ds_write_b64 v38, v[8:9] offset:6856
  ds_write_b64 v38, v[10:11] offset:6864
  ds_write_b64 v38, v[16:17] offset:6872
  ds_add_u32 v38, v19 offset:6672
  s_mov_b64 exec, -1
L_tail:
  s_cmp_eq_u32 s60, 0
  s_cbranch_scc1 L_fin
  s_cmp_lg_u32 s60, 4
  s_cbranch_scc1 L_tl2
  s_branch L_fin
L_tl2:
  s_mov_b32 s70, 0
L_sn_51:
  ds_read_b32 v8, v38 offset:6704
  s_waitcnt lgkmcnt(0)
  v_cmp_gt_u32 vcc, 0xa, v8
  s_cmp_eq_u64 vcc, 0
  s_cbranch_scc1 L_snd_52
  s_sleep 8
  s_add_u32 s70, s70, 1
  s_cmp_lt_u32 s70, 2097152
  s_cbranch_scc1 L_sn_51
L_snd_52:
  s_cmp_eq_u32 s60, 1
  s_cbranch_scc1 L_t_wo0
  s_cmp_eq_u32 s60, 3
  s_cbranch_scc1 L_t_f2
  s_mov_b32 s70, 0
L_sn_53:
  ds_read_b32 v9, v38 offset:6720
  s_waitcnt lgkmcnt(0)
  v_cmp_gt_u32 vcc, 0x4, v9
  s_cmp_eq_u64 vcc, 0
  s_cbranch_scc1 L_snd_54
  s_sleep 8
  s_add_u32 s70, s70, 1
  s_cmp_lt_u32 s70, 2097152
  s_cbranch_scc1 L_sn_53
L_snd_54:
  s_branch L_t_f1
L_t_wo0:
L_t_wo:
  s_mov_b64 s[20:21], -1
  s_mov_b64 s[22:23], -1
  s_mov_b64 s[24:25], -1
  s_mov_b64 s[26:27], -1
  s_mov_b64 exec, s[20:21]
  global_load_dwordx4 v[152:155], v15, s[42:43] offset:0 sc1
  s_mov_b64 exec, s[22:23]
  global_load_dwordx4 v[156:159], v15, s[42:43] offset:512 sc1
  s_mov_b64 exec, s[24:25]
  global_load_dwordx4 v[160:163], v15, s[42:43] offset:1024 sc1
  s_mov_b64 exec, s[26:27]
  global_load_dwordx4 v[164:167], v15, s[42:43] offset:1536 sc1
  s_mov_b64 exec, -1
  s_waitcnt vmcnt(0)
  s_mov_b32 s70, 0
  s_branch L_wo_c
L_wo_:
  s_mov_b64 exec, s[20:21]
  global_load_dwordx4 v[152:155], v15, s[42:43] offset:0 sc1
  s_mov_b64 exec, s[22:23]
  global_load_dwordx4 v[156:159], v15, s[42:43] offset:512 sc1
  s_mov_b64 exec, s[24:25]
  global_load_dwordx4 v[160:163], v15, s[42:43] offset:1024 sc1
  s_mov_b64 exec, s[26:27]
  global_load_dwordx4 v[164:167], v15, s[42:43] offset:1536 sc1
  s_mov_b64 exec, -1
  s_waitcnt vmcnt(0)
L_wo_c:
  v_xor_b32 v136, s32, v152
  v_xor_b32 v137, s33, v153
  v_xor_b32 v138, s34, v154
  v_xor_b32 v139, s35, v155
  v_xor_b32 v140, s32, v156
  v_xor_b32 v141, s33, v157
  v_xor_b32 v142, s34, v158
  v_xor_b32 v143, s35, v159
  v_xor_b32 v144, s32, v160
  v_xor_b32 v145, s33, v161
  v_xor_b32 v146, s34, v162
  v_xor_b32 v147, s35, v163
  v_xor_b32 v148, s32, v164
  v_xor_b32 v149, s33, v165
  v_xor_b32 v150, s34, v166
  v_xor_b32 v151, s35, v167
  v_or3_b32 v28, v136, v137, v138
  v_or3_b32 v29, v140, v141, v142
  v_or3_b32 v30, v144, v145, v146
  v_or3_b32 v31, v148, v149, v150
  v_or_b32 v28, v28, v139
  v_or_b32 v29, v29, v143
  v_or_b32 v30, v30, v147
  v_or_b32 v31, v31, v151
  v_cmp_ne_u32_sdwa s[20:21], v28, v38 src0_sel:BYTE_0 src1_sel:DWORD
  v_cmp_ne_u32_sdwa s[22:23], v29, v38 src0_sel:BYTE_0 src1_sel:DWORD
  v_cmp_ne_u32_sdwa s[24:25], v30, v38 src0_sel:BYTE_0 src1_sel:DWORD
  v_cmp_ne_u32_sdwa s[26:27], v31, v38 src0_sel:BYTE_0 src1_sel:DWORD
  v_or_b32 v136, 0x80, v136
  v_or_b32 v137, 0x80, v137
  v_or_b32 v138, 0x80, v138
  v_or_b32 v139, 0x80, v139
  v_or_b32 v140, 0x80, v140
  v_or_b32 v141, 0x80, v141
  v_or_b32 v142, 0x80, v142
  v_or_b32 v143, 0x80, v143
  v_or_b32 v144, 0x80, v144
  v_or_b32 v145, 0x80, v145
  v_or_b32 v146, 0x80, v146
  v_or_b32 v147, 0x80, v147
  v_or_b32 v148, 0x80, v148
  v_or_b32 v149, 0x80, v149
  v_or_b32 v150, 0x80, v150
  v_or_b32 v151, 0x80, v151
  v_pk_add_f32 v[16:17], v[136:137], v[144:145]
  v_pk_add_f32 v[18:19], v[138:139], v[146:147]
  v_pk_add_f32 v[20:21], v[140:141], v[148:149]
  v_pk_add_f32 v[22:23], v[142:143], v[150:151]
  v_pk_add_f32 v[16:17], v[16:17], v[20:21]
  v_pk_add_f32 v[18:19], v[18:19], v[22:23]
  s_mov_b64 vcc, s[20:21]
  s_or_b64 vcc, vcc, s[22:23]
  s_or_b64 vcc, vcc, s[24:25]
  s_or_b64 vcc, vcc, s[26:27]
  s_or_b32 s20, s20, 1
  s_or_b32 s22, s22, 1
  s_or_b32 s24, s24, 1
  s_or_b32 s26, s26, 1
  s_cmp_eq_u64 vcc, 0
  s_cbranch_scc1 L_wo_ok
  s_add_u32 s70, s70, 1
  s_cmp_lt_u32 s70, 262144
  s_cbranch_scc1 L_wo_
L_wo_ok:
  v_cvt_pk_bf16_f32 v8, v16, v17
  v_cvt_pk_bf16_f32 v9, v18, v19
  ds_write_b64 v12, v[8:9] offset:0
  s_add_u32 s77, s77, 4
  v_mov_b32 v10, 1
  s_mov_b64 exec, 1
  ds_add_u32 v38, v10 offset:6720
  s_mov_b64 exec, -1
  s_mov_b32 s70, 0
L_hy_55:
  ds_read_b32 v10, v38 offset:6720
  s_waitcnt lgkmcnt(0)
  v_cmp_gt_u32 vcc, s77, v10
  s_cmp_eq_u64 vcc, 0
  s_cbranch_scc1 L_hyd_56
  s_add_u32 s70, s70, 1
  s_cmp_lt_u32 s70, 2097152
  s_cbranch_scc1 L_hy_55
L_hyd_56:
  ds_write_b32 v38, v38 offset:6700
  ds_read_b128 v[104:107], v14 offset:0
  ds_read_b128 v[108:111], v14 offset:64
  ds_read_b128 v[112:115], v14 offset:128
  ds_read_b128 v[116:119], v14 offset:192
  ds_read_b128 v[120:123], v14 offset:256
  ds_read_b128 v[124:127], v14 offset:320
  ds_read_b128 v[128:131], v14 offset:384
  ds_read_b128 v[132:135], v14 offset:448
  ds_read_b128 v[136:139], v14 offset:512
  ds_read_b128 v[140:143], v14 offset:576
  ds_read_b128 v[144:147], v14 offset:640
  ds_read_b128 v[148:151], v14 offset:704
  s_waitcnt lgkmcnt(11)
  v_mfma_f32_16x16x32_bf16 v[8:11], v[40:43], v[104:107], 0
  s_waitcnt lgkmcnt(10)
  v_mfma_f32_16x16x32_bf16 v[8:11], v[44:47], v[108:111], v[8:11]
  ds_read_b128 v[104:107], v14 offset:768
  s_waitcnt lgkmcnt(10)
  v_mfma_f32_16x16x32_bf16 v[8:11], v[48:51], v[112:115], v[8:11]
  ds_read_b128 v[108:111], v14 offset:832
  s_waitcnt lgkmcnt(10)
  v_mfma_f32_16x16x32_bf16 v[8:11], v[52:55], v[116:119], v[8:11]
  ds_read_b128 v[112:115], v14 offset:896
  s_waitcnt lgkmcnt(10)
  v_mfma_f32_16x16x32_bf16 v[8:11], v[56:59], v[120:123], v[8:11]
  ds_read_b128 v[116:119], v14 offset:960
  s_waitcnt lgkmcnt(10)
  v_mfma_f32_16x16x32_bf16 v[8:11], v[60:63], v[124:127], v[8:11]
  s_waitcnt lgkmcnt(9)
  v_mfma_f32_16x16x32_bf16 v[8:11], v[64:67], v[128:131], v[8:11]
  s_waitcnt lgkmcnt(8)
  v_mfma_f32_16x16x32_bf16 v[8:11], v[68:71], v[132:135], v[8:11]
  s_waitcnt lgkmcnt(7)
  v_mfma_f32_16x16x32_bf16 v[8:11], v[72:75], v[136:139], v[8:11]
  s_waitcnt lgkmcnt(6)
  v_mfma_f32_16x16x32_bf16 v[8:11], v[76:79], v[140:143], v[8:11]
  s_waitcnt lgkmcnt(5)
  v_mfma_f32_16x16x32_bf16 v[8:11], v[80:83], v[144:147], v[8:11]
  s_waitcnt lgkmcnt(4)
  v_mfma_f32_16x16x32_bf16 v[8:11], v[84:87], v[148:151], v[8:11]
  s_waitcnt lgkmcnt(3)
  v_mfma_f32_16x16x32_bf16 v[8:11], v[88:91], v[104:107], v[8:11]
  s_waitcnt lgkmcnt(2)
  v_mfma_f32_16x16x32_bf16 v[8:11], v[92:95], v[108:111], v[8:11]
  s_waitcnt lgkmcnt(1)
  v_mfma_f32_16x16x32_bf16 v[8:11], v[96:99], v[112:115], v[8:11]
  s_waitcnt lgkmcnt(0)
  v_mfma_f32_16x16x32_bf16 v[8:11], v[100:103], v[116:119], v[8:11]
  s_nop 7
  v_bfi_b32 v8, v36, s32, v8
  v_bfi_b32 v9, v36, s33, v9
  v_bfi_b32 v10, v36, s34, v10
  v_bfi_b32 v11, v36, s35, v11
  s_mov_b32 exec_lo, 0x00030003
  s_mov_b32 exec_hi, 0x00030003
  global_store_dwordx4 v13, v[8:11], s[42:43] sc1
  s_branch L_fin
L_t_f1:
  ds_read_b64_tr_b16 v[40:41], v2 offset:0
  ds_read_b64_tr_b16 v[42:43], v2 offset:512
  ds_read_b64_tr_b16 v[44:45], v2 offset:1024
  ds_read_b64_tr_b16 v[46:47], v2 offset:1536
  ds_read_b64_tr_b16 v[48:49], v2 offset:2048
  ds_read_b64_tr_b16 v[50:51], v2 offset:2560
  ds_read_b64_tr_b16 v[52:53], v2 offset:3072
  ds_read_b64_tr_b16 v[54:55], v2 offset:3584
  ds_read_b64_tr_b16 v[56:57], v2 offset:4096
  ds_read_b64_tr_b16 v[58:59], v2 offset:4608
  ds_read_b64_tr_b16 v[60:61], v2 offset:5120
  ds_read_b64_tr_b16 v[62:63], v2 offset:5632
  s_waitcnt lgkmcnt(10)
  ds_read_b64_tr_b16 v[64:65], v2 offset:6144
  ds_read_b64_tr_b16 v[66:67], v2 offset:6656
  s_waitcnt lgkmcnt(10)
  ds_read_b64_tr_b16 v[68:69], v2 offset:7168
  ds_read_b64_tr_b16 v[70:71], v2 offset:7680
  s_waitcnt lgkmcnt(10)
  ds_read_b64_tr_b16 v[72:73], v2 offset:8192
  ds_read_b64_tr_b16 v[74:75], v2 offset:8704
  s_waitcnt lgkmcnt(10)
  ds_read_b64_tr_b16 v[76:77], v2 offset:9216
  ds_read_b64_tr_b16 v[78:79], v2 offset:9728
  s_waitcnt lgkmcnt(10)
  ds_read_b64_tr_b16 v[80:81], v2 offset:10240
  ds_read_b64_tr_b16 v[82:83], v2 offset:10752
  s_waitcnt lgkmcnt(10)
  ds_read_b64_tr_b16 v[84:85], v2 offset:11264
  ds_read_b64_tr_b16 v[86:87], v2 offset:11776
  s_waitcnt lgkmcnt(10)
  ds_read_b64_tr_b16 v[88:89], v2 offset:12288
  ds_read_b64_tr_b16 v[90:91], v2 offset:12800
  s_waitcnt lgkmcnt(10)
  ds_read_b64_tr_b16 v[92:93], v2 offset:13312
  ds_read_b64_tr_b16 v[94:95], v2 offset:13824
  s_waitcnt lgkmcnt(10)
  ds_read_b64_tr_b16 v[96:97], v2 offset:14336
  ds_read_b64_tr_b16 v[98:99], v2 offset:14848
  s_waitcnt lgkmcnt(10)
  ds_read_b64_tr_b16 v[100:101], v2 offset:15360
  ds_read_b64_tr_b16 v[102:103], v2 offset:15872
  s_waitcnt lgkmcnt(10)
  s_waitcnt lgkmcnt(0)
  v_add_u32 v4, 8192, v15
  v_add_u32 v0, 16384, v15
  v_add_u32 v36, 24576, v15
  global_load_dwordx2 v[8:9], v37, s[16:17]
  s_mov_b32 s70, 0
L_pg_57:
  global_load_dwordx4 v[136:139], v39, s[42:43] offset:-4096 sc1
  global_load_dwordx4 v[140:143], v39, s[42:43] offset:0 sc1
  v_add_u32 v3, 4096, v39
  global_load_dwordx4 v[144:147], v3, s[42:43] sc1
  s_waitcnt vmcnt(0)
  s_mov_b64 vcc, 0
  v_cmp_ne_u32 s[68:69], s74, v137
  s_or_b64 vcc, vcc, s[68:69]
  v_cmp_ne_u32 s[68:69], s74, v139
  s_or_b64 vcc, vcc, s[68:69]
  v_cmp_ne_u32 s[68:69], s74, v141
  s_or_b64 vcc, vcc, s[68:69]
  v_cmp_ne_u32 s[68:69], s74, v143
  s_or_b64 vcc, vcc, s[68:69]
  v_cmp_ne_u32 s[68:69], s74, v145
  s_or_b64 vcc, vcc, s[68:69]
  v_cmp_ne_u32 s[68:69], s74, v147
  s_or_b64 vcc, vcc, s[68:69]
  s_cmp_eq_u64 vcc, 0
  s_cbranch_scc1 L_pge_58
  s_sleep 8
  s_add_u32 s70, s70, 1
  s_cmp_lt_u32 s70, 262144
  s_cbranch_scc1 L_pg_57
L_pge_58:
  v_and_b32 v39, 1, v1
  v_lshlrev_b32 v39, 6, v39
  v_add_u32 v39, 139136, v39
  v_lshrrev_b32 v3, 4, v1
  v_lshl_add_u32 v37, v3, 4, v39
  v_bfe_u32 v3, v1, 1, 3
  v_lshlrev_b32 v3, 7, v3
  v_sub_u32 v37, v37, v3
  v_bfe_u32 v3, v1, 4, 1
  v_lshl_add_u32 v39, v3, 3, v39
  v_lshrrev_b32 v3, 5, v1
  v_lshl_add_u32 v39, v3, 2, v39
  s_lshl_b32 s49, s5, 4
  v_add_u32 v39, s49, v39
  v_lshlrev_b32 v16, 16, v8
  v_and_b32 v17, s73, v8
  v_lshlrev_b32 v18, 16, v9
  v_and_b32 v19, s73, v9
  v_lshlrev_b32 v20, 16, v136
  v_and_b32 v21, s73, v136
  v_lshlrev_b32 v22, 16, v138
  v_and_b32 v23, s73, v138
  v_lshlrev_b32 v28, 16, v144
  v_and_b32 v29, s73, v144
  v_lshlrev_b32 v30, 16, v146
  v_and_b32 v31, s73, v146
  v_add_f32 v28, 1.0, v28
  v_add_f32 v29, 1.0, v29
  v_add_f32 v30, 1.0, v30
  v_add_f32 v31, 1.0, v31
  v_cvt_pk_bf16_f32 v8, v28, v29
  v_cvt_pk_bf16_f32 v9, v30, v31
  v_mov_b32 v141, v142
  ds_write_b64 v12, v[8:9] offset:2112
  ds_write_b64 v12, v[140:141] offset:4224
  v_cvt_pk_bf16_f32 v28, 0, v28
  v_cvt_pk_bf16_f32 v29, 0, v29
  v_cvt_pk_bf16_f32 v30, 0, v30
  v_cvt_pk_bf16_f32 v31, 0, v31
  v_mul_f32 v24, v20, v28
  v_mul_f32 v25, v21, v29
  v_mul_f32 v26, v22, v30
  v_mul_f32 v27, v23, v31
  v_mul_f32 v28, v16, v28
  v_mul_f32 v29, v17, v29
  v_mul_f32 v30, v18, v30
  v_mul_f32 v31, v19, v31
  s_waitcnt lgkmcnt(0)
  ds_read_b32 v8, v38 offset:6696
  s_waitcnt lgkmcnt(0)
  v_subrev_u32 v8, 1024, v8
  v_mul_i32_i24 v8, 8, v8
  v_ashrrev_i32 v8, 4, v8
  v_add_u32 v9, 1032, v8
  s_mov_b32 s70, 0
L_af_59:
  ds_read_b32 v8, v38 offset:6696
  s_waitcnt lgkmcnt(0)
  v_cmp_lt_u32 vcc, v9, v8
  s_cmp_eq_u64 vcc, 0
  s_cbranch_scc1 L_afd_60
  s_sleep 4
  s_add_u32 s70, s70, 1
  s_cmp_lt_u32 s70, 2097152
  s_cbranch_scc1 L_af_59
L_afd_60:
  s_mov_b32 s70, 0
  s_mov_b32 s71, 15
L_f1_p:
  s_add_u32 s70, s70, 1
  s_cmp_ge_u32 s70, 262144
  s_cbranch_scc1 L_f1_ok
  s_bitcmp1_b32 s71, 0
  s_cbranch_scc0 L_fl_61
  global_load_dwordx4 v[104:107], v15, s[42:43] offset:-4096 sc1
  global_load_dwordx4 v[108:111], v15, s[42:43] offset:0 sc1
L_fl_61:
  s_bitcmp1_b32 s71, 1
  s_cbranch_scc0 L_fl_62
  global_load_dwordx4 v[112:115], v4, s[42:43] offset:-4096 sc1
  global_load_dwordx4 v[116:119], v4, s[42:43] offset:0 sc1
L_fl_62:
  s_bitcmp1_b32 s71, 2
  s_cbranch_scc0 L_fl_63
  global_load_dwordx4 v[120:123], v0, s[42:43] offset:-4096 sc1
  global_load_dwordx4 v[124:127], v0, s[42:43] offset:0 sc1
L_fl_63:
  s_bitcmp1_b32 s71, 3
  s_cbranch_scc0 L_fl_64
  global_load_dwordx4 v[128:131], v36, s[42:43] offset:-4096 sc1
  global_load_dwordx4 v[132:135], v36, s[42:43] offset:0 sc1
L_fl_64:
  s_waitcnt vmcnt(0)
  s_bitcmp1_b32 s71, 0
  s_cbranch_scc0 L_fc_65
  v_xor_b32 v104, s32, v104
  v_xor_b32 v105, s33, v105
  v_xor_b32 v106, s34, v106
  v_xor_b32 v107, s35, v107
  v_xor_b32 v108, s32, v108
  v_xor_b32 v109, s33, v109
  v_xor_b32 v110, s34, v110
  v_xor_b32 v111, s35, v111
  v_or3_b32 v8, v104, v105, v106
  v_or3_b32 v9, v107, v108, v109
  v_or3_b32 v8, v8, v110, v111
  v_pk_add_f32 v[136:137], v[104:105], v[108:109]
  v_pk_add_f32 v[138:139], v[106:107], v[110:111]
  v_or_b32 v8, v8, v9
  v_lshlrev_b32 v8, 24, v8
  v_cmp_ne_u32 vcc, 0, v8
  s_cmp_lg_u64 vcc, 0
  s_cbranch_scc1 L_fc_65
  s_bitset0_b32 s71, 0
L_fc_65:
  s_bitcmp1_b32 s71, 1
  s_cbranch_scc0 L_fc_66
  v_xor_b32 v112, s32, v112
  v_xor_b32 v113, s33, v113
  v_xor_b32 v114, s34, v114
  v_xor_b32 v115, s35, v115
  v_xor_b32 v116, s32, v116
  v_xor_b32 v117, s33, v117
  v_xor_b32 v118, s34, v118
  v_xor_b32 v119, s35, v119
  v_or3_b32 v8, v112, v113, v114
  v_or3_b32 v9, v115, v116, v117
  v_or3_b32 v8, v8, v118, v119
  v_pk_add_f32 v[144:145], v[112:113], v[116:117]
  v_pk_add_f32 v[146:147], v[114:115], v[118:119]
  v_or_b32 v8, v8, v9
  v_lshlrev_b32 v8, 24, v8
  v_cmp_ne_u32 vcc, 0, v8
  s_cmp_lg_u64 vcc, 0
  s_cbranch_scc1 L_fc_66
  s_bitset0_b32 s71, 1
L_fc_66:
  s_bitcmp1_b32 s71, 2
  s_cbranch_scc0 L_fc_67
  v_xor_b32 v120, s32, v120
  v_xor_b32 v121, s33, v121
  v_xor_b32 v122, s34, v122
  v_xor_b32 v123, s35, v123
  v_xor_b32 v124, s32, v124
  v_xor_b32 v125, s33, v125
  v_xor_b32 v126, s34, v126
  v_xor_b32 v127, s35, v127
  v_or3_b32 v8, v120, v121, v122
  v_or3_b32 v9, v123, v124, v125
  v_or3_b32 v8, v8, v126, v127
  v_pk_add_f32 v[152:153], v[120:121], v[124:125]
  v_pk_add_f32 v[154:155], v[122:123], v[126:127]
  v_or_b32 v8, v8, v9
  v_lshlrev_b32 v8, 24, v8
  v_cmp_ne_u32 vcc, 0, v8
  s_cmp_lg_u64 vcc, 0
  s_cbranch_scc1 L_fc_67
  s_bitset0_b32 s71, 2
L_fc_67:
  s_bitcmp1_b32 s71, 3
  s_cbranch_scc0 L_fc_68
  v_xor_b32 v128, s32, v128
  v_xor_b32 v129, s33, v129
  v_xor_b32 v130, s34, v130
  v_xor_b32 v131, s35, v131
  v_xor_b32 v132, s32, v132
  v_xor_b32 v133, s33, v133
  v_xor_b32 v134, s34, v134
  v_xor_b32 v135, s35, v135
  v_or3_b32 v8, v128, v129, v130
  v_or3_b32 v9, v131, v132, v133
  v_or3_b32 v8, v8, v134, v135
  v_pk_add_f32 v[160:161], v[128:129], v[132:133]
  v_pk_add_f32 v[162:163], v[130:131], v[134:135]
  v_or_b32 v8, v8, v9
  v_lshlrev_b32 v8, 24, v8
  v_cmp_ne_u32 vcc, 0, v8
  s_cmp_lg_u64 vcc, 0
  s_cbranch_scc1 L_fc_68
  s_bitset0_b32 s71, 3
L_fc_68:
  s_cmp_lg_u32 s71, 0
  s_cbranch_scc1 L_f1_p
L_f1_ok:
  v_pk_add_f32 v[136:137], v[136:137], v[144:145]
  v_pk_add_f32 v[138:139], v[138:139], v[146:147]
  v_pk_add_f32 v[152:153], v[152:153], v[160:161]
  v_pk_add_f32 v[154:155], v[154:155], v[162:163]
  v_pk_add_f32 v[136:137], v[136:137], v[152:153]
  v_pk_add_f32 v[138:139], v[138:139], v[154:155]
  v_pk_fma_f32 v[8:9], v[136:137], v[24:25], v[28:29]
  v_pk_fma_f32 v[10:11], v[138:139], v[26:27], v[30:31]
  v_cvt_pk_bf16_f32 v8, v8, v9
  v_cvt_pk_bf16_f32 v9, v10, v11
  ds_write_b64 v12, v[8:9] offset:0
  v_pk_fma_f32 v[16:17], v[136:137], v[20:21], v[16:17]
  v_pk_fma_f32 v[18:19], v[138:139], v[22:23], v[18:19]
  v_add_f32 v24, v16, v17
  v_mul_f32 v25, v16, v16
  v_add_f32 v26, v18, v19
  v_mul_f32 v27, v18, v18
  v_fmac_f32 v25, v17, v17
  v_fmac_f32 v27, v19, v19
  v_pk_add_f32 v[24:25], v[24:25], v[26:27]
  s_nop 1
  v_add_f32_dpp v24, v24, v24 quad_perm:[1,0,3,2] row_mask:0xf bank_mask:0xf
  v_add_f32_dpp v25, v25, v25 quad_perm:[1,0,3,2] row_mask:0xf bank_mask:0xf
  s_nop 0
  v_add_f32_dpp v24, v24, v24 quad_perm:[2,3,0,1] row_mask:0xf bank_mask:0xf
  v_add_f32_dpp v25, v25, v25 quad_perm:[2,3,0,1] row_mask:0xf bank_mask:0xf
  ds_write_b64 v5, v[24:25]
  s_add_u32 s77, s77, 4
  v_mov_b32 v10, 1
  s_mov_b64 exec, 1
  ds_add_u32 v38, v10 offset:6720
  s_mov_b64 exec, -1
  s_mov_b32 s70, 0
L_hy_69:
  ds_read_b32 v10, v38 offset:6720
  s_waitcnt lgkmcnt(0)
  v_cmp_gt_u32 vcc, s77, v10
  s_cmp_eq_u64 vcc, 0
  s_cbranch_scc1 L_hyd_70
  s_add_u32 s70, s70, 1
  s_cmp_lt_u32 s70, 2097152
  s_cbranch_scc1 L_hy_69
L_hyd_70:
  ds_read_b128 v[104:107], v14 offset:0
  ds_read_b128 v[108:111], v14 offset:64
  ds_read_b128 v[112:115], v14 offset:128
  ds_read_b128 v[116:119], v14 offset:192
  ds_read_b64 v[20:21], v7
  ds_read_b128 v[120:123], v14 offset:256
  ds_read_b128 v[124:127], v14 offset:320
  ds_read_b128 v[128:131], v14 offset:384
  ds_read_b128 v[132:135], v14 offset:448
  ds_read_b128 v[136:139], v14 offset:512
  ds_read_b128 v[140:143], v14 offset:576
  ds_read_b128 v[144:147], v14 offset:640
  ds_read_b128 v[148:151], v14 offset:704
  s_waitcnt lgkmcnt(12)
  v_mfma_f32_16x16x32_bf16 v[32:35], v[40:43], v[104:107], 0
  ds_read_b128 v[152:155], v14 offset:768
  s_waitcnt lgkmcnt(12)
  v_mfma_f32_16x16x32_bf16 v[32:35], v[44:47], v[108:111], v[32:35]
  ds_read_b128 v[156:159], v14 offset:832
  s_waitcnt lgkmcnt(12)
  v_mfma_f32_16x16x32_bf16 v[32:35], v[48:51], v[112:115], v[32:35]
  ds_read_b128 v[160:163], v14 offset:896
  s_waitcnt lgkmcnt(12)
  v_mfma_f32_16x16x32_bf16 v[32:35], v[52:55], v[116:119], v[32:35]
  ds_read_b128 v[164:167], v14 offset:960
  s_waitcnt lgkmcnt(11)
  v_mfma_f32_16x16x32_bf16 v[32:35], v[56:59], v[120:123], v[32:35]
  v_add_f32_dpp v20, v20, v20 quad_perm:[2,3,0,1] row_mask:0xf bank_mask:0xf
  v_add_f32_dpp v21, v21, v21 quad_perm:[2,3,0,1] row_mask:0xf bank_mask:0xf
  s_waitcnt lgkmcnt(10)
  v_mfma_f32_16x16x32_bf16 v[32:35], v[60:63], v[124:127], v[32:35]
  v_add_f32_dpp v20, v20, v20 row_ror:4 row_mask:0xf bank_mask:0xf
  v_add_f32_dpp v21, v21, v21 row_ror:4 row_mask:0xf bank_mask:0xf
  s_waitcnt lgkmcnt(9)
  v_mfma_f32_16x16x32_bf16 v[32:35], v[64:67], v[128:131], v[32:35]
  v_add_f32_dpp v20, v20, v20 row_ror:8 row_mask:0xf bank_mask:0xf
  v_add_f32_dpp v21, v21, v21 row_ror:8 row_mask:0xf bank_mask:0xf
  s_waitcnt lgkmcnt(8)
  v_mfma_f32_16x16x32_bf16 v[32:35], v[68:71], v[132:135], v[32:35]
  v_mov_b32 v22, v20
  v_mov_b32 v23, v21
  s_waitcnt lgkmcnt(7)
  v_mfma_f32_16x16x32_bf16 v[32:35], v[72:75], v[136:139], v[32:35]
  v_permlane16_swap_b32 v22, v20
  v_permlane16_swap_b32 v23, v21
  s_waitcnt lgkmcnt(6)
  v_mfma_f32_16x16x32_bf16 v[32:35], v[76:79], v[140:143], v[32:35]
  v_pk_add_f32 v[20:21], v[20:21], v[22:23]
  v_mov_b32 v22, v20
  v_mov_b32 v23, v21
  s_waitcnt lgkmcnt(5)
  v_mfma_f32_16x16x32_bf16 v[32:35], v[80:83], v[144:147], v[32:35]
  v_permlane32_swap_b32 v22, v20
  v_permlane32_swap_b32 v23, v21
  s_waitcnt lgkmcnt(4)
  v_mfma_f32_16x16x32_bf16 v[32:35], v[84:87], v[148:151], v[32:35]
  v_pk_add_f32 v[20:21], v[20:21], v[22:23]
  v_mul_f32 v20, 0xbb000000, v20
  s_waitcnt lgkmcnt(3)
  v_mfma_f32_16x16x32_bf16 v[32:35], v[88:91], v[152:155], v[32:35]
  v_mul_f32 v21, 0x3b000000, v21
  v_fma_f32 v21, -v20, v20, v21
  s_waitcnt lgkmcnt(2)
  v_mfma_f32_16x16x32_bf16 v[32:35], v[92:95], v[156:159], v[32:35]
  v_max_f32 v21, 0, v21
  v_add_f32 v21, 0x3727c5ac, v21
  s_waitcnt lgkmcnt(1)
  v_mfma_f32_16x16x32_bf16 v[32:35], v[96:99], v[160:163], v[32:35]
  v_rsq_f32 v21, v21
  s_waitcnt lgkmcnt(0)
  v_mfma_f32_16x16x32_bf16 v[32:35], v[100:103], v[164:167], v[32:35]
  ds_read_b64_tr_b16 v[40:41], v6 offset:0
  ds_read_b64_tr_b16 v[42:43], v6 offset:4224
  ds_read_b64_tr_b16 v[44:45], v6 offset:32
  ds_read_b64_tr_b16 v[46:47], v6 offset:4256
  ds_read_b64_tr_b16 v[48:49], v6 offset:64
  ds_read_b64_tr_b16 v[50:51], v6 offset:4288
  ds_read_b64_tr_b16 v[52:53], v6 offset:96
  ds_read_b64_tr_b16 v[54:55], v6 offset:4320
  v_fmac_f32_dpp v32, v32, v20 row_shl:2 row_mask:0xf bank_mask:0x1
  v_fmac_f32_dpp v33, v33, v20 row_shl:2 row_mask:0xf bank_mask:0x1
  v_fmac_f32_dpp v34, v34, v20 row_shl:2 row_mask:0xf bank_mask:0x1
  v_fmac_f32_dpp v35, v35, v20 row_shl:2 row_mask:0xf bank_mask:0x1
  v_mul_f32 v8, v32, v21
  v_mul_f32 v9, v33, v21
  v_mul_f32 v10, v34, v21
  v_mul_f32 v11, v35, v21
  v_add_f32_dpp v8, v32, v8 row_shl:4 row_mask:0xf bank_mask:0xf
  v_add_f32_dpp v9, v33, v9 row_shl:4 row_mask:0xf bank_mask:0xf
  v_add_f32_dpp v10, v34, v10 row_shl:4 row_mask:0xf bank_mask:0xf
  v_add_f32_dpp v11, v35, v11 row_shl:4 row_mask:0xf bank_mask:0xf
  s_waitcnt lgkmcnt(4)
  ds_read_b64_tr_b16 v[56:57], v6 offset:128
  ds_read_b64_tr_b16 v[58:59], v6 offset:4352
  ds_read_b64_tr_b16 v[60:61], v6 offset:160
  ds_read_b64_tr_b16 v[62:63], v6 offset:4384
  ds_read_b64_tr_b16 v[64:65], v6 offset:192
  ds_read_b64_tr_b16 v[66:67], v6 offset:4416
  ds_read_b64_tr_b16 v[68:69], v6 offset:224
  ds_read_b64_tr_b16 v[70:71], v6 offset:4448
  v_permlane32_swap_b32 v8, v10
  v_permlane32_swap_b32 v9, v11
  v_mul_f32 v20, 0xbfb8aa3b, v8
  v_mul_f32 v21, 0xbfb8aa3b, v9
  v_exp_f32 v20, v20
  v_exp_f32 v21, v21
  v_mul_f32 v8, v8, v10
  v_mul_f32 v9, v9, v11
  v_add_f32 v20, 1.0, v20
  v_add_f32 v21, 1.0, v21
  v_rcp_f32 v20, v20
  v_rcp_f32 v21, v21
  s_mov_b32 exec_lo, 0x00030003
  s_mov_b32 exec_hi, 0x00030003
  v_mul_f32 v8, v8, v20
  v_mul_f32 v9, v9, v21
  v_cvt_pk_bf16_f32 v8, v8, v9
  ds_write_b32 v39, v8
  s_mov_b64 exec, -1
  s_add_u32 s77, s77, 4
  v_mov_b32 v10, 1
  s_mov_b64 exec, 1
  ds_add_u32 v38, v10 offset:6720
  s_mov_b64 exec, -1
  s_mov_b32 s70, 0
L_hy_71:
  ds_read_b32 v10, v38 offset:6720
  s_waitcnt lgkmcnt(0)
  v_cmp_gt_u32 vcc, s77, v10
  s_cmp_eq_u64 vcc, 0
  s_cbranch_scc1 L_hyd_72
  s_add_u32 s70, s70, 1
  s_cmp_lt_u32 s70, 2097152
  s_cbranch_scc1 L_hy_71
L_hyd_72:
  ds_read_b128 v[104:107], v37 offset:0
  ds_read_b128 v[108:111], v37 offset:128
  ds_read_b128 v[112:115], v37 offset:256
  ds_read_b128 v[116:119], v37 offset:384
  ds_read_b128 v[120:123], v37 offset:512
  ds_read_b128 v[124:127], v37 offset:640
  ds_read_b128 v[128:131], v37 offset:768
  ds_read_b128 v[132:135], v37 offset:896
  v_mov_b32 v3, 0xff
  s_waitcnt lgkmcnt(7)
  v_mfma_f32_16x16x32_bf16 v[8:11], v[40:43], v[104:107], 0
  s_waitcnt lgkmcnt(6)
  v_mfma_f32_16x16x32_bf16 v[8:11], v[44:47], v[108:111], v[8:11]
  s_waitcnt lgkmcnt(5)
  v_mfma_f32_16x16x32_bf16 v[8:11], v[48:51], v[112:115], v[8:11]
  s_waitcnt lgkmcnt(4)
  v_mfma_f32_16x16x32_bf16 v[8:11], v[52:55], v[116:119], v[8:11]
  s_waitcnt lgkmcnt(3)
  v_mfma_f32_16x16x32_bf16 v[8:11], v[56:59], v[120:123], v[8:11]
  s_waitcnt lgkmcnt(2)
  v_mfma_f32_16x16x32_bf16 v[8:11], v[60:63], v[124:127], v[8:11]
  s_waitcnt lgkmcnt(1)
  v_mfma_f32_16x16x32_bf16 v[8:11], v[64:67], v[128:131], v[8:11]
  s_waitcnt lgkmcnt(0)
  v_mfma_f32_16x16x32_bf16 v[8:11], v[68:71], v[132:135], v[8:11]
  s_nop 7
  v_bfi_b32 v8, v3, s32, v8
  v_bfi_b32 v9, v3, s33, v9
  v_bfi_b32 v10, v3, s34, v10
  v_bfi_b32 v11, v3, s35, v11
  global_store_dwordx4 v13, v[8:11], s[42:43] sc1
  s_branch L_fin
L_t_f2:
  s_cmp_lg_u32 s5, 3
  s_cbranch_scc1 L_fin
  global_load_dwordx2 v[8:9], v37, s[16:17]
  s_mov_b32 s70, 0
L_pg_73:
  global_load_dwordx4 v[136:139], v39, s[42:43] offset:-4096 sc1
  v_add_u32 v3, 8192, v39
  global_load_dwordx4 v[140:143], v3, s[42:43] sc1
  s_waitcnt vmcnt(0)
  s_mov_b64 vcc, 0
  v_cmp_ne_u32 s[68:69], s74, v137
  s_or_b64 vcc, vcc, s[68:69]
  v_cmp_ne_u32 s[68:69], s74, v139
  s_or_b64 vcc, vcc, s[68:69]
  v_cmp_ne_u32 s[68:69], s74, v141
  s_or_b64 vcc, vcc, s[68:69]
  v_cmp_ne_u32 s[68:69], s74, v143
  s_or_b64 vcc, vcc, s[68:69]
  s_cmp_eq_u64 vcc, 0
  s_cbranch_scc1 L_pge_74
  s_sleep 8
  s_add_u32 s70, s70, 1
  s_cmp_lt_u32 s70, 262144
  s_cbranch_scc1 L_pg_73
L_pge_74:
  v_lshlrev_b32 v16, 16, v8
  v_and_b32 v17, s73, v8
  v_lshlrev_b32 v18, 16, v9
  v_and_b32 v19, s73, v9
  v_lshlrev_b32 v20, 16, v136
  v_and_b32 v21, s73, v136
  v_lshlrev_b32 v22, 16, v138
  v_and_b32 v23, s73, v138
  v_lshlrev_b32 v24, 16, v140
  v_and_b32 v25, s73, v140
  v_lshlrev_b32 v26, 16, v142
  v_and_b32 v27, s73, v142
  s_mov_b32 s70, 0
L_f2_a:
  global_load_dwordx4 v[136:139], v15, s[42:43] sc1
  s_waitcnt vmcnt(0)
  v_xor_b32 v136, s32, v136
  v_xor_b32 v137, s33, v137
  v_xor_b32 v138, s34, v138
  v_xor_b32 v139, s35, v139
  v_or3_b32 v3, v136, v137, v138
  v_or_b32 v3, v3, v139
  v_lshlrev_b32 v3, 24, v3
  v_cmp_ne_u32 vcc, 0, v3
  s_cmp_eq_u64 vcc, 0
  s_cbranch_scc1 L_f2_ad
  s_sleep 8
  s_add_u32 s70, s70, 1
  s_cmp_lt_u32 s70, 262144
  s_cbranch_scc1 L_f2_a
L_f2_ad:
  s_cmp_lg_u32 s61, 0
  s_cbranch_scc1 L_f2_e
  v_mov_b32 v10, s74
  s_mov_b64 exec, 1
  global_store_dword v38, v10, s[42:43] offset:0 sc1
  s_mov_b64 exec, -1
L_f2_e:
  s_nop 1
  v_add_f32_dpp v136, v136, v136 row_ror:8 row_mask:0xf bank_mask:0xf
  v_add_f32_dpp v137, v137, v137 row_ror:8 row_mask:0xf bank_mask:0xf
  v_add_f32_dpp v138, v138, v138 row_ror:8 row_mask:0xf bank_mask:0xf
  v_add_f32_dpp v139, v139, v139 row_ror:8 row_mask:0xf bank_mask:0xf
  v_mov_b32 v140, v136
  v_mov_b32 v141, v137
  v_mov_b32 v142, v138
  v_mov_b32 v143, v139
  v_permlane16_swap_b32 v140, v136
  v_permlane16_swap_b32 v141, v137
  v_permlane16_swap_b32 v142, v138
  v_permlane16_swap_b32 v143, v139
  v_add_f32 v136, v136, v140
  v_add_f32 v137, v137, v141
  v_add_f32 v138, v138, v142
  v_add_f32 v139, v139, v143
  v_mov_b32 v140, v136
  v_mov_b32 v141, v137
  v_mov_b32 v142, v138
  v_mov_b32 v143, v139
  v_permlane32_swap_b32 v140, v136
  v_permlane32_swap_b32 v141, v137
  v_permlane32_swap_b32 v142, v138
  v_permlane32_swap_b32 v143, v139
  v_add_f32 v136, v136, v140
  v_add_f32 v137, v137, v141
  v_add_f32 v138, v138, v142
  v_add_f32 v139, v139, v143
  v_cvt_pk_bf16_f32 v136, 0, v136
  v_cvt_pk_bf16_f32 v137, 0, v137
  v_cvt_pk_bf16_f32 v138, 0, v138
  v_cvt_pk_bf16_f32 v139, 0, v139
  v_mul_f32 v136, v136, v20
  v_mul_f32 v137, v137, v21
  v_mul_f32 v138, v138, v22
  v_mul_f32 v139, v139, v23
  v_cvt_pk_bf16_f32 v136, 0, v136
  v_cvt_pk_bf16_f32 v137, 0, v137
  v_cvt_pk_bf16_f32 v138, 0, v138
  v_cvt_pk_bf16_f32 v139, 0, v139
  v_add_f32 v16, v16, v136
  v_add_f32 v17, v17, v137
  v_add_f32 v18, v18, v138
  v_add_f32 v19, v19, v139
  v_cvt_pk_bf16_f32 v16, 0, v16
  v_cvt_pk_bf16_f32 v17, 0, v17
  v_cvt_pk_bf16_f32 v18, 0, v18
  v_cvt_pk_bf16_f32 v19, 0, v19
  v_add_u32 v28, 32768, v15
  v_add_u32 v29, 65536, v15
  v_add_u32 v30, 98304, v15
  v_add_u32 v31, 131072, v15
  v_add_u32 v32, 163840, v15
  v_add_u32 v33, 196608, v15
  s_mov_b32 s70, 0
L_f2_p:
  v_mov_b32 v124, s32
  v_mov_b32 v125, s33
  v_mov_b32 v126, s34
  v_mov_b32 v127, s35
  global_load_dwordx4 v[104:107], v28, s[42:43] sc1
  global_load_dwordx4 v[108:111], v29, s[42:43] sc1
  global_load_dwordx4 v[112:115], v30, s[42:43] sc1
  global_load_dwordx4 v[116:119], v31, s[42:43] sc1
  global_load_dwordx4 v[120:123], v32, s[42:43] sc1
  s_mov_b64 exec, 0xffffff
  global_load_dwordx4 v[124:127], v33, s[42:43] sc1
  s_mov_b64 exec, -1
  s_waitcnt vmcnt(5)
  v_xor_b32 v104, s32, v104
  v_xor_b32 v105, s33, v105
  v_xor_b32 v106, s34, v106
  v_xor_b32 v107, s35, v107
  s_waitcnt vmcnt(4)
  v_xor_b32 v108, s32, v108
  v_xor_b32 v109, s33, v109
  v_xor_b32 v110, s34, v110
  v_xor_b32 v111, s35, v111
  s_waitcnt vmcnt(3)
  v_xor_b32 v112, s32, v112
  v_xor_b32 v113, s33, v113
  v_xor_b32 v114, s34, v114
  v_xor_b32 v115, s35, v115
  s_waitcnt vmcnt(2)
  v_xor_b32 v116, s32, v116
  v_xor_b32 v117, s33, v117
  v_xor_b32 v118, s34, v118
  v_xor_b32 v119, s35, v119
  s_waitcnt vmcnt(1)
  v_xor_b32 v120, s32, v120
  v_xor_b32 v121, s33, v121
  v_xor_b32 v122, s34, v122
  v_xor_b32 v123, s35, v123
  s_waitcnt vmcnt(0)
  v_xor_b32 v124, s32, v124
  v_xor_b32 v125, s33, v125
  v_xor_b32 v126, s34, v126
  v_xor_b32 v127, s35, v127
  v_or3_b32 v8, v104, v105, v106
  v_or3_b32 v9, v110, v111, v112
  v_or3_b32 v10, v116, v117, v118
  v_or3_b32 v11, v122, v123, v124
  v_or3_b32 v8, v8, v107, v108
  v_or3_b32 v9, v9, v113, v114
  v_or3_b32 v10, v10, v119, v120
  v_or3_b32 v11, v11, v125, v126
  v_or_b32 v8, v8, v109
  v_or_b32 v9, v9, v115
  v_or_b32 v10, v10, v121
  v_or_b32 v11, v11, v127
  v_or3_b32 v3, v8, v9, v10
  v_or_b32 v3, v3, v11
  v_lshlrev_b32 v3, 24, v3
  v_cmp_ne_u32 vcc, 0, v3
  s_cmp_eq_u64 vcc, 0
  s_cbranch_scc1 L_f2_ok
  s_add_u32 s70, s70, 1
  s_cmp_lt_u32 s70, 262144
  s_cbranch_scc1 L_f2_p
L_f2_ok:
  v_pk_add_f32 v[104:105], v[104:105], v[108:109]
  v_pk_add_f32 v[106:107], v[106:107], v[110:111]
  v_pk_add_f32 v[112:113], v[112:113], v[116:117]
  v_pk_add_f32 v[114:115], v[114:115], v[118:119]
  v_pk_add_f32 v[120:121], v[120:121], v[124:125]
  v_pk_add_f32 v[122:123], v[122:123], v[126:127]
  v_pk_add_f32 v[104:105], v[104:105], v[112:113]
  v_pk_add_f32 v[106:107], v[106:107], v[114:115]
  v_pk_add_f32 v[104:105], v[104:105], v[120:121]
  v_pk_add_f32 v[106:107], v[106:107], v[122:123]
  s_nop 1
  v_add_f32_dpp v104, v104, v104 row_ror:8 row_mask:0xf bank_mask:0xf
  v_add_f32_dpp v105, v105, v105 row_ror:8 row_mask:0xf bank_mask:0xf
  v_add_f32_dpp v106, v106, v106 row_ror:8 row_mask:0xf bank_mask:0xf
  v_add_f32_dpp v107, v107, v107 row_ror:8 row_mask:0xf bank_mask:0xf
  v_mov_b32 v108, v104
  v_mov_b32 v109, v105
  v_mov_b32 v110, v106
  v_mov_b32 v111, v107
  v_permlane16_swap_b32 v108, v104
  v_permlane16_swap_b32 v109, v105
  v_permlane16_swap_b32 v110, v106
  v_permlane16_swap_b32 v111, v107
  v_add_f32 v104, v104, v108
  v_add_f32 v105, v105, v109
  v_add_f32 v106, v106, v110
  v_add_f32 v107, v107, v111
  v_mov_b32 v108, v104
  v_mov_b32 v109, v105
  v_mov_b32 v110, v106
  v_mov_b32 v111, v107
  v_permlane32_swap_b32 v108, v104
  v_permlane32_swap_b32 v109, v105
  v_permlane32_swap_b32 v110, v106
  v_permlane32_swap_b32 v111, v107
  v_add_f32 v104, v104, v108
  v_add_f32 v105, v105, v109
  v_add_f32 v106, v106, v110
  v_add_f32 v107, v107, v111
  v_cvt_pk_bf16_f32 v104, 0, v104
  v_cvt_pk_bf16_f32 v105, 0, v105
  v_cvt_pk_bf16_f32 v106, 0, v106
  v_cvt_pk_bf16_f32 v107, 0, v107
  v_mul_f32 v104, v104, v24
  v_mul_f32 v105, v105, v25
  v_mul_f32 v106, v106, v26
  v_mul_f32 v107, v107, v27
  v_cvt_pk_bf16_f32 v104, 0, v104
  v_cvt_pk_bf16_f32 v105, 0, v105
  v_cvt_pk_bf16_f32 v106, 0, v106
  v_cvt_pk_bf16_f32 v107, 0, v107
  v_add_f32 v8, v104, v16
  v_add_f32 v9, v105, v17
  v_add_f32 v10, v106, v18
  v_add_f32 v11, v107, v19
  v_cvt_pk_bf16_f32 v8, v8, v9
  v_cvt_pk_bf16_f32 v9, v10, v11
  s_mov_b64 exec, 0xff
  global_store_dwordx2 v37, v[8:9], s[38:39] sc1
  s_mov_b64 exec, 1
  v_mov_b32 v10, s74
  s_lshl_b32 s49, s61, 7
  s_add_u32 s49, s49, 28672
  v_mov_b32 v11, s49
  global_store_dword v11, v10, s[42:43] sc1
L_fin:
  s_cmp_lg_u32 s5, 0
  s_cbranch_scc1 L_fin2
  s_mov_b64 exec, -1
  s_mov_b32 s70, 0
L_sn_75:
  ds_read_b32 v8, v38 offset:6708
  s_waitcnt lgkmcnt(0)
  v_cmp_gt_u32 vcc, 0x4, v8
  s_cmp_eq_u64 vcc, 0
  s_cbranch_scc1 L_snd_76
  s_sleep 8
  s_add_u32 s70, s70, 1
  s_cmp_lt_u32 s70, 2097152
  s_cbranch_scc1 L_sn_75
L_snd_76:
  s_waitcnt vmcnt(0)
  v_lshlrev_b32 v72, 3, v1
  ds_read_b128 v[60:63], v38 offset:6784
  ds_read_b128 v[64:67], v38 offset:6800
  ds_read_b128 v[68:71], v38 offset:6816
  ds_read_b64 v[40:41], v72 offset:13056
  ds_read_b64 v[42:43], v72 offset:13568
  ds_read_b64 v[44:45], v72 offset:14080
  ds_read_b64 v[46:47], v72 offset:14592
  ds_read_b64 v[48:49], v72 offset:15104
  ds_read_b64 v[50:51], v72 offset:15616
  ds_read_b64 v[52:53], v72 offset:16128
  ds_read_b64 v[54:55], v72 offset:16640
  ds_read_b64 v[56:57], v72 offset:17152
  ds_read_b64 v[58:59], v72 offset:17664
  s_lshl_b32 s68, s6, 2
  s_add_u32 s68, s68, s7
  s_lshl_b32 s68, s68, 9
  s_add_u32 s68, s68, 131072
  v_add_u32 v72, s68, v72
  v_and_b32 v73, 1, v1
  v_lshlrev_b32 v73, 4, v73
  v_lshrrev_b32 v73, v73, s74
  v_lshrrev_b32 v74, 8, v73
  s_movk_i32 s69, 0xff
  s_waitcnt lgkmcnt(9)
  v_pk_mul_f32 v[40:41], v[40:41], v[60:61] op_sel:[0,0] op_sel_hi:[1,0]
  s_waitcnt lgkmcnt(8)
  v_pk_mul_f32 v[42:43], v[42:43], v[60:61] op_sel:[0,1] op_sel_hi:[1,1]
  s_waitcnt lgkmcnt(7)
  v_pk_fma_f32 v[40:41], v[44:45], v[62:63], v[40:41] op_sel:[0,0,0] op_sel_hi:[1,0,1]
  s_waitcnt lgkmcnt(6)
  v_pk_fma_f32 v[42:43], v[46:47], v[62:63], v[42:43] op_sel:[0,1,0] op_sel_hi:[1,1,1]
  s_waitcnt lgkmcnt(5)
  v_pk_fma_f32 v[40:41], v[48:49], v[64:65], v[40:41] op_sel:[0,0,0] op_sel_hi:[1,0,1]
  s_waitcnt lgkmcnt(4)
  v_pk_fma_f32 v[42:43], v[50:51], v[64:65], v[42:43] op_sel:[0,1,0] op_sel_hi:[1,1,1]
  s_waitcnt lgkmcnt(3)
  v_pk_fma_f32 v[40:41], v[52:53], v[66:67], v[40:41] op_sel:[0,0,0] op_sel_hi:[1,0,1]
  s_waitcnt lgkmcnt(2)
  v_pk_fma_f32 v[42:43], v[54:55], v[66:67], v[42:43] op_sel:[0,1,0] op_sel_hi:[1,1,1]
  s_waitcnt lgkmcnt(1)
  v_pk_fma_f32 v[40:41], v[56:57], v[68:69], v[40:41] op_sel:[0,0,0] op_sel_hi:[1,0,1]
  s_waitcnt lgkmcnt(0)
  v_pk_fma_f32 v[42:43], v[58:59], v[68:69], v[42:43] op_sel:[0,1,0] op_sel_hi:[1,1,1]
  v_pk_add_f32 v[40:41], v[40:41], v[42:43]
  v_bfi_b32 v40, s69, v73, v40
  v_bfi_b32 v41, s69, v74, v41
  global_store_dwordx2 v72, v[40:41], s[42:43] sc1
L_fin2:
L_end:
  s_endpgm
.p2align 7
L_table:
  .long 0xffda000e, 0x10000008, 0x34a34a10, 0, 0xffda0806, 0x10000008, 0x34a34a10, 0
  .long 0xffda1016, 0x10000008, 0x34a34a10, 0, 0xffda1806, 0x10000008, 0x34a34a10, 0
  .long 0xffda2006, 0x10000008, 0x34a34a10, 0, 0xffda2806, 0x10000008, 0x34a34a10, 0
  .long 0xffda3006, 0x10000008, 0x34a34a10, 0, 0xffda3806, 0x10000008, 0x34a34a10, 0
  .long 0xffda010e, 0x10000008, 0x34a34a10, 0, 0xffda0906, 0x10000008, 0x34a34a10, 0
  .long 0xffda1116, 0x10000008, 0x34a34a10, 0, 0xffda1906, 0x10000008, 0x34a34a10, 0
  .long 0xffda2106, 0x10000008, 0x34a34a10, 0, 0xffda2906, 0x10000008, 0x34a34a10, 0
  .long 0xffda3106, 0x10000008, 0x34a34a10, 0, 0xffda3906, 0x10000008, 0x34a34a10, 0
  .long 0xffda020e, 0x10000008, 0x34a34a10, 0, 0xffda0a06, 0x10000008, 0x34a34a10, 0
  .long 0xffda1216, 0x10000008, 0x34a34a10, 0, 0xffda1a06, 0x10000008, 0x34a34a10, 0
  .long 0xffda2206, 0x10000008, 0x34a34a10, 0, 0xffda2a06, 0x10000008, 0x34a34a10, 0
  .long 0xffda3206, 0x10000008, 0x34a34a10, 0, 0xffda3a06, 0x10000008, 0x34a34a10, 0
  .long 0xffda030e, 0x10000008, 0x40540510, 0, 0xffda0b06, 0x10000008, 0x40540510, 0
  .long 0xffda1316, 0x10000008, 0x40540510, 0, 0xffda1b06, 0x10000008, 0x40540510, 0
  .long 0xffda2306, 0x10000008, 0x40540510, 0, 0xffda2b06, 0x10000008, 0x40540510, 0
  .long 0xffda3306, 0x10000008, 0x40540510, 0, 0xffda3b06, 0x10000008, 0x40540510, 0
  .long 0xffda040e, 0x10000008, 0x34a34a10, 0, 0xffda0c06, 0x10000008, 0x34a34a10, 0
  .long 0xffda1416, 0x10000008, 0x34a34a10, 0, 0xffda1c06, 0x10000008, 0x34a34a10, 0
  .long 0xffda2406, 0x10000008, 0x34a34a10, 0, 0xffda2c06, 0x10000008, 0x34a34a10, 0
  .long 0xffda3406, 0x10000008, 0x34a34a10, 0, 0xffda3c06, 0x10000008, 0x34a34a10, 0
  .long 0xffda050e, 0x10000008, 0x34a34a10, 0, 0xffda0d06, 0x10000008, 0x34a34a10, 0
  .long 0xffda1516, 0x10000008, 0x34a34a10, 0, 0xffda1d06, 0x10000008, 0x34a34a10, 0
  .long 0xffda2506, 0x10000008, 0x34a34a10, 0, 0xffda2d06, 0x10000008, 0x34a34a10, 0
  .long 0xffda3506, 0x10000008, 0x34a34a10, 0, 0xffda3d06, 0x10000008, 0x34a34a10, 0
  .long 0xffda060e, 0x10000008, 0x34a34a10, 0, 0xffda0e06, 0x10000008, 0x34a34a10, 0
  .long 0xffda1616, 0x10000008, 0x34a34a10, 0, 0xffda1e06, 0x10000008, 0x34a34a10, 0
  .long 0xffda2606, 0x10000008, 0x34a34a10, 0, 0xffda2e06, 0x10000008, 0x34a34a10, 0
  .long 0xffda3606, 0x10000008, 0x34a34a10, 0, 0xffda3e06, 0x10000008, 0x34a34a10, 0
  .long 0xffda070e, 0x10000008, 0x34a34a10, 0, 0xffda0f06, 0x10000008, 0x34a34a10, 0
  .long 0xffda1716, 0x10000008, 0x34a34a10, 0, 0xffda1f06, 0x10000008, 0x34a34a10, 0
  .long 0xffda2706, 0x10000008, 0x34a34a10, 0, 0xffda2f06, 0x10000008, 0x34a34a10, 0
  .long 0xffda3706, 0x10000008, 0x34a34a10, 0, 0xffda3f06, 0x10000008, 0x34a34a10, 0
  .long 0x004d0009, 0x10000008, 0x32924310, 0, 0x004d0001, 0x10000008, 0x32924310, 0
  .long 0x004d0011, 0x10000008, 0x32924310, 0, 0x004d0001, 0x10000008, 0x32924310, 0
  .long 0x004d0001, 0x10000008, 0x32924310, 0, 0x004d0001, 0x10000008, 0x32924310, 0
  .long 0x004d0001, 0x10000008, 0x32924310, 0, 0x004d0001, 0x10000008, 0x32924310, 0
  .long 0x004d0109, 0x10000008, 0x32924310, 0, 0x004d0101, 0x10000008, 0x32924310, 0
  .long 0x004d0111, 0x10000008, 0x32924310, 0, 0x004d0101, 0x10000008, 0x32924310, 0
  .long 0x004d0101, 0x10000008, 0x32924310, 0, 0x004d0101, 0x10000008, 0x32924310, 0
  .long 0x004d0101, 0x10000008, 0x32924310, 0, 0x004d0101, 0x10000008, 0x32924310, 0
  .long 0x004d0209, 0x10000008, 0x32924310, 0, 0x004d0201, 0x10000008, 0x32924310, 0
  .long 0x004d0211, 0x10000008, 0x32924310, 0, 0x004d0201, 0x10000008, 0x32924310, 0
  .long 0x004d0201, 0x10000008, 0x32924310, 0, 0x004d0201, 0x10000008, 0x32924310, 0
  .long 0x004d0201, 0x10000008, 0x32924310, 0, 0x004d0201, 0x10000008, 0x32924310, 0
  .long 0x00330309, 0x10000008, 0x34325c10, 0, 0x00330301, 0x10000008, 0x34325c10, 0
  .long 0x00330311, 0x10000008, 0x34325c10, 0, 0x00330301, 0x10000008, 0x34325c10, 0
  .long 0x00330301, 0x10000008, 0x34325c10, 0, 0x00330301, 0x10000008, 0x34325c10, 0
  .long 0x00330301, 0x10000008, 0x34325c10, 0, 0x00330301, 0x10000008, 0x34325c10, 0
  .long 0x004d0409, 0x10000008, 0x32924310, 0, 0x004d0401, 0x10000008, 0x32924310, 0
  .long 0x004d0411, 0x10000008, 0x32924310, 0, 0x004d0401, 0x10000008, 0x32924310, 0
  .long 0x004d0401, 0x10000008, 0x32924310, 0, 0x004d0401, 0x10000008, 0x32924310, 0
  .long 0x004d0401, 0x10000008, 0x32924310, 0, 0x004d0401, 0x10000008, 0x32924310, 0
  .long 0x004d0509, 0x10000008, 0x32924310, 0, 0x004d0501, 0x10000008, 0x32924310, 0
  .long 0x004d0511, 0x10000008, 0x32924310, 0, 0x004d0501, 0x10000008, 0x32924310, 0
  .long 0x004d0501, 0x10000008, 0x32924310, 0, 0x004d0501, 0x10000008, 0x32924310, 0
  .long 0x004d0501, 0x10000008, 0x32924310, 0, 0x004d0501, 0x10000008, 0x32924310, 0
  .long 0x004d0609, 0x10000008, 0x32924310, 0, 0x004d0601, 0x10000008, 0x32924310, 0
  .long 0x004d0611, 0x10000008, 0x32924310, 0, 0x004d0601, 0x10000008, 0x32924310, 0
  .long 0x004d0601, 0x10000008, 0x32924310, 0, 0x004d0601, 0x10000008, 0x32924310, 0
  .long 0x004d0601, 0x10000008, 0x32924310, 0, 0x004d0601, 0x10000008, 0x32924310, 0
  .long 0x004d0709, 0x10000008, 0x32924310, 0, 0x004d0701, 0x10000008, 0x32924310, 0
  .long 0x004d0711, 0x10000008, 0x32924310, 0, 0x004d0701, 0x10000008, 0x32924310, 0
  .long 0x004d0701, 0x10000008, 0x32924310, 0, 0x004d0701, 0x10000008, 0x32924310, 0
  .long 0x004d0701, 0x10000008, 0x32924310, 0, 0x004d0701, 0x10000008, 0x32924310, 0
  .long 0x0000030d, 0x10000008, 0x37337310, 0, 0x00000405, 0x10000008, 0x37337310, 0
  .long 0x00000515, 0x10000008, 0x37337310, 0, 0x00000605, 0x10000008, 0x37337310, 0
  .long 0x00000705, 0x10000008, 0x37337310, 0, 0x00000005, 0x10000008, 0x37337310, 0
  .long 0x00000105, 0x10000008, 0x37337310, 0, 0x00000205, 0x10000008, 0x37337310, 0
  .long 0x0000090d, 0x10000008, 0x37337310, 0, 0x00000a05, 0x10000008, 0x37337310, 0
  .long 0x00000b15, 0x10000008, 0x37337310, 0, 0x00000c05, 0x10000008, 0x37337310, 0
  .long 0x00000d05, 0x10000008, 0x37337310, 0, 0x00000e05, 0x10000008, 0x37337310, 0
  .long 0x00000f05, 0x10000008, 0x37337310, 0, 0x00000805, 0x10000008, 0x37337310, 0
  .long 0x0000150c, 0x10000008, 0x32c24510, 0, 0x00001604, 0x10000008, 0x32c24510, 0
  .long 0x00001714, 0x10000008, 0x32c24510, 0, 0x00001004, 0x10000008, 0x32c24510, 0
  .long 0x00001104, 0x10000008, 0x32c24510, 0, 0x00001204, 0x10000008, 0x32c24510, 0
  .long 0x00001304, 0x10000008, 0x38029a10, 0, 0x00001404, 0x10000008, 0x32c24510, 0
  .long 0x00001f0c, 0x10000008, 0x32c24510, 0, 0x00001804, 0x10000008, 0x32c24510, 0
  .long 0x00001914, 0x10000008, 0x32c24510, 0, 0x00001a04, 0x10000008, 0x32c24510, 0
  .long 0x00001b04, 0x10000008, 0x38029a10, 0, 0x00001c04, 0x10000008, 0x32c24510, 0
  .long 0x00001d04, 0x10000008, 0x32c24510, 0, 0x00001e04, 0x10000008, 0x32c24510, 0
  .long 0x0000220c, 0x10000008, 0x32c24510, 0, 0x00002304, 0x10000008, 0x38029a10, 0
  .long 0x00002414, 0x10000008, 0x32c24510, 0, 0x00002504, 0x10000008, 0x32c24510, 0
  .long 0x00002604, 0x10000008, 0x32c24510, 0, 0x00002704, 0x10000008, 0x32c24510, 0
  .long 0x00002004, 0x10000008, 0x32c24510, 0, 0x00002104, 0x10000008, 0x32c24510, 0
  .long 0x00002c0c, 0x10000008, 0x32c24510, 0, 0x00002d04, 0x10000008, 0x32c24510, 0
  .long 0x00002e14, 0x10000008, 0x32c24510, 0, 0x00a60f02, 0x12503f17, 0x3bd2d710, 0
  .long 0x00002804, 0x10000008, 0x32c24510, 0, 0x00a61a02, 0x12503f17, 0x3bd2d710, 0
  .long 0x00a62002, 0x12503f17, 0x3bd2d710, 0, 0x00002b04, 0x10000008, 0x38029a10, 0
  .long 0x0180000a, 0x15503f26, 0x41a33310, 0, 0x01800502, 0x15503f26, 0x41a33310, 0
  .long 0x01800a12, 0x15503f26, 0x41a33310, 0, 0x00a61002, 0x12503f17, 0x3bd2d710, 0
  .long 0x01801502, 0x15503f26, 0x41a33310, 0, 0x00a61b02, 0x12503f17, 0x3bd2d710, 0
  .long 0x00a62102, 0x12503f17, 0x3bd2d710, 0, 0x01802602, 0x15503f26, 0x41a33310, 0
  .long 0x0033000b, 0x0cd35e8a, 0x40031a10, 0, 0x00330403, 0x0cd35e8a, 0x39a2b310, 0
  .long 0x00330813, 0x0cd35e8a, 0x40031a10, 0, 0x00330c03, 0x0cd3dd8a, 0x39a2b310, 0
  .long 0x00331003, 0x0cd35e8a, 0x39a2b310, 0, 0x00331403, 0x0cd3dd8a, 0x39a2b310, 0
  .long 0x00331803, 0x0cd3dd8a, 0x39a2b310, 0, 0x00331c03, 0x0cd35e8a, 0x39a2b310, 0
  .long 0x0180010a, 0x15503f26, 0x41a33310, 0, 0x01800602, 0x15503f26, 0x41a33310, 0
  .long 0x01800b12, 0x15503f26, 0x41a33310, 0, 0x01801102, 0x15503f26, 0x41a33310, 0
  .long 0x01801602, 0x15503f26, 0x41a33310, 0, 0x01801c02, 0x15503f26, 0x41a33310, 0
  .long 0x01802202, 0x15503f26, 0x41a33310, 0, 0x01802702, 0x15503f26, 0x41a33310, 0
  .long 0x0033010b, 0x0cd31c8a, 0x40031a10, 0, 0x00330503, 0x0cd31c8a, 0x39a2b310, 0
  .long 0x00330913, 0x0cd31c8a, 0x40031a10, 0, 0x00330d03, 0x0cd31c8a, 0x39a2b310, 0
  .long 0x00331103, 0x0cd31c8a, 0x39a2b310, 0, 0x00331503, 0x0cd31c8a, 0x39a2b310, 0
  .long 0x00331903, 0x0cd31c8a, 0x39a2b310, 0, 0x00331d03, 0x0cd31c8a, 0x39a2b310, 0
  .long 0x0180020a, 0x15503f26, 0x41a33310, 0, 0x01800702, 0x15503f26, 0x41a33310, 0
  .long 0x01800c12, 0x15503f26, 0x41a33310, 0, 0x01801202, 0x15503f26, 0x41a33310, 0
  .long 0x01801702, 0x15503f26, 0x41a33310, 0, 0x01801d02, 0x15503f26, 0x41a33310, 0
  .long 0x01802302, 0x15503f26, 0x41a33310, 0, 0x01802802, 0x15503f26, 0x41a33310, 0
  .long 0x0033020b, 0x0cd35e8a, 0x40031a10, 0, 0x00330603, 0x0cd35e8a, 0x39a2b310, 0
  .long 0x00330a13, 0x0cd35e8a, 0x40031a10, 0, 0x00330e03, 0x0cd35e8a, 0x39a2b310, 0
  .long 0x00331203, 0x0cd35e8a, 0x39a2b310, 0, 0x00331603, 0x0cd35e8a, 0x39a2b310, 0
  .long 0x00331a03, 0x0cd35e8a, 0x39a2b310, 0, 0x00331e03, 0x0cd35e8a, 0x39a2b310, 0
  .long 0x0180030a, 0x15503f26, 0x41a33310, 0, 0x01800802, 0x15503f26, 0x41a33310, 0
  .long 0x01800d12, 0x15503f26, 0x41a33310, 0, 0x00002f04, 0x10000008, 0x32c24510, 0
  .long 0x01801802, 0x15503f26, 0x41a33310, 0, 0x00002904, 0x10000008, 0x32c24510, 0
  .long 0x00002a04, 0x10000008, 0x32c24510, 0, 0x01802902, 0x15503f26, 0x41a33310, 0
  .long 0x0033030b, 0x0cd31c8a, 0x40031a10, 0, 0x00330703, 0x0cd31c8a, 0x39a2b310, 0
  .long 0x00330b13, 0x0cd31c8a, 0x40031a10, 0, 0x00a61302, 0x12503f17, 0x3bd2d710, 0
  .long 0x00331303, 0x0cd31c8a, 0x39a2b310, 0, 0x00a61e02, 0x12503f17, 0x3bd2d710, 0
  .long 0x00a62402, 0x12503f17, 0x3bd2d710, 0, 0x00331f03, 0x0cd31c8a, 0x39a2b310, 0
  .long 0x0180040a, 0x15503f26, 0x41a33310, 0, 0x01800902, 0x15503f26, 0x41a33310, 0
  .long 0x01800e12, 0x15503f26, 0x41a33310, 0, 0x00a61402, 0x12503f17, 0x3bd2d710, 0
  .long 0x01801902, 0x15503f26, 0x41a33310, 0, 0x00a61f02, 0x12503f17, 0x3bd2d710, 0
  .long 0x00a62502, 0x12503f17, 0x3bd2d710, 0, 0x01802a02, 0x15503f26, 0x41a33310, 0
  .long 0x00330008, 0x0cd35e8a, 0x39a2b310, 0, 0x00330000, 0x0cd35e8a, 0x39a2b310, 0
  .long 0x00330010, 0x0cd35e8a, 0x39a2b310, 0, 0x00330f03, 0x0cd3dd8a, 0x39a2b310, 0
  .long 0x00330000, 0x0cd35e8a, 0x39a2b310, 0, 0x00331703, 0x0cd3dd8a, 0x39a2b310, 0
  .long 0x00331b03, 0x0cd3dd8a, 0x39a2b310, 0, 0x00330000, 0x0cd35e8a, 0x39a2b310, 0
.section .rodata,"a"
.p2align 6
.amdhsa_kernel adaLN_cond__sliding_block_cached__glu_gated_swiglu__decode_kernel
  .amdhsa_next_free_vgpr 168
  .amdhsa_next_free_sgpr 102
  .amdhsa_accum_offset 168
  .amdhsa_group_segment_fixed_size 0
  .amdhsa_kernarg_size 112
  .amdhsa_user_sgpr_count 2
  .amdhsa_user_sgpr_kernarg_segment_ptr 1
  .amdhsa_system_sgpr_workgroup_id_x 1
.end_amdhsa_kernel
```

```asm
; @launch grid=(256,1,1) block=(768,1,1) lds=140288
.amdgcn_target "amdgcn-amd-amdhsa--gfx950"
.text
.globl adaLN_cond__sliding_block_cached__glu_gated_swiglu__decode_kernel
.p2align 8
.type adaLN_cond__sliding_block_cached__glu_gated_swiglu__decode_kernel,@function
adaLN_cond__sliding_block_cached__glu_gated_swiglu__decode_kernel:
  s_cmp_ge_u32 s2, 256
  s_cbranch_scc1 L_end
  s_load_dwordx16 s[16:31], s[0:1], 0
  s_load_dwordx8 s[32:39], s[0:1], 64
  s_load_dwordx4 s[40:43], s[0:1], 96
  s_getpc_b64 s[56:57]
L_pc:
  s_lshl_b32 s3, s2, 4
  s_add_u32 s3, s3, L_table-L_pc
  s_and_b32 s13, s2, 0xe8
  s_cmp_eq_u32 s13, 0xc8
  s_cselect_b32 s13, 0, 0
  s_cmp_lt_u32 s2, 144
  s_cselect_b32 s13, 1, s13
  s_cmp_lt_u32 s2, 128
  s_cselect_b32 s13, 0, s13
  s_cmp_lt_u32 s2, 64
  s_cselect_b32 s13, 2, s13
  v_lshrrev_b32 v2, 6, v0
  v_and_b32 v1, 63, v0
  v_readfirstlane_b32 s5, v2
  s_bfe_u32 s7, s2, 0x20003
  s_bfe_u32 s6, s2, 0x20005
  s_and_b32 s8, s2, 7
  s_lshl_b32 s9, s8, 2
  s_add_u32 s6, s6, s9
  s_lshr_b32 s9, s2, 7
  s_lshl_b32 s9, s9, 5
  s_add_u32 s6, s6, s9
  s_mov_b32 s72, 0xfffffffe
  s_mov_b32 s73, 0xffff0000
  s_cmp_lt_u32 s5, 4
  s_cbranch_scc1 L_helper
  s_sub_u32 s9, s5, 4
  s_lshl_b32 s4, s7, 18
  s_lshl_b32 s11, s9, 10
L_stream:
  s_lshl_b32 s10, s6, 22
  s_add_u32 s10, s10, s4
  s_add_u32 s10, s10, 0x300000
  v_lshl_add_u32 v0, v1, 4, s11
  s_lshr_b32 s12, s2, 3
  s_mul_i32 s12, s12, 5
  s_mul_i32 s15, s8, 3
  s_add_u32 s12, s12, s15
  s_lshl_b32 s12, s12, 13
  s_and_b32 s12, s12, 0x3ffff
  s_waitcnt lgkmcnt(0)
  s_add_u32 s44, s18, s10
  s_addc_u32 s45, s19, 0
  s_mov_b32 s46, 0x40000
  s_mov_b32 s47, 0x20000
  s_cmp_le_i32 s13, 0
  s_cbranch_scc1 L_nb1
  s_barrier
L_nb1:
  buffer_load_dwordx4 v[40:43], v0, s[44:47], s12 offen nt
  s_add_u32 s12, s12, 0x2000
  s_and_b32 s12, s12, 0x3ffff
  buffer_load_dwordx4 v[44:47], v0, s[44:47], s12 offen nt
  s_add_u32 s12, s12, 0x2000
  s_and_b32 s12, s12, 0x3ffff
  buffer_load_dwordx4 v[48:51], v0, s[44:47], s12 offen nt
  s_add_u32 s12, s12, 0x2000
  s_and_b32 s12, s12, 0x3ffff
  buffer_load_dwordx4 v[52:55], v0, s[44:47], s12 offen nt
  s_add_u32 s12, s12, 0x2000
  s_and_b32 s12, s12, 0x3ffff
  s_load_dwordx2 s[14:15], s[56:57], s3
  s_load_dword s77, s[56:57], s3 offset:8
  s_load_dword s74, s[42:43], 0
  s_add_u32 s48, s20, s10
  s_addc_u32 s49, s21, 0
  s_mov_b32 s50, 0x40000
  s_mov_b32 s51, 0x20000
  s_mov_b32 s52, 0xcccccccc
  s_mov_b32 s53, 0xcccccccc
  s_mov_b32 s54, 0xaaaaaaaa
  s_mov_b32 s55, 0xaaaaaaaa
  v_and_b32 v38, 15, v1
  v_lshlrev_b32 v38, 4, v38
  s_lshl_b32 s10, s9, 11
  s_add_u32 s10, s10, 83968
  v_lshl_add_u32 v3, v1, 3, s10
  v_mov_b32 v4, 0x7fff0000
  v_mov_b32 v5, 0xff800000
  ds_write_b64 v3, v[4:5] offset:0
  ds_write_b64 v3, v[4:5] offset:512
  ds_write_b64 v3, v[4:5] offset:1024
  v_lshrrev_b32 v3, 4, v1
  v_lshl_add_u32 v39, v38, 1, s10
  v_lshl_add_u32 v39, v3, 3, v39
  s_sub_u32 s68, s12, 32768
  v_bfrev_b32 v24, v1
  v_lshrrev_b32 v24, 15, v24
  v_and_b32 v24, 0x1e000, v24
  v_add_u32 v24, s68, v24
  v_and_b32 v24, 0x3e000, v24
  v_lshl_add_u32 v24, v3, 8, v24
  v_add_u32 v24, s11, v24
  v_xor_b32 v26, 0x20000, v24
  s_lshl_b32 s11, s9, 9
  v_lshl_add_u32 v22, v38, 1, s11
  v_lshl_add_u32 v22, v3, 3, v22
  s_mov_b32 s32, 4
  s_mul_i32 s33, s9, 0x5e000000
  s_mov_b64 s[64:65], 0
  s_mov_b64 s[66:67], 0
  s_mov_b32 s38, 0
  s_mov_b32 s39, 0
  s_mov_b32 s75, 0
  s_mov_b32 s61, 0
  s_lshl_b32 s40, s6, 9
  s_lshl_b32 s68, s9, 6
  s_add_u32 s40, s40, s68
  s_add_u32 s40, s40, 32768
  s_cmp_eq_u32 s13, 0
  s_cbranch_scc0 L_nb2
  s_barrier
L_nb2:
  s_waitcnt lgkmcnt(0)
  s_mov_b32 s56, s10
  s_mul_i32 s74, s74, 0x9e3779b1
  s_add_u32 s74, s74, 0x7f4a7c15
  s_and_b32 s57, s77, 0xff
  s_bfe_u32 s34, s77, 0xc0008
  s_lshr_b32 s58, s77, 20
  s_and_b32 s76, s15, 15
  s_mov_b32 s41, 5
  s_mov_b32 s35, 28
  s_mov_b32 s59, 0
  s_mul_i32 s68, s76, 28
  s_add_u32 s68, s68, 1024
  v_mov_b32 v20, s68
  v_mov_b32 v21, 0
  v_mov_b32 v23, 0
  s_cmp_ge_u32 s9, 8
  s_cselect_b32 s39, 2, 0
  s_bfe_u32 s68, s15, 0x20004
  s_add_u32 s68, s68, s9
  s_lshr_b32 s69, s9, 3
  s_lshr_b32 s68, s68, 3
  s_cmp_lg_u32 s68, s69
  s_cbranch_scc1 L_away
  s_call_b64 s[62:63], L_ks
  buffer_load_dwordx4 v[56:59], v0, s[44:47], s12 offen nt
  s_add_u32 s12, s12, 0x2000
  s_and_b32 s12, s12, 0x3ffff
  s_call_b64 s[62:63], L_ks
  buffer_load_dwordx4 v[60:63], v0, s[44:47], s12 offen nt
  s_add_u32 s12, s12, 0x2000
  s_and_b32 s12, s12, 0x3ffff
  s_call_b64 s[62:63], L_ks
  buffer_load_dwordx4 v[64:67], v0, s[44:47], s12 offen nt
  s_add_u32 s12, s12, 0x2000
  s_and_b32 s12, s12, 0x3ffff
  s_call_b64 s[62:63], L_ks
  buffer_load_dwordx4 v[68:71], v0, s[44:47], s12 offen nt
  s_add_u32 s12, s12, 0x2000
  s_and_b32 s12, s12, 0x3ffff
  s_call_b64 s[62:63], L_ks
  buffer_load_dwordx4 v[72:75], v0, s[44:47], s12 offen nt
  s_add_u32 s12, s12, 0x2000
  s_and_b32 s12, s12, 0x3ffff
  s_call_b64 s[62:63], L_ks
  buffer_load_dwordx4 v[76:79], v0, s[44:47], s12 offen nt
  s_add_u32 s12, s12, 0x2000
  s_and_b32 s12, s12, 0x3ffff
  s_call_b64 s[62:63], L_ks
  buffer_load_dwordx4 v[80:83], v0, s[44:47], s12 offen nt
  s_add_u32 s12, s12, 0x2000
  s_and_b32 s12, s12, 0x3ffff
  s_call_b64 s[62:63], L_ks
  buffer_load_dwordx4 v[84:87], v0, s[44:47], s12 offen nt
  s_add_u32 s12, s12, 0x2000
  s_and_b32 s12, s12, 0x3ffff
  s_call_b64 s[62:63], L_ks
  buffer_load_dwordx4 v[88:91], v0, s[44:47], s12 offen nt
  s_add_u32 s12, s12, 0x2000
  s_and_b32 s12, s12, 0x3ffff
  s_call_b64 s[62:63], L_ks
  buffer_load_dwordx4 v[92:95], v0, s[44:47], s12 offen nt
  s_add_u32 s12, s12, 0x2000
  s_and_b32 s12, s12, 0x3ffff
  s_call_b64 s[62:63], L_ks
  buffer_load_dwordx4 v[96:99], v0, s[44:47], s12 offen nt
  s_add_u32 s12, s12, 0x2000
  s_and_b32 s12, s12, 0x3ffff
  s_call_b64 s[62:63], L_ks
  buffer_load_dwordx4 v[100:103], v0, s[44:47], s12 offen nt
  s_add_u32 s12, s12, 0x2000
  s_and_b32 s12, s12, 0x3ffff
  s_call_b64 s[62:63], L_ks
  buffer_load_dwordx4 v[104:107], v0, s[44:47], s12 offen nt
  s_add_u32 s12, s12, 0x2000
  s_and_b32 s12, s12, 0x3ffff
  s_call_b64 s[62:63], L_ks
  buffer_load_dwordx4 v[108:111], v0, s[44:47], s12 offen nt
  s_add_u32 s12, s12, 0x2000
  s_and_b32 s12, s12, 0x3ffff
  s_call_b64 s[62:63], L_ks
  buffer_load_dwordx4 v[112:115], v0, s[44:47], s12 offen nt
  s_add_u32 s12, s12, 0x2000
  s_and_b32 s12, s12, 0x3ffff
  s_call_b64 s[62:63], L_ks
  buffer_load_dwordx4 v[116:119], v0, s[44:47], s12 offen nt
  s_add_u32 s12, s12, 0x2000
  s_and_b32 s12, s12, 0x3ffff
  s_call_b64 s[62:63], L_ks
  buffer_load_dwordx4 v[120:123], v0, s[44:47], s12 offen nt
  s_add_u32 s12, s12, 0x2000
  s_and_b32 s12, s12, 0x3ffff
  s_call_b64 s[62:63], L_ks
  buffer_load_dwordx4 v[124:127], v0, s[44:47], s12 offen nt
  s_add_u32 s12, s12, 0x2000
  s_and_b32 s12, s12, 0x3ffff
  s_call_b64 s[62:63], L_ks
  buffer_load_dwordx4 v[128:131], v0, s[44:47], s12 offen nt
  s_add_u32 s12, s12, 0x2000
  s_and_b32 s12, s12, 0x3ffff
  s_call_b64 s[62:63], L_ks
  buffer_load_dwordx4 v[132:135], v0, s[44:47], s12 offen nt
  s_add_u32 s12, s12, 0x2000
  s_and_b32 s12, s12, 0x3ffff
  s_call_b64 s[62:63], L_ks
  buffer_load_dwordx4 v[136:139], v0, s[44:47], s12 offen nt
  s_add_u32 s12, s12, 0x2000
  s_and_b32 s12, s12, 0x3ffff
  s_call_b64 s[62:63], L_ks
  buffer_load_dwordx4 v[140:143], v0, s[44:47], s12 offen nt
  s_add_u32 s12, s12, 0x2000
  s_and_b32 s12, s12, 0x3ffff
  s_call_b64 s[62:63], L_ks
  buffer_load_dwordx4 v[144:147], v0, s[44:47], s12 offen nt
  s_add_u32 s12, s12, 0x2000
  s_and_b32 s12, s12, 0x3ffff
  s_call_b64 s[62:63], L_ks
  buffer_load_dwordx4 v[148:151], v0, s[44:47], s12 offen nt
  s_add_u32 s12, s12, 0x2000
  s_and_b32 s12, s12, 0x3ffff
  s_call_b64 s[62:63], L_ks
  buffer_load_dwordx4 v[152:155], v0, s[44:47], s12 offen nt
  s_add_u32 s12, s12, 0x2000
  s_and_b32 s12, s12, 0x3ffff
  s_call_b64 s[62:63], L_ks
  buffer_load_dwordx4 v[156:159], v0, s[44:47], s12 offen nt
  s_add_u32 s12, s12, 0x2000
  s_and_b32 s12, s12, 0x3ffff
  s_call_b64 s[62:63], L_ks
  buffer_load_dwordx4 v[160:163], v0, s[44:47], s12 offen nt
  s_add_u32 s12, s12, 0x2000
  s_and_b32 s12, s12, 0x3ffff
  s_call_b64 s[62:63], L_ks
  buffer_load_dwordx4 v[164:167], v0, s[44:47], s12 offen nt
  s_add_u32 s12, s12, 0x2000
  s_and_b32 s12, s12, 0x3ffff
  s_mov_b32 s10, 0
L_kw:
  s_cmp_ge_u32 s39, 4
  s_cbranch_scc1 L_v0
  s_call_b64 s[100:101], L_work
  s_sleep 1
  s_add_u32 s10, s10, 1
  s_cmp_lt_u32 s10, 262144
  s_cbranch_scc1 L_kw
L_v0:
  s_mov_b32 s32, 0
  s_mov_b32 s37, 255
  v_mov_b32 v23, 8
  s_mov_b32 s35, s59
  ds_read_b64 v[20:21], v23 offset:6688
  s_ashr_i32 s14, s14, 16
  s_waitcnt lgkmcnt(0)
  v_readfirstlane_b32 s34, v20
  s_mul_i32 s34, s34, 96
  s_ashr_i32 s34, s34, 4
  s_add_i32 s34, s34, -6093
  s_add_i32 s34, s34, s14
  s_lshr_b32 s68, s15, 20
  s_mul_i32 s34, s34, s68
  s_ashr_i32 s34, s34, 8
  s_call_b64 s[62:63], L_vs
  s_cbranch_scc1 L_nl0
  v_add_u32_dpp v3, v28, v38 row_newbcast:0 row_mask:0xf bank_mask:0xf
  buffer_load_dwordx4 v[40:43], v3, s[48:51], 0 offen nt
L_nl0:
  v_dot2_f32_bf16 v8, v104, v4, 0
  v_dot2_f32_bf16 v9, v108, v4, 0
  v_dot2_f32_bf16 v10, v112, v4, 0
  v_dot2_f32_bf16 v11, v116, v4, 0
  v_dot2_f32_bf16 v12, v120, v4, 0
  v_dot2_f32_bf16 v13, v124, v4, 0
  v_dot2_f32_bf16 v14, v128, v4, 0
  v_dot2_f32_bf16 v15, v132, v4, 0
  v_dot2_f32_bf16 v8, v105, v5, v8
  v_dot2_f32_bf16 v9, v109, v5, v9
  v_dot2_f32_bf16 v10, v113, v5, v10
  v_dot2_f32_bf16 v11, v117, v5, v11
  v_dot2_f32_bf16 v12, v121, v5, v12
  v_dot2_f32_bf16 v13, v125, v5, v13
  v_dot2_f32_bf16 v14, v129, v5, v14
  v_dot2_f32_bf16 v15, v133, v5, v15
  v_dot2_f32_bf16 v8, v106, v6, v8
  v_dot2_f32_bf16 v9, v110, v6, v9
  v_dot2_f32_bf16 v10, v114, v6, v10
  v_dot2_f32_bf16 v11, v118, v6, v11
  v_dot2_f32_bf16 v12, v122, v6, v12
  v_dot2_f32_bf16 v13, v126, v6, v13
  v_dot2_f32_bf16 v14, v130, v6, v14
  v_dot2_f32_bf16 v15, v134, v6, v15
  v_dot2_f32_bf16 v8, v107, v7, v8
  v_dot2_f32_bf16 v9, v111, v7, v9
  v_dot2_f32_bf16 v10, v115, v7, v10
  v_dot2_f32_bf16 v11, v119, v7, v11
  v_dot2_f32_bf16 v12, v123, v7, v12
  v_dot2_f32_bf16 v13, v127, v7, v13
  v_dot2_f32_bf16 v14, v131, v7, v14
  v_dot2_f32_bf16 v15, v135, v7, v15
  v_add_f32_dpp v8, v8, v8 row_ror:8 row_mask:0xf bank_mask:0x3
  v_add_f32_dpp v8, v9, v9 row_ror:8 row_mask:0xf bank_mask:0xc
  v_add_f32_dpp v10, v10, v10 row_ror:8 row_mask:0xf bank_mask:0x3
  v_add_f32_dpp v10, v11, v11 row_ror:8 row_mask:0xf bank_mask:0xc
  v_add_f32_dpp v12, v12, v12 row_ror:8 row_mask:0xf bank_mask:0x3
  v_add_f32_dpp v12, v13, v13 row_ror:8 row_mask:0xf bank_mask:0xc
  v_add_f32_dpp v14, v14, v14 row_ror:8 row_mask:0xf bank_mask:0x3
  v_add_f32_dpp v14, v15, v15 row_ror:8 row_mask:0xf bank_mask:0xc
  v_add_f32_dpp v16, v8, v8 row_shl:4 row_mask:0xf bank_mask:0x5
  v_add_f32_dpp v16, v10, v10 row_shr:4 row_mask:0xf bank_mask:0xa
  v_add_f32_dpp v17, v12, v12 row_shl:4 row_mask:0xf bank_mask:0x5
  v_add_f32_dpp v17, v14, v14 row_shr:4 row_mask:0xf bank_mask:0xa
  s_call_b64 s[62:63], L_vs
  s_cbranch_scc1 L_nl1
  v_add_u32_dpp v3, v28, v38 row_newbcast:1 row_mask:0xf bank_mask:0xf
  buffer_load_dwordx4 v[44:47], v3, s[48:51], 0 offen nt
L_nl1:
  s_call_b64 s[62:63], L_vs
  s_cbranch_scc1 L_nl2
  v_add_u32_dpp v3, v28, v38 row_newbcast:2 row_mask:0xf bank_mask:0xf
  buffer_load_dwordx4 v[48:51], v3, s[48:51], 0 offen nt
L_nl2:
  s_call_b64 s[62:63], L_vs
  s_cbranch_scc1 L_nl3
  v_add_u32_dpp v3, v28, v38 row_newbcast:3 row_mask:0xf bank_mask:0xf
  buffer_load_dwordx4 v[52:55], v3, s[48:51], 0 offen nt
L_nl3:
  s_call_b64 s[62:63], L_vs
  s_cbranch_scc1 L_nl4
  v_add_u32_dpp v3, v28, v38 row_newbcast:4 row_mask:0xf bank_mask:0xf
  buffer_load_dwordx4 v[56:59], v3, s[48:51], 0 offen nt
L_nl4:
  s_call_b64 s[62:63], L_vs
  s_cbranch_scc1 L_nl5
  v_add_u32_dpp v3, v28, v38 row_newbcast:5 row_mask:0xf bank_mask:0xf
  buffer_load_dwordx4 v[60:63], v3, s[48:51], 0 offen nt
L_nl5:
  v_dot2c_f32_bf16_dpp v8, v29, v40 row_newbcast:0 row_mask:0xf bank_mask:0xf
  v_dot2c_f32_bf16_dpp v9, v34, v40 row_newbcast:0 row_mask:0xf bank_mask:0xf
  v_dot2c_f32_bf16_dpp v10, v29, v41 row_newbcast:0 row_mask:0xf bank_mask:0xf
  v_dot2c_f32_bf16_dpp v11, v34, v41 row_newbcast:0 row_mask:0xf bank_mask:0xf
  v_dot2c_f32_bf16_dpp v12, v29, v42 row_newbcast:0 row_mask:0xf bank_mask:0xf
  v_dot2c_f32_bf16_dpp v13, v34, v42 row_newbcast:0 row_mask:0xf bank_mask:0xf
  v_dot2c_f32_bf16_dpp v14, v29, v43 row_newbcast:0 row_mask:0xf bank_mask:0xf
  v_dot2c_f32_bf16_dpp v15, v34, v43 row_newbcast:0 row_mask:0xf bank_mask:0xf
  s_cmp_eq_u32 s75, 6
  s_cbranch_scc1 L_epi
  s_call_b64 s[62:63], L_vs
  s_cbranch_scc1 L_nl6
  v_add_u32_dpp v3, v28, v38 row_newbcast:6 row_mask:0xf bank_mask:0xf
  buffer_load_dwordx4 v[64:67], v3, s[48:51], 0 offen nt
L_nl6:
  v_dot2c_f32_bf16_dpp v8, v29, v44 row_newbcast:1 row_mask:0xf bank_mask:0xf
  v_dot2c_f32_bf16_dpp v9, v34, v44 row_newbcast:1 row_mask:0xf bank_mask:0xf
  v_dot2c_f32_bf16_dpp v10, v29, v45 row_newbcast:1 row_mask:0xf bank_mask:0xf
  v_dot2c_f32_bf16_dpp v11, v34, v45 row_newbcast:1 row_mask:0xf bank_mask:0xf
  v_dot2c_f32_bf16_dpp v12, v29, v46 row_newbcast:1 row_mask:0xf bank_mask:0xf
  v_dot2c_f32_bf16_dpp v13, v34, v46 row_newbcast:1 row_mask:0xf bank_mask:0xf
  v_dot2c_f32_bf16_dpp v14, v29, v47 row_newbcast:1 row_mask:0xf bank_mask:0xf
  v_dot2c_f32_bf16_dpp v15, v34, v47 row_newbcast:1 row_mask:0xf bank_mask:0xf
  s_cmp_eq_u32 s75, 7
  s_cbranch_scc1 L_epi
  s_call_b64 s[62:63], L_vs
  s_cbranch_scc1 L_nl7
  v_add_u32_dpp v3, v28, v38 row_newbcast:7 row_mask:0xf bank_mask:0xf
  buffer_load_dwordx4 v[68:71], v3, s[48:51], 0 offen nt
L_nl7:
  v_dot2c_f32_bf16_dpp v8, v29, v48 row_newbcast:2 row_mask:0xf bank_mask:0xf
  v_dot2c_f32_bf16_dpp v9, v34, v48 row_newbcast:2 row_mask:0xf bank_mask:0xf
  v_dot2c_f32_bf16_dpp v10, v29, v49 row_newbcast:2 row_mask:0xf bank_mask:0xf
  v_dot2c_f32_bf16_dpp v11, v34, v49 row_newbcast:2 row_mask:0xf bank_mask:0xf
  v_dot2c_f32_bf16_dpp v12, v29, v50 row_newbcast:2 row_mask:0xf bank_mask:0xf
  v_dot2c_f32_bf16_dpp v13, v34, v50 row_newbcast:2 row_mask:0xf bank_mask:0xf
  v_dot2c_f32_bf16_dpp v14, v29, v51 row_newbcast:2 row_mask:0xf bank_mask:0xf
  v_dot2c_f32_bf16_dpp v15, v34, v51 row_newbcast:2 row_mask:0xf bank_mask:0xf
  s_cmp_eq_u32 s75, 8
  s_cbranch_scc1 L_epi
  s_call_b64 s[62:63], L_vs
  s_cbranch_scc1 L_nl8
  v_add_u32_dpp v3, v28, v38 row_newbcast:8 row_mask:0xf bank_mask:0xf
  buffer_load_dwordx4 v[72:75], v3, s[48:51], 0 offen nt
L_nl8:
  v_dot2c_f32_bf16_dpp v8, v29, v52 row_newbcast:3 row_mask:0xf bank_mask:0xf
  v_dot2c_f32_bf16_dpp v9, v34, v52 row_newbcast:3 row_mask:0xf bank_mask:0xf
  v_dot2c_f32_bf16_dpp v10, v29, v53 row_newbcast:3 row_mask:0xf bank_mask:0xf
  v_dot2c_f32_bf16_dpp v11, v34, v53 row_newbcast:3 row_mask:0xf bank_mask:0xf
  v_dot2c_f32_bf16_dpp v12, v29, v54 row_newbcast:3 row_mask:0xf bank_mask:0xf
  v_dot2c_f32_bf16_dpp v13, v34, v54 row_newbcast:3 row_mask:0xf bank_mask:0xf
  v_dot2c_f32_bf16_dpp v14, v29, v55 row_newbcast:3 row_mask:0xf bank_mask:0xf
  v_dot2c_f32_bf16_dpp v15, v34, v55 row_newbcast:3 row_mask:0xf bank_mask:0xf
  s_cmp_eq_u32 s75, 9
  s_cbranch_scc1 L_epi
  s_call_b64 s[62:63], L_vs
  s_cbranch_scc1 L_nl9
  v_add_u32_dpp v3, v28, v38 row_newbcast:9 row_mask:0xf bank_mask:0xf
  buffer_load_dwordx4 v[76:79], v3, s[48:51], 0 offen nt
L_nl9:
  v_dot2c_f32_bf16_dpp v8, v29, v56 row_newbcast:4 row_mask:0xf bank_mask:0xf
  v_dot2c_f32_bf16_dpp v9, v34, v56 row_newbcast:4 row_mask:0xf bank_mask:0xf
  v_dot2c_f32_bf16_dpp v10, v29, v57 row_newbcast:4 row_mask:0xf bank_mask:0xf
  v_dot2c_f32_bf16_dpp v11, v34, v57 row_newbcast:4 row_mask:0xf bank_mask:0xf
  v_dot2c_f32_bf16_dpp v12, v29, v58 row_newbcast:4 row_mask:0xf bank_mask:0xf
  v_dot2c_f32_bf16_dpp v13, v34, v58 row_newbcast:4 row_mask:0xf bank_mask:0xf
  v_dot2c_f32_bf16_dpp v14, v29, v59 row_newbcast:4 row_mask:0xf bank_mask:0xf
  v_dot2c_f32_bf16_dpp v15, v34, v59 row_newbcast:4 row_mask:0xf bank_mask:0xf
  s_cmp_eq_u32 s75, 10
  s_cbranch_scc1 L_epi
  s_call_b64 s[62:63], L_vs
  s_cbranch_scc1 L_nl10
  v_add_u32_dpp v3, v28, v38 row_newbcast:10 row_mask:0xf bank_mask:0xf
  buffer_load_dwordx4 v[80:83], v3, s[48:51], 0 offen nt
L_nl10:
  v_dot2c_f32_bf16_dpp v8, v29, v60 row_newbcast:5 row_mask:0xf bank_mask:0xf
  v_dot2c_f32_bf16_dpp v9, v34, v60 row_newbcast:5 row_mask:0xf bank_mask:0xf
  v_dot2c_f32_bf16_dpp v10, v29, v61 row_newbcast:5 row_mask:0xf bank_mask:0xf
  v_dot2c_f32_bf16_dpp v11, v34, v61 row_newbcast:5 row_mask:0xf bank_mask:0xf
  v_dot2c_f32_bf16_dpp v12, v29, v62 row_newbcast:5 row_mask:0xf bank_mask:0xf
  v_dot2c_f32_bf16_dpp v13, v34, v62 row_newbcast:5 row_mask:0xf bank_mask:0xf
  v_dot2c_f32_bf16_dpp v14, v29, v63 row_newbcast:5 row_mask:0xf bank_mask:0xf
  v_dot2c_f32_bf16_dpp v15, v34, v63 row_newbcast:5 row_mask:0xf bank_mask:0xf
  s_cmp_eq_u32 s75, 11
  s_cbranch_scc1 L_epi
  s_call_b64 s[62:63], L_vs
  s_cbranch_scc1 L_nl11
  v_add_u32_dpp v3, v28, v38 row_newbcast:11 row_mask:0xf bank_mask:0xf
  buffer_load_dwordx4 v[84:87], v3, s[48:51], 0 offen nt
L_nl11:
  v_dot2c_f32_bf16_dpp v8, v29, v64 row_newbcast:6 row_mask:0xf bank_mask:0xf
  v_dot2c_f32_bf16_dpp v9, v34, v64 row_newbcast:6 row_mask:0xf bank_mask:0xf
  v_dot2c_f32_bf16_dpp v10, v29, v65 row_newbcast:6 row_mask:0xf bank_mask:0xf
  v_dot2c_f32_bf16_dpp v11, v34, v65 row_newbcast:6 row_mask:0xf bank_mask:0xf
  v_dot2c_f32_bf16_dpp v12, v29, v66 row_newbcast:6 row_mask:0xf bank_mask:0xf
  v_dot2c_f32_bf16_dpp v13, v34, v66 row_newbcast:6 row_mask:0xf bank_mask:0xf
  v_dot2c_f32_bf16_dpp v14, v29, v67 row_newbcast:6 row_mask:0xf bank_mask:0xf
  v_dot2c_f32_bf16_dpp v15, v34, v67 row_newbcast:6 row_mask:0xf bank_mask:0xf
  s_cmp_eq_u32 s75, 12
  s_cbranch_scc1 L_epi
  s_call_b64 s[62:63], L_vs
  s_cbranch_scc1 L_nl12
  v_add_u32_dpp v3, v28, v38 row_newbcast:12 row_mask:0xf bank_mask:0xf
  buffer_load_dwordx4 v[88:91], v3, s[48:51], 0 offen nt
L_nl12:
  v_dot2c_f32_bf16_dpp v8, v29, v68 row_newbcast:7 row_mask:0xf bank_mask:0xf
  v_dot2c_f32_bf16_dpp v9, v34, v68 row_newbcast:7 row_mask:0xf bank_mask:0xf
  v_dot2c_f32_bf16_dpp v10, v29, v69 row_newbcast:7 row_mask:0xf bank_mask:0xf
  v_dot2c_f32_bf16_dpp v11, v34, v69 row_newbcast:7 row_mask:0xf bank_mask:0xf
  v_dot2c_f32_bf16_dpp v12, v29, v70 row_newbcast:7 row_mask:0xf bank_mask:0xf
  v_dot2c_f32_bf16_dpp v13, v34, v70 row_newbcast:7 row_mask:0xf bank_mask:0xf
  v_dot2c_f32_bf16_dpp v14, v29, v71 row_newbcast:7 row_mask:0xf bank_mask:0xf
  v_dot2c_f32_bf16_dpp v15, v34, v71 row_newbcast:7 row_mask:0xf bank_mask:0xf
  s_cmp_eq_u32 s75, 13
  s_cbranch_scc1 L_epi
  s_call_b64 s[62:63], L_vs
  s_cbranch_scc1 L_nl13
  v_add_u32_dpp v3, v28, v38 row_newbcast:13 row_mask:0xf bank_mask:0xf
  buffer_load_dwordx4 v[92:95], v3, s[48:51], 0 offen nt
L_nl13:
  v_dot2c_f32_bf16_dpp v8, v29, v72 row_newbcast:8 row_mask:0xf bank_mask:0xf
  v_dot2c_f32_bf16_dpp v9, v34, v72 row_newbcast:8 row_mask:0xf bank_mask:0xf
  v_dot2c_f32_bf16_dpp v10, v29, v73 row_newbcast:8 row_mask:0xf bank_mask:0xf
  v_dot2c_f32_bf16_dpp v11, v34, v73 row_newbcast:8 row_mask:0xf bank_mask:0xf
  v_dot2c_f32_bf16_dpp v12, v29, v74 row_newbcast:8 row_mask:0xf bank_mask:0xf
  v_dot2c_f32_bf16_dpp v13, v34, v74 row_newbcast:8 row_mask:0xf bank_mask:0xf
  v_dot2c_f32_bf16_dpp v14, v29, v75 row_newbcast:8 row_mask:0xf bank_mask:0xf
  v_dot2c_f32_bf16_dpp v15, v34, v75 row_newbcast:8 row_mask:0xf bank_mask:0xf
  s_cmp_eq_u32 s75, 14
  s_cbranch_scc1 L_epi
  s_call_b64 s[62:63], L_vs
  s_cbranch_scc1 L_nl14
  v_add_u32_dpp v3, v28, v38 row_newbcast:14 row_mask:0xf bank_mask:0xf
  buffer_load_dwordx4 v[96:99], v3, s[48:51], 0 offen nt
L_nl14:
  v_dot2c_f32_bf16_dpp v8, v29, v76 row_newbcast:9 row_mask:0xf bank_mask:0xf
  v_dot2c_f32_bf16_dpp v9, v34, v76 row_newbcast:9 row_mask:0xf bank_mask:0xf
  v_dot2c_f32_bf16_dpp v10, v29, v77 row_newbcast:9 row_mask:0xf bank_mask:0xf
  v_dot2c_f32_bf16_dpp v11, v34, v77 row_newbcast:9 row_mask:0xf bank_mask:0xf
  v_dot2c_f32_bf16_dpp v12, v29, v78 row_newbcast:9 row_mask:0xf bank_mask:0xf
  v_dot2c_f32_bf16_dpp v13, v34, v78 row_newbcast:9 row_mask:0xf bank_mask:0xf
  v_dot2c_f32_bf16_dpp v14, v29, v79 row_newbcast:9 row_mask:0xf bank_mask:0xf
  v_dot2c_f32_bf16_dpp v15, v34, v79 row_newbcast:9 row_mask:0xf bank_mask:0xf
  s_cmp_eq_u32 s75, 15
  s_cbranch_scc1 L_epi
  s_call_b64 s[62:63], L_vs
  s_cbranch_scc1 L_nl15
  v_add_u32_dpp v3, v28, v38 row_newbcast:15 row_mask:0xf bank_mask:0xf
  buffer_load_dwordx4 v[100:103], v3, s[48:51], 0 offen nt
L_nl15:
  v_dot2c_f32_bf16_dpp v8, v29, v80 row_newbcast:10 row_mask:0xf bank_mask:0xf
  v_dot2c_f32_bf16_dpp v9, v34, v80 row_newbcast:10 row_mask:0xf bank_mask:0xf
  v_dot2c_f32_bf16_dpp v10, v29, v81 row_newbcast:10 row_mask:0xf bank_mask:0xf
  v_dot2c_f32_bf16_dpp v11, v34, v81 row_newbcast:10 row_mask:0xf bank_mask:0xf
  v_dot2c_f32_bf16_dpp v12, v29, v82 row_newbcast:10 row_mask:0xf bank_mask:0xf
  v_dot2c_f32_bf16_dpp v13, v34, v82 row_newbcast:10 row_mask:0xf bank_mask:0xf
  v_dot2c_f32_bf16_dpp v14, v29, v83 row_newbcast:10 row_mask:0xf bank_mask:0xf
  v_dot2c_f32_bf16_dpp v15, v34, v83 row_newbcast:10 row_mask:0xf bank_mask:0xf
  s_cmp_eq_u32 s75, 16
  s_cbranch_scc1 L_epi
  s_call_b64 s[62:63], L_vs
  s_cbranch_scc1 L_nl16
  v_add_u32_dpp v3, v30, v38 row_newbcast:0 row_mask:0xf bank_mask:0xf
  buffer_load_dwordx4 v[104:107], v3, s[48:51], 0 offen nt
L_nl16:
  v_dot2c_f32_bf16_dpp v8, v29, v84 row_newbcast:11 row_mask:0xf bank_mask:0xf
  v_dot2c_f32_bf16_dpp v9, v34, v84 row_newbcast:11 row_mask:0xf bank_mask:0xf
  v_dot2c_f32_bf16_dpp v10, v29, v85 row_newbcast:11 row_mask:0xf bank_mask:0xf
  v_dot2c_f32_bf16_dpp v11, v34, v85 row_newbcast:11 row_mask:0xf bank_mask:0xf
  v_dot2c_f32_bf16_dpp v12, v29, v86 row_newbcast:11 row_mask:0xf bank_mask:0xf
  v_dot2c_f32_bf16_dpp v13, v34, v86 row_newbcast:11 row_mask:0xf bank_mask:0xf
  v_dot2c_f32_bf16_dpp v14, v29, v87 row_newbcast:11 row_mask:0xf bank_mask:0xf
  v_dot2c_f32_bf16_dpp v15, v34, v87 row_newbcast:11 row_mask:0xf bank_mask:0xf
  s_cmp_eq_u32 s75, 17
  s_cbranch_scc1 L_epi
  s_call_b64 s[62:63], L_vs
  s_cbranch_scc1 L_nl17
  v_add_u32_dpp v3, v30, v38 row_newbcast:1 row_mask:0xf bank_mask:0xf
  buffer_load_dwordx4 v[108:111], v3, s[48:51], 0 offen nt
L_nl17:
  v_dot2c_f32_bf16_dpp v8, v29, v88 row_newbcast:12 row_mask:0xf bank_mask:0xf
  v_dot2c_f32_bf16_dpp v9, v34, v88 row_newbcast:12 row_mask:0xf bank_mask:0xf
  v_dot2c_f32_bf16_dpp v10, v29, v89 row_newbcast:12 row_mask:0xf bank_mask:0xf
  v_dot2c_f32_bf16_dpp v11, v34, v89 row_newbcast:12 row_mask:0xf bank_mask:0xf
  v_dot2c_f32_bf16_dpp v12, v29, v90 row_newbcast:12 row_mask:0xf bank_mask:0xf
  v_dot2c_f32_bf16_dpp v13, v34, v90 row_newbcast:12 row_mask:0xf bank_mask:0xf
  v_dot2c_f32_bf16_dpp v14, v29, v91 row_newbcast:12 row_mask:0xf bank_mask:0xf
  v_dot2c_f32_bf16_dpp v15, v34, v91 row_newbcast:12 row_mask:0xf bank_mask:0xf
  s_cmp_eq_u32 s75, 18
  s_cbranch_scc1 L_epi
  s_call_b64 s[62:63], L_vs
  s_cbranch_scc1 L_nl18
  v_add_u32_dpp v3, v30, v38 row_newbcast:2 row_mask:0xf bank_mask:0xf
  buffer_load_dwordx4 v[112:115], v3, s[48:51], 0 offen nt
L_nl18:
  v_dot2c_f32_bf16_dpp v8, v29, v92 row_newbcast:13 row_mask:0xf bank_mask:0xf
  v_dot2c_f32_bf16_dpp v9, v34, v92 row_newbcast:13 row_mask:0xf bank_mask:0xf
  v_dot2c_f32_bf16_dpp v10, v29, v93 row_newbcast:13 row_mask:0xf bank_mask:0xf
  v_dot2c_f32_bf16_dpp v11, v34, v93 row_newbcast:13 row_mask:0xf bank_mask:0xf
  v_dot2c_f32_bf16_dpp v12, v29, v94 row_newbcast:13 row_mask:0xf bank_mask:0xf
  v_dot2c_f32_bf16_dpp v13, v34, v94 row_newbcast:13 row_mask:0xf bank_mask:0xf
  v_dot2c_f32_bf16_dpp v14, v29, v95 row_newbcast:13 row_mask:0xf bank_mask:0xf
  v_dot2c_f32_bf16_dpp v15, v34, v95 row_newbcast:13 row_mask:0xf bank_mask:0xf
  s_cmp_eq_u32 s75, 19
  s_cbranch_scc1 L_epi
  s_call_b64 s[62:63], L_vs
  s_cbranch_scc1 L_nl19
  v_add_u32_dpp v3, v30, v38 row_newbcast:3 row_mask:0xf bank_mask:0xf
  buffer_load_dwordx4 v[116:119], v3, s[48:51], 0 offen nt
L_nl19:
  v_dot2c_f32_bf16_dpp v8, v29, v96 row_newbcast:14 row_mask:0xf bank_mask:0xf
  v_dot2c_f32_bf16_dpp v9, v34, v96 row_newbcast:14 row_mask:0xf bank_mask:0xf
  v_dot2c_f32_bf16_dpp v10, v29, v97 row_newbcast:14 row_mask:0xf bank_mask:0xf
  v_dot2c_f32_bf16_dpp v11, v34, v97 row_newbcast:14 row_mask:0xf bank_mask:0xf
  v_dot2c_f32_bf16_dpp v12, v29, v98 row_newbcast:14 row_mask:0xf bank_mask:0xf
  v_dot2c_f32_bf16_dpp v13, v34, v98 row_newbcast:14 row_mask:0xf bank_mask:0xf
  v_dot2c_f32_bf16_dpp v14, v29, v99 row_newbcast:14 row_mask:0xf bank_mask:0xf
  v_dot2c_f32_bf16_dpp v15, v34, v99 row_newbcast:14 row_mask:0xf bank_mask:0xf
  s_cmp_eq_u32 s75, 20
  s_cbranch_scc1 L_epi
  s_call_b64 s[62:63], L_vs
  s_cbranch_scc1 L_nl20
  v_add_u32_dpp v3, v30, v38 row_newbcast:4 row_mask:0xf bank_mask:0xf
  buffer_load_dwordx4 v[120:123], v3, s[48:51], 0 offen nt
L_nl20:
  v_dot2c_f32_bf16_dpp v8, v29, v100 row_newbcast:15 row_mask:0xf bank_mask:0xf
  v_dot2c_f32_bf16_dpp v9, v34, v100 row_newbcast:15 row_mask:0xf bank_mask:0xf
  v_dot2c_f32_bf16_dpp v10, v29, v101 row_newbcast:15 row_mask:0xf bank_mask:0xf
  v_dot2c_f32_bf16_dpp v11, v34, v101 row_newbcast:15 row_mask:0xf bank_mask:0xf
  v_dot2c_f32_bf16_dpp v12, v29, v102 row_newbcast:15 row_mask:0xf bank_mask:0xf
  v_dot2c_f32_bf16_dpp v13, v34, v102 row_newbcast:15 row_mask:0xf bank_mask:0xf
  v_dot2c_f32_bf16_dpp v14, v29, v103 row_newbcast:15 row_mask:0xf bank_mask:0xf
  v_dot2c_f32_bf16_dpp v15, v34, v103 row_newbcast:15 row_mask:0xf bank_mask:0xf
  s_cmp_eq_u32 s75, 21
  s_cbranch_scc1 L_epi
  s_call_b64 s[62:63], L_vs
  s_cbranch_scc1 L_nl21
  v_add_u32_dpp v3, v30, v38 row_newbcast:5 row_mask:0xf bank_mask:0xf
  buffer_load_dwordx4 v[124:127], v3, s[48:51], 0 offen nt
L_nl21:
  v_dot2c_f32_bf16_dpp v8, v31, v104 row_newbcast:0 row_mask:0xf bank_mask:0xf
  v_dot2c_f32_bf16_dpp v9, v35, v104 row_newbcast:0 row_mask:0xf bank_mask:0xf
  v_dot2c_f32_bf16_dpp v10, v31, v105 row_newbcast:0 row_mask:0xf bank_mask:0xf
  v_dot2c_f32_bf16_dpp v11, v35, v105 row_newbcast:0 row_mask:0xf bank_mask:0xf
  v_dot2c_f32_bf16_dpp v12, v31, v106 row_newbcast:0 row_mask:0xf bank_mask:0xf
  v_dot2c_f32_bf16_dpp v13, v35, v106 row_newbcast:0 row_mask:0xf bank_mask:0xf
  v_dot2c_f32_bf16_dpp v14, v31, v107 row_newbcast:0 row_mask:0xf bank_mask:0xf
  v_dot2c_f32_bf16_dpp v15, v35, v107 row_newbcast:0 row_mask:0xf bank_mask:0xf
  s_cmp_eq_u32 s75, 22
  s_cbranch_scc1 L_epi
  s_call_b64 s[62:63], L_vs
  s_cbranch_scc1 L_nl22
  v_add_u32_dpp v3, v30, v38 row_newbcast:6 row_mask:0xf bank_mask:0xf
  buffer_load_dwordx4 v[128:131], v3, s[48:51], 0 offen nt
L_nl22:
  v_dot2c_f32_bf16_dpp v8, v31, v108 row_newbcast:1 row_mask:0xf bank_mask:0xf
  v_dot2c_f32_bf16_dpp v9, v35, v108 row_newbcast:1 row_mask:0xf bank_mask:0xf
  v_dot2c_f32_bf16_dpp v10, v31, v109 row_newbcast:1 row_mask:0xf bank_mask:0xf
  v_dot2c_f32_bf16_dpp v11, v35, v109 row_newbcast:1 row_mask:0xf bank_mask:0xf
  v_dot2c_f32_bf16_dpp v12, v31, v110 row_newbcast:1 row_mask:0xf bank_mask:0xf
  v_dot2c_f32_bf16_dpp v13, v35, v110 row_newbcast:1 row_mask:0xf bank_mask:0xf
  v_dot2c_f32_bf16_dpp v14, v31, v111 row_newbcast:1 row_mask:0xf bank_mask:0xf
  v_dot2c_f32_bf16_dpp v15, v35, v111 row_newbcast:1 row_mask:0xf bank_mask:0xf
  s_cmp_eq_u32 s75, 23
  s_cbranch_scc1 L_epi
  s_call_b64 s[62:63], L_vs
  s_cbranch_scc1 L_nl23
  v_add_u32_dpp v3, v30, v38 row_newbcast:7 row_mask:0xf bank_mask:0xf
  buffer_load_dwordx4 v[132:135], v3, s[48:51], 0 offen nt
L_nl23:
  v_dot2c_f32_bf16_dpp v8, v31, v112 row_newbcast:2 row_mask:0xf bank_mask:0xf
  v_dot2c_f32_bf16_dpp v9, v35, v112 row_newbcast:2 row_mask:0xf bank_mask:0xf
  v_dot2c_f32_bf16_dpp v10, v31, v113 row_newbcast:2 row_mask:0xf bank_mask:0xf
  v_dot2c_f32_bf16_dpp v11, v35, v113 row_newbcast:2 row_mask:0xf bank_mask:0xf
  v_dot2c_f32_bf16_dpp v12, v31, v114 row_newbcast:2 row_mask:0xf bank_mask:0xf
  v_dot2c_f32_bf16_dpp v13, v35, v114 row_newbcast:2 row_mask:0xf bank_mask:0xf
  v_dot2c_f32_bf16_dpp v14, v31, v115 row_newbcast:2 row_mask:0xf bank_mask:0xf
  v_dot2c_f32_bf16_dpp v15, v35, v115 row_newbcast:2 row_mask:0xf bank_mask:0xf
  s_cmp_eq_u32 s75, 24
  s_cbranch_scc1 L_epi
  s_call_b64 s[62:63], L_vs
  s_cbranch_scc1 L_nl24
  v_add_u32_dpp v3, v30, v38 row_newbcast:8 row_mask:0xf bank_mask:0xf
  buffer_load_dwordx4 v[136:139], v3, s[48:51], 0 offen nt
L_nl24:
  v_dot2c_f32_bf16_dpp v8, v31, v116 row_newbcast:3 row_mask:0xf bank_mask:0xf
  v_dot2c_f32_bf16_dpp v9, v35, v116 row_newbcast:3 row_mask:0xf bank_mask:0xf
  v_dot2c_f32_bf16_dpp v10, v31, v117 row_newbcast:3 row_mask:0xf bank_mask:0xf
  v_dot2c_f32_bf16_dpp v11, v35, v117 row_newbcast:3 row_mask:0xf bank_mask:0xf
  v_dot2c_f32_bf16_dpp v12, v31, v118 row_newbcast:3 row_mask:0xf bank_mask:0xf
  v_dot2c_f32_bf16_dpp v13, v35, v118 row_newbcast:3 row_mask:0xf bank_mask:0xf
  v_dot2c_f32_bf16_dpp v14, v31, v119 row_newbcast:3 row_mask:0xf bank_mask:0xf
  v_dot2c_f32_bf16_dpp v15, v35, v119 row_newbcast:3 row_mask:0xf bank_mask:0xf
  s_cmp_eq_u32 s75, 25
  s_cbranch_scc1 L_epi
  s_call_b64 s[62:63], L_vs
  s_cbranch_scc1 L_nl25
  v_add_u32_dpp v3, v30, v38 row_newbcast:9 row_mask:0xf bank_mask:0xf
  buffer_load_dwordx4 v[140:143], v3, s[48:51], 0 offen nt
L_nl25:
  v_dot2c_f32_bf16_dpp v8, v31, v120 row_newbcast:4 row_mask:0xf bank_mask:0xf
  v_dot2c_f32_bf16_dpp v9, v35, v120 row_newbcast:4 row_mask:0xf bank_mask:0xf
  v_dot2c_f32_bf16_dpp v10, v31, v121 row_newbcast:4 row_mask:0xf bank_mask:0xf
  v_dot2c_f32_bf16_dpp v11, v35, v121 row_newbcast:4 row_mask:0xf bank_mask:0xf
  v_dot2c_f32_bf16_dpp v12, v31, v122 row_newbcast:4 row_mask:0xf bank_mask:0xf
  v_dot2c_f32_bf16_dpp v13, v35, v122 row_newbcast:4 row_mask:0xf bank_mask:0xf
  v_dot2c_f32_bf16_dpp v14, v31, v123 row_newbcast:4 row_mask:0xf bank_mask:0xf
  v_dot2c_f32_bf16_dpp v15, v35, v123 row_newbcast:4 row_mask:0xf bank_mask:0xf
  s_cmp_eq_u32 s75, 26
  s_cbranch_scc1 L_epi
  s_call_b64 s[62:63], L_vs
  s_cbranch_scc1 L_nl26
  v_add_u32_dpp v3, v30, v38 row_newbcast:10 row_mask:0xf bank_mask:0xf
  buffer_load_dwordx4 v[144:147], v3, s[48:51], 0 offen nt
L_nl26:
  v_dot2c_f32_bf16_dpp v8, v31, v124 row_newbcast:5 row_mask:0xf bank_mask:0xf
  v_dot2c_f32_bf16_dpp v9, v35, v124 row_newbcast:5 row_mask:0xf bank_mask:0xf
  v_dot2c_f32_bf16_dpp v10, v31, v125 row_newbcast:5 row_mask:0xf bank_mask:0xf
  v_dot2c_f32_bf16_dpp v11, v35, v125 row_newbcast:5 row_mask:0xf bank_mask:0xf
  v_dot2c_f32_bf16_dpp v12, v31, v126 row_newbcast:5 row_mask:0xf bank_mask:0xf
  v_dot2c_f32_bf16_dpp v13, v35, v126 row_newbcast:5 row_mask:0xf bank_mask:0xf
  v_dot2c_f32_bf16_dpp v14, v31, v127 row_newbcast:5 row_mask:0xf bank_mask:0xf
  v_dot2c_f32_bf16_dpp v15, v35, v127 row_newbcast:5 row_mask:0xf bank_mask:0xf
  s_cmp_eq_u32 s75, 27
  s_cbranch_scc1 L_epi
  s_call_b64 s[62:63], L_vs
  s_cbranch_scc1 L_nl27
  v_add_u32_dpp v3, v30, v38 row_newbcast:11 row_mask:0xf bank_mask:0xf
  buffer_load_dwordx4 v[148:151], v3, s[48:51], 0 offen nt
L_nl27:
  v_dot2c_f32_bf16_dpp v8, v31, v128 row_newbcast:6 row_mask:0xf bank_mask:0xf
  v_dot2c_f32_bf16_dpp v9, v35, v128 row_newbcast:6 row_mask:0xf bank_mask:0xf
  v_dot2c_f32_bf16_dpp v10, v31, v129 row_newbcast:6 row_mask:0xf bank_mask:0xf
  v_dot2c_f32_bf16_dpp v11, v35, v129 row_newbcast:6 row_mask:0xf bank_mask:0xf
  v_dot2c_f32_bf16_dpp v12, v31, v130 row_newbcast:6 row_mask:0xf bank_mask:0xf
  v_dot2c_f32_bf16_dpp v13, v35, v130 row_newbcast:6 row_mask:0xf bank_mask:0xf
  v_dot2c_f32_bf16_dpp v14, v31, v131 row_newbcast:6 row_mask:0xf bank_mask:0xf
  v_dot2c_f32_bf16_dpp v15, v35, v131 row_newbcast:6 row_mask:0xf bank_mask:0xf
  s_cmp_eq_u32 s75, 28
  s_cbranch_scc1 L_epi
  s_call_b64 s[62:63], L_vs
  s_cbranch_scc1 L_nl28
  v_add_u32_dpp v3, v30, v38 row_newbcast:12 row_mask:0xf bank_mask:0xf
  buffer_load_dwordx4 v[152:155], v3, s[48:51], 0 offen nt
L_nl28:
  v_dot2c_f32_bf16_dpp v8, v31, v132 row_newbcast:7 row_mask:0xf bank_mask:0xf
  v_dot2c_f32_bf16_dpp v9, v35, v132 row_newbcast:7 row_mask:0xf bank_mask:0xf
  v_dot2c_f32_bf16_dpp v10, v31, v133 row_newbcast:7 row_mask:0xf bank_mask:0xf
  v_dot2c_f32_bf16_dpp v11, v35, v133 row_newbcast:7 row_mask:0xf bank_mask:0xf
  v_dot2c_f32_bf16_dpp v12, v31, v134 row_newbcast:7 row_mask:0xf bank_mask:0xf
  v_dot2c_f32_bf16_dpp v13, v35, v134 row_newbcast:7 row_mask:0xf bank_mask:0xf
  v_dot2c_f32_bf16_dpp v14, v31, v135 row_newbcast:7 row_mask:0xf bank_mask:0xf
  v_dot2c_f32_bf16_dpp v15, v35, v135 row_newbcast:7 row_mask:0xf bank_mask:0xf
  s_cmp_eq_u32 s75, 29
  s_cbranch_scc1 L_epi
  s_call_b64 s[62:63], L_vs
  s_cbranch_scc1 L_nl29
  v_add_u32_dpp v3, v30, v38 row_newbcast:13 row_mask:0xf bank_mask:0xf
  buffer_load_dwordx4 v[156:159], v3, s[48:51], 0 offen nt
L_nl29:
  v_dot2c_f32_bf16_dpp v8, v31, v136 row_newbcast:8 row_mask:0xf bank_mask:0xf
  v_dot2c_f32_bf16_dpp v9, v35, v136 row_newbcast:8 row_mask:0xf bank_mask:0xf
  v_dot2c_f32_bf16_dpp v10, v31, v137 row_newbcast:8 row_mask:0xf bank_mask:0xf
  v_dot2c_f32_bf16_dpp v11, v35, v137 row_newbcast:8 row_mask:0xf bank_mask:0xf
  v_dot2c_f32_bf16_dpp v12, v31, v138 row_newbcast:8 row_mask:0xf bank_mask:0xf
  v_dot2c_f32_bf16_dpp v13, v35, v138 row_newbcast:8 row_mask:0xf bank_mask:0xf
  v_dot2c_f32_bf16_dpp v14, v31, v139 row_newbcast:8 row_mask:0xf bank_mask:0xf
  v_dot2c_f32_bf16_dpp v15, v35, v139 row_newbcast:8 row_mask:0xf bank_mask:0xf
  s_cmp_eq_u32 s75, 30
  s_cbranch_scc1 L_epi
  s_call_b64 s[62:63], L_vs
  s_cbranch_scc1 L_nl30
  v_add_u32_dpp v3, v30, v38 row_newbcast:14 row_mask:0xf bank_mask:0xf
  buffer_load_dwordx4 v[160:163], v3, s[48:51], 0 offen nt
L_nl30:
  v_dot2c_f32_bf16_dpp v8, v31, v140 row_newbcast:9 row_mask:0xf bank_mask:0xf
  v_dot2c_f32_bf16_dpp v9, v35, v140 row_newbcast:9 row_mask:0xf bank_mask:0xf
  v_dot2c_f32_bf16_dpp v10, v31, v141 row_newbcast:9 row_mask:0xf bank_mask:0xf
  v_dot2c_f32_bf16_dpp v11, v35, v141 row_newbcast:9 row_mask:0xf bank_mask:0xf
  v_dot2c_f32_bf16_dpp v12, v31, v142 row_newbcast:9 row_mask:0xf bank_mask:0xf
  v_dot2c_f32_bf16_dpp v13, v35, v142 row_newbcast:9 row_mask:0xf bank_mask:0xf
  v_dot2c_f32_bf16_dpp v14, v31, v143 row_newbcast:9 row_mask:0xf bank_mask:0xf
  v_dot2c_f32_bf16_dpp v15, v35, v143 row_newbcast:9 row_mask:0xf bank_mask:0xf
  s_cmp_eq_u32 s75, 31
  s_cbranch_scc1 L_epi
  s_call_b64 s[62:63], L_vs
  s_cbranch_scc1 L_nl31
  v_add_u32_dpp v3, v30, v38 row_newbcast:15 row_mask:0xf bank_mask:0xf
  buffer_load_dwordx4 v[164:167], v3, s[48:51], 0 offen nt
L_nl31:
  v_dot2c_f32_bf16_dpp v8, v31, v144 row_newbcast:10 row_mask:0xf bank_mask:0xf
  v_dot2c_f32_bf16_dpp v9, v35, v144 row_newbcast:10 row_mask:0xf bank_mask:0xf
  v_dot2c_f32_bf16_dpp v10, v31, v145 row_newbcast:10 row_mask:0xf bank_mask:0xf
  v_dot2c_f32_bf16_dpp v11, v35, v145 row_newbcast:10 row_mask:0xf bank_mask:0xf
  v_dot2c_f32_bf16_dpp v12, v31, v146 row_newbcast:10 row_mask:0xf bank_mask:0xf
  v_dot2c_f32_bf16_dpp v13, v35, v146 row_newbcast:10 row_mask:0xf bank_mask:0xf
  v_dot2c_f32_bf16_dpp v14, v31, v147 row_newbcast:10 row_mask:0xf bank_mask:0xf
  v_dot2c_f32_bf16_dpp v15, v35, v147 row_newbcast:10 row_mask:0xf bank_mask:0xf
  s_cmp_eq_u32 s75, 32
  s_cbranch_scc1 L_epi
  s_call_b64 s[62:63], L_vs
  s_cbranch_scc1 L_nl32
  v_add_u32_dpp v3, v32, v38 row_newbcast:0 row_mask:0xf bank_mask:0xf
  buffer_load_dwordx4 v[40:43], v3, s[48:51], 0 offen nt
L_nl32:
  v_dot2c_f32_bf16_dpp v8, v31, v148 row_newbcast:11 row_mask:0xf bank_mask:0xf
  v_dot2c_f32_bf16_dpp v9, v35, v148 row_newbcast:11 row_mask:0xf bank_mask:0xf
  v_dot2c_f32_bf16_dpp v10, v31, v149 row_newbcast:11 row_mask:0xf bank_mask:0xf
  v_dot2c_f32_bf16_dpp v11, v35, v149 row_newbcast:11 row_mask:0xf bank_mask:0xf
  v_dot2c_f32_bf16_dpp v12, v31, v150 row_newbcast:11 row_mask:0xf bank_mask:0xf
  v_dot2c_f32_bf16_dpp v13, v35, v150 row_newbcast:11 row_mask:0xf bank_mask:0xf
  v_dot2c_f32_bf16_dpp v14, v31, v151 row_newbcast:11 row_mask:0xf bank_mask:0xf
  v_dot2c_f32_bf16_dpp v15, v35, v151 row_newbcast:11 row_mask:0xf bank_mask:0xf
  s_cmp_eq_u32 s75, 33
  s_cbranch_scc1 L_epi
  s_call_b64 s[62:63], L_vs
  s_cbranch_scc1 L_nl33
  v_add_u32_dpp v3, v32, v38 row_newbcast:1 row_mask:0xf bank_mask:0xf
  buffer_load_dwordx4 v[44:47], v3, s[48:51], 0 offen nt
L_nl33:
  v_dot2c_f32_bf16_dpp v8, v31, v152 row_newbcast:12 row_mask:0xf bank_mask:0xf
  v_dot2c_f32_bf16_dpp v9, v35, v152 row_newbcast:12 row_mask:0xf bank_mask:0xf
  v_dot2c_f32_bf16_dpp v10, v31, v153 row_newbcast:12 row_mask:0xf bank_mask:0xf
  v_dot2c_f32_bf16_dpp v11, v35, v153 row_newbcast:12 row_mask:0xf bank_mask:0xf
  v_dot2c_f32_bf16_dpp v12, v31, v154 row_newbcast:12 row_mask:0xf bank_mask:0xf
  v_dot2c_f32_bf16_dpp v13, v35, v154 row_newbcast:12 row_mask:0xf bank_mask:0xf
  v_dot2c_f32_bf16_dpp v14, v31, v155 row_newbcast:12 row_mask:0xf bank_mask:0xf
  v_dot2c_f32_bf16_dpp v15, v35, v155 row_newbcast:12 row_mask:0xf bank_mask:0xf
  s_cmp_eq_u32 s75, 34
  s_cbranch_scc1 L_epi
  s_call_b64 s[62:63], L_vs
  s_cbranch_scc1 L_nl34
  v_add_u32_dpp v3, v32, v38 row_newbcast:2 row_mask:0xf bank_mask:0xf
  buffer_load_dwordx4 v[48:51], v3, s[48:51], 0 offen nt
L_nl34:
  v_dot2c_f32_bf16_dpp v8, v31, v156 row_newbcast:13 row_mask:0xf bank_mask:0xf
  v_dot2c_f32_bf16_dpp v9, v35, v156 row_newbcast:13 row_mask:0xf bank_mask:0xf
  v_dot2c_f32_bf16_dpp v10, v31, v157 row_newbcast:13 row_mask:0xf bank_mask:0xf
  v_dot2c_f32_bf16_dpp v11, v35, v157 row_newbcast:13 row_mask:0xf bank_mask:0xf
  v_dot2c_f32_bf16_dpp v12, v31, v158 row_newbcast:13 row_mask:0xf bank_mask:0xf
  v_dot2c_f32_bf16_dpp v13, v35, v158 row_newbcast:13 row_mask:0xf bank_mask:0xf
  v_dot2c_f32_bf16_dpp v14, v31, v159 row_newbcast:13 row_mask:0xf bank_mask:0xf
  v_dot2c_f32_bf16_dpp v15, v35, v159 row_newbcast:13 row_mask:0xf bank_mask:0xf
  s_cmp_eq_u32 s75, 35
  s_cbranch_scc1 L_epi
  s_call_b64 s[62:63], L_vs
  s_cbranch_scc1 L_nl35
  v_add_u32_dpp v3, v32, v38 row_newbcast:3 row_mask:0xf bank_mask:0xf
  buffer_load_dwordx4 v[52:55], v3, s[48:51], 0 offen nt
L_nl35:
  v_dot2c_f32_bf16_dpp v8, v31, v160 row_newbcast:14 row_mask:0xf bank_mask:0xf
  v_dot2c_f32_bf16_dpp v9, v35, v160 row_newbcast:14 row_mask:0xf bank_mask:0xf
  v_dot2c_f32_bf16_dpp v10, v31, v161 row_newbcast:14 row_mask:0xf bank_mask:0xf
  v_dot2c_f32_bf16_dpp v11, v35, v161 row_newbcast:14 row_mask:0xf bank_mask:0xf
  v_dot2c_f32_bf16_dpp v12, v31, v162 row_newbcast:14 row_mask:0xf bank_mask:0xf
  v_dot2c_f32_bf16_dpp v13, v35, v162 row_newbcast:14 row_mask:0xf bank_mask:0xf
  v_dot2c_f32_bf16_dpp v14, v31, v163 row_newbcast:14 row_mask:0xf bank_mask:0xf
  v_dot2c_f32_bf16_dpp v15, v35, v163 row_newbcast:14 row_mask:0xf bank_mask:0xf
  s_cmp_eq_u32 s75, 36
  s_cbranch_scc1 L_epi
  s_call_b64 s[62:63], L_vs
  s_cbranch_scc1 L_nl36
  v_add_u32_dpp v3, v32, v38 row_newbcast:4 row_mask:0xf bank_mask:0xf
  buffer_load_dwordx4 v[56:59], v3, s[48:51], 0 offen nt
L_nl36:
  v_dot2c_f32_bf16_dpp v8, v31, v164 row_newbcast:15 row_mask:0xf bank_mask:0xf
  v_dot2c_f32_bf16_dpp v9, v35, v164 row_newbcast:15 row_mask:0xf bank_mask:0xf
  v_dot2c_f32_bf16_dpp v10, v31, v165 row_newbcast:15 row_mask:0xf bank_mask:0xf
  v_dot2c_f32_bf16_dpp v11, v35, v165 row_newbcast:15 row_mask:0xf bank_mask:0xf
  v_dot2c_f32_bf16_dpp v12, v31, v166 row_newbcast:15 row_mask:0xf bank_mask:0xf
  v_dot2c_f32_bf16_dpp v13, v35, v166 row_newbcast:15 row_mask:0xf bank_mask:0xf
  v_dot2c_f32_bf16_dpp v14, v31, v167 row_newbcast:15 row_mask:0xf bank_mask:0xf
  v_dot2c_f32_bf16_dpp v15, v35, v167 row_newbcast:15 row_mask:0xf bank_mask:0xf
  s_cmp_eq_u32 s75, 37
  s_cbranch_scc1 L_epi
  s_call_b64 s[62:63], L_vs
  s_cbranch_scc1 L_nl37
  v_add_u32_dpp v3, v32, v38 row_newbcast:5 row_mask:0xf bank_mask:0xf
  buffer_load_dwordx4 v[60:63], v3, s[48:51], 0 offen nt
L_nl37:
  v_dot2c_f32_bf16_dpp v8, v33, v40 row_newbcast:0 row_mask:0xf bank_mask:0xf
  v_dot2c_f32_bf16_dpp v9, v36, v40 row_newbcast:0 row_mask:0xf bank_mask:0xf
  v_dot2c_f32_bf16_dpp v10, v33, v41 row_newbcast:0 row_mask:0xf bank_mask:0xf
  v_dot2c_f32_bf16_dpp v11, v36, v41 row_newbcast:0 row_mask:0xf bank_mask:0xf
  v_dot2c_f32_bf16_dpp v12, v33, v42 row_newbcast:0 row_mask:0xf bank_mask:0xf
  v_dot2c_f32_bf16_dpp v13, v36, v42 row_newbcast:0 row_mask:0xf bank_mask:0xf
  v_dot2c_f32_bf16_dpp v14, v33, v43 row_newbcast:0 row_mask:0xf bank_mask:0xf
  v_dot2c_f32_bf16_dpp v15, v36, v43 row_newbcast:0 row_mask:0xf bank_mask:0xf
  s_cmp_eq_u32 s75, 38
  s_cbranch_scc1 L_epi
  s_call_b64 s[62:63], L_vs
  v_dot2c_f32_bf16_dpp v8, v33, v44 row_newbcast:1 row_mask:0xf bank_mask:0xf
  v_dot2c_f32_bf16_dpp v9, v36, v44 row_newbcast:1 row_mask:0xf bank_mask:0xf
  v_dot2c_f32_bf16_dpp v10, v33, v45 row_newbcast:1 row_mask:0xf bank_mask:0xf
  v_dot2c_f32_bf16_dpp v11, v36, v45 row_newbcast:1 row_mask:0xf bank_mask:0xf
  v_dot2c_f32_bf16_dpp v12, v33, v46 row_newbcast:1 row_mask:0xf bank_mask:0xf
  v_dot2c_f32_bf16_dpp v13, v36, v46 row_newbcast:1 row_mask:0xf bank_mask:0xf
  v_dot2c_f32_bf16_dpp v14, v33, v47 row_newbcast:1 row_mask:0xf bank_mask:0xf
  v_dot2c_f32_bf16_dpp v15, v36, v47 row_newbcast:1 row_mask:0xf bank_mask:0xf
  s_cmp_eq_u32 s75, 39
  s_cbranch_scc1 L_epi
  s_call_b64 s[62:63], L_vs
  v_dot2c_f32_bf16_dpp v8, v33, v48 row_newbcast:2 row_mask:0xf bank_mask:0xf
  v_dot2c_f32_bf16_dpp v9, v36, v48 row_newbcast:2 row_mask:0xf bank_mask:0xf
  v_dot2c_f32_bf16_dpp v10, v33, v49 row_newbcast:2 row_mask:0xf bank_mask:0xf
  v_dot2c_f32_bf16_dpp v11, v36, v49 row_newbcast:2 row_mask:0xf bank_mask:0xf
  v_dot2c_f32_bf16_dpp v12, v33, v50 row_newbcast:2 row_mask:0xf bank_mask:0xf
  v_dot2c_f32_bf16_dpp v13, v36, v50 row_newbcast:2 row_mask:0xf bank_mask:0xf
  v_dot2c_f32_bf16_dpp v14, v33, v51 row_newbcast:2 row_mask:0xf bank_mask:0xf
  v_dot2c_f32_bf16_dpp v15, v36, v51 row_newbcast:2 row_mask:0xf bank_mask:0xf
  s_cmp_eq_u32 s75, 40
  s_cbranch_scc1 L_epi
  s_call_b64 s[62:63], L_vs
  v_dot2c_f32_bf16_dpp v8, v33, v52 row_newbcast:3 row_mask:0xf bank_mask:0xf
  v_dot2c_f32_bf16_dpp v9, v36, v52 row_newbcast:3 row_mask:0xf bank_mask:0xf
  v_dot2c_f32_bf16_dpp v10, v33, v53 row_newbcast:3 row_mask:0xf bank_mask:0xf
  v_dot2c_f32_bf16_dpp v11, v36, v53 row_newbcast:3 row_mask:0xf bank_mask:0xf
  v_dot2c_f32_bf16_dpp v12, v33, v54 row_newbcast:3 row_mask:0xf bank_mask:0xf
  v_dot2c_f32_bf16_dpp v13, v36, v54 row_newbcast:3 row_mask:0xf bank_mask:0xf
  v_dot2c_f32_bf16_dpp v14, v33, v55 row_newbcast:3 row_mask:0xf bank_mask:0xf
  v_dot2c_f32_bf16_dpp v15, v36, v55 row_newbcast:3 row_mask:0xf bank_mask:0xf
  s_cmp_eq_u32 s75, 41
  s_cbranch_scc1 L_epi
  s_call_b64 s[62:63], L_vs
  v_dot2c_f32_bf16_dpp v8, v33, v56 row_newbcast:4 row_mask:0xf bank_mask:0xf
  v_dot2c_f32_bf16_dpp v9, v36, v56 row_newbcast:4 row_mask:0xf bank_mask:0xf
  v_dot2c_f32_bf16_dpp v10, v33, v57 row_newbcast:4 row_mask:0xf bank_mask:0xf
  v_dot2c_f32_bf16_dpp v11, v36, v57 row_newbcast:4 row_mask:0xf bank_mask:0xf
  v_dot2c_f32_bf16_dpp v12, v33, v58 row_newbcast:4 row_mask:0xf bank_mask:0xf
  v_dot2c_f32_bf16_dpp v13, v36, v58 row_newbcast:4 row_mask:0xf bank_mask:0xf
  v_dot2c_f32_bf16_dpp v14, v33, v59 row_newbcast:4 row_mask:0xf bank_mask:0xf
  v_dot2c_f32_bf16_dpp v15, v36, v59 row_newbcast:4 row_mask:0xf bank_mask:0xf
  s_cmp_eq_u32 s75, 42
  s_cbranch_scc1 L_epi
  s_call_b64 s[62:63], L_vs
  v_dot2c_f32_bf16_dpp v8, v33, v60 row_newbcast:5 row_mask:0xf bank_mask:0xf
  v_dot2c_f32_bf16_dpp v9, v36, v60 row_newbcast:5 row_mask:0xf bank_mask:0xf
  v_dot2c_f32_bf16_dpp v10, v33, v61 row_newbcast:5 row_mask:0xf bank_mask:0xf
  v_dot2c_f32_bf16_dpp v11, v36, v61 row_newbcast:5 row_mask:0xf bank_mask:0xf
  v_dot2c_f32_bf16_dpp v12, v33, v62 row_newbcast:5 row_mask:0xf bank_mask:0xf
  v_dot2c_f32_bf16_dpp v13, v36, v62 row_newbcast:5 row_mask:0xf bank_mask:0xf
  v_dot2c_f32_bf16_dpp v14, v33, v63 row_newbcast:5 row_mask:0xf bank_mask:0xf
  v_dot2c_f32_bf16_dpp v15, v36, v63 row_newbcast:5 row_mask:0xf bank_mask:0xf
  s_nop 1
L_epi:
  s_nop 0
  s_nop 0
  v_permlane32_swap_b32 v8, v12
  v_permlane32_swap_b32 v9, v13
  v_permlane32_swap_b32 v10, v14
  v_permlane32_swap_b32 v11, v15
  v_add_f32 v8, v8, v12
  v_add_f32 v9, v9, v13
  v_add_f32 v10, v10, v14
  v_add_f32 v11, v11, v15
  v_mov_b32 v3, 1
  v_permlane16_swap_b32 v8, v10
  v_permlane16_swap_b32 v9, v11
  v_add_f32 v8, v8, v10
  v_add_f32 v9, v9, v11
  v_pk_add_f32 v[8:9], v[8:9], v[4:5]
  ds_write_b64 v22, v[8:9] offset:7936
  s_cmp_eq_u32 s21, 0
  s_cbranch_scc1 L_ep2
  ds_write_b64 v22, v[8:9] offset:13056
  s_mov_b64 exec, 1
  ds_add_u32 v1, v3 offset:6704
  s_mov_b64 exec, -1
L_ep2:
  s_mov_b64 exec, 1
  ds_add_rtn_u32 v3, v1, v3 offset:6708
  s_mov_b64 exec, -1
  v_mov_b32 v4, 0
  s_lshl_b32 s10, s6, 11
  s_add_u32 s10, s10, 131072
  v_lshl_add_u32 v2, v1, 3, s10
  v_add_u32 v0, 393216, v2
  s_waitcnt lgkmcnt(0)
  v_readfirstlane_b32 s68, v3
  s_cmp_lg_u32 s68, 9
  s_cbranch_scc1 L_send
  s_cmp_lg_u32 s7, 0
  s_cbranch_scc1 L_nolook
  global_load_dwordx2 v[42:43], v0, s[42:43] offset:512 sc1
  global_load_dwordx2 v[44:45], v0, s[42:43] offset:1024 sc1
  global_load_dwordx2 v[46:47], v0, s[42:43] offset:1536 sc1
  global_load_dwordx2 v[48:49], v2, s[42:43] offset:0 sc1
  global_load_dwordx2 v[50:51], v2, s[42:43] offset:512 sc1
  global_load_dwordx2 v[52:53], v2, s[42:43] offset:1024 sc1
  global_load_dwordx2 v[54:55], v2, s[42:43] offset:1536 sc1
L_nolook:
  s_mov_b32 s70, 0
L_pl_1:
  ds_read_b32 v5, v4 offset:6656
  s_waitcnt lgkmcnt(0)
  v_cmp_eq_u32 vcc, -1, v5
  s_cmp_eq_u64 vcc, 0
  s_cbranch_scc1 L_pld_2
  s_sleep 1
  s_add_u32 s70, s70, 1
  s_cmp_lt_u32 s70, 1048576
  s_cbranch_scc1 L_pl_1
L_pld_2:
  v_lshlrev_b32 v160, 3, v1
  ds_read_b128 v[148:151], v4 offset:6784
  ds_read_b128 v[152:155], v4 offset:6800
  ds_read_b128 v[156:159], v4 offset:6816
  ds_read_b64 v[128:129], v160 offset:7936
  ds_read_b64 v[130:131], v160 offset:8448
  ds_read_b64 v[132:133], v160 offset:8960
  ds_read_b64 v[134:135], v160 offset:9472
  ds_read_b64 v[136:137], v160 offset:9984
  ds_read_b64 v[138:139], v160 offset:10496
  ds_read_b64 v[140:141], v160 offset:11008
  ds_read_b64 v[142:143], v160 offset:11520
  ds_read_b64 v[144:145], v160 offset:12032
  ds_read_b64 v[146:147], v160 offset:12544
  s_lshl_b32 s68, s6, 2
  s_add_u32 s68, s68, s7
  s_lshl_b32 s68, s68, 9
  s_add_u32 s68, s68, 524288
  v_add_u32 v160, s68, v160
  v_and_b32 v161, 1, v1
  v_lshlrev_b32 v161, 4, v161
  v_lshrrev_b32 v161, v161, s74
  v_lshrrev_b32 v162, 8, v161
  s_movk_i32 s69, 0xff
  s_waitcnt lgkmcnt(9)
  v_pk_mul_f32 v[128:129], v[128:129], v[148:149] op_sel:[0,0] op_sel_hi:[1,0]
  s_waitcnt lgkmcnt(8)
  v_pk_mul_f32 v[130:131], v[130:131], v[148:149] op_sel:[0,1] op_sel_hi:[1,1]
  s_waitcnt lgkmcnt(7)
  v_pk_fma_f32 v[128:129], v[132:133], v[150:151], v[128:129] op_sel:[0,0,0] op_sel_hi:[1,0,1]
  s_waitcnt lgkmcnt(6)
  v_pk_fma_f32 v[130:131], v[134:135], v[150:151], v[130:131] op_sel:[0,1,0] op_sel_hi:[1,1,1]
  s_waitcnt lgkmcnt(5)
  v_pk_fma_f32 v[128:129], v[136:137], v[152:153], v[128:129] op_sel:[0,0,0] op_sel_hi:[1,0,1]
  s_waitcnt lgkmcnt(4)
  v_pk_fma_f32 v[130:131], v[138:139], v[152:153], v[130:131] op_sel:[0,1,0] op_sel_hi:[1,1,1]
  s_waitcnt lgkmcnt(3)
  v_pk_fma_f32 v[128:129], v[140:141], v[154:155], v[128:129] op_sel:[0,0,0] op_sel_hi:[1,0,1]
  s_waitcnt lgkmcnt(2)
  v_pk_fma_f32 v[130:131], v[142:143], v[154:155], v[130:131] op_sel:[0,1,0] op_sel_hi:[1,1,1]
  s_waitcnt lgkmcnt(1)
  v_pk_fma_f32 v[128:129], v[144:145], v[156:157], v[128:129] op_sel:[0,0,0] op_sel_hi:[1,0,1]
  s_waitcnt lgkmcnt(0)
  v_pk_fma_f32 v[130:131], v[146:147], v[156:157], v[130:131] op_sel:[0,1,0] op_sel_hi:[1,1,1]
  v_pk_add_f32 v[128:129], v[128:129], v[130:131]
  v_bfi_b32 v128, s69, v161, v128
  v_bfi_b32 v129, s69, v162, v129
  global_store_dwordx2 v160, v[128:129], s[42:43] sc1
  s_cmp_lg_u32 s7, 0
  s_cbranch_scc1 L_send
  v_and_b32 v161, 0xff, v161
  v_and_b32 v162, 0xff, v162
  s_mov_b32 s70, 0
  s_waitcnt vmcnt(1)
  s_branch L_cp1
L_cp0:
  global_load_dwordx2 v[42:43], v0, s[42:43] offset:512 sc1
  global_load_dwordx2 v[44:45], v0, s[42:43] offset:1024 sc1
  global_load_dwordx2 v[46:47], v0, s[42:43] offset:1536 sc1
  global_load_dwordx2 v[48:49], v2, s[42:43] offset:0 sc1
  global_load_dwordx2 v[50:51], v2, s[42:43] offset:512 sc1
  global_load_dwordx2 v[52:53], v2, s[42:43] offset:1024 sc1
  global_load_dwordx2 v[54:55], v2, s[42:43] offset:1536 sc1
  s_waitcnt vmcnt(0)
L_cp1:
  v_xor_b32 v48, v48, v161
  v_xor_b32 v49, v49, v162
  v_xor_b32 v50, v50, v161
  v_xor_b32 v51, v51, v162
  v_xor_b32 v52, v52, v161
  v_xor_b32 v53, v53, v162
  v_xor_b32 v54, v54, v161
  v_xor_b32 v55, v55, v162
  v_or3_b32 v56, v48, v49, v50
  v_or3_b32 v57, v51, v52, v53
  v_or3_b32 v56, v56, v54, v55
  v_or_b32 v48, 0x80, v48
  v_or_b32 v49, 0x80, v49
  v_or_b32 v50, 0x80, v50
  v_or_b32 v51, 0x80, v51
  v_or_b32 v52, 0x80, v52
  v_or_b32 v53, 0x80, v53
  v_or_b32 v54, 0x80, v54
  v_or_b32 v55, 0x80, v55
  v_or_b32 v56, v56, v57
  v_pk_add_f32 v[48:49], v[48:49], v[52:53]
  v_pk_add_f32 v[50:51], v[50:51], v[54:55]
  v_lshlrev_b32 v56, 24, v56
  v_pk_add_f32 v[48:49], v[48:49], v[50:51]
  v_cmp_ne_u32 vcc, 0, v56
  v_cvt_pk_bf16_f32 v48, v48, v49
  s_cmp_eq_u64 vcc, 0
  s_cbranch_scc1 L_cp2
  s_sleep 4
  s_add_u32 s70, s70, 1
  s_cmp_lt_u32 s70, 262144
  s_cbranch_scc1 L_cp0
L_cp2:
  s_mov_b32 s70, 0
  s_branch L_cp4
L_cp3:
  global_load_dwordx2 v[42:43], v0, s[42:43] offset:512 sc1
  global_load_dwordx2 v[44:45], v0, s[42:43] offset:1024 sc1
  global_load_dwordx2 v[46:47], v0, s[42:43] offset:1536 sc1
  s_waitcnt vmcnt(0)
L_cp4:
  v_mov_b32 v40, v128
  v_mov_b32 v41, v129
  v_xor_b32 v40, v40, v161
  v_xor_b32 v41, v41, v162
  v_xor_b32 v42, v42, v161
  v_xor_b32 v43, v43, v162
  v_xor_b32 v44, v44, v161
  v_xor_b32 v45, v45, v162
  v_xor_b32 v46, v46, v161
  v_xor_b32 v47, v47, v162
  v_or3_b32 v56, v40, v41, v42
  v_or3_b32 v57, v43, v44, v45
  v_or3_b32 v56, v56, v46, v47
  v_or_b32 v40, 0x80, v40
  v_or_b32 v41, 0x80, v41
  v_or_b32 v42, 0x80, v42
  v_or_b32 v43, 0x80, v43
  v_or_b32 v44, 0x80, v44
  v_or_b32 v45, 0x80, v45
  v_or_b32 v46, 0x80, v46
  v_or_b32 v47, 0x80, v47
  v_or_b32 v56, v56, v57
  v_pk_add_f32 v[40:41], v[40:41], v[44:45]
  v_pk_add_f32 v[42:43], v[42:43], v[46:47]
  v_lshlrev_b32 v56, 24, v56
  v_pk_add_f32 v[40:41], v[40:41], v[42:43]
  v_cmp_ne_u32 vcc, 0, v56
  v_cvt_pk_bf16_f32 v40, v40, v41
  s_cmp_eq_u64 vcc, 0
  s_cbranch_scc1 L_cp5
  s_add_u32 s70, s70, 1
  s_cmp_lt_u32 s70, 262144
  s_cbranch_scc1 L_cp3
L_cp5:
  v_cmp_ne_u32 vcc, v40, v48
  s_cmp_lg_u64 vcc, 0
  s_cbranch_scc1 L_slow
L_send:
  s_endpgm
L_away:
  v_mov_b32 v4, 1
  v_lshlrev_b32 v5, 6, v4
  v_mul_i32_i24 v6, -28, v4
  s_mov_b64 exec, 1
  ds_add_u32 v1, v5 offset:6680
  ds_add_u32 v1, v5 offset:6672
  ds_add_u32 v1, v4 offset:6704
  ds_add_u32 v1, v4 offset:6708
  ds_add_u32 v1, v6 offset:6688
  s_mov_b64 exec, -1
  v_mov_b32 v3, 0
  s_mov_b32 s70, 0
L_aw_3:
  ds_read_b32 v4, v3 offset:6688
  s_waitcnt lgkmcnt(0)
  v_cmp_lt_u32 vcc, 1120, v4
  s_cmp_eq_u64 vcc, 0
  s_cbranch_scc1 L_aw_3d
  s_sleep 8
  s_add_u32 s70, s70, 1
  s_cmp_lt_u32 s70, 2097152
  s_cbranch_scc1 L_aw_3
L_aw_3d:
  s_mov_b32 s32, 16
  s_mov_b32 s10, 0
L_aw2:
  s_call_b64 s[100:101], L_work
  s_sleep 4
  s_add_u32 s10, s10, 1
  s_cmp_ge_u32 s10, 262144
  s_cbranch_scc1 L_end
  s_cmp_lt_u32 s39, 2
  s_cbranch_scc1 L_aw2
  s_bfe_u32 s61, s15, 0x60008
  s_cmp_lg_u32 s9, 7
  s_cbranch_scc1 L_end
  s_cmp_ge_u32 s61, 32
  s_cbranch_scc1 L_end
  s_waitcnt lgkmcnt(0)
  s_load_dwordx2 s[16:17], s[0:1], 0
  s_load_dwordx2 s[38:39], s[0:1], 88
  v_mov_b32 v38, 0
  s_mov_b32 s60, 3
  s_waitcnt vmcnt(0) lgkmcnt(0)
  s_branch L_mid
L_slow:
  s_load_dwordx16 s[16:31], s[0:1], 0
  s_load_dwordx8 s[32:39], s[0:1], 64
  v_and_b32 v2, 31, v1
  v_lshlrev_b32 v2, 7, v2
  v_add_u32 v2, 28672, v2
  s_mov_b32 s70, 0
L_sl_d:
  global_load_dword v3, v2, s[42:43] sc1
  s_waitcnt vmcnt(0) lgkmcnt(0)
  v_cmp_ne_u32 vcc, s74, v3
  s_cmp_eq_u64 vcc, 0
  s_cbranch_scc1 L_sl_dd
  s_sleep 8
  s_add_u32 s70, s70, 1
  s_cmp_lt_u32 s70, 262144
  s_cbranch_scc1 L_sl_d
L_sl_dd:
  v_lshlrev_b32 v2, 3, v1
  v_add_u32 v2, 524288, v2
  v_lshlrev_b32 v0, 2, v1
  v_add_u32 v0, 83968, v0
  s_mov_b32 s10, 0
L_sl_h:
  s_mov_b32 s70, 0
L_sl_hp:
  global_load_dwordx2 v[40:41], v2, s[42:43] offset:0 sc1
  global_load_dwordx2 v[42:43], v2, s[42:43] offset:512 sc1
  global_load_dwordx2 v[44:45], v2, s[42:43] offset:1024 sc1
  global_load_dwordx2 v[46:47], v2, s[42:43] offset:1536 sc1
  s_waitcnt vmcnt(0)
  v_xor_b32 v40, v40, v161
  v_xor_b32 v41, v41, v162
  v_xor_b32 v42, v42, v161
  v_xor_b32 v43, v43, v162
  v_xor_b32 v44, v44, v161
  v_xor_b32 v45, v45, v162
  v_xor_b32 v46, v46, v161
  v_xor_b32 v47, v47, v162
  v_or3_b32 v48, v40, v41, v42
  v_or3_b32 v49, v43, v44, v45
  v_or3_b32 v48, v48, v46, v47
  v_or_b32 v40, 0x80, v40
  v_or_b32 v41, 0x80, v41
  v_or_b32 v42, 0x80, v42
  v_or_b32 v43, 0x80, v43
  v_or_b32 v44, 0x80, v44
  v_or_b32 v45, 0x80, v45
  v_or_b32 v46, 0x80, v46
  v_or_b32 v47, 0x80, v47
  v_or_b32 v48, v48, v49
  v_pk_add_f32 v[40:41], v[40:41], v[44:45]
  v_pk_add_f32 v[42:43], v[42:43], v[46:47]
  v_lshlrev_b32 v48, 24, v48
  v_pk_add_f32 v[40:41], v[40:41], v[42:43]
  v_cmp_ne_u32 vcc, 0, v48
  v_cvt_pk_bf16_f32 v40, v40, v41
  s_cmp_eq_u64 vcc, 0
  s_cbranch_scc1 L_sl_hd
  s_sleep 8
  s_add_u32 s70, s70, 1
  s_cmp_lt_u32 s70, 262144
  s_cbranch_scc1 L_sl_hp
L_sl_hd:
  ds_write_b32 v0, v40
  v_add_u32 v2, 2048, v2
  v_add_u32 v0, 256, v0
  s_add_u32 s10, s10, 1
  s_cmp_lt_u32 s10, 64
  s_cbranch_scc1 L_sl_h
  s_mov_b32 s44, s24
  s_mov_b32 s45, s25
  s_mov_b32 s46, 4194304
  s_mov_b32 s11, 1024
  s_mov_b32 s12, 4194304
  v_mov_b32 v4, 83968
  v_mov_b32 v5, 92160
  v_lshlrev_b32 v2, 4, v1
  s_call_b64 s[62:63], L_gv
  v_lshlrev_b32 v0, 4, v1
  global_load_dwordx4 v[40:43], v0, s[16:17] offset:0
  global_load_dwordx4 v[44:47], v0, s[16:17] offset:1024
  s_waitcnt vmcnt(0)
  v_lshlrev_b32 v104, 16, v40
  v_and_b32 v105, s73, v40
  v_lshlrev_b32 v106, 16, v41
  v_and_b32 v107, s73, v41
  v_lshlrev_b32 v108, 16, v42
  v_and_b32 v109, s73, v42
  v_lshlrev_b32 v110, 16, v43
  v_and_b32 v111, s73, v43
  v_lshlrev_b32 v112, 16, v44
  v_and_b32 v113, s73, v44
  v_lshlrev_b32 v114, 16, v45
  v_and_b32 v115, s73, v45
  v_lshlrev_b32 v116, 16, v46
  v_and_b32 v117, s73, v46
  v_lshlrev_b32 v118, 16, v47
  v_and_b32 v119, s73, v47
  v_lshrrev_b32 v2, 1, v1
  v_lshlrev_b32 v2, 7, v2
  v_and_b32 v3, 1, v1
  v_lshl_add_u32 v2, v3, 5, v2
  v_add_u32 v2, 12288, v2
  global_load_dwordx4 v[40:43], v2, s[42:43] offset:0 sc1
  global_load_dwordx4 v[44:47], v2, s[42:43] offset:16 sc1
  global_load_dwordx4 v[48:51], v2, s[42:43] offset:64 sc1
  global_load_dwordx4 v[52:55], v2, s[42:43] offset:80 sc1
  s_waitcnt vmcnt(0)
  v_lshlrev_b32 v88, 16, v40
  v_and_b32 v89, s73, v40
  v_lshlrev_b32 v90, 16, v42
  v_and_b32 v91, s73, v42
  v_lshlrev_b32 v92, 16, v44
  v_and_b32 v93, s73, v44
  v_lshlrev_b32 v94, 16, v46
  v_and_b32 v95, s73, v46
  v_lshlrev_b32 v96, 16, v48
  v_and_b32 v97, s73, v48
  v_lshlrev_b32 v98, 16, v50
  v_and_b32 v99, s73, v50
  v_lshlrev_b32 v100, 16, v52
  v_and_b32 v101, s73, v52
  v_lshlrev_b32 v102, 16, v54
  v_and_b32 v103, s73, v54
  v_cvt_pk_bf16_f32 v72, 0, v72
  v_cvt_pk_bf16_f32 v73, 0, v73
  v_cvt_pk_bf16_f32 v74, 0, v74
  v_cvt_pk_bf16_f32 v75, 0, v75
  v_cvt_pk_bf16_f32 v76, 0, v76
  v_cvt_pk_bf16_f32 v77, 0, v77
  v_cvt_pk_bf16_f32 v78, 0, v78
  v_cvt_pk_bf16_f32 v79, 0, v79
  v_cvt_pk_bf16_f32 v80, 0, v80
  v_cvt_pk_bf16_f32 v81, 0, v81
  v_cvt_pk_bf16_f32 v82, 0, v82
  v_cvt_pk_bf16_f32 v83, 0, v83
  v_cvt_pk_bf16_f32 v84, 0, v84
  v_cvt_pk_bf16_f32 v85, 0, v85
  v_cvt_pk_bf16_f32 v86, 0, v86
  v_cvt_pk_bf16_f32 v87, 0, v87
  v_mul_f32 v72, v72, v88
  v_mul_f32 v73, v73, v89
  v_mul_f32 v74, v74, v90
  v_mul_f32 v75, v75, v91
  v_mul_f32 v76, v76, v92
  v_mul_f32 v77, v77, v93
  v_mul_f32 v78, v78, v94
  v_mul_f32 v79, v79, v95
  v_mul_f32 v80, v80, v96
  v_mul_f32 v81, v81, v97
  v_mul_f32 v82, v82, v98
  v_mul_f32 v83, v83, v99
  v_mul_f32 v84, v84, v100
  v_mul_f32 v85, v85, v101
  v_mul_f32 v86, v86, v102
  v_mul_f32 v87, v87, v103
  v_cvt_pk_bf16_f32 v72, 0, v72
  v_cvt_pk_bf16_f32 v73, 0, v73
  v_cvt_pk_bf16_f32 v74, 0, v74
  v_cvt_pk_bf16_f32 v75, 0, v75
  v_cvt_pk_bf16_f32 v76, 0, v76
  v_cvt_pk_bf16_f32 v77, 0, v77
  v_cvt_pk_bf16_f32 v78, 0, v78
  v_cvt_pk_bf16_f32 v79, 0, v79
  v_cvt_pk_bf16_f32 v80, 0, v80
  v_cvt_pk_bf16_f32 v81, 0, v81
  v_cvt_pk_bf16_f32 v82, 0, v82
  v_cvt_pk_bf16_f32 v83, 0, v83
  v_cvt_pk_bf16_f32 v84, 0, v84
  v_cvt_pk_bf16_f32 v85, 0, v85
  v_cvt_pk_bf16_f32 v86, 0, v86
  v_cvt_pk_bf16_f32 v87, 0, v87
  v_add_f32 v104, v104, v72
  v_add_f32 v105, v105, v73
  v_add_f32 v106, v106, v74
  v_add_f32 v107, v107, v75
  v_add_f32 v108, v108, v76
  v_add_f32 v109, v109, v77
  v_add_f32 v110, v110, v78
  v_add_f32 v111, v111, v79
  v_add_f32 v112, v112, v80
  v_add_f32 v113, v113, v81
  v_add_f32 v114, v114, v82
  v_add_f32 v115, v115, v83
  v_add_f32 v116, v116, v84
  v_add_f32 v117, v117, v85
  v_add_f32 v118, v118, v86
  v_add_f32 v119, v119, v87
  v_cvt_pk_bf16_f32 v104, 0, v104
  v_cvt_pk_bf16_f32 v105, 0, v105
  v_cvt_pk_bf16_f32 v106, 0, v106
  v_cvt_pk_bf16_f32 v107, 0, v107
  v_cvt_pk_bf16_f32 v108, 0, v108
  v_cvt_pk_bf16_f32 v109, 0, v109
  v_cvt_pk_bf16_f32 v110, 0, v110
  v_cvt_pk_bf16_f32 v111, 0, v111
  v_cvt_pk_bf16_f32 v112, 0, v112
  v_cvt_pk_bf16_f32 v113, 0, v113
  v_cvt_pk_bf16_f32 v114, 0, v114
  v_cvt_pk_bf16_f32 v115, 0, v115
  v_cvt_pk_bf16_f32 v116, 0, v116
  v_cvt_pk_bf16_f32 v117, 0, v117
  v_cvt_pk_bf16_f32 v118, 0, v118
  v_cvt_pk_bf16_f32 v119, 0, v119
  v_add_f32 v8, v104, v105
  v_add_f32 v8, v8, v106
  v_add_f32 v8, v8, v107
  v_add_f32 v8, v8, v108
  v_add_f32 v8, v8, v109
  v_add_f32 v8, v8, v110
  v_add_f32 v8, v8, v111
  s_nop 1
  v_add_f32_dpp v8, v8, v8 row_ror:8 row_mask:0xf bank_mask:0xf
  s_nop 1
  v_add_f32_dpp v8, v8, v8 row_ror:4 row_mask:0xf bank_mask:0xf
  s_nop 1
  v_add_f32_dpp v8, v8, v8 row_ror:2 row_mask:0xf bank_mask:0xf
  s_nop 1
  v_add_f32_dpp v8, v8, v8 row_ror:1 row_mask:0xf bank_mask:0xf
  v_mov_b32 v9, v8
  s_nop 1
  v_permlane16_swap_b32 v9, v8
  v_add_f32 v8, v8, v9
  v_mov_b32 v9, v8
  s_nop 1
  v_permlane32_swap_b32 v9, v8
  v_add_f32 v8, v8, v9
  v_mul_f32 v8, 0x3b000000, v8
  v_sub_f32 v72, v104, v8
  v_sub_f32 v73, v105, v8
  v_sub_f32 v74, v106, v8
  v_sub_f32 v75, v107, v8
  v_sub_f32 v76, v108, v8
  v_sub_f32 v77, v109, v8
  v_sub_f32 v78, v110, v8
  v_sub_f32 v79, v111, v8
  v_mul_f32 v10, v72, v72
  v_fmac_f32 v10, v73, v73
  v_fmac_f32 v10, v74, v74
  v_fmac_f32 v10, v75, v75
  v_fmac_f32 v10, v76, v76
  v_fmac_f32 v10, v77, v77
  v_fmac_f32 v10, v78, v78
  v_fmac_f32 v10, v79, v79
  s_nop 1
  v_add_f32_dpp v10, v10, v10 row_ror:8 row_mask:0xf bank_mask:0xf
  s_nop 1
  v_add_f32_dpp v10, v10, v10 row_ror:4 row_mask:0xf bank_mask:0xf
  s_nop 1
  v_add_f32_dpp v10, v10, v10 row_ror:2 row_mask:0xf bank_mask:0xf
  s_nop 1
  v_add_f32_dpp v10, v10, v10 row_ror:1 row_mask:0xf bank_mask:0xf
  v_mov_b32 v9, v10
  s_nop 1
  v_permlane16_swap_b32 v9, v10
  v_add_f32 v10, v10, v9
  v_mov_b32 v9, v10
  s_nop 1
  v_permlane32_swap_b32 v9, v10
  v_add_f32 v10, v10, v9
  v_mul_f32 v10, 0x3b000000, v10
  v_cvt_pk_bf16_f32 v8, 0, v8
  v_cvt_pk_bf16_f32 v10, 0, v10
  v_add_f32 v10, 0x3727c5ac, v10
  v_cvt_pk_bf16_f32 v10, 0, v10
  v_sqrt_f32 v10, v10
  v_sub_f32 v72, v104, v8
  v_sub_f32 v73, v105, v8
  v_sub_f32 v74, v106, v8
  v_sub_f32 v75, v107, v8
  v_sub_f32 v76, v108, v8
  v_sub_f32 v77, v109, v8
  v_sub_f32 v78, v110, v8
  v_sub_f32 v79, v111, v8
  v_cvt_pk_bf16_f32 v10, 0, v10
  v_cvt_pk_bf16_f32 v72, 0, v72
  v_cvt_pk_bf16_f32 v73, 0, v73
  v_cvt_pk_bf16_f32 v74, 0, v74
  v_cvt_pk_bf16_f32 v75, 0, v75
  v_cvt_pk_bf16_f32 v76, 0, v76
  v_cvt_pk_bf16_f32 v77, 0, v77
  v_cvt_pk_bf16_f32 v78, 0, v78
  v_cvt_pk_bf16_f32 v79, 0, v79
  v_rcp_f32 v10, v10
  s_nop 0
  v_mul_f32 v72, v72, v10
  v_mul_f32 v73, v73, v10
  v_mul_f32 v74, v74, v10
  v_mul_f32 v75, v75, v10
  v_mul_f32 v76, v76, v10
  v_mul_f32 v77, v77, v10
  v_mul_f32 v78, v78, v10
  v_mul_f32 v79, v79, v10
  v_cvt_pk_bf16_f32 v72, 0, v72
  v_cvt_pk_bf16_f32 v73, 0, v73
  v_cvt_pk_bf16_f32 v74, 0, v74
  v_cvt_pk_bf16_f32 v75, 0, v75
  v_cvt_pk_bf16_f32 v76, 0, v76
  v_cvt_pk_bf16_f32 v77, 0, v77
  v_cvt_pk_bf16_f32 v78, 0, v78
  v_cvt_pk_bf16_f32 v79, 0, v79
  v_add_f32 v8, v112, v113
  v_add_f32 v8, v8, v114
  v_add_f32 v8, v8, v115
  v_add_f32 v8, v8, v116
  v_add_f32 v8, v8, v117
  v_add_f32 v8, v8, v118
  v_add_f32 v8, v8, v119
  s_nop 1
  v_add_f32_dpp v8, v8, v8 row_ror:8 row_mask:0xf bank_mask:0xf
  s_nop 1
  v_add_f32_dpp v8, v8, v8 row_ror:4 row_mask:0xf bank_mask:0xf
  s_nop 1
  v_add_f32_dpp v8, v8, v8 row_ror:2 row_mask:0xf bank_mask:0xf
  s_nop 1
  v_add_f32_dpp v8, v8, v8 row_ror:1 row_mask:0xf bank_mask:0xf
  v_mov_b32 v9, v8
  s_nop 1
  v_permlane16_swap_b32 v9, v8
  v_add_f32 v8, v8, v9
  v_mov_b32 v9, v8
  s_nop 1
  v_permlane32_swap_b32 v9, v8
  v_add_f32 v8, v8, v9
  v_mul_f32 v8, 0x3b000000, v8
  v_sub_f32 v80, v112, v8
  v_sub_f32 v81, v113, v8
  v_sub_f32 v82, v114, v8
  v_sub_f32 v83, v115, v8
  v_sub_f32 v84, v116, v8
  v_sub_f32 v85, v117, v8
  v_sub_f32 v86, v118, v8
  v_sub_f32 v87, v119, v8
  v_mul_f32 v10, v80, v80
  v_fmac_f32 v10, v81, v81
  v_fmac_f32 v10, v82, v82
  v_fmac_f32 v10, v83, v83
  v_fmac_f32 v10, v84, v84
  v_fmac_f32 v10, v85, v85
  v_fmac_f32 v10, v86, v86
  v_fmac_f32 v10, v87, v87
  s_nop 1
  v_add_f32_dpp v10, v10, v10 row_ror:8 row_mask:0xf bank_mask:0xf
  s_nop 1
  v_add_f32_dpp v10, v10, v10 row_ror:4 row_mask:0xf bank_mask:0xf
  s_nop 1
  v_add_f32_dpp v10, v10, v10 row_ror:2 row_mask:0xf bank_mask:0xf
  s_nop 1
  v_add_f32_dpp v10, v10, v10 row_ror:1 row_mask:0xf bank_mask:0xf
  v_mov_b32 v9, v10
  s_nop 1
  v_permlane16_swap_b32 v9, v10
  v_add_f32 v10, v10, v9
  v_mov_b32 v9, v10
  s_nop 1
  v_permlane32_swap_b32 v9, v10
  v_add_f32 v10, v10, v9
  v_mul_f32 v10, 0x3b000000, v10
  v_cvt_pk_bf16_f32 v8, 0, v8
  v_cvt_pk_bf16_f32 v10, 0, v10
  v_add_f32 v10, 0x3727c5ac, v10
  v_cvt_pk_bf16_f32 v10, 0, v10
  v_sqrt_f32 v10, v10
  v_sub_f32 v80, v112, v8
  v_sub_f32 v81, v113, v8
  v_sub_f32 v82, v114, v8
  v_sub_f32 v83, v115, v8
  v_sub_f32 v84, v116, v8
  v_sub_f32 v85, v117, v8
  v_sub_f32 v86, v118, v8
  v_sub_f32 v87, v119, v8
  v_cvt_pk_bf16_f32 v10, 0, v10
  v_cvt_pk_bf16_f32 v80, 0, v80
  v_cvt_pk_bf16_f32 v81, 0, v81
  v_cvt_pk_bf16_f32 v82, 0, v82
  v_cvt_pk_bf16_f32 v83, 0, v83
  v_cvt_pk_bf16_f32 v84, 0, v84
  v_cvt_pk_bf16_f32 v85, 0, v85
  v_cvt_pk_bf16_f32 v86, 0, v86
  v_cvt_pk_bf16_f32 v87, 0, v87
  v_rcp_f32 v10, v10
  s_nop 0
  v_mul_f32 v80, v80, v10
  v_mul_f32 v81, v81, v10
  v_mul_f32 v82, v82, v10
  v_mul_f32 v83, v83, v10
  v_mul_f32 v84, v84, v10
  v_mul_f32 v85, v85, v10
  v_mul_f32 v86, v86, v10
  v_mul_f32 v87, v87, v10
  v_cvt_pk_bf16_f32 v80, 0, v80
  v_cvt_pk_bf16_f32 v81, 0, v81
  v_cvt_pk_bf16_f32 v82, 0, v82
  v_cvt_pk_bf16_f32 v83, 0, v83
  v_cvt_pk_bf16_f32 v84, 0, v84
  v_cvt_pk_bf16_f32 v85, 0, v85
  v_cvt_pk_bf16_f32 v86, 0, v86
  v_cvt_pk_bf16_f32 v87, 0, v87
  v_lshrrev_b32 v2, 1, v1
  v_lshlrev_b32 v2, 7, v2
  v_and_b32 v3, 1, v1
  v_lshl_add_u32 v2, v3, 5, v2
  v_add_u32 v2, 20480, v2
  global_load_dwordx4 v[40:43], v2, s[42:43] offset:0 sc1
  global_load_dwordx4 v[44:47], v2, s[42:43] offset:16 sc1
  global_load_dwordx4 v[48:51], v2, s[42:43] offset:64 sc1
  global_load_dwordx4 v[52:55], v2, s[42:43] offset:80 sc1
  s_waitcnt vmcnt(0)
  v_lshlrev_b32 v88, 16, v40
  v_and_b32 v89, s73, v40
  v_lshlrev_b32 v90, 16, v42
  v_and_b32 v91, s73, v42
  v_lshlrev_b32 v92, 16, v44
  v_and_b32 v93, s73, v44
  v_lshlrev_b32 v94, 16, v46
  v_and_b32 v95, s73, v46
  v_lshlrev_b32 v96, 16, v48
  v_and_b32 v97, s73, v48
  v_lshlrev_b32 v98, 16, v50
  v_and_b32 v99, s73, v50
  v_lshlrev_b32 v100, 16, v52
  v_and_b32 v101, s73, v52
  v_lshlrev_b32 v102, 16, v54
  v_and_b32 v103, s73, v54
  v_add_f32 v88, 1.0, v88
  v_add_f32 v89, 1.0, v89
  v_add_f32 v90, 1.0, v90
  v_add_f32 v91, 1.0, v91
  v_add_f32 v92, 1.0, v92
  v_add_f32 v93, 1.0, v93
  v_add_f32 v94, 1.0, v94
  v_add_f32 v95, 1.0, v95
  v_add_f32 v96, 1.0, v96
  v_add_f32 v97, 1.0, v97
  v_add_f32 v98, 1.0, v98
  v_add_f32 v99, 1.0, v99
  v_add_f32 v100, 1.0, v100
  v_add_f32 v101, 1.0, v101
  v_add_f32 v102, 1.0, v102
  v_add_f32 v103, 1.0, v103
  v_cvt_pk_bf16_f32 v88, 0, v88
  v_cvt_pk_bf16_f32 v89, 0, v89
  v_cvt_pk_bf16_f32 v90, 0, v90
  v_cvt_pk_bf16_f32 v91, 0, v91
  v_cvt_pk_bf16_f32 v92, 0, v92
  v_cvt_pk_bf16_f32 v93, 0, v93
  v_cvt_pk_bf16_f32 v94, 0, v94
  v_cvt_pk_bf16_f32 v95, 0, v95
  v_cvt_pk_bf16_f32 v96, 0, v96
  v_cvt_pk_bf16_f32 v97, 0, v97
  v_cvt_pk_bf16_f32 v98, 0, v98
  v_cvt_pk_bf16_f32 v99, 0, v99
  v_cvt_pk_bf16_f32 v100, 0, v100
  v_cvt_pk_bf16_f32 v101, 0, v101
  v_cvt_pk_bf16_f32 v102, 0, v102
  v_cvt_pk_bf16_f32 v103, 0, v103
  v_mul_f32 v72, v72, v88
  v_mul_f32 v73, v73, v89
  v_mul_f32 v74, v74, v90
  v_mul_f32 v75, v75, v91
  v_mul_f32 v76, v76, v92
  v_mul_f32 v77, v77, v93
  v_mul_f32 v78, v78, v94
  v_mul_f32 v79, v79, v95
  v_mul_f32 v80, v80, v96
  v_mul_f32 v81, v81, v97
  v_mul_f32 v82, v82, v98
  v_mul_f32 v83, v83, v99
  v_mul_f32 v84, v84, v100
  v_mul_f32 v85, v85, v101
  v_mul_f32 v86, v86, v102
  v_mul_f32 v87, v87, v103
  v_cvt_pk_bf16_f32 v72, 0, v72
  v_cvt_pk_bf16_f32 v73, 0, v73
  v_cvt_pk_bf16_f32 v74, 0, v74
  v_cvt_pk_bf16_f32 v75, 0, v75
  v_cvt_pk_bf16_f32 v76, 0, v76
  v_cvt_pk_bf16_f32 v77, 0, v77
  v_cvt_pk_bf16_f32 v78, 0, v78
  v_cvt_pk_bf16_f32 v79, 0, v79
  v_cvt_pk_bf16_f32 v80, 0, v80
  v_cvt_pk_bf16_f32 v81, 0, v81
  v_cvt_pk_bf16_f32 v82, 0, v82
  v_cvt_pk_bf16_f32 v83, 0, v83
  v_cvt_pk_bf16_f32 v84, 0, v84
  v_cvt_pk_bf16_f32 v85, 0, v85
  v_cvt_pk_bf16_f32 v86, 0, v86
  v_cvt_pk_bf16_f32 v87, 0, v87
  v_lshrrev_b32 v2, 1, v1
  v_lshlrev_b32 v2, 7, v2
  v_and_b32 v3, 1, v1
  v_lshl_add_u32 v2, v3, 5, v2
  v_add_u32 v2, 16384, v2
  global_load_dwordx4 v[40:43], v2, s[42:43] offset:0 sc1
  global_load_dwordx4 v[44:47], v2, s[42:43] offset:16 sc1
  global_load_dwordx4 v[48:51], v2, s[42:43] offset:64 sc1
  global_load_dwordx4 v[52:55], v2, s[42:43] offset:80 sc1
  s_waitcnt vmcnt(0)
  v_lshlrev_b32 v88, 16, v40
  v_and_b32 v89, s73, v40
  v_lshlrev_b32 v90, 16, v42
  v_and_b32 v91, s73, v42
  v_lshlrev_b32 v92, 16, v44
  v_and_b32 v93, s73, v44
  v_lshlrev_b32 v94, 16, v46
  v_and_b32 v95, s73, v46
  v_lshlrev_b32 v96, 16, v48
  v_and_b32 v97, s73, v48
  v_lshlrev_b32 v98, 16, v50
  v_and_b32 v99, s73, v50
  v_lshlrev_b32 v100, 16, v52
  v_and_b32 v101, s73, v52
  v_lshlrev_b32 v102, 16, v54
  v_and_b32 v103, s73, v54
  v_add_f32 v72, v72, v88
  v_add_f32 v73, v73, v89
  v_add_f32 v74, v74, v90
  v_add_f32 v75, v75, v91
  v_add_f32 v76, v76, v92
  v_add_f32 v77, v77, v93
  v_add_f32 v78, v78, v94
  v_add_f32 v79, v79, v95
  v_add_f32 v80, v80, v96
  v_add_f32 v81, v81, v97
  v_add_f32 v82, v82, v98
  v_add_f32 v83, v83, v99
  v_add_f32 v84, v84, v100
  v_add_f32 v85, v85, v101
  v_add_f32 v86, v86, v102
  v_add_f32 v87, v87, v103
  v_cvt_pk_bf16_f32 v40, v72, v73
  v_cvt_pk_bf16_f32 v41, v74, v75
  v_cvt_pk_bf16_f32 v42, v76, v77
  v_cvt_pk_bf16_f32 v43, v78, v79
  v_cvt_pk_bf16_f32 v44, v80, v81
  v_cvt_pk_bf16_f32 v45, v82, v83
  v_cvt_pk_bf16_f32 v46, v84, v85
  v_cvt_pk_bf16_f32 v47, v86, v87
  v_add_u32 v3, 83968, v0
  ds_write_b128 v3, v[40:43] offset:0
  ds_write_b128 v3, v[44:47] offset:1024
  s_mov_b32 s44, s28
  s_mov_b32 s45, s29
  s_mov_b32 s46, 1409024
  s_mov_b32 s11, 2752
  s_mov_b32 s12, 1409024
  v_mov_b32 v4, 83968
  v_mov_b32 v5, 84992
  v_lshlrev_b32 v2, 4, v1
  s_call_b64 s[62:63], L_gv
  v_cvt_pk_bf16_f32 v120, 0, v72
  v_cvt_pk_bf16_f32 v121, 0, v73
  v_cvt_pk_bf16_f32 v122, 0, v74
  v_cvt_pk_bf16_f32 v123, 0, v75
  v_cvt_pk_bf16_f32 v124, 0, v76
  v_cvt_pk_bf16_f32 v125, 0, v77
  v_cvt_pk_bf16_f32 v126, 0, v78
  v_cvt_pk_bf16_f32 v127, 0, v79
  v_cvt_pk_bf16_f32 v128, 0, v80
  v_cvt_pk_bf16_f32 v129, 0, v81
  v_cvt_pk_bf16_f32 v130, 0, v82
  v_cvt_pk_bf16_f32 v131, 0, v83
  v_cvt_pk_bf16_f32 v132, 0, v84
  v_cvt_pk_bf16_f32 v133, 0, v85
  v_cvt_pk_bf16_f32 v134, 0, v86
  v_cvt_pk_bf16_f32 v135, 0, v87
  s_mov_b32 s44, s30
  s_mov_b32 s45, s31
  s_mov_b32 s46, 1409024
  s_mov_b32 s11, 2752
  s_mov_b32 s12, 1409024
  v_mov_b32 v4, 83968
  v_mov_b32 v5, 84992
  v_lshlrev_b32 v2, 4, v1
  s_call_b64 s[62:63], L_gv
  v_mul_f32 v88, 0xbfb8aa3b, v120
  v_mul_f32 v89, 0xbfb8aa3b, v121
  v_mul_f32 v90, 0xbfb8aa3b, v122
  v_mul_f32 v91, 0xbfb8aa3b, v123
  v_exp_f32 v88, v88
  v_exp_f32 v89, v89
  v_exp_f32 v90, v90
  v_exp_f32 v91, v91
  s_nop 0
  v_add_f32 v88, 1.0, v88
  v_add_f32 v89, 1.0, v89
  v_add_f32 v90, 1.0, v90
  v_add_f32 v91, 1.0, v91
  v_rcp_f32 v88, v88
  v_rcp_f32 v89, v89
  v_rcp_f32 v90, v90
  v_rcp_f32 v91, v91
  s_nop 0
  v_mul_f32 v120, v120, v88
  v_mul_f32 v121, v121, v89
  v_mul_f32 v122, v122, v90
  v_mul_f32 v123, v123, v91
  v_mul_f32 v88, 0xbfb8aa3b, v124
  v_mul_f32 v89, 0xbfb8aa3b, v125
  v_mul_f32 v90, 0xbfb8aa3b, v126
  v_mul_f32 v91, 0xbfb8aa3b, v127
  v_exp_f32 v88, v88
  v_exp_f32 v89, v89
  v_exp_f32 v90, v90
  v_exp_f32 v91, v91
  s_nop 0
  v_add_f32 v88, 1.0, v88
  v_add_f32 v89, 1.0, v89
  v_add_f32 v90, 1.0, v90
  v_add_f32 v91, 1.0, v91
  v_rcp_f32 v88, v88
  v_rcp_f32 v89, v89
  v_rcp_f32 v90, v90
  v_rcp_f32 v91, v91
  s_nop 0
  v_mul_f32 v124, v124, v88
  v_mul_f32 v125, v125, v89
  v_mul_f32 v126, v126, v90
  v_mul_f32 v127, v127, v91
  v_mul_f32 v88, 0xbfb8aa3b, v128
  v_mul_f32 v89, 0xbfb8aa3b, v129
  v_mul_f32 v90, 0xbfb8aa3b, v130
  v_mul_f32 v91, 0xbfb8aa3b, v131
  v_exp_f32 v88, v88
  v_exp_f32 v89, v89
  v_exp_f32 v90, v90
  v_exp_f32 v91, v91
  s_nop 0
  v_add_f32 v88, 1.0, v88
  v_add_f32 v89, 1.0, v89
  v_add_f32 v90, 1.0, v90
  v_add_f32 v91, 1.0, v91
  v_rcp_f32 v88, v88
  v_rcp_f32 v89, v89
  v_rcp_f32 v90, v90
  v_rcp_f32 v91, v91
  s_nop 0
  v_mul_f32 v128, v128, v88
  v_mul_f32 v129, v129, v89
  v_mul_f32 v130, v130, v90
  v_mul_f32 v131, v131, v91
  v_mul_f32 v88, 0xbfb8aa3b, v132
  v_mul_f32 v89, 0xbfb8aa3b, v133
  v_mul_f32 v90, 0xbfb8aa3b, v134
  v_mul_f32 v91, 0xbfb8aa3b, v135
  v_exp_f32 v88, v88
  v_exp_f32 v89, v89
  v_exp_f32 v90, v90
  v_exp_f32 v91, v91
  s_nop 0
  v_add_f32 v88, 1.0, v88
  v_add_f32 v89, 1.0, v89
  v_add_f32 v90, 1.0, v90
  v_add_f32 v91, 1.0, v91
  v_rcp_f32 v88, v88
  v_rcp_f32 v89, v89
  v_rcp_f32 v90, v90
  v_rcp_f32 v91, v91
  s_nop 0
  v_mul_f32 v132, v132, v88
  v_mul_f32 v133, v133, v89
  v_mul_f32 v134, v134, v90
  v_mul_f32 v135, v135, v91
  v_cvt_pk_bf16_f32 v120, 0, v120
  v_cvt_pk_bf16_f32 v121, 0, v121
  v_cvt_pk_bf16_f32 v122, 0, v122
  v_cvt_pk_bf16_f32 v123, 0, v123
  v_cvt_pk_bf16_f32 v124, 0, v124
  v_cvt_pk_bf16_f32 v125, 0, v125
  v_cvt_pk_bf16_f32 v126, 0, v126
  v_cvt_pk_bf16_f32 v127, 0, v127
  v_cvt_pk_bf16_f32 v128, 0, v128
  v_cvt_pk_bf16_f32 v129, 0, v129
  v_cvt_pk_bf16_f32 v130, 0, v130
  v_cvt_pk_bf16_f32 v131, 0, v131
  v_cvt_pk_bf16_f32 v132, 0, v132
  v_cvt_pk_bf16_f32 v133, 0, v133
  v_cvt_pk_bf16_f32 v134, 0, v134
  v_cvt_pk_bf16_f32 v135, 0, v135
  v_cvt_pk_bf16_f32 v72, 0, v72
  v_cvt_pk_bf16_f32 v73, 0, v73
  v_cvt_pk_bf16_f32 v74, 0, v74
  v_cvt_pk_bf16_f32 v75, 0, v75
  v_cvt_pk_bf16_f32 v76, 0, v76
  v_cvt_pk_bf16_f32 v77, 0, v77
  v_cvt_pk_bf16_f32 v78, 0, v78
  v_cvt_pk_bf16_f32 v79, 0, v79
  v_cvt_pk_bf16_f32 v80, 0, v80
  v_cvt_pk_bf16_f32 v81, 0, v81
  v_cvt_pk_bf16_f32 v82, 0, v82
  v_cvt_pk_bf16_f32 v83, 0, v83
  v_cvt_pk_bf16_f32 v84, 0, v84
  v_cvt_pk_bf16_f32 v85, 0, v85
  v_cvt_pk_bf16_f32 v86, 0, v86
  v_cvt_pk_bf16_f32 v87, 0, v87
  v_mul_f32 v72, v72, v120
  v_mul_f32 v73, v73, v121
  v_mul_f32 v74, v74, v122
  v_mul_f32 v75, v75, v123
  v_mul_f32 v76, v76, v124
  v_mul_f32 v77, v77, v125
  v_mul_f32 v78, v78, v126
  v_mul_f32 v79, v79, v127
  v_mul_f32 v80, v80, v128
  v_mul_f32 v81, v81, v129
  v_mul_f32 v82, v82, v130
  v_mul_f32 v83, v83, v131
  v_mul_f32 v84, v84, v132
  v_mul_f32 v85, v85, v133
  v_mul_f32 v86, v86, v134
  v_mul_f32 v87, v87, v135
  v_cvt_pk_bf16_f32 v40, v72, v73
  v_cvt_pk_bf16_f32 v41, v74, v75
  v_cvt_pk_bf16_f32 v42, v76, v77
  v_cvt_pk_bf16_f32 v43, v78, v79
  v_cvt_pk_bf16_f32 v44, v80, v81
  v_cvt_pk_bf16_f32 v45, v82, v83
  v_cvt_pk_bf16_f32 v46, v84, v85
  v_cvt_pk_bf16_f32 v47, v86, v87
  v_add_u32 v3, 86016, v0
  ds_write_b128 v3, v[40:43] offset:0
  ds_write_b128 v3, v[44:47] offset:3072
  s_mov_b32 s44, s28
  s_mov_b32 s45, s29
  s_mov_b32 s46, 1409024
  s_mov_b32 s11, 2752
  s_mov_b32 s12, 1409024
  v_mov_b32 v4, 83968
  v_mov_b32 v5, 84992
  v_lshlrev_b32 v2, 4, v1
  v_add_u32 v2, 1024, v2
  s_call_b64 s[62:63], L_gv
  v_cvt_pk_bf16_f32 v120, 0, v72
  v_cvt_pk_bf16_f32 v121, 0, v73
  v_cvt_pk_bf16_f32 v122, 0, v74
  v_cvt_pk_bf16_f32 v123, 0, v75
  v_cvt_pk_bf16_f32 v124, 0, v76
  v_cvt_pk_bf16_f32 v125, 0, v77
  v_cvt_pk_bf16_f32 v126, 0, v78
  v_cvt_pk_bf16_f32 v127, 0, v79
  v_cvt_pk_bf16_f32 v128, 0, v80
  v_cvt_pk_bf16_f32 v129, 0, v81
  v_cvt_pk_bf16_f32 v130, 0, v82
  v_cvt_pk_bf16_f32 v131, 0, v83
  v_cvt_pk_bf16_f32 v132, 0, v84
  v_cvt_pk_bf16_f32 v133, 0, v85
  v_cvt_pk_bf16_f32 v134, 0, v86
  v_cvt_pk_bf16_f32 v135, 0, v87
  s_mov_b32 s44, s30
  s_mov_b32 s45, s31
  s_mov_b32 s46, 1409024
  s_mov_b32 s11, 2752
  s_mov_b32 s12, 1409024
  v_mov_b32 v4, 83968
  v_mov_b32 v5, 84992
  v_lshlrev_b32 v2, 4, v1
  v_add_u32 v2, 1024, v2
  s_call_b64 s[62:63], L_gv
  v_mul_f32 v88, 0xbfb8aa3b, v120
  v_mul_f32 v89, 0xbfb8aa3b, v121
  v_mul_f32 v90, 0xbfb8aa3b, v122
  v_mul_f32 v91, 0xbfb8aa3b, v123
  v_exp_f32 v88, v88
  v_exp_f32 v89, v89
  v_exp_f32 v90, v90
  v_exp_f32 v91, v91
  s_nop 0
  v_add_f32 v88, 1.0, v88
  v_add_f32 v89, 1.0, v89
  v_add_f32 v90, 1.0, v90
  v_add_f32 v91, 1.0, v91
  v_rcp_f32 v88, v88
  v_rcp_f32 v89, v89
  v_rcp_f32 v90, v90
  v_rcp_f32 v91, v91
  s_nop 0
  v_mul_f32 v120, v120, v88
  v_mul_f32 v121, v121, v89
  v_mul_f32 v122, v122, v90
  v_mul_f32 v123, v123, v91
  v_mul_f32 v88, 0xbfb8aa3b, v124
  v_mul_f32 v89, 0xbfb8aa3b, v125
  v_mul_f32 v90, 0xbfb8aa3b, v126
  v_mul_f32 v91, 0xbfb8aa3b, v127
  v_exp_f32 v88, v88
  v_exp_f32 v89, v89
  v_exp_f32 v90, v90
  v_exp_f32 v91, v91
  s_nop 0
  v_add_f32 v88, 1.0, v88
  v_add_f32 v89, 1.0, v89
  v_add_f32 v90, 1.0, v90
  v_add_f32 v91, 1.0, v91
  v_rcp_f32 v88, v88
  v_rcp_f32 v89, v89
  v_rcp_f32 v90, v90
  v_rcp_f32 v91, v91
  s_nop 0
  v_mul_f32 v124, v124, v88
  v_mul_f32 v125, v125, v89
  v_mul_f32 v126, v126, v90
  v_mul_f32 v127, v127, v91
  v_mul_f32 v88, 0xbfb8aa3b, v128
  v_mul_f32 v89, 0xbfb8aa3b, v129
  v_mul_f32 v90, 0xbfb8aa3b, v130
  v_mul_f32 v91, 0xbfb8aa3b, v131
  v_exp_f32 v88, v88
  v_exp_f32 v89, v89
  v_exp_f32 v90, v90
  v_exp_f32 v91, v91
  s_nop 0
  v_add_f32 v88, 1.0, v88
  v_add_f32 v89, 1.0, v89
  v_add_f32 v90, 1.0, v90
  v_add_f32 v91, 1.0, v91
  v_rcp_f32 v88, v88
  v_rcp_f32 v89, v89
  v_rcp_f32 v90, v90
  v_rcp_f32 v91, v91
  s_nop 0
  v_mul_f32 v128, v128, v88
  v_mul_f32 v129, v129, v89
  v_mul_f32 v130, v130, v90
  v_mul_f32 v131, v131, v91
  v_mul_f32 v88, 0xbfb8aa3b, v132
  v_mul_f32 v89, 0xbfb8aa3b, v133
  v_mul_f32 v90, 0xbfb8aa3b, v134
  v_mul_f32 v91, 0xbfb8aa3b, v135
  v_exp_f32 v88, v88
  v_exp_f32 v89, v89
  v_exp_f32 v90, v90
  v_exp_f32 v91, v91
  s_nop 0
  v_add_f32 v88, 1.0, v88
  v_add_f32 v89, 1.0, v89
  v_add_f32 v90, 1.0, v90
  v_add_f32 v91, 1.0, v91
  v_rcp_f32 v88, v88
  v_rcp_f32 v89, v89
  v_rcp_f32 v90, v90
  v_rcp_f32 v91, v91
  s_nop 0
  v_mul_f32 v132, v132, v88
  v_mul_f32 v133, v133, v89
  v_mul_f32 v134, v134, v90
  v_mul_f32 v135, v135, v91
  v_cvt_pk_bf16_f32 v120, 0, v120
  v_cvt_pk_bf16_f32 v121, 0, v121
  v_cvt_pk_bf16_f32 v122, 0, v122
  v_cvt_pk_bf16_f32 v123, 0, v123
  v_cvt_pk_bf16_f32 v124, 0, v124
  v_cvt_pk_bf16_f32 v125, 0, v125
  v_cvt_pk_bf16_f32 v126, 0, v126
  v_cvt_pk_bf16_f32 v127, 0, v127
  v_cvt_pk_bf16_f32 v128, 0, v128
  v_cvt_pk_bf16_f32 v129, 0, v129
  v_cvt_pk_bf16_f32 v130, 0, v130
  v_cvt_pk_bf16_f32 v131, 0, v131
  v_cvt_pk_bf16_f32 v132, 0, v132
  v_cvt_pk_bf16_f32 v133, 0, v133
  v_cvt_pk_bf16_f32 v134, 0, v134
  v_cvt_pk_bf16_f32 v135, 0, v135
  v_cvt_pk_bf16_f32 v72, 0, v72
  v_cvt_pk_bf16_f32 v73, 0, v73
  v_cvt_pk_bf16_f32 v74, 0, v74
  v_cvt_pk_bf16_f32 v75, 0, v75
  v_cvt_pk_bf16_f32 v76, 0, v76
  v_cvt_pk_bf16_f32 v77, 0, v77
  v_cvt_pk_bf16_f32 v78, 0, v78
  v_cvt_pk_bf16_f32 v79, 0, v79
  v_cvt_pk_bf16_f32 v80, 0, v80
  v_cvt_pk_bf16_f32 v81, 0, v81
  v_cvt_pk_bf16_f32 v82, 0, v82
  v_cvt_pk_bf16_f32 v83, 0, v83
  v_cvt_pk_bf16_f32 v84, 0, v84
  v_cvt_pk_bf16_f32 v85, 0, v85
  v_cvt_pk_bf16_f32 v86, 0, v86
  v_cvt_pk_bf16_f32 v87, 0, v87
  v_mul_f32 v72, v72, v120
  v_mul_f32 v73, v73, v121
  v_mul_f32 v74, v74, v122
  v_mul_f32 v75, v75, v123
  v_mul_f32 v76, v76, v124
  v_mul_f32 v77, v77, v125
  v_mul_f32 v78, v78, v126
  v_mul_f32 v79, v79, v127
  v_mul_f32 v80, v80, v128
  v_mul_f32 v81, v81, v129
  v_mul_f32 v82, v82, v130
  v_mul_f32 v83, v83, v131
  v_mul_f32 v84, v84, v132
  v_mul_f32 v85, v85, v133
  v_mul_f32 v86, v86, v134
  v_mul_f32 v87, v87, v135
  v_cvt_pk_bf16_f32 v40, v72, v73
  v_cvt_pk_bf16_f32 v41, v74, v75
  v_cvt_pk_bf16_f32 v42, v76, v77
  v_cvt_pk_bf16_f32 v43, v78, v79
  v_cvt_pk_bf16_f32 v44, v80, v81
  v_cvt_pk_bf16_f32 v45, v82, v83
  v_cvt_pk_bf16_f32 v46, v84, v85
  v_cvt_pk_bf16_f32 v47, v86, v87
  v_add_u32 v3, 87040, v0
  ds_write_b128 v3, v[40:43] offset:0
  ds_write_b128 v3, v[44:47] offset:3072
  s_mov_b32 s44, s28
  s_mov_b32 s45, s29
  s_mov_b32 s46, 1409024
  s_mov_b32 s11, 2752
  s_mov_b32 s12, 1409024
  v_mov_b32 v4, 83968
  v_mov_b32 v5, 84992
  v_lshlrev_b32 v2, 4, v1
  v_add_u32 v2, 2048, v2
  s_call_b64 s[62:63], L_gv
  v_cvt_pk_bf16_f32 v120, 0, v72
  v_cvt_pk_bf16_f32 v121, 0, v73
  v_cvt_pk_bf16_f32 v122, 0, v74
  v_cvt_pk_bf16_f32 v123, 0, v75
  v_cvt_pk_bf16_f32 v124, 0, v76
  v_cvt_pk_bf16_f32 v125, 0, v77
  v_cvt_pk_bf16_f32 v126, 0, v78
  v_cvt_pk_bf16_f32 v127, 0, v79
  v_cvt_pk_bf16_f32 v128, 0, v80
  v_cvt_pk_bf16_f32 v129, 0, v81
  v_cvt_pk_bf16_f32 v130, 0, v82
  v_cvt_pk_bf16_f32 v131, 0, v83
  v_cvt_pk_bf16_f32 v132, 0, v84
  v_cvt_pk_bf16_f32 v133, 0, v85
  v_cvt_pk_bf16_f32 v134, 0, v86
  v_cvt_pk_bf16_f32 v135, 0, v87
  s_mov_b32 s44, s30
  s_mov_b32 s45, s31
  s_mov_b32 s46, 1409024
  s_mov_b32 s11, 2752
  s_mov_b32 s12, 1409024
  v_mov_b32 v4, 83968
  v_mov_b32 v5, 84992
  v_lshlrev_b32 v2, 4, v1
  v_add_u32 v2, 2048, v2
  s_call_b64 s[62:63], L_gv
  v_mul_f32 v88, 0xbfb8aa3b, v120
  v_mul_f32 v89, 0xbfb8aa3b, v121
  v_mul_f32 v90, 0xbfb8aa3b, v122
  v_mul_f32 v91, 0xbfb8aa3b, v123
  v_exp_f32 v88, v88
  v_exp_f32 v89, v89
  v_exp_f32 v90, v90
  v_exp_f32 v91, v91
  s_nop 0
  v_add_f32 v88, 1.0, v88
  v_add_f32 v89, 1.0, v89
  v_add_f32 v90, 1.0, v90
  v_add_f32 v91, 1.0, v91
  v_rcp_f32 v88, v88
  v_rcp_f32 v89, v89
  v_rcp_f32 v90, v90
  v_rcp_f32 v91, v91
  s_nop 0
  v_mul_f32 v120, v120, v88
  v_mul_f32 v121, v121, v89
  v_mul_f32 v122, v122, v90
  v_mul_f32 v123, v123, v91
  v_mul_f32 v88, 0xbfb8aa3b, v124
  v_mul_f32 v89, 0xbfb8aa3b, v125
  v_mul_f32 v90, 0xbfb8aa3b, v126
  v_mul_f32 v91, 0xbfb8aa3b, v127
  v_exp_f32 v88, v88
  v_exp_f32 v89, v89
  v_exp_f32 v90, v90
  v_exp_f32 v91, v91
  s_nop 0
  v_add_f32 v88, 1.0, v88
  v_add_f32 v89, 1.0, v89
  v_add_f32 v90, 1.0, v90
  v_add_f32 v91, 1.0, v91
  v_rcp_f32 v88, v88
  v_rcp_f32 v89, v89
  v_rcp_f32 v90, v90
  v_rcp_f32 v91, v91
  s_nop 0
  v_mul_f32 v124, v124, v88
  v_mul_f32 v125, v125, v89
  v_mul_f32 v126, v126, v90
  v_mul_f32 v127, v127, v91
  v_mul_f32 v88, 0xbfb8aa3b, v128
  v_mul_f32 v89, 0xbfb8aa3b, v129
  v_mul_f32 v90, 0xbfb8aa3b, v130
  v_mul_f32 v91, 0xbfb8aa3b, v131
  v_exp_f32 v88, v88
  v_exp_f32 v89, v89
  v_exp_f32 v90, v90
  v_exp_f32 v91, v91
  s_nop 0
  v_add_f32 v88, 1.0, v88
  v_add_f32 v89, 1.0, v89
  v_add_f32 v90, 1.0, v90
  v_add_f32 v91, 1.0, v91
  v_rcp_f32 v88, v88
  v_rcp_f32 v89, v89
  v_rcp_f32 v90, v90
  v_rcp_f32 v91, v91
  s_nop 0
  v_mul_f32 v128, v128, v88
  v_mul_f32 v129, v129, v89
  v_mul_f32 v130, v130, v90
  v_mul_f32 v131, v131, v91
  v_mul_f32 v88, 0xbfb8aa3b, v132
  v_mul_f32 v89, 0xbfb8aa3b, v133
  v_mul_f32 v90, 0xbfb8aa3b, v134
  v_mul_f32 v91, 0xbfb8aa3b, v135
  v_exp_f32 v88, v88
  v_exp_f32 v89, v89
  v_exp_f32 v90, v90
  v_exp_f32 v91, v91
  s_nop 0
  v_add_f32 v88, 1.0, v88
  v_add_f32 v89, 1.0, v89
  v_add_f32 v90, 1.0, v90
  v_add_f32 v91, 1.0, v91
  v_rcp_f32 v88, v88
  v_rcp_f32 v89, v89
  v_rcp_f32 v90, v90
  v_rcp_f32 v91, v91
  s_nop 0
  v_mul_f32 v132, v132, v88
  v_mul_f32 v133, v133, v89
  v_mul_f32 v134, v134, v90
  v_mul_f32 v135, v135, v91
  v_cvt_pk_bf16_f32 v120, 0, v120
  v_cvt_pk_bf16_f32 v121, 0, v121
  v_cvt_pk_bf16_f32 v122, 0, v122
  v_cvt_pk_bf16_f32 v123, 0, v123
  v_cvt_pk_bf16_f32 v124, 0, v124
  v_cvt_pk_bf16_f32 v125, 0, v125
  v_cvt_pk_bf16_f32 v126, 0, v126
  v_cvt_pk_bf16_f32 v127, 0, v127
  v_cvt_pk_bf16_f32 v128, 0, v128
  v_cvt_pk_bf16_f32 v129, 0, v129
  v_cvt_pk_bf16_f32 v130, 0, v130
  v_cvt_pk_bf16_f32 v131, 0, v131
  v_cvt_pk_bf16_f32 v132, 0, v132
  v_cvt_pk_bf16_f32 v133, 0, v133
  v_cvt_pk_bf16_f32 v134, 0, v134
  v_cvt_pk_bf16_f32 v135, 0, v135
  v_cvt_pk_bf16_f32 v72, 0, v72
  v_cvt_pk_bf16_f32 v73, 0, v73
  v_cvt_pk_bf16_f32 v74, 0, v74
  v_cvt_pk_bf16_f32 v75, 0, v75
  v_cvt_pk_bf16_f32 v76, 0, v76
  v_cvt_pk_bf16_f32 v77, 0, v77
  v_cvt_pk_bf16_f32 v78, 0, v78
  v_cvt_pk_bf16_f32 v79, 0, v79
  v_cvt_pk_bf16_f32 v80, 0, v80
  v_cvt_pk_bf16_f32 v81, 0, v81
  v_cvt_pk_bf16_f32 v82, 0, v82
  v_cvt_pk_bf16_f32 v83, 0, v83
  v_cvt_pk_bf16_f32 v84, 0, v84
  v_cvt_pk_bf16_f32 v85, 0, v85
  v_cvt_pk_bf16_f32 v86, 0, v86
  v_cvt_pk_bf16_f32 v87, 0, v87
  v_mul_f32 v72, v72, v120
  v_mul_f32 v73, v73, v121
  v_mul_f32 v74, v74, v122
  v_mul_f32 v75, v75, v123
  v_mul_f32 v76, v76, v124
  v_mul_f32 v77, v77, v125
  v_mul_f32 v78, v78, v126
  v_mul_f32 v79, v79, v127
  v_mul_f32 v80, v80, v128
  v_mul_f32 v81, v81, v129
  v_mul_f32 v82, v82, v130
  v_mul_f32 v83, v83, v131
  v_mul_f32 v84, v84, v132
  v_mul_f32 v85, v85, v133
  v_mul_f32 v86, v86, v134
  v_mul_f32 v87, v87, v135
  v_cvt_pk_bf16_f32 v40, v72, v73
  v_cvt_pk_bf16_f32 v41, v74, v75
  v_cvt_pk_bf16_f32 v42, v76, v77
  v_cvt_pk_bf16_f32 v43, v78, v79
  v_cvt_pk_bf16_f32 v44, v80, v81
  v_cvt_pk_bf16_f32 v45, v82, v83
  v_cvt_pk_bf16_f32 v46, v84, v85
  v_cvt_pk_bf16_f32 v47, v86, v87
  v_add_u32 v3, 88064, v0
  ds_write_b128 v3, v[40:43] offset:0
  ds_write_b128 v3, v[44:47] offset:3072
  s_mov_b32 s44, s32
  s_mov_b32 s45, s33
  s_mov_b32 s46, 1409024
  s_mov_b32 s11, 1024
  s_mov_b32 s12, 1409024
  v_mov_b32 v4, 86016
  v_mov_b32 v5, 89088
  v_lshlrev_b32 v2, 4, v1
  s_call_b64 s[62:63], L_gv
  v_lshrrev_b32 v2, 1, v1
  v_lshlrev_b32 v2, 7, v2
  v_and_b32 v3, 1, v1
  v_lshl_add_u32 v2, v3, 5, v2
  v_add_u32 v2, 24576, v2
  global_load_dwordx4 v[40:43], v2, s[42:43] offset:0 sc1
  global_load_dwordx4 v[44:47], v2, s[42:43] offset:16 sc1
  global_load_dwordx4 v[48:51], v2, s[42:43] offset:64 sc1
  global_load_dwordx4 v[52:55], v2, s[42:43] offset:80 sc1
  s_waitcnt vmcnt(0)
  v_lshlrev_b32 v88, 16, v40
  v_and_b32 v89, s73, v40
  v_lshlrev_b32 v90, 16, v42
  v_and_b32 v91, s73, v42
  v_lshlrev_b32 v92, 16, v44
  v_and_b32 v93, s73, v44
  v_lshlrev_b32 v94, 16, v46
  v_and_b32 v95, s73, v46
  v_lshlrev_b32 v96, 16, v48
  v_and_b32 v97, s73, v48
  v_lshlrev_b32 v98, 16, v50
  v_and_b32 v99, s73, v50
  v_lshlrev_b32 v100, 16, v52
  v_and_b32 v101, s73, v52
  v_lshlrev_b32 v102, 16, v54
  v_and_b32 v103, s73, v54
  v_cvt_pk_bf16_f32 v72, 0, v72
  v_cvt_pk_bf16_f32 v73, 0, v73
  v_cvt_pk_bf16_f32 v74, 0, v74
  v_cvt_pk_bf16_f32 v75, 0, v75
  v_cvt_pk_bf16_f32 v76, 0, v76
  v_cvt_pk_bf16_f32 v77, 0, v77
  v_cvt_pk_bf16_f32 v78, 0, v78
  v_cvt_pk_bf16_f32 v79, 0, v79
  v_cvt_pk_bf16_f32 v80, 0, v80
  v_cvt_pk_bf16_f32 v81, 0, v81
  v_cvt_pk_bf16_f32 v82, 0, v82
  v_cvt_pk_bf16_f32 v83, 0, v83
  v_cvt_pk_bf16_f32 v84, 0, v84
  v_cvt_pk_bf16_f32 v85, 0, v85
  v_cvt_pk_bf16_f32 v86, 0, v86
  v_cvt_pk_bf16_f32 v87, 0, v87
  v_mul_f32 v72, v72, v88
  v_mul_f32 v73, v73, v89
  v_mul_f32 v74, v74, v90
  v_mul_f32 v75, v75, v91
  v_mul_f32 v76, v76, v92
  v_mul_f32 v77, v77, v93
  v_mul_f32 v78, v78, v94
  v_mul_f32 v79, v79, v95
  v_mul_f32 v80, v80, v96
  v_mul_f32 v81, v81, v97
  v_mul_f32 v82, v82, v98
  v_mul_f32 v83, v83, v99
  v_mul_f32 v84, v84, v100
  v_mul_f32 v85, v85, v101
  v_mul_f32 v86, v86, v102
  v_mul_f32 v87, v87, v103
  v_cvt_pk_bf16_f32 v72, 0, v72
  v_cvt_pk_bf16_f32 v73, 0, v73
  v_cvt_pk_bf16_f32 v74, 0, v74
  v_cvt_pk_bf16_f32 v75, 0, v75
  v_cvt_pk_bf16_f32 v76, 0, v76
  v_cvt_pk_bf16_f32 v77, 0, v77
  v_cvt_pk_bf16_f32 v78, 0, v78
  v_cvt_pk_bf16_f32 v79, 0, v79
  v_cvt_pk_bf16_f32 v80, 0, v80
  v_cvt_pk_bf16_f32 v81, 0, v81
  v_cvt_pk_bf16_f32 v82, 0, v82
  v_cvt_pk_bf16_f32 v83, 0, v83
  v_cvt_pk_bf16_f32 v84, 0, v84
  v_cvt_pk_bf16_f32 v85, 0, v85
  v_cvt_pk_bf16_f32 v86, 0, v86
  v_cvt_pk_bf16_f32 v87, 0, v87
  v_add_f32 v104, v104, v72
  v_add_f32 v105, v105, v73
  v_add_f32 v106, v106, v74
  v_add_f32 v107, v107, v75
  v_add_f32 v108, v108, v76
  v_add_f32 v109, v109, v77
  v_add_f32 v110, v110, v78
  v_add_f32 v111, v111, v79
  v_add_f32 v112, v112, v80
  v_add_f32 v113, v113, v81
  v_add_f32 v114, v114, v82
  v_add_f32 v115, v115, v83
  v_add_f32 v116, v116, v84
  v_add_f32 v117, v117, v85
  v_add_f32 v118, v118, v86
  v_add_f32 v119, v119, v87
  v_cvt_pk_bf16_f32 v104, 0, v104
  v_cvt_pk_bf16_f32 v105, 0, v105
  v_cvt_pk_bf16_f32 v106, 0, v106
  v_cvt_pk_bf16_f32 v107, 0, v107
  v_cvt_pk_bf16_f32 v108, 0, v108
  v_cvt_pk_bf16_f32 v109, 0, v109
  v_cvt_pk_bf16_f32 v110, 0, v110
  v_cvt_pk_bf16_f32 v111, 0, v111
  v_cvt_pk_bf16_f32 v112, 0, v112
  v_cvt_pk_bf16_f32 v113, 0, v113
  v_cvt_pk_bf16_f32 v114, 0, v114
  v_cvt_pk_bf16_f32 v115, 0, v115
  v_cvt_pk_bf16_f32 v116, 0, v116
  v_cvt_pk_bf16_f32 v117, 0, v117
  v_cvt_pk_bf16_f32 v118, 0, v118
  v_cvt_pk_bf16_f32 v119, 0, v119
  v_cvt_pk_bf16_f32 v40, v104, v105
  v_cvt_pk_bf16_f32 v41, v106, v107
  v_cvt_pk_bf16_f32 v42, v108, v109
  v_cvt_pk_bf16_f32 v43, v110, v111
  v_cvt_pk_bf16_f32 v44, v112, v113
  v_cvt_pk_bf16_f32 v45, v114, v115
  v_cvt_pk_bf16_f32 v46, v116, v117
  v_cvt_pk_bf16_f32 v47, v118, v119
  global_store_dwordx4 v0, v[40:43], s[38:39] offset:0 sc1
  global_store_dwordx4 v0, v[44:47], s[38:39] offset:1024 sc1
  s_endpgm
L_gv:
  v_mov_b32 v72, 0
  v_mov_b32 v73, 0
  v_mov_b32 v74, 0
  v_mov_b32 v75, 0
  v_mov_b32 v76, 0
  v_mov_b32 v77, 0
  v_mov_b32 v78, 0
  v_mov_b32 v79, 0
  v_mov_b32 v80, 0
  v_mov_b32 v81, 0
  v_mov_b32 v82, 0
  v_mov_b32 v83, 0
  v_mov_b32 v84, 0
  v_mov_b32 v85, 0
  v_mov_b32 v86, 0
  v_mov_b32 v87, 0
  s_mov_b32 s10, 0
L_gvl:
  buffer_load_dwordx4 v[40:43], v2, s[44:47], s10 offen
  s_add_u32 s10, s10, s11
  buffer_load_dwordx4 v[44:47], v2, s[44:47], s10 offen
  s_add_u32 s10, s10, s11
  buffer_load_dwordx4 v[48:51], v2, s[44:47], s10 offen
  s_add_u32 s10, s10, s11
  buffer_load_dwordx4 v[52:55], v2, s[44:47], s10 offen
  s_add_u32 s10, s10, s11
  buffer_load_dwordx4 v[56:59], v2, s[44:47], s10 offen
  s_add_u32 s10, s10, s11
  buffer_load_dwordx4 v[60:63], v2, s[44:47], s10 offen
  s_add_u32 s10, s10, s11
  buffer_load_dwordx4 v[64:67], v2, s[44:47], s10 offen
  s_add_u32 s10, s10, s11
  buffer_load_dwordx4 v[68:71], v2, s[44:47], s10 offen
  s_add_u32 s10, s10, s11
  ds_read_b128 v[88:91], v4
  ds_read_b128 v[92:95], v5
  v_add_u32 v4, 16, v4
  v_add_u32 v5, 16, v5
  s_waitcnt lgkmcnt(0)
  v_and_b32 v8, 0xffff, v88
  v_lshlrev_b32 v9, 16, v88
  v_and_b32 v10, 0xffff, v92
  v_lshlrev_b32 v11, 16, v92
  s_waitcnt vmcnt(7)
  v_dot2c_f32_bf16 v72, v8, v40
  v_dot2c_f32_bf16 v73, v9, v40
  v_dot2c_f32_bf16 v74, v8, v41
  v_dot2c_f32_bf16 v75, v9, v41
  v_dot2c_f32_bf16 v76, v8, v42
  v_dot2c_f32_bf16 v77, v9, v42
  v_dot2c_f32_bf16 v78, v8, v43
  v_dot2c_f32_bf16 v79, v9, v43
  v_dot2c_f32_bf16 v80, v10, v40
  v_dot2c_f32_bf16 v81, v11, v40
  v_dot2c_f32_bf16 v82, v10, v41
  v_dot2c_f32_bf16 v83, v11, v41
  v_dot2c_f32_bf16 v84, v10, v42
  v_dot2c_f32_bf16 v85, v11, v42
  v_dot2c_f32_bf16 v86, v10, v43
  v_dot2c_f32_bf16 v87, v11, v43
  v_lshrrev_b32 v8, 16, v88
  v_and_b32 v9, s73, v88
  v_lshrrev_b32 v10, 16, v92
  v_and_b32 v11, s73, v92
  s_waitcnt vmcnt(6)
  v_dot2c_f32_bf16 v72, v8, v44
  v_dot2c_f32_bf16 v73, v9, v44
  v_dot2c_f32_bf16 v74, v8, v45
  v_dot2c_f32_bf16 v75, v9, v45
  v_dot2c_f32_bf16 v76, v8, v46
  v_dot2c_f32_bf16 v77, v9, v46
  v_dot2c_f32_bf16 v78, v8, v47
  v_dot2c_f32_bf16 v79, v9, v47
  v_dot2c_f32_bf16 v80, v10, v44
  v_dot2c_f32_bf16 v81, v11, v44
  v_dot2c_f32_bf16 v82, v10, v45
  v_dot2c_f32_bf16 v83, v11, v45
  v_dot2c_f32_bf16 v84, v10, v46
  v_dot2c_f32_bf16 v85, v11, v46
  v_dot2c_f32_bf16 v86, v10, v47
  v_dot2c_f32_bf16 v87, v11, v47
  v_and_b32 v8, 0xffff, v89
  v_lshlrev_b32 v9, 16, v89
  v_and_b32 v10, 0xffff, v93
  v_lshlrev_b32 v11, 16, v93
  s_waitcnt vmcnt(5)
  v_dot2c_f32_bf16 v72, v8, v48
  v_dot2c_f32_bf16 v73, v9, v48
  v_dot2c_f32_bf16 v74, v8, v49
  v_dot2c_f32_bf16 v75, v9, v49
  v_dot2c_f32_bf16 v76, v8, v50
  v_dot2c_f32_bf16 v77, v9, v50
  v_dot2c_f32_bf16 v78, v8, v51
  v_dot2c_f32_bf16 v79, v9, v51
  v_dot2c_f32_bf16 v80, v10, v48
  v_dot2c_f32_bf16 v81, v11, v48
  v_dot2c_f32_bf16 v82, v10, v49
  v_dot2c_f32_bf16 v83, v11, v49
  v_dot2c_f32_bf16 v84, v10, v50
  v_dot2c_f32_bf16 v85, v11, v50
  v_dot2c_f32_bf16 v86, v10, v51
  v_dot2c_f32_bf16 v87, v11, v51
  v_lshrrev_b32 v8, 16, v89
  v_and_b32 v9, s73, v89
  v_lshrrev_b32 v10, 16, v93
  v_and_b32 v11, s73, v93
  s_waitcnt vmcnt(4)
  v_dot2c_f32_bf16 v72, v8, v52
  v_dot2c_f32_bf16 v73, v9, v52
  v_dot2c_f32_bf16 v74, v8, v53
  v_dot2c_f32_bf16 v75, v9, v53
  v_dot2c_f32_bf16 v76, v8, v54
  v_dot2c_f32_bf16 v77, v9, v54
  v_dot2c_f32_bf16 v78, v8, v55
  v_dot2c_f32_bf16 v79, v9, v55
  v_dot2c_f32_bf16 v80, v10, v52
  v_dot2c_f32_bf16 v81, v11, v52
  v_dot2c_f32_bf16 v82, v10, v53
  v_dot2c_f32_bf16 v83, v11, v53
  v_dot2c_f32_bf16 v84, v10, v54
  v_dot2c_f32_bf16 v85, v11, v54
  v_dot2c_f32_bf16 v86, v10, v55
  v_dot2c_f32_bf16 v87, v11, v55
  v_and_b32 v8, 0xffff, v90
  v_lshlrev_b32 v9, 16, v90
  v_and_b32 v10, 0xffff, v94
  v_lshlrev_b32 v11, 16, v94
  s_waitcnt vmcnt(3)
  v_dot2c_f32_bf16 v72, v8, v56
  v_dot2c_f32_bf16 v73, v9, v56
  v_dot2c_f32_bf16 v74, v8, v57
  v_dot2c_f32_bf16 v75, v9, v57
  v_dot2c_f32_bf16 v76, v8, v58
  v_dot2c_f32_bf16 v77, v9, v58
  v_dot2c_f32_bf16 v78, v8, v59
  v_dot2c_f32_bf16 v79, v9, v59
  v_dot2c_f32_bf16 v80, v10, v56
  v_dot2c_f32_bf16 v81, v11, v56
  v_dot2c_f32_bf16 v82, v10, v57
  v_dot2c_f32_bf16 v83, v11, v57
  v_dot2c_f32_bf16 v84, v10, v58
  v_dot2c_f32_bf16 v85, v11, v58
  v_dot2c_f32_bf16 v86, v10, v59
  v_dot2c_f32_bf16 v87, v11, v59
  v_lshrrev_b32 v8, 16, v90
  v_and_b32 v9, s73, v90
  v_lshrrev_b32 v10, 16, v94
  v_and_b32 v11, s73, v94
  s_waitcnt vmcnt(2)
  v_dot2c_f32_bf16 v72, v8, v60
  v_dot2c_f32_bf16 v73, v9, v60
  v_dot2c_f32_bf16 v74, v8, v61
  v_dot2c_f32_bf16 v75, v9, v61
  v_dot2c_f32_bf16 v76, v8, v62
  v_dot2c_f32_bf16 v77, v9, v62
  v_dot2c_f32_bf16 v78, v8, v63
  v_dot2c_f32_bf16 v79, v9, v63
  v_dot2c_f32_bf16 v80, v10, v60
  v_dot2c_f32_bf16 v81, v11, v60
  v_dot2c_f32_bf16 v82, v10, v61
  v_dot2c_f32_bf16 v83, v11, v61
  v_dot2c_f32_bf16 v84, v10, v62
  v_dot2c_f32_bf16 v85, v11, v62
  v_dot2c_f32_bf16 v86, v10, v63
  v_dot2c_f32_bf16 v87, v11, v63
  v_and_b32 v8, 0xffff, v91
  v_lshlrev_b32 v9, 16, v91
  v_and_b32 v10, 0xffff, v95
  v_lshlrev_b32 v11, 16, v95
  s_waitcnt vmcnt(1)
  v_dot2c_f32_bf16 v72, v8, v64
  v_dot2c_f32_bf16 v73, v9, v64
  v_dot2c_f32_bf16 v74, v8, v65
  v_dot2c_f32_bf16 v75, v9, v65
  v_dot2c_f32_bf16 v76, v8, v66
  v_dot2c_f32_bf16 v77, v9, v66
  v_dot2c_f32_bf16 v78, v8, v67
  v_dot2c_f32_bf16 v79, v9, v67
  v_dot2c_f32_bf16 v80, v10, v64
  v_dot2c_f32_bf16 v81, v11, v64
  v_dot2c_f32_bf16 v82, v10, v65
  v_dot2c_f32_bf16 v83, v11, v65
  v_dot2c_f32_bf16 v84, v10, v66
  v_dot2c_f32_bf16 v85, v11, v66
  v_dot2c_f32_bf16 v86, v10, v67
  v_dot2c_f32_bf16 v87, v11, v67
  v_lshrrev_b32 v8, 16, v91
  v_and_b32 v9, s73, v91
  v_lshrrev_b32 v10, 16, v95
  v_and_b32 v11, s73, v95
  s_waitcnt vmcnt(0)
  v_dot2c_f32_bf16 v72, v8, v68
  v_dot2c_f32_bf16 v73, v9, v68
  v_dot2c_f32_bf16 v74, v8, v69
  v_dot2c_f32_bf16 v75, v9, v69
  v_dot2c_f32_bf16 v76, v8, v70
  v_dot2c_f32_bf16 v77, v9, v70
  v_dot2c_f32_bf16 v78, v8, v71
  v_dot2c_f32_bf16 v79, v9, v71
  v_dot2c_f32_bf16 v80, v10, v68
  v_dot2c_f32_bf16 v81, v11, v68
  v_dot2c_f32_bf16 v82, v10, v69
  v_dot2c_f32_bf16 v83, v11, v69
  v_dot2c_f32_bf16 v84, v10, v70
  v_dot2c_f32_bf16 v85, v11, v70
  v_dot2c_f32_bf16 v86, v10, v71
  v_dot2c_f32_bf16 v87, v11, v71
  s_cmp_lt_u32 s10, s12
  s_cbranch_scc1 L_gvl
  s_nop 1
  s_setpc_b64 s[62:63]
L_ks:
  s_waitcnt lgkmcnt(0)
  v_readfirstlane_b32 s78, v20
  v_readfirstlane_b32 s79, v21
  s_cmp_eq_u32 s32, s57
  s_cselect_b32 s34, s58, s34
  s_cmp_ge_u32 s39, 4
  s_cbranch_scc1 L_ks2
  s_call_b64 s[100:101], L_work
L_ks2:
  s_add_u32 s32, s32, 1
  s_mul_i32 s68, s35, s76
  s_sub_i32 s68, s68, s78
  s_sub_u32 s35, s35, 1
  s_add_i32 s68, s68, 1024
  s_mul_i32 s68, s68, 14
  s_add_i32 s68, s68, s34
  s_add_i32 s68, s68, s79
  s_max_i32 s68, s68, 384
  s_min_i32 s68, s68, 1280
  s_lshl_b32 s69, s68, 24
  s_lshr_b32 s68, s68, 8
  s_add_u32 s33, s33, s69
  s_addc_u32 s41, s68, 0
L_wait:
  s_waitcnt vmcnt(4)
  s_cmp_ge_u32 s41, 5
  s_cbranch_scc1 L_ret
  s_waitcnt vmcnt(3)
  s_cmp_ge_u32 s41, 4
  s_cbranch_scc1 L_ret
  s_waitcnt vmcnt(2)
  s_cmp_ge_u32 s41, 3
  s_cbranch_scc1 L_ret
  s_waitcnt vmcnt(1)
  s_cmp_ge_u32 s41, 2
  s_cbranch_scc1 L_ret
  s_waitcnt vmcnt(0)
L_ret:
  s_mov_b64 exec, 1
  ds_dec_u32 v23, v39 offset:6688
  ds_read_b64 v[20:21], v23 offset:6688
  s_mov_b64 exec, -1
  s_cmp_lg_u32 s32, s32
  s_setpc_b64 s[62:63]
L_vs:
  s_waitcnt lgkmcnt(0)
  v_readfirstlane_b32 s78, v20
  v_readfirstlane_b32 s79, v21
  s_cmp_eq_u32 s61, 2
  s_cbranch_scc1 L_vs1
  s_cmp_eq_u32 s61, 1
  s_cbranch_scc1 L_x3
  s_cmp_gt_u32 s41, s32
  s_cbranch_scc1 L_ks2
L_x1:
  v_dot2_f32_bf16 v8, v136, v4, 0
  v_dot2_f32_bf16 v9, v140, v4, 0
  v_dot2_f32_bf16 v10, v144, v4, 0
  v_dot2_f32_bf16 v11, v148, v4, 0
  v_dot2_f32_bf16 v12, v152, v4, 0
  v_dot2_f32_bf16 v13, v156, v4, 0
  v_dot2_f32_bf16 v14, v160, v4, 0
  v_dot2_f32_bf16 v15, v164, v4, 0
  v_dot2_f32_bf16 v8, v137, v5, v8
  v_dot2_f32_bf16 v9, v141, v5, v9
  v_dot2_f32_bf16 v10, v145, v5, v10
  v_dot2_f32_bf16 v11, v149, v5, v11
  v_dot2_f32_bf16 v12, v153, v5, v12
  v_dot2_f32_bf16 v13, v157, v5, v13
  v_dot2_f32_bf16 v14, v161, v5, v14
  v_dot2_f32_bf16 v15, v165, v5, v15
  v_dot2_f32_bf16 v8, v138, v6, v8
  v_dot2_f32_bf16 v9, v142, v6, v9
  v_dot2_f32_bf16 v10, v146, v6, v10
  v_dot2_f32_bf16 v11, v150, v6, v11
  v_dot2_f32_bf16 v12, v154, v6, v12
  v_dot2_f32_bf16 v13, v158, v6, v13
  v_dot2_f32_bf16 v14, v162, v6, v14
  v_dot2_f32_bf16 v15, v166, v6, v15
  v_dot2_f32_bf16 v8, v139, v7, v8
  v_dot2_f32_bf16 v9, v143, v7, v9
  v_dot2_f32_bf16 v10, v147, v7, v10
  v_dot2_f32_bf16 v11, v151, v7, v11
  v_dot2_f32_bf16 v12, v155, v7, v12
  v_dot2_f32_bf16 v13, v159, v7, v13
  v_dot2_f32_bf16 v14, v163, v7, v14
  v_dot2_f32_bf16 v15, v167, v7, v15
  v_add_f32_dpp v8, v8, v8 row_ror:8 row_mask:0xf bank_mask:0x3
  v_add_f32_dpp v8, v9, v9 row_ror:8 row_mask:0xf bank_mask:0xc
  v_add_f32_dpp v10, v10, v10 row_ror:8 row_mask:0xf bank_mask:0x3
  v_add_f32_dpp v10, v11, v11 row_ror:8 row_mask:0xf bank_mask:0xc
  v_add_f32_dpp v12, v12, v12 row_ror:8 row_mask:0xf bank_mask:0x3
  v_add_f32_dpp v12, v13, v13 row_ror:8 row_mask:0xf bank_mask:0xc
  v_add_f32_dpp v14, v14, v14 row_ror:8 row_mask:0xf bank_mask:0x3
  v_add_f32_dpp v14, v15, v15 row_ror:8 row_mask:0xf bank_mask:0xc
  v_add_f32_dpp v18, v8, v8 row_shl:4 row_mask:0xf bank_mask:0x5
  v_add_f32_dpp v18, v10, v10 row_shr:4 row_mask:0xf bank_mask:0xa
  v_add_f32_dpp v19, v12, v12 row_shl:4 row_mask:0xf bank_mask:0x5
  v_add_f32_dpp v19, v14, v14 row_shr:4 row_mask:0xf bank_mask:0xa
  s_lshl_b32 s68, s20, 3
  s_add_u32 s68, s68, s56
  v_add_f32_dpp v16, v16, v16 quad_perm:[2,3,0,1] row_mask:0xf bank_mask:0xf
  v_add_f32_dpp v17, v17, v17 quad_perm:[2,3,0,1] row_mask:0xf bank_mask:0xf
  v_add_f32_dpp v18, v18, v18 quad_perm:[2,3,0,1] row_mask:0xf bank_mask:0xf
  v_add_f32_dpp v19, v19, v19 quad_perm:[2,3,0,1] row_mask:0xf bank_mask:0xf
  v_cndmask_b32 v8, v16, v17, s[52:53]
  v_cndmask_b32 v9, v18, v19, s[52:53]
  v_mov_b32 v20, 64
  v_lshlrev_b32 v21, 3, s9
  v_add_f32_dpp v8, v8, v8 quad_perm:[1,0,3,2] row_mask:0xf bank_mask:0xf
  v_add_f32_dpp v9, v9, v9 quad_perm:[1,0,3,2] row_mask:0xf bank_mask:0xf
  v_cndmask_b32 v27, v8, v9, s[54:55]
  v_cvt_pk_bf16_f32 v27, 0, v27
  v_mul_f32 v27, 0x3db504f3, v27
  v_cvt_pk_bf16_f32 v27, 0, v27
  v_max_f32 v37, v37, v27
  v_cmp_ngt_f32 vcc, s22, v27
  v_mov_b32 v4, 0
  v_max_f32_dpp v37, v37, v37 row_ror:8 row_mask:0xf bank_mask:0xf
  s_bcnt1_i32_b64 s69, vcc
  s_add_u32 s69, s69, s20
  v_max_f32_dpp v37, v37, v37 row_ror:4 row_mask:0xf bank_mask:0xf
  s_cmp_gt_u32 s69, 32
  s_cselect_b32 s21, 1, s21
  v_max_f32_dpp v37, v37, v37 row_ror:2 row_mask:0xf bank_mask:0xf
  s_cmp_eq_u32 s21, 0
  s_cselect_b64 s[66:67], vcc, 0
  s_cselect_b32 s20, s69, s20
  v_max_f32_dpp v37, v37, v37 row_ror:1 row_mask:0xf bank_mask:0xf
  v_mbcnt_lo_u32_b32 v3, s66, 0
  v_mov_b32 v8, v37
  v_mbcnt_hi_u32_b32 v3, s67, v3
  v_lshl_add_u32 v3, v3, 3, s68
  v_permlane16_swap_b32 v8, v37
  s_mov_b64 exec, s[66:67]
  ds_write_b64 v3, v[26:27] offset:1280
  s_mov_b64 exec, -1
  ds_read_b32 v32, v39 offset:1024
  v_max_f32 v37, v37, v8
  v_mov_b32 v8, v37
  v_mov_b32 v5, 0
  s_mov_b32 s18, s32
  v_permlane32_swap_b32 v8, v37
  v_max_f32 v37, v37, v8
  v_sub_f32 v17, v25, v37
  v_sub_f32 v18, v27, v37
  v_mul_f32 v17, 0x3fb8aa3b, v17
  v_mul_f32 v18, 0x3fb8aa3b, v18
  v_exp_f32 v17, v17
  v_exp_f32 v18, v18
  v_mov_b32 v16, v37
  v_add_f32 v17, v17, v18
  s_waitcnt lgkmcnt(0)
  s_cmp_le_u32 s20, 0
  s_cbranch_scc1 L_x2
  v_add_u32_dpp v3, v32, v38 row_newbcast:8 row_mask:0xf bank_mask:0xf
  buffer_load_dwordx4 v[136:139], v3, s[48:51], 0 offen nt
  s_cmp_le_u32 s20, 4
  s_cbranch_scc1 L_x2
  v_add_u32_dpp v3, v32, v38 row_newbcast:9 row_mask:0xf bank_mask:0xf
  buffer_load_dwordx4 v[140:143], v3, s[48:51], 0 offen nt
  s_cmp_le_u32 s20, 8
  s_cbranch_scc1 L_x2
  v_add_u32_dpp v3, v32, v38 row_newbcast:10 row_mask:0xf bank_mask:0xf
  buffer_load_dwordx4 v[144:147], v3, s[48:51], 0 offen nt
  s_cmp_le_u32 s20, 12
  s_cbranch_scc1 L_x2
  v_add_u32_dpp v3, v32, v38 row_newbcast:11 row_mask:0xf bank_mask:0xf
  buffer_load_dwordx4 v[148:151], v3, s[48:51], 0 offen nt
  s_cmp_le_u32 s20, 16
  s_cbranch_scc1 L_x2
  v_add_u32_dpp v3, v32, v38 row_newbcast:12 row_mask:0xf bank_mask:0xf
  buffer_load_dwordx4 v[152:155], v3, s[48:51], 0 offen nt
  s_cmp_le_u32 s20, 20
  s_cbranch_scc1 L_x2
  v_add_u32_dpp v3, v32, v38 row_newbcast:13 row_mask:0xf bank_mask:0xf
  buffer_load_dwordx4 v[156:159], v3, s[48:51], 0 offen nt
  s_cmp_le_u32 s20, 24
  s_cbranch_scc1 L_x2
  v_add_u32_dpp v3, v32, v38 row_newbcast:14 row_mask:0xf bank_mask:0xf
  buffer_load_dwordx4 v[160:163], v3, s[48:51], 0 offen nt
  s_cmp_le_u32 s20, 28
  s_cbranch_scc1 L_x2
  v_add_u32_dpp v3, v32, v38 row_newbcast:15 row_mask:0xf bank_mask:0xf
  buffer_load_dwordx4 v[164:167], v3, s[48:51], 0 offen nt
L_x2:
  s_nop 1
  v_add_f32_dpp v17, v17, v17 row_ror:8 row_mask:0xf bank_mask:0xf
  s_nop 1
  v_add_f32_dpp v17, v17, v17 row_ror:4 row_mask:0xf bank_mask:0xf
  s_nop 1
  v_add_f32_dpp v17, v17, v17 row_ror:2 row_mask:0xf bank_mask:0xf
  s_nop 1
  v_add_f32_dpp v17, v17, v17 row_ror:1 row_mask:0xf bank_mask:0xf
  v_mov_b32 v8, v17
  s_nop 1
  v_permlane16_swap_b32 v8, v17
  v_add_f32 v17, v17, v8
  v_mov_b32 v8, v17
  s_nop 1
  v_permlane32_swap_b32 v8, v17
  v_add_f32 v17, v17, v8
  s_mov_b64 exec, 1
  ds_max_f32 v1, v37 offset:6676
  ds_write_b64 v21, v[16:17] offset:6912
  ds_add_u32 v1, v20 offset:6672
  s_mov_b64 exec, -1
  s_mov_b32 s61, 1
  s_mov_b32 s19, 1
  s_cmp_lt_u32 s32, 5
  s_cbranch_scc1 L_ks2
L_x3:
  v_max_f32 v21, v2, v37
  s_add_u32 s38, s38, 3
  s_lshr_b32 s38, s38, 2
  v_add_f32 v21, 0xc2ac0000, v21
  s_max_u32 s38, s38, s32
  s_lshl_b32 s38, s38, 2
  v_cmp_nlt_f32 vcc, v27, v21
  s_lshl_b32 s68, s38, 3
  s_add_u32 s68, s68, s56
  s_andn2_b64 s[70:71], vcc, s[66:67]
  v_mbcnt_lo_u32_b32 v3, s70, 0
  v_mbcnt_hi_u32_b32 v3, s71, v3
  s_bcnt1_i32_b64 s69, s[70:71]
  v_lshl_add_u32 v3, v3, 3, s68
  s_mov_b64 exec, s[70:71]
  ds_write_b64 v3, v[26:27]
  s_mov_b64 exec, -1
  s_or_b64 s[66:67], s[66:67], s[70:71]
  s_add_u32 s38, s38, s69
  ds_read_b64 v[28:29], v39 offset:0
  ds_read_b64 v[30:31], v39 offset:512
  ds_read_b64 v[32:33], v39 offset:1024
  v_mov_b32 v8, 0
  v_mov_b32 v9, 0
  v_mov_b32 v10, 0
  v_mov_b32 v11, 0
  v_mov_b32 v12, 0
  v_mov_b32 v13, 0
  v_mov_b32 v14, 0
  v_mov_b32 v15, 0
  s_lshr_b32 s36, s38, 2
  s_mov_b32 s61, 2
  s_add_u32 s68, s38, 8
  s_lshr_b32 s68, s68, 2
  s_sub_u32 s69, s68, s59
  s_mov_b32 s59, s68
  s_add_u32 s35, s35, s69
  s_add_u32 s78, s78, s69
  v_mov_b32 v3, s69
  s_mov_b64 exec, 1
  ds_add_u32 v1, v3 offset:6696
  s_mov_b64 exec, -1
  s_waitcnt lgkmcnt(0)
  v_sub_f32 v29, v29, v37
  v_sub_f32 v31, v31, v37
  v_sub_f32 v33, v33, v37
  v_mul_f32 v29, 0x3fb8aa3b, v29
  v_mul_f32 v31, 0x3fb8aa3b, v31
  v_mul_f32 v33, 0x3fb8aa3b, v33
  v_exp_f32 v29, v29
  v_exp_f32 v31, v31
  v_exp_f32 v33, v33
  s_nop 0
  v_cvt_pk_bf16_f32 v34, 0, v29
  v_cvt_pk_bf16_f32 v35, 0, v31
  v_cvt_pk_bf16_f32 v36, 0, v33
  v_cvt_pk_bf16_f32 v29, v29, 0
  v_cvt_pk_bf16_f32 v31, v31, 0
  v_cvt_pk_bf16_f32 v33, v33, 0
  s_cmp_eq_u32 s20, 0
  s_cselect_b32 s41, 0, s41
L_vs1:
  s_cmp_eq_u32 s19, 0
  s_cbranch_scc1 L_vs1b
  s_sub_u32 s68, s32, s18
  s_cmp_le_u32 s41, s68
  s_cbranch_scc1 L_snap
  s_cmp_lg_u32 s36, s32
  s_cbranch_scc1 L_vs2
  s_waitcnt vmcnt(0)
L_snap:
  v_mov_b32 v6, 0
  v_mov_b32 v7, 0
  v_mov_b32 v16, 0
  v_mov_b32 v17, 0
  v_mov_b32 v18, 0
  v_mov_b32 v19, 0
  s_cmp_le_u32 s20, 0
  s_cbranch_scc1 L_snp2
  v_dot2c_f32_bf16_dpp v4, v33, v136 row_newbcast:8 row_mask:0xf bank_mask:0xf
  v_dot2c_f32_bf16_dpp v5, v36, v136 row_newbcast:8 row_mask:0xf bank_mask:0xf
  v_dot2c_f32_bf16_dpp v6, v33, v137 row_newbcast:8 row_mask:0xf bank_mask:0xf
  v_dot2c_f32_bf16_dpp v7, v36, v137 row_newbcast:8 row_mask:0xf bank_mask:0xf
  v_dot2c_f32_bf16_dpp v16, v33, v138 row_newbcast:8 row_mask:0xf bank_mask:0xf
  v_dot2c_f32_bf16_dpp v17, v36, v138 row_newbcast:8 row_mask:0xf bank_mask:0xf
  v_dot2c_f32_bf16_dpp v18, v33, v139 row_newbcast:8 row_mask:0xf bank_mask:0xf
  v_dot2c_f32_bf16_dpp v19, v36, v139 row_newbcast:8 row_mask:0xf bank_mask:0xf
  s_cmp_le_u32 s20, 4
  s_cbranch_scc1 L_snp2
  v_dot2c_f32_bf16_dpp v4, v33, v140 row_newbcast:9 row_mask:0xf bank_mask:0xf
  v_dot2c_f32_bf16_dpp v5, v36, v140 row_newbcast:9 row_mask:0xf bank_mask:0xf
  v_dot2c_f32_bf16_dpp v6, v33, v141 row_newbcast:9 row_mask:0xf bank_mask:0xf
  v_dot2c_f32_bf16_dpp v7, v36, v141 row_newbcast:9 row_mask:0xf bank_mask:0xf
  v_dot2c_f32_bf16_dpp v16, v33, v142 row_newbcast:9 row_mask:0xf bank_mask:0xf
  v_dot2c_f32_bf16_dpp v17, v36, v142 row_newbcast:9 row_mask:0xf bank_mask:0xf
  v_dot2c_f32_bf16_dpp v18, v33, v143 row_newbcast:9 row_mask:0xf bank_mask:0xf
  v_dot2c_f32_bf16_dpp v19, v36, v143 row_newbcast:9 row_mask:0xf bank_mask:0xf
  s_cmp_le_u32 s20, 8
  s_cbranch_scc1 L_snp2
  v_dot2c_f32_bf16_dpp v4, v33, v144 row_newbcast:10 row_mask:0xf bank_mask:0xf
  v_dot2c_f32_bf16_dpp v5, v36, v144 row_newbcast:10 row_mask:0xf bank_mask:0xf
  v_dot2c_f32_bf16_dpp v6, v33, v145 row_newbcast:10 row_mask:0xf bank_mask:0xf
  v_dot2c_f32_bf16_dpp v7, v36, v145 row_newbcast:10 row_mask:0xf bank_mask:0xf
  v_dot2c_f32_bf16_dpp v16, v33, v146 row_newbcast:10 row_mask:0xf bank_mask:0xf
  v_dot2c_f32_bf16_dpp v17, v36, v146 row_newbcast:10 row_mask:0xf bank_mask:0xf
  v_dot2c_f32_bf16_dpp v18, v33, v147 row_newbcast:10 row_mask:0xf bank_mask:0xf
  v_dot2c_f32_bf16_dpp v19, v36, v147 row_newbcast:10 row_mask:0xf bank_mask:0xf
  s_cmp_le_u32 s20, 12
  s_cbranch_scc1 L_snp2
  v_dot2c_f32_bf16_dpp v4, v33, v148 row_newbcast:11 row_mask:0xf bank_mask:0xf
  v_dot2c_f32_bf16_dpp v5, v36, v148 row_newbcast:11 row_mask:0xf bank_mask:0xf
  v_dot2c_f32_bf16_dpp v6, v33, v149 row_newbcast:11 row_mask:0xf bank_mask:0xf
  v_dot2c_f32_bf16_dpp v7, v36, v149 row_newbcast:11 row_mask:0xf bank_mask:0xf
  v_dot2c_f32_bf16_dpp v16, v33, v150 row_newbcast:11 row_mask:0xf bank_mask:0xf
  v_dot2c_f32_bf16_dpp v17, v36, v150 row_newbcast:11 row_mask:0xf bank_mask:0xf
  v_dot2c_f32_bf16_dpp v18, v33, v151 row_newbcast:11 row_mask:0xf bank_mask:0xf
  v_dot2c_f32_bf16_dpp v19, v36, v151 row_newbcast:11 row_mask:0xf bank_mask:0xf
  s_cmp_le_u32 s20, 16
  s_cbranch_scc1 L_snp2
  v_dot2c_f32_bf16_dpp v4, v33, v152 row_newbcast:12 row_mask:0xf bank_mask:0xf
  v_dot2c_f32_bf16_dpp v5, v36, v152 row_newbcast:12 row_mask:0xf bank_mask:0xf
  v_dot2c_f32_bf16_dpp v6, v33, v153 row_newbcast:12 row_mask:0xf bank_mask:0xf
  v_dot2c_f32_bf16_dpp v7, v36, v153 row_newbcast:12 row_mask:0xf bank_mask:0xf
  v_dot2c_f32_bf16_dpp v16, v33, v154 row_newbcast:12 row_mask:0xf bank_mask:0xf
  v_dot2c_f32_bf16_dpp v17, v36, v154 row_newbcast:12 row_mask:0xf bank_mask:0xf
  v_dot2c_f32_bf16_dpp v18, v33, v155 row_newbcast:12 row_mask:0xf bank_mask:0xf
  v_dot2c_f32_bf16_dpp v19, v36, v155 row_newbcast:12 row_mask:0xf bank_mask:0xf
  s_cmp_le_u32 s20, 20
  s_cbranch_scc1 L_snp2
  v_dot2c_f32_bf16_dpp v4, v33, v156 row_newbcast:13 row_mask:0xf bank_mask:0xf
  v_dot2c_f32_bf16_dpp v5, v36, v156 row_newbcast:13 row_mask:0xf bank_mask:0xf
  v_dot2c_f32_bf16_dpp v6, v33, v157 row_newbcast:13 row_mask:0xf bank_mask:0xf
  v_dot2c_f32_bf16_dpp v7, v36, v157 row_newbcast:13 row_mask:0xf bank_mask:0xf
  v_dot2c_f32_bf16_dpp v16, v33, v158 row_newbcast:13 row_mask:0xf bank_mask:0xf
  v_dot2c_f32_bf16_dpp v17, v36, v158 row_newbcast:13 row_mask:0xf bank_mask:0xf
  v_dot2c_f32_bf16_dpp v18, v33, v159 row_newbcast:13 row_mask:0xf bank_mask:0xf
  v_dot2c_f32_bf16_dpp v19, v36, v159 row_newbcast:13 row_mask:0xf bank_mask:0xf
  s_cmp_le_u32 s20, 24
  s_cbranch_scc1 L_snp2
  v_dot2c_f32_bf16_dpp v4, v33, v160 row_newbcast:14 row_mask:0xf bank_mask:0xf
  v_dot2c_f32_bf16_dpp v5, v36, v160 row_newbcast:14 row_mask:0xf bank_mask:0xf
  v_dot2c_f32_bf16_dpp v6, v33, v161 row_newbcast:14 row_mask:0xf bank_mask:0xf
  v_dot2c_f32_bf16_dpp v7, v36, v161 row_newbcast:14 row_mask:0xf bank_mask:0xf
  v_dot2c_f32_bf16_dpp v16, v33, v162 row_newbcast:14 row_mask:0xf bank_mask:0xf
  v_dot2c_f32_bf16_dpp v17, v36, v162 row_newbcast:14 row_mask:0xf bank_mask:0xf
  v_dot2c_f32_bf16_dpp v18, v33, v163 row_newbcast:14 row_mask:0xf bank_mask:0xf
  v_dot2c_f32_bf16_dpp v19, v36, v163 row_newbcast:14 row_mask:0xf bank_mask:0xf
  s_cmp_le_u32 s20, 28
  s_cbranch_scc1 L_snp2
  v_dot2c_f32_bf16_dpp v4, v33, v164 row_newbcast:15 row_mask:0xf bank_mask:0xf
  v_dot2c_f32_bf16_dpp v5, v36, v164 row_newbcast:15 row_mask:0xf bank_mask:0xf
  v_dot2c_f32_bf16_dpp v6, v33, v165 row_newbcast:15 row_mask:0xf bank_mask:0xf
  v_dot2c_f32_bf16_dpp v7, v36, v165 row_newbcast:15 row_mask:0xf bank_mask:0xf
  v_dot2c_f32_bf16_dpp v16, v33, v166 row_newbcast:15 row_mask:0xf bank_mask:0xf
  v_dot2c_f32_bf16_dpp v17, v36, v166 row_newbcast:15 row_mask:0xf bank_mask:0xf
  v_dot2c_f32_bf16_dpp v18, v33, v167 row_newbcast:15 row_mask:0xf bank_mask:0xf
  v_dot2c_f32_bf16_dpp v19, v36, v167 row_newbcast:15 row_mask:0xf bank_mask:0xf
L_snp2:
  s_nop 1
  s_nop 0
  v_permlane32_swap_b32 v4, v16
  v_permlane32_swap_b32 v5, v17
  v_permlane32_swap_b32 v6, v18
  v_permlane32_swap_b32 v7, v19
  v_add_f32 v4, v4, v16
  v_add_f32 v5, v5, v17
  v_add_f32 v6, v6, v18
  v_add_f32 v7, v7, v19
  v_mov_b32 v3, 1
  v_permlane16_swap_b32 v4, v6
  v_permlane16_swap_b32 v5, v7
  v_add_f32 v4, v4, v6
  v_add_f32 v5, v5, v7
  s_mov_b32 s19, 0
  s_cmp_lg_u32 s21, 0
  s_cbranch_scc1 L_vs1b
  ds_write_b64 v22, v[4:5] offset:13056
  s_mov_b64 exec, 1
  ds_add_u32 v1, v3 offset:6704
  s_mov_b64 exec, -1
L_vs1b:
  s_cmp_eq_u32 s36, s32
  s_cbranch_scc1 L_hand
L_vs2:
  s_cmp_lt_u32 s32, s37
  s_cbranch_scc1 L_ks2
  s_sub_u32 s41, s36, s32
  s_add_u32 s32, s32, 1
  s_cmp_gt_u32 s41, 5
  s_cbranch_scc1 L_wait
  s_waitcnt vmcnt(4)
  s_cmp_ge_u32 s41, 5
  s_cbranch_scc1 L_ret2
  s_waitcnt vmcnt(3)
  s_cmp_ge_u32 s41, 4
  s_cbranch_scc1 L_ret2
  s_waitcnt vmcnt(2)
  s_cmp_ge_u32 s41, 3
  s_cbranch_scc1 L_ret2
  s_waitcnt vmcnt(1)
  s_cmp_ge_u32 s41, 2
  s_cbranch_scc1 L_ret2
  s_waitcnt vmcnt(0)
L_ret2:
  s_cmp_eq_u32 s32, s32
  s_setpc_b64 s[62:63]
L_hand:
  v_mov_b32 v3, 0
  s_mov_b32 s70, 0
L_sn_4:
  ds_read_b64 v[18:19], v3 offset:6672
  s_waitcnt lgkmcnt(0)
  v_cmp_gt_u32 vcc, 0x10280, v18
  s_cmp_eq_u64 vcc, 0
  s_cbranch_scc1 L_snd_5
  s_sleep 1
  s_add_u32 s70, s70, 1
  s_cmp_lt_u32 s70, 2097152
  s_cbranch_scc1 L_sn_4
L_snd_5:
  v_add_f32 v21, 0xc2ba0000, v19
  v_cmp_nlt_f32 vcc, v25, v21
  s_lshl_b32 s68, s38, 3
  s_add_u32 s68, s68, s56
  s_andn2_b64 s[70:71], vcc, s[64:65]
  v_mbcnt_lo_u32_b32 v3, s70, 0
  v_mbcnt_hi_u32_b32 v3, s71, v3
  s_bcnt1_i32_b64 s69, s[70:71]
  v_lshl_add_u32 v3, v3, 3, s68
  s_mov_b64 exec, s[70:71]
  ds_write_b64 v3, v[24:25]
  s_mov_b64 exec, -1
  s_or_b64 s[64:65], s[64:65], s[70:71]
  s_add_u32 s38, s38, s69
  v_cmp_nlt_f32 vcc, v27, v21
  s_lshl_b32 s68, s38, 3
  s_add_u32 s68, s68, s56
  s_andn2_b64 s[70:71], vcc, s[66:67]
  v_mbcnt_lo_u32_b32 v3, s70, 0
  v_mbcnt_hi_u32_b32 v3, s71, v3
  s_bcnt1_i32_b64 s69, s[70:71]
  v_lshl_add_u32 v3, v3, 3, s68
  s_mov_b64 exec, s[70:71]
  ds_write_b64 v3, v[26:27]
  s_mov_b64 exec, -1
  s_or_b64 s[66:67], s[66:67], s[70:71]
  s_add_u32 s38, s38, s69
  ds_read_b64 v[28:29], v39 offset:0
  ds_read_b64 v[30:31], v39 offset:512
  ds_read_b64 v[32:33], v39 offset:1024
  s_add_u32 s36, s38, 23
  s_lshr_b32 s36, s36, 2
  s_sub_u32 s37, s36, 9
  s_max_i32 s37, s37, 0
  s_mov_b32 s75, s36
  s_add_u32 s68, s38, 3
  s_lshr_b32 s68, s68, 2
  s_sub_u32 s69, s68, s59
  s_mov_b32 s59, s68
  s_add_u32 s35, s35, s69
  s_add_u32 s78, s78, s69
  v_mov_b32 v3, s69
  s_mov_b64 exec, 1
  ds_add_u32 v1, v3 offset:6696
  s_mov_b64 exec, -1
  s_waitcnt lgkmcnt(0)
  v_sub_f32 v29, v29, v37
  v_sub_f32 v31, v31, v37
  v_sub_f32 v33, v33, v37
  v_mul_f32 v29, 0x3fb8aa3b, v29
  v_mul_f32 v31, 0x3fb8aa3b, v31
  v_mul_f32 v33, 0x3fb8aa3b, v33
  v_exp_f32 v29, v29
  v_exp_f32 v31, v31
  v_exp_f32 v33, v33
  s_nop 0
  v_cvt_pk_bf16_f32 v34, 0, v29
  v_cvt_pk_bf16_f32 v35, 0, v31
  v_cvt_pk_bf16_f32 v36, 0, v33
  v_cvt_pk_bf16_f32 v29, v29, 0
  v_cvt_pk_bf16_f32 v31, v31, 0
  v_cvt_pk_bf16_f32 v33, v33, 0
  s_branch L_vs2
L_work:
  s_cmp_eq_u32 s39, 1
  s_cbranch_scc1 L_w1
  s_cmp_eq_u32 s39, 2
  s_cbranch_scc1 L_w2
  s_cmp_eq_u32 s39, 3
  s_cbranch_scc1 L_w3
  s_cmp_lt_u32 s32, 16
  s_cbranch_scc1 L_wr
L_w0:
  s_load_dwordx16 s[16:31], s[42:43], s40 glc
  s_mov_b32 s39, 1
L_wr:
  s_setpc_b64 s[100:101]
L_w1:
  s_waitcnt lgkmcnt(0)
  s_xor_b32 s68, s17, s74
  s_xor_b32 s69, s19, s74
  s_or_b32 s68, s68, s69
  s_xor_b32 s69, s21, s74
  s_or_b32 s68, s68, s69
  s_xor_b32 s69, s23, s74
  s_or_b32 s68, s68, s69
  s_xor_b32 s69, s25, s74
  s_or_b32 s68, s68, s69
  s_xor_b32 s69, s27, s74
  s_or_b32 s68, s68, s69
  s_xor_b32 s69, s29, s74
  s_or_b32 s68, s68, s69
  s_xor_b32 s69, s31, s74
  s_or_b32 s68, s68, s69
  s_cbranch_scc1 L_w0
  v_mov_b32 v8, s16
  v_mov_b32 v9, s18
  v_mov_b32 v10, s20
  v_mov_b32 v11, s22
  v_mov_b32 v12, s24
  v_mov_b32 v13, s26
  v_mov_b32 v14, s28
  v_mov_b32 v15, s30
  v_lshlrev_b32 v3, 5, s9
  s_mov_b64 exec, 1
  ds_write_b128 v3, v[8:11] offset:6400
  ds_write_b128 v3, v[12:15] offset:6416
  s_mov_b64 exec, -1
  s_mov_b32 s39, 2
L_w2:
  s_add_u32 s68, s41, 16
  s_cmp_lt_u32 s32, s68
  s_cbranch_scc1 L_wr
  ds_read_b128 v[4:7], v38 offset:6400
  s_waitcnt lgkmcnt(0)
  v_max3_u32 v8, v4, v5, v6
  v_max_u32 v8, v8, v7
  v_cmp_eq_u32 vcc, -1, v8
  s_cmp_lg_u64 vcc, 0
  s_cbranch_scc1 L_wr
  v_dot2_f32_bf16 v8, v40, v4, 0
  v_dot2_f32_bf16 v9, v44, v4, 0
  v_dot2_f32_bf16 v10, v48, v4, 0
  v_dot2_f32_bf16 v11, v52, v4, 0
  v_dot2_f32_bf16 v12, v56, v4, 0
  v_dot2_f32_bf16 v13, v60, v4, 0
  v_dot2_f32_bf16 v14, v64, v4, 0
  v_dot2_f32_bf16 v15, v68, v4, 0
  v_dot2_f32_bf16 v8, v41, v5, v8
  v_dot2_f32_bf16 v9, v45, v5, v9
  v_dot2_f32_bf16 v10, v49, v5, v10
  v_dot2_f32_bf16 v11, v53, v5, v11
  v_dot2_f32_bf16 v12, v57, v5, v12
  v_dot2_f32_bf16 v13, v61, v5, v13
  v_dot2_f32_bf16 v14, v65, v5, v14
  v_dot2_f32_bf16 v15, v69, v5, v15
  v_dot2_f32_bf16 v8, v42, v6, v8
  v_dot2_f32_bf16 v9, v46, v6, v9
  v_dot2_f32_bf16 v10, v50, v6, v10
  v_dot2_f32_bf16 v11, v54, v6, v11
  v_dot2_f32_bf16 v12, v58, v6, v12
  v_dot2_f32_bf16 v13, v62, v6, v13
  v_dot2_f32_bf16 v14, v66, v6, v14
  v_dot2_f32_bf16 v15, v70, v6, v15
  v_dot2_f32_bf16 v8, v43, v7, v8
  v_dot2_f32_bf16 v9, v47, v7, v9
  v_dot2_f32_bf16 v10, v51, v7, v10
  v_dot2_f32_bf16 v11, v55, v7, v11
  v_dot2_f32_bf16 v12, v59, v7, v12
  v_dot2_f32_bf16 v13, v63, v7, v13
  v_dot2_f32_bf16 v14, v67, v7, v14
  v_dot2_f32_bf16 v15, v71, v7, v15
  v_add_f32_dpp v8, v8, v8 row_ror:8 row_mask:0xf bank_mask:0x3
  v_add_f32_dpp v8, v9, v9 row_ror:8 row_mask:0xf bank_mask:0xc
  v_add_f32_dpp v10, v10, v10 row_ror:8 row_mask:0xf bank_mask:0x3
  v_add_f32_dpp v10, v11, v11 row_ror:8 row_mask:0xf bank_mask:0xc
  v_add_f32_dpp v12, v12, v12 row_ror:8 row_mask:0xf bank_mask:0x3
  v_add_f32_dpp v12, v13, v13 row_ror:8 row_mask:0xf bank_mask:0xc
  v_add_f32_dpp v14, v14, v14 row_ror:8 row_mask:0xf bank_mask:0x3
  v_add_f32_dpp v14, v15, v15 row_ror:8 row_mask:0xf bank_mask:0xc
  v_add_f32_dpp v16, v8, v8 row_shl:4 row_mask:0xf bank_mask:0x5
  v_add_f32_dpp v16, v10, v10 row_shr:4 row_mask:0xf bank_mask:0xa
  v_add_f32_dpp v17, v12, v12 row_shl:4 row_mask:0xf bank_mask:0x5
  v_add_f32_dpp v17, v14, v14 row_shr:4 row_mask:0xf bank_mask:0xa
  v_dot2_f32_bf16 v8, v72, v4, 0
  v_dot2_f32_bf16 v9, v76, v4, 0
  v_dot2_f32_bf16 v10, v80, v4, 0
  v_dot2_f32_bf16 v11, v84, v4, 0
  v_dot2_f32_bf16 v12, v88, v4, 0
  v_dot2_f32_bf16 v13, v92, v4, 0
  v_dot2_f32_bf16 v14, v96, v4, 0
  v_dot2_f32_bf16 v15, v100, v4, 0
  v_dot2_f32_bf16 v8, v73, v5, v8
  v_dot2_f32_bf16 v9, v77, v5, v9
  v_dot2_f32_bf16 v10, v81, v5, v10
  v_dot2_f32_bf16 v11, v85, v5, v11
  v_dot2_f32_bf16 v12, v89, v5, v12
  v_dot2_f32_bf16 v13, v93, v5, v13
  v_dot2_f32_bf16 v14, v97, v5, v14
  v_dot2_f32_bf16 v15, v101, v5, v15
  v_dot2_f32_bf16 v8, v74, v6, v8
  v_dot2_f32_bf16 v9, v78, v6, v9
  v_dot2_f32_bf16 v10, v82, v6, v10
  v_dot2_f32_bf16 v11, v86, v6, v11
  v_dot2_f32_bf16 v12, v90, v6, v12
  v_dot2_f32_bf16 v13, v94, v6, v13
  v_dot2_f32_bf16 v14, v98, v6, v14
  v_dot2_f32_bf16 v15, v102, v6, v15
  v_dot2_f32_bf16 v8, v75, v7, v8
  v_dot2_f32_bf16 v9, v79, v7, v9
  v_dot2_f32_bf16 v10, v83, v7, v10
  v_dot2_f32_bf16 v11, v87, v7, v11
  v_dot2_f32_bf16 v12, v91, v7, v12
  v_dot2_f32_bf16 v13, v95, v7, v13
  v_dot2_f32_bf16 v14, v99, v7, v14
  v_dot2_f32_bf16 v15, v103, v7, v15
  v_add_f32_dpp v8, v8, v8 row_ror:8 row_mask:0xf bank_mask:0x3
  v_add_f32_dpp v8, v9, v9 row_ror:8 row_mask:0xf bank_mask:0xc
  v_add_f32_dpp v10, v10, v10 row_ror:8 row_mask:0xf bank_mask:0x3
  v_add_f32_dpp v10, v11, v11 row_ror:8 row_mask:0xf bank_mask:0xc
  v_add_f32_dpp v12, v12, v12 row_ror:8 row_mask:0xf bank_mask:0x3
  v_add_f32_dpp v12, v13, v13 row_ror:8 row_mask:0xf bank_mask:0xc
  v_add_f32_dpp v14, v14, v14 row_ror:8 row_mask:0xf bank_mask:0x3
  v_add_f32_dpp v14, v15, v15 row_ror:8 row_mask:0xf bank_mask:0xc
  v_add_f32_dpp v18, v8, v8 row_shl:4 row_mask:0xf bank_mask:0x5
  v_add_f32_dpp v18, v10, v10 row_shr:4 row_mask:0xf bank_mask:0xa
  v_add_f32_dpp v19, v12, v12 row_shl:4 row_mask:0xf bank_mask:0x5
  v_add_f32_dpp v19, v14, v14 row_shr:4 row_mask:0xf bank_mask:0xa
  v_mov_b32 v3, 0
  v_mov_b32 v20, 64
  v_add_f32_dpp v16, v16, v16 quad_perm:[2,3,0,1] row_mask:0xf bank_mask:0xf
  v_add_f32_dpp v17, v17, v17 quad_perm:[2,3,0,1] row_mask:0xf bank_mask:0xf
  v_add_f32_dpp v18, v18, v18 quad_perm:[2,3,0,1] row_mask:0xf bank_mask:0xf
  v_add_f32_dpp v19, v19, v19 quad_perm:[2,3,0,1] row_mask:0xf bank_mask:0xf
  v_cndmask_b32 v8, v16, v17, s[52:53]
  v_cndmask_b32 v9, v18, v19, s[52:53]
  s_nop 0
  v_lshlrev_b32 v21, 3, s9
  v_add_f32_dpp v8, v8, v8 quad_perm:[1,0,3,2] row_mask:0xf bank_mask:0xf
  v_add_f32_dpp v9, v9, v9 quad_perm:[1,0,3,2] row_mask:0xf bank_mask:0xf
  v_cndmask_b32 v25, v8, v9, s[54:55]
  v_cvt_pk_bf16_f32 v25, 0, v25
  v_mul_f32 v25, 0x3db504f3, v25
  v_cvt_pk_bf16_f32 v25, 0, v25
  v_mov_b32 v37, v25
  s_nop 1
  v_max_f32_dpp v37, v37, v37 row_ror:8 row_mask:0xf bank_mask:0xf
  s_nop 1
  v_max_f32_dpp v37, v37, v37 row_ror:4 row_mask:0xf bank_mask:0xf
  s_nop 1
  v_max_f32_dpp v37, v37, v37 row_ror:2 row_mask:0xf bank_mask:0xf
  s_nop 1
  v_max_f32_dpp v37, v37, v37 row_ror:1 row_mask:0xf bank_mask:0xf
  v_mov_b32 v8, v37
  s_nop 1
  v_permlane16_swap_b32 v8, v37
  v_max_f32 v37, v37, v8
  v_mov_b32 v8, v37
  s_nop 1
  v_permlane32_swap_b32 v8, v37
  v_max_f32 v37, v37, v8
  s_mov_b64 exec, 1
  ds_max_f32 v3, v37 offset:6684
  ds_add_u32 v3, v20 offset:6680
  s_mov_b64 exec, -1
  s_mov_b32 s39, 3
  s_mov_b32 s19, 0
  s_setpc_b64 s[100:101]
L_w3:
  v_mov_b32 v3, 0
  ds_read_b64 v[18:19], v3 offset:6680
  s_waitcnt lgkmcnt(0)
  v_cmp_gt_u32 vcc, 0x10280, v18
  s_cmp_lg_u64 vcc, 0
  s_cbranch_scc1 L_wr
  ds_read_b96 v[16:18], v3 offset:6736
  s_waitcnt lgkmcnt(0)
  v_max_f32 v2, v19, v18
  v_med3_f32 v21, v19, v16, v17
  v_add_f32 v21, 0xc1c00000, v21
  v_cmp_nlt_f32 vcc, v25, v21
  v_readfirstlane_b32 s22, v21
  s_mov_b32 s20, 0
  s_bcnt1_i32_b64 s68, vcc
  s_cmp_gt_u32 s68, 32
  s_cselect_b32 s21, 1, 0
  s_cbranch_scc1 L_w4
  s_mov_b32 s38, 160
  v_cmp_nlt_f32 vcc, v25, v21
  s_lshl_b32 s68, s38, 3
  s_add_u32 s68, s68, s56
  s_andn2_b64 s[70:71], vcc, s[64:65]
  v_mbcnt_lo_u32_b32 v3, s70, 0
  v_mbcnt_hi_u32_b32 v3, s71, v3
  s_bcnt1_i32_b64 s69, s[70:71]
  v_lshl_add_u32 v3, v3, 3, s68
  s_mov_b64 exec, s[70:71]
  ds_write_b64 v3, v[24:25]
  s_mov_b64 exec, -1
  s_or_b64 s[64:65], s[64:65], s[70:71]
  s_add_u32 s38, s38, s69
  s_mov_b32 s20, s69
  s_mov_b32 s38, 0
L_w4:
  v_add_f32 v21, 0xc2ac0000, v2
  v_cmp_nlt_f32 vcc, v25, v21
  s_lshl_b32 s68, s38, 3
  s_add_u32 s68, s68, s56
  s_andn2_b64 s[70:71], vcc, s[64:65]
  v_mbcnt_lo_u32_b32 v3, s70, 0
  v_mbcnt_hi_u32_b32 v3, s71, v3
  s_bcnt1_i32_b64 s69, s[70:71]
  v_lshl_add_u32 v3, v3, 3, s68
  s_mov_b64 exec, s[70:71]
  ds_write_b64 v3, v[24:25]
  s_mov_b64 exec, -1
  s_or_b64 s[64:65], s[64:65], s[70:71]
  s_add_u32 s38, s38, s69
  s_add_u32 s68, s38, 4
  s_lshr_b32 s68, s68, 1
  s_sub_u32 s69, s68, s59
  s_mov_b32 s59, s68
  v_mov_b32 v3, s69
  s_mov_b64 exec, 1
  ds_add_u32 v1, v3 offset:6696
  s_mov_b64 exec, -1
  s_mov_b32 s39, 4
  ds_read_b64 v[28:29], v39 offset:0
  s_waitcnt lgkmcnt(0)
  s_setpc_b64 s[100:101]
L_helper:
  s_bfe_u32 s61, s2, 0x30003
  s_lshl_b32 s48, s8, 3
  s_add_u32 s61, s61, s48
  s_cmp_lt_u32 s2, 144
  s_cselect_b32 s48, 3, 4
  s_lshr_b32 s48, s2, s48
  s_and_b32 s48, s48, 1
  s_lshl_b32 s49, s48, 1
  s_add_u32 s50, s2, 3
  s_sub_u32 s50, s50, s49
  s_and_b32 s50, s50, 7
  s_lshl_b32 s48, s48, 3
  s_or_b32 s50, s50, s48
  s_cmp_lt_u32 s2, 128
  s_cselect_b32 s61, s61, s50
  v_mov_b32 v4, -1
  v_mov_b32 v5, -1
  v_mov_b32 v6, -1
  v_mov_b32 v7, -1
  v_mov_b32 v8, 0xff800000
  v_mov_b32 v9, 0
  v_mov_b32 v10, 0xff800000
  v_lshlrev_b32 v2, 3, v1
  ds_write_b64 v2, v[8:9] offset:6912
  v_lshlrev_b32 v2, 2, v1
  ds_write_b32 v2, v4 offset:6400
  v_mov_b32 v38, 0
  v_mov_b32 v39, 0xff800000
  ds_write_b128 v38, v[4:7] offset:6656
  ds_write_b32 v38, v38 offset:6720
  v_mov_b32 v8, 128
  v_mov_b32 v9, v39
  v_mov_b32 v10, v8
  v_mov_b32 v11, v39
  ds_write_b128 v38, v[8:11] offset:6672
  v_mov_b32 v8, 1248
  v_mov_b32 v9, 0
  v_mov_b32 v10, 1024
  v_mov_b32 v11, -153
  ds_write_b128 v38, v[8:11] offset:6688
  v_mov_b32 v8, 0
  v_mov_b32 v9, 0
  v_mov_b32 v10, 0
  v_mov_b32 v11, 0
  v_lshlrev_b32 v2, 3, v0
  ds_write_b64 v2, v[8:9] offset:11008
  ds_write_b64 v2, v[8:9] offset:16128
  v_mov_b32 v8, 2
  v_mov_b32 v9, 2
  ds_write_b128 v38, v[8:11] offset:6704
  s_mov_b32 s77, 4
  s_getreg_b32 s76, hwreg(HW_REG_XCC_ID, 0, 4)
  v_lshrrev_b32 v12, 3, v0
  v_lshlrev_b32 v12, 5, v12
  v_bfe_u32 v3, v1, 2, 1
  v_lshl_add_u32 v12, v3, 10, v12
  v_and_b32 v8, 3, v1
  v_lshl_add_u32 v13, v8, 3, v12
  v_and_b32 v12, 0xffffffdf, v12
  v_lshl_add_u32 v12, v8, 4, v12
  v_bfe_u32 v8, v1, 3, 1
  v_lshl_add_u32 v12, v8, 3, v12
  v_lshl_add_u32 v12, v3, 5, v12
  s_lshl_b32 s48, s61, 7
  s_lshl_b32 s49, s5, 7
  s_add_u32 s49, s49, 64
  v_add_u32 v8, s49, v1
  s_waitcnt lgkmcnt(0)
  s_load_dword s74, s[42:43], 0
  s_cmp_eq_u32 s13, 2
  s_cbranch_scc1 L_r_q
  s_cmp_eq_u32 s13, 1
  s_cbranch_scc1 L_r_moda
  s_load_dwordx2 s[14:15], s[56:57], s3
  s_barrier
  s_waitcnt lgkmcnt(0)
  s_and_b32 s13, s14, 7
  s_bfe_u32 s61, s14, 0x80008
  s_cmp_eq_u32 s13, 1
  s_cbranch_scc1 L_r_wo
  s_cmp_eq_u32 s13, 4
  s_cbranch_scc1 L_r_modb
  s_cmp_eq_u32 s13, 2
  s_cbranch_scc1 L_r_f1
  s_cmp_eq_u32 s13, 3
  s_cbranch_scc1 L_r_f2
  s_branch L_r_none
L_r_moda:
  s_lshl_b32 s48, s61, 7
  s_lshl_b32 s58, s61, 9
  s_add_u32 s58, s58, 4096
  s_mov_b32 s44, s36
  s_mov_b32 s45, s37
  s_mov_b32 s46, 3145728
  s_mov_b32 s47, 0x20000
  global_load_dwordx2 v[14:15], v13, s[34:35]
  v_lshrrev_b32 v2, 3, v1
  v_and_b32 v3, 6, v2
  v_xor_b32 v3, v3, v1
  v_mul_u32_u24 v2, 6144, v2
  v_and_b32 v3, 7, v3
  v_lshl_add_u32 v2, v3, 4, v2
  s_mul_i32 s49, s5, 786432
  s_lshl_b32 s50, s5, 14
  s_add_u32 s49, s49, s48
  s_add_u32 s50, s50, 18432
  s_add_u32 s51, s50, 16384
L_dma_6:
  s_mov_b32 m0, s50
  s_add_u32 s50, s50, 1024
  buffer_load_dwordx4 v2, s[44:47], s49 offen nt lds
  s_add_u32 s49, s49, 49152
  s_cmp_lt_u32 s50, s51
  s_cbranch_scc1 L_dma_6
L_dmae_7:
  s_barrier
  s_waitcnt lgkmcnt(0)
  s_mul_i32 s74, s74, 0x9e3779b1
  s_add_u32 s74, s74, 0x7f4a7c15
  s_add_u32 s76, s76, s74
  s_waitcnt vmcnt(16)
  v_lshlrev_b32 v16, 16, v14
  v_and_b32 v17, s73, v14
  v_lshlrev_b32 v18, 16, v15
  v_and_b32 v19, s73, v15
  v_mul_f32 v20, 0xbfb8aa3b, v16
  v_mul_f32 v21, 0xbfb8aa3b, v17
  v_mul_f32 v22, 0xbfb8aa3b, v18
  v_mul_f32 v23, 0xbfb8aa3b, v19
  v_exp_f32 v20, v20
  v_exp_f32 v21, v21
  v_exp_f32 v22, v22
  v_exp_f32 v23, v23
  s_nop 0
  v_add_f32 v20, 1.0, v20
  v_add_f32 v21, 1.0, v21
  v_add_f32 v22, 1.0, v22
  v_add_f32 v23, 1.0, v23
  v_rcp_f32 v20, v20
  v_rcp_f32 v21, v21
  v_rcp_f32 v22, v22
  v_rcp_f32 v23, v23
  s_nop 0
  v_mul_f32 v16, v16, v20
  v_mul_f32 v17, v17, v21
  v_mul_f32 v18, v18, v22
  v_mul_f32 v19, v19, v23
  v_cvt_pk_bf16_f32 v14, v16, v17
  v_cvt_pk_bf16_f32 v15, v18, v19
  ds_write_b64 v12, v[14:15] offset:0
  v_and_b32 v13, 1, v1
  v_lshlrev_b32 v13, 6, v13
  v_lshrrev_b32 v3, 4, v1
  v_lshl_add_u32 v13, v3, 4, v13
  s_lshl_b32 s49, s5, 7
  s_add_u32 s49, s49, s58
  v_add_u32 v13, s49, v13
  v_bfe_u32 v3, v1, 1, 3
  v_lshl_add_u32 v13, v3, 13, v13
  v_add_u32 v13, 913408, v13
  v_and_b32 v14, 1, v1
  v_mul_u32_u24 v14, 1056, v14
  v_lshrrev_b32 v3, 4, v1
  v_lshl_add_u32 v14, v3, 4, v14
  v_lshrrev_b32 v2, 2, v1
  v_bfe_u32 v3, v1, 1, 1
  s_lshl_b32 s49, s5, 1
  v_or_b32 v3, s49, v3
  v_and_b32 v10, 6, v2
  v_xor_b32 v3, v3, v10
  v_lshlrev_b32 v2, 7, v2
  v_lshl_add_u32 v2, v3, 4, v2
  v_and_b32 v3, 1, v1
  v_lshl_add_u32 v2, v3, 3, v2
  v_add_u32 v2, 18432, v2
  s_waitcnt vmcnt(0) lgkmcnt(0)
  v_mov_b32 v9, 1
  s_mov_b64 exec, 1
  ds_add_u32 v38, v9 offset:6720
  s_mov_b64 exec, -1
  s_mov_b32 s70, 0
L_sn_8:
  ds_read_b32 v9, v38 offset:6720
  s_waitcnt lgkmcnt(0)
  v_cmp_gt_u32 vcc, 0x4, v9
  s_cmp_eq_u64 vcc, 0
  s_cbranch_scc1 L_snd_9
  s_add_u32 s70, s70, 1
  s_cmp_lt_u32 s70, 2097152
  s_cbranch_scc1 L_sn_8
L_snd_9:
  ds_read_b64_tr_b16 v[40:41], v2 offset:0
  ds_read_b64_tr_b16 v[42:43], v2 offset:2048
  ds_read_b128 v[104:107], v14 offset:0
  ds_read_b64_tr_b16 v[44:45], v2 offset:4096
  ds_read_b64_tr_b16 v[46:47], v2 offset:6144
  ds_read_b128 v[108:111], v14 offset:64
  ds_read_b64_tr_b16 v[48:49], v2 offset:8192
  ds_read_b64_tr_b16 v[50:51], v2 offset:10240
  ds_read_b128 v[112:115], v14 offset:128
  ds_read_b64_tr_b16 v[52:53], v2 offset:12288
  ds_read_b64_tr_b16 v[54:55], v2 offset:14336
  ds_read_b128 v[116:119], v14 offset:192
  ds_read_b64_tr_b16 v[56:57], v2 offset:16384
  ds_read_b64_tr_b16 v[58:59], v2 offset:18432
  ds_read_b128 v[120:123], v14 offset:256
  s_waitcnt lgkmcnt(12)
  v_mfma_f32_16x16x32_bf16 v[8:11], v[40:43], v[104:107], 0
  ds_read_b64_tr_b16 v[60:61], v2 offset:20480
  ds_read_b64_tr_b16 v[62:63], v2 offset:22528
  ds_read_b128 v[124:127], v14 offset:320
  s_waitcnt lgkmcnt(12)
  v_mfma_f32_16x16x32_bf16 v[8:11], v[44:47], v[108:111], v[8:11]
  ds_read_b64_tr_b16 v[64:65], v2 offset:24576
  ds_read_b64_tr_b16 v[66:67], v2 offset:26624
  ds_read_b128 v[128:131], v14 offset:384
  s_waitcnt lgkmcnt(12)
  v_mfma_f32_16x16x32_bf16 v[8:11], v[48:51], v[112:115], v[8:11]
  ds_read_b64_tr_b16 v[68:69], v2 offset:28672
  ds_read_b64_tr_b16 v[70:71], v2 offset:30720
  ds_read_b128 v[132:135], v14 offset:448
  s_waitcnt lgkmcnt(12)
  v_mfma_f32_16x16x32_bf16 v[8:11], v[52:55], v[116:119], v[8:11]
  ds_read_b64_tr_b16 v[72:73], v2 offset:32768
  ds_read_b64_tr_b16 v[74:75], v2 offset:34816
  ds_read_b128 v[136:139], v14 offset:512
  s_waitcnt lgkmcnt(12)
  v_mfma_f32_16x16x32_bf16 v[8:11], v[56:59], v[120:123], v[8:11]
  ds_read_b64_tr_b16 v[76:77], v2 offset:36864
  ds_read_b64_tr_b16 v[78:79], v2 offset:38912
  ds_read_b128 v[140:143], v14 offset:576
  s_waitcnt lgkmcnt(12)
  v_mfma_f32_16x16x32_bf16 v[8:11], v[60:63], v[124:127], v[8:11]
  ds_read_b64_tr_b16 v[80:81], v2 offset:40960
  ds_read_b64_tr_b16 v[82:83], v2 offset:43008
  ds_read_b128 v[144:147], v14 offset:640
  s_waitcnt lgkmcnt(12)
  v_mfma_f32_16x16x32_bf16 v[8:11], v[64:67], v[128:131], v[8:11]
  ds_read_b64_tr_b16 v[84:85], v2 offset:45056
  ds_read_b64_tr_b16 v[86:87], v2 offset:47104
  ds_read_b128 v[148:151], v14 offset:704
  s_waitcnt lgkmcnt(12)
  v_mfma_f32_16x16x32_bf16 v[8:11], v[68:71], v[132:135], v[8:11]
  ds_read_b64_tr_b16 v[88:89], v2 offset:49152
  ds_read_b64_tr_b16 v[90:91], v2 offset:51200
  ds_read_b128 v[152:155], v14 offset:768
  s_waitcnt lgkmcnt(12)
  v_mfma_f32_16x16x32_bf16 v[8:11], v[72:75], v[136:139], v[8:11]
  ds_read_b64_tr_b16 v[92:93], v2 offset:53248
  ds_read_b64_tr_b16 v[94:95], v2 offset:55296
  ds_read_b128 v[156:159], v14 offset:832
  s_waitcnt lgkmcnt(12)
  v_mfma_f32_16x16x32_bf16 v[8:11], v[76:79], v[140:143], v[8:11]
  ds_read_b64_tr_b16 v[96:97], v2 offset:57344
  ds_read_b64_tr_b16 v[98:99], v2 offset:59392
  ds_read_b128 v[160:163], v14 offset:896
  s_waitcnt lgkmcnt(12)
  v_mfma_f32_16x16x32_bf16 v[8:11], v[80:83], v[144:147], v[8:11]
  ds_read_b64_tr_b16 v[100:101], v2 offset:61440
  ds_read_b64_tr_b16 v[102:103], v2 offset:63488
  ds_read_b128 v[164:167], v14 offset:960
  s_waitcnt lgkmcnt(12)
  v_mfma_f32_16x16x32_bf16 v[8:11], v[84:87], v[148:151], v[8:11]
  s_waitcnt lgkmcnt(9)
  v_mfma_f32_16x16x32_bf16 v[8:11], v[88:91], v[152:155], v[8:11]
  s_waitcnt lgkmcnt(6)
  v_mfma_f32_16x16x32_bf16 v[8:11], v[92:95], v[156:159], v[8:11]
  s_waitcnt lgkmcnt(3)
  v_mfma_f32_16x16x32_bf16 v[8:11], v[96:99], v[160:163], v[8:11]
  s_waitcnt lgkmcnt(0)
  v_mfma_f32_16x16x32_bf16 v[8:11], v[100:103], v[164:167], v[8:11]
  s_nop 7
  v_cvt_pk_bf16_f32 v8, v8, v9
  v_cvt_pk_bf16_f32 v10, v10, v11
  v_mov_b32 v9, s74
  v_mov_b32 v11, s74
  s_mov_b32 exec_lo, 0xffffffff
  s_mov_b32 exec_hi, exec_lo
  global_store_dwordx4 v13, v[8:11], s[42:43] sc1
  s_mov_b64 exec, -1
  ds_write_b32 v38, v38 offset:6660
  s_mov_b32 s60, 0
  s_branch L_svc
L_r_q:
  s_lshl_b32 s58, s61, 8
  s_add_u32 s58, s58, 32768
  global_load_dwordx2 v[14:15], v13, s[16:17]
  s_mov_b32 s44, s22
  s_mov_b32 s45, s23
  s_mov_b32 s46, 4194304
  s_mov_b32 s47, 0x20000
  v_lshrrev_b32 v2, 3, v1
  v_and_b32 v3, 6, v2
  v_xor_b32 v3, v3, v1
  v_mul_u32_u24 v2, 8192, v2
  v_and_b32 v3, 7, v3
  v_lshl_add_u32 v2, v3, 4, v2
  s_mul_i32 s49, s5, 1048576
  s_lshl_b32 s50, s5, 14
  s_add_u32 s49, s49, s48
  s_add_u32 s50, s50, 18432
  s_add_u32 s51, s50, 16384
L_dma_10:
  s_mov_b32 m0, s50
  s_add_u32 s50, s50, 1024
  buffer_load_dwordx4 v2, s[44:47], s49 offen nt lds
  s_add_u32 s49, s49, 65536
  s_cmp_lt_u32 s50, s51
  s_cbranch_scc1 L_dma_10
L_dmae_11:
  s_barrier
  s_waitcnt lgkmcnt(0)
  s_mul_i32 s74, s74, 0x9e3779b1
  s_add_u32 s74, s74, 0x7f4a7c15
  s_add_u32 s76, s76, s74
  s_waitcnt vmcnt(16)
  v_bfe_u32 v6, v1, 2, 1
  v_lshlrev_b32 v6, 5, v6
  v_add_u32 v6, 7424, v6
  s_lshl_b32 s49, s5, 3
  v_add_u32 v5, s49, v6
  v_lshlrev_b32 v20, 16, v14
  v_and_b32 v21, s73, v14
  v_lshlrev_b32 v22, 16, v15
  v_and_b32 v23, s73, v15
  v_add_f32 v8, v20, v21
  v_mul_f32 v9, v20, v20
  v_add_f32 v10, v22, v23
  v_mul_f32 v11, v22, v22
  v_fmac_f32 v9, v21, v21
  v_fmac_f32 v11, v23, v23
  v_add_f32 v8, v8, v10
  v_add_f32 v9, v9, v11
  s_nop 0
  v_add_f32_dpp v8, v8, v8 quad_perm:[1,0,3,2] row_mask:0xf bank_mask:0xf
  v_add_f32_dpp v9, v9, v9 quad_perm:[1,0,3,2] row_mask:0xf bank_mask:0xf
  s_nop 0
  v_add_f32_dpp v8, v8, v8 quad_perm:[2,3,0,1] row_mask:0xf bank_mask:0xf
  v_add_f32_dpp v9, v9, v9 quad_perm:[2,3,0,1] row_mask:0xf bank_mask:0xf
  s_nop 0
  v_add_f32_dpp v8, v8, v8 row_ror:8 row_mask:0xf bank_mask:0xf
  v_add_f32_dpp v9, v9, v9 row_ror:8 row_mask:0xf bank_mask:0xf
  s_nop 0
  v_mov_b32 v10, v8
  v_mov_b32 v11, v9
  s_nop 0
  v_permlane16_swap_b32 v10, v8
  v_permlane16_swap_b32 v11, v9
  v_add_f32 v8, v8, v10
  v_add_f32 v9, v9, v11
  v_mov_b32 v10, v8
  v_mov_b32 v11, v9
  s_nop 0
  v_permlane32_swap_b32 v10, v8
  v_permlane32_swap_b32 v11, v9
  v_add_f32 v8, v8, v10
  v_add_f32 v9, v9, v11
  ds_write_b64 v5, v[8:9]
  s_waitcnt vmcnt(0) lgkmcnt(0)
  v_mov_b32 v9, 1
  s_mov_b64 exec, 1
  ds_add_u32 v38, v9 offset:6720
  s_mov_b64 exec, -1
  s_mov_b32 s70, 0
L_sn_12:
  ds_read_b32 v9, v38 offset:6720
  s_waitcnt lgkmcnt(0)
  v_cmp_gt_u32 vcc, 0x4, v9
  s_cmp_eq_u64 vcc, 0
  s_cbranch_scc1 L_snd_13
  s_sleep 1
  s_add_u32 s70, s70, 1
  s_cmp_lt_u32 s70, 2097152
  s_cbranch_scc1 L_sn_12
L_snd_13:
  ds_read_b128 v[24:27], v6
  ds_read_b128 v[28:31], v6 offset:16
  s_waitcnt lgkmcnt(0)
  v_pk_add_f32 v[24:25], v[24:25], v[26:27]
  v_pk_add_f32 v[28:29], v[28:29], v[30:31]
  v_pk_add_f32 v[24:25], v[24:25], v[28:29]
  v_mul_f32 v8, 0x3b000000, v24
  v_mul_f32 v9, 0x3b000000, v25
  v_fma_f32 v9, -v8, v8, v9
  v_cvt_pk_bf16_f32 v8, 0, v8
  v_max_f32 v9, 0, v9
  v_cvt_pk_bf16_f32 v9, 0, v9
  v_sub_f32 v20, v20, v8
  v_sub_f32 v21, v21, v8
  v_add_f32 v9, 0x3727c5ac, v9
  v_sub_f32 v22, v22, v8
  v_sub_f32 v23, v23, v8
  v_cvt_pk_bf16_f32 v9, 0, v9
  v_cvt_pk_bf16_f32 v20, 0, v20
  v_sqrt_f32 v9, v9
  v_cvt_pk_bf16_f32 v21, 0, v21
  v_cvt_pk_bf16_f32 v9, 0, v9
  v_cvt_pk_bf16_f32 v22, 0, v22
  v_rcp_f32 v9, v9
  v_cvt_pk_bf16_f32 v23, 0, v23
  v_mul_f32 v20, v20, v9
  v_mul_f32 v21, v21, v9
  v_mul_f32 v22, v22, v9
  v_mul_f32 v23, v23, v9
  v_cvt_pk_bf16_f32 v20, 0, v20
  v_cvt_pk_bf16_f32 v21, 0, v21
  v_cvt_pk_bf16_f32 v22, 0, v22
  v_cvt_pk_bf16_f32 v23, 0, v23
  v_lshlrev_b32 v15, 4, v0
  s_and_b32 s49, s2, 7
  s_lshl_b32 s49, s49, 13
  s_add_u32 s49, s49, 917504
  v_add_u32 v15, s49, v15
  v_add_u32 v36, 0x1000, v15
  s_mov_b64 s[64:65], -1
  s_mov_b64 s[66:67], -1
  s_mov_b64 exec, s[64:65]
  global_load_dwordx4 v[16:19], v15, s[42:43] sc1
  s_mov_b64 exec, s[66:67]
  global_load_dwordx4 v[32:35], v36, s[42:43] sc1
  s_mov_b64 exec, -1
  v_lshrrev_b32 v2, 2, v1
  v_bfe_u32 v3, v1, 1, 1
  s_lshl_b32 s49, s5, 1
  v_or_b32 v3, s49, v3
  v_and_b32 v10, 6, v2
  v_xor_b32 v3, v3, v10
  v_lshlrev_b32 v2, 7, v2
  v_lshl_add_u32 v2, v3, 4, v2
  v_and_b32 v3, 1, v1
  v_lshl_add_u32 v2, v3, 3, v2
  v_add_u32 v2, 18432, v2
  ds_read_b64_tr_b16 v[40:41], v2 offset:0
  ds_read_b64_tr_b16 v[42:43], v2 offset:2048
  ds_read_b64_tr_b16 v[44:45], v2 offset:4096
  ds_read_b64_tr_b16 v[46:47], v2 offset:6144
  ds_read_b64_tr_b16 v[48:49], v2 offset:8192
  ds_read_b64_tr_b16 v[50:51], v2 offset:10240
  ds_read_b64_tr_b16 v[52:53], v2 offset:12288
  ds_read_b64_tr_b16 v[54:55], v2 offset:14336
  ds_read_b64_tr_b16 v[56:57], v2 offset:16384
  ds_read_b64_tr_b16 v[58:59], v2 offset:18432
  ds_read_b64_tr_b16 v[60:61], v2 offset:20480
  ds_read_b64_tr_b16 v[62:63], v2 offset:22528
  s_waitcnt lgkmcnt(10)
  ds_read_b64_tr_b16 v[64:65], v2 offset:24576
  ds_read_b64_tr_b16 v[66:67], v2 offset:26624
  s_waitcnt lgkmcnt(10)
  ds_read_b64_tr_b16 v[68:69], v2 offset:28672
  ds_read_b64_tr_b16 v[70:71], v2 offset:30720
  s_waitcnt lgkmcnt(10)
  ds_read_b64_tr_b16 v[72:73], v2 offset:32768
  ds_read_b64_tr_b16 v[74:75], v2 offset:34816
  s_waitcnt lgkmcnt(10)
  ds_read_b64_tr_b16 v[76:77], v2 offset:36864
  ds_read_b64_tr_b16 v[78:79], v2 offset:38912
  s_waitcnt lgkmcnt(10)
  ds_read_b64_tr_b16 v[80:81], v2 offset:40960
  ds_read_b64_tr_b16 v[82:83], v2 offset:43008
  s_waitcnt lgkmcnt(10)
  ds_read_b64_tr_b16 v[84:85], v2 offset:45056
  ds_read_b64_tr_b16 v[86:87], v2 offset:47104
  s_waitcnt lgkmcnt(10)
  ds_read_b64_tr_b16 v[88:89], v2 offset:49152
  ds_read_b64_tr_b16 v[90:91], v2 offset:51200
  s_waitcnt lgkmcnt(10)
  ds_read_b64_tr_b16 v[92:93], v2 offset:53248
  ds_read_b64_tr_b16 v[94:95], v2 offset:55296
  s_waitcnt lgkmcnt(10)
  ds_read_b64_tr_b16 v[96:97], v2 offset:57344
  ds_read_b64_tr_b16 v[98:99], v2 offset:59392
  s_waitcnt lgkmcnt(10)
  ds_read_b64_tr_b16 v[100:101], v2 offset:61440
  ds_read_b64_tr_b16 v[102:103], v2 offset:63488
  s_waitcnt lgkmcnt(10)
  s_waitcnt lgkmcnt(0)
  v_and_b32 v13, 1, v1
  v_lshlrev_b32 v13, 14, v13
  v_lshrrev_b32 v3, 4, v1
  v_lshl_add_u32 v13, v3, 4, v13
  s_lshl_b32 s49, s5, 6
  s_add_u32 s49, s49, s58
  v_add_u32 v13, s49, v13
  v_and_b32 v14, 1, v1
  v_mul_u32_u24 v14, 1056, v14
  v_lshrrev_b32 v3, 4, v1
  v_lshl_add_u32 v14, v3, 4, v14
  s_mov_b32 s70, 0
  s_branch L_q_c
L_q_p:
  s_mov_b64 exec, s[64:65]
  global_load_dwordx4 v[16:19], v15, s[42:43] sc1
  s_mov_b64 exec, s[66:67]
  global_load_dwordx4 v[32:35], v36, s[42:43] sc1
  s_mov_b64 exec, -1
L_q_c:
  s_waitcnt vmcnt(0)
  v_cmp_ne_u32 s[64:65], s74, v17
  v_cmp_ne_u32 s[68:69], s74, v19
  s_or_b64 s[64:65], s[64:65], s[68:69]
  v_cmp_ne_u32 s[66:67], s74, v33
  v_cmp_ne_u32 s[68:69], s74, v35
  s_or_b64 s[66:67], s[66:67], s[68:69]
  s_or_b64 vcc, s[64:65], s[66:67]
  s_cmp_eq_u64 vcc, 0
  s_cbranch_scc1 L_q_ok
  s_add_u32 s70, s70, 1
  s_cmp_lt_u32 s70, 262144
  s_cbranch_scc1 L_q_p
L_q_ok:
  v_lshlrev_b32 v28, 16, v32
  v_and_b32 v29, s73, v32
  v_lshlrev_b32 v30, 16, v34
  v_and_b32 v31, s73, v34
  v_lshlrev_b32 v24, 16, v16
  v_and_b32 v25, s73, v16
  v_lshlrev_b32 v26, 16, v18
  v_and_b32 v27, s73, v18
  v_add_f32 v28, 1.0, v28
  v_add_f32 v29, 1.0, v29
  v_add_f32 v30, 1.0, v30
  v_add_f32 v31, 1.0, v31
  v_cvt_pk_bf16_f32 v28, 0, v28
  v_cvt_pk_bf16_f32 v29, 0, v29
  v_cvt_pk_bf16_f32 v30, 0, v30
  v_cvt_pk_bf16_f32 v31, 0, v31
  v_mul_f32 v20, v20, v28
  v_mul_f32 v21, v21, v29
  v_mul_f32 v22, v22, v30
  v_mul_f32 v23, v23, v31
  v_cvt_pk_bf16_f32 v20, 0, v20
  v_cvt_pk_bf16_f32 v21, 0, v21
  v_cvt_pk_bf16_f32 v22, 0, v22
  v_cvt_pk_bf16_f32 v23, 0, v23
  v_add_f32 v20, v20, v24
  v_add_f32 v21, v21, v25
  v_add_f32 v22, v22, v26
  v_add_f32 v23, v23, v27
  v_cvt_pk_bf16_f32 v16, v20, v21
  v_cvt_pk_bf16_f32 v17, v22, v23
  ds_write_b64 v12, v[16:17] offset:0
  v_mov_b32 v9, 1
  s_mov_b64 exec, 1
  ds_add_u32 v38, v9 offset:6720
  s_mov_b64 exec, -1
  s_mov_b32 s70, 0
L_sn_14:
  ds_read_b32 v9, v38 offset:6720
  s_waitcnt lgkmcnt(0)
  v_cmp_gt_u32 vcc, 0x8, v9
  s_cmp_eq_u64 vcc, 0
  s_cbranch_scc1 L_snd_15
  s_add_u32 s70, s70, 1
  s_cmp_lt_u32 s70, 2097152
  s_cbranch_scc1 L_sn_14
L_snd_15:
  ds_write_b32 v38, v38 offset:6660
  ds_read_b128 v[104:107], v14 offset:0
  ds_read_b128 v[108:111], v14 offset:64
  ds_read_b128 v[112:115], v14 offset:128
  ds_read_b128 v[116:119], v14 offset:192
  ds_read_b128 v[120:123], v14 offset:256
  ds_read_b128 v[124:127], v14 offset:320
  ds_read_b128 v[128:131], v14 offset:384
  ds_read_b128 v[132:135], v14 offset:448
  ds_read_b128 v[136:139], v14 offset:512
  ds_read_b128 v[140:143], v14 offset:576
  ds_read_b128 v[144:147], v14 offset:640
  ds_read_b128 v[148:151], v14 offset:704
  s_waitcnt lgkmcnt(11)
  v_mfma_f32_16x16x32_bf16 v[8:11], v[40:43], v[104:107], 0
  ds_read_b128 v[152:155], v14 offset:768
  s_waitcnt lgkmcnt(11)
  v_mfma_f32_16x16x32_bf16 v[8:11], v[44:47], v[108:111], v[8:11]
  ds_read_b128 v[156:159], v14 offset:832
  s_waitcnt lgkmcnt(11)
  v_mfma_f32_16x16x32_bf16 v[8:11], v[48:51], v[112:115], v[8:11]
  ds_read_b128 v[160:163], v14 offset:896
  s_waitcnt lgkmcnt(11)
  v_mfma_f32_16x16x32_bf16 v[8:11], v[52:55], v[116:119], v[8:11]
  ds_read_b128 v[164:167], v14 offset:960
  s_waitcnt lgkmcnt(11)
  v_mfma_f32_16x16x32_bf16 v[8:11], v[56:59], v[120:123], v[8:11]
  s_waitcnt lgkmcnt(10)
  v_mfma_f32_16x16x32_bf16 v[8:11], v[60:63], v[124:127], v[8:11]
  s_waitcnt lgkmcnt(9)
  v_mfma_f32_16x16x32_bf16 v[8:11], v[64:67], v[128:131], v[8:11]
  s_waitcnt lgkmcnt(8)
  v_mfma_f32_16x16x32_bf16 v[8:11], v[68:71], v[132:135], v[8:11]
  s_waitcnt lgkmcnt(7)
  v_mfma_f32_16x16x32_bf16 v[8:11], v[72:75], v[136:139], v[8:11]
  s_waitcnt lgkmcnt(6)
  v_mfma_f32_16x16x32_bf16 v[8:11], v[76:79], v[140:143], v[8:11]
  s_waitcnt lgkmcnt(5)
  v_mfma_f32_16x16x32_bf16 v[8:11], v[80:83], v[144:147], v[8:11]
  s_waitcnt lgkmcnt(4)
  v_mfma_f32_16x16x32_bf16 v[8:11], v[84:87], v[148:151], v[8:11]
  s_waitcnt lgkmcnt(3)
  v_mfma_f32_16x16x32_bf16 v[8:11], v[88:91], v[152:155], v[8:11]
  s_waitcnt lgkmcnt(2)
  v_mfma_f32_16x16x32_bf16 v[8:11], v[92:95], v[156:159], v[8:11]
  s_waitcnt lgkmcnt(1)
  v_mfma_f32_16x16x32_bf16 v[8:11], v[96:99], v[160:163], v[8:11]
  s_waitcnt lgkmcnt(0)
  v_mfma_f32_16x16x32_bf16 v[8:11], v[100:103], v[164:167], v[8:11]
  s_nop 7
  v_cvt_pk_bf16_f32 v8, v8, v9
  v_cvt_pk_bf16_f32 v10, v10, v11
  v_mov_b32 v9, s74
  v_mov_b32 v11, s74
  v_min_u32 v8, s72, v8
  v_min_u32 v10, s72, v10
  s_mov_b32 exec_lo, 0x00030003
  s_mov_b32 exec_hi, 0x00030003
  global_store_dwordx4 v13, v[8:11], s[42:43] sc1
  s_mov_b64 exec, -1
  s_mov_b32 s60, 0
  s_branch L_svc
L_r_modb:
  s_lshl_b32 s48, s61, 7
  s_lshl_b32 s58, s61, 9
  s_add_u32 s58, s58, 4096
  s_mov_b32 s44, s36
  s_mov_b32 s45, s37
  s_mov_b32 s46, 3145728
  s_mov_b32 s47, 0x20000
  global_load_dwordx2 v[14:15], v13, s[34:35]
  s_waitcnt lgkmcnt(0)
  s_mul_i32 s74, s74, 0x9e3779b1
  s_add_u32 s74, s74, 0x7f4a7c15
  s_add_u32 s76, s76, s74
  s_waitcnt vmcnt(0)
  v_lshlrev_b32 v16, 16, v14
  v_and_b32 v17, s73, v14
  v_lshlrev_b32 v18, 16, v15
  v_and_b32 v19, s73, v15
  v_mul_f32 v20, 0xbfb8aa3b, v16
  v_mul_f32 v21, 0xbfb8aa3b, v17
  v_mul_f32 v22, 0xbfb8aa3b, v18
  v_mul_f32 v23, 0xbfb8aa3b, v19
  v_exp_f32 v20, v20
  v_exp_f32 v21, v21
  v_exp_f32 v22, v22
  v_exp_f32 v23, v23
  s_nop 0
  v_add_f32 v20, 1.0, v20
  v_add_f32 v21, 1.0, v21
  v_add_f32 v22, 1.0, v22
  v_add_f32 v23, 1.0, v23
  v_rcp_f32 v20, v20
  v_rcp_f32 v21, v21
  v_rcp_f32 v22, v22
  v_rcp_f32 v23, v23
  s_nop 0
  v_mul_f32 v16, v16, v20
  v_mul_f32 v17, v17, v21
  v_mul_f32 v18, v18, v22
  v_mul_f32 v19, v19, v23
  v_cvt_pk_bf16_f32 v14, v16, v17
  v_cvt_pk_bf16_f32 v15, v18, v19
  ds_write_b64 v12, v[14:15] offset:0
  s_mov_b32 s60, 4
  s_sub_u32 s53, s5, 1
  s_cmp_gt_u32 s53, 1
  s_cbranch_scc1 L_sig
  v_lshrrev_b32 v2, 3, v1
  v_and_b32 v3, 6, v2
  v_xor_b32 v3, v3, v1
  v_mul_u32_u24 v2, 6144, v2
  v_and_b32 v3, 7, v3
  v_lshl_add_u32 v2, v3, 4, v2
  s_mul_i32 s49, s53, 1572864
  s_lshl_b32 s50, s53, 15
  s_add_u32 s49, s49, s48
  s_add_u32 s50, s50, 18432
  s_add_u32 s51, s50, 32768
L_dma_16:
  s_mov_b32 m0, s50
  s_add_u32 s50, s50, 1024
  buffer_load_dwordx4 v2, s[44:47], s49 offen nt lds
  s_add_u32 s49, s49, 49152
  s_waitcnt vmcnt(3)
  s_cmp_lt_u32 s50, s51
  s_cbranch_scc1 L_dma_16
L_dmae_17:
  s_branch L_sig
L_r_wo:
  s_lshl_b32 s48, s8, 19
  s_lshl_b32 s49, s61, 7
  s_add_u32 s48, s48, s49
  s_lshr_b32 s58, s8, 1
  s_lshl_b32 s58, s58, 14
  s_and_b32 s49, s8, 1
  s_lshl_b32 s49, s49, 12
  s_add_u32 s58, s58, s49
  s_lshl_b32 s49, s61, 9
  s_add_u32 s58, s58, s49
  s_add_u32 s58, s58, 262144
  s_mov_b32 s44, s24
  s_mov_b32 s45, s25
  s_mov_b32 s46, 4194304
  s_mov_b32 s47, 0x20000
  s_waitcnt lgkmcnt(0)
  s_mul_i32 s74, s74, 0x9e3779b1
  s_add_u32 s74, s74, 0x7f4a7c15
  s_add_u32 s76, s76, s74
  s_cmp_lg_u32 s5, 3
  s_cbranch_scc1 L_sig_18
  s_lshl_b32 s56, s8, 5
  s_add_u32 s56, s56, s61
  s_lshl_b32 s56, s56, 2
  v_mov_b32 v8, s56
  v_mov_b32 v9, s76
  s_mov_b64 exec, 1
  global_store_dword v8, v9, s[42:43] offset:1024 sc1
  s_mov_b64 exec, -1
L_sig_18:
  s_mov_b32 s60, 1
  s_sub_u32 s53, s5, 1
  s_cmp_gt_u32 s53, 1
  s_cbranch_scc1 L_sig
  v_lshrrev_b32 v2, 3, v1
  v_and_b32 v3, 6, v2
  v_xor_b32 v3, v3, v1
  v_mul_u32_u24 v2, 1024, v2
  v_and_b32 v3, 7, v3
  v_lshl_add_u32 v2, v3, 4, v2
  s_mul_i32 s49, s53, 262144
  s_lshl_b32 s50, s53, 15
  s_add_u32 s49, s49, s48
  s_add_u32 s50, s50, 18432
  s_add_u32 s51, s50, 32768
L_dma_19:
  s_mov_b32 m0, s50
  s_add_u32 s50, s50, 1024
  buffer_load_dwordx4 v2, s[44:47], s49 offen nt lds
  s_add_u32 s49, s49, 8192
  s_waitcnt vmcnt(3)
  s_cmp_lt_u32 s50, s51
  s_cbranch_scc1 L_dma_19
L_dmae_20:
  s_branch L_sig
L_r_f1:
  s_lshl_b32 s48, s61, 6
  s_lshl_b32 s58, s61, 7
  s_add_u32 s58, s58, 2097152
  s_waitcnt lgkmcnt(0)
  s_mul_i32 s74, s74, 0x9e3779b1
  s_add_u32 s74, s74, 0x7f4a7c15
  s_add_u32 s76, s76, s74
  s_cmp_lt_u32 s5, 2
  s_cselect_b32 s44, s28, s30
  s_cselect_b32 s45, s29, s31
  s_mov_b32 s46, 1409024
  s_mov_b32 s47, 0x20000
  s_mov_b32 s60, 2
  s_sub_u32 s53, s5, 1
  s_cmp_gt_u32 s53, 1
  s_cbranch_scc1 L_sig
  s_and_b32 s54, s61, 1
  v_lshrrev_b32 v2, 2, v1
  v_mul_u32_u24 v2, 5504, v2
  s_and_b32 s49, s5, 2
  s_or_b32 s49, s49, s54
  v_xor_b32 v3, s49, v1
  v_and_b32 v3, 3, v3
  v_lshl_add_u32 v2, v3, 4, v2
  s_mul_i32 s49, s54, 2752
  s_add_u32 s49, s49, s48
  s_lshl_b32 s50, s53, 15
  s_lshl_b32 s54, s54, 14
  s_add_u32 s50, s50, s54
  s_add_u32 s50, s50, 18432
  s_add_u32 s51, s50, 16384
L_dma_21:
  s_mov_b32 m0, s50
  s_add_u32 s50, s50, 1024
  buffer_load_dwordx4 v2, s[44:47], s49 offen  lds
  s_add_u32 s49, s49, 88064
  s_waitcnt vmcnt(3)
  s_cmp_lt_u32 s50, s51
  s_cbranch_scc1 L_dma_21
L_dmae_22:
  s_andn2_b32 s54, 1, s61
  v_lshrrev_b32 v2, 2, v1
  v_mul_u32_u24 v2, 5504, v2
  s_and_b32 s49, s5, 2
  s_or_b32 s49, s49, s54
  v_xor_b32 v3, s49, v1
  v_and_b32 v3, 3, v3
  v_lshl_add_u32 v2, v3, 4, v2
  s_mul_i32 s49, s54, 2752
  s_add_u32 s49, s49, s48
  s_lshl_b32 s50, s53, 15
  s_lshl_b32 s54, s54, 14
  s_add_u32 s50, s50, s54
  s_add_u32 s50, s50, 18432
  s_add_u32 s51, s50, 16384
L_dma_23:
  s_mov_b32 m0, s50
  s_add_u32 s50, s50, 1024
  buffer_load_dwordx4 v2, s[44:47], s49 offen nt lds
  s_add_u32 s49, s49, 88064
  s_waitcnt vmcnt(3)
  s_cmp_lt_u32 s50, s51
  s_cbranch_scc1 L_dma_23
L_dmae_24:
  s_mov_b32 s44, s32
  s_mov_b32 s45, s33
  s_mov_b32 s46, 1409024
  s_mov_b32 s47, 0x20000
  v_lshlrev_b32 v2, 4, v1
  s_lshl_b32 s49, s61, 1
  s_add_u32 s49, s49, s53
  s_lshl_b32 s49, s49, 14
  s_mul_i32 s50, s53, 16896
  s_add_u32 s50, s50, 104448
  s_add_u32 s51, s50, 16896
L_dma_25:
  s_mov_b32 m0, s50
  s_add_u32 s50, s50, 1056
  buffer_load_dwordx4 v2, s[44:47], s49 offen nt lds
  s_add_u32 s49, s49, 1024
  s_waitcnt vmcnt(5)
  s_cmp_lt_u32 s50, s51
  s_cbranch_scc1 L_dma_25
L_dmae_26:
  s_branch L_sig
L_r_f2:
  s_mov_b32 s60, 3
  s_sub_u32 s53, s5, 1
  s_cmp_gt_u32 s53, 1
  s_cbranch_scc1 L_gs_27
  s_bfe_u32 s49, s15, 0x20006
  s_cmp_ge_u32 s53, s49
  s_cbranch_scc1 L_end
  s_mul_i32 s49, s53, 5
  s_add_u32 s49, s49, 8
  s_lshr_b32 s49, s15, s49
  s_and_b32 s4, s49, 3
  s_lshl_b32 s4, s4, 18
  s_bfe_u32 s11, s49, 0x30002
  s_lshl_b32 s11, s11, 10
  s_add_u32 s9, s53, 8
  s_mov_b32 s13, -1
  s_branch L_stream
L_gs_27:
  s_cmp_lg_u32 s5, 3
  s_cbranch_scc1 L_tch_28
  s_and_b32 s49, s61, 3
  s_lshl_b32 s49, s49, 7
  v_add_u32 v8, s49, v1
  s_bfe_u32 s50, s14, 0x50003
  s_cmp_eq_u32 s50, 0
  s_cbranch_scc1 L_tchm_29
  s_lshl_b32 s50, s50, 10
  s_sub_u32 s50, s50, 640
  v_mul_u32_u24 v9, 6144, v8
  v_add_u32 v9, s50, v9
  global_load_dword v167, v9, s[36:37]
  v_add_u32 v10, 393216, v9
  global_load_dword v167, v10, s[36:37]
L_tchm_29:
  s_lshl_b32 s50, s8, 10
  s_add_u32 s50, s50, 384
  v_mul_u32_u24 v9, 8192, v8
  v_add_u32 v9, s50, v9
  global_load_dword v167, v9, s[22:23]
  v_add_u32 v10, 524288, v9
  global_load_dword v167, v10, s[22:23]
L_tch_28:
L_light:
  s_waitcnt lgkmcnt(0)
  s_mul_i32 s74, s74, 0x9e3779b1
  s_add_u32 s74, s74, 0x7f4a7c15
  s_add_u32 s76, s76, s74
  s_cmp_eq_u32 s5, 3
  s_cbranch_scc1 L_lt3
  s_bfe_u32 s49, s15, 0x20006
  s_sub_u32 s49, 0, s49
  v_mov_b32 v4, s49
  v_lshlrev_b32 v5, 6, v4
  v_mul_i32_i24 v6, -28, v4
  s_mov_b64 exec, 1
  ds_add_u32 v38, v5 offset:6680
  ds_add_u32 v38, v5 offset:6672
  ds_add_u32 v38, v4 offset:6704
  ds_add_u32 v38, v4 offset:6708
  ds_add_u32 v38, v6 offset:6688
  s_mov_b64 exec, -1
  v_mov_b32 v9, 1
  s_mov_b64 exec, 1
  ds_add_u32 v38, v9 offset:6720
  s_mov_b64 exec, -1
  s_branch L_svc
L_lt3:
  s_mov_b32 s70, 0
L_sn_30:
  ds_read_b32 v9, v38 offset:6720
  s_waitcnt lgkmcnt(0)
  v_cmp_gt_u32 vcc, 0x1, v9
  s_cmp_eq_u64 vcc, 0
  s_cbranch_scc1 L_snd_31
  s_sleep 2
  s_add_u32 s70, s70, 1
  s_cmp_lt_u32 s70, 2097152
  s_cbranch_scc1 L_sn_30
L_snd_31:
  s_branch L_svc
L_r_none:
  s_mov_b32 s60, 0
  s_sub_u32 s53, s5, 1
  s_cmp_gt_u32 s53, 1
  s_cbranch_scc1 L_gs_32
  s_bfe_u32 s49, s15, 0x20006
  s_cmp_ge_u32 s53, s49
  s_cbranch_scc1 L_end
  s_mul_i32 s49, s53, 5
  s_add_u32 s49, s49, 8
  s_lshr_b32 s49, s15, s49
  s_and_b32 s4, s49, 3
  s_lshl_b32 s4, s4, 18
  s_bfe_u32 s11, s49, 0x30002
  s_lshl_b32 s11, s11, 10
  s_add_u32 s9, s53, 8
  s_mov_b32 s13, -1
  s_branch L_stream
L_gs_32:
  s_branch L_light
L_sig:
  s_waitcnt vmcnt(0) lgkmcnt(0)
  v_mov_b32 v9, 1
  s_mov_b64 exec, 1
  ds_add_u32 v38, v9 offset:6720
  s_mov_b64 exec, -1
L_svc:
  s_cmp_eq_u32 s5, 3
  s_cbranch_scc1 L_svc3
  s_cmp_lg_u32 s5, 0
  s_cbranch_scc1 L_mid
  s_lshl_b32 s64, s6, 2
  s_add_u32 s64, s64, s7
  s_lshl_b32 s64, s64, 7
  s_add_u32 s64, s64, 65536
  v_mov_b32 v18, s64
  s_mov_b32 s70, 0
L_sn_33:
  ds_read_b64 v[8:9], v38 offset:6680
  s_waitcnt lgkmcnt(0)
  v_and_b32 v8, 0xffff, v8
  v_cmp_gt_u32 vcc, 0x280, v8
  s_cmp_eq_u64 vcc, 0
  s_cbranch_scc1 L_snd_34
  s_sleep 2
  s_add_u32 s70, s70, 1
  s_cmp_lt_u32 s70, 2097152
  s_cbranch_scc1 L_sn_33
L_snd_34:
  v_mov_b32 v8, v9
  v_mov_b32 v9, s74
  s_mov_b64 exec, 1
  global_store_dwordx2 v18, v[8:9], s[42:43] sc1
  s_mov_b64 exec, -1
  s_lshl_b32 s64, s8, 7
  s_load_dwordx8 s[20:27], s[42:43], s64 offset:1024 glc
  s_waitcnt lgkmcnt(0)
  s_xor_b32 s68, s20, s76
  s_xor_b32 s69, s21, s76
  s_or_b32 s68, s68, s69
  s_xor_b32 s69, s22, s76
  s_or_b32 s68, s68, s69
  s_xor_b32 s69, s23, s76
  s_or_b32 s68, s68, s69
  s_xor_b32 s69, s24, s76
  s_or_b32 s68, s68, s69
  s_xor_b32 s69, s25, s76
  s_or_b32 s68, s68, s69
  s_xor_b32 s69, s26, s76
  s_or_b32 s68, s68, s69
  s_xor_b32 s69, s27, s76
  s_or_b32 s68, s68, s69
  s_cselect_b32 s68, 0, 1
  v_mov_b32 v8, s68
  s_mov_b64 exec, 1
  ds_add_u32 v38, v8 offset:6712
  s_mov_b64 exec, -1
  s_branch L_mid
L_svc3:
  s_mov_b32 s70, 0
L_sn_35:
  ds_read_b32 v8, v38 offset:6680
  s_waitcnt lgkmcnt(0)
  v_cmp_gt_u32 vcc, 0x180, v8
  s_cmp_eq_u64 vcc, 0
  s_cbranch_scc1 L_snd_36
  s_sleep 4
  s_add_u32 s70, s70, 1
  s_cmp_lt_u32 s70, 2097152
  s_cbranch_scc1 L_sn_35
L_snd_36:
  s_lshl_b32 s64, s6, 9
  s_xor_b32 s54, s7, 1
  s_lshl_b32 s54, s54, 7
  s_add_u32 s54, s54, s64
  s_xor_b32 s55, s7, 2
  s_lshl_b32 s55, s55, 7
  s_add_u32 s55, s55, s64
  s_xor_b32 s56, s7, 3
  s_lshl_b32 s56, s56, 7
  s_add_u32 s56, s56, s64
  s_mov_b32 s70, 0
L_s3e:
  s_load_dwordx2 s[20:21], s[42:43], s54 offset:65536 glc
  s_load_dwordx2 s[24:25], s[42:43], s55 offset:65536 glc
  s_load_dwordx2 s[28:29], s[42:43], s56 offset:65536 glc
  s_waitcnt lgkmcnt(0)
  s_xor_b32 s68, s21, s74
  s_xor_b32 s69, s25, s74
  s_or_b32 s68, s68, s69
  s_xor_b32 s69, s29, s74
  s_or_b32 s68, s68, s69
  s_cbranch_scc0 L_s3ed
  s_sleep 2
  s_add_u32 s70, s70, 1
  s_cmp_lt_u32 s70, 262144
  s_cbranch_scc1 L_s3e
L_s3ed:
  v_mov_b32 v8, s20
  v_mov_b32 v10, s24
  v_mov_b32 v16, s28
  v_max3_f32 v18, v8, v10, v16
  v_mov_b32 v19, 0x10000
  v_med3_f32 v17, v8, v10, v16
  v_min3_f32 v16, v8, v10, v16
  s_mov_b64 exec, 1
  ds_write_b96 v38, v[16:18] offset:6736
  ds_add_u32 v38, v19 offset:6680
  s_mov_b64 exec, -1
L_mid:
  s_bfe_u32 s32, s74, 0x80000
  s_bfe_u32 s33, s74, 0x80008
  s_bfe_u32 s34, s74, 0x80010
  s_bfe_u32 s35, s74, 0x80018
  s_cmp_eq_u32 s60, 2
  s_cbranch_scc1 L_pre_f1
  s_cmp_eq_u32 s60, 3
  s_cbranch_scc1 L_pre_f2
  s_cmp_eq_u32 s60, 1
  s_cbranch_scc1 L_pre_wo
  s_cmp_lg_u32 s60, 4
  s_cbranch_scc1 L_svd
  v_and_b32 v13, 1, v1
  v_lshlrev_b32 v13, 6, v13
  v_lshrrev_b32 v3, 4, v1
  v_lshl_add_u32 v13, v3, 4, v13
  s_lshl_b32 s49, s5, 7
  s_add_u32 s49, s49, s58
  v_add_u32 v13, s49, v13
  v_and_b32 v14, 1, v1
  v_mul_u32_u24 v14, 1056, v14
  v_lshrrev_b32 v3, 4, v1
  v_lshl_add_u32 v14, v3, 4, v14
  v_lshrrev_b32 v2, 2, v1
  v_bfe_u32 v3, v1, 1, 1
  s_lshl_b32 s49, s5, 1
  v_or_b32 v3, s49, v3
  v_and_b32 v10, 6, v2
  v_xor_b32 v3, v3, v10
  v_lshlrev_b32 v2, 7, v2
  v_lshl_add_u32 v2, v3, 4, v2
  v_and_b32 v3, 1, v1
  v_lshl_add_u32 v2, v3, 3, v2
  v_add_u32 v2, 18432, v2
  s_mov_b32 s70, 0
L_sn_37:
  ds_read_b32 v9, v38 offset:6720
  s_waitcnt lgkmcnt(0)
  v_cmp_gt_u32 vcc, 0x4, v9
  s_cmp_eq_u64 vcc, 0
  s_cbranch_scc1 L_snd_38
  s_sleep 8
  s_add_u32 s70, s70, 1
  s_cmp_lt_u32 s70, 2097152
  s_cbranch_scc1 L_sn_37
L_snd_38:
  ds_read_b64_tr_b16 v[40:41], v2 offset:0
  ds_read_b64_tr_b16 v[42:43], v2 offset:2048
  ds_read_b128 v[104:107], v14 offset:0
  ds_read_b64_tr_b16 v[44:45], v2 offset:4096
  ds_read_b64_tr_b16 v[46:47], v2 offset:6144
  ds_read_b128 v[108:111], v14 offset:64
  ds_read_b64_tr_b16 v[48:49], v2 offset:8192
  ds_read_b64_tr_b16 v[50:51], v2 offset:10240
  ds_read_b128 v[112:115], v14 offset:128
  ds_read_b64_tr_b16 v[52:53], v2 offset:12288
  ds_read_b64_tr_b16 v[54:55], v2 offset:14336
  ds_read_b128 v[116:119], v14 offset:192
  ds_read_b64_tr_b16 v[56:57], v2 offset:16384
  ds_read_b64_tr_b16 v[58:59], v2 offset:18432
  ds_read_b128 v[120:123], v14 offset:256
  s_waitcnt lgkmcnt(12)
  v_mfma_f32_16x16x32_bf16 v[8:11], v[40:43], v[104:107], 0
  ds_read_b64_tr_b16 v[60:61], v2 offset:20480
  ds_read_b64_tr_b16 v[62:63], v2 offset:22528
  ds_read_b128 v[124:127], v14 offset:320
  s_waitcnt lgkmcnt(12)
  v_mfma_f32_16x16x32_bf16 v[8:11], v[44:47], v[108:111], v[8:11]
  ds_read_b64_tr_b16 v[64:65], v2 offset:24576
  ds_read_b64_tr_b16 v[66:67], v2 offset:26624
  ds_read_b128 v[128:131], v14 offset:384
  s_waitcnt lgkmcnt(12)
  v_mfma_f32_16x16x32_bf16 v[8:11], v[48:51], v[112:115], v[8:11]
  ds_read_b64_tr_b16 v[68:69], v2 offset:28672
  ds_read_b64_tr_b16 v[70:71], v2 offset:30720
  ds_read_b128 v[132:135], v14 offset:448
  s_waitcnt lgkmcnt(12)
  v_mfma_f32_16x16x32_bf16 v[8:11], v[52:55], v[116:119], v[8:11]
  ds_read_b64_tr_b16 v[72:73], v2 offset:32768
  ds_read_b64_tr_b16 v[74:75], v2 offset:34816
  ds_read_b128 v[136:139], v14 offset:512
  s_waitcnt lgkmcnt(12)
  v_mfma_f32_16x16x32_bf16 v[8:11], v[56:59], v[120:123], v[8:11]
  ds_read_b64_tr_b16 v[76:77], v2 offset:36864
  ds_read_b64_tr_b16 v[78:79], v2 offset:38912
  ds_read_b128 v[140:143], v14 offset:576
  s_waitcnt lgkmcnt(12)
  v_mfma_f32_16x16x32_bf16 v[8:11], v[60:63], v[124:127], v[8:11]
  ds_read_b64_tr_b16 v[80:81], v2 offset:40960
  ds_read_b64_tr_b16 v[82:83], v2 offset:43008
  ds_read_b128 v[144:147], v14 offset:640
  s_waitcnt lgkmcnt(12)
  v_mfma_f32_16x16x32_bf16 v[8:11], v[64:67], v[128:131], v[8:11]
  ds_read_b64_tr_b16 v[84:85], v2 offset:45056
  ds_read_b64_tr_b16 v[86:87], v2 offset:47104
  ds_read_b128 v[148:151], v14 offset:704
  s_waitcnt lgkmcnt(12)
  v_mfma_f32_16x16x32_bf16 v[8:11], v[68:71], v[132:135], v[8:11]
  ds_read_b64_tr_b16 v[88:89], v2 offset:49152
  ds_read_b64_tr_b16 v[90:91], v2 offset:51200
  ds_read_b128 v[152:155], v14 offset:768
  s_waitcnt lgkmcnt(12)
  v_mfma_f32_16x16x32_bf16 v[8:11], v[72:75], v[136:139], v[8:11]
  ds_read_b64_tr_b16 v[92:93], v2 offset:53248
  ds_read_b64_tr_b16 v[94:95], v2 offset:55296
  ds_read_b128 v[156:159], v14 offset:832
  s_waitcnt lgkmcnt(12)
  v_mfma_f32_16x16x32_bf16 v[8:11], v[76:79], v[140:143], v[8:11]
  ds_read_b64_tr_b16 v[96:97], v2 offset:57344
  ds_read_b64_tr_b16 v[98:99], v2 offset:59392
  ds_read_b128 v[160:163], v14 offset:896
  s_waitcnt lgkmcnt(12)
  v_mfma_f32_16x16x32_bf16 v[8:11], v[80:83], v[144:147], v[8:11]
  ds_read_b64_tr_b16 v[100:101], v2 offset:61440
  ds_read_b64_tr_b16 v[102:103], v2 offset:63488
  ds_read_b128 v[164:167], v14 offset:960
  s_waitcnt lgkmcnt(12)
  v_mfma_f32_16x16x32_bf16 v[8:11], v[84:87], v[148:151], v[8:11]
  s_waitcnt lgkmcnt(9)
  v_mfma_f32_16x16x32_bf16 v[8:11], v[88:91], v[152:155], v[8:11]
  s_waitcnt lgkmcnt(6)
  v_mfma_f32_16x16x32_bf16 v[8:11], v[92:95], v[156:159], v[8:11]
  s_waitcnt lgkmcnt(3)
  v_mfma_f32_16x16x32_bf16 v[8:11], v[96:99], v[160:163], v[8:11]
  s_waitcnt lgkmcnt(0)
  v_mfma_f32_16x16x32_bf16 v[8:11], v[100:103], v[164:167], v[8:11]
  s_nop 7
  v_cvt_pk_bf16_f32 v8, v8, v9
  v_cvt_pk_bf16_f32 v10, v10, v11
  v_mov_b32 v9, s74
  v_mov_b32 v11, s74
  s_mov_b32 exec_lo, 0x00030003
  s_mov_b32 exec_hi, 0x00030003
  global_store_dwordx4 v13, v[8:11], s[42:43] sc1
  s_mov_b64 exec, -1
  s_branch L_svd
L_pre_wo:
  s_mov_b32 s70, 0
L_sn_39:
  ds_read_b32 v9, v38 offset:6720
  s_waitcnt lgkmcnt(0)
  v_cmp_gt_u32 vcc, 0x4, v9
  s_cmp_eq_u64 vcc, 0
  s_cbranch_scc1 L_snd_40
  s_sleep 8
  s_add_u32 s70, s70, 1
  s_cmp_lt_u32 s70, 2097152
  s_cbranch_scc1 L_sn_39
L_snd_40:
  v_lshrrev_b32 v2, 2, v1
  v_bfe_u32 v3, v1, 1, 1
  s_lshl_b32 s49, s5, 1
  v_or_b32 v3, s49, v3
  v_and_b32 v10, 6, v2
  v_xor_b32 v3, v3, v10
  v_lshlrev_b32 v2, 7, v2
  v_lshl_add_u32 v2, v3, 4, v2
  v_and_b32 v3, 1, v1
  v_lshl_add_u32 v2, v3, 3, v2
  v_add_u32 v2, 18432, v2
  ds_read_b64_tr_b16 v[40:41], v2 offset:0
  ds_read_b64_tr_b16 v[42:43], v2 offset:2048
  ds_read_b64_tr_b16 v[44:45], v2 offset:4096
  ds_read_b64_tr_b16 v[46:47], v2 offset:6144
  ds_read_b64_tr_b16 v[48:49], v2 offset:8192
  ds_read_b64_tr_b16 v[50:51], v2 offset:10240
  ds_read_b64_tr_b16 v[52:53], v2 offset:12288
  ds_read_b64_tr_b16 v[54:55], v2 offset:14336
  ds_read_b64_tr_b16 v[56:57], v2 offset:16384
  ds_read_b64_tr_b16 v[58:59], v2 offset:18432
  ds_read_b64_tr_b16 v[60:61], v2 offset:20480
  ds_read_b64_tr_b16 v[62:63], v2 offset:22528
  s_waitcnt lgkmcnt(10)
  ds_read_b64_tr_b16 v[64:65], v2 offset:24576
  ds_read_b64_tr_b16 v[66:67], v2 offset:26624
  s_waitcnt lgkmcnt(10)
  ds_read_b64_tr_b16 v[68:69], v2 offset:28672
  ds_read_b64_tr_b16 v[70:71], v2 offset:30720
  s_waitcnt lgkmcnt(10)
  ds_read_b64_tr_b16 v[72:73], v2 offset:32768
  ds_read_b64_tr_b16 v[74:75], v2 offset:34816
  s_waitcnt lgkmcnt(10)
  ds_read_b64_tr_b16 v[76:77], v2 offset:36864
  ds_read_b64_tr_b16 v[78:79], v2 offset:38912
  s_waitcnt lgkmcnt(10)
  ds_read_b64_tr_b16 v[80:81], v2 offset:40960
  ds_read_b64_tr_b16 v[82:83], v2 offset:43008
  s_waitcnt lgkmcnt(10)
  ds_read_b64_tr_b16 v[84:85], v2 offset:45056
  ds_read_b64_tr_b16 v[86:87], v2 offset:47104
  s_waitcnt lgkmcnt(10)
  ds_read_b64_tr_b16 v[88:89], v2 offset:49152
  ds_read_b64_tr_b16 v[90:91], v2 offset:51200
  s_waitcnt lgkmcnt(10)
  ds_read_b64_tr_b16 v[92:93], v2 offset:53248
  ds_read_b64_tr_b16 v[94:95], v2 offset:55296
  s_waitcnt lgkmcnt(10)
  ds_read_b64_tr_b16 v[96:97], v2 offset:57344
  ds_read_b64_tr_b16 v[98:99], v2 offset:59392
  s_waitcnt lgkmcnt(10)
  ds_read_b64_tr_b16 v[100:101], v2 offset:61440
  ds_read_b64_tr_b16 v[102:103], v2 offset:63488
  s_waitcnt lgkmcnt(10)
  s_waitcnt lgkmcnt(0)
  s_lshl_b32 s49, s8, 2
  s_add_u32 s49, s49, s5
  s_lshl_b32 s49, s49, 11
  s_add_u32 s49, s49, 131072
  v_lshrrev_b32 v12, 5, v1
  v_and_b32 v16, 31, v1
  v_lshlrev_b32 v15, 16, v12
  v_lshl_add_u32 v15, v16, 4, v15
  v_add_u32 v15, s49, v15
  v_mul_u32_u24 v12, 1056, v12
  v_bfe_u32 v16, v1, 3, 2
  v_lshl_add_u32 v12, v16, 6, v12
  v_and_b32 v16, 3, v1
  v_lshl_add_u32 v12, v16, 4, v12
  v_bfe_u32 v16, v1, 2, 1
  v_lshl_add_u32 v12, v16, 3, v12
  s_lshl_b32 s49, s5, 8
  v_add_u32 v12, s49, v12
  v_and_b32 v14, 1, v1
  v_mul_u32_u24 v14, 1056, v14
  v_lshrrev_b32 v3, 4, v1
  v_lshl_add_u32 v14, v3, 4, v14
  v_and_b32 v13, 1, v1
  v_lshlrev_b32 v13, 6, v13
  v_lshrrev_b32 v3, 4, v1
  v_lshl_add_u32 v13, v3, 4, v13
  s_lshl_b32 s49, s5, 7
  s_add_u32 s49, s49, s58
  v_add_u32 v13, s49, v13
  v_bfe_u32 v3, v1, 1, 1
  v_lshl_add_u32 v13, v3, 13, v13
  v_mov_b32 v36, 0xff
  s_branch L_svd
L_pre_f1:
  v_mov_b32 v37, v13
  v_lshlrev_b32 v15, 4, v0
  v_add_u32 v39, 16384, v15
  v_add_u32 v15, 266240, v15
  s_sub_u32 s59, s76, s74
  s_xor_b32 s59, s59, 8
  s_and_b32 s59, s59, 4
  s_lshl_b32 s59, s59, 11
  s_mov_b32 s59, 0
  v_add_u32 v15, s59, v15
  v_lshrrev_b32 v5, 2, v0
  v_lshlrev_b32 v5, 3, v5
  v_add_u32 v5, 7424, v5
  v_lshlrev_b32 v7, 3, v1
  v_add_u32 v7, 7424, v7
  v_and_b32 v14, 7, v1
  v_mul_u32_u24 v14, 1056, v14
  v_lshrrev_b32 v3, 4, v1
  v_lshl_add_u32 v14, v3, 4, v14
  v_bfe_u32 v6, v1, 2, 2
  v_lshl_add_u32 v6, v3, 3, v6
  v_mul_u32_u24 v6, 1056, v6
  v_and_b32 v8, 3, v1
  v_lshl_add_u32 v6, v8, 3, v6
  s_lshl_b32 s49, s5, 8
  s_add_u32 s49, s49, 104448
  v_add_u32 v6, s49, v6
  v_lshlrev_b32 v10, 3, v0
  v_add_u32 v10, 138240, v10
  v_mov_b32 v8, 0
  v_mov_b32 v9, 0
  ds_write_b64 v10, v[8:9]
  v_and_b32 v13, 1, v1
  v_lshlrev_b32 v13, 6, v13
  v_lshrrev_b32 v3, 4, v1
  v_lshl_add_u32 v13, v3, 4, v13
  s_lshl_b32 s49, s5, 17
  s_add_u32 s49, s49, s58
  v_add_u32 v13, s49, v13
  v_bfe_u32 v3, v1, 1, 3
  v_lshl_add_u32 v13, v3, 14, v13
  v_lshrrev_b32 v2, 3, v1
  v_lshlrev_b32 v2, 6, v2
  v_bfe_u32 v3, v1, 2, 1
  v_lshl_add_u32 v2, v3, 14, v2
  v_and_b32 v8, 2, v1
  v_or_b32 v3, v3, v8
  v_xor_b32 v3, s5, v3
  v_lshl_add_u32 v2, v3, 4, v2
  v_lshl_add_u32 v2, v8, 14, v2
  v_and_b32 v3, 1, v1
  v_lshl_add_u32 v2, v3, 3, v2
  v_add_u32 v2, 18432, v2
  s_branch L_svd
L_pre_f2:
  v_bfe_u32 v12, v1, 2, 1
  v_and_b32 v14, 3, v1
  s_lshl_b32 s49, s61, 5
  v_lshl_add_u32 v3, v14, 3, s49
  v_lshl_add_u32 v37, v12, 10, v3
  v_and_b32 v15, 7, v1
  s_lshl_b32 s49, s61, 7
  v_lshl_add_u32 v15, v15, 4, s49
  v_add_u32 v39, 16384, v15
  v_bfe_u32 v3, v1, 3, 1
  v_lshl_add_u32 v15, v3, 12, v15
  v_lshrrev_b32 v3, 4, v1
  v_lshl_add_u32 v15, v3, 14, v15
  v_add_u32 v15, 262144, v15
  s_sub_u32 s59, s76, s74
  s_xor_b32 s59, s59, 8
  s_and_b32 s59, s59, 4
  s_lshl_b32 s59, s59, 11
  s_mov_b32 s59, 0
  v_add_u32 v15, s59, v15
  s_lshl_b32 s49, s61, 14
  s_add_u32 s49, s49, s59
  s_add_u32 s49, s49, 2099200
  v_lshl_add_u32 v36, v1, 4, s49
L_svd:
  s_cmp_eq_u32 s5, 3
  s_cbranch_scc1 L_svd3
  s_cmp_lg_u32 s5, 0
  s_cbranch_scc1 L_tail
  s_lshl_b32 s64, s6, 2
  s_add_u32 s64, s64, s7
  s_lshl_b32 s64, s64, 7
  s_add_u32 s64, s64, 98304
  v_mov_b32 v18, s64
  s_mov_b32 s70, 0
L_sn_41:
  ds_read_b32 v8, v38 offset:6672
  s_waitcnt lgkmcnt(0)
  v_and_b32 v8, 0xffff, v8
  v_cmp_gt_u32 vcc, 0x280, v8
  s_cmp_eq_u64 vcc, 0
  s_cbranch_scc1 L_snd_42
  s_sleep 1
  s_add_u32 s70, s70, 1
  s_cmp_lt_u32 s70, 2097152
  s_cbranch_scc1 L_sn_41
L_snd_42:
  v_and_b32 v9, 15, v1
  v_lshlrev_b32 v9, 3, v9
  ds_read_b64 v[10:11], v9 offset:6912
  s_waitcnt lgkmcnt(0)
  v_mov_b32 v16, v10
  v_max_f32_dpp v8, v10, v10 quad_perm:[1,0,3,2] row_mask:0xf bank_mask:0xf
  s_nop 1
  v_max_f32_dpp v8, v8, v8 quad_perm:[2,3,0,1] row_mask:0xf bank_mask:0xf
  s_nop 1
  v_max_f32_dpp v8, v8, v8 row_half_mirror row_mask:0xf bank_mask:0xf
  s_nop 1
  v_max_f32_dpp v8, v8, v8 row_mirror row_mask:0xf bank_mask:0xf
  v_sub_f32 v9, v10, v8
  v_mul_f32 v9, 0x3fb8aa3b, v9
  v_exp_f32 v9, v9
  s_nop 0
  v_mul_f32 v10, v9, v11
  s_nop 1
  v_add_f32_dpp v10, v10, v10 quad_perm:[1,0,3,2] row_mask:0xf bank_mask:0xf
  s_nop 1
  v_add_f32_dpp v10, v10, v10 quad_perm:[2,3,0,1] row_mask:0xf bank_mask:0xf
  s_nop 1
  v_add_f32_dpp v10, v10, v10 row_half_mirror row_mask:0xf bank_mask:0xf
  s_nop 1
  v_add_f32_dpp v10, v10, v10 row_mirror row_mask:0xf bank_mask:0xf
  v_mov_b32 v9, s74
  v_mov_b32 v11, s76
  s_mov_b64 exec, 1
  global_store_dwordx4 v18, v[8:11], s[42:43] sc1
  ds_write_b32 v38, v8 offset:6848
  ds_write_b32 v38, v10 offset:6852
  s_mov_b64 exec, -1
  s_mov_b32 s70, 0
L_sn_43:
  ds_read_b32 v8, v38 offset:6672
  s_waitcnt lgkmcnt(0)
  v_cmp_gt_u32 vcc, 0x10000, v8
  s_cmp_eq_u64 vcc, 0
  s_cbranch_scc1 L_snd_44
  s_sleep 1
  s_add_u32 s70, s70, 1
  s_cmp_lt_u32 s70, 2097152
  s_cbranch_scc1 L_sn_43
L_snd_44:
  v_and_b32 v9, 3, v1
  v_lshlrev_b32 v9, 3, v9
  ds_read_b64 v[10:11], v9 offset:6848
  s_waitcnt lgkmcnt(0)
  v_max_f32_dpp v8, v10, v10 quad_perm:[1,0,3,2] row_mask:0xf bank_mask:0xf
  s_nop 1
  v_max_f32_dpp v8, v8, v8 quad_perm:[2,3,0,1] row_mask:0xf bank_mask:0xf
  v_sub_f32 v9, v10, v8
  v_mul_f32 v9, 0x3fb8aa3b, v9
  v_exp_f32 v9, v9
  s_nop 0
  v_mul_f32 v10, v9, v11
  s_nop 1
  v_add_f32_dpp v10, v10, v10 quad_perm:[1,0,3,2] row_mask:0xf bank_mask:0xf
  s_nop 1
  v_add_f32_dpp v10, v10, v10 quad_perm:[2,3,0,1] row_mask:0xf bank_mask:0xf
  v_sub_f32 v9, v16, v8
  v_rcp_f32 v10, v10
  v_mul_f32 v9, 0x3fb8aa3b, v9
  v_exp_f32 v9, v9
  v_lshlrev_b32 v8, 2, v1
  v_mul_f32 v9, v9, v10
  s_mov_b64 exec, 0xffff
  ds_write_b32 v8, v9 offset:6784
  s_mov_b64 exec, -1
  ds_write_b32 v38, v38 offset:6656
  s_mov_b32 s70, 0
L_sn_45:
  ds_read_b32 v8, v38 offset:6704
  s_waitcnt lgkmcnt(0)
  v_cmp_gt_u32 vcc, 0xa, v8
  s_cmp_eq_u64 vcc, 0
  s_cbranch_scc1 L_snd_46
  s_sleep 1
  s_add_u32 s70, s70, 1
  s_cmp_lt_u32 s70, 2097152
  s_cbranch_scc1 L_sn_45
L_snd_46:
  v_lshlrev_b32 v136, 3, v1
  ds_read_b32 v139, v38 offset:6712
  ds_read_b128 v[124:127], v38 offset:6784
  ds_read_b128 v[128:131], v38 offset:6800
  ds_read_b128 v[132:135], v38 offset:6816
  ds_read_b64 v[104:105], v136 offset:13056
  ds_read_b64 v[106:107], v136 offset:13568
  ds_read_b64 v[108:109], v136 offset:14080
  ds_read_b64 v[110:111], v136 offset:14592
  ds_read_b64 v[112:113], v136 offset:15104
  ds_read_b64 v[114:115], v136 offset:15616
  ds_read_b64 v[116:117], v136 offset:16128
  ds_read_b64 v[118:119], v136 offset:16640
  ds_read_b64 v[120:121], v136 offset:17152
  ds_read_b64 v[122:123], v136 offset:17664
  s_lshl_b32 s68, s6, 2
  s_add_u32 s68, s68, s7
  s_lshl_b32 s68, s68, 9
  s_add_u32 s68, s68, 131072
  v_add_u32 v136, s68, v136
  v_and_b32 v137, 1, v1
  v_lshlrev_b32 v137, 4, v137
  v_lshrrev_b32 v137, v137, s74
  v_lshrrev_b32 v138, 8, v137
  s_movk_i32 s69, 0xff
  s_waitcnt lgkmcnt(9)
  v_pk_mul_f32 v[104:105], v[104:105], v[124:125] op_sel:[0,0] op_sel_hi:[1,0]
  v_readfirstlane_b32 s75, v139
  s_waitcnt lgkmcnt(8)
  v_pk_mul_f32 v[106:107], v[106:107], v[124:125] op_sel:[0,1] op_sel_hi:[1,1]
  s_waitcnt lgkmcnt(7)
  v_pk_fma_f32 v[104:105], v[108:109], v[126:127], v[104:105] op_sel:[0,0,0] op_sel_hi:[1,0,1]
  s_waitcnt lgkmcnt(6)
  v_pk_fma_f32 v[106:107], v[110:111], v[126:127], v[106:107] op_sel:[0,1,0] op_sel_hi:[1,1,1]
  s_waitcnt lgkmcnt(5)
  v_pk_fma_f32 v[104:105], v[112:113], v[128:129], v[104:105] op_sel:[0,0,0] op_sel_hi:[1,0,1]
  s_waitcnt lgkmcnt(4)
  v_pk_fma_f32 v[106:107], v[114:115], v[128:129], v[106:107] op_sel:[0,1,0] op_sel_hi:[1,1,1]
  s_waitcnt lgkmcnt(3)
  v_pk_fma_f32 v[104:105], v[116:117], v[130:131], v[104:105] op_sel:[0,0,0] op_sel_hi:[1,0,1]
  s_waitcnt lgkmcnt(2)
  v_pk_fma_f32 v[106:107], v[118:119], v[130:131], v[106:107] op_sel:[0,1,0] op_sel_hi:[1,1,1]
  s_waitcnt lgkmcnt(1)
  v_pk_fma_f32 v[104:105], v[120:121], v[132:133], v[104:105] op_sel:[0,0,0] op_sel_hi:[1,0,1]
  s_waitcnt lgkmcnt(0)
  v_pk_fma_f32 v[106:107], v[122:123], v[132:133], v[106:107] op_sel:[0,1,0] op_sel_hi:[1,1,1]
  v_pk_add_f32 v[104:105], v[104:105], v[106:107]
  v_bfi_b32 v104, s69, v137, v104
  v_bfi_b32 v105, s69, v138, v105
  s_cmp_eq_u32 s75, 2
  s_cbranch_scc0 L_pf_47
  global_store_dwordx2 v136, v[104:105], s[42:43]
  s_branch L_pe_48
L_pf_47:
  global_store_dwordx2 v136, v[104:105], s[42:43] sc1
L_pe_48:
  s_cmp_eq_u32 s60, 1
  s_cbranch_scc1 L_tail
  s_waitcnt vmcnt(0)
  ds_write_b32 v38, v38 offset:6700
  s_branch L_tail
L_svd3:
  s_mov_b32 s70, 0
L_sn_49:
  ds_read_b32 v8, v38 offset:6672
  s_waitcnt lgkmcnt(0)
  v_cmp_gt_u32 vcc, 0x180, v8
  s_cmp_eq_u64 vcc, 0
  s_cbranch_scc1 L_snd_50
  s_sleep 4
  s_add_u32 s70, s70, 1
  s_cmp_lt_u32 s70, 2097152
  s_cbranch_scc1 L_sn_49
L_snd_50:
  s_lshl_b32 s64, s6, 9
  s_xor_b32 s54, s7, 1
  s_lshl_b32 s54, s54, 7
  s_add_u32 s54, s54, s64
  s_xor_b32 s55, s7, 2
  s_lshl_b32 s55, s55, 7
  s_add_u32 s55, s55, s64
  s_xor_b32 s56, s7, 3
  s_lshl_b32 s56, s56, 7
  s_add_u32 s56, s56, s64
  s_mov_b32 s70, 0
L_s3p:
  s_load_dwordx4 s[20:23], s[42:43], s54 offset:98304 glc
  s_load_dwordx4 s[24:27], s[42:43], s55 offset:98304 glc
  s_load_dwordx4 s[28:31], s[42:43], s56 offset:98304 glc
  s_waitcnt lgkmcnt(0)
  s_xor_b32 s68, s21, s74
  s_sub_u32 s69, s23, s74
  s_lshr_b32 s69, s69, 4
  s_or_b32 s68, s68, s69
  s_xor_b32 s69, s25, s74
  s_or_b32 s68, s68, s69
  s_sub_u32 s69, s27, s74
  s_lshr_b32 s69, s69, 4
  s_or_b32 s68, s68, s69
  s_xor_b32 s69, s29, s74
  s_or_b32 s68, s68, s69
  s_sub_u32 s69, s31, s74
  s_lshr_b32 s69, s69, 4
  s_or_b32 s68, s68, s69
  s_cbranch_scc0 L_s3pd
  s_sleep 2
  s_add_u32 s70, s70, 1
  s_cmp_lt_u32 s70, 262144
  s_cbranch_scc1 L_s3p
L_s3pd:
  v_mov_b32 v8, s20
  v_mov_b32 v10, s24
  v_mov_b32 v16, s28
  v_max3_f32 v18, v8, v10, v16
  v_mov_b32 v19, 0x10000
  v_mov_b32 v9, s22
  v_mov_b32 v11, s26
  v_mov_b32 v17, s30
  s_xor_b32 s68, s23, s76
  s_xor_b32 s69, s27, s76
  s_or_b32 s68, s68, s69
  s_xor_b32 s69, s31, s76
  s_or_b32 s68, s68, s69
  s_cselect_b32 s68, 0, 1
  v_mov_b32 v3, s68
  s_mov_b64 exec, 1
  ds_add_u32 v38, v3 offset:6712
  ds_max_f32 v38, v18 offset:6676
  ds_write_b64 v38, v[8:9] offset:6856
  ds_write_b64 v38, v[10:11] offset:6864
  ds_write_b64 v38, v[16:17] offset:6872
  ds_add_u32 v38, v19 offset:6672
  s_mov_b64 exec, -1
L_tail:
  s_cmp_eq_u32 s60, 0
  s_cbranch_scc1 L_fin
  s_cmp_lg_u32 s60, 4
  s_cbranch_scc1 L_tl2
  s_branch L_fin
L_tl2:
  s_mov_b32 s70, 0
L_sn_51:
  ds_read_b32 v8, v38 offset:6704
  s_waitcnt lgkmcnt(0)
  v_cmp_gt_u32 vcc, 0xa, v8
  s_cmp_eq_u64 vcc, 0
  s_cbranch_scc1 L_snd_52
  s_sleep 8
  s_add_u32 s70, s70, 1
  s_cmp_lt_u32 s70, 2097152
  s_cbranch_scc1 L_sn_51
L_snd_52:
  s_cmp_eq_u32 s60, 1
  s_cbranch_scc1 L_t_wo0
  s_cmp_eq_u32 s60, 3
  s_cbranch_scc1 L_t_f2
  s_mov_b32 s70, 0
L_sn_53:
  ds_read_b32 v9, v38 offset:6720
  s_waitcnt lgkmcnt(0)
  v_cmp_gt_u32 vcc, 0x4, v9
  s_cmp_eq_u64 vcc, 0
  s_cbranch_scc1 L_snd_54
  s_sleep 8
  s_add_u32 s70, s70, 1
  s_cmp_lt_u32 s70, 2097152
  s_cbranch_scc1 L_sn_53
L_snd_54:
  s_branch L_t_f1
L_t_wo0:
L_t_wo:
  s_mov_b64 s[20:21], -1
  s_mov_b64 s[22:23], -1
  s_mov_b64 s[24:25], -1
  s_mov_b64 s[26:27], -1
  s_mov_b64 exec, s[20:21]
  global_load_dwordx4 v[152:155], v15, s[42:43] offset:0 sc1
  s_mov_b64 exec, s[22:23]
  global_load_dwordx4 v[156:159], v15, s[42:43] offset:512 sc1
  s_mov_b64 exec, s[24:25]
  global_load_dwordx4 v[160:163], v15, s[42:43] offset:1024 sc1
  s_mov_b64 exec, s[26:27]
  global_load_dwordx4 v[164:167], v15, s[42:43] offset:1536 sc1
  s_mov_b64 exec, -1
  s_waitcnt vmcnt(0)
  s_mov_b32 s70, 0
  s_branch L_wo_c
L_wo_:
  s_mov_b64 exec, s[20:21]
  global_load_dwordx4 v[152:155], v15, s[42:43] offset:0 sc1
  s_mov_b64 exec, s[22:23]
  global_load_dwordx4 v[156:159], v15, s[42:43] offset:512 sc1
  s_mov_b64 exec, s[24:25]
  global_load_dwordx4 v[160:163], v15, s[42:43] offset:1024 sc1
  s_mov_b64 exec, s[26:27]
  global_load_dwordx4 v[164:167], v15, s[42:43] offset:1536 sc1
  s_mov_b64 exec, -1
  s_waitcnt vmcnt(0)
L_wo_c:
  v_xor_b32 v136, s32, v152
  v_xor_b32 v137, s33, v153
  v_xor_b32 v138, s34, v154
  v_xor_b32 v139, s35, v155
  v_xor_b32 v140, s32, v156
  v_xor_b32 v141, s33, v157
  v_xor_b32 v142, s34, v158
  v_xor_b32 v143, s35, v159
  v_xor_b32 v144, s32, v160
  v_xor_b32 v145, s33, v161
  v_xor_b32 v146, s34, v162
  v_xor_b32 v147, s35, v163
  v_xor_b32 v148, s32, v164
  v_xor_b32 v149, s33, v165
  v_xor_b32 v150, s34, v166
  v_xor_b32 v151, s35, v167
  v_or3_b32 v28, v136, v137, v138
  v_or3_b32 v29, v140, v141, v142
  v_or3_b32 v30, v144, v145, v146
  v_or3_b32 v31, v148, v149, v150
  v_or_b32 v28, v28, v139
  v_or_b32 v29, v29, v143
  v_or_b32 v30, v30, v147
  v_or_b32 v31, v31, v151
  v_cmp_ne_u32_sdwa s[20:21], v28, v38 src0_sel:BYTE_0 src1_sel:DWORD
  v_cmp_ne_u32_sdwa s[22:23], v29, v38 src0_sel:BYTE_0 src1_sel:DWORD
  v_cmp_ne_u32_sdwa s[24:25], v30, v38 src0_sel:BYTE_0 src1_sel:DWORD
  v_cmp_ne_u32_sdwa s[26:27], v31, v38 src0_sel:BYTE_0 src1_sel:DWORD
  v_or_b32 v136, 0x80, v136
  v_or_b32 v137, 0x80, v137
  v_or_b32 v138, 0x80, v138
  v_or_b32 v139, 0x80, v139
  v_or_b32 v140, 0x80, v140
  v_or_b32 v141, 0x80, v141
  v_or_b32 v142, 0x80, v142
  v_or_b32 v143, 0x80, v143
  v_or_b32 v144, 0x80, v144
  v_or_b32 v145, 0x80, v145
  v_or_b32 v146, 0x80, v146
  v_or_b32 v147, 0x80, v147
  v_or_b32 v148, 0x80, v148
  v_or_b32 v149, 0x80, v149
  v_or_b32 v150, 0x80, v150
  v_or_b32 v151, 0x80, v151
  v_pk_add_f32 v[16:17], v[136:137], v[144:145]
  v_pk_add_f32 v[18:19], v[138:139], v[146:147]
  v_pk_add_f32 v[20:21], v[140:141], v[148:149]
  v_pk_add_f32 v[22:23], v[142:143], v[150:151]
  v_pk_add_f32 v[16:17], v[16:17], v[20:21]
  v_pk_add_f32 v[18:19], v[18:19], v[22:23]
  s_mov_b64 vcc, s[20:21]
  s_or_b64 vcc, vcc, s[22:23]
  s_or_b64 vcc, vcc, s[24:25]
  s_or_b64 vcc, vcc, s[26:27]
  s_or_b32 s20, s20, 1
  s_or_b32 s22, s22, 1
  s_or_b32 s24, s24, 1
  s_or_b32 s26, s26, 1
  s_cmp_eq_u64 vcc, 0
  s_cbranch_scc1 L_wo_ok
  s_add_u32 s70, s70, 1
  s_cmp_lt_u32 s70, 262144
  s_cbranch_scc1 L_wo_
L_wo_ok:
  v_cvt_pk_bf16_f32 v8, v16, v17
  v_cvt_pk_bf16_f32 v9, v18, v19
  ds_write_b64 v12, v[8:9] offset:0
  s_add_u32 s77, s77, 4
  v_mov_b32 v10, 1
  s_mov_b64 exec, 1
  ds_add_u32 v38, v10 offset:6720
  s_mov_b64 exec, -1
  s_mov_b32 s70, 0
L_hy_55:
  ds_read_b32 v10, v38 offset:6720
  s_waitcnt lgkmcnt(0)
  v_cmp_gt_u32 vcc, s77, v10
  s_cmp_eq_u64 vcc, 0
  s_cbranch_scc1 L_hyd_56
  s_add_u32 s70, s70, 1
  s_cmp_lt_u32 s70, 2097152
  s_cbranch_scc1 L_hy_55
L_hyd_56:
  ds_write_b32 v38, v38 offset:6700
  ds_read_b128 v[104:107], v14 offset:0
  ds_read_b128 v[108:111], v14 offset:64
  ds_read_b128 v[112:115], v14 offset:128
  ds_read_b128 v[116:119], v14 offset:192
  ds_read_b128 v[120:123], v14 offset:256
  ds_read_b128 v[124:127], v14 offset:320
  ds_read_b128 v[128:131], v14 offset:384
  ds_read_b128 v[132:135], v14 offset:448
  ds_read_b128 v[136:139], v14 offset:512
  ds_read_b128 v[140:143], v14 offset:576
  ds_read_b128 v[144:147], v14 offset:640
  ds_read_b128 v[148:151], v14 offset:704
  s_waitcnt lgkmcnt(11)
  v_mfma_f32_16x16x32_bf16 v[8:11], v[40:43], v[104:107], 0
  s_waitcnt lgkmcnt(10)
  v_mfma_f32_16x16x32_bf16 v[8:11], v[44:47], v[108:111], v[8:11]
  ds_read_b128 v[104:107], v14 offset:768
  s_waitcnt lgkmcnt(10)
  v_mfma_f32_16x16x32_bf16 v[8:11], v[48:51], v[112:115], v[8:11]
  ds_read_b128 v[108:111], v14 offset:832
  s_waitcnt lgkmcnt(10)
  v_mfma_f32_16x16x32_bf16 v[8:11], v[52:55], v[116:119], v[8:11]
  ds_read_b128 v[112:115], v14 offset:896
  s_waitcnt lgkmcnt(10)
  v_mfma_f32_16x16x32_bf16 v[8:11], v[56:59], v[120:123], v[8:11]
  ds_read_b128 v[116:119], v14 offset:960
  s_waitcnt lgkmcnt(10)
  v_mfma_f32_16x16x32_bf16 v[8:11], v[60:63], v[124:127], v[8:11]
  s_waitcnt lgkmcnt(9)
  v_mfma_f32_16x16x32_bf16 v[8:11], v[64:67], v[128:131], v[8:11]
  s_waitcnt lgkmcnt(8)
  v_mfma_f32_16x16x32_bf16 v[8:11], v[68:71], v[132:135], v[8:11]
  s_waitcnt lgkmcnt(7)
  v_mfma_f32_16x16x32_bf16 v[8:11], v[72:75], v[136:139], v[8:11]
  s_waitcnt lgkmcnt(6)
  v_mfma_f32_16x16x32_bf16 v[8:11], v[76:79], v[140:143], v[8:11]
  s_waitcnt lgkmcnt(5)
  v_mfma_f32_16x16x32_bf16 v[8:11], v[80:83], v[144:147], v[8:11]
  s_waitcnt lgkmcnt(4)
  v_mfma_f32_16x16x32_bf16 v[8:11], v[84:87], v[148:151], v[8:11]
  s_waitcnt lgkmcnt(3)
  v_mfma_f32_16x16x32_bf16 v[8:11], v[88:91], v[104:107], v[8:11]
  s_waitcnt lgkmcnt(2)
  v_mfma_f32_16x16x32_bf16 v[8:11], v[92:95], v[108:111], v[8:11]
  s_waitcnt lgkmcnt(1)
  v_mfma_f32_16x16x32_bf16 v[8:11], v[96:99], v[112:115], v[8:11]
  s_waitcnt lgkmcnt(0)
  v_mfma_f32_16x16x32_bf16 v[8:11], v[100:103], v[116:119], v[8:11]
  s_nop 7
  v_bfi_b32 v8, v36, s32, v8
  v_bfi_b32 v9, v36, s33, v9
  v_bfi_b32 v10, v36, s34, v10
  v_bfi_b32 v11, v36, s35, v11
  s_mov_b32 exec_lo, 0x00030003
  s_mov_b32 exec_hi, 0x00030003
  global_store_dwordx4 v13, v[8:11], s[42:43] sc1
  s_branch L_fin
L_t_f1:
  ds_read_b64_tr_b16 v[40:41], v2 offset:0
  ds_read_b64_tr_b16 v[42:43], v2 offset:512
  ds_read_b64_tr_b16 v[44:45], v2 offset:1024
  ds_read_b64_tr_b16 v[46:47], v2 offset:1536
  ds_read_b64_tr_b16 v[48:49], v2 offset:2048
  ds_read_b64_tr_b16 v[50:51], v2 offset:2560
  ds_read_b64_tr_b16 v[52:53], v2 offset:3072
  ds_read_b64_tr_b16 v[54:55], v2 offset:3584
  ds_read_b64_tr_b16 v[56:57], v2 offset:4096
  ds_read_b64_tr_b16 v[58:59], v2 offset:4608
  ds_read_b64_tr_b16 v[60:61], v2 offset:5120
  ds_read_b64_tr_b16 v[62:63], v2 offset:5632
  s_waitcnt lgkmcnt(10)
  ds_read_b64_tr_b16 v[64:65], v2 offset:6144
  ds_read_b64_tr_b16 v[66:67], v2 offset:6656
  s_waitcnt lgkmcnt(10)
  ds_read_b64_tr_b16 v[68:69], v2 offset:7168
  ds_read_b64_tr_b16 v[70:71], v2 offset:7680
  s_waitcnt lgkmcnt(10)
  ds_read_b64_tr_b16 v[72:73], v2 offset:8192
  ds_read_b64_tr_b16 v[74:75], v2 offset:8704
  s_waitcnt lgkmcnt(10)
  ds_read_b64_tr_b16 v[76:77], v2 offset:9216
  ds_read_b64_tr_b16 v[78:79], v2 offset:9728
  s_waitcnt lgkmcnt(10)
  ds_read_b64_tr_b16 v[80:81], v2 offset:10240
  ds_read_b64_tr_b16 v[82:83], v2 offset:10752
  s_waitcnt lgkmcnt(10)
  ds_read_b64_tr_b16 v[84:85], v2 offset:11264
  ds_read_b64_tr_b16 v[86:87], v2 offset:11776
  s_waitcnt lgkmcnt(10)
  ds_read_b64_tr_b16 v[88:89], v2 offset:12288
  ds_read_b64_tr_b16 v[90:91], v2 offset:12800
  s_waitcnt lgkmcnt(10)
  ds_read_b64_tr_b16 v[92:93], v2 offset:13312
  ds_read_b64_tr_b16 v[94:95], v2 offset:13824
  s_waitcnt lgkmcnt(10)
  ds_read_b64_tr_b16 v[96:97], v2 offset:14336
  ds_read_b64_tr_b16 v[98:99], v2 offset:14848
  s_waitcnt lgkmcnt(10)
  ds_read_b64_tr_b16 v[100:101], v2 offset:15360
  ds_read_b64_tr_b16 v[102:103], v2 offset:15872
  s_waitcnt lgkmcnt(10)
  s_waitcnt lgkmcnt(0)
  v_add_u32 v4, 16384, v15
  v_add_u32 v0, 32768, v15
  v_add_u32 v36, 49152, v15
  global_load_dwordx2 v[8:9], v37, s[16:17]
  s_mov_b32 s70, 0
L_pg_57:
  global_load_dwordx4 v[136:139], v39, s[42:43] offset:-4096 sc1
  global_load_dwordx4 v[140:143], v39, s[42:43] offset:0 sc1
  v_add_u32 v3, 4096, v39
  global_load_dwordx4 v[144:147], v3, s[42:43] sc1
  s_waitcnt vmcnt(0)
  s_mov_b64 vcc, 0
  v_cmp_ne_u32 s[68:69], s74, v137
  s_or_b64 vcc, vcc, s[68:69]
  v_cmp_ne_u32 s[68:69], s74, v139
  s_or_b64 vcc, vcc, s[68:69]
  v_cmp_ne_u32 s[68:69], s74, v141
  s_or_b64 vcc, vcc, s[68:69]
  v_cmp_ne_u32 s[68:69], s74, v143
  s_or_b64 vcc, vcc, s[68:69]
  v_cmp_ne_u32 s[68:69], s74, v145
  s_or_b64 vcc, vcc, s[68:69]
  v_cmp_ne_u32 s[68:69], s74, v147
  s_or_b64 vcc, vcc, s[68:69]
  s_cmp_eq_u64 vcc, 0
  s_cbranch_scc1 L_pge_58
  s_sleep 8
  s_add_u32 s70, s70, 1
  s_cmp_lt_u32 s70, 262144
  s_cbranch_scc1 L_pg_57
L_pge_58:
  v_and_b32 v39, 1, v1
  v_lshlrev_b32 v39, 6, v39
  v_add_u32 v39, 139136, v39
  v_lshrrev_b32 v3, 4, v1
  v_lshl_add_u32 v37, v3, 4, v39
  v_bfe_u32 v3, v1, 1, 3
  v_lshlrev_b32 v3, 7, v3
  v_sub_u32 v37, v37, v3
  v_bfe_u32 v3, v1, 4, 1
  v_lshl_add_u32 v39, v3, 3, v39
  v_lshrrev_b32 v3, 5, v1
  v_lshl_add_u32 v39, v3, 2, v39
  s_lshl_b32 s49, s5, 4
  v_add_u32 v39, s49, v39
  v_lshlrev_b32 v16, 16, v8
  v_and_b32 v17, s73, v8
  v_lshlrev_b32 v18, 16, v9
  v_and_b32 v19, s73, v9
  v_lshlrev_b32 v20, 16, v136
  v_and_b32 v21, s73, v136
  v_lshlrev_b32 v22, 16, v138
  v_and_b32 v23, s73, v138
  v_lshlrev_b32 v28, 16, v144
  v_and_b32 v29, s73, v144
  v_lshlrev_b32 v30, 16, v146
  v_and_b32 v31, s73, v146
  v_add_f32 v28, 1.0, v28
  v_add_f32 v29, 1.0, v29
  v_add_f32 v30, 1.0, v30
  v_add_f32 v31, 1.0, v31
  v_cvt_pk_bf16_f32 v8, v28, v29
  v_cvt_pk_bf16_f32 v9, v30, v31
  v_mov_b32 v141, v142
  ds_write_b64 v12, v[8:9] offset:2112
  ds_write_b64 v12, v[140:141] offset:4224
  v_cvt_pk_bf16_f32 v28, 0, v28
  v_cvt_pk_bf16_f32 v29, 0, v29
  v_cvt_pk_bf16_f32 v30, 0, v30
  v_cvt_pk_bf16_f32 v31, 0, v31
  v_mul_f32 v24, v20, v28
  v_mul_f32 v25, v21, v29
  v_mul_f32 v26, v22, v30
  v_mul_f32 v27, v23, v31
  v_mul_f32 v28, v16, v28
  v_mul_f32 v29, v17, v29
  v_mul_f32 v30, v18, v30
  v_mul_f32 v31, v19, v31
  s_waitcnt lgkmcnt(0)
  ds_read_b32 v8, v38 offset:6696
  s_waitcnt lgkmcnt(0)
  v_subrev_u32 v8, 1024, v8
  v_mul_i32_i24 v8, 8, v8
  v_ashrrev_i32 v8, 4, v8
  v_add_u32 v9, 1032, v8
  s_mov_b32 s70, 0
L_af_59:
  ds_read_b32 v8, v38 offset:6696
  s_waitcnt lgkmcnt(0)
  v_cmp_lt_u32 vcc, v9, v8
  s_cmp_eq_u64 vcc, 0
  s_cbranch_scc1 L_afd_60
  s_sleep 4
  s_add_u32 s70, s70, 1
  s_cmp_lt_u32 s70, 2097152
  s_cbranch_scc1 L_af_59
L_afd_60:
  s_mov_b32 s70, 0
  s_mov_b32 s71, 15
L_f1_p:
  s_add_u32 s70, s70, 1
  s_cmp_ge_u32 s70, 262144
  s_cbranch_scc1 L_f1_ok
  s_bitcmp1_b32 s71, 0
  s_cbranch_scc0 L_fl_61
  global_load_dwordx4 v[104:107], v15, s[42:43] offset:-4096 sc1
  global_load_dwordx4 v[108:111], v15, s[42:43] offset:0 sc1
L_fl_61:
  s_bitcmp1_b32 s71, 1
  s_cbranch_scc0 L_fl_62
  global_load_dwordx4 v[112:115], v4, s[42:43] offset:-4096 sc1
  global_load_dwordx4 v[116:119], v4, s[42:43] offset:0 sc1
L_fl_62:
  s_bitcmp1_b32 s71, 2
  s_cbranch_scc0 L_fl_63
  global_load_dwordx4 v[120:123], v0, s[42:43] offset:-4096 sc1
  global_load_dwordx4 v[124:127], v0, s[42:43] offset:0 sc1
L_fl_63:
  s_bitcmp1_b32 s71, 3
  s_cbranch_scc0 L_fl_64
  global_load_dwordx4 v[128:131], v36, s[42:43] offset:-4096 sc1
  global_load_dwordx4 v[132:135], v36, s[42:43] offset:0 sc1
L_fl_64:
  s_waitcnt vmcnt(0)
  s_bitcmp1_b32 s71, 0
  s_cbranch_scc0 L_fc_65
  v_xor_b32 v104, s32, v104
  v_xor_b32 v105, s33, v105
  v_xor_b32 v106, s34, v106
  v_xor_b32 v107, s35, v107
  v_xor_b32 v108, s32, v108
  v_xor_b32 v109, s33, v109
  v_xor_b32 v110, s34, v110
  v_xor_b32 v111, s35, v111
  v_or3_b32 v8, v104, v105, v106
  v_or3_b32 v9, v107, v108, v109
  v_or3_b32 v8, v8, v110, v111
  v_pk_add_f32 v[136:137], v[104:105], v[108:109]
  v_pk_add_f32 v[138:139], v[106:107], v[110:111]
  v_or_b32 v8, v8, v9
  v_lshlrev_b32 v8, 24, v8
  v_cmp_ne_u32 vcc, 0, v8
  s_cmp_lg_u64 vcc, 0
  s_cbranch_scc1 L_fc_65
  s_bitset0_b32 s71, 0
L_fc_65:
  s_bitcmp1_b32 s71, 1
  s_cbranch_scc0 L_fc_66
  v_xor_b32 v112, s32, v112
  v_xor_b32 v113, s33, v113
  v_xor_b32 v114, s34, v114
  v_xor_b32 v115, s35, v115
  v_xor_b32 v116, s32, v116
  v_xor_b32 v117, s33, v117
  v_xor_b32 v118, s34, v118
  v_xor_b32 v119, s35, v119
  v_or3_b32 v8, v112, v113, v114
  v_or3_b32 v9, v115, v116, v117
  v_or3_b32 v8, v8, v118, v119
  v_pk_add_f32 v[144:145], v[112:113], v[116:117]
  v_pk_add_f32 v[146:147], v[114:115], v[118:119]
  v_or_b32 v8, v8, v9
  v_lshlrev_b32 v8, 24, v8
  v_cmp_ne_u32 vcc, 0, v8
  s_cmp_lg_u64 vcc, 0
  s_cbranch_scc1 L_fc_66
  s_bitset0_b32 s71, 1
L_fc_66:
  s_bitcmp1_b32 s71, 2
  s_cbranch_scc0 L_fc_67
  v_xor_b32 v120, s32, v120
  v_xor_b32 v121, s33, v121
  v_xor_b32 v122, s34, v122
  v_xor_b32 v123, s35, v123
  v_xor_b32 v124, s32, v124
  v_xor_b32 v125, s33, v125
  v_xor_b32 v126, s34, v126
  v_xor_b32 v127, s35, v127
  v_or3_b32 v8, v120, v121, v122
  v_or3_b32 v9, v123, v124, v125
  v_or3_b32 v8, v8, v126, v127
  v_pk_add_f32 v[152:153], v[120:121], v[124:125]
  v_pk_add_f32 v[154:155], v[122:123], v[126:127]
  v_or_b32 v8, v8, v9
  v_lshlrev_b32 v8, 24, v8
  v_cmp_ne_u32 vcc, 0, v8
  s_cmp_lg_u64 vcc, 0
  s_cbranch_scc1 L_fc_67
  s_bitset0_b32 s71, 2
L_fc_67:
  s_bitcmp1_b32 s71, 3
  s_cbranch_scc0 L_fc_68
  v_xor_b32 v128, s32, v128
  v_xor_b32 v129, s33, v129
  v_xor_b32 v130, s34, v130
  v_xor_b32 v131, s35, v131
  v_xor_b32 v132, s32, v132
  v_xor_b32 v133, s33, v133
  v_xor_b32 v134, s34, v134
  v_xor_b32 v135, s35, v135
  v_or3_b32 v8, v128, v129, v130
  v_or3_b32 v9, v131, v132, v133
  v_or3_b32 v8, v8, v134, v135
  v_pk_add_f32 v[160:161], v[128:129], v[132:133]
  v_pk_add_f32 v[162:163], v[130:131], v[134:135]
  v_or_b32 v8, v8, v9
  v_lshlrev_b32 v8, 24, v8
  v_cmp_ne_u32 vcc, 0, v8
  s_cmp_lg_u64 vcc, 0
  s_cbranch_scc1 L_fc_68
  s_bitset0_b32 s71, 3
L_fc_68:
  s_cmp_lg_u32 s71, 0
  s_cbranch_scc1 L_f1_p
L_f1_ok:
  v_pk_add_f32 v[136:137], v[136:137], v[144:145]
  v_pk_add_f32 v[138:139], v[138:139], v[146:147]
  v_pk_add_f32 v[152:153], v[152:153], v[160:161]
  v_pk_add_f32 v[154:155], v[154:155], v[162:163]
  v_pk_add_f32 v[136:137], v[136:137], v[152:153]
  v_pk_add_f32 v[138:139], v[138:139], v[154:155]
  v_pk_fma_f32 v[8:9], v[136:137], v[24:25], v[28:29]
  v_pk_fma_f32 v[10:11], v[138:139], v[26:27], v[30:31]
  v_cvt_pk_bf16_f32 v8, v8, v9
  v_cvt_pk_bf16_f32 v9, v10, v11
  ds_write_b64 v12, v[8:9] offset:0
  v_pk_fma_f32 v[16:17], v[136:137], v[20:21], v[16:17]
  v_pk_fma_f32 v[18:19], v[138:139], v[22:23], v[18:19]
  v_add_f32 v24, v16, v17
  v_mul_f32 v25, v16, v16
  v_add_f32 v26, v18, v19
  v_mul_f32 v27, v18, v18
  v_fmac_f32 v25, v17, v17
  v_fmac_f32 v27, v19, v19
  v_pk_add_f32 v[24:25], v[24:25], v[26:27]
  s_nop 1
  v_add_f32_dpp v24, v24, v24 quad_perm:[1,0,3,2] row_mask:0xf bank_mask:0xf
  v_add_f32_dpp v25, v25, v25 quad_perm:[1,0,3,2] row_mask:0xf bank_mask:0xf
  s_nop 0
  v_add_f32_dpp v24, v24, v24 quad_perm:[2,3,0,1] row_mask:0xf bank_mask:0xf
  v_add_f32_dpp v25, v25, v25 quad_perm:[2,3,0,1] row_mask:0xf bank_mask:0xf
  ds_write_b64 v5, v[24:25]
  s_add_u32 s77, s77, 4
  v_mov_b32 v10, 1
  s_mov_b64 exec, 1
  ds_add_u32 v38, v10 offset:6720
  s_mov_b64 exec, -1
  s_mov_b32 s70, 0
L_hy_69:
  ds_read_b32 v10, v38 offset:6720
  s_waitcnt lgkmcnt(0)
  v_cmp_gt_u32 vcc, s77, v10
  s_cmp_eq_u64 vcc, 0
  s_cbranch_scc1 L_hyd_70
  s_add_u32 s70, s70, 1
  s_cmp_lt_u32 s70, 2097152
  s_cbranch_scc1 L_hy_69
L_hyd_70:
  ds_read_b128 v[104:107], v14 offset:0
  ds_read_b128 v[108:111], v14 offset:64
  ds_read_b128 v[112:115], v14 offset:128
  ds_read_b128 v[116:119], v14 offset:192
  ds_read_b64 v[20:21], v7
  ds_read_b128 v[120:123], v14 offset:256
  ds_read_b128 v[124:127], v14 offset:320
  ds_read_b128 v[128:131], v14 offset:384
  ds_read_b128 v[132:135], v14 offset:448
  ds_read_b128 v[136:139], v14 offset:512
  ds_read_b128 v[140:143], v14 offset:576
  ds_read_b128 v[144:147], v14 offset:640
  ds_read_b128 v[148:151], v14 offset:704
  s_waitcnt lgkmcnt(12)
  v_mfma_f32_16x16x32_bf16 v[32:35], v[40:43], v[104:107], 0
  ds_read_b128 v[152:155], v14 offset:768
  s_waitcnt lgkmcnt(12)
  v_mfma_f32_16x16x32_bf16 v[32:35], v[44:47], v[108:111], v[32:35]
  ds_read_b128 v[156:159], v14 offset:832
  s_waitcnt lgkmcnt(12)
  v_mfma_f32_16x16x32_bf16 v[32:35], v[48:51], v[112:115], v[32:35]
  ds_read_b128 v[160:163], v14 offset:896
  s_waitcnt lgkmcnt(12)
  v_mfma_f32_16x16x32_bf16 v[32:35], v[52:55], v[116:119], v[32:35]
  ds_read_b128 v[164:167], v14 offset:960
  s_waitcnt lgkmcnt(11)
  v_mfma_f32_16x16x32_bf16 v[32:35], v[56:59], v[120:123], v[32:35]
  v_add_f32_dpp v20, v20, v20 quad_perm:[2,3,0,1] row_mask:0xf bank_mask:0xf
  v_add_f32_dpp v21, v21, v21 quad_perm:[2,3,0,1] row_mask:0xf bank_mask:0xf
  s_waitcnt lgkmcnt(10)
  v_mfma_f32_16x16x32_bf16 v[32:35], v[60:63], v[124:127], v[32:35]
  v_add_f32_dpp v20, v20, v20 row_ror:4 row_mask:0xf bank_mask:0xf
  v_add_f32_dpp v21, v21, v21 row_ror:4 row_mask:0xf bank_mask:0xf
  s_waitcnt lgkmcnt(9)
  v_mfma_f32_16x16x32_bf16 v[32:35], v[64:67], v[128:131], v[32:35]
  v_add_f32_dpp v20, v20, v20 row_ror:8 row_mask:0xf bank_mask:0xf
  v_add_f32_dpp v21, v21, v21 row_ror:8 row_mask:0xf bank_mask:0xf
  s_waitcnt lgkmcnt(8)
  v_mfma_f32_16x16x32_bf16 v[32:35], v[68:71], v[132:135], v[32:35]
  v_mov_b32 v22, v20
  v_mov_b32 v23, v21
  s_waitcnt lgkmcnt(7)
  v_mfma_f32_16x16x32_bf16 v[32:35], v[72:75], v[136:139], v[32:35]
  v_permlane16_swap_b32 v22, v20
  v_permlane16_swap_b32 v23, v21
  s_waitcnt lgkmcnt(6)
  v_mfma_f32_16x16x32_bf16 v[32:35], v[76:79], v[140:143], v[32:35]
  v_pk_add_f32 v[20:21], v[20:21], v[22:23]
  v_mov_b32 v22, v20
  v_mov_b32 v23, v21
  s_waitcnt lgkmcnt(5)
  v_mfma_f32_16x16x32_bf16 v[32:35], v[80:83], v[144:147], v[32:35]
  v_permlane32_swap_b32 v22, v20
  v_permlane32_swap_b32 v23, v21
  s_waitcnt lgkmcnt(4)
  v_mfma_f32_16x16x32_bf16 v[32:35], v[84:87], v[148:151], v[32:35]
  v_pk_add_f32 v[20:21], v[20:21], v[22:23]
  v_mul_f32 v20, 0xbb000000, v20
  s_waitcnt lgkmcnt(3)
  v_mfma_f32_16x16x32_bf16 v[32:35], v[88:91], v[152:155], v[32:35]
  v_mul_f32 v21, 0x3b000000, v21
  v_fma_f32 v21, -v20, v20, v21
  s_waitcnt lgkmcnt(2)
  v_mfma_f32_16x16x32_bf16 v[32:35], v[92:95], v[156:159], v[32:35]
  v_max_f32 v21, 0, v21
  v_add_f32 v21, 0x3727c5ac, v21
  s_waitcnt lgkmcnt(1)
  v_mfma_f32_16x16x32_bf16 v[32:35], v[96:99], v[160:163], v[32:35]
  v_rsq_f32 v21, v21
  s_waitcnt lgkmcnt(0)
  v_mfma_f32_16x16x32_bf16 v[32:35], v[100:103], v[164:167], v[32:35]
  ds_read_b64_tr_b16 v[40:41], v6 offset:0
  ds_read_b64_tr_b16 v[42:43], v6 offset:4224
  ds_read_b64_tr_b16 v[44:45], v6 offset:32
  ds_read_b64_tr_b16 v[46:47], v6 offset:4256
  ds_read_b64_tr_b16 v[48:49], v6 offset:64
  ds_read_b64_tr_b16 v[50:51], v6 offset:4288
  ds_read_b64_tr_b16 v[52:53], v6 offset:96
  ds_read_b64_tr_b16 v[54:55], v6 offset:4320
  v_fmac_f32_dpp v32, v32, v20 row_shl:2 row_mask:0xf bank_mask:0x1
  v_fmac_f32_dpp v33, v33, v20 row_shl:2 row_mask:0xf bank_mask:0x1
  v_fmac_f32_dpp v34, v34, v20 row_shl:2 row_mask:0xf bank_mask:0x1
  v_fmac_f32_dpp v35, v35, v20 row_shl:2 row_mask:0xf bank_mask:0x1
  v_mul_f32 v8, v32, v21
  v_mul_f32 v9, v33, v21
  v_mul_f32 v10, v34, v21
  v_mul_f32 v11, v35, v21
  v_add_f32_dpp v8, v32, v8 row_shl:4 row_mask:0xf bank_mask:0xf
  v_add_f32_dpp v9, v33, v9 row_shl:4 row_mask:0xf bank_mask:0xf
  v_add_f32_dpp v10, v34, v10 row_shl:4 row_mask:0xf bank_mask:0xf
  v_add_f32_dpp v11, v35, v11 row_shl:4 row_mask:0xf bank_mask:0xf
  s_waitcnt lgkmcnt(4)
  ds_read_b64_tr_b16 v[56:57], v6 offset:128
  ds_read_b64_tr_b16 v[58:59], v6 offset:4352
  ds_read_b64_tr_b16 v[60:61], v6 offset:160
  ds_read_b64_tr_b16 v[62:63], v6 offset:4384
  ds_read_b64_tr_b16 v[64:65], v6 offset:192
  ds_read_b64_tr_b16 v[66:67], v6 offset:4416
  ds_read_b64_tr_b16 v[68:69], v6 offset:224
  ds_read_b64_tr_b16 v[70:71], v6 offset:4448
  v_permlane32_swap_b32 v8, v10
  v_permlane32_swap_b32 v9, v11
  v_mul_f32 v20, 0xbfb8aa3b, v8
  v_mul_f32 v21, 0xbfb8aa3b, v9
  v_exp_f32 v20, v20
  v_exp_f32 v21, v21
  v_mul_f32 v8, v8, v10
  v_mul_f32 v9, v9, v11
  v_add_f32 v20, 1.0, v20
  v_add_f32 v21, 1.0, v21
  v_rcp_f32 v20, v20
  v_rcp_f32 v21, v21
  s_mov_b32 exec_lo, 0x00030003
  s_mov_b32 exec_hi, 0x00030003
  v_mul_f32 v8, v8, v20
  v_mul_f32 v9, v9, v21
  v_cvt_pk_bf16_f32 v8, v8, v9
  ds_write_b32 v39, v8
  s_mov_b64 exec, -1
  s_add_u32 s77, s77, 4
  v_mov_b32 v10, 1
  s_mov_b64 exec, 1
  ds_add_u32 v38, v10 offset:6720
  s_mov_b64 exec, -1
  s_mov_b32 s70, 0
L_hy_71:
  ds_read_b32 v10, v38 offset:6720
  s_waitcnt lgkmcnt(0)
  v_cmp_gt_u32 vcc, s77, v10
  s_cmp_eq_u64 vcc, 0
  s_cbranch_scc1 L_hyd_72
  s_add_u32 s70, s70, 1
  s_cmp_lt_u32 s70, 2097152
  s_cbranch_scc1 L_hy_71
L_hyd_72:
  ds_read_b128 v[104:107], v37 offset:0
  ds_read_b128 v[108:111], v37 offset:128
  ds_read_b128 v[112:115], v37 offset:256
  ds_read_b128 v[116:119], v37 offset:384
  ds_read_b128 v[120:123], v37 offset:512
  ds_read_b128 v[124:127], v37 offset:640
  ds_read_b128 v[128:131], v37 offset:768
  ds_read_b128 v[132:135], v37 offset:896
  v_mov_b32 v3, 0xff
  s_waitcnt lgkmcnt(7)
  v_mfma_f32_16x16x32_bf16 v[8:11], v[40:43], v[104:107], 0
  s_waitcnt lgkmcnt(6)
  v_mfma_f32_16x16x32_bf16 v[8:11], v[44:47], v[108:111], v[8:11]
  s_waitcnt lgkmcnt(5)
  v_mfma_f32_16x16x32_bf16 v[8:11], v[48:51], v[112:115], v[8:11]
  s_waitcnt lgkmcnt(4)
  v_mfma_f32_16x16x32_bf16 v[8:11], v[52:55], v[116:119], v[8:11]
  s_waitcnt lgkmcnt(3)
  v_mfma_f32_16x16x32_bf16 v[8:11], v[56:59], v[120:123], v[8:11]
  s_waitcnt lgkmcnt(2)
  v_mfma_f32_16x16x32_bf16 v[8:11], v[60:63], v[124:127], v[8:11]
  s_waitcnt lgkmcnt(1)
  v_mfma_f32_16x16x32_bf16 v[8:11], v[64:67], v[128:131], v[8:11]
  s_waitcnt lgkmcnt(0)
  v_mfma_f32_16x16x32_bf16 v[8:11], v[68:71], v[132:135], v[8:11]
  s_nop 7
  v_bfi_b32 v8, v3, s32, v8
  v_bfi_b32 v9, v3, s33, v9
  v_bfi_b32 v10, v3, s34, v10
  v_bfi_b32 v11, v3, s35, v11
  global_store_dwordx4 v13, v[8:11], s[42:43] sc1
  s_branch L_fin
L_t_f2:
  s_cmp_lg_u32 s5, 3
  s_cbranch_scc1 L_fin
  global_load_dwordx2 v[8:9], v37, s[16:17]
  s_mov_b32 s70, 0
L_pg_73:
  global_load_dwordx4 v[136:139], v39, s[42:43] offset:-4096 sc1
  v_add_u32 v3, 8192, v39
  global_load_dwordx4 v[140:143], v3, s[42:43] sc1
  s_waitcnt vmcnt(0)
  s_mov_b64 vcc, 0
  v_cmp_ne_u32 s[68:69], s74, v137
  s_or_b64 vcc, vcc, s[68:69]
  v_cmp_ne_u32 s[68:69], s74, v139
  s_or_b64 vcc, vcc, s[68:69]
  v_cmp_ne_u32 s[68:69], s74, v141
  s_or_b64 vcc, vcc, s[68:69]
  v_cmp_ne_u32 s[68:69], s74, v143
  s_or_b64 vcc, vcc, s[68:69]
  s_cmp_eq_u64 vcc, 0
  s_cbranch_scc1 L_pge_74
  s_sleep 8
  s_add_u32 s70, s70, 1
  s_cmp_lt_u32 s70, 262144
  s_cbranch_scc1 L_pg_73
L_pge_74:
  v_lshlrev_b32 v16, 16, v8
  v_and_b32 v17, s73, v8
  v_lshlrev_b32 v18, 16, v9
  v_and_b32 v19, s73, v9
  v_lshlrev_b32 v20, 16, v136
  v_and_b32 v21, s73, v136
  v_lshlrev_b32 v22, 16, v138
  v_and_b32 v23, s73, v138
  v_lshlrev_b32 v24, 16, v140
  v_and_b32 v25, s73, v140
  v_lshlrev_b32 v26, 16, v142
  v_and_b32 v27, s73, v142
  s_mov_b32 s70, 0
L_f2_a:
  global_load_dwordx4 v[136:139], v15, s[42:43] sc1
  s_waitcnt vmcnt(0)
  v_xor_b32 v136, s32, v136
  v_xor_b32 v137, s33, v137
  v_xor_b32 v138, s34, v138
  v_xor_b32 v139, s35, v139
  v_or3_b32 v3, v136, v137, v138
  v_or_b32 v3, v3, v139
  v_lshlrev_b32 v3, 24, v3
  v_cmp_ne_u32 vcc, 0, v3
  s_cmp_eq_u64 vcc, 0
  s_cbranch_scc1 L_f2_ad
  s_sleep 8
  s_add_u32 s70, s70, 1
  s_cmp_lt_u32 s70, 262144
  s_cbranch_scc1 L_f2_a
L_f2_ad:
  s_cmp_lg_u32 s61, 0
  s_cbranch_scc1 L_f2_e
  v_mov_b32 v10, s74
  s_mov_b64 exec, 1
  global_store_dword v38, v10, s[42:43] offset:0 sc1
  s_mov_b64 exec, -1
L_f2_e:
  s_nop 1
  v_add_f32_dpp v136, v136, v136 row_ror:8 row_mask:0xf bank_mask:0xf
  v_add_f32_dpp v137, v137, v137 row_ror:8 row_mask:0xf bank_mask:0xf
  v_add_f32_dpp v138, v138, v138 row_ror:8 row_mask:0xf bank_mask:0xf
  v_add_f32_dpp v139, v139, v139 row_ror:8 row_mask:0xf bank_mask:0xf
  v_mov_b32 v140, v136
  v_mov_b32 v141, v137
  v_mov_b32 v142, v138
  v_mov_b32 v143, v139
  v_permlane16_swap_b32 v140, v136
  v_permlane16_swap_b32 v141, v137
  v_permlane16_swap_b32 v142, v138
  v_permlane16_swap_b32 v143, v139
  v_add_f32 v136, v136, v140
  v_add_f32 v137, v137, v141
  v_add_f32 v138, v138, v142
  v_add_f32 v139, v139, v143
  v_mov_b32 v140, v136
  v_mov_b32 v141, v137
  v_mov_b32 v142, v138
  v_mov_b32 v143, v139
  v_permlane32_swap_b32 v140, v136
  v_permlane32_swap_b32 v141, v137
  v_permlane32_swap_b32 v142, v138
  v_permlane32_swap_b32 v143, v139
  v_add_f32 v136, v136, v140
  v_add_f32 v137, v137, v141
  v_add_f32 v138, v138, v142
  v_add_f32 v139, v139, v143
  v_cvt_pk_bf16_f32 v136, 0, v136
  v_cvt_pk_bf16_f32 v137, 0, v137
  v_cvt_pk_bf16_f32 v138, 0, v138
  v_cvt_pk_bf16_f32 v139, 0, v139
  v_mul_f32 v136, v136, v20
  v_mul_f32 v137, v137, v21
  v_mul_f32 v138, v138, v22
  v_mul_f32 v139, v139, v23
  v_cvt_pk_bf16_f32 v136, 0, v136
  v_cvt_pk_bf16_f32 v137, 0, v137
  v_cvt_pk_bf16_f32 v138, 0, v138
  v_cvt_pk_bf16_f32 v139, 0, v139
  v_add_f32 v16, v16, v136
  v_add_f32 v17, v17, v137
  v_add_f32 v18, v18, v138
  v_add_f32 v19, v19, v139
  v_cvt_pk_bf16_f32 v16, 0, v16
  v_cvt_pk_bf16_f32 v17, 0, v17
  v_cvt_pk_bf16_f32 v18, 0, v18
  v_cvt_pk_bf16_f32 v19, 0, v19
  v_mov_b32 v156, s32
  v_mov_b32 v157, s33
  v_mov_b32 v158, s34
  v_mov_b32 v159, s35
  s_mov_b64 s[20:21], -1
  s_mov_b64 s[22:23], -1
  s_mov_b64 s[24:25], -1
  s_mov_b64 s[26:27], -1
  s_mov_b64 s[28:29], -1
  s_mov_b64 s[30:31], 0xffffff
  s_mov_b64 exec, s[20:21]
  global_load_dwordx4 v[136:139], v36, s[42:43] offset:-2048 sc1
  s_mov_b64 exec, s[22:23]
  global_load_dwordx4 v[140:143], v36, s[42:43] offset:-1024 sc1
  s_mov_b64 exec, s[24:25]
  global_load_dwordx4 v[144:147], v36, s[42:43] offset:0 sc1
  s_mov_b64 exec, s[26:27]
  global_load_dwordx4 v[148:151], v36, s[42:43] offset:1024 sc1
  s_mov_b64 exec, s[28:29]
  global_load_dwordx4 v[152:155], v36, s[42:43] offset:2048 sc1
  s_mov_b64 exec, s[30:31]
  global_load_dwordx4 v[156:159], v36, s[42:43] offset:3072 sc1
  s_mov_b64 exec, -1
  s_waitcnt vmcnt(0)
  s_mov_b32 s70, 0
  s_branch L_f2_pc
L_f2_p:
  s_mov_b64 exec, s[20:21]
  global_load_dwordx4 v[136:139], v36, s[42:43] offset:-2048 sc1
  s_mov_b64 exec, s[22:23]
  global_load_dwordx4 v[140:143], v36, s[42:43] offset:-1024 sc1
  s_mov_b64 exec, s[24:25]
  global_load_dwordx4 v[144:147], v36, s[42:43] offset:0 sc1
  s_mov_b64 exec, s[26:27]
  global_load_dwordx4 v[148:151], v36, s[42:43] offset:1024 sc1
  s_mov_b64 exec, s[28:29]
  global_load_dwordx4 v[152:155], v36, s[42:43] offset:2048 sc1
  s_mov_b64 exec, s[30:31]
  global_load_dwordx4 v[156:159], v36, s[42:43] offset:3072 sc1
  s_mov_b64 exec, -1
  s_sleep 2
  s_waitcnt vmcnt(6)
L_f2_pc:
  v_xor_b32 v104, s32, v136
  v_xor_b32 v105, s33, v137
  v_xor_b32 v106, s34, v138
  v_xor_b32 v107, s35, v139
  v_xor_b32 v108, s32, v140
  v_xor_b32 v109, s33, v141
  v_xor_b32 v110, s34, v142
  v_xor_b32 v111, s35, v143
  v_xor_b32 v112, s32, v144
  v_xor_b32 v113, s33, v145
  v_xor_b32 v114, s34, v146
  v_xor_b32 v115, s35, v147
  v_xor_b32 v116, s32, v148
  v_xor_b32 v117, s33, v149
  v_xor_b32 v118, s34, v150
  v_xor_b32 v119, s35, v151
  v_xor_b32 v120, s32, v152
  v_xor_b32 v121, s33, v153
  v_xor_b32 v122, s34, v154
  v_xor_b32 v123, s35, v155
  v_xor_b32 v124, s32, v156
  v_xor_b32 v125, s33, v157
  v_xor_b32 v126, s34, v158
  v_xor_b32 v127, s35, v159
  v_or3_b32 v28, v104, v105, v106
  v_or3_b32 v29, v108, v109, v110
  v_or3_b32 v30, v112, v113, v114
  v_or3_b32 v31, v116, v117, v118
  v_or3_b32 v32, v120, v121, v122
  v_or3_b32 v33, v124, v125, v126
  v_or_b32 v28, v28, v107
  v_or_b32 v29, v29, v111
  v_or_b32 v30, v30, v115
  v_or_b32 v31, v31, v119
  v_or_b32 v32, v32, v123
  v_or_b32 v33, v33, v127
  v_cmp_ne_u32_sdwa s[20:21], v28, v38 src0_sel:BYTE_0 src1_sel:DWORD
  v_cmp_ne_u32_sdwa s[22:23], v29, v38 src0_sel:BYTE_0 src1_sel:DWORD
  v_cmp_ne_u32_sdwa s[24:25], v30, v38 src0_sel:BYTE_0 src1_sel:DWORD
  v_cmp_ne_u32_sdwa s[26:27], v31, v38 src0_sel:BYTE_0 src1_sel:DWORD
  v_cmp_ne_u32_sdwa s[28:29], v32, v38 src0_sel:BYTE_0 src1_sel:DWORD
  v_cmp_ne_u32_sdwa s[30:31], v33, v38 src0_sel:BYTE_0 src1_sel:DWORD
  v_pk_add_f32 v[104:105], v[104:105], v[108:109]
  v_pk_add_f32 v[106:107], v[106:107], v[110:111]
  v_pk_add_f32 v[112:113], v[112:113], v[116:117]
  v_pk_add_f32 v[114:115], v[114:115], v[118:119]
  v_pk_add_f32 v[120:121], v[120:121], v[124:125]
  v_pk_add_f32 v[122:123], v[122:123], v[126:127]
  v_pk_add_f32 v[104:105], v[104:105], v[112:113]
  v_pk_add_f32 v[106:107], v[106:107], v[114:115]
  v_pk_add_f32 v[104:105], v[104:105], v[120:121]
  v_pk_add_f32 v[106:107], v[106:107], v[122:123]
  s_mov_b64 vcc, s[20:21]
  s_or_b64 vcc, vcc, s[22:23]
  s_or_b64 vcc, vcc, s[24:25]
  s_or_b64 vcc, vcc, s[26:27]
  s_or_b64 vcc, vcc, s[28:29]
  s_or_b64 vcc, vcc, s[30:31]
  s_or_b32 s20, s20, 1
  s_or_b32 s22, s22, 1
  s_or_b32 s24, s24, 1
  s_or_b32 s26, s26, 1
  s_or_b32 s28, s28, 1
  s_or_b32 s30, s30, 1
  s_cmp_eq_u64 vcc, 0
  s_cbranch_scc1 L_f2_pok
  s_add_u32 s70, s70, 1
  s_cmp_lt_u32 s70, 262144
  s_cbranch_scc1 L_f2_p
L_f2_pok:
  s_nop 1
  v_add_f32_dpp v104, v104, v104 row_ror:8 row_mask:0xf bank_mask:0xf
  v_add_f32_dpp v105, v105, v105 row_ror:8 row_mask:0xf bank_mask:0xf
  v_add_f32_dpp v106, v106, v106 row_ror:8 row_mask:0xf bank_mask:0xf
  v_add_f32_dpp v107, v107, v107 row_ror:8 row_mask:0xf bank_mask:0xf
  v_mov_b32 v108, v104
  v_mov_b32 v109, v105
  v_mov_b32 v110, v106
  v_mov_b32 v111, v107
  v_permlane16_swap_b32 v108, v104
  v_permlane16_swap_b32 v109, v105
  v_permlane16_swap_b32 v110, v106
  v_permlane16_swap_b32 v111, v107
  v_add_f32 v104, v104, v108
  v_add_f32 v105, v105, v109
  v_add_f32 v106, v106, v110
  v_add_f32 v107, v107, v111
  v_mov_b32 v108, v104
  v_mov_b32 v109, v105
  v_mov_b32 v110, v106
  v_mov_b32 v111, v107
  v_permlane32_swap_b32 v108, v104
  v_permlane32_swap_b32 v109, v105
  v_permlane32_swap_b32 v110, v106
  v_permlane32_swap_b32 v111, v107
  v_add_f32 v104, v104, v108
  v_add_f32 v105, v105, v109
  v_add_f32 v106, v106, v110
  v_add_f32 v107, v107, v111
  v_cvt_pk_bf16_f32 v104, 0, v104
  v_cvt_pk_bf16_f32 v105, 0, v105
  v_cvt_pk_bf16_f32 v106, 0, v106
  v_cvt_pk_bf16_f32 v107, 0, v107
  v_mul_f32 v104, v104, v24
  v_mul_f32 v105, v105, v25
  v_mul_f32 v106, v106, v26
  v_mul_f32 v107, v107, v27
  v_cvt_pk_bf16_f32 v104, 0, v104
  v_cvt_pk_bf16_f32 v105, 0, v105
  v_cvt_pk_bf16_f32 v106, 0, v106
  v_cvt_pk_bf16_f32 v107, 0, v107
  v_add_f32 v8, v104, v16
  v_add_f32 v9, v105, v17
  v_add_f32 v10, v106, v18
  v_add_f32 v11, v107, v19
  v_cvt_pk_bf16_f32 v8, v8, v9
  v_cvt_pk_bf16_f32 v9, v10, v11
  s_mov_b64 exec, 0xff
  global_store_dwordx2 v37, v[8:9], s[38:39] sc1
  s_mov_b64 exec, 1
  v_mov_b32 v10, s74
  s_lshl_b32 s49, s61, 7
  s_add_u32 s49, s49, 28672
  v_mov_b32 v11, s49
  global_store_dword v11, v10, s[42:43] sc1
L_fin:
  s_cmp_lg_u32 s5, 0
  s_cbranch_scc1 L_fin2
  s_mov_b64 exec, -1
  s_mov_b32 s70, 0
L_sn_75:
  ds_read_b32 v8, v38 offset:6708
  s_waitcnt lgkmcnt(0)
  v_cmp_gt_u32 vcc, 0x4, v8
  s_cmp_eq_u64 vcc, 0
  s_cbranch_scc1 L_snd_76
  s_sleep 8
  s_add_u32 s70, s70, 1
  s_cmp_lt_u32 s70, 2097152
  s_cbranch_scc1 L_sn_75
L_snd_76:
  s_waitcnt vmcnt(0)
  v_lshlrev_b32 v72, 3, v1
  ds_read_b128 v[60:63], v38 offset:6784
  ds_read_b128 v[64:67], v38 offset:6800
  ds_read_b128 v[68:71], v38 offset:6816
  ds_read_b64 v[40:41], v72 offset:13056
  ds_read_b64 v[42:43], v72 offset:13568
  ds_read_b64 v[44:45], v72 offset:14080
  ds_read_b64 v[46:47], v72 offset:14592
  ds_read_b64 v[48:49], v72 offset:15104
  ds_read_b64 v[50:51], v72 offset:15616
  ds_read_b64 v[52:53], v72 offset:16128
  ds_read_b64 v[54:55], v72 offset:16640
  ds_read_b64 v[56:57], v72 offset:17152
  ds_read_b64 v[58:59], v72 offset:17664
  s_lshl_b32 s68, s6, 2
  s_add_u32 s68, s68, s7
  s_lshl_b32 s68, s68, 9
  s_add_u32 s68, s68, 131072
  v_add_u32 v72, s68, v72
  v_and_b32 v73, 1, v1
  v_lshlrev_b32 v73, 4, v73
  v_lshrrev_b32 v73, v73, s74
  v_lshrrev_b32 v74, 8, v73
  s_movk_i32 s69, 0xff
  s_waitcnt lgkmcnt(9)
  v_pk_mul_f32 v[40:41], v[40:41], v[60:61] op_sel:[0,0] op_sel_hi:[1,0]
  s_waitcnt lgkmcnt(8)
  v_pk_mul_f32 v[42:43], v[42:43], v[60:61] op_sel:[0,1] op_sel_hi:[1,1]
  s_waitcnt lgkmcnt(7)
  v_pk_fma_f32 v[40:41], v[44:45], v[62:63], v[40:41] op_sel:[0,0,0] op_sel_hi:[1,0,1]
  s_waitcnt lgkmcnt(6)
  v_pk_fma_f32 v[42:43], v[46:47], v[62:63], v[42:43] op_sel:[0,1,0] op_sel_hi:[1,1,1]
  s_waitcnt lgkmcnt(5)
  v_pk_fma_f32 v[40:41], v[48:49], v[64:65], v[40:41] op_sel:[0,0,0] op_sel_hi:[1,0,1]
  s_waitcnt lgkmcnt(4)
  v_pk_fma_f32 v[42:43], v[50:51], v[64:65], v[42:43] op_sel:[0,1,0] op_sel_hi:[1,1,1]
  s_waitcnt lgkmcnt(3)
  v_pk_fma_f32 v[40:41], v[52:53], v[66:67], v[40:41] op_sel:[0,0,0] op_sel_hi:[1,0,1]
  s_waitcnt lgkmcnt(2)
  v_pk_fma_f32 v[42:43], v[54:55], v[66:67], v[42:43] op_sel:[0,1,0] op_sel_hi:[1,1,1]
  s_waitcnt lgkmcnt(1)
  v_pk_fma_f32 v[40:41], v[56:57], v[68:69], v[40:41] op_sel:[0,0,0] op_sel_hi:[1,0,1]
  s_waitcnt lgkmcnt(0)
  v_pk_fma_f32 v[42:43], v[58:59], v[68:69], v[42:43] op_sel:[0,1,0] op_sel_hi:[1,1,1]
  v_pk_add_f32 v[40:41], v[40:41], v[42:43]
  v_bfi_b32 v40, s69, v73, v40
  v_bfi_b32 v41, s69, v74, v41
  global_store_dwordx2 v72, v[40:41], s[42:43] sc1
L_fin2:
L_end:
  s_endpgm
.p2align 7
L_table:
  .long 0xffda000e, 0x10000008, 0x34a34a10, 0, 0xffda0806, 0x10000008, 0x34a34a10, 0
  .long 0xffda1016, 0x10000008, 0x34a34a10, 0, 0xffda1806, 0x10000008, 0x34a34a10, 0
  .long 0xffda2006, 0x10000008, 0x34a34a10, 0, 0xffda2806, 0x10000008, 0x34a34a10, 0
  .long 0xffda3006, 0x10000008, 0x34a34a10, 0, 0xffda3806, 0x10000008, 0x34a34a10, 0
  .long 0xffda010e, 0x10000008, 0x34a34a10, 0, 0xffda0906, 0x10000008, 0x34a34a10, 0
  .long 0xffda1116, 0x10000008, 0x34a34a10, 0, 0xffda1906, 0x10000008, 0x34a34a10, 0
  .long 0xffda2106, 0x10000008, 0x34a34a10, 0, 0xffda2906, 0x10000008, 0x34a34a10, 0
  .long 0xffda3106, 0x10000008, 0x34a34a10, 0, 0xffda3906, 0x10000008, 0x34a34a10, 0
  .long 0xffda020e, 0x10000008, 0x34a34a10, 0, 0xffda0a06, 0x10000008, 0x34a34a10, 0
  .long 0xffda1216, 0x10000008, 0x34a34a10, 0, 0xffda1a06, 0x10000008, 0x34a34a10, 0
  .long 0xffda2206, 0x10000008, 0x34a34a10, 0, 0xffda2a06, 0x10000008, 0x34a34a10, 0
  .long 0xffda3206, 0x10000008, 0x34a34a10, 0, 0xffda3a06, 0x10000008, 0x34a34a10, 0
  .long 0xffda030e, 0x10000008, 0x40540510, 0, 0xffda0b06, 0x10000008, 0x40540510, 0
  .long 0xffda1316, 0x10000008, 0x40540510, 0, 0xffda1b06, 0x10000008, 0x40540510, 0
  .long 0xffda2306, 0x10000008, 0x40540510, 0, 0xffda2b06, 0x10000008, 0x40540510, 0
  .long 0xffda3306, 0x10000008, 0x40540510, 0, 0xffda3b06, 0x10000008, 0x40540510, 0
  .long 0xffda040e, 0x10000008, 0x34a34a10, 0, 0xffda0c06, 0x10000008, 0x34a34a10, 0
  .long 0xffda1416, 0x10000008, 0x34a34a10, 0, 0xffda1c06, 0x10000008, 0x34a34a10, 0
  .long 0xffda2406, 0x10000008, 0x34a34a10, 0, 0xffda2c06, 0x10000008, 0x34a34a10, 0
  .long 0xffda3406, 0x10000008, 0x34a34a10, 0, 0xffda3c06, 0x10000008, 0x34a34a10, 0
  .long 0xffda050e, 0x10000008, 0x34a34a10, 0, 0xffda0d06, 0x10000008, 0x34a34a10, 0
  .long 0xffda1516, 0x10000008, 0x34a34a10, 0, 0xffda1d06, 0x10000008, 0x34a34a10, 0
  .long 0xffda2506, 0x10000008, 0x34a34a10, 0, 0xffda2d06, 0x10000008, 0x34a34a10, 0
  .long 0xffda3506, 0x10000008, 0x34a34a10, 0, 0xffda3d06, 0x10000008, 0x34a34a10, 0
  .long 0xffda060e, 0x10000008, 0x34a34a10, 0, 0xffda0e06, 0x10000008, 0x34a34a10, 0
  .long 0xffda1616, 0x10000008, 0x34a34a10, 0, 0xffda1e06, 0x10000008, 0x34a34a10, 0
  .long 0xffda2606, 0x10000008, 0x34a34a10, 0, 0xffda2e06, 0x10000008, 0x34a34a10, 0
  .long 0xffda3606, 0x10000008, 0x34a34a10, 0, 0xffda3e06, 0x10000008, 0x34a34a10, 0
  .long 0xffda070e, 0x10000008, 0x34a34a10, 0, 0xffda0f06, 0x10000008, 0x34a34a10, 0
  .long 0xffda1716, 0x10000008, 0x34a34a10, 0, 0xffda1f06, 0x10000008, 0x34a34a10, 0
  .long 0xffda2706, 0x10000008, 0x34a34a10, 0, 0xffda2f06, 0x10000008, 0x34a34a10, 0
  .long 0xffda3706, 0x10000008, 0x34a34a10, 0, 0xffda3f06, 0x10000008, 0x34a34a10, 0
  .long 0x004d0009, 0x10000008, 0x32924310, 0, 0x004d0001, 0x10000008, 0x32924310, 0
  .long 0x004d0011, 0x10000008, 0x32924310, 0, 0x004d0001, 0x10000008, 0x32924310, 0
  .long 0x004d0001, 0x10000008, 0x32924310, 0, 0x004d0001, 0x10000008, 0x32924310, 0
  .long 0x004d0001, 0x10000008, 0x32924310, 0, 0x004d0001, 0x10000008, 0x32924310, 0
  .long 0x004d0109, 0x10000008, 0x32924310, 0, 0x004d0101, 0x10000008, 0x32924310, 0
  .long 0x004d0111, 0x10000008, 0x32924310, 0, 0x004d0101, 0x10000008, 0x32924310, 0
  .long 0x004d0101, 0x10000008, 0x32924310, 0, 0x004d0101, 0x10000008, 0x32924310, 0
  .long 0x004d0101, 0x10000008, 0x32924310, 0, 0x004d0101, 0x10000008, 0x32924310, 0
  .long 0x004d0209, 0x10000008, 0x32924310, 0, 0x004d0201, 0x10000008, 0x32924310, 0
  .long 0x004d0211, 0x10000008, 0x32924310, 0, 0x004d0201, 0x10000008, 0x32924310, 0
  .long 0x004d0201, 0x10000008, 0x32924310, 0, 0x004d0201, 0x10000008, 0x32924310, 0
  .long 0x004d0201, 0x10000008, 0x32924310, 0, 0x004d0201, 0x10000008, 0x32924310, 0
  .long 0x00330309, 0x10000008, 0x34325c10, 0, 0x00330301, 0x10000008, 0x34325c10, 0
  .long 0x00330311, 0x10000008, 0x34325c10, 0, 0x00330301, 0x10000008, 0x34325c10, 0
  .long 0x00330301, 0x10000008, 0x34325c10, 0, 0x00330301, 0x10000008, 0x34325c10, 0
  .long 0x00330301, 0x10000008, 0x34325c10, 0, 0x00330301, 0x10000008, 0x34325c10, 0
  .long 0x004d0409, 0x10000008, 0x32924310, 0, 0x004d0401, 0x10000008, 0x32924310, 0
  .long 0x004d0411, 0x10000008, 0x32924310, 0, 0x004d0401, 0x10000008, 0x32924310, 0
  .long 0x004d0401, 0x10000008, 0x32924310, 0, 0x004d0401, 0x10000008, 0x32924310, 0
  .long 0x004d0401, 0x10000008, 0x32924310, 0, 0x004d0401, 0x10000008, 0x32924310, 0
  .long 0x004d0509, 0x10000008, 0x32924310, 0, 0x004d0501, 0x10000008, 0x32924310, 0
  .long 0x004d0511, 0x10000008, 0x32924310, 0, 0x004d0501, 0x10000008, 0x32924310, 0
  .long 0x004d0501, 0x10000008, 0x32924310, 0, 0x004d0501, 0x10000008, 0x32924310, 0
  .long 0x004d0501, 0x10000008, 0x32924310, 0, 0x004d0501, 0x10000008, 0x32924310, 0
  .long 0x004d0609, 0x10000008, 0x32924310, 0, 0x004d0601, 0x10000008, 0x32924310, 0
  .long 0x004d0611, 0x10000008, 0x32924310, 0, 0x004d0601, 0x10000008, 0x32924310, 0
  .long 0x004d0601, 0x10000008, 0x32924310, 0, 0x004d0601, 0x10000008, 0x32924310, 0
  .long 0x004d0601, 0x10000008, 0x32924310, 0, 0x004d0601, 0x10000008, 0x32924310, 0
  .long 0x004d0709, 0x10000008, 0x32924310, 0, 0x004d0701, 0x10000008, 0x32924310, 0
  .long 0x004d0711, 0x10000008, 0x32924310, 0, 0x004d0701, 0x10000008, 0x32924310, 0
  .long 0x004d0701, 0x10000008, 0x32924310, 0, 0x004d0701, 0x10000008, 0x32924310, 0
  .long 0x004d0701, 0x10000008, 0x32924310, 0, 0x004d0701, 0x10000008, 0x32924310, 0
  .long 0x0000030d, 0x10000008, 0x37337310, 0, 0x00000405, 0x10000008, 0x37337310, 0
  .long 0x00000515, 0x10000008, 0x37337310, 0, 0x00000605, 0x10000008, 0x37337310, 0
  .long 0x00000705, 0x10000008, 0x37337310, 0, 0x00000005, 0x10000008, 0x37337310, 0
  .long 0x00000105, 0x10000008, 0x37337310, 0, 0x00000205, 0x10000008, 0x37337310, 0
  .long 0x0000090d, 0x10000008, 0x37337310, 0, 0x00000a05, 0x10000008, 0x37337310, 0
  .long 0x00000b15, 0x10000008, 0x37337310, 0, 0x00000c05, 0x10000008, 0x37337310, 0
  .long 0x00000d05, 0x10000008, 0x37337310, 0, 0x00000e05, 0x10000008, 0x37337310, 0
  .long 0x00000f05, 0x10000008, 0x37337310, 0, 0x00000805, 0x10000008, 0x37337310, 0
  .long 0x0000150c, 0x10000008, 0x32c24510, 0, 0x00001604, 0x10000008, 0x32c24510, 0
  .long 0x00001714, 0x10000008, 0x32c24510, 0, 0x00001004, 0x10000008, 0x32c24510, 0
  .long 0x00001104, 0x10000008, 0x32c24510, 0, 0x00001204, 0x10000008, 0x32c24510, 0
  .long 0x00001304, 0x10000008, 0x38029a10, 0, 0x00001404, 0x10000008, 0x32c24510, 0
  .long 0x00001f0c, 0x10000008, 0x32c24510, 0, 0x00001804, 0x10000008, 0x32c24510, 0
  .long 0x00001914, 0x10000008, 0x32c24510, 0, 0x00001a04, 0x10000008, 0x32c24510, 0
  .long 0x00001b04, 0x10000008, 0x38029a10, 0, 0x00001c04, 0x10000008, 0x32c24510, 0
  .long 0x00001d04, 0x10000008, 0x32c24510, 0, 0x00001e04, 0x10000008, 0x32c24510, 0
  .long 0x0000220c, 0x10000008, 0x32c24510, 0, 0x00002304, 0x10000008, 0x38029a10, 0
  .long 0x00002414, 0x10000008, 0x32c24510, 0, 0x00002504, 0x10000008, 0x32c24510, 0
  .long 0x00002604, 0x10000008, 0x32c24510, 0, 0x00002704, 0x10000008, 0x32c24510, 0
  .long 0x00002004, 0x10000008, 0x32c24510, 0, 0x00002104, 0x10000008, 0x32c24510, 0
  .long 0x00002c0c, 0x10000008, 0x32c24510, 0, 0x00002d04, 0x10000008, 0x32c24510, 0
  .long 0x00002e14, 0x10000008, 0x32c24510, 0, 0x00a60f02, 0x12503f17, 0x3bd2d710, 0
  .long 0x00002804, 0x10000008, 0x32c24510, 0, 0x00a61a02, 0x12503f17, 0x3bd2d710, 0
  .long 0x00a62002, 0x12503f17, 0x3bd2d710, 0, 0x00002b04, 0x10000008, 0x38029a10, 0
  .long 0x0180000a, 0x15503f26, 0x41a33310, 0, 0x01800502, 0x15503f26, 0x41a33310, 0
  .long 0x01800a12, 0x15503f26, 0x41a33310, 0, 0x00a61002, 0x12503f17, 0x3bd2d710, 0
  .long 0x01801502, 0x15503f26, 0x41a33310, 0, 0x00a61b02, 0x12503f17, 0x3bd2d710, 0
  .long 0x00a62102, 0x12503f17, 0x3bd2d710, 0, 0x01802602, 0x15503f26, 0x41a33310, 0
  .long 0x0033000b, 0x0cd35e8a, 0x48039a10, 0, 0x00330403, 0x0cd35e8a, 0x41a33310, 0
  .long 0x00330813, 0x0cd35e8a, 0x48039a10, 0, 0x00330c03, 0x0cd3dd8a, 0x41a33310, 0
  .long 0x00331003, 0x0cd35e8a, 0x41a33310, 0, 0x00331403, 0x0cd3dd8a, 0x41a33310, 0
  .long 0x00331803, 0x0cd3dd8a, 0x41a33310, 0, 0x00331c03, 0x0cd35e8a, 0x41a33310, 0
  .long 0x0180010a, 0x15503f26, 0x41a33310, 0, 0x01800602, 0x15503f26, 0x41a33310, 0
  .long 0x01800b12, 0x15503f26, 0x41a33310, 0, 0x01801102, 0x15503f26, 0x41a33310, 0
  .long 0x01801602, 0x15503f26, 0x41a33310, 0, 0x01801c02, 0x15503f26, 0x41a33310, 0
  .long 0x01802202, 0x15503f26, 0x41a33310, 0, 0x01802702, 0x15503f26, 0x41a33310, 0
  .long 0x0033010b, 0x0cd31c8a, 0x48039a10, 0, 0x00330503, 0x0cd31c8a, 0x41a33310, 0
  .long 0x00330913, 0x0cd31c8a, 0x48039a10, 0, 0x00330d03, 0x0cd31c8a, 0x41a33310, 0
  .long 0x00331103, 0x0cd31c8a, 0x41a33310, 0, 0x00331503, 0x0cd31c8a, 0x41a33310, 0
  .long 0x00331903, 0x0cd31c8a, 0x41a33310, 0, 0x00331d03, 0x0cd31c8a, 0x41a33310, 0
  .long 0x0180020a, 0x15503f26, 0x41a33310, 0, 0x01800702, 0x15503f26, 0x41a33310, 0
  .long 0x01800c12, 0x15503f26, 0x41a33310, 0, 0x01801202, 0x15503f26, 0x41a33310, 0
  .long 0x01801702, 0x15503f26, 0x41a33310, 0, 0x01801d02, 0x15503f26, 0x41a33310, 0
  .long 0x01802302, 0x15503f26, 0x41a33310, 0, 0x01802802, 0x15503f26, 0x41a33310, 0
  .long 0x0033020b, 0x0cd35e8a, 0x48039a10, 0, 0x00330603, 0x0cd35e8a, 0x41a33310, 0
  .long 0x00330a13, 0x0cd35e8a, 0x48039a10, 0, 0x00330e03, 0x0cd35e8a, 0x41a33310, 0
  .long 0x00331203, 0x0cd35e8a, 0x41a33310, 0, 0x00331603, 0x0cd35e8a, 0x41a33310, 0
  .long 0x00331a03, 0x0cd35e8a, 0x41a33310, 0, 0x00331e03, 0x0cd35e8a, 0x41a33310, 0
  .long 0x0180030a, 0x15503f26, 0x41a33310, 0, 0x01800802, 0x15503f26, 0x41a33310, 0
  .long 0x01800d12, 0x15503f26, 0x41a33310, 0, 0x00002f04, 0x10000008, 0x32c24510, 0
  .long 0x01801802, 0x15503f26, 0x41a33310, 0, 0x00002904, 0x10000008, 0x32c24510, 0
  .long 0x00002a04, 0x10000008, 0x32c24510, 0, 0x01802902, 0x15503f26, 0x41a33310, 0
  .long 0x0033030b, 0x0cd31c8a, 0x48039a10, 0, 0x00330703, 0x0cd31c8a, 0x41a33310, 0
  .long 0x00330b13, 0x0cd31c8a, 0x48039a10, 0, 0x00a61302, 0x12503f17, 0x3bd2d710, 0
  .long 0x00331303, 0x0cd31c8a, 0x41a33310, 0, 0x00a61e02, 0x12503f17, 0x3bd2d710, 0
  .long 0x00a62402, 0x12503f17, 0x3bd2d710, 0, 0x00331f03, 0x0cd31c8a, 0x41a33310, 0
  .long 0x0180040a, 0x15503f26, 0x41a33310, 0, 0x01800902, 0x15503f26, 0x41a33310, 0
  .long 0x01800e12, 0x15503f26, 0x41a33310, 0, 0x00a61402, 0x12503f17, 0x3bd2d710, 0
  .long 0x01801902, 0x15503f26, 0x41a33310, 0, 0x00a61f02, 0x12503f17, 0x3bd2d710, 0
  .long 0x00a62502, 0x12503f17, 0x3bd2d710, 0, 0x01802a02, 0x15503f26, 0x41a33310, 0
  .long 0x00330008, 0x0cd35e8a, 0x41a33310, 0, 0x00330000, 0x0cd35e8a, 0x41a33310, 0
  .long 0x00330010, 0x0cd35e8a, 0x41a33310, 0, 0x00330f03, 0x0cd3dd8a, 0x41a33310, 0
  .long 0x00330000, 0x0cd35e8a, 0x41a33310, 0, 0x00331703, 0x0cd3dd8a, 0x41a33310, 0
  .long 0x00331b03, 0x0cd3dd8a, 0x41a33310, 0, 0x00330000, 0x0cd35e8a, 0x41a33310, 0
.section .rodata,"a"
.p2align 6
.amdhsa_kernel adaLN_cond__sliding_block_cached__glu_gated_swiglu__decode_kernel
  .amdhsa_next_free_vgpr 168
  .amdhsa_next_free_sgpr 102
  .amdhsa_accum_offset 168
  .amdhsa_group_segment_fixed_size 0
  .amdhsa_kernarg_size 112
  .amdhsa_user_sgpr_count 2
  .amdhsa_user_sgpr_kernarg_segment_ptr 1
  .amdhsa_system_sgpr_workgroup_id_x 1
.end_amdhsa_kernel
```

```asm
; @launch grid=(256,1,1) block=(768,1,1) lds=140288
.amdgcn_target "amdgcn-amd-amdhsa--gfx950"
.text
.globl adaLN_cond__sliding_block_cached__glu_gated_swiglu__decode_kernel
.p2align 8
.type adaLN_cond__sliding_block_cached__glu_gated_swiglu__decode_kernel,@function
adaLN_cond__sliding_block_cached__glu_gated_swiglu__decode_kernel:
  s_cmp_ge_u32 s2, 256
  s_cbranch_scc1 L_end
  s_load_dwordx16 s[16:31], s[0:1], 0
  s_load_dwordx8 s[32:39], s[0:1], 64
  s_load_dwordx4 s[40:43], s[0:1], 96
  s_getpc_b64 s[56:57]
L_pc:
  s_lshl_b32 s3, s2, 4
  s_add_u32 s3, s3, L_table-L_pc
  s_and_b32 s13, s2, 0xe8
  s_cmp_eq_u32 s13, 0xc8
  s_cselect_b32 s13, 0, 0
  s_cmp_lt_u32 s2, 144
  s_cselect_b32 s13, 1, s13
  s_cmp_lt_u32 s2, 128
  s_cselect_b32 s13, 0, s13
  s_cmp_lt_u32 s2, 64
  s_cselect_b32 s13, 2, s13
  v_lshrrev_b32 v2, 6, v0
  v_and_b32 v1, 63, v0
  v_readfirstlane_b32 s5, v2
  s_bfe_u32 s7, s2, 0x20003
  s_bfe_u32 s6, s2, 0x20005
  s_and_b32 s8, s2, 7
  s_lshl_b32 s9, s8, 2
  s_add_u32 s6, s6, s9
  s_lshr_b32 s9, s2, 7
  s_lshl_b32 s9, s9, 5
  s_add_u32 s6, s6, s9
  s_mov_b32 s72, 0xfffffffe
  s_mov_b32 s73, 0xffff0000
  s_cmp_lt_u32 s5, 4
  s_cbranch_scc1 L_helper
  s_sub_u32 s9, s5, 4
  s_lshl_b32 s4, s7, 18
  s_lshl_b32 s11, s9, 10
L_stream:
  s_lshl_b32 s10, s6, 22
  s_add_u32 s10, s10, s4
  s_add_u32 s10, s10, 0x300000
  v_lshl_add_u32 v0, v1, 4, s11
  s_lshr_b32 s12, s2, 3
  s_mul_i32 s12, s12, 5
  s_mul_i32 s15, s8, 3
  s_add_u32 s12, s12, s15
  s_lshl_b32 s12, s12, 13
  s_and_b32 s12, s12, 0x3ffff
  s_waitcnt lgkmcnt(0)
  s_add_u32 s44, s18, s10
  s_addc_u32 s45, s19, 0
  s_mov_b32 s46, 0x40000
  s_mov_b32 s47, 0x20000
  s_cmp_le_i32 s13, 0
  s_cbranch_scc1 L_nb1
  s_barrier
L_nb1:
  buffer_load_dwordx4 v[40:43], v0, s[44:47], s12 offen nt
  s_add_u32 s12, s12, 0x2000
  s_and_b32 s12, s12, 0x3ffff
  buffer_load_dwordx4 v[44:47], v0, s[44:47], s12 offen nt
  s_add_u32 s12, s12, 0x2000
  s_and_b32 s12, s12, 0x3ffff
  buffer_load_dwordx4 v[48:51], v0, s[44:47], s12 offen nt
  s_add_u32 s12, s12, 0x2000
  s_and_b32 s12, s12, 0x3ffff
  buffer_load_dwordx4 v[52:55], v0, s[44:47], s12 offen nt
  s_add_u32 s12, s12, 0x2000
  s_and_b32 s12, s12, 0x3ffff
  s_load_dwordx2 s[14:15], s[56:57], s3
  s_load_dword s77, s[56:57], s3 offset:8
  s_load_dword s74, s[42:43], 0
  s_add_u32 s48, s20, s10
  s_addc_u32 s49, s21, 0
  s_mov_b32 s50, 0x40000
  s_mov_b32 s51, 0x20000
  s_mov_b32 s52, 0xcccccccc
  s_mov_b32 s53, 0xcccccccc
  s_mov_b32 s54, 0xaaaaaaaa
  s_mov_b32 s55, 0xaaaaaaaa
  v_and_b32 v38, 15, v1
  v_lshlrev_b32 v38, 4, v38
  s_lshl_b32 s10, s9, 11
  s_add_u32 s10, s10, 83968
  v_lshl_add_u32 v3, v1, 3, s10
  v_mov_b32 v4, 0x7fff0000
  v_mov_b32 v5, 0xff800000
  ds_write_b64 v3, v[4:5] offset:0
  ds_write_b64 v3, v[4:5] offset:512
  ds_write_b64 v3, v[4:5] offset:1024
  v_lshrrev_b32 v3, 4, v1
  v_lshl_add_u32 v39, v38, 1, s10
  v_lshl_add_u32 v39, v3, 3, v39
  s_sub_u32 s68, s12, 32768
  v_bfrev_b32 v24, v1
  v_lshrrev_b32 v24, 15, v24
  v_and_b32 v24, 0x1e000, v24
  v_add_u32 v24, s68, v24
  v_and_b32 v24, 0x3e000, v24
  v_lshl_add_u32 v24, v3, 8, v24
  v_add_u32 v24, s11, v24
  v_xor_b32 v26, 0x20000, v24
  s_lshl_b32 s11, s9, 9
  v_lshl_add_u32 v22, v38, 1, s11
  v_lshl_add_u32 v22, v3, 3, v22
  s_mov_b32 s32, 4
  s_mul_i32 s33, s9, 0x5e000000
  s_mov_b64 s[64:65], 0
  s_mov_b64 s[66:67], 0
  s_mov_b32 s38, 0
  s_mov_b32 s39, 0
  s_mov_b32 s75, 0
  s_mov_b32 s61, 0
  s_lshl_b32 s40, s6, 9
  s_lshl_b32 s68, s9, 6
  s_add_u32 s40, s40, s68
  s_add_u32 s40, s40, 32768
  s_cmp_eq_u32 s13, 0
  s_cbranch_scc0 L_nb2
  s_barrier
L_nb2:
  s_waitcnt lgkmcnt(0)
  s_mov_b32 s56, s10
  s_mul_i32 s74, s74, 0x9e3779b1
  s_add_u32 s74, s74, 0x7f4a7c15
  s_and_b32 s57, s77, 0xff
  s_bfe_u32 s34, s77, 0xc0008
  s_lshr_b32 s58, s77, 20
  s_and_b32 s76, s15, 15
  s_mov_b32 s41, 5
  s_mov_b32 s35, 28
  s_mov_b32 s59, 0
  s_mul_i32 s68, s76, 28
  s_add_u32 s68, s68, 1024
  v_mov_b32 v20, s68
  v_mov_b32 v21, 0
  v_mov_b32 v23, 0
  s_cmp_ge_u32 s9, 8
  s_cselect_b32 s39, 2, 0
  s_bfe_u32 s68, s15, 0x20004
  s_add_u32 s68, s68, s9
  s_lshr_b32 s69, s9, 3
  s_lshr_b32 s68, s68, 3
  s_cmp_lg_u32 s68, s69
  s_cbranch_scc1 L_away
  s_call_b64 s[62:63], L_ks
  buffer_load_dwordx4 v[56:59], v0, s[44:47], s12 offen nt
  s_add_u32 s12, s12, 0x2000
  s_and_b32 s12, s12, 0x3ffff
  s_call_b64 s[62:63], L_ks
  buffer_load_dwordx4 v[60:63], v0, s[44:47], s12 offen nt
  s_add_u32 s12, s12, 0x2000
  s_and_b32 s12, s12, 0x3ffff
  s_call_b64 s[62:63], L_ks
  buffer_load_dwordx4 v[64:67], v0, s[44:47], s12 offen nt
  s_add_u32 s12, s12, 0x2000
  s_and_b32 s12, s12, 0x3ffff
  s_call_b64 s[62:63], L_ks
  buffer_load_dwordx4 v[68:71], v0, s[44:47], s12 offen nt
  s_add_u32 s12, s12, 0x2000
  s_and_b32 s12, s12, 0x3ffff
  s_call_b64 s[62:63], L_ks
  buffer_load_dwordx4 v[72:75], v0, s[44:47], s12 offen nt
  s_add_u32 s12, s12, 0x2000
  s_and_b32 s12, s12, 0x3ffff
  s_call_b64 s[62:63], L_ks
  buffer_load_dwordx4 v[76:79], v0, s[44:47], s12 offen nt
  s_add_u32 s12, s12, 0x2000
  s_and_b32 s12, s12, 0x3ffff
  s_call_b64 s[62:63], L_ks
  buffer_load_dwordx4 v[80:83], v0, s[44:47], s12 offen nt
  s_add_u32 s12, s12, 0x2000
  s_and_b32 s12, s12, 0x3ffff
  s_call_b64 s[62:63], L_ks
  buffer_load_dwordx4 v[84:87], v0, s[44:47], s12 offen nt
  s_add_u32 s12, s12, 0x2000
  s_and_b32 s12, s12, 0x3ffff
  s_call_b64 s[62:63], L_ks
  buffer_load_dwordx4 v[88:91], v0, s[44:47], s12 offen nt
  s_add_u32 s12, s12, 0x2000
  s_and_b32 s12, s12, 0x3ffff
  s_call_b64 s[62:63], L_ks
  buffer_load_dwordx4 v[92:95], v0, s[44:47], s12 offen nt
  s_add_u32 s12, s12, 0x2000
  s_and_b32 s12, s12, 0x3ffff
  s_call_b64 s[62:63], L_ks
  buffer_load_dwordx4 v[96:99], v0, s[44:47], s12 offen nt
  s_add_u32 s12, s12, 0x2000
  s_and_b32 s12, s12, 0x3ffff
  s_call_b64 s[62:63], L_ks
  buffer_load_dwordx4 v[100:103], v0, s[44:47], s12 offen nt
  s_add_u32 s12, s12, 0x2000
  s_and_b32 s12, s12, 0x3ffff
  s_call_b64 s[62:63], L_ks
  buffer_load_dwordx4 v[104:107], v0, s[44:47], s12 offen nt
  s_add_u32 s12, s12, 0x2000
  s_and_b32 s12, s12, 0x3ffff
  s_call_b64 s[62:63], L_ks
  buffer_load_dwordx4 v[108:111], v0, s[44:47], s12 offen nt
  s_add_u32 s12, s12, 0x2000
  s_and_b32 s12, s12, 0x3ffff
  s_call_b64 s[62:63], L_ks
  buffer_load_dwordx4 v[112:115], v0, s[44:47], s12 offen nt
  s_add_u32 s12, s12, 0x2000
  s_and_b32 s12, s12, 0x3ffff
  s_call_b64 s[62:63], L_ks
  buffer_load_dwordx4 v[116:119], v0, s[44:47], s12 offen nt
  s_add_u32 s12, s12, 0x2000
  s_and_b32 s12, s12, 0x3ffff
  s_call_b64 s[62:63], L_ks
  buffer_load_dwordx4 v[120:123], v0, s[44:47], s12 offen nt
  s_add_u32 s12, s12, 0x2000
  s_and_b32 s12, s12, 0x3ffff
  s_call_b64 s[62:63], L_ks
  buffer_load_dwordx4 v[124:127], v0, s[44:47], s12 offen nt
  s_add_u32 s12, s12, 0x2000
  s_and_b32 s12, s12, 0x3ffff
  s_call_b64 s[62:63], L_ks
  buffer_load_dwordx4 v[128:131], v0, s[44:47], s12 offen nt
  s_add_u32 s12, s12, 0x2000
  s_and_b32 s12, s12, 0x3ffff
  s_call_b64 s[62:63], L_ks
  buffer_load_dwordx4 v[132:135], v0, s[44:47], s12 offen nt
  s_add_u32 s12, s12, 0x2000
  s_and_b32 s12, s12, 0x3ffff
  s_call_b64 s[62:63], L_ks
  buffer_load_dwordx4 v[136:139], v0, s[44:47], s12 offen nt
  s_add_u32 s12, s12, 0x2000
  s_and_b32 s12, s12, 0x3ffff
  s_call_b64 s[62:63], L_ks
  buffer_load_dwordx4 v[140:143], v0, s[44:47], s12 offen nt
  s_add_u32 s12, s12, 0x2000
  s_and_b32 s12, s12, 0x3ffff
  s_call_b64 s[62:63], L_ks
  buffer_load_dwordx4 v[144:147], v0, s[44:47], s12 offen nt
  s_add_u32 s12, s12, 0x2000
  s_and_b32 s12, s12, 0x3ffff
  s_call_b64 s[62:63], L_ks
  buffer_load_dwordx4 v[148:151], v0, s[44:47], s12 offen nt
  s_add_u32 s12, s12, 0x2000
  s_and_b32 s12, s12, 0x3ffff
  s_call_b64 s[62:63], L_ks
  buffer_load_dwordx4 v[152:155], v0, s[44:47], s12 offen nt
  s_add_u32 s12, s12, 0x2000
  s_and_b32 s12, s12, 0x3ffff
  s_call_b64 s[62:63], L_ks
  buffer_load_dwordx4 v[156:159], v0, s[44:47], s12 offen nt
  s_add_u32 s12, s12, 0x2000
  s_and_b32 s12, s12, 0x3ffff
  s_call_b64 s[62:63], L_ks
  buffer_load_dwordx4 v[160:163], v0, s[44:47], s12 offen nt
  s_add_u32 s12, s12, 0x2000
  s_and_b32 s12, s12, 0x3ffff
  s_call_b64 s[62:63], L_ks
  buffer_load_dwordx4 v[164:167], v0, s[44:47], s12 offen nt
  s_add_u32 s12, s12, 0x2000
  s_and_b32 s12, s12, 0x3ffff
  s_mov_b32 s10, 0
L_kw:
  s_cmp_ge_u32 s39, 4
  s_cbranch_scc1 L_v0
  s_call_b64 s[100:101], L_work
  s_sleep 1
  s_add_u32 s10, s10, 1
  s_cmp_lt_u32 s10, 262144
  s_cbranch_scc1 L_kw
L_v0:
  s_mov_b32 s32, 0
  s_mov_b32 s37, 255
  v_mov_b32 v23, 8
  s_mov_b32 s35, s59
  ds_read_b64 v[20:21], v23 offset:6688
  s_ashr_i32 s14, s14, 16
  s_waitcnt lgkmcnt(0)
  v_readfirstlane_b32 s34, v20
  s_mul_i32 s34, s34, 96
  s_ashr_i32 s34, s34, 4
  s_add_i32 s34, s34, -6093
  s_add_i32 s34, s34, s14
  s_lshr_b32 s68, s15, 20
  s_mul_i32 s34, s34, s68
  s_ashr_i32 s34, s34, 8
  s_call_b64 s[62:63], L_vs
  s_cbranch_scc1 L_nl0
  v_add_u32_dpp v3, v28, v38 row_newbcast:0 row_mask:0xf bank_mask:0xf
  buffer_load_dwordx4 v[40:43], v3, s[48:51], 0 offen nt
L_nl0:
  v_dot2_f32_bf16 v8, v104, v4, 0
  v_dot2_f32_bf16 v9, v108, v4, 0
  v_dot2_f32_bf16 v10, v112, v4, 0
  v_dot2_f32_bf16 v11, v116, v4, 0
  v_dot2_f32_bf16 v12, v120, v4, 0
  v_dot2_f32_bf16 v13, v124, v4, 0
  v_dot2_f32_bf16 v14, v128, v4, 0
  v_dot2_f32_bf16 v15, v132, v4, 0
  v_dot2_f32_bf16 v8, v105, v5, v8
  v_dot2_f32_bf16 v9, v109, v5, v9
  v_dot2_f32_bf16 v10, v113, v5, v10
  v_dot2_f32_bf16 v11, v117, v5, v11
  v_dot2_f32_bf16 v12, v121, v5, v12
  v_dot2_f32_bf16 v13, v125, v5, v13
  v_dot2_f32_bf16 v14, v129, v5, v14
  v_dot2_f32_bf16 v15, v133, v5, v15
  v_dot2_f32_bf16 v8, v106, v6, v8
  v_dot2_f32_bf16 v9, v110, v6, v9
  v_dot2_f32_bf16 v10, v114, v6, v10
  v_dot2_f32_bf16 v11, v118, v6, v11
  v_dot2_f32_bf16 v12, v122, v6, v12
  v_dot2_f32_bf16 v13, v126, v6, v13
  v_dot2_f32_bf16 v14, v130, v6, v14
  v_dot2_f32_bf16 v15, v134, v6, v15
  v_dot2_f32_bf16 v8, v107, v7, v8
  v_dot2_f32_bf16 v9, v111, v7, v9
  v_dot2_f32_bf16 v10, v115, v7, v10
  v_dot2_f32_bf16 v11, v119, v7, v11
  v_dot2_f32_bf16 v12, v123, v7, v12
  v_dot2_f32_bf16 v13, v127, v7, v13
  v_dot2_f32_bf16 v14, v131, v7, v14
  v_dot2_f32_bf16 v15, v135, v7, v15
  v_add_f32_dpp v8, v8, v8 row_ror:8 row_mask:0xf bank_mask:0x3
  v_add_f32_dpp v8, v9, v9 row_ror:8 row_mask:0xf bank_mask:0xc
  v_add_f32_dpp v10, v10, v10 row_ror:8 row_mask:0xf bank_mask:0x3
  v_add_f32_dpp v10, v11, v11 row_ror:8 row_mask:0xf bank_mask:0xc
  v_add_f32_dpp v12, v12, v12 row_ror:8 row_mask:0xf bank_mask:0x3
  v_add_f32_dpp v12, v13, v13 row_ror:8 row_mask:0xf bank_mask:0xc
  v_add_f32_dpp v14, v14, v14 row_ror:8 row_mask:0xf bank_mask:0x3
  v_add_f32_dpp v14, v15, v15 row_ror:8 row_mask:0xf bank_mask:0xc
  v_add_f32_dpp v16, v8, v8 row_shl:4 row_mask:0xf bank_mask:0x5
  v_add_f32_dpp v16, v10, v10 row_shr:4 row_mask:0xf bank_mask:0xa
  v_add_f32_dpp v17, v12, v12 row_shl:4 row_mask:0xf bank_mask:0x5
  v_add_f32_dpp v17, v14, v14 row_shr:4 row_mask:0xf bank_mask:0xa
  s_call_b64 s[62:63], L_vs
  s_cbranch_scc1 L_nl1
  v_add_u32_dpp v3, v28, v38 row_newbcast:1 row_mask:0xf bank_mask:0xf
  buffer_load_dwordx4 v[44:47], v3, s[48:51], 0 offen nt
L_nl1:
  s_call_b64 s[62:63], L_vs
  s_cbranch_scc1 L_nl2
  v_add_u32_dpp v3, v28, v38 row_newbcast:2 row_mask:0xf bank_mask:0xf
  buffer_load_dwordx4 v[48:51], v3, s[48:51], 0 offen nt
L_nl2:
  s_call_b64 s[62:63], L_vs
  s_cbranch_scc1 L_nl3
  v_add_u32_dpp v3, v28, v38 row_newbcast:3 row_mask:0xf bank_mask:0xf
  buffer_load_dwordx4 v[52:55], v3, s[48:51], 0 offen nt
L_nl3:
  s_call_b64 s[62:63], L_vs
  s_cbranch_scc1 L_nl4
  v_add_u32_dpp v3, v28, v38 row_newbcast:4 row_mask:0xf bank_mask:0xf
  buffer_load_dwordx4 v[56:59], v3, s[48:51], 0 offen nt
L_nl4:
  s_call_b64 s[62:63], L_vs
  s_cbranch_scc1 L_nl5
  v_add_u32_dpp v3, v28, v38 row_newbcast:5 row_mask:0xf bank_mask:0xf
  buffer_load_dwordx4 v[60:63], v3, s[48:51], 0 offen nt
L_nl5:
  v_dot2c_f32_bf16_dpp v8, v29, v40 row_newbcast:0 row_mask:0xf bank_mask:0xf
  v_dot2c_f32_bf16_dpp v9, v34, v40 row_newbcast:0 row_mask:0xf bank_mask:0xf
  v_dot2c_f32_bf16_dpp v10, v29, v41 row_newbcast:0 row_mask:0xf bank_mask:0xf
  v_dot2c_f32_bf16_dpp v11, v34, v41 row_newbcast:0 row_mask:0xf bank_mask:0xf
  v_dot2c_f32_bf16_dpp v12, v29, v42 row_newbcast:0 row_mask:0xf bank_mask:0xf
  v_dot2c_f32_bf16_dpp v13, v34, v42 row_newbcast:0 row_mask:0xf bank_mask:0xf
  v_dot2c_f32_bf16_dpp v14, v29, v43 row_newbcast:0 row_mask:0xf bank_mask:0xf
  v_dot2c_f32_bf16_dpp v15, v34, v43 row_newbcast:0 row_mask:0xf bank_mask:0xf
  s_cmp_eq_u32 s75, 6
  s_cbranch_scc1 L_epi
  s_call_b64 s[62:63], L_vs
  s_cbranch_scc1 L_nl6
  v_add_u32_dpp v3, v28, v38 row_newbcast:6 row_mask:0xf bank_mask:0xf
  buffer_load_dwordx4 v[64:67], v3, s[48:51], 0 offen nt
L_nl6:
  v_dot2c_f32_bf16_dpp v8, v29, v44 row_newbcast:1 row_mask:0xf bank_mask:0xf
  v_dot2c_f32_bf16_dpp v9, v34, v44 row_newbcast:1 row_mask:0xf bank_mask:0xf
  v_dot2c_f32_bf16_dpp v10, v29, v45 row_newbcast:1 row_mask:0xf bank_mask:0xf
  v_dot2c_f32_bf16_dpp v11, v34, v45 row_newbcast:1 row_mask:0xf bank_mask:0xf
  v_dot2c_f32_bf16_dpp v12, v29, v46 row_newbcast:1 row_mask:0xf bank_mask:0xf
  v_dot2c_f32_bf16_dpp v13, v34, v46 row_newbcast:1 row_mask:0xf bank_mask:0xf
  v_dot2c_f32_bf16_dpp v14, v29, v47 row_newbcast:1 row_mask:0xf bank_mask:0xf
  v_dot2c_f32_bf16_dpp v15, v34, v47 row_newbcast:1 row_mask:0xf bank_mask:0xf
  s_cmp_eq_u32 s75, 7
  s_cbranch_scc1 L_epi
  s_call_b64 s[62:63], L_vs
  s_cbranch_scc1 L_nl7
  v_add_u32_dpp v3, v28, v38 row_newbcast:7 row_mask:0xf bank_mask:0xf
  buffer_load_dwordx4 v[68:71], v3, s[48:51], 0 offen nt
L_nl7:
  v_dot2c_f32_bf16_dpp v8, v29, v48 row_newbcast:2 row_mask:0xf bank_mask:0xf
  v_dot2c_f32_bf16_dpp v9, v34, v48 row_newbcast:2 row_mask:0xf bank_mask:0xf
  v_dot2c_f32_bf16_dpp v10, v29, v49 row_newbcast:2 row_mask:0xf bank_mask:0xf
  v_dot2c_f32_bf16_dpp v11, v34, v49 row_newbcast:2 row_mask:0xf bank_mask:0xf
  v_dot2c_f32_bf16_dpp v12, v29, v50 row_newbcast:2 row_mask:0xf bank_mask:0xf
  v_dot2c_f32_bf16_dpp v13, v34, v50 row_newbcast:2 row_mask:0xf bank_mask:0xf
  v_dot2c_f32_bf16_dpp v14, v29, v51 row_newbcast:2 row_mask:0xf bank_mask:0xf
  v_dot2c_f32_bf16_dpp v15, v34, v51 row_newbcast:2 row_mask:0xf bank_mask:0xf
  s_cmp_eq_u32 s75, 8
  s_cbranch_scc1 L_epi
  s_call_b64 s[62:63], L_vs
  s_cbranch_scc1 L_nl8
  v_add_u32_dpp v3, v28, v38 row_newbcast:8 row_mask:0xf bank_mask:0xf
  buffer_load_dwordx4 v[72:75], v3, s[48:51], 0 offen nt
L_nl8:
  v_dot2c_f32_bf16_dpp v8, v29, v52 row_newbcast:3 row_mask:0xf bank_mask:0xf
  v_dot2c_f32_bf16_dpp v9, v34, v52 row_newbcast:3 row_mask:0xf bank_mask:0xf
  v_dot2c_f32_bf16_dpp v10, v29, v53 row_newbcast:3 row_mask:0xf bank_mask:0xf
  v_dot2c_f32_bf16_dpp v11, v34, v53 row_newbcast:3 row_mask:0xf bank_mask:0xf
  v_dot2c_f32_bf16_dpp v12, v29, v54 row_newbcast:3 row_mask:0xf bank_mask:0xf
  v_dot2c_f32_bf16_dpp v13, v34, v54 row_newbcast:3 row_mask:0xf bank_mask:0xf
  v_dot2c_f32_bf16_dpp v14, v29, v55 row_newbcast:3 row_mask:0xf bank_mask:0xf
  v_dot2c_f32_bf16_dpp v15, v34, v55 row_newbcast:3 row_mask:0xf bank_mask:0xf
  s_cmp_eq_u32 s75, 9
  s_cbranch_scc1 L_epi
  s_call_b64 s[62:63], L_vs
  s_cbranch_scc1 L_nl9
  v_add_u32_dpp v3, v28, v38 row_newbcast:9 row_mask:0xf bank_mask:0xf
  buffer_load_dwordx4 v[76:79], v3, s[48:51], 0 offen nt
L_nl9:
  v_dot2c_f32_bf16_dpp v8, v29, v56 row_newbcast:4 row_mask:0xf bank_mask:0xf
  v_dot2c_f32_bf16_dpp v9, v34, v56 row_newbcast:4 row_mask:0xf bank_mask:0xf
  v_dot2c_f32_bf16_dpp v10, v29, v57 row_newbcast:4 row_mask:0xf bank_mask:0xf
  v_dot2c_f32_bf16_dpp v11, v34, v57 row_newbcast:4 row_mask:0xf bank_mask:0xf
  v_dot2c_f32_bf16_dpp v12, v29, v58 row_newbcast:4 row_mask:0xf bank_mask:0xf
  v_dot2c_f32_bf16_dpp v13, v34, v58 row_newbcast:4 row_mask:0xf bank_mask:0xf
  v_dot2c_f32_bf16_dpp v14, v29, v59 row_newbcast:4 row_mask:0xf bank_mask:0xf
  v_dot2c_f32_bf16_dpp v15, v34, v59 row_newbcast:4 row_mask:0xf bank_mask:0xf
  s_cmp_eq_u32 s75, 10
  s_cbranch_scc1 L_epi
  s_call_b64 s[62:63], L_vs
  s_cbranch_scc1 L_nl10
  v_add_u32_dpp v3, v28, v38 row_newbcast:10 row_mask:0xf bank_mask:0xf
  buffer_load_dwordx4 v[80:83], v3, s[48:51], 0 offen nt
L_nl10:
  v_dot2c_f32_bf16_dpp v8, v29, v60 row_newbcast:5 row_mask:0xf bank_mask:0xf
  v_dot2c_f32_bf16_dpp v9, v34, v60 row_newbcast:5 row_mask:0xf bank_mask:0xf
  v_dot2c_f32_bf16_dpp v10, v29, v61 row_newbcast:5 row_mask:0xf bank_mask:0xf
  v_dot2c_f32_bf16_dpp v11, v34, v61 row_newbcast:5 row_mask:0xf bank_mask:0xf
  v_dot2c_f32_bf16_dpp v12, v29, v62 row_newbcast:5 row_mask:0xf bank_mask:0xf
  v_dot2c_f32_bf16_dpp v13, v34, v62 row_newbcast:5 row_mask:0xf bank_mask:0xf
  v_dot2c_f32_bf16_dpp v14, v29, v63 row_newbcast:5 row_mask:0xf bank_mask:0xf
  v_dot2c_f32_bf16_dpp v15, v34, v63 row_newbcast:5 row_mask:0xf bank_mask:0xf
  s_cmp_eq_u32 s75, 11
  s_cbranch_scc1 L_epi
  s_call_b64 s[62:63], L_vs
  s_cbranch_scc1 L_nl11
  v_add_u32_dpp v3, v28, v38 row_newbcast:11 row_mask:0xf bank_mask:0xf
  buffer_load_dwordx4 v[84:87], v3, s[48:51], 0 offen nt
L_nl11:
  v_dot2c_f32_bf16_dpp v8, v29, v64 row_newbcast:6 row_mask:0xf bank_mask:0xf
  v_dot2c_f32_bf16_dpp v9, v34, v64 row_newbcast:6 row_mask:0xf bank_mask:0xf
  v_dot2c_f32_bf16_dpp v10, v29, v65 row_newbcast:6 row_mask:0xf bank_mask:0xf
  v_dot2c_f32_bf16_dpp v11, v34, v65 row_newbcast:6 row_mask:0xf bank_mask:0xf
  v_dot2c_f32_bf16_dpp v12, v29, v66 row_newbcast:6 row_mask:0xf bank_mask:0xf
  v_dot2c_f32_bf16_dpp v13, v34, v66 row_newbcast:6 row_mask:0xf bank_mask:0xf
  v_dot2c_f32_bf16_dpp v14, v29, v67 row_newbcast:6 row_mask:0xf bank_mask:0xf
  v_dot2c_f32_bf16_dpp v15, v34, v67 row_newbcast:6 row_mask:0xf bank_mask:0xf
  s_cmp_eq_u32 s75, 12
  s_cbranch_scc1 L_epi
  s_call_b64 s[62:63], L_vs
  s_cbranch_scc1 L_nl12
  v_add_u32_dpp v3, v28, v38 row_newbcast:12 row_mask:0xf bank_mask:0xf
  buffer_load_dwordx4 v[88:91], v3, s[48:51], 0 offen nt
L_nl12:
  v_dot2c_f32_bf16_dpp v8, v29, v68 row_newbcast:7 row_mask:0xf bank_mask:0xf
  v_dot2c_f32_bf16_dpp v9, v34, v68 row_newbcast:7 row_mask:0xf bank_mask:0xf
  v_dot2c_f32_bf16_dpp v10, v29, v69 row_newbcast:7 row_mask:0xf bank_mask:0xf
  v_dot2c_f32_bf16_dpp v11, v34, v69 row_newbcast:7 row_mask:0xf bank_mask:0xf
  v_dot2c_f32_bf16_dpp v12, v29, v70 row_newbcast:7 row_mask:0xf bank_mask:0xf
  v_dot2c_f32_bf16_dpp v13, v34, v70 row_newbcast:7 row_mask:0xf bank_mask:0xf
  v_dot2c_f32_bf16_dpp v14, v29, v71 row_newbcast:7 row_mask:0xf bank_mask:0xf
  v_dot2c_f32_bf16_dpp v15, v34, v71 row_newbcast:7 row_mask:0xf bank_mask:0xf
  s_cmp_eq_u32 s75, 13
  s_cbranch_scc1 L_epi
  s_call_b64 s[62:63], L_vs
  s_cbranch_scc1 L_nl13
  v_add_u32_dpp v3, v28, v38 row_newbcast:13 row_mask:0xf bank_mask:0xf
  buffer_load_dwordx4 v[92:95], v3, s[48:51], 0 offen nt
L_nl13:
  v_dot2c_f32_bf16_dpp v8, v29, v72 row_newbcast:8 row_mask:0xf bank_mask:0xf
  v_dot2c_f32_bf16_dpp v9, v34, v72 row_newbcast:8 row_mask:0xf bank_mask:0xf
  v_dot2c_f32_bf16_dpp v10, v29, v73 row_newbcast:8 row_mask:0xf bank_mask:0xf
  v_dot2c_f32_bf16_dpp v11, v34, v73 row_newbcast:8 row_mask:0xf bank_mask:0xf
  v_dot2c_f32_bf16_dpp v12, v29, v74 row_newbcast:8 row_mask:0xf bank_mask:0xf
  v_dot2c_f32_bf16_dpp v13, v34, v74 row_newbcast:8 row_mask:0xf bank_mask:0xf
  v_dot2c_f32_bf16_dpp v14, v29, v75 row_newbcast:8 row_mask:0xf bank_mask:0xf
  v_dot2c_f32_bf16_dpp v15, v34, v75 row_newbcast:8 row_mask:0xf bank_mask:0xf
  s_cmp_eq_u32 s75, 14
  s_cbranch_scc1 L_epi
  s_call_b64 s[62:63], L_vs
  s_cbranch_scc1 L_nl14
  v_add_u32_dpp v3, v28, v38 row_newbcast:14 row_mask:0xf bank_mask:0xf
  buffer_load_dwordx4 v[96:99], v3, s[48:51], 0 offen nt
L_nl14:
  v_dot2c_f32_bf16_dpp v8, v29, v76 row_newbcast:9 row_mask:0xf bank_mask:0xf
  v_dot2c_f32_bf16_dpp v9, v34, v76 row_newbcast:9 row_mask:0xf bank_mask:0xf
  v_dot2c_f32_bf16_dpp v10, v29, v77 row_newbcast:9 row_mask:0xf bank_mask:0xf
  v_dot2c_f32_bf16_dpp v11, v34, v77 row_newbcast:9 row_mask:0xf bank_mask:0xf
  v_dot2c_f32_bf16_dpp v12, v29, v78 row_newbcast:9 row_mask:0xf bank_mask:0xf
  v_dot2c_f32_bf16_dpp v13, v34, v78 row_newbcast:9 row_mask:0xf bank_mask:0xf
  v_dot2c_f32_bf16_dpp v14, v29, v79 row_newbcast:9 row_mask:0xf bank_mask:0xf
  v_dot2c_f32_bf16_dpp v15, v34, v79 row_newbcast:9 row_mask:0xf bank_mask:0xf
  s_cmp_eq_u32 s75, 15
  s_cbranch_scc1 L_epi
  s_call_b64 s[62:63], L_vs
  s_cbranch_scc1 L_nl15
  v_add_u32_dpp v3, v28, v38 row_newbcast:15 row_mask:0xf bank_mask:0xf
  buffer_load_dwordx4 v[100:103], v3, s[48:51], 0 offen nt
L_nl15:
  v_dot2c_f32_bf16_dpp v8, v29, v80 row_newbcast:10 row_mask:0xf bank_mask:0xf
  v_dot2c_f32_bf16_dpp v9, v34, v80 row_newbcast:10 row_mask:0xf bank_mask:0xf
  v_dot2c_f32_bf16_dpp v10, v29, v81 row_newbcast:10 row_mask:0xf bank_mask:0xf
  v_dot2c_f32_bf16_dpp v11, v34, v81 row_newbcast:10 row_mask:0xf bank_mask:0xf
  v_dot2c_f32_bf16_dpp v12, v29, v82 row_newbcast:10 row_mask:0xf bank_mask:0xf
  v_dot2c_f32_bf16_dpp v13, v34, v82 row_newbcast:10 row_mask:0xf bank_mask:0xf
  v_dot2c_f32_bf16_dpp v14, v29, v83 row_newbcast:10 row_mask:0xf bank_mask:0xf
  v_dot2c_f32_bf16_dpp v15, v34, v83 row_newbcast:10 row_mask:0xf bank_mask:0xf
  s_cmp_eq_u32 s75, 16
  s_cbranch_scc1 L_epi
  s_call_b64 s[62:63], L_vs
  s_cbranch_scc1 L_nl16
  v_add_u32_dpp v3, v30, v38 row_newbcast:0 row_mask:0xf bank_mask:0xf
  buffer_load_dwordx4 v[104:107], v3, s[48:51], 0 offen nt
L_nl16:
  v_dot2c_f32_bf16_dpp v8, v29, v84 row_newbcast:11 row_mask:0xf bank_mask:0xf
  v_dot2c_f32_bf16_dpp v9, v34, v84 row_newbcast:11 row_mask:0xf bank_mask:0xf
  v_dot2c_f32_bf16_dpp v10, v29, v85 row_newbcast:11 row_mask:0xf bank_mask:0xf
  v_dot2c_f32_bf16_dpp v11, v34, v85 row_newbcast:11 row_mask:0xf bank_mask:0xf
  v_dot2c_f32_bf16_dpp v12, v29, v86 row_newbcast:11 row_mask:0xf bank_mask:0xf
  v_dot2c_f32_bf16_dpp v13, v34, v86 row_newbcast:11 row_mask:0xf bank_mask:0xf
  v_dot2c_f32_bf16_dpp v14, v29, v87 row_newbcast:11 row_mask:0xf bank_mask:0xf
  v_dot2c_f32_bf16_dpp v15, v34, v87 row_newbcast:11 row_mask:0xf bank_mask:0xf
  s_cmp_eq_u32 s75, 17
  s_cbranch_scc1 L_epi
  s_call_b64 s[62:63], L_vs
  s_cbranch_scc1 L_nl17
  v_add_u32_dpp v3, v30, v38 row_newbcast:1 row_mask:0xf bank_mask:0xf
  buffer_load_dwordx4 v[108:111], v3, s[48:51], 0 offen nt
L_nl17:
  v_dot2c_f32_bf16_dpp v8, v29, v88 row_newbcast:12 row_mask:0xf bank_mask:0xf
  v_dot2c_f32_bf16_dpp v9, v34, v88 row_newbcast:12 row_mask:0xf bank_mask:0xf
  v_dot2c_f32_bf16_dpp v10, v29, v89 row_newbcast:12 row_mask:0xf bank_mask:0xf
  v_dot2c_f32_bf16_dpp v11, v34, v89 row_newbcast:12 row_mask:0xf bank_mask:0xf
  v_dot2c_f32_bf16_dpp v12, v29, v90 row_newbcast:12 row_mask:0xf bank_mask:0xf
  v_dot2c_f32_bf16_dpp v13, v34, v90 row_newbcast:12 row_mask:0xf bank_mask:0xf
  v_dot2c_f32_bf16_dpp v14, v29, v91 row_newbcast:12 row_mask:0xf bank_mask:0xf
  v_dot2c_f32_bf16_dpp v15, v34, v91 row_newbcast:12 row_mask:0xf bank_mask:0xf
  s_cmp_eq_u32 s75, 18
  s_cbranch_scc1 L_epi
  s_call_b64 s[62:63], L_vs
  s_cbranch_scc1 L_nl18
  v_add_u32_dpp v3, v30, v38 row_newbcast:2 row_mask:0xf bank_mask:0xf
  buffer_load_dwordx4 v[112:115], v3, s[48:51], 0 offen nt
L_nl18:
  v_dot2c_f32_bf16_dpp v8, v29, v92 row_newbcast:13 row_mask:0xf bank_mask:0xf
  v_dot2c_f32_bf16_dpp v9, v34, v92 row_newbcast:13 row_mask:0xf bank_mask:0xf
  v_dot2c_f32_bf16_dpp v10, v29, v93 row_newbcast:13 row_mask:0xf bank_mask:0xf
  v_dot2c_f32_bf16_dpp v11, v34, v93 row_newbcast:13 row_mask:0xf bank_mask:0xf
  v_dot2c_f32_bf16_dpp v12, v29, v94 row_newbcast:13 row_mask:0xf bank_mask:0xf
  v_dot2c_f32_bf16_dpp v13, v34, v94 row_newbcast:13 row_mask:0xf bank_mask:0xf
  v_dot2c_f32_bf16_dpp v14, v29, v95 row_newbcast:13 row_mask:0xf bank_mask:0xf
  v_dot2c_f32_bf16_dpp v15, v34, v95 row_newbcast:13 row_mask:0xf bank_mask:0xf
  s_cmp_eq_u32 s75, 19
  s_cbranch_scc1 L_epi
  s_call_b64 s[62:63], L_vs
  s_cbranch_scc1 L_nl19
  v_add_u32_dpp v3, v30, v38 row_newbcast:3 row_mask:0xf bank_mask:0xf
  buffer_load_dwordx4 v[116:119], v3, s[48:51], 0 offen nt
L_nl19:
  v_dot2c_f32_bf16_dpp v8, v29, v96 row_newbcast:14 row_mask:0xf bank_mask:0xf
  v_dot2c_f32_bf16_dpp v9, v34, v96 row_newbcast:14 row_mask:0xf bank_mask:0xf
  v_dot2c_f32_bf16_dpp v10, v29, v97 row_newbcast:14 row_mask:0xf bank_mask:0xf
  v_dot2c_f32_bf16_dpp v11, v34, v97 row_newbcast:14 row_mask:0xf bank_mask:0xf
  v_dot2c_f32_bf16_dpp v12, v29, v98 row_newbcast:14 row_mask:0xf bank_mask:0xf
  v_dot2c_f32_bf16_dpp v13, v34, v98 row_newbcast:14 row_mask:0xf bank_mask:0xf
  v_dot2c_f32_bf16_dpp v14, v29, v99 row_newbcast:14 row_mask:0xf bank_mask:0xf
  v_dot2c_f32_bf16_dpp v15, v34, v99 row_newbcast:14 row_mask:0xf bank_mask:0xf
  s_cmp_eq_u32 s75, 20
  s_cbranch_scc1 L_epi
  s_call_b64 s[62:63], L_vs
  s_cbranch_scc1 L_nl20
  v_add_u32_dpp v3, v30, v38 row_newbcast:4 row_mask:0xf bank_mask:0xf
  buffer_load_dwordx4 v[120:123], v3, s[48:51], 0 offen nt
L_nl20:
  v_dot2c_f32_bf16_dpp v8, v29, v100 row_newbcast:15 row_mask:0xf bank_mask:0xf
  v_dot2c_f32_bf16_dpp v9, v34, v100 row_newbcast:15 row_mask:0xf bank_mask:0xf
  v_dot2c_f32_bf16_dpp v10, v29, v101 row_newbcast:15 row_mask:0xf bank_mask:0xf
  v_dot2c_f32_bf16_dpp v11, v34, v101 row_newbcast:15 row_mask:0xf bank_mask:0xf
  v_dot2c_f32_bf16_dpp v12, v29, v102 row_newbcast:15 row_mask:0xf bank_mask:0xf
  v_dot2c_f32_bf16_dpp v13, v34, v102 row_newbcast:15 row_mask:0xf bank_mask:0xf
  v_dot2c_f32_bf16_dpp v14, v29, v103 row_newbcast:15 row_mask:0xf bank_mask:0xf
  v_dot2c_f32_bf16_dpp v15, v34, v103 row_newbcast:15 row_mask:0xf bank_mask:0xf
  s_cmp_eq_u32 s75, 21
  s_cbranch_scc1 L_epi
  s_call_b64 s[62:63], L_vs
  s_cbranch_scc1 L_nl21
  v_add_u32_dpp v3, v30, v38 row_newbcast:5 row_mask:0xf bank_mask:0xf
  buffer_load_dwordx4 v[124:127], v3, s[48:51], 0 offen nt
L_nl21:
  v_dot2c_f32_bf16_dpp v8, v31, v104 row_newbcast:0 row_mask:0xf bank_mask:0xf
  v_dot2c_f32_bf16_dpp v9, v35, v104 row_newbcast:0 row_mask:0xf bank_mask:0xf
  v_dot2c_f32_bf16_dpp v10, v31, v105 row_newbcast:0 row_mask:0xf bank_mask:0xf
  v_dot2c_f32_bf16_dpp v11, v35, v105 row_newbcast:0 row_mask:0xf bank_mask:0xf
  v_dot2c_f32_bf16_dpp v12, v31, v106 row_newbcast:0 row_mask:0xf bank_mask:0xf
  v_dot2c_f32_bf16_dpp v13, v35, v106 row_newbcast:0 row_mask:0xf bank_mask:0xf
  v_dot2c_f32_bf16_dpp v14, v31, v107 row_newbcast:0 row_mask:0xf bank_mask:0xf
  v_dot2c_f32_bf16_dpp v15, v35, v107 row_newbcast:0 row_mask:0xf bank_mask:0xf
  s_cmp_eq_u32 s75, 22
  s_cbranch_scc1 L_epi
  s_call_b64 s[62:63], L_vs
  s_cbranch_scc1 L_nl22
  v_add_u32_dpp v3, v30, v38 row_newbcast:6 row_mask:0xf bank_mask:0xf
  buffer_load_dwordx4 v[128:131], v3, s[48:51], 0 offen nt
L_nl22:
  v_dot2c_f32_bf16_dpp v8, v31, v108 row_newbcast:1 row_mask:0xf bank_mask:0xf
  v_dot2c_f32_bf16_dpp v9, v35, v108 row_newbcast:1 row_mask:0xf bank_mask:0xf
  v_dot2c_f32_bf16_dpp v10, v31, v109 row_newbcast:1 row_mask:0xf bank_mask:0xf
  v_dot2c_f32_bf16_dpp v11, v35, v109 row_newbcast:1 row_mask:0xf bank_mask:0xf
  v_dot2c_f32_bf16_dpp v12, v31, v110 row_newbcast:1 row_mask:0xf bank_mask:0xf
  v_dot2c_f32_bf16_dpp v13, v35, v110 row_newbcast:1 row_mask:0xf bank_mask:0xf
  v_dot2c_f32_bf16_dpp v14, v31, v111 row_newbcast:1 row_mask:0xf bank_mask:0xf
  v_dot2c_f32_bf16_dpp v15, v35, v111 row_newbcast:1 row_mask:0xf bank_mask:0xf
  s_cmp_eq_u32 s75, 23
  s_cbranch_scc1 L_epi
  s_call_b64 s[62:63], L_vs
  s_cbranch_scc1 L_nl23
  v_add_u32_dpp v3, v30, v38 row_newbcast:7 row_mask:0xf bank_mask:0xf
  buffer_load_dwordx4 v[132:135], v3, s[48:51], 0 offen nt
L_nl23:
  v_dot2c_f32_bf16_dpp v8, v31, v112 row_newbcast:2 row_mask:0xf bank_mask:0xf
  v_dot2c_f32_bf16_dpp v9, v35, v112 row_newbcast:2 row_mask:0xf bank_mask:0xf
  v_dot2c_f32_bf16_dpp v10, v31, v113 row_newbcast:2 row_mask:0xf bank_mask:0xf
  v_dot2c_f32_bf16_dpp v11, v35, v113 row_newbcast:2 row_mask:0xf bank_mask:0xf
  v_dot2c_f32_bf16_dpp v12, v31, v114 row_newbcast:2 row_mask:0xf bank_mask:0xf
  v_dot2c_f32_bf16_dpp v13, v35, v114 row_newbcast:2 row_mask:0xf bank_mask:0xf
  v_dot2c_f32_bf16_dpp v14, v31, v115 row_newbcast:2 row_mask:0xf bank_mask:0xf
  v_dot2c_f32_bf16_dpp v15, v35, v115 row_newbcast:2 row_mask:0xf bank_mask:0xf
  s_cmp_eq_u32 s75, 24
  s_cbranch_scc1 L_epi
  s_call_b64 s[62:63], L_vs
  s_cbranch_scc1 L_nl24
  v_add_u32_dpp v3, v30, v38 row_newbcast:8 row_mask:0xf bank_mask:0xf
  buffer_load_dwordx4 v[136:139], v3, s[48:51], 0 offen nt
L_nl24:
  v_dot2c_f32_bf16_dpp v8, v31, v116 row_newbcast:3 row_mask:0xf bank_mask:0xf
  v_dot2c_f32_bf16_dpp v9, v35, v116 row_newbcast:3 row_mask:0xf bank_mask:0xf
  v_dot2c_f32_bf16_dpp v10, v31, v117 row_newbcast:3 row_mask:0xf bank_mask:0xf
  v_dot2c_f32_bf16_dpp v11, v35, v117 row_newbcast:3 row_mask:0xf bank_mask:0xf
  v_dot2c_f32_bf16_dpp v12, v31, v118 row_newbcast:3 row_mask:0xf bank_mask:0xf
  v_dot2c_f32_bf16_dpp v13, v35, v118 row_newbcast:3 row_mask:0xf bank_mask:0xf
  v_dot2c_f32_bf16_dpp v14, v31, v119 row_newbcast:3 row_mask:0xf bank_mask:0xf
  v_dot2c_f32_bf16_dpp v15, v35, v119 row_newbcast:3 row_mask:0xf bank_mask:0xf
  s_cmp_eq_u32 s75, 25
  s_cbranch_scc1 L_epi
  s_call_b64 s[62:63], L_vs
  s_cbranch_scc1 L_nl25
  v_add_u32_dpp v3, v30, v38 row_newbcast:9 row_mask:0xf bank_mask:0xf
  buffer_load_dwordx4 v[140:143], v3, s[48:51], 0 offen nt
L_nl25:
  v_dot2c_f32_bf16_dpp v8, v31, v120 row_newbcast:4 row_mask:0xf bank_mask:0xf
  v_dot2c_f32_bf16_dpp v9, v35, v120 row_newbcast:4 row_mask:0xf bank_mask:0xf
  v_dot2c_f32_bf16_dpp v10, v31, v121 row_newbcast:4 row_mask:0xf bank_mask:0xf
  v_dot2c_f32_bf16_dpp v11, v35, v121 row_newbcast:4 row_mask:0xf bank_mask:0xf
  v_dot2c_f32_bf16_dpp v12, v31, v122 row_newbcast:4 row_mask:0xf bank_mask:0xf
  v_dot2c_f32_bf16_dpp v13, v35, v122 row_newbcast:4 row_mask:0xf bank_mask:0xf
  v_dot2c_f32_bf16_dpp v14, v31, v123 row_newbcast:4 row_mask:0xf bank_mask:0xf
  v_dot2c_f32_bf16_dpp v15, v35, v123 row_newbcast:4 row_mask:0xf bank_mask:0xf
  s_cmp_eq_u32 s75, 26
  s_cbranch_scc1 L_epi
  s_call_b64 s[62:63], L_vs
  s_cbranch_scc1 L_nl26
  v_add_u32_dpp v3, v30, v38 row_newbcast:10 row_mask:0xf bank_mask:0xf
  buffer_load_dwordx4 v[144:147], v3, s[48:51], 0 offen nt
L_nl26:
  v_dot2c_f32_bf16_dpp v8, v31, v124 row_newbcast:5 row_mask:0xf bank_mask:0xf
  v_dot2c_f32_bf16_dpp v9, v35, v124 row_newbcast:5 row_mask:0xf bank_mask:0xf
  v_dot2c_f32_bf16_dpp v10, v31, v125 row_newbcast:5 row_mask:0xf bank_mask:0xf
  v_dot2c_f32_bf16_dpp v11, v35, v125 row_newbcast:5 row_mask:0xf bank_mask:0xf
  v_dot2c_f32_bf16_dpp v12, v31, v126 row_newbcast:5 row_mask:0xf bank_mask:0xf
  v_dot2c_f32_bf16_dpp v13, v35, v126 row_newbcast:5 row_mask:0xf bank_mask:0xf
  v_dot2c_f32_bf16_dpp v14, v31, v127 row_newbcast:5 row_mask:0xf bank_mask:0xf
  v_dot2c_f32_bf16_dpp v15, v35, v127 row_newbcast:5 row_mask:0xf bank_mask:0xf
  s_cmp_eq_u32 s75, 27
  s_cbranch_scc1 L_epi
  s_call_b64 s[62:63], L_vs
  s_cbranch_scc1 L_nl27
  v_add_u32_dpp v3, v30, v38 row_newbcast:11 row_mask:0xf bank_mask:0xf
  buffer_load_dwordx4 v[148:151], v3, s[48:51], 0 offen nt
L_nl27:
  v_dot2c_f32_bf16_dpp v8, v31, v128 row_newbcast:6 row_mask:0xf bank_mask:0xf
  v_dot2c_f32_bf16_dpp v9, v35, v128 row_newbcast:6 row_mask:0xf bank_mask:0xf
  v_dot2c_f32_bf16_dpp v10, v31, v129 row_newbcast:6 row_mask:0xf bank_mask:0xf
  v_dot2c_f32_bf16_dpp v11, v35, v129 row_newbcast:6 row_mask:0xf bank_mask:0xf
  v_dot2c_f32_bf16_dpp v12, v31, v130 row_newbcast:6 row_mask:0xf bank_mask:0xf
  v_dot2c_f32_bf16_dpp v13, v35, v130 row_newbcast:6 row_mask:0xf bank_mask:0xf
  v_dot2c_f32_bf16_dpp v14, v31, v131 row_newbcast:6 row_mask:0xf bank_mask:0xf
  v_dot2c_f32_bf16_dpp v15, v35, v131 row_newbcast:6 row_mask:0xf bank_mask:0xf
  s_cmp_eq_u32 s75, 28
  s_cbranch_scc1 L_epi
  s_call_b64 s[62:63], L_vs
  s_cbranch_scc1 L_nl28
  v_add_u32_dpp v3, v30, v38 row_newbcast:12 row_mask:0xf bank_mask:0xf
  buffer_load_dwordx4 v[152:155], v3, s[48:51], 0 offen nt
L_nl28:
  v_dot2c_f32_bf16_dpp v8, v31, v132 row_newbcast:7 row_mask:0xf bank_mask:0xf
  v_dot2c_f32_bf16_dpp v9, v35, v132 row_newbcast:7 row_mask:0xf bank_mask:0xf
  v_dot2c_f32_bf16_dpp v10, v31, v133 row_newbcast:7 row_mask:0xf bank_mask:0xf
  v_dot2c_f32_bf16_dpp v11, v35, v133 row_newbcast:7 row_mask:0xf bank_mask:0xf
  v_dot2c_f32_bf16_dpp v12, v31, v134 row_newbcast:7 row_mask:0xf bank_mask:0xf
  v_dot2c_f32_bf16_dpp v13, v35, v134 row_newbcast:7 row_mask:0xf bank_mask:0xf
  v_dot2c_f32_bf16_dpp v14, v31, v135 row_newbcast:7 row_mask:0xf bank_mask:0xf
  v_dot2c_f32_bf16_dpp v15, v35, v135 row_newbcast:7 row_mask:0xf bank_mask:0xf
  s_cmp_eq_u32 s75, 29
  s_cbranch_scc1 L_epi
  s_call_b64 s[62:63], L_vs
  s_cbranch_scc1 L_nl29
  v_add_u32_dpp v3, v30, v38 row_newbcast:13 row_mask:0xf bank_mask:0xf
  buffer_load_dwordx4 v[156:159], v3, s[48:51], 0 offen nt
L_nl29:
  v_dot2c_f32_bf16_dpp v8, v31, v136 row_newbcast:8 row_mask:0xf bank_mask:0xf
  v_dot2c_f32_bf16_dpp v9, v35, v136 row_newbcast:8 row_mask:0xf bank_mask:0xf
  v_dot2c_f32_bf16_dpp v10, v31, v137 row_newbcast:8 row_mask:0xf bank_mask:0xf
  v_dot2c_f32_bf16_dpp v11, v35, v137 row_newbcast:8 row_mask:0xf bank_mask:0xf
  v_dot2c_f32_bf16_dpp v12, v31, v138 row_newbcast:8 row_mask:0xf bank_mask:0xf
  v_dot2c_f32_bf16_dpp v13, v35, v138 row_newbcast:8 row_mask:0xf bank_mask:0xf
  v_dot2c_f32_bf16_dpp v14, v31, v139 row_newbcast:8 row_mask:0xf bank_mask:0xf
  v_dot2c_f32_bf16_dpp v15, v35, v139 row_newbcast:8 row_mask:0xf bank_mask:0xf
  s_cmp_eq_u32 s75, 30
  s_cbranch_scc1 L_epi
  s_call_b64 s[62:63], L_vs
  s_cbranch_scc1 L_nl30
  v_add_u32_dpp v3, v30, v38 row_newbcast:14 row_mask:0xf bank_mask:0xf
  buffer_load_dwordx4 v[160:163], v3, s[48:51], 0 offen nt
L_nl30:
  v_dot2c_f32_bf16_dpp v8, v31, v140 row_newbcast:9 row_mask:0xf bank_mask:0xf
  v_dot2c_f32_bf16_dpp v9, v35, v140 row_newbcast:9 row_mask:0xf bank_mask:0xf
  v_dot2c_f32_bf16_dpp v10, v31, v141 row_newbcast:9 row_mask:0xf bank_mask:0xf
  v_dot2c_f32_bf16_dpp v11, v35, v141 row_newbcast:9 row_mask:0xf bank_mask:0xf
  v_dot2c_f32_bf16_dpp v12, v31, v142 row_newbcast:9 row_mask:0xf bank_mask:0xf
  v_dot2c_f32_bf16_dpp v13, v35, v142 row_newbcast:9 row_mask:0xf bank_mask:0xf
  v_dot2c_f32_bf16_dpp v14, v31, v143 row_newbcast:9 row_mask:0xf bank_mask:0xf
  v_dot2c_f32_bf16_dpp v15, v35, v143 row_newbcast:9 row_mask:0xf bank_mask:0xf
  s_cmp_eq_u32 s75, 31
  s_cbranch_scc1 L_epi
  s_call_b64 s[62:63], L_vs
  s_cbranch_scc1 L_nl31
  v_add_u32_dpp v3, v30, v38 row_newbcast:15 row_mask:0xf bank_mask:0xf
  buffer_load_dwordx4 v[164:167], v3, s[48:51], 0 offen nt
L_nl31:
  v_dot2c_f32_bf16_dpp v8, v31, v144 row_newbcast:10 row_mask:0xf bank_mask:0xf
  v_dot2c_f32_bf16_dpp v9, v35, v144 row_newbcast:10 row_mask:0xf bank_mask:0xf
  v_dot2c_f32_bf16_dpp v10, v31, v145 row_newbcast:10 row_mask:0xf bank_mask:0xf
  v_dot2c_f32_bf16_dpp v11, v35, v145 row_newbcast:10 row_mask:0xf bank_mask:0xf
  v_dot2c_f32_bf16_dpp v12, v31, v146 row_newbcast:10 row_mask:0xf bank_mask:0xf
  v_dot2c_f32_bf16_dpp v13, v35, v146 row_newbcast:10 row_mask:0xf bank_mask:0xf
  v_dot2c_f32_bf16_dpp v14, v31, v147 row_newbcast:10 row_mask:0xf bank_mask:0xf
  v_dot2c_f32_bf16_dpp v15, v35, v147 row_newbcast:10 row_mask:0xf bank_mask:0xf
  s_cmp_eq_u32 s75, 32
  s_cbranch_scc1 L_epi
  s_call_b64 s[62:63], L_vs
  s_cbranch_scc1 L_nl32
  v_add_u32_dpp v3, v32, v38 row_newbcast:0 row_mask:0xf bank_mask:0xf
  buffer_load_dwordx4 v[40:43], v3, s[48:51], 0 offen nt
L_nl32:
  v_dot2c_f32_bf16_dpp v8, v31, v148 row_newbcast:11 row_mask:0xf bank_mask:0xf
  v_dot2c_f32_bf16_dpp v9, v35, v148 row_newbcast:11 row_mask:0xf bank_mask:0xf
  v_dot2c_f32_bf16_dpp v10, v31, v149 row_newbcast:11 row_mask:0xf bank_mask:0xf
  v_dot2c_f32_bf16_dpp v11, v35, v149 row_newbcast:11 row_mask:0xf bank_mask:0xf
  v_dot2c_f32_bf16_dpp v12, v31, v150 row_newbcast:11 row_mask:0xf bank_mask:0xf
  v_dot2c_f32_bf16_dpp v13, v35, v150 row_newbcast:11 row_mask:0xf bank_mask:0xf
  v_dot2c_f32_bf16_dpp v14, v31, v151 row_newbcast:11 row_mask:0xf bank_mask:0xf
  v_dot2c_f32_bf16_dpp v15, v35, v151 row_newbcast:11 row_mask:0xf bank_mask:0xf
  s_cmp_eq_u32 s75, 33
  s_cbranch_scc1 L_epi
  s_call_b64 s[62:63], L_vs
  s_cbranch_scc1 L_nl33
  v_add_u32_dpp v3, v32, v38 row_newbcast:1 row_mask:0xf bank_mask:0xf
  buffer_load_dwordx4 v[44:47], v3, s[48:51], 0 offen nt
L_nl33:
  v_dot2c_f32_bf16_dpp v8, v31, v152 row_newbcast:12 row_mask:0xf bank_mask:0xf
  v_dot2c_f32_bf16_dpp v9, v35, v152 row_newbcast:12 row_mask:0xf bank_mask:0xf
  v_dot2c_f32_bf16_dpp v10, v31, v153 row_newbcast:12 row_mask:0xf bank_mask:0xf
  v_dot2c_f32_bf16_dpp v11, v35, v153 row_newbcast:12 row_mask:0xf bank_mask:0xf
  v_dot2c_f32_bf16_dpp v12, v31, v154 row_newbcast:12 row_mask:0xf bank_mask:0xf
  v_dot2c_f32_bf16_dpp v13, v35, v154 row_newbcast:12 row_mask:0xf bank_mask:0xf
  v_dot2c_f32_bf16_dpp v14, v31, v155 row_newbcast:12 row_mask:0xf bank_mask:0xf
  v_dot2c_f32_bf16_dpp v15, v35, v155 row_newbcast:12 row_mask:0xf bank_mask:0xf
  s_cmp_eq_u32 s75, 34
  s_cbranch_scc1 L_epi
  s_call_b64 s[62:63], L_vs
  s_cbranch_scc1 L_nl34
  v_add_u32_dpp v3, v32, v38 row_newbcast:2 row_mask:0xf bank_mask:0xf
  buffer_load_dwordx4 v[48:51], v3, s[48:51], 0 offen nt
L_nl34:
  v_dot2c_f32_bf16_dpp v8, v31, v156 row_newbcast:13 row_mask:0xf bank_mask:0xf
  v_dot2c_f32_bf16_dpp v9, v35, v156 row_newbcast:13 row_mask:0xf bank_mask:0xf
  v_dot2c_f32_bf16_dpp v10, v31, v157 row_newbcast:13 row_mask:0xf bank_mask:0xf
  v_dot2c_f32_bf16_dpp v11, v35, v157 row_newbcast:13 row_mask:0xf bank_mask:0xf
  v_dot2c_f32_bf16_dpp v12, v31, v158 row_newbcast:13 row_mask:0xf bank_mask:0xf
  v_dot2c_f32_bf16_dpp v13, v35, v158 row_newbcast:13 row_mask:0xf bank_mask:0xf
  v_dot2c_f32_bf16_dpp v14, v31, v159 row_newbcast:13 row_mask:0xf bank_mask:0xf
  v_dot2c_f32_bf16_dpp v15, v35, v159 row_newbcast:13 row_mask:0xf bank_mask:0xf
  s_cmp_eq_u32 s75, 35
  s_cbranch_scc1 L_epi
  s_call_b64 s[62:63], L_vs
  s_cbranch_scc1 L_nl35
  v_add_u32_dpp v3, v32, v38 row_newbcast:3 row_mask:0xf bank_mask:0xf
  buffer_load_dwordx4 v[52:55], v3, s[48:51], 0 offen nt
L_nl35:
  v_dot2c_f32_bf16_dpp v8, v31, v160 row_newbcast:14 row_mask:0xf bank_mask:0xf
  v_dot2c_f32_bf16_dpp v9, v35, v160 row_newbcast:14 row_mask:0xf bank_mask:0xf
  v_dot2c_f32_bf16_dpp v10, v31, v161 row_newbcast:14 row_mask:0xf bank_mask:0xf
  v_dot2c_f32_bf16_dpp v11, v35, v161 row_newbcast:14 row_mask:0xf bank_mask:0xf
  v_dot2c_f32_bf16_dpp v12, v31, v162 row_newbcast:14 row_mask:0xf bank_mask:0xf
  v_dot2c_f32_bf16_dpp v13, v35, v162 row_newbcast:14 row_mask:0xf bank_mask:0xf
  v_dot2c_f32_bf16_dpp v14, v31, v163 row_newbcast:14 row_mask:0xf bank_mask:0xf
  v_dot2c_f32_bf16_dpp v15, v35, v163 row_newbcast:14 row_mask:0xf bank_mask:0xf
  s_cmp_eq_u32 s75, 36
  s_cbranch_scc1 L_epi
  s_call_b64 s[62:63], L_vs
  s_cbranch_scc1 L_nl36
  v_add_u32_dpp v3, v32, v38 row_newbcast:4 row_mask:0xf bank_mask:0xf
  buffer_load_dwordx4 v[56:59], v3, s[48:51], 0 offen nt
L_nl36:
  v_dot2c_f32_bf16_dpp v8, v31, v164 row_newbcast:15 row_mask:0xf bank_mask:0xf
  v_dot2c_f32_bf16_dpp v9, v35, v164 row_newbcast:15 row_mask:0xf bank_mask:0xf
  v_dot2c_f32_bf16_dpp v10, v31, v165 row_newbcast:15 row_mask:0xf bank_mask:0xf
  v_dot2c_f32_bf16_dpp v11, v35, v165 row_newbcast:15 row_mask:0xf bank_mask:0xf
  v_dot2c_f32_bf16_dpp v12, v31, v166 row_newbcast:15 row_mask:0xf bank_mask:0xf
  v_dot2c_f32_bf16_dpp v13, v35, v166 row_newbcast:15 row_mask:0xf bank_mask:0xf
  v_dot2c_f32_bf16_dpp v14, v31, v167 row_newbcast:15 row_mask:0xf bank_mask:0xf
  v_dot2c_f32_bf16_dpp v15, v35, v167 row_newbcast:15 row_mask:0xf bank_mask:0xf
  s_cmp_eq_u32 s75, 37
  s_cbranch_scc1 L_epi
  s_call_b64 s[62:63], L_vs
  s_cbranch_scc1 L_nl37
  v_add_u32_dpp v3, v32, v38 row_newbcast:5 row_mask:0xf bank_mask:0xf
  buffer_load_dwordx4 v[60:63], v3, s[48:51], 0 offen nt
L_nl37:
  v_dot2c_f32_bf16_dpp v8, v33, v40 row_newbcast:0 row_mask:0xf bank_mask:0xf
  v_dot2c_f32_bf16_dpp v9, v36, v40 row_newbcast:0 row_mask:0xf bank_mask:0xf
  v_dot2c_f32_bf16_dpp v10, v33, v41 row_newbcast:0 row_mask:0xf bank_mask:0xf
  v_dot2c_f32_bf16_dpp v11, v36, v41 row_newbcast:0 row_mask:0xf bank_mask:0xf
  v_dot2c_f32_bf16_dpp v12, v33, v42 row_newbcast:0 row_mask:0xf bank_mask:0xf
  v_dot2c_f32_bf16_dpp v13, v36, v42 row_newbcast:0 row_mask:0xf bank_mask:0xf
  v_dot2c_f32_bf16_dpp v14, v33, v43 row_newbcast:0 row_mask:0xf bank_mask:0xf
  v_dot2c_f32_bf16_dpp v15, v36, v43 row_newbcast:0 row_mask:0xf bank_mask:0xf
  s_cmp_eq_u32 s75, 38
  s_cbranch_scc1 L_epi
  s_call_b64 s[62:63], L_vs
  v_dot2c_f32_bf16_dpp v8, v33, v44 row_newbcast:1 row_mask:0xf bank_mask:0xf
  v_dot2c_f32_bf16_dpp v9, v36, v44 row_newbcast:1 row_mask:0xf bank_mask:0xf
  v_dot2c_f32_bf16_dpp v10, v33, v45 row_newbcast:1 row_mask:0xf bank_mask:0xf
  v_dot2c_f32_bf16_dpp v11, v36, v45 row_newbcast:1 row_mask:0xf bank_mask:0xf
  v_dot2c_f32_bf16_dpp v12, v33, v46 row_newbcast:1 row_mask:0xf bank_mask:0xf
  v_dot2c_f32_bf16_dpp v13, v36, v46 row_newbcast:1 row_mask:0xf bank_mask:0xf
  v_dot2c_f32_bf16_dpp v14, v33, v47 row_newbcast:1 row_mask:0xf bank_mask:0xf
  v_dot2c_f32_bf16_dpp v15, v36, v47 row_newbcast:1 row_mask:0xf bank_mask:0xf
  s_cmp_eq_u32 s75, 39
  s_cbranch_scc1 L_epi
  s_call_b64 s[62:63], L_vs
  v_dot2c_f32_bf16_dpp v8, v33, v48 row_newbcast:2 row_mask:0xf bank_mask:0xf
  v_dot2c_f32_bf16_dpp v9, v36, v48 row_newbcast:2 row_mask:0xf bank_mask:0xf
  v_dot2c_f32_bf16_dpp v10, v33, v49 row_newbcast:2 row_mask:0xf bank_mask:0xf
  v_dot2c_f32_bf16_dpp v11, v36, v49 row_newbcast:2 row_mask:0xf bank_mask:0xf
  v_dot2c_f32_bf16_dpp v12, v33, v50 row_newbcast:2 row_mask:0xf bank_mask:0xf
  v_dot2c_f32_bf16_dpp v13, v36, v50 row_newbcast:2 row_mask:0xf bank_mask:0xf
  v_dot2c_f32_bf16_dpp v14, v33, v51 row_newbcast:2 row_mask:0xf bank_mask:0xf
  v_dot2c_f32_bf16_dpp v15, v36, v51 row_newbcast:2 row_mask:0xf bank_mask:0xf
  s_cmp_eq_u32 s75, 40
  s_cbranch_scc1 L_epi
  s_call_b64 s[62:63], L_vs
  v_dot2c_f32_bf16_dpp v8, v33, v52 row_newbcast:3 row_mask:0xf bank_mask:0xf
  v_dot2c_f32_bf16_dpp v9, v36, v52 row_newbcast:3 row_mask:0xf bank_mask:0xf
  v_dot2c_f32_bf16_dpp v10, v33, v53 row_newbcast:3 row_mask:0xf bank_mask:0xf
  v_dot2c_f32_bf16_dpp v11, v36, v53 row_newbcast:3 row_mask:0xf bank_mask:0xf
  v_dot2c_f32_bf16_dpp v12, v33, v54 row_newbcast:3 row_mask:0xf bank_mask:0xf
  v_dot2c_f32_bf16_dpp v13, v36, v54 row_newbcast:3 row_mask:0xf bank_mask:0xf
  v_dot2c_f32_bf16_dpp v14, v33, v55 row_newbcast:3 row_mask:0xf bank_mask:0xf
  v_dot2c_f32_bf16_dpp v15, v36, v55 row_newbcast:3 row_mask:0xf bank_mask:0xf
  s_cmp_eq_u32 s75, 41
  s_cbranch_scc1 L_epi
  s_call_b64 s[62:63], L_vs
  v_dot2c_f32_bf16_dpp v8, v33, v56 row_newbcast:4 row_mask:0xf bank_mask:0xf
  v_dot2c_f32_bf16_dpp v9, v36, v56 row_newbcast:4 row_mask:0xf bank_mask:0xf
  v_dot2c_f32_bf16_dpp v10, v33, v57 row_newbcast:4 row_mask:0xf bank_mask:0xf
  v_dot2c_f32_bf16_dpp v11, v36, v57 row_newbcast:4 row_mask:0xf bank_mask:0xf
  v_dot2c_f32_bf16_dpp v12, v33, v58 row_newbcast:4 row_mask:0xf bank_mask:0xf
  v_dot2c_f32_bf16_dpp v13, v36, v58 row_newbcast:4 row_mask:0xf bank_mask:0xf
  v_dot2c_f32_bf16_dpp v14, v33, v59 row_newbcast:4 row_mask:0xf bank_mask:0xf
  v_dot2c_f32_bf16_dpp v15, v36, v59 row_newbcast:4 row_mask:0xf bank_mask:0xf
  s_cmp_eq_u32 s75, 42
  s_cbranch_scc1 L_epi
  s_call_b64 s[62:63], L_vs
  v_dot2c_f32_bf16_dpp v8, v33, v60 row_newbcast:5 row_mask:0xf bank_mask:0xf
  v_dot2c_f32_bf16_dpp v9, v36, v60 row_newbcast:5 row_mask:0xf bank_mask:0xf
  v_dot2c_f32_bf16_dpp v10, v33, v61 row_newbcast:5 row_mask:0xf bank_mask:0xf
  v_dot2c_f32_bf16_dpp v11, v36, v61 row_newbcast:5 row_mask:0xf bank_mask:0xf
  v_dot2c_f32_bf16_dpp v12, v33, v62 row_newbcast:5 row_mask:0xf bank_mask:0xf
  v_dot2c_f32_bf16_dpp v13, v36, v62 row_newbcast:5 row_mask:0xf bank_mask:0xf
  v_dot2c_f32_bf16_dpp v14, v33, v63 row_newbcast:5 row_mask:0xf bank_mask:0xf
  v_dot2c_f32_bf16_dpp v15, v36, v63 row_newbcast:5 row_mask:0xf bank_mask:0xf
  s_nop 1
L_epi:
  s_nop 0
  s_nop 0
  v_permlane32_swap_b32 v8, v12
  v_permlane32_swap_b32 v9, v13
  v_permlane32_swap_b32 v10, v14
  v_permlane32_swap_b32 v11, v15
  v_add_f32 v8, v8, v12
  v_add_f32 v9, v9, v13
  v_add_f32 v10, v10, v14
  v_add_f32 v11, v11, v15
  v_mov_b32 v3, 1
  v_permlane16_swap_b32 v8, v10
  v_permlane16_swap_b32 v9, v11
  v_add_f32 v8, v8, v10
  v_add_f32 v9, v9, v11
  v_pk_add_f32 v[8:9], v[8:9], v[4:5]
  ds_write_b64 v22, v[8:9] offset:7936
  s_cmp_eq_u32 s21, 0
  s_cbranch_scc1 L_ep2
  ds_write_b64 v22, v[8:9] offset:13056
  s_mov_b64 exec, 1
  ds_add_u32 v1, v3 offset:6704
  s_mov_b64 exec, -1
L_ep2:
  s_mov_b64 exec, 1
  ds_add_rtn_u32 v3, v1, v3 offset:6708
  s_mov_b64 exec, -1
  v_mov_b32 v4, 0
  s_lshl_b32 s10, s6, 11
  s_add_u32 s10, s10, 131072
  v_lshl_add_u32 v2, v1, 3, s10
  v_add_u32 v0, 393216, v2
  s_waitcnt lgkmcnt(0)
  v_readfirstlane_b32 s68, v3
  s_cmp_lg_u32 s68, 9
  s_cbranch_scc1 L_send
  s_cmp_lg_u32 s7, 0
  s_cbranch_scc1 L_nolook
  global_load_dwordx2 v[42:43], v0, s[42:43] offset:512 sc1
  global_load_dwordx2 v[44:45], v0, s[42:43] offset:1024 sc1
  global_load_dwordx2 v[46:47], v0, s[42:43] offset:1536 sc1
  global_load_dwordx2 v[48:49], v2, s[42:43] offset:0 sc1
  global_load_dwordx2 v[50:51], v2, s[42:43] offset:512 sc1
  global_load_dwordx2 v[52:53], v2, s[42:43] offset:1024 sc1
  global_load_dwordx2 v[54:55], v2, s[42:43] offset:1536 sc1
L_nolook:
  s_mov_b32 s70, 0
L_pl_1:
  ds_read_b32 v5, v4 offset:6656
  s_waitcnt lgkmcnt(0)
  v_cmp_eq_u32 vcc, -1, v5
  s_cmp_eq_u64 vcc, 0
  s_cbranch_scc1 L_pld_2
  s_sleep 1
  s_add_u32 s70, s70, 1
  s_cmp_lt_u32 s70, 1048576
  s_cbranch_scc1 L_pl_1
L_pld_2:
  v_lshlrev_b32 v160, 3, v1
  ds_read_b128 v[148:151], v4 offset:6784
  ds_read_b128 v[152:155], v4 offset:6800
  ds_read_b128 v[156:159], v4 offset:6816
  ds_read_b64 v[128:129], v160 offset:7936
  ds_read_b64 v[130:131], v160 offset:8448
  ds_read_b64 v[132:133], v160 offset:8960
  ds_read_b64 v[134:135], v160 offset:9472
  ds_read_b64 v[136:137], v160 offset:9984
  ds_read_b64 v[138:139], v160 offset:10496
  ds_read_b64 v[140:141], v160 offset:11008
  ds_read_b64 v[142:143], v160 offset:11520
  ds_read_b64 v[144:145], v160 offset:12032
  ds_read_b64 v[146:147], v160 offset:12544
  s_lshl_b32 s68, s6, 2
  s_add_u32 s68, s68, s7
  s_lshl_b32 s68, s68, 9
  s_add_u32 s68, s68, 524288
  v_add_u32 v160, s68, v160
  v_and_b32 v161, 1, v1
  v_lshlrev_b32 v161, 4, v161
  v_lshrrev_b32 v161, v161, s74
  v_lshrrev_b32 v162, 8, v161
  s_movk_i32 s69, 0xff
  s_waitcnt lgkmcnt(9)
  v_pk_mul_f32 v[128:129], v[128:129], v[148:149] op_sel:[0,0] op_sel_hi:[1,0]
  s_waitcnt lgkmcnt(8)
  v_pk_mul_f32 v[130:131], v[130:131], v[148:149] op_sel:[0,1] op_sel_hi:[1,1]
  s_waitcnt lgkmcnt(7)
  v_pk_fma_f32 v[128:129], v[132:133], v[150:151], v[128:129] op_sel:[0,0,0] op_sel_hi:[1,0,1]
  s_waitcnt lgkmcnt(6)
  v_pk_fma_f32 v[130:131], v[134:135], v[150:151], v[130:131] op_sel:[0,1,0] op_sel_hi:[1,1,1]
  s_waitcnt lgkmcnt(5)
  v_pk_fma_f32 v[128:129], v[136:137], v[152:153], v[128:129] op_sel:[0,0,0] op_sel_hi:[1,0,1]
  s_waitcnt lgkmcnt(4)
  v_pk_fma_f32 v[130:131], v[138:139], v[152:153], v[130:131] op_sel:[0,1,0] op_sel_hi:[1,1,1]
  s_waitcnt lgkmcnt(3)
  v_pk_fma_f32 v[128:129], v[140:141], v[154:155], v[128:129] op_sel:[0,0,0] op_sel_hi:[1,0,1]
  s_waitcnt lgkmcnt(2)
  v_pk_fma_f32 v[130:131], v[142:143], v[154:155], v[130:131] op_sel:[0,1,0] op_sel_hi:[1,1,1]
  s_waitcnt lgkmcnt(1)
  v_pk_fma_f32 v[128:129], v[144:145], v[156:157], v[128:129] op_sel:[0,0,0] op_sel_hi:[1,0,1]
  s_waitcnt lgkmcnt(0)
  v_pk_fma_f32 v[130:131], v[146:147], v[156:157], v[130:131] op_sel:[0,1,0] op_sel_hi:[1,1,1]
  v_pk_add_f32 v[128:129], v[128:129], v[130:131]
  v_bfi_b32 v128, s69, v161, v128
  v_bfi_b32 v129, s69, v162, v129
  global_store_dwordx2 v160, v[128:129], s[42:43] sc1
  s_cmp_lg_u32 s7, 0
  s_cbranch_scc1 L_send
  v_and_b32 v161, 0xff, v161
  v_and_b32 v162, 0xff, v162
  s_mov_b32 s70, 0
  s_waitcnt vmcnt(1)
  s_branch L_cp1
L_cp0:
  global_load_dwordx2 v[42:43], v0, s[42:43] offset:512 sc1
  global_load_dwordx2 v[44:45], v0, s[42:43] offset:1024 sc1
  global_load_dwordx2 v[46:47], v0, s[42:43] offset:1536 sc1
  global_load_dwordx2 v[48:49], v2, s[42:43] offset:0 sc1
  global_load_dwordx2 v[50:51], v2, s[42:43] offset:512 sc1
  global_load_dwordx2 v[52:53], v2, s[42:43] offset:1024 sc1
  global_load_dwordx2 v[54:55], v2, s[42:43] offset:1536 sc1
  s_waitcnt vmcnt(0)
L_cp1:
  v_xor_b32 v48, v48, v161
  v_xor_b32 v49, v49, v162
  v_xor_b32 v50, v50, v161
  v_xor_b32 v51, v51, v162
  v_xor_b32 v52, v52, v161
  v_xor_b32 v53, v53, v162
  v_xor_b32 v54, v54, v161
  v_xor_b32 v55, v55, v162
  v_or3_b32 v56, v48, v49, v50
  v_or3_b32 v57, v51, v52, v53
  v_or3_b32 v56, v56, v54, v55
  v_or_b32 v48, 0x80, v48
  v_or_b32 v49, 0x80, v49
  v_or_b32 v50, 0x80, v50
  v_or_b32 v51, 0x80, v51
  v_or_b32 v52, 0x80, v52
  v_or_b32 v53, 0x80, v53
  v_or_b32 v54, 0x80, v54
  v_or_b32 v55, 0x80, v55
  v_or_b32 v56, v56, v57
  v_pk_add_f32 v[48:49], v[48:49], v[52:53]
  v_pk_add_f32 v[50:51], v[50:51], v[54:55]
  v_lshlrev_b32 v56, 24, v56
  v_pk_add_f32 v[48:49], v[48:49], v[50:51]
  v_cmp_ne_u32 vcc, 0, v56
  v_cvt_pk_bf16_f32 v48, v48, v49
  s_cmp_eq_u64 vcc, 0
  s_cbranch_scc1 L_cp2
  s_sleep 4
  s_add_u32 s70, s70, 1
  s_cmp_lt_u32 s70, 262144
  s_cbranch_scc1 L_cp0
L_cp2:
  s_mov_b32 s70, 0
  s_branch L_cp4
L_cp3:
  global_load_dwordx2 v[42:43], v0, s[42:43] offset:512 sc1
  global_load_dwordx2 v[44:45], v0, s[42:43] offset:1024 sc1
  global_load_dwordx2 v[46:47], v0, s[42:43] offset:1536 sc1
  s_waitcnt vmcnt(0)
L_cp4:
  v_mov_b32 v40, v128
  v_mov_b32 v41, v129
  v_xor_b32 v40, v40, v161
  v_xor_b32 v41, v41, v162
  v_xor_b32 v42, v42, v161
  v_xor_b32 v43, v43, v162
  v_xor_b32 v44, v44, v161
  v_xor_b32 v45, v45, v162
  v_xor_b32 v46, v46, v161
  v_xor_b32 v47, v47, v162
  v_or3_b32 v56, v40, v41, v42
  v_or3_b32 v57, v43, v44, v45
  v_or3_b32 v56, v56, v46, v47
  v_or_b32 v40, 0x80, v40
  v_or_b32 v41, 0x80, v41
  v_or_b32 v42, 0x80, v42
  v_or_b32 v43, 0x80, v43
  v_or_b32 v44, 0x80, v44
  v_or_b32 v45, 0x80, v45
  v_or_b32 v46, 0x80, v46
  v_or_b32 v47, 0x80, v47
  v_or_b32 v56, v56, v57
  v_pk_add_f32 v[40:41], v[40:41], v[44:45]
  v_pk_add_f32 v[42:43], v[42:43], v[46:47]
  v_lshlrev_b32 v56, 24, v56
  v_pk_add_f32 v[40:41], v[40:41], v[42:43]
  v_cmp_ne_u32 vcc, 0, v56
  v_cvt_pk_bf16_f32 v40, v40, v41
  s_cmp_eq_u64 vcc, 0
  s_cbranch_scc1 L_cp5
  s_add_u32 s70, s70, 1
  s_cmp_lt_u32 s70, 262144
  s_cbranch_scc1 L_cp3
L_cp5:
  v_cmp_ne_u32 vcc, v40, v48
  s_cmp_lg_u64 vcc, 0
  s_cbranch_scc1 L_slow
L_send:
  s_endpgm
L_away:
  v_mov_b32 v4, 1
  v_lshlrev_b32 v5, 6, v4
  v_mul_i32_i24 v6, -28, v4
  s_mov_b64 exec, 1
  ds_add_u32 v1, v5 offset:6680
  ds_add_u32 v1, v5 offset:6672
  ds_add_u32 v1, v4 offset:6704
  ds_add_u32 v1, v4 offset:6708
  ds_add_u32 v1, v6 offset:6688
  s_mov_b64 exec, -1
  v_mov_b32 v3, 0
  s_mov_b32 s70, 0
L_aw_3:
  ds_read_b32 v4, v3 offset:6688
  s_waitcnt lgkmcnt(0)
  v_cmp_lt_u32 vcc, 1120, v4
  s_cmp_eq_u64 vcc, 0
  s_cbranch_scc1 L_aw_3d
  s_sleep 8
  s_add_u32 s70, s70, 1
  s_cmp_lt_u32 s70, 2097152
  s_cbranch_scc1 L_aw_3
L_aw_3d:
  s_mov_b32 s32, 16
  s_mov_b32 s10, 0
L_aw2:
  s_call_b64 s[100:101], L_work
  s_sleep 4
  s_add_u32 s10, s10, 1
  s_cmp_ge_u32 s10, 262144
  s_cbranch_scc1 L_end
  s_cmp_lt_u32 s39, 2
  s_cbranch_scc1 L_aw2
  s_bfe_u32 s61, s15, 0x60008
  s_cmp_lg_u32 s9, 7
  s_cbranch_scc1 L_end
  s_cmp_ge_u32 s61, 32
  s_cbranch_scc1 L_end
  s_waitcnt lgkmcnt(0)
  s_load_dwordx2 s[16:17], s[0:1], 0
  s_load_dwordx2 s[38:39], s[0:1], 88
  v_mov_b32 v38, 0
  s_mov_b32 s60, 3
  s_waitcnt vmcnt(0) lgkmcnt(0)
  s_branch L_mid
L_slow:
  s_load_dwordx16 s[16:31], s[0:1], 0
  s_load_dwordx8 s[32:39], s[0:1], 64
  v_and_b32 v2, 31, v1
  v_lshlrev_b32 v2, 7, v2
  v_add_u32 v2, 28672, v2
  s_mov_b32 s70, 0
L_sl_d:
  global_load_dword v3, v2, s[42:43] sc1
  s_waitcnt vmcnt(0) lgkmcnt(0)
  v_cmp_ne_u32 vcc, s74, v3
  s_cmp_eq_u64 vcc, 0
  s_cbranch_scc1 L_sl_dd
  s_sleep 8
  s_add_u32 s70, s70, 1
  s_cmp_lt_u32 s70, 262144
  s_cbranch_scc1 L_sl_d
L_sl_dd:
  v_lshlrev_b32 v2, 3, v1
  v_add_u32 v2, 524288, v2
  v_lshlrev_b32 v0, 2, v1
  v_add_u32 v0, 83968, v0
  s_mov_b32 s10, 0
L_sl_h:
  s_mov_b32 s70, 0
L_sl_hp:
  global_load_dwordx2 v[40:41], v2, s[42:43] offset:0 sc1
  global_load_dwordx2 v[42:43], v2, s[42:43] offset:512 sc1
  global_load_dwordx2 v[44:45], v2, s[42:43] offset:1024 sc1
  global_load_dwordx2 v[46:47], v2, s[42:43] offset:1536 sc1
  s_waitcnt vmcnt(0)
  v_xor_b32 v40, v40, v161
  v_xor_b32 v41, v41, v162
  v_xor_b32 v42, v42, v161
  v_xor_b32 v43, v43, v162
  v_xor_b32 v44, v44, v161
  v_xor_b32 v45, v45, v162
  v_xor_b32 v46, v46, v161
  v_xor_b32 v47, v47, v162
  v_or3_b32 v48, v40, v41, v42
  v_or3_b32 v49, v43, v44, v45
  v_or3_b32 v48, v48, v46, v47
  v_or_b32 v40, 0x80, v40
  v_or_b32 v41, 0x80, v41
  v_or_b32 v42, 0x80, v42
  v_or_b32 v43, 0x80, v43
  v_or_b32 v44, 0x80, v44
  v_or_b32 v45, 0x80, v45
  v_or_b32 v46, 0x80, v46
  v_or_b32 v47, 0x80, v47
  v_or_b32 v48, v48, v49
  v_pk_add_f32 v[40:41], v[40:41], v[44:45]
  v_pk_add_f32 v[42:43], v[42:43], v[46:47]
  v_lshlrev_b32 v48, 24, v48
  v_pk_add_f32 v[40:41], v[40:41], v[42:43]
  v_cmp_ne_u32 vcc, 0, v48
  v_cvt_pk_bf16_f32 v40, v40, v41
  s_cmp_eq_u64 vcc, 0
  s_cbranch_scc1 L_sl_hd
  s_sleep 8
  s_add_u32 s70, s70, 1
  s_cmp_lt_u32 s70, 262144
  s_cbranch_scc1 L_sl_hp
L_sl_hd:
  ds_write_b32 v0, v40
  v_add_u32 v2, 2048, v2
  v_add_u32 v0, 256, v0
  s_add_u32 s10, s10, 1
  s_cmp_lt_u32 s10, 64
  s_cbranch_scc1 L_sl_h
  s_mov_b32 s44, s24
  s_mov_b32 s45, s25
  s_mov_b32 s46, 4194304
  s_mov_b32 s11, 1024
  s_mov_b32 s12, 4194304
  v_mov_b32 v4, 83968
  v_mov_b32 v5, 92160
  v_lshlrev_b32 v2, 4, v1
  s_call_b64 s[62:63], L_gv
  v_lshlrev_b32 v0, 4, v1
  global_load_dwordx4 v[40:43], v0, s[16:17] offset:0
  global_load_dwordx4 v[44:47], v0, s[16:17] offset:1024
  s_waitcnt vmcnt(0)
  v_lshlrev_b32 v104, 16, v40
  v_and_b32 v105, s73, v40
  v_lshlrev_b32 v106, 16, v41
  v_and_b32 v107, s73, v41
  v_lshlrev_b32 v108, 16, v42
  v_and_b32 v109, s73, v42
  v_lshlrev_b32 v110, 16, v43
  v_and_b32 v111, s73, v43
  v_lshlrev_b32 v112, 16, v44
  v_and_b32 v113, s73, v44
  v_lshlrev_b32 v114, 16, v45
  v_and_b32 v115, s73, v45
  v_lshlrev_b32 v116, 16, v46
  v_and_b32 v117, s73, v46
  v_lshlrev_b32 v118, 16, v47
  v_and_b32 v119, s73, v47
  v_lshrrev_b32 v2, 1, v1
  v_lshlrev_b32 v2, 7, v2
  v_and_b32 v3, 1, v1
  v_lshl_add_u32 v2, v3, 5, v2
  v_add_u32 v2, 12288, v2
  global_load_dwordx4 v[40:43], v2, s[42:43] offset:0 sc1
  global_load_dwordx4 v[44:47], v2, s[42:43] offset:16 sc1
  global_load_dwordx4 v[48:51], v2, s[42:43] offset:64 sc1
  global_load_dwordx4 v[52:55], v2, s[42:43] offset:80 sc1
  s_waitcnt vmcnt(0)
  v_lshlrev_b32 v88, 16, v40
  v_and_b32 v89, s73, v40
  v_lshlrev_b32 v90, 16, v42
  v_and_b32 v91, s73, v42
  v_lshlrev_b32 v92, 16, v44
  v_and_b32 v93, s73, v44
  v_lshlrev_b32 v94, 16, v46
  v_and_b32 v95, s73, v46
  v_lshlrev_b32 v96, 16, v48
  v_and_b32 v97, s73, v48
  v_lshlrev_b32 v98, 16, v50
  v_and_b32 v99, s73, v50
  v_lshlrev_b32 v100, 16, v52
  v_and_b32 v101, s73, v52
  v_lshlrev_b32 v102, 16, v54
  v_and_b32 v103, s73, v54
  v_cvt_pk_bf16_f32 v72, 0, v72
  v_cvt_pk_bf16_f32 v73, 0, v73
  v_cvt_pk_bf16_f32 v74, 0, v74
  v_cvt_pk_bf16_f32 v75, 0, v75
  v_cvt_pk_bf16_f32 v76, 0, v76
  v_cvt_pk_bf16_f32 v77, 0, v77
  v_cvt_pk_bf16_f32 v78, 0, v78
  v_cvt_pk_bf16_f32 v79, 0, v79
  v_cvt_pk_bf16_f32 v80, 0, v80
  v_cvt_pk_bf16_f32 v81, 0, v81
  v_cvt_pk_bf16_f32 v82, 0, v82
  v_cvt_pk_bf16_f32 v83, 0, v83
  v_cvt_pk_bf16_f32 v84, 0, v84
  v_cvt_pk_bf16_f32 v85, 0, v85
  v_cvt_pk_bf16_f32 v86, 0, v86
  v_cvt_pk_bf16_f32 v87, 0, v87
  v_mul_f32 v72, v72, v88
  v_mul_f32 v73, v73, v89
  v_mul_f32 v74, v74, v90
  v_mul_f32 v75, v75, v91
  v_mul_f32 v76, v76, v92
  v_mul_f32 v77, v77, v93
  v_mul_f32 v78, v78, v94
  v_mul_f32 v79, v79, v95
  v_mul_f32 v80, v80, v96
  v_mul_f32 v81, v81, v97
  v_mul_f32 v82, v82, v98
  v_mul_f32 v83, v83, v99
  v_mul_f32 v84, v84, v100
  v_mul_f32 v85, v85, v101
  v_mul_f32 v86, v86, v102
  v_mul_f32 v87, v87, v103
  v_cvt_pk_bf16_f32 v72, 0, v72
  v_cvt_pk_bf16_f32 v73, 0, v73
  v_cvt_pk_bf16_f32 v74, 0, v74
  v_cvt_pk_bf16_f32 v75, 0, v75
  v_cvt_pk_bf16_f32 v76, 0, v76
  v_cvt_pk_bf16_f32 v77, 0, v77
  v_cvt_pk_bf16_f32 v78, 0, v78
  v_cvt_pk_bf16_f32 v79, 0, v79
  v_cvt_pk_bf16_f32 v80, 0, v80
  v_cvt_pk_bf16_f32 v81, 0, v81
  v_cvt_pk_bf16_f32 v82, 0, v82
  v_cvt_pk_bf16_f32 v83, 0, v83
  v_cvt_pk_bf16_f32 v84, 0, v84
  v_cvt_pk_bf16_f32 v85, 0, v85
  v_cvt_pk_bf16_f32 v86, 0, v86
  v_cvt_pk_bf16_f32 v87, 0, v87
  v_add_f32 v104, v104, v72
  v_add_f32 v105, v105, v73
  v_add_f32 v106, v106, v74
  v_add_f32 v107, v107, v75
  v_add_f32 v108, v108, v76
  v_add_f32 v109, v109, v77
  v_add_f32 v110, v110, v78
  v_add_f32 v111, v111, v79
  v_add_f32 v112, v112, v80
  v_add_f32 v113, v113, v81
  v_add_f32 v114, v114, v82
  v_add_f32 v115, v115, v83
  v_add_f32 v116, v116, v84
  v_add_f32 v117, v117, v85
  v_add_f32 v118, v118, v86
  v_add_f32 v119, v119, v87
  v_cvt_pk_bf16_f32 v104, 0, v104
  v_cvt_pk_bf16_f32 v105, 0, v105
  v_cvt_pk_bf16_f32 v106, 0, v106
  v_cvt_pk_bf16_f32 v107, 0, v107
  v_cvt_pk_bf16_f32 v108, 0, v108
  v_cvt_pk_bf16_f32 v109, 0, v109
  v_cvt_pk_bf16_f32 v110, 0, v110
  v_cvt_pk_bf16_f32 v111, 0, v111
  v_cvt_pk_bf16_f32 v112, 0, v112
  v_cvt_pk_bf16_f32 v113, 0, v113
  v_cvt_pk_bf16_f32 v114, 0, v114
  v_cvt_pk_bf16_f32 v115, 0, v115
  v_cvt_pk_bf16_f32 v116, 0, v116
  v_cvt_pk_bf16_f32 v117, 0, v117
  v_cvt_pk_bf16_f32 v118, 0, v118
  v_cvt_pk_bf16_f32 v119, 0, v119
  v_add_f32 v8, v104, v105
  v_add_f32 v8, v8, v106
  v_add_f32 v8, v8, v107
  v_add_f32 v8, v8, v108
  v_add_f32 v8, v8, v109
  v_add_f32 v8, v8, v110
  v_add_f32 v8, v8, v111
  s_nop 1
  v_add_f32_dpp v8, v8, v8 row_ror:8 row_mask:0xf bank_mask:0xf
  s_nop 1
  v_add_f32_dpp v8, v8, v8 row_ror:4 row_mask:0xf bank_mask:0xf
  s_nop 1
  v_add_f32_dpp v8, v8, v8 row_ror:2 row_mask:0xf bank_mask:0xf
  s_nop 1
  v_add_f32_dpp v8, v8, v8 row_ror:1 row_mask:0xf bank_mask:0xf
  v_mov_b32 v9, v8
  s_nop 1
  v_permlane16_swap_b32 v9, v8
  v_add_f32 v8, v8, v9
  v_mov_b32 v9, v8
  s_nop 1
  v_permlane32_swap_b32 v9, v8
  v_add_f32 v8, v8, v9
  v_mul_f32 v8, 0x3b000000, v8
  v_sub_f32 v72, v104, v8
  v_sub_f32 v73, v105, v8
  v_sub_f32 v74, v106, v8
  v_sub_f32 v75, v107, v8
  v_sub_f32 v76, v108, v8
  v_sub_f32 v77, v109, v8
  v_sub_f32 v78, v110, v8
  v_sub_f32 v79, v111, v8
  v_mul_f32 v10, v72, v72
  v_fmac_f32 v10, v73, v73
  v_fmac_f32 v10, v74, v74
  v_fmac_f32 v10, v75, v75
  v_fmac_f32 v10, v76, v76
  v_fmac_f32 v10, v77, v77
  v_fmac_f32 v10, v78, v78
  v_fmac_f32 v10, v79, v79
  s_nop 1
  v_add_f32_dpp v10, v10, v10 row_ror:8 row_mask:0xf bank_mask:0xf
  s_nop 1
  v_add_f32_dpp v10, v10, v10 row_ror:4 row_mask:0xf bank_mask:0xf
  s_nop 1
  v_add_f32_dpp v10, v10, v10 row_ror:2 row_mask:0xf bank_mask:0xf
  s_nop 1
  v_add_f32_dpp v10, v10, v10 row_ror:1 row_mask:0xf bank_mask:0xf
  v_mov_b32 v9, v10
  s_nop 1
  v_permlane16_swap_b32 v9, v10
  v_add_f32 v10, v10, v9
  v_mov_b32 v9, v10
  s_nop 1
  v_permlane32_swap_b32 v9, v10
  v_add_f32 v10, v10, v9
  v_mul_f32 v10, 0x3b000000, v10
  v_cvt_pk_bf16_f32 v8, 0, v8
  v_cvt_pk_bf16_f32 v10, 0, v10
  v_add_f32 v10, 0x3727c5ac, v10
  v_cvt_pk_bf16_f32 v10, 0, v10
  v_sqrt_f32 v10, v10
  v_sub_f32 v72, v104, v8
  v_sub_f32 v73, v105, v8
  v_sub_f32 v74, v106, v8
  v_sub_f32 v75, v107, v8
  v_sub_f32 v76, v108, v8
  v_sub_f32 v77, v109, v8
  v_sub_f32 v78, v110, v8
  v_sub_f32 v79, v111, v8
  v_cvt_pk_bf16_f32 v10, 0, v10
  v_cvt_pk_bf16_f32 v72, 0, v72
  v_cvt_pk_bf16_f32 v73, 0, v73
  v_cvt_pk_bf16_f32 v74, 0, v74
  v_cvt_pk_bf16_f32 v75, 0, v75
  v_cvt_pk_bf16_f32 v76, 0, v76
  v_cvt_pk_bf16_f32 v77, 0, v77
  v_cvt_pk_bf16_f32 v78, 0, v78
  v_cvt_pk_bf16_f32 v79, 0, v79
  v_rcp_f32 v10, v10
  s_nop 0
  v_mul_f32 v72, v72, v10
  v_mul_f32 v73, v73, v10
  v_mul_f32 v74, v74, v10
  v_mul_f32 v75, v75, v10
  v_mul_f32 v76, v76, v10
  v_mul_f32 v77, v77, v10
  v_mul_f32 v78, v78, v10
  v_mul_f32 v79, v79, v10
  v_cvt_pk_bf16_f32 v72, 0, v72
  v_cvt_pk_bf16_f32 v73, 0, v73
  v_cvt_pk_bf16_f32 v74, 0, v74
  v_cvt_pk_bf16_f32 v75, 0, v75
  v_cvt_pk_bf16_f32 v76, 0, v76
  v_cvt_pk_bf16_f32 v77, 0, v77
  v_cvt_pk_bf16_f32 v78, 0, v78
  v_cvt_pk_bf16_f32 v79, 0, v79
  v_add_f32 v8, v112, v113
  v_add_f32 v8, v8, v114
  v_add_f32 v8, v8, v115
  v_add_f32 v8, v8, v116
  v_add_f32 v8, v8, v117
  v_add_f32 v8, v8, v118
  v_add_f32 v8, v8, v119
  s_nop 1
  v_add_f32_dpp v8, v8, v8 row_ror:8 row_mask:0xf bank_mask:0xf
  s_nop 1
  v_add_f32_dpp v8, v8, v8 row_ror:4 row_mask:0xf bank_mask:0xf
  s_nop 1
  v_add_f32_dpp v8, v8, v8 row_ror:2 row_mask:0xf bank_mask:0xf
  s_nop 1
  v_add_f32_dpp v8, v8, v8 row_ror:1 row_mask:0xf bank_mask:0xf
  v_mov_b32 v9, v8
  s_nop 1
  v_permlane16_swap_b32 v9, v8
  v_add_f32 v8, v8, v9
  v_mov_b32 v9, v8
  s_nop 1
  v_permlane32_swap_b32 v9, v8
  v_add_f32 v8, v8, v9
  v_mul_f32 v8, 0x3b000000, v8
  v_sub_f32 v80, v112, v8
  v_sub_f32 v81, v113, v8
  v_sub_f32 v82, v114, v8
  v_sub_f32 v83, v115, v8
  v_sub_f32 v84, v116, v8
  v_sub_f32 v85, v117, v8
  v_sub_f32 v86, v118, v8
  v_sub_f32 v87, v119, v8
  v_mul_f32 v10, v80, v80
  v_fmac_f32 v10, v81, v81
  v_fmac_f32 v10, v82, v82
  v_fmac_f32 v10, v83, v83
  v_fmac_f32 v10, v84, v84
  v_fmac_f32 v10, v85, v85
  v_fmac_f32 v10, v86, v86
  v_fmac_f32 v10, v87, v87
  s_nop 1
  v_add_f32_dpp v10, v10, v10 row_ror:8 row_mask:0xf bank_mask:0xf
  s_nop 1
  v_add_f32_dpp v10, v10, v10 row_ror:4 row_mask:0xf bank_mask:0xf
  s_nop 1
  v_add_f32_dpp v10, v10, v10 row_ror:2 row_mask:0xf bank_mask:0xf
  s_nop 1
  v_add_f32_dpp v10, v10, v10 row_ror:1 row_mask:0xf bank_mask:0xf
  v_mov_b32 v9, v10
  s_nop 1
  v_permlane16_swap_b32 v9, v10
  v_add_f32 v10, v10, v9
  v_mov_b32 v9, v10
  s_nop 1
  v_permlane32_swap_b32 v9, v10
  v_add_f32 v10, v10, v9
  v_mul_f32 v10, 0x3b000000, v10
  v_cvt_pk_bf16_f32 v8, 0, v8
  v_cvt_pk_bf16_f32 v10, 0, v10
  v_add_f32 v10, 0x3727c5ac, v10
  v_cvt_pk_bf16_f32 v10, 0, v10
  v_sqrt_f32 v10, v10
  v_sub_f32 v80, v112, v8
  v_sub_f32 v81, v113, v8
  v_sub_f32 v82, v114, v8
  v_sub_f32 v83, v115, v8
  v_sub_f32 v84, v116, v8
  v_sub_f32 v85, v117, v8
  v_sub_f32 v86, v118, v8
  v_sub_f32 v87, v119, v8
  v_cvt_pk_bf16_f32 v10, 0, v10
  v_cvt_pk_bf16_f32 v80, 0, v80
  v_cvt_pk_bf16_f32 v81, 0, v81
  v_cvt_pk_bf16_f32 v82, 0, v82
  v_cvt_pk_bf16_f32 v83, 0, v83
  v_cvt_pk_bf16_f32 v84, 0, v84
  v_cvt_pk_bf16_f32 v85, 0, v85
  v_cvt_pk_bf16_f32 v86, 0, v86
  v_cvt_pk_bf16_f32 v87, 0, v87
  v_rcp_f32 v10, v10
  s_nop 0
  v_mul_f32 v80, v80, v10
  v_mul_f32 v81, v81, v10
  v_mul_f32 v82, v82, v10
  v_mul_f32 v83, v83, v10
  v_mul_f32 v84, v84, v10
  v_mul_f32 v85, v85, v10
  v_mul_f32 v86, v86, v10
  v_mul_f32 v87, v87, v10
  v_cvt_pk_bf16_f32 v80, 0, v80
  v_cvt_pk_bf16_f32 v81, 0, v81
  v_cvt_pk_bf16_f32 v82, 0, v82
  v_cvt_pk_bf16_f32 v83, 0, v83
  v_cvt_pk_bf16_f32 v84, 0, v84
  v_cvt_pk_bf16_f32 v85, 0, v85
  v_cvt_pk_bf16_f32 v86, 0, v86
  v_cvt_pk_bf16_f32 v87, 0, v87
  v_lshrrev_b32 v2, 1, v1
  v_lshlrev_b32 v2, 7, v2
  v_and_b32 v3, 1, v1
  v_lshl_add_u32 v2, v3, 5, v2
  v_add_u32 v2, 20480, v2
  global_load_dwordx4 v[40:43], v2, s[42:43] offset:0 sc1
  global_load_dwordx4 v[44:47], v2, s[42:43] offset:16 sc1
  global_load_dwordx4 v[48:51], v2, s[42:43] offset:64 sc1
  global_load_dwordx4 v[52:55], v2, s[42:43] offset:80 sc1
  s_waitcnt vmcnt(0)
  v_lshlrev_b32 v88, 16, v40
  v_and_b32 v89, s73, v40
  v_lshlrev_b32 v90, 16, v42
  v_and_b32 v91, s73, v42
  v_lshlrev_b32 v92, 16, v44
  v_and_b32 v93, s73, v44
  v_lshlrev_b32 v94, 16, v46
  v_and_b32 v95, s73, v46
  v_lshlrev_b32 v96, 16, v48
  v_and_b32 v97, s73, v48
  v_lshlrev_b32 v98, 16, v50
  v_and_b32 v99, s73, v50
  v_lshlrev_b32 v100, 16, v52
  v_and_b32 v101, s73, v52
  v_lshlrev_b32 v102, 16, v54
  v_and_b32 v103, s73, v54
  v_add_f32 v88, 1.0, v88
  v_add_f32 v89, 1.0, v89
  v_add_f32 v90, 1.0, v90
  v_add_f32 v91, 1.0, v91
  v_add_f32 v92, 1.0, v92
  v_add_f32 v93, 1.0, v93
  v_add_f32 v94, 1.0, v94
  v_add_f32 v95, 1.0, v95
  v_add_f32 v96, 1.0, v96
  v_add_f32 v97, 1.0, v97
  v_add_f32 v98, 1.0, v98
  v_add_f32 v99, 1.0, v99
  v_add_f32 v100, 1.0, v100
  v_add_f32 v101, 1.0, v101
  v_add_f32 v102, 1.0, v102
  v_add_f32 v103, 1.0, v103
  v_cvt_pk_bf16_f32 v88, 0, v88
  v_cvt_pk_bf16_f32 v89, 0, v89
  v_cvt_pk_bf16_f32 v90, 0, v90
  v_cvt_pk_bf16_f32 v91, 0, v91
  v_cvt_pk_bf16_f32 v92, 0, v92
  v_cvt_pk_bf16_f32 v93, 0, v93
  v_cvt_pk_bf16_f32 v94, 0, v94
  v_cvt_pk_bf16_f32 v95, 0, v95
  v_cvt_pk_bf16_f32 v96, 0, v96
  v_cvt_pk_bf16_f32 v97, 0, v97
  v_cvt_pk_bf16_f32 v98, 0, v98
  v_cvt_pk_bf16_f32 v99, 0, v99
  v_cvt_pk_bf16_f32 v100, 0, v100
  v_cvt_pk_bf16_f32 v101, 0, v101
  v_cvt_pk_bf16_f32 v102, 0, v102
  v_cvt_pk_bf16_f32 v103, 0, v103
  v_mul_f32 v72, v72, v88
  v_mul_f32 v73, v73, v89
  v_mul_f32 v74, v74, v90
  v_mul_f32 v75, v75, v91
  v_mul_f32 v76, v76, v92
  v_mul_f32 v77, v77, v93
  v_mul_f32 v78, v78, v94
  v_mul_f32 v79, v79, v95
  v_mul_f32 v80, v80, v96
  v_mul_f32 v81, v81, v97
  v_mul_f32 v82, v82, v98
  v_mul_f32 v83, v83, v99
  v_mul_f32 v84, v84, v100
  v_mul_f32 v85, v85, v101
  v_mul_f32 v86, v86, v102
  v_mul_f32 v87, v87, v103
  v_cvt_pk_bf16_f32 v72, 0, v72
  v_cvt_pk_bf16_f32 v73, 0, v73
  v_cvt_pk_bf16_f32 v74, 0, v74
  v_cvt_pk_bf16_f32 v75, 0, v75
  v_cvt_pk_bf16_f32 v76, 0, v76
  v_cvt_pk_bf16_f32 v77, 0, v77
  v_cvt_pk_bf16_f32 v78, 0, v78
  v_cvt_pk_bf16_f32 v79, 0, v79
  v_cvt_pk_bf16_f32 v80, 0, v80
  v_cvt_pk_bf16_f32 v81, 0, v81
  v_cvt_pk_bf16_f32 v82, 0, v82
  v_cvt_pk_bf16_f32 v83, 0, v83
  v_cvt_pk_bf16_f32 v84, 0, v84
  v_cvt_pk_bf16_f32 v85, 0, v85
  v_cvt_pk_bf16_f32 v86, 0, v86
  v_cvt_pk_bf16_f32 v87, 0, v87
  v_lshrrev_b32 v2, 1, v1
  v_lshlrev_b32 v2, 7, v2
  v_and_b32 v3, 1, v1
  v_lshl_add_u32 v2, v3, 5, v2
  v_add_u32 v2, 16384, v2
  global_load_dwordx4 v[40:43], v2, s[42:43] offset:0 sc1
  global_load_dwordx4 v[44:47], v2, s[42:43] offset:16 sc1
  global_load_dwordx4 v[48:51], v2, s[42:43] offset:64 sc1
  global_load_dwordx4 v[52:55], v2, s[42:43] offset:80 sc1
  s_waitcnt vmcnt(0)
  v_lshlrev_b32 v88, 16, v40
  v_and_b32 v89, s73, v40
  v_lshlrev_b32 v90, 16, v42
  v_and_b32 v91, s73, v42
  v_lshlrev_b32 v92, 16, v44
  v_and_b32 v93, s73, v44
  v_lshlrev_b32 v94, 16, v46
  v_and_b32 v95, s73, v46
  v_lshlrev_b32 v96, 16, v48
  v_and_b32 v97, s73, v48
  v_lshlrev_b32 v98, 16, v50
  v_and_b32 v99, s73, v50
  v_lshlrev_b32 v100, 16, v52
  v_and_b32 v101, s73, v52
  v_lshlrev_b32 v102, 16, v54
  v_and_b32 v103, s73, v54
  v_add_f32 v72, v72, v88
  v_add_f32 v73, v73, v89
  v_add_f32 v74, v74, v90
  v_add_f32 v75, v75, v91
  v_add_f32 v76, v76, v92
  v_add_f32 v77, v77, v93
  v_add_f32 v78, v78, v94
  v_add_f32 v79, v79, v95
  v_add_f32 v80, v80, v96
  v_add_f32 v81, v81, v97
  v_add_f32 v82, v82, v98
  v_add_f32 v83, v83, v99
  v_add_f32 v84, v84, v100
  v_add_f32 v85, v85, v101
  v_add_f32 v86, v86, v102
  v_add_f32 v87, v87, v103
  v_cvt_pk_bf16_f32 v40, v72, v73
  v_cvt_pk_bf16_f32 v41, v74, v75
  v_cvt_pk_bf16_f32 v42, v76, v77
  v_cvt_pk_bf16_f32 v43, v78, v79
  v_cvt_pk_bf16_f32 v44, v80, v81
  v_cvt_pk_bf16_f32 v45, v82, v83
  v_cvt_pk_bf16_f32 v46, v84, v85
  v_cvt_pk_bf16_f32 v47, v86, v87
  v_add_u32 v3, 83968, v0
  ds_write_b128 v3, v[40:43] offset:0
  ds_write_b128 v3, v[44:47] offset:1024
  s_mov_b32 s44, s28
  s_mov_b32 s45, s29
  s_mov_b32 s46, 1409024
  s_mov_b32 s11, 2752
  s_mov_b32 s12, 1409024
  v_mov_b32 v4, 83968
  v_mov_b32 v5, 84992
  v_lshlrev_b32 v2, 4, v1
  s_call_b64 s[62:63], L_gv
  v_cvt_pk_bf16_f32 v120, 0, v72
  v_cvt_pk_bf16_f32 v121, 0, v73
  v_cvt_pk_bf16_f32 v122, 0, v74
  v_cvt_pk_bf16_f32 v123, 0, v75
  v_cvt_pk_bf16_f32 v124, 0, v76
  v_cvt_pk_bf16_f32 v125, 0, v77
  v_cvt_pk_bf16_f32 v126, 0, v78
  v_cvt_pk_bf16_f32 v127, 0, v79
  v_cvt_pk_bf16_f32 v128, 0, v80
  v_cvt_pk_bf16_f32 v129, 0, v81
  v_cvt_pk_bf16_f32 v130, 0, v82
  v_cvt_pk_bf16_f32 v131, 0, v83
  v_cvt_pk_bf16_f32 v132, 0, v84
  v_cvt_pk_bf16_f32 v133, 0, v85
  v_cvt_pk_bf16_f32 v134, 0, v86
  v_cvt_pk_bf16_f32 v135, 0, v87
  s_mov_b32 s44, s30
  s_mov_b32 s45, s31
  s_mov_b32 s46, 1409024
  s_mov_b32 s11, 2752
  s_mov_b32 s12, 1409024
  v_mov_b32 v4, 83968
  v_mov_b32 v5, 84992
  v_lshlrev_b32 v2, 4, v1
  s_call_b64 s[62:63], L_gv
  v_mul_f32 v88, 0xbfb8aa3b, v120
  v_mul_f32 v89, 0xbfb8aa3b, v121
  v_mul_f32 v90, 0xbfb8aa3b, v122
  v_mul_f32 v91, 0xbfb8aa3b, v123
  v_exp_f32 v88, v88
  v_exp_f32 v89, v89
  v_exp_f32 v90, v90
  v_exp_f32 v91, v91
  s_nop 0
  v_add_f32 v88, 1.0, v88
  v_add_f32 v89, 1.0, v89
  v_add_f32 v90, 1.0, v90
  v_add_f32 v91, 1.0, v91
  v_rcp_f32 v88, v88
  v_rcp_f32 v89, v89
  v_rcp_f32 v90, v90
  v_rcp_f32 v91, v91
  s_nop 0
  v_mul_f32 v120, v120, v88
  v_mul_f32 v121, v121, v89
  v_mul_f32 v122, v122, v90
  v_mul_f32 v123, v123, v91
  v_mul_f32 v88, 0xbfb8aa3b, v124
  v_mul_f32 v89, 0xbfb8aa3b, v125
  v_mul_f32 v90, 0xbfb8aa3b, v126
  v_mul_f32 v91, 0xbfb8aa3b, v127
  v_exp_f32 v88, v88
  v_exp_f32 v89, v89
  v_exp_f32 v90, v90
  v_exp_f32 v91, v91
  s_nop 0
  v_add_f32 v88, 1.0, v88
  v_add_f32 v89, 1.0, v89
  v_add_f32 v90, 1.0, v90
  v_add_f32 v91, 1.0, v91
  v_rcp_f32 v88, v88
  v_rcp_f32 v89, v89
  v_rcp_f32 v90, v90
  v_rcp_f32 v91, v91
  s_nop 0
  v_mul_f32 v124, v124, v88
  v_mul_f32 v125, v125, v89
  v_mul_f32 v126, v126, v90
  v_mul_f32 v127, v127, v91
  v_mul_f32 v88, 0xbfb8aa3b, v128
  v_mul_f32 v89, 0xbfb8aa3b, v129
  v_mul_f32 v90, 0xbfb8aa3b, v130
  v_mul_f32 v91, 0xbfb8aa3b, v131
  v_exp_f32 v88, v88
  v_exp_f32 v89, v89
  v_exp_f32 v90, v90
  v_exp_f32 v91, v91
  s_nop 0
  v_add_f32 v88, 1.0, v88
  v_add_f32 v89, 1.0, v89
  v_add_f32 v90, 1.0, v90
  v_add_f32 v91, 1.0, v91
  v_rcp_f32 v88, v88
  v_rcp_f32 v89, v89
  v_rcp_f32 v90, v90
  v_rcp_f32 v91, v91
  s_nop 0
  v_mul_f32 v128, v128, v88
  v_mul_f32 v129, v129, v89
  v_mul_f32 v130, v130, v90
  v_mul_f32 v131, v131, v91
  v_mul_f32 v88, 0xbfb8aa3b, v132
  v_mul_f32 v89, 0xbfb8aa3b, v133
  v_mul_f32 v90, 0xbfb8aa3b, v134
  v_mul_f32 v91, 0xbfb8aa3b, v135
  v_exp_f32 v88, v88
  v_exp_f32 v89, v89
  v_exp_f32 v90, v90
  v_exp_f32 v91, v91
  s_nop 0
  v_add_f32 v88, 1.0, v88
  v_add_f32 v89, 1.0, v89
  v_add_f32 v90, 1.0, v90
  v_add_f32 v91, 1.0, v91
  v_rcp_f32 v88, v88
  v_rcp_f32 v89, v89
  v_rcp_f32 v90, v90
  v_rcp_f32 v91, v91
  s_nop 0
  v_mul_f32 v132, v132, v88
  v_mul_f32 v133, v133, v89
  v_mul_f32 v134, v134, v90
  v_mul_f32 v135, v135, v91
  v_cvt_pk_bf16_f32 v120, 0, v120
  v_cvt_pk_bf16_f32 v121, 0, v121
  v_cvt_pk_bf16_f32 v122, 0, v122
  v_cvt_pk_bf16_f32 v123, 0, v123
  v_cvt_pk_bf16_f32 v124, 0, v124
  v_cvt_pk_bf16_f32 v125, 0, v125
  v_cvt_pk_bf16_f32 v126, 0, v126
  v_cvt_pk_bf16_f32 v127, 0, v127
  v_cvt_pk_bf16_f32 v128, 0, v128
  v_cvt_pk_bf16_f32 v129, 0, v129
  v_cvt_pk_bf16_f32 v130, 0, v130
  v_cvt_pk_bf16_f32 v131, 0, v131
  v_cvt_pk_bf16_f32 v132, 0, v132
  v_cvt_pk_bf16_f32 v133, 0, v133
  v_cvt_pk_bf16_f32 v134, 0, v134
  v_cvt_pk_bf16_f32 v135, 0, v135
  v_cvt_pk_bf16_f32 v72, 0, v72
  v_cvt_pk_bf16_f32 v73, 0, v73
  v_cvt_pk_bf16_f32 v74, 0, v74
  v_cvt_pk_bf16_f32 v75, 0, v75
  v_cvt_pk_bf16_f32 v76, 0, v76
  v_cvt_pk_bf16_f32 v77, 0, v77
  v_cvt_pk_bf16_f32 v78, 0, v78
  v_cvt_pk_bf16_f32 v79, 0, v79
  v_cvt_pk_bf16_f32 v80, 0, v80
  v_cvt_pk_bf16_f32 v81, 0, v81
  v_cvt_pk_bf16_f32 v82, 0, v82
  v_cvt_pk_bf16_f32 v83, 0, v83
  v_cvt_pk_bf16_f32 v84, 0, v84
  v_cvt_pk_bf16_f32 v85, 0, v85
  v_cvt_pk_bf16_f32 v86, 0, v86
  v_cvt_pk_bf16_f32 v87, 0, v87
  v_mul_f32 v72, v72, v120
  v_mul_f32 v73, v73, v121
  v_mul_f32 v74, v74, v122
  v_mul_f32 v75, v75, v123
  v_mul_f32 v76, v76, v124
  v_mul_f32 v77, v77, v125
  v_mul_f32 v78, v78, v126
  v_mul_f32 v79, v79, v127
  v_mul_f32 v80, v80, v128
  v_mul_f32 v81, v81, v129
  v_mul_f32 v82, v82, v130
  v_mul_f32 v83, v83, v131
  v_mul_f32 v84, v84, v132
  v_mul_f32 v85, v85, v133
  v_mul_f32 v86, v86, v134
  v_mul_f32 v87, v87, v135
  v_cvt_pk_bf16_f32 v40, v72, v73
  v_cvt_pk_bf16_f32 v41, v74, v75
  v_cvt_pk_bf16_f32 v42, v76, v77
  v_cvt_pk_bf16_f32 v43, v78, v79
  v_cvt_pk_bf16_f32 v44, v80, v81
  v_cvt_pk_bf16_f32 v45, v82, v83
  v_cvt_pk_bf16_f32 v46, v84, v85
  v_cvt_pk_bf16_f32 v47, v86, v87
  v_add_u32 v3, 86016, v0
  ds_write_b128 v3, v[40:43] offset:0
  ds_write_b128 v3, v[44:47] offset:3072
  s_mov_b32 s44, s28
  s_mov_b32 s45, s29
  s_mov_b32 s46, 1409024
  s_mov_b32 s11, 2752
  s_mov_b32 s12, 1409024
  v_mov_b32 v4, 83968
  v_mov_b32 v5, 84992
  v_lshlrev_b32 v2, 4, v1
  v_add_u32 v2, 1024, v2
  s_call_b64 s[62:63], L_gv
  v_cvt_pk_bf16_f32 v120, 0, v72
  v_cvt_pk_bf16_f32 v121, 0, v73
  v_cvt_pk_bf16_f32 v122, 0, v74
  v_cvt_pk_bf16_f32 v123, 0, v75
  v_cvt_pk_bf16_f32 v124, 0, v76
  v_cvt_pk_bf16_f32 v125, 0, v77
  v_cvt_pk_bf16_f32 v126, 0, v78
  v_cvt_pk_bf16_f32 v127, 0, v79
  v_cvt_pk_bf16_f32 v128, 0, v80
  v_cvt_pk_bf16_f32 v129, 0, v81
  v_cvt_pk_bf16_f32 v130, 0, v82
  v_cvt_pk_bf16_f32 v131, 0, v83
  v_cvt_pk_bf16_f32 v132, 0, v84
  v_cvt_pk_bf16_f32 v133, 0, v85
  v_cvt_pk_bf16_f32 v134, 0, v86
  v_cvt_pk_bf16_f32 v135, 0, v87
  s_mov_b32 s44, s30
  s_mov_b32 s45, s31
  s_mov_b32 s46, 1409024
  s_mov_b32 s11, 2752
  s_mov_b32 s12, 1409024
  v_mov_b32 v4, 83968
  v_mov_b32 v5, 84992
  v_lshlrev_b32 v2, 4, v1
  v_add_u32 v2, 1024, v2
  s_call_b64 s[62:63], L_gv
  v_mul_f32 v88, 0xbfb8aa3b, v120
  v_mul_f32 v89, 0xbfb8aa3b, v121
  v_mul_f32 v90, 0xbfb8aa3b, v122
  v_mul_f32 v91, 0xbfb8aa3b, v123
  v_exp_f32 v88, v88
  v_exp_f32 v89, v89
  v_exp_f32 v90, v90
  v_exp_f32 v91, v91
  s_nop 0
  v_add_f32 v88, 1.0, v88
  v_add_f32 v89, 1.0, v89
  v_add_f32 v90, 1.0, v90
  v_add_f32 v91, 1.0, v91
  v_rcp_f32 v88, v88
  v_rcp_f32 v89, v89
  v_rcp_f32 v90, v90
  v_rcp_f32 v91, v91
  s_nop 0
  v_mul_f32 v120, v120, v88
  v_mul_f32 v121, v121, v89
  v_mul_f32 v122, v122, v90
  v_mul_f32 v123, v123, v91
  v_mul_f32 v88, 0xbfb8aa3b, v124
  v_mul_f32 v89, 0xbfb8aa3b, v125
  v_mul_f32 v90, 0xbfb8aa3b, v126
  v_mul_f32 v91, 0xbfb8aa3b, v127
  v_exp_f32 v88, v88
  v_exp_f32 v89, v89
  v_exp_f32 v90, v90
  v_exp_f32 v91, v91
  s_nop 0
  v_add_f32 v88, 1.0, v88
  v_add_f32 v89, 1.0, v89
  v_add_f32 v90, 1.0, v90
  v_add_f32 v91, 1.0, v91
  v_rcp_f32 v88, v88
  v_rcp_f32 v89, v89
  v_rcp_f32 v90, v90
  v_rcp_f32 v91, v91
  s_nop 0
  v_mul_f32 v124, v124, v88
  v_mul_f32 v125, v125, v89
  v_mul_f32 v126, v126, v90
  v_mul_f32 v127, v127, v91
  v_mul_f32 v88, 0xbfb8aa3b, v128
  v_mul_f32 v89, 0xbfb8aa3b, v129
  v_mul_f32 v90, 0xbfb8aa3b, v130
  v_mul_f32 v91, 0xbfb8aa3b, v131
  v_exp_f32 v88, v88
  v_exp_f32 v89, v89
  v_exp_f32 v90, v90
  v_exp_f32 v91, v91
  s_nop 0
  v_add_f32 v88, 1.0, v88
  v_add_f32 v89, 1.0, v89
  v_add_f32 v90, 1.0, v90
  v_add_f32 v91, 1.0, v91
  v_rcp_f32 v88, v88
  v_rcp_f32 v89, v89
  v_rcp_f32 v90, v90
  v_rcp_f32 v91, v91
  s_nop 0
  v_mul_f32 v128, v128, v88
  v_mul_f32 v129, v129, v89
  v_mul_f32 v130, v130, v90
  v_mul_f32 v131, v131, v91
  v_mul_f32 v88, 0xbfb8aa3b, v132
  v_mul_f32 v89, 0xbfb8aa3b, v133
  v_mul_f32 v90, 0xbfb8aa3b, v134
  v_mul_f32 v91, 0xbfb8aa3b, v135
  v_exp_f32 v88, v88
  v_exp_f32 v89, v89
  v_exp_f32 v90, v90
  v_exp_f32 v91, v91
  s_nop 0
  v_add_f32 v88, 1.0, v88
  v_add_f32 v89, 1.0, v89
  v_add_f32 v90, 1.0, v90
  v_add_f32 v91, 1.0, v91
  v_rcp_f32 v88, v88
  v_rcp_f32 v89, v89
  v_rcp_f32 v90, v90
  v_rcp_f32 v91, v91
  s_nop 0
  v_mul_f32 v132, v132, v88
  v_mul_f32 v133, v133, v89
  v_mul_f32 v134, v134, v90
  v_mul_f32 v135, v135, v91
  v_cvt_pk_bf16_f32 v120, 0, v120
  v_cvt_pk_bf16_f32 v121, 0, v121
  v_cvt_pk_bf16_f32 v122, 0, v122
  v_cvt_pk_bf16_f32 v123, 0, v123
  v_cvt_pk_bf16_f32 v124, 0, v124
  v_cvt_pk_bf16_f32 v125, 0, v125
  v_cvt_pk_bf16_f32 v126, 0, v126
  v_cvt_pk_bf16_f32 v127, 0, v127
  v_cvt_pk_bf16_f32 v128, 0, v128
  v_cvt_pk_bf16_f32 v129, 0, v129
  v_cvt_pk_bf16_f32 v130, 0, v130
  v_cvt_pk_bf16_f32 v131, 0, v131
  v_cvt_pk_bf16_f32 v132, 0, v132
  v_cvt_pk_bf16_f32 v133, 0, v133
  v_cvt_pk_bf16_f32 v134, 0, v134
  v_cvt_pk_bf16_f32 v135, 0, v135
  v_cvt_pk_bf16_f32 v72, 0, v72
  v_cvt_pk_bf16_f32 v73, 0, v73
  v_cvt_pk_bf16_f32 v74, 0, v74
  v_cvt_pk_bf16_f32 v75, 0, v75
  v_cvt_pk_bf16_f32 v76, 0, v76
  v_cvt_pk_bf16_f32 v77, 0, v77
  v_cvt_pk_bf16_f32 v78, 0, v78
  v_cvt_pk_bf16_f32 v79, 0, v79
  v_cvt_pk_bf16_f32 v80, 0, v80
  v_cvt_pk_bf16_f32 v81, 0, v81
  v_cvt_pk_bf16_f32 v82, 0, v82
  v_cvt_pk_bf16_f32 v83, 0, v83
  v_cvt_pk_bf16_f32 v84, 0, v84
  v_cvt_pk_bf16_f32 v85, 0, v85
  v_cvt_pk_bf16_f32 v86, 0, v86
  v_cvt_pk_bf16_f32 v87, 0, v87
  v_mul_f32 v72, v72, v120
  v_mul_f32 v73, v73, v121
  v_mul_f32 v74, v74, v122
  v_mul_f32 v75, v75, v123
  v_mul_f32 v76, v76, v124
  v_mul_f32 v77, v77, v125
  v_mul_f32 v78, v78, v126
  v_mul_f32 v79, v79, v127
  v_mul_f32 v80, v80, v128
  v_mul_f32 v81, v81, v129
  v_mul_f32 v82, v82, v130
  v_mul_f32 v83, v83, v131
  v_mul_f32 v84, v84, v132
  v_mul_f32 v85, v85, v133
  v_mul_f32 v86, v86, v134
  v_mul_f32 v87, v87, v135
  v_cvt_pk_bf16_f32 v40, v72, v73
  v_cvt_pk_bf16_f32 v41, v74, v75
  v_cvt_pk_bf16_f32 v42, v76, v77
  v_cvt_pk_bf16_f32 v43, v78, v79
  v_cvt_pk_bf16_f32 v44, v80, v81
  v_cvt_pk_bf16_f32 v45, v82, v83
  v_cvt_pk_bf16_f32 v46, v84, v85
  v_cvt_pk_bf16_f32 v47, v86, v87
  v_add_u32 v3, 87040, v0
  ds_write_b128 v3, v[40:43] offset:0
  ds_write_b128 v3, v[44:47] offset:3072
  s_mov_b32 s44, s28
  s_mov_b32 s45, s29
  s_mov_b32 s46, 1409024
  s_mov_b32 s11, 2752
  s_mov_b32 s12, 1409024
  v_mov_b32 v4, 83968
  v_mov_b32 v5, 84992
  v_lshlrev_b32 v2, 4, v1
  v_add_u32 v2, 2048, v2
  s_call_b64 s[62:63], L_gv
  v_cvt_pk_bf16_f32 v120, 0, v72
  v_cvt_pk_bf16_f32 v121, 0, v73
  v_cvt_pk_bf16_f32 v122, 0, v74
  v_cvt_pk_bf16_f32 v123, 0, v75
  v_cvt_pk_bf16_f32 v124, 0, v76
  v_cvt_pk_bf16_f32 v125, 0, v77
  v_cvt_pk_bf16_f32 v126, 0, v78
  v_cvt_pk_bf16_f32 v127, 0, v79
  v_cvt_pk_bf16_f32 v128, 0, v80
  v_cvt_pk_bf16_f32 v129, 0, v81
  v_cvt_pk_bf16_f32 v130, 0, v82
  v_cvt_pk_bf16_f32 v131, 0, v83
  v_cvt_pk_bf16_f32 v132, 0, v84
  v_cvt_pk_bf16_f32 v133, 0, v85
  v_cvt_pk_bf16_f32 v134, 0, v86
  v_cvt_pk_bf16_f32 v135, 0, v87
  s_mov_b32 s44, s30
  s_mov_b32 s45, s31
  s_mov_b32 s46, 1409024
  s_mov_b32 s11, 2752
  s_mov_b32 s12, 1409024
  v_mov_b32 v4, 83968
  v_mov_b32 v5, 84992
  v_lshlrev_b32 v2, 4, v1
  v_add_u32 v2, 2048, v2
  s_call_b64 s[62:63], L_gv
  v_mul_f32 v88, 0xbfb8aa3b, v120
  v_mul_f32 v89, 0xbfb8aa3b, v121
  v_mul_f32 v90, 0xbfb8aa3b, v122
  v_mul_f32 v91, 0xbfb8aa3b, v123
  v_exp_f32 v88, v88
  v_exp_f32 v89, v89
  v_exp_f32 v90, v90
  v_exp_f32 v91, v91
  s_nop 0
  v_add_f32 v88, 1.0, v88
  v_add_f32 v89, 1.0, v89
  v_add_f32 v90, 1.0, v90
  v_add_f32 v91, 1.0, v91
  v_rcp_f32 v88, v88
  v_rcp_f32 v89, v89
  v_rcp_f32 v90, v90
  v_rcp_f32 v91, v91
  s_nop 0
  v_mul_f32 v120, v120, v88
  v_mul_f32 v121, v121, v89
  v_mul_f32 v122, v122, v90
  v_mul_f32 v123, v123, v91
  v_mul_f32 v88, 0xbfb8aa3b, v124
  v_mul_f32 v89, 0xbfb8aa3b, v125
  v_mul_f32 v90, 0xbfb8aa3b, v126
  v_mul_f32 v91, 0xbfb8aa3b, v127
  v_exp_f32 v88, v88
  v_exp_f32 v89, v89
  v_exp_f32 v90, v90
  v_exp_f32 v91, v91
  s_nop 0
  v_add_f32 v88, 1.0, v88
  v_add_f32 v89, 1.0, v89
  v_add_f32 v90, 1.0, v90
  v_add_f32 v91, 1.0, v91
  v_rcp_f32 v88, v88
  v_rcp_f32 v89, v89
  v_rcp_f32 v90, v90
  v_rcp_f32 v91, v91
  s_nop 0
  v_mul_f32 v124, v124, v88
  v_mul_f32 v125, v125, v89
  v_mul_f32 v126, v126, v90
  v_mul_f32 v127, v127, v91
  v_mul_f32 v88, 0xbfb8aa3b, v128
  v_mul_f32 v89, 0xbfb8aa3b, v129
  v_mul_f32 v90, 0xbfb8aa3b, v130
  v_mul_f32 v91, 0xbfb8aa3b, v131
  v_exp_f32 v88, v88
  v_exp_f32 v89, v89
  v_exp_f32 v90, v90
  v_exp_f32 v91, v91
  s_nop 0
  v_add_f32 v88, 1.0, v88
  v_add_f32 v89, 1.0, v89
  v_add_f32 v90, 1.0, v90
  v_add_f32 v91, 1.0, v91
  v_rcp_f32 v88, v88
  v_rcp_f32 v89, v89
  v_rcp_f32 v90, v90
  v_rcp_f32 v91, v91
  s_nop 0
  v_mul_f32 v128, v128, v88
  v_mul_f32 v129, v129, v89
  v_mul_f32 v130, v130, v90
  v_mul_f32 v131, v131, v91
  v_mul_f32 v88, 0xbfb8aa3b, v132
  v_mul_f32 v89, 0xbfb8aa3b, v133
  v_mul_f32 v90, 0xbfb8aa3b, v134
  v_mul_f32 v91, 0xbfb8aa3b, v135
  v_exp_f32 v88, v88
  v_exp_f32 v89, v89
  v_exp_f32 v90, v90
  v_exp_f32 v91, v91
  s_nop 0
  v_add_f32 v88, 1.0, v88
  v_add_f32 v89, 1.0, v89
  v_add_f32 v90, 1.0, v90
  v_add_f32 v91, 1.0, v91
  v_rcp_f32 v88, v88
  v_rcp_f32 v89, v89
  v_rcp_f32 v90, v90
  v_rcp_f32 v91, v91
  s_nop 0
  v_mul_f32 v132, v132, v88
  v_mul_f32 v133, v133, v89
  v_mul_f32 v134, v134, v90
  v_mul_f32 v135, v135, v91
  v_cvt_pk_bf16_f32 v120, 0, v120
  v_cvt_pk_bf16_f32 v121, 0, v121
  v_cvt_pk_bf16_f32 v122, 0, v122
  v_cvt_pk_bf16_f32 v123, 0, v123
  v_cvt_pk_bf16_f32 v124, 0, v124
  v_cvt_pk_bf16_f32 v125, 0, v125
  v_cvt_pk_bf16_f32 v126, 0, v126
  v_cvt_pk_bf16_f32 v127, 0, v127
  v_cvt_pk_bf16_f32 v128, 0, v128
  v_cvt_pk_bf16_f32 v129, 0, v129
  v_cvt_pk_bf16_f32 v130, 0, v130
  v_cvt_pk_bf16_f32 v131, 0, v131
  v_cvt_pk_bf16_f32 v132, 0, v132
  v_cvt_pk_bf16_f32 v133, 0, v133
  v_cvt_pk_bf16_f32 v134, 0, v134
  v_cvt_pk_bf16_f32 v135, 0, v135
  v_cvt_pk_bf16_f32 v72, 0, v72
  v_cvt_pk_bf16_f32 v73, 0, v73
  v_cvt_pk_bf16_f32 v74, 0, v74
  v_cvt_pk_bf16_f32 v75, 0, v75
  v_cvt_pk_bf16_f32 v76, 0, v76
  v_cvt_pk_bf16_f32 v77, 0, v77
  v_cvt_pk_bf16_f32 v78, 0, v78
  v_cvt_pk_bf16_f32 v79, 0, v79
  v_cvt_pk_bf16_f32 v80, 0, v80
  v_cvt_pk_bf16_f32 v81, 0, v81
  v_cvt_pk_bf16_f32 v82, 0, v82
  v_cvt_pk_bf16_f32 v83, 0, v83
  v_cvt_pk_bf16_f32 v84, 0, v84
  v_cvt_pk_bf16_f32 v85, 0, v85
  v_cvt_pk_bf16_f32 v86, 0, v86
  v_cvt_pk_bf16_f32 v87, 0, v87
  v_mul_f32 v72, v72, v120
  v_mul_f32 v73, v73, v121
  v_mul_f32 v74, v74, v122
  v_mul_f32 v75, v75, v123
  v_mul_f32 v76, v76, v124
  v_mul_f32 v77, v77, v125
  v_mul_f32 v78, v78, v126
  v_mul_f32 v79, v79, v127
  v_mul_f32 v80, v80, v128
  v_mul_f32 v81, v81, v129
  v_mul_f32 v82, v82, v130
  v_mul_f32 v83, v83, v131
  v_mul_f32 v84, v84, v132
  v_mul_f32 v85, v85, v133
  v_mul_f32 v86, v86, v134
  v_mul_f32 v87, v87, v135
  v_cvt_pk_bf16_f32 v40, v72, v73
  v_cvt_pk_bf16_f32 v41, v74, v75
  v_cvt_pk_bf16_f32 v42, v76, v77
  v_cvt_pk_bf16_f32 v43, v78, v79
  v_cvt_pk_bf16_f32 v44, v80, v81
  v_cvt_pk_bf16_f32 v45, v82, v83
  v_cvt_pk_bf16_f32 v46, v84, v85
  v_cvt_pk_bf16_f32 v47, v86, v87
  v_add_u32 v3, 88064, v0
  ds_write_b128 v3, v[40:43] offset:0
  ds_write_b128 v3, v[44:47] offset:3072
  s_mov_b32 s44, s32
  s_mov_b32 s45, s33
  s_mov_b32 s46, 1409024
  s_mov_b32 s11, 1024
  s_mov_b32 s12, 1409024
  v_mov_b32 v4, 86016
  v_mov_b32 v5, 89088
  v_lshlrev_b32 v2, 4, v1
  s_call_b64 s[62:63], L_gv
  v_lshrrev_b32 v2, 1, v1
  v_lshlrev_b32 v2, 7, v2
  v_and_b32 v3, 1, v1
  v_lshl_add_u32 v2, v3, 5, v2
  v_add_u32 v2, 24576, v2
  global_load_dwordx4 v[40:43], v2, s[42:43] offset:0 sc1
  global_load_dwordx4 v[44:47], v2, s[42:43] offset:16 sc1
  global_load_dwordx4 v[48:51], v2, s[42:43] offset:64 sc1
  global_load_dwordx4 v[52:55], v2, s[42:43] offset:80 sc1
  s_waitcnt vmcnt(0)
  v_lshlrev_b32 v88, 16, v40
  v_and_b32 v89, s73, v40
  v_lshlrev_b32 v90, 16, v42
  v_and_b32 v91, s73, v42
  v_lshlrev_b32 v92, 16, v44
  v_and_b32 v93, s73, v44
  v_lshlrev_b32 v94, 16, v46
  v_and_b32 v95, s73, v46
  v_lshlrev_b32 v96, 16, v48
  v_and_b32 v97, s73, v48
  v_lshlrev_b32 v98, 16, v50
  v_and_b32 v99, s73, v50
  v_lshlrev_b32 v100, 16, v52
  v_and_b32 v101, s73, v52
  v_lshlrev_b32 v102, 16, v54
  v_and_b32 v103, s73, v54
  v_cvt_pk_bf16_f32 v72, 0, v72
  v_cvt_pk_bf16_f32 v73, 0, v73
  v_cvt_pk_bf16_f32 v74, 0, v74
  v_cvt_pk_bf16_f32 v75, 0, v75
  v_cvt_pk_bf16_f32 v76, 0, v76
  v_cvt_pk_bf16_f32 v77, 0, v77
  v_cvt_pk_bf16_f32 v78, 0, v78
  v_cvt_pk_bf16_f32 v79, 0, v79
  v_cvt_pk_bf16_f32 v80, 0, v80
  v_cvt_pk_bf16_f32 v81, 0, v81
  v_cvt_pk_bf16_f32 v82, 0, v82
  v_cvt_pk_bf16_f32 v83, 0, v83
  v_cvt_pk_bf16_f32 v84, 0, v84
  v_cvt_pk_bf16_f32 v85, 0, v85
  v_cvt_pk_bf16_f32 v86, 0, v86
  v_cvt_pk_bf16_f32 v87, 0, v87
  v_mul_f32 v72, v72, v88
  v_mul_f32 v73, v73, v89
  v_mul_f32 v74, v74, v90
  v_mul_f32 v75, v75, v91
  v_mul_f32 v76, v76, v92
  v_mul_f32 v77, v77, v93
  v_mul_f32 v78, v78, v94
  v_mul_f32 v79, v79, v95
  v_mul_f32 v80, v80, v96
  v_mul_f32 v81, v81, v97
  v_mul_f32 v82, v82, v98
  v_mul_f32 v83, v83, v99
  v_mul_f32 v84, v84, v100
  v_mul_f32 v85, v85, v101
  v_mul_f32 v86, v86, v102
  v_mul_f32 v87, v87, v103
  v_cvt_pk_bf16_f32 v72, 0, v72
  v_cvt_pk_bf16_f32 v73, 0, v73
  v_cvt_pk_bf16_f32 v74, 0, v74
  v_cvt_pk_bf16_f32 v75, 0, v75
  v_cvt_pk_bf16_f32 v76, 0, v76
  v_cvt_pk_bf16_f32 v77, 0, v77
  v_cvt_pk_bf16_f32 v78, 0, v78
  v_cvt_pk_bf16_f32 v79, 0, v79
  v_cvt_pk_bf16_f32 v80, 0, v80
  v_cvt_pk_bf16_f32 v81, 0, v81
  v_cvt_pk_bf16_f32 v82, 0, v82
  v_cvt_pk_bf16_f32 v83, 0, v83
  v_cvt_pk_bf16_f32 v84, 0, v84
  v_cvt_pk_bf16_f32 v85, 0, v85
  v_cvt_pk_bf16_f32 v86, 0, v86
  v_cvt_pk_bf16_f32 v87, 0, v87
  v_add_f32 v104, v104, v72
  v_add_f32 v105, v105, v73
  v_add_f32 v106, v106, v74
  v_add_f32 v107, v107, v75
  v_add_f32 v108, v108, v76
  v_add_f32 v109, v109, v77
  v_add_f32 v110, v110, v78
  v_add_f32 v111, v111, v79
  v_add_f32 v112, v112, v80
  v_add_f32 v113, v113, v81
  v_add_f32 v114, v114, v82
  v_add_f32 v115, v115, v83
  v_add_f32 v116, v116, v84
  v_add_f32 v117, v117, v85
  v_add_f32 v118, v118, v86
  v_add_f32 v119, v119, v87
  v_cvt_pk_bf16_f32 v104, 0, v104
  v_cvt_pk_bf16_f32 v105, 0, v105
  v_cvt_pk_bf16_f32 v106, 0, v106
  v_cvt_pk_bf16_f32 v107, 0, v107
  v_cvt_pk_bf16_f32 v108, 0, v108
  v_cvt_pk_bf16_f32 v109, 0, v109
  v_cvt_pk_bf16_f32 v110, 0, v110
  v_cvt_pk_bf16_f32 v111, 0, v111
  v_cvt_pk_bf16_f32 v112, 0, v112
  v_cvt_pk_bf16_f32 v113, 0, v113
  v_cvt_pk_bf16_f32 v114, 0, v114
  v_cvt_pk_bf16_f32 v115, 0, v115
  v_cvt_pk_bf16_f32 v116, 0, v116
  v_cvt_pk_bf16_f32 v117, 0, v117
  v_cvt_pk_bf16_f32 v118, 0, v118
  v_cvt_pk_bf16_f32 v119, 0, v119
  v_cvt_pk_bf16_f32 v40, v104, v105
  v_cvt_pk_bf16_f32 v41, v106, v107
  v_cvt_pk_bf16_f32 v42, v108, v109
  v_cvt_pk_bf16_f32 v43, v110, v111
  v_cvt_pk_bf16_f32 v44, v112, v113
  v_cvt_pk_bf16_f32 v45, v114, v115
  v_cvt_pk_bf16_f32 v46, v116, v117
  v_cvt_pk_bf16_f32 v47, v118, v119
  global_store_dwordx4 v0, v[40:43], s[38:39] offset:0 sc1
  global_store_dwordx4 v0, v[44:47], s[38:39] offset:1024 sc1
  s_endpgm
L_gv:
  v_mov_b32 v72, 0
  v_mov_b32 v73, 0
  v_mov_b32 v74, 0
  v_mov_b32 v75, 0
  v_mov_b32 v76, 0
  v_mov_b32 v77, 0
  v_mov_b32 v78, 0
  v_mov_b32 v79, 0
  v_mov_b32 v80, 0
  v_mov_b32 v81, 0
  v_mov_b32 v82, 0
  v_mov_b32 v83, 0
  v_mov_b32 v84, 0
  v_mov_b32 v85, 0
  v_mov_b32 v86, 0
  v_mov_b32 v87, 0
  s_mov_b32 s10, 0
L_gvl:
  buffer_load_dwordx4 v[40:43], v2, s[44:47], s10 offen
  s_add_u32 s10, s10, s11
  buffer_load_dwordx4 v[44:47], v2, s[44:47], s10 offen
  s_add_u32 s10, s10, s11
  buffer_load_dwordx4 v[48:51], v2, s[44:47], s10 offen
  s_add_u32 s10, s10, s11
  buffer_load_dwordx4 v[52:55], v2, s[44:47], s10 offen
  s_add_u32 s10, s10, s11
  buffer_load_dwordx4 v[56:59], v2, s[44:47], s10 offen
  s_add_u32 s10, s10, s11
  buffer_load_dwordx4 v[60:63], v2, s[44:47], s10 offen
  s_add_u32 s10, s10, s11
  buffer_load_dwordx4 v[64:67], v2, s[44:47], s10 offen
  s_add_u32 s10, s10, s11
  buffer_load_dwordx4 v[68:71], v2, s[44:47], s10 offen
  s_add_u32 s10, s10, s11
  ds_read_b128 v[88:91], v4
  ds_read_b128 v[92:95], v5
  v_add_u32 v4, 16, v4
  v_add_u32 v5, 16, v5
  s_waitcnt lgkmcnt(0)
  v_and_b32 v8, 0xffff, v88
  v_lshlrev_b32 v9, 16, v88
  v_and_b32 v10, 0xffff, v92
  v_lshlrev_b32 v11, 16, v92
  s_waitcnt vmcnt(7)
  v_dot2c_f32_bf16 v72, v8, v40
  v_dot2c_f32_bf16 v73, v9, v40
  v_dot2c_f32_bf16 v74, v8, v41
  v_dot2c_f32_bf16 v75, v9, v41
  v_dot2c_f32_bf16 v76, v8, v42
  v_dot2c_f32_bf16 v77, v9, v42
  v_dot2c_f32_bf16 v78, v8, v43
  v_dot2c_f32_bf16 v79, v9, v43
  v_dot2c_f32_bf16 v80, v10, v40
  v_dot2c_f32_bf16 v81, v11, v40
  v_dot2c_f32_bf16 v82, v10, v41
  v_dot2c_f32_bf16 v83, v11, v41
  v_dot2c_f32_bf16 v84, v10, v42
  v_dot2c_f32_bf16 v85, v11, v42
  v_dot2c_f32_bf16 v86, v10, v43
  v_dot2c_f32_bf16 v87, v11, v43
  v_lshrrev_b32 v8, 16, v88
  v_and_b32 v9, s73, v88
  v_lshrrev_b32 v10, 16, v92
  v_and_b32 v11, s73, v92
  s_waitcnt vmcnt(6)
  v_dot2c_f32_bf16 v72, v8, v44
  v_dot2c_f32_bf16 v73, v9, v44
  v_dot2c_f32_bf16 v74, v8, v45
  v_dot2c_f32_bf16 v75, v9, v45
  v_dot2c_f32_bf16 v76, v8, v46
  v_dot2c_f32_bf16 v77, v9, v46
  v_dot2c_f32_bf16 v78, v8, v47
  v_dot2c_f32_bf16 v79, v9, v47
  v_dot2c_f32_bf16 v80, v10, v44
  v_dot2c_f32_bf16 v81, v11, v44
  v_dot2c_f32_bf16 v82, v10, v45
  v_dot2c_f32_bf16 v83, v11, v45
  v_dot2c_f32_bf16 v84, v10, v46
  v_dot2c_f32_bf16 v85, v11, v46
  v_dot2c_f32_bf16 v86, v10, v47
  v_dot2c_f32_bf16 v87, v11, v47
  v_and_b32 v8, 0xffff, v89
  v_lshlrev_b32 v9, 16, v89
  v_and_b32 v10, 0xffff, v93
  v_lshlrev_b32 v11, 16, v93
  s_waitcnt vmcnt(5)
  v_dot2c_f32_bf16 v72, v8, v48
  v_dot2c_f32_bf16 v73, v9, v48
  v_dot2c_f32_bf16 v74, v8, v49
  v_dot2c_f32_bf16 v75, v9, v49
  v_dot2c_f32_bf16 v76, v8, v50
  v_dot2c_f32_bf16 v77, v9, v50
  v_dot2c_f32_bf16 v78, v8, v51
  v_dot2c_f32_bf16 v79, v9, v51
  v_dot2c_f32_bf16 v80, v10, v48
  v_dot2c_f32_bf16 v81, v11, v48
  v_dot2c_f32_bf16 v82, v10, v49
  v_dot2c_f32_bf16 v83, v11, v49
  v_dot2c_f32_bf16 v84, v10, v50
  v_dot2c_f32_bf16 v85, v11, v50
  v_dot2c_f32_bf16 v86, v10, v51
  v_dot2c_f32_bf16 v87, v11, v51
  v_lshrrev_b32 v8, 16, v89
  v_and_b32 v9, s73, v89
  v_lshrrev_b32 v10, 16, v93
  v_and_b32 v11, s73, v93
  s_waitcnt vmcnt(4)
  v_dot2c_f32_bf16 v72, v8, v52
  v_dot2c_f32_bf16 v73, v9, v52
  v_dot2c_f32_bf16 v74, v8, v53
  v_dot2c_f32_bf16 v75, v9, v53
  v_dot2c_f32_bf16 v76, v8, v54
  v_dot2c_f32_bf16 v77, v9, v54
  v_dot2c_f32_bf16 v78, v8, v55
  v_dot2c_f32_bf16 v79, v9, v55
  v_dot2c_f32_bf16 v80, v10, v52
  v_dot2c_f32_bf16 v81, v11, v52
  v_dot2c_f32_bf16 v82, v10, v53
  v_dot2c_f32_bf16 v83, v11, v53
  v_dot2c_f32_bf16 v84, v10, v54
  v_dot2c_f32_bf16 v85, v11, v54
  v_dot2c_f32_bf16 v86, v10, v55
  v_dot2c_f32_bf16 v87, v11, v55
  v_and_b32 v8, 0xffff, v90
  v_lshlrev_b32 v9, 16, v90
  v_and_b32 v10, 0xffff, v94
  v_lshlrev_b32 v11, 16, v94
  s_waitcnt vmcnt(3)
  v_dot2c_f32_bf16 v72, v8, v56
  v_dot2c_f32_bf16 v73, v9, v56
  v_dot2c_f32_bf16 v74, v8, v57
  v_dot2c_f32_bf16 v75, v9, v57
  v_dot2c_f32_bf16 v76, v8, v58
  v_dot2c_f32_bf16 v77, v9, v58
  v_dot2c_f32_bf16 v78, v8, v59
  v_dot2c_f32_bf16 v79, v9, v59
  v_dot2c_f32_bf16 v80, v10, v56
  v_dot2c_f32_bf16 v81, v11, v56
  v_dot2c_f32_bf16 v82, v10, v57
  v_dot2c_f32_bf16 v83, v11, v57
  v_dot2c_f32_bf16 v84, v10, v58
  v_dot2c_f32_bf16 v85, v11, v58
  v_dot2c_f32_bf16 v86, v10, v59
  v_dot2c_f32_bf16 v87, v11, v59
  v_lshrrev_b32 v8, 16, v90
  v_and_b32 v9, s73, v90
  v_lshrrev_b32 v10, 16, v94
  v_and_b32 v11, s73, v94
  s_waitcnt vmcnt(2)
  v_dot2c_f32_bf16 v72, v8, v60
  v_dot2c_f32_bf16 v73, v9, v60
  v_dot2c_f32_bf16 v74, v8, v61
  v_dot2c_f32_bf16 v75, v9, v61
  v_dot2c_f32_bf16 v76, v8, v62
  v_dot2c_f32_bf16 v77, v9, v62
  v_dot2c_f32_bf16 v78, v8, v63
  v_dot2c_f32_bf16 v79, v9, v63
  v_dot2c_f32_bf16 v80, v10, v60
  v_dot2c_f32_bf16 v81, v11, v60
  v_dot2c_f32_bf16 v82, v10, v61
  v_dot2c_f32_bf16 v83, v11, v61
  v_dot2c_f32_bf16 v84, v10, v62
  v_dot2c_f32_bf16 v85, v11, v62
  v_dot2c_f32_bf16 v86, v10, v63
  v_dot2c_f32_bf16 v87, v11, v63
  v_and_b32 v8, 0xffff, v91
  v_lshlrev_b32 v9, 16, v91
  v_and_b32 v10, 0xffff, v95
  v_lshlrev_b32 v11, 16, v95
  s_waitcnt vmcnt(1)
  v_dot2c_f32_bf16 v72, v8, v64
  v_dot2c_f32_bf16 v73, v9, v64
  v_dot2c_f32_bf16 v74, v8, v65
  v_dot2c_f32_bf16 v75, v9, v65
  v_dot2c_f32_bf16 v76, v8, v66
  v_dot2c_f32_bf16 v77, v9, v66
  v_dot2c_f32_bf16 v78, v8, v67
  v_dot2c_f32_bf16 v79, v9, v67
  v_dot2c_f32_bf16 v80, v10, v64
  v_dot2c_f32_bf16 v81, v11, v64
  v_dot2c_f32_bf16 v82, v10, v65
  v_dot2c_f32_bf16 v83, v11, v65
  v_dot2c_f32_bf16 v84, v10, v66
  v_dot2c_f32_bf16 v85, v11, v66
  v_dot2c_f32_bf16 v86, v10, v67
  v_dot2c_f32_bf16 v87, v11, v67
  v_lshrrev_b32 v8, 16, v91
  v_and_b32 v9, s73, v91
  v_lshrrev_b32 v10, 16, v95
  v_and_b32 v11, s73, v95
  s_waitcnt vmcnt(0)
  v_dot2c_f32_bf16 v72, v8, v68
  v_dot2c_f32_bf16 v73, v9, v68
  v_dot2c_f32_bf16 v74, v8, v69
  v_dot2c_f32_bf16 v75, v9, v69
  v_dot2c_f32_bf16 v76, v8, v70
  v_dot2c_f32_bf16 v77, v9, v70
  v_dot2c_f32_bf16 v78, v8, v71
  v_dot2c_f32_bf16 v79, v9, v71
  v_dot2c_f32_bf16 v80, v10, v68
  v_dot2c_f32_bf16 v81, v11, v68
  v_dot2c_f32_bf16 v82, v10, v69
  v_dot2c_f32_bf16 v83, v11, v69
  v_dot2c_f32_bf16 v84, v10, v70
  v_dot2c_f32_bf16 v85, v11, v70
  v_dot2c_f32_bf16 v86, v10, v71
  v_dot2c_f32_bf16 v87, v11, v71
  s_cmp_lt_u32 s10, s12
  s_cbranch_scc1 L_gvl
  s_nop 1
  s_setpc_b64 s[62:63]
L_ks:
  s_waitcnt lgkmcnt(0)
  v_readfirstlane_b32 s78, v20
  v_readfirstlane_b32 s79, v21
  s_cmp_eq_u32 s32, s57
  s_cselect_b32 s34, s58, s34
  s_cmp_ge_u32 s39, 4
  s_cbranch_scc1 L_ks2
  s_call_b64 s[100:101], L_work
L_ks2:
  s_add_u32 s32, s32, 1
  s_mul_i32 s68, s35, s76
  s_sub_i32 s68, s68, s78
  s_sub_u32 s35, s35, 1
  s_add_i32 s68, s68, 1024
  s_mul_i32 s68, s68, 14
  s_add_i32 s68, s68, s34
  s_add_i32 s68, s68, s79
  s_max_i32 s68, s68, 384
  s_min_i32 s68, s68, 1280
  s_lshl_b32 s69, s68, 24
  s_lshr_b32 s68, s68, 8
  s_add_u32 s33, s33, s69
  s_addc_u32 s41, s68, 0
L_wait:
  s_waitcnt vmcnt(4)
  s_cmp_ge_u32 s41, 5
  s_cbranch_scc1 L_ret
  s_waitcnt vmcnt(3)
  s_cmp_ge_u32 s41, 4
  s_cbranch_scc1 L_ret
  s_waitcnt vmcnt(2)
  s_cmp_ge_u32 s41, 3
  s_cbranch_scc1 L_ret
  s_waitcnt vmcnt(1)
  s_cmp_ge_u32 s41, 2
  s_cbranch_scc1 L_ret
  s_waitcnt vmcnt(0)
L_ret:
  s_mov_b64 exec, 1
  ds_dec_u32 v23, v39 offset:6688
  ds_read_b64 v[20:21], v23 offset:6688
  s_mov_b64 exec, -1
  s_cmp_lg_u32 s32, s32
  s_setpc_b64 s[62:63]
L_vs:
  s_waitcnt lgkmcnt(0)
  v_readfirstlane_b32 s78, v20
  v_readfirstlane_b32 s79, v21
  s_cmp_eq_u32 s61, 2
  s_cbranch_scc1 L_vs1
  s_cmp_eq_u32 s61, 1
  s_cbranch_scc1 L_x3
  s_cmp_gt_u32 s41, s32
  s_cbranch_scc1 L_ks2
L_x1:
  v_dot2_f32_bf16 v8, v136, v4, 0
  v_dot2_f32_bf16 v9, v140, v4, 0
  v_dot2_f32_bf16 v10, v144, v4, 0
  v_dot2_f32_bf16 v11, v148, v4, 0
  v_dot2_f32_bf16 v12, v152, v4, 0
  v_dot2_f32_bf16 v13, v156, v4, 0
  v_dot2_f32_bf16 v14, v160, v4, 0
  v_dot2_f32_bf16 v15, v164, v4, 0
  v_dot2_f32_bf16 v8, v137, v5, v8
  v_dot2_f32_bf16 v9, v141, v5, v9
  v_dot2_f32_bf16 v10, v145, v5, v10
  v_dot2_f32_bf16 v11, v149, v5, v11
  v_dot2_f32_bf16 v12, v153, v5, v12
  v_dot2_f32_bf16 v13, v157, v5, v13
  v_dot2_f32_bf16 v14, v161, v5, v14
  v_dot2_f32_bf16 v15, v165, v5, v15
  v_dot2_f32_bf16 v8, v138, v6, v8
  v_dot2_f32_bf16 v9, v142, v6, v9
  v_dot2_f32_bf16 v10, v146, v6, v10
  v_dot2_f32_bf16 v11, v150, v6, v11
  v_dot2_f32_bf16 v12, v154, v6, v12
  v_dot2_f32_bf16 v13, v158, v6, v13
  v_dot2_f32_bf16 v14, v162, v6, v14
  v_dot2_f32_bf16 v15, v166, v6, v15
  v_dot2_f32_bf16 v8, v139, v7, v8
  v_dot2_f32_bf16 v9, v143, v7, v9
  v_dot2_f32_bf16 v10, v147, v7, v10
  v_dot2_f32_bf16 v11, v151, v7, v11
  v_dot2_f32_bf16 v12, v155, v7, v12
  v_dot2_f32_bf16 v13, v159, v7, v13
  v_dot2_f32_bf16 v14, v163, v7, v14
  v_dot2_f32_bf16 v15, v167, v7, v15
  v_add_f32_dpp v8, v8, v8 row_ror:8 row_mask:0xf bank_mask:0x3
  v_add_f32_dpp v8, v9, v9 row_ror:8 row_mask:0xf bank_mask:0xc
  v_add_f32_dpp v10, v10, v10 row_ror:8 row_mask:0xf bank_mask:0x3
  v_add_f32_dpp v10, v11, v11 row_ror:8 row_mask:0xf bank_mask:0xc
  v_add_f32_dpp v12, v12, v12 row_ror:8 row_mask:0xf bank_mask:0x3
  v_add_f32_dpp v12, v13, v13 row_ror:8 row_mask:0xf bank_mask:0xc
  v_add_f32_dpp v14, v14, v14 row_ror:8 row_mask:0xf bank_mask:0x3
  v_add_f32_dpp v14, v15, v15 row_ror:8 row_mask:0xf bank_mask:0xc
  v_add_f32_dpp v18, v8, v8 row_shl:4 row_mask:0xf bank_mask:0x5
  v_add_f32_dpp v18, v10, v10 row_shr:4 row_mask:0xf bank_mask:0xa
  v_add_f32_dpp v19, v12, v12 row_shl:4 row_mask:0xf bank_mask:0x5
  v_add_f32_dpp v19, v14, v14 row_shr:4 row_mask:0xf bank_mask:0xa
  s_lshl_b32 s68, s20, 3
  s_add_u32 s68, s68, s56
  v_add_f32_dpp v16, v16, v16 quad_perm:[2,3,0,1] row_mask:0xf bank_mask:0xf
  v_add_f32_dpp v17, v17, v17 quad_perm:[2,3,0,1] row_mask:0xf bank_mask:0xf
  v_add_f32_dpp v18, v18, v18 quad_perm:[2,3,0,1] row_mask:0xf bank_mask:0xf
  v_add_f32_dpp v19, v19, v19 quad_perm:[2,3,0,1] row_mask:0xf bank_mask:0xf
  v_cndmask_b32 v8, v16, v17, s[52:53]
  v_cndmask_b32 v9, v18, v19, s[52:53]
  v_mov_b32 v20, 64
  v_lshlrev_b32 v21, 3, s9
  v_add_f32_dpp v8, v8, v8 quad_perm:[1,0,3,2] row_mask:0xf bank_mask:0xf
  v_add_f32_dpp v9, v9, v9 quad_perm:[1,0,3,2] row_mask:0xf bank_mask:0xf
  v_cndmask_b32 v27, v8, v9, s[54:55]
  v_cvt_pk_bf16_f32 v27, 0, v27
  v_mul_f32 v27, 0x3db504f3, v27
  v_cvt_pk_bf16_f32 v27, 0, v27
  v_max_f32 v37, v37, v27
  v_cmp_ngt_f32 vcc, s22, v27
  v_mov_b32 v4, 0
  v_max_f32_dpp v37, v37, v37 row_ror:8 row_mask:0xf bank_mask:0xf
  s_bcnt1_i32_b64 s69, vcc
  s_add_u32 s69, s69, s20
  v_max_f32_dpp v37, v37, v37 row_ror:4 row_mask:0xf bank_mask:0xf
  s_cmp_gt_u32 s69, 32
  s_cselect_b32 s21, 1, s21
  v_max_f32_dpp v37, v37, v37 row_ror:2 row_mask:0xf bank_mask:0xf
  s_cmp_eq_u32 s21, 0
  s_cselect_b64 s[66:67], vcc, 0
  s_cselect_b32 s20, s69, s20
  v_max_f32_dpp v37, v37, v37 row_ror:1 row_mask:0xf bank_mask:0xf
  v_mbcnt_lo_u32_b32 v3, s66, 0
  v_mov_b32 v8, v37
  v_mbcnt_hi_u32_b32 v3, s67, v3
  v_lshl_add_u32 v3, v3, 3, s68
  v_permlane16_swap_b32 v8, v37
  s_mov_b64 exec, s[66:67]
  ds_write_b64 v3, v[26:27] offset:1280
  s_mov_b64 exec, -1
  ds_read_b32 v32, v39 offset:1024
  v_max_f32 v37, v37, v8
  v_mov_b32 v8, v37
  v_mov_b32 v5, 0
  s_mov_b32 s18, s32
  v_permlane32_swap_b32 v8, v37
  v_max_f32 v37, v37, v8
  v_sub_f32 v17, v25, v37
  v_sub_f32 v18, v27, v37
  v_mul_f32 v17, 0x3fb8aa3b, v17
  v_mul_f32 v18, 0x3fb8aa3b, v18
  v_exp_f32 v17, v17
  v_exp_f32 v18, v18
  v_mov_b32 v16, v37
  v_add_f32 v17, v17, v18
  s_waitcnt lgkmcnt(0)
  s_cmp_le_u32 s20, 0
  s_cbranch_scc1 L_x2
  v_add_u32_dpp v3, v32, v38 row_newbcast:8 row_mask:0xf bank_mask:0xf
  buffer_load_dwordx4 v[136:139], v3, s[48:51], 0 offen nt
  s_cmp_le_u32 s20, 4
  s_cbranch_scc1 L_x2
  v_add_u32_dpp v3, v32, v38 row_newbcast:9 row_mask:0xf bank_mask:0xf
  buffer_load_dwordx4 v[140:143], v3, s[48:51], 0 offen nt
  s_cmp_le_u32 s20, 8
  s_cbranch_scc1 L_x2
  v_add_u32_dpp v3, v32, v38 row_newbcast:10 row_mask:0xf bank_mask:0xf
  buffer_load_dwordx4 v[144:147], v3, s[48:51], 0 offen nt
  s_cmp_le_u32 s20, 12
  s_cbranch_scc1 L_x2
  v_add_u32_dpp v3, v32, v38 row_newbcast:11 row_mask:0xf bank_mask:0xf
  buffer_load_dwordx4 v[148:151], v3, s[48:51], 0 offen nt
  s_cmp_le_u32 s20, 16
  s_cbranch_scc1 L_x2
  v_add_u32_dpp v3, v32, v38 row_newbcast:12 row_mask:0xf bank_mask:0xf
  buffer_load_dwordx4 v[152:155], v3, s[48:51], 0 offen nt
  s_cmp_le_u32 s20, 20
  s_cbranch_scc1 L_x2
  v_add_u32_dpp v3, v32, v38 row_newbcast:13 row_mask:0xf bank_mask:0xf
  buffer_load_dwordx4 v[156:159], v3, s[48:51], 0 offen nt
  s_cmp_le_u32 s20, 24
  s_cbranch_scc1 L_x2
  v_add_u32_dpp v3, v32, v38 row_newbcast:14 row_mask:0xf bank_mask:0xf
  buffer_load_dwordx4 v[160:163], v3, s[48:51], 0 offen nt
  s_cmp_le_u32 s20, 28
  s_cbranch_scc1 L_x2
  v_add_u32_dpp v3, v32, v38 row_newbcast:15 row_mask:0xf bank_mask:0xf
  buffer_load_dwordx4 v[164:167], v3, s[48:51], 0 offen nt
L_x2:
  s_nop 1
  v_add_f32_dpp v17, v17, v17 row_ror:8 row_mask:0xf bank_mask:0xf
  s_nop 1
  v_add_f32_dpp v17, v17, v17 row_ror:4 row_mask:0xf bank_mask:0xf
  s_nop 1
  v_add_f32_dpp v17, v17, v17 row_ror:2 row_mask:0xf bank_mask:0xf
  s_nop 1
  v_add_f32_dpp v17, v17, v17 row_ror:1 row_mask:0xf bank_mask:0xf
  v_mov_b32 v8, v17
  s_nop 1
  v_permlane16_swap_b32 v8, v17
  v_add_f32 v17, v17, v8
  v_mov_b32 v8, v17
  s_nop 1
  v_permlane32_swap_b32 v8, v17
  v_add_f32 v17, v17, v8
  s_mov_b64 exec, 1
  ds_max_f32 v1, v37 offset:6676
  ds_write_b64 v21, v[16:17] offset:6912
  ds_add_u32 v1, v20 offset:6672
  s_mov_b64 exec, -1
  s_mov_b32 s61, 1
  s_mov_b32 s19, 1
  s_cmp_lt_u32 s32, 5
  s_cbranch_scc1 L_ks2
L_x3:
  v_max_f32 v21, v2, v37
  s_add_u32 s38, s38, 3
  s_lshr_b32 s38, s38, 2
  v_add_f32 v21, 0xc2ac0000, v21
  s_max_u32 s38, s38, s32
  s_lshl_b32 s38, s38, 2
  v_cmp_nlt_f32 vcc, v27, v21
  s_lshl_b32 s68, s38, 3
  s_add_u32 s68, s68, s56
  s_andn2_b64 s[70:71], vcc, s[66:67]
  v_mbcnt_lo_u32_b32 v3, s70, 0
  v_mbcnt_hi_u32_b32 v3, s71, v3
  s_bcnt1_i32_b64 s69, s[70:71]
  v_lshl_add_u32 v3, v3, 3, s68
  s_mov_b64 exec, s[70:71]
  ds_write_b64 v3, v[26:27]
  s_mov_b64 exec, -1
  s_or_b64 s[66:67], s[66:67], s[70:71]
  s_add_u32 s38, s38, s69
  ds_read_b64 v[28:29], v39 offset:0
  ds_read_b64 v[30:31], v39 offset:512
  ds_read_b64 v[32:33], v39 offset:1024
  v_mov_b32 v8, 0
  v_mov_b32 v9, 0
  v_mov_b32 v10, 0
  v_mov_b32 v11, 0
  v_mov_b32 v12, 0
  v_mov_b32 v13, 0
  v_mov_b32 v14, 0
  v_mov_b32 v15, 0
  s_lshr_b32 s36, s38, 2
  s_mov_b32 s61, 2
  s_add_u32 s68, s38, 8
  s_lshr_b32 s68, s68, 2
  s_sub_u32 s69, s68, s59
  s_mov_b32 s59, s68
  s_add_u32 s35, s35, s69
  s_add_u32 s78, s78, s69
  v_mov_b32 v3, s69
  s_mov_b64 exec, 1
  ds_add_u32 v1, v3 offset:6696
  s_mov_b64 exec, -1
  s_waitcnt lgkmcnt(0)
  v_sub_f32 v29, v29, v37
  v_sub_f32 v31, v31, v37
  v_sub_f32 v33, v33, v37
  v_mul_f32 v29, 0x3fb8aa3b, v29
  v_mul_f32 v31, 0x3fb8aa3b, v31
  v_mul_f32 v33, 0x3fb8aa3b, v33
  v_exp_f32 v29, v29
  v_exp_f32 v31, v31
  v_exp_f32 v33, v33
  s_nop 0
  v_cvt_pk_bf16_f32 v34, 0, v29
  v_cvt_pk_bf16_f32 v35, 0, v31
  v_cvt_pk_bf16_f32 v36, 0, v33
  v_cvt_pk_bf16_f32 v29, v29, 0
  v_cvt_pk_bf16_f32 v31, v31, 0
  v_cvt_pk_bf16_f32 v33, v33, 0
  s_cmp_eq_u32 s20, 0
  s_cselect_b32 s41, 0, s41
L_vs1:
  s_cmp_eq_u32 s19, 0
  s_cbranch_scc1 L_vs1b
  s_sub_u32 s68, s32, s18
  s_cmp_le_u32 s41, s68
  s_cbranch_scc1 L_snap
  s_cmp_lg_u32 s36, s32
  s_cbranch_scc1 L_vs2
  s_waitcnt vmcnt(0)
L_snap:
  v_mov_b32 v6, 0
  v_mov_b32 v7, 0
  v_mov_b32 v16, 0
  v_mov_b32 v17, 0
  v_mov_b32 v18, 0
  v_mov_b32 v19, 0
  s_cmp_le_u32 s20, 0
  s_cbranch_scc1 L_snp2
  v_dot2c_f32_bf16_dpp v4, v33, v136 row_newbcast:8 row_mask:0xf bank_mask:0xf
  v_dot2c_f32_bf16_dpp v5, v36, v136 row_newbcast:8 row_mask:0xf bank_mask:0xf
  v_dot2c_f32_bf16_dpp v6, v33, v137 row_newbcast:8 row_mask:0xf bank_mask:0xf
  v_dot2c_f32_bf16_dpp v7, v36, v137 row_newbcast:8 row_mask:0xf bank_mask:0xf
  v_dot2c_f32_bf16_dpp v16, v33, v138 row_newbcast:8 row_mask:0xf bank_mask:0xf
  v_dot2c_f32_bf16_dpp v17, v36, v138 row_newbcast:8 row_mask:0xf bank_mask:0xf
  v_dot2c_f32_bf16_dpp v18, v33, v139 row_newbcast:8 row_mask:0xf bank_mask:0xf
  v_dot2c_f32_bf16_dpp v19, v36, v139 row_newbcast:8 row_mask:0xf bank_mask:0xf
  s_cmp_le_u32 s20, 4
  s_cbranch_scc1 L_snp2
  v_dot2c_f32_bf16_dpp v4, v33, v140 row_newbcast:9 row_mask:0xf bank_mask:0xf
  v_dot2c_f32_bf16_dpp v5, v36, v140 row_newbcast:9 row_mask:0xf bank_mask:0xf
  v_dot2c_f32_bf16_dpp v6, v33, v141 row_newbcast:9 row_mask:0xf bank_mask:0xf
  v_dot2c_f32_bf16_dpp v7, v36, v141 row_newbcast:9 row_mask:0xf bank_mask:0xf
  v_dot2c_f32_bf16_dpp v16, v33, v142 row_newbcast:9 row_mask:0xf bank_mask:0xf
  v_dot2c_f32_bf16_dpp v17, v36, v142 row_newbcast:9 row_mask:0xf bank_mask:0xf
  v_dot2c_f32_bf16_dpp v18, v33, v143 row_newbcast:9 row_mask:0xf bank_mask:0xf
  v_dot2c_f32_bf16_dpp v19, v36, v143 row_newbcast:9 row_mask:0xf bank_mask:0xf
  s_cmp_le_u32 s20, 8
  s_cbranch_scc1 L_snp2
  v_dot2c_f32_bf16_dpp v4, v33, v144 row_newbcast:10 row_mask:0xf bank_mask:0xf
  v_dot2c_f32_bf16_dpp v5, v36, v144 row_newbcast:10 row_mask:0xf bank_mask:0xf
  v_dot2c_f32_bf16_dpp v6, v33, v145 row_newbcast:10 row_mask:0xf bank_mask:0xf
  v_dot2c_f32_bf16_dpp v7, v36, v145 row_newbcast:10 row_mask:0xf bank_mask:0xf
  v_dot2c_f32_bf16_dpp v16, v33, v146 row_newbcast:10 row_mask:0xf bank_mask:0xf
  v_dot2c_f32_bf16_dpp v17, v36, v146 row_newbcast:10 row_mask:0xf bank_mask:0xf
  v_dot2c_f32_bf16_dpp v18, v33, v147 row_newbcast:10 row_mask:0xf bank_mask:0xf
  v_dot2c_f32_bf16_dpp v19, v36, v147 row_newbcast:10 row_mask:0xf bank_mask:0xf
  s_cmp_le_u32 s20, 12
  s_cbranch_scc1 L_snp2
  v_dot2c_f32_bf16_dpp v4, v33, v148 row_newbcast:11 row_mask:0xf bank_mask:0xf
  v_dot2c_f32_bf16_dpp v5, v36, v148 row_newbcast:11 row_mask:0xf bank_mask:0xf
  v_dot2c_f32_bf16_dpp v6, v33, v149 row_newbcast:11 row_mask:0xf bank_mask:0xf
  v_dot2c_f32_bf16_dpp v7, v36, v149 row_newbcast:11 row_mask:0xf bank_mask:0xf
  v_dot2c_f32_bf16_dpp v16, v33, v150 row_newbcast:11 row_mask:0xf bank_mask:0xf
  v_dot2c_f32_bf16_dpp v17, v36, v150 row_newbcast:11 row_mask:0xf bank_mask:0xf
  v_dot2c_f32_bf16_dpp v18, v33, v151 row_newbcast:11 row_mask:0xf bank_mask:0xf
  v_dot2c_f32_bf16_dpp v19, v36, v151 row_newbcast:11 row_mask:0xf bank_mask:0xf
  s_cmp_le_u32 s20, 16
  s_cbranch_scc1 L_snp2
  v_dot2c_f32_bf16_dpp v4, v33, v152 row_newbcast:12 row_mask:0xf bank_mask:0xf
  v_dot2c_f32_bf16_dpp v5, v36, v152 row_newbcast:12 row_mask:0xf bank_mask:0xf
  v_dot2c_f32_bf16_dpp v6, v33, v153 row_newbcast:12 row_mask:0xf bank_mask:0xf
  v_dot2c_f32_bf16_dpp v7, v36, v153 row_newbcast:12 row_mask:0xf bank_mask:0xf
  v_dot2c_f32_bf16_dpp v16, v33, v154 row_newbcast:12 row_mask:0xf bank_mask:0xf
  v_dot2c_f32_bf16_dpp v17, v36, v154 row_newbcast:12 row_mask:0xf bank_mask:0xf
  v_dot2c_f32_bf16_dpp v18, v33, v155 row_newbcast:12 row_mask:0xf bank_mask:0xf
  v_dot2c_f32_bf16_dpp v19, v36, v155 row_newbcast:12 row_mask:0xf bank_mask:0xf
  s_cmp_le_u32 s20, 20
  s_cbranch_scc1 L_snp2
  v_dot2c_f32_bf16_dpp v4, v33, v156 row_newbcast:13 row_mask:0xf bank_mask:0xf
  v_dot2c_f32_bf16_dpp v5, v36, v156 row_newbcast:13 row_mask:0xf bank_mask:0xf
  v_dot2c_f32_bf16_dpp v6, v33, v157 row_newbcast:13 row_mask:0xf bank_mask:0xf
  v_dot2c_f32_bf16_dpp v7, v36, v157 row_newbcast:13 row_mask:0xf bank_mask:0xf
  v_dot2c_f32_bf16_dpp v16, v33, v158 row_newbcast:13 row_mask:0xf bank_mask:0xf
  v_dot2c_f32_bf16_dpp v17, v36, v158 row_newbcast:13 row_mask:0xf bank_mask:0xf
  v_dot2c_f32_bf16_dpp v18, v33, v159 row_newbcast:13 row_mask:0xf bank_mask:0xf
  v_dot2c_f32_bf16_dpp v19, v36, v159 row_newbcast:13 row_mask:0xf bank_mask:0xf
  s_cmp_le_u32 s20, 24
  s_cbranch_scc1 L_snp2
  v_dot2c_f32_bf16_dpp v4, v33, v160 row_newbcast:14 row_mask:0xf bank_mask:0xf
  v_dot2c_f32_bf16_dpp v5, v36, v160 row_newbcast:14 row_mask:0xf bank_mask:0xf
  v_dot2c_f32_bf16_dpp v6, v33, v161 row_newbcast:14 row_mask:0xf bank_mask:0xf
  v_dot2c_f32_bf16_dpp v7, v36, v161 row_newbcast:14 row_mask:0xf bank_mask:0xf
  v_dot2c_f32_bf16_dpp v16, v33, v162 row_newbcast:14 row_mask:0xf bank_mask:0xf
  v_dot2c_f32_bf16_dpp v17, v36, v162 row_newbcast:14 row_mask:0xf bank_mask:0xf
  v_dot2c_f32_bf16_dpp v18, v33, v163 row_newbcast:14 row_mask:0xf bank_mask:0xf
  v_dot2c_f32_bf16_dpp v19, v36, v163 row_newbcast:14 row_mask:0xf bank_mask:0xf
  s_cmp_le_u32 s20, 28
  s_cbranch_scc1 L_snp2
  v_dot2c_f32_bf16_dpp v4, v33, v164 row_newbcast:15 row_mask:0xf bank_mask:0xf
  v_dot2c_f32_bf16_dpp v5, v36, v164 row_newbcast:15 row_mask:0xf bank_mask:0xf
  v_dot2c_f32_bf16_dpp v6, v33, v165 row_newbcast:15 row_mask:0xf bank_mask:0xf
  v_dot2c_f32_bf16_dpp v7, v36, v165 row_newbcast:15 row_mask:0xf bank_mask:0xf
  v_dot2c_f32_bf16_dpp v16, v33, v166 row_newbcast:15 row_mask:0xf bank_mask:0xf
  v_dot2c_f32_bf16_dpp v17, v36, v166 row_newbcast:15 row_mask:0xf bank_mask:0xf
  v_dot2c_f32_bf16_dpp v18, v33, v167 row_newbcast:15 row_mask:0xf bank_mask:0xf
  v_dot2c_f32_bf16_dpp v19, v36, v167 row_newbcast:15 row_mask:0xf bank_mask:0xf
L_snp2:
  s_nop 1
  s_nop 0
  v_permlane32_swap_b32 v4, v16
  v_permlane32_swap_b32 v5, v17
  v_permlane32_swap_b32 v6, v18
  v_permlane32_swap_b32 v7, v19
  v_add_f32 v4, v4, v16
  v_add_f32 v5, v5, v17
  v_add_f32 v6, v6, v18
  v_add_f32 v7, v7, v19
  v_mov_b32 v3, 1
  v_permlane16_swap_b32 v4, v6
  v_permlane16_swap_b32 v5, v7
  v_add_f32 v4, v4, v6
  v_add_f32 v5, v5, v7
  s_mov_b32 s19, 0
  s_cmp_lg_u32 s21, 0
  s_cbranch_scc1 L_vs1b
  ds_write_b64 v22, v[4:5] offset:13056
  s_mov_b64 exec, 1
  ds_add_u32 v1, v3 offset:6704
  s_mov_b64 exec, -1
L_vs1b:
  s_cmp_eq_u32 s36, s32
  s_cbranch_scc1 L_hand
L_vs2:
  s_cmp_lt_u32 s32, s37
  s_cbranch_scc1 L_ks2
  s_sub_u32 s41, s36, s32
  s_add_u32 s32, s32, 1
  s_cmp_gt_u32 s41, 5
  s_cbranch_scc1 L_wait
  s_waitcnt vmcnt(4)
  s_cmp_ge_u32 s41, 5
  s_cbranch_scc1 L_ret2
  s_waitcnt vmcnt(3)
  s_cmp_ge_u32 s41, 4
  s_cbranch_scc1 L_ret2
  s_waitcnt vmcnt(2)
  s_cmp_ge_u32 s41, 3
  s_cbranch_scc1 L_ret2
  s_waitcnt vmcnt(1)
  s_cmp_ge_u32 s41, 2
  s_cbranch_scc1 L_ret2
  s_waitcnt vmcnt(0)
L_ret2:
  s_cmp_eq_u32 s32, s32
  s_setpc_b64 s[62:63]
L_hand:
  v_mov_b32 v3, 0
  s_mov_b32 s70, 0
L_sn_4:
  ds_read_b64 v[18:19], v3 offset:6672
  s_waitcnt lgkmcnt(0)
  v_cmp_gt_u32 vcc, 0x10280, v18
  s_cmp_eq_u64 vcc, 0
  s_cbranch_scc1 L_snd_5
  s_sleep 1
  s_add_u32 s70, s70, 1
  s_cmp_lt_u32 s70, 2097152
  s_cbranch_scc1 L_sn_4
L_snd_5:
  v_add_f32 v21, 0xc2ba0000, v19
  v_cmp_nlt_f32 vcc, v25, v21
  s_lshl_b32 s68, s38, 3
  s_add_u32 s68, s68, s56
  s_andn2_b64 s[70:71], vcc, s[64:65]
  v_mbcnt_lo_u32_b32 v3, s70, 0
  v_mbcnt_hi_u32_b32 v3, s71, v3
  s_bcnt1_i32_b64 s69, s[70:71]
  v_lshl_add_u32 v3, v3, 3, s68
  s_mov_b64 exec, s[70:71]
  ds_write_b64 v3, v[24:25]
  s_mov_b64 exec, -1
  s_or_b64 s[64:65], s[64:65], s[70:71]
  s_add_u32 s38, s38, s69
  v_cmp_nlt_f32 vcc, v27, v21
  s_lshl_b32 s68, s38, 3
  s_add_u32 s68, s68, s56
  s_andn2_b64 s[70:71], vcc, s[66:67]
  v_mbcnt_lo_u32_b32 v3, s70, 0
  v_mbcnt_hi_u32_b32 v3, s71, v3
  s_bcnt1_i32_b64 s69, s[70:71]
  v_lshl_add_u32 v3, v3, 3, s68
  s_mov_b64 exec, s[70:71]
  ds_write_b64 v3, v[26:27]
  s_mov_b64 exec, -1
  s_or_b64 s[66:67], s[66:67], s[70:71]
  s_add_u32 s38, s38, s69
  ds_read_b64 v[28:29], v39 offset:0
  ds_read_b64 v[30:31], v39 offset:512
  ds_read_b64 v[32:33], v39 offset:1024
  s_add_u32 s36, s38, 23
  s_lshr_b32 s36, s36, 2
  s_sub_u32 s37, s36, 9
  s_max_i32 s37, s37, 0
  s_mov_b32 s75, s36
  s_add_u32 s68, s38, 3
  s_lshr_b32 s68, s68, 2
  s_sub_u32 s69, s68, s59
  s_mov_b32 s59, s68
  s_add_u32 s35, s35, s69
  s_add_u32 s78, s78, s69
  v_mov_b32 v3, s69
  s_mov_b64 exec, 1
  ds_add_u32 v1, v3 offset:6696
  s_mov_b64 exec, -1
  s_waitcnt lgkmcnt(0)
  v_sub_f32 v29, v29, v37
  v_sub_f32 v31, v31, v37
  v_sub_f32 v33, v33, v37
  v_mul_f32 v29, 0x3fb8aa3b, v29
  v_mul_f32 v31, 0x3fb8aa3b, v31
  v_mul_f32 v33, 0x3fb8aa3b, v33
  v_exp_f32 v29, v29
  v_exp_f32 v31, v31
  v_exp_f32 v33, v33
  s_nop 0
  v_cvt_pk_bf16_f32 v34, 0, v29
  v_cvt_pk_bf16_f32 v35, 0, v31
  v_cvt_pk_bf16_f32 v36, 0, v33
  v_cvt_pk_bf16_f32 v29, v29, 0
  v_cvt_pk_bf16_f32 v31, v31, 0
  v_cvt_pk_bf16_f32 v33, v33, 0
  s_branch L_vs2
L_work:
  s_cmp_eq_u32 s39, 1
  s_cbranch_scc1 L_w1
  s_cmp_eq_u32 s39, 2
  s_cbranch_scc1 L_w2
  s_cmp_eq_u32 s39, 3
  s_cbranch_scc1 L_w3
  s_cmp_lt_u32 s32, 16
  s_cbranch_scc1 L_wr
L_w0:
  s_load_dwordx16 s[16:31], s[42:43], s40 glc
  s_mov_b32 s39, 1
L_wr:
  s_setpc_b64 s[100:101]
L_w1:
  s_waitcnt lgkmcnt(0)
  s_xor_b32 s68, s17, s74
  s_xor_b32 s69, s19, s74
  s_or_b32 s68, s68, s69
  s_xor_b32 s69, s21, s74
  s_or_b32 s68, s68, s69
  s_xor_b32 s69, s23, s74
  s_or_b32 s68, s68, s69
  s_xor_b32 s69, s25, s74
  s_or_b32 s68, s68, s69
  s_xor_b32 s69, s27, s74
  s_or_b32 s68, s68, s69
  s_xor_b32 s69, s29, s74
  s_or_b32 s68, s68, s69
  s_xor_b32 s69, s31, s74
  s_or_b32 s68, s68, s69
  s_cbranch_scc1 L_w0
  v_mov_b32 v8, s16
  v_mov_b32 v9, s18
  v_mov_b32 v10, s20
  v_mov_b32 v11, s22
  v_mov_b32 v12, s24
  v_mov_b32 v13, s26
  v_mov_b32 v14, s28
  v_mov_b32 v15, s30
  v_lshlrev_b32 v3, 5, s9
  s_mov_b64 exec, 1
  ds_write_b128 v3, v[8:11] offset:6400
  ds_write_b128 v3, v[12:15] offset:6416
  s_mov_b64 exec, -1
  s_mov_b32 s39, 2
L_w2:
  s_add_u32 s68, s41, 16
  s_cmp_lt_u32 s32, s68
  s_cbranch_scc1 L_wr
  ds_read_b128 v[4:7], v38 offset:6400
  s_waitcnt lgkmcnt(0)
  v_max3_u32 v8, v4, v5, v6
  v_max_u32 v8, v8, v7
  v_cmp_eq_u32 vcc, -1, v8
  s_cmp_lg_u64 vcc, 0
  s_cbranch_scc1 L_wr
  v_dot2_f32_bf16 v8, v40, v4, 0
  v_dot2_f32_bf16 v9, v44, v4, 0
  v_dot2_f32_bf16 v10, v48, v4, 0
  v_dot2_f32_bf16 v11, v52, v4, 0
  v_dot2_f32_bf16 v12, v56, v4, 0
  v_dot2_f32_bf16 v13, v60, v4, 0
  v_dot2_f32_bf16 v14, v64, v4, 0
  v_dot2_f32_bf16 v15, v68, v4, 0
  v_dot2_f32_bf16 v8, v41, v5, v8
  v_dot2_f32_bf16 v9, v45, v5, v9
  v_dot2_f32_bf16 v10, v49, v5, v10
  v_dot2_f32_bf16 v11, v53, v5, v11
  v_dot2_f32_bf16 v12, v57, v5, v12
  v_dot2_f32_bf16 v13, v61, v5, v13
  v_dot2_f32_bf16 v14, v65, v5, v14
  v_dot2_f32_bf16 v15, v69, v5, v15
  v_dot2_f32_bf16 v8, v42, v6, v8
  v_dot2_f32_bf16 v9, v46, v6, v9
  v_dot2_f32_bf16 v10, v50, v6, v10
  v_dot2_f32_bf16 v11, v54, v6, v11
  v_dot2_f32_bf16 v12, v58, v6, v12
  v_dot2_f32_bf16 v13, v62, v6, v13
  v_dot2_f32_bf16 v14, v66, v6, v14
  v_dot2_f32_bf16 v15, v70, v6, v15
  v_dot2_f32_bf16 v8, v43, v7, v8
  v_dot2_f32_bf16 v9, v47, v7, v9
  v_dot2_f32_bf16 v10, v51, v7, v10
  v_dot2_f32_bf16 v11, v55, v7, v11
  v_dot2_f32_bf16 v12, v59, v7, v12
  v_dot2_f32_bf16 v13, v63, v7, v13
  v_dot2_f32_bf16 v14, v67, v7, v14
  v_dot2_f32_bf16 v15, v71, v7, v15
  v_add_f32_dpp v8, v8, v8 row_ror:8 row_mask:0xf bank_mask:0x3
  v_add_f32_dpp v8, v9, v9 row_ror:8 row_mask:0xf bank_mask:0xc
  v_add_f32_dpp v10, v10, v10 row_ror:8 row_mask:0xf bank_mask:0x3
  v_add_f32_dpp v10, v11, v11 row_ror:8 row_mask:0xf bank_mask:0xc
  v_add_f32_dpp v12, v12, v12 row_ror:8 row_mask:0xf bank_mask:0x3
  v_add_f32_dpp v12, v13, v13 row_ror:8 row_mask:0xf bank_mask:0xc
  v_add_f32_dpp v14, v14, v14 row_ror:8 row_mask:0xf bank_mask:0x3
  v_add_f32_dpp v14, v15, v15 row_ror:8 row_mask:0xf bank_mask:0xc
  v_add_f32_dpp v16, v8, v8 row_shl:4 row_mask:0xf bank_mask:0x5
  v_add_f32_dpp v16, v10, v10 row_shr:4 row_mask:0xf bank_mask:0xa
  v_add_f32_dpp v17, v12, v12 row_shl:4 row_mask:0xf bank_mask:0x5
  v_add_f32_dpp v17, v14, v14 row_shr:4 row_mask:0xf bank_mask:0xa
  v_dot2_f32_bf16 v8, v72, v4, 0
  v_dot2_f32_bf16 v9, v76, v4, 0
  v_dot2_f32_bf16 v10, v80, v4, 0
  v_dot2_f32_bf16 v11, v84, v4, 0
  v_dot2_f32_bf16 v12, v88, v4, 0
  v_dot2_f32_bf16 v13, v92, v4, 0
  v_dot2_f32_bf16 v14, v96, v4, 0
  v_dot2_f32_bf16 v15, v100, v4, 0
  v_dot2_f32_bf16 v8, v73, v5, v8
  v_dot2_f32_bf16 v9, v77, v5, v9
  v_dot2_f32_bf16 v10, v81, v5, v10
  v_dot2_f32_bf16 v11, v85, v5, v11
  v_dot2_f32_bf16 v12, v89, v5, v12
  v_dot2_f32_bf16 v13, v93, v5, v13
  v_dot2_f32_bf16 v14, v97, v5, v14
  v_dot2_f32_bf16 v15, v101, v5, v15
  v_dot2_f32_bf16 v8, v74, v6, v8
  v_dot2_f32_bf16 v9, v78, v6, v9
  v_dot2_f32_bf16 v10, v82, v6, v10
  v_dot2_f32_bf16 v11, v86, v6, v11
  v_dot2_f32_bf16 v12, v90, v6, v12
  v_dot2_f32_bf16 v13, v94, v6, v13
  v_dot2_f32_bf16 v14, v98, v6, v14
  v_dot2_f32_bf16 v15, v102, v6, v15
  v_dot2_f32_bf16 v8, v75, v7, v8
  v_dot2_f32_bf16 v9, v79, v7, v9
  v_dot2_f32_bf16 v10, v83, v7, v10
  v_dot2_f32_bf16 v11, v87, v7, v11
  v_dot2_f32_bf16 v12, v91, v7, v12
  v_dot2_f32_bf16 v13, v95, v7, v13
  v_dot2_f32_bf16 v14, v99, v7, v14
  v_dot2_f32_bf16 v15, v103, v7, v15
  v_add_f32_dpp v8, v8, v8 row_ror:8 row_mask:0xf bank_mask:0x3
  v_add_f32_dpp v8, v9, v9 row_ror:8 row_mask:0xf bank_mask:0xc
  v_add_f32_dpp v10, v10, v10 row_ror:8 row_mask:0xf bank_mask:0x3
  v_add_f32_dpp v10, v11, v11 row_ror:8 row_mask:0xf bank_mask:0xc
  v_add_f32_dpp v12, v12, v12 row_ror:8 row_mask:0xf bank_mask:0x3
  v_add_f32_dpp v12, v13, v13 row_ror:8 row_mask:0xf bank_mask:0xc
  v_add_f32_dpp v14, v14, v14 row_ror:8 row_mask:0xf bank_mask:0x3
  v_add_f32_dpp v14, v15, v15 row_ror:8 row_mask:0xf bank_mask:0xc
  v_add_f32_dpp v18, v8, v8 row_shl:4 row_mask:0xf bank_mask:0x5
  v_add_f32_dpp v18, v10, v10 row_shr:4 row_mask:0xf bank_mask:0xa
  v_add_f32_dpp v19, v12, v12 row_shl:4 row_mask:0xf bank_mask:0x5
  v_add_f32_dpp v19, v14, v14 row_shr:4 row_mask:0xf bank_mask:0xa
  v_mov_b32 v3, 0
  v_mov_b32 v20, 64
  v_add_f32_dpp v16, v16, v16 quad_perm:[2,3,0,1] row_mask:0xf bank_mask:0xf
  v_add_f32_dpp v17, v17, v17 quad_perm:[2,3,0,1] row_mask:0xf bank_mask:0xf
  v_add_f32_dpp v18, v18, v18 quad_perm:[2,3,0,1] row_mask:0xf bank_mask:0xf
  v_add_f32_dpp v19, v19, v19 quad_perm:[2,3,0,1] row_mask:0xf bank_mask:0xf
  v_cndmask_b32 v8, v16, v17, s[52:53]
  v_cndmask_b32 v9, v18, v19, s[52:53]
  s_nop 0
  v_lshlrev_b32 v21, 3, s9
  v_add_f32_dpp v8, v8, v8 quad_perm:[1,0,3,2] row_mask:0xf bank_mask:0xf
  v_add_f32_dpp v9, v9, v9 quad_perm:[1,0,3,2] row_mask:0xf bank_mask:0xf
  v_cndmask_b32 v25, v8, v9, s[54:55]
  v_cvt_pk_bf16_f32 v25, 0, v25
  v_mul_f32 v25, 0x3db504f3, v25
  v_cvt_pk_bf16_f32 v25, 0, v25
  v_mov_b32 v37, v25
  s_nop 1
  v_max_f32_dpp v37, v37, v37 row_ror:8 row_mask:0xf bank_mask:0xf
  s_nop 1
  v_max_f32_dpp v37, v37, v37 row_ror:4 row_mask:0xf bank_mask:0xf
  s_nop 1
  v_max_f32_dpp v37, v37, v37 row_ror:2 row_mask:0xf bank_mask:0xf
  s_nop 1
  v_max_f32_dpp v37, v37, v37 row_ror:1 row_mask:0xf bank_mask:0xf
  v_mov_b32 v8, v37
  s_nop 1
  v_permlane16_swap_b32 v8, v37
  v_max_f32 v37, v37, v8
  v_mov_b32 v8, v37
  s_nop 1
  v_permlane32_swap_b32 v8, v37
  v_max_f32 v37, v37, v8
  s_mov_b64 exec, 1
  ds_max_f32 v3, v37 offset:6684
  ds_add_u32 v3, v20 offset:6680
  s_mov_b64 exec, -1
  s_mov_b32 s39, 3
  s_mov_b32 s19, 0
  s_setpc_b64 s[100:101]
L_w3:
  v_mov_b32 v3, 0
  ds_read_b64 v[18:19], v3 offset:6680
  s_waitcnt lgkmcnt(0)
  v_cmp_gt_u32 vcc, 0x10280, v18
  s_cmp_lg_u64 vcc, 0
  s_cbranch_scc1 L_wr
  ds_read_b96 v[16:18], v3 offset:6736
  s_waitcnt lgkmcnt(0)
  v_max_f32 v2, v19, v18
  v_med3_f32 v21, v19, v16, v17
  v_add_f32 v21, 0xc1c00000, v21
  v_cmp_nlt_f32 vcc, v25, v21
  v_readfirstlane_b32 s22, v21
  s_mov_b32 s20, 0
  s_bcnt1_i32_b64 s68, vcc
  s_cmp_gt_u32 s68, 32
  s_cselect_b32 s21, 1, 0
  s_cbranch_scc1 L_w4
  s_mov_b32 s38, 160
  v_cmp_nlt_f32 vcc, v25, v21
  s_lshl_b32 s68, s38, 3
  s_add_u32 s68, s68, s56
  s_andn2_b64 s[70:71], vcc, s[64:65]
  v_mbcnt_lo_u32_b32 v3, s70, 0
  v_mbcnt_hi_u32_b32 v3, s71, v3
  s_bcnt1_i32_b64 s69, s[70:71]
  v_lshl_add_u32 v3, v3, 3, s68
  s_mov_b64 exec, s[70:71]
  ds_write_b64 v3, v[24:25]
  s_mov_b64 exec, -1
  s_or_b64 s[64:65], s[64:65], s[70:71]
  s_add_u32 s38, s38, s69
  s_mov_b32 s20, s69
  s_mov_b32 s38, 0
L_w4:
  v_add_f32 v21, 0xc2ac0000, v2
  v_cmp_nlt_f32 vcc, v25, v21
  s_lshl_b32 s68, s38, 3
  s_add_u32 s68, s68, s56
  s_andn2_b64 s[70:71], vcc, s[64:65]
  v_mbcnt_lo_u32_b32 v3, s70, 0
  v_mbcnt_hi_u32_b32 v3, s71, v3
  s_bcnt1_i32_b64 s69, s[70:71]
  v_lshl_add_u32 v3, v3, 3, s68
  s_mov_b64 exec, s[70:71]
  ds_write_b64 v3, v[24:25]
  s_mov_b64 exec, -1
  s_or_b64 s[64:65], s[64:65], s[70:71]
  s_add_u32 s38, s38, s69
  s_add_u32 s68, s38, 4
  s_lshr_b32 s68, s68, 1
  s_sub_u32 s69, s68, s59
  s_mov_b32 s59, s68
  v_mov_b32 v3, s69
  s_mov_b64 exec, 1
  ds_add_u32 v1, v3 offset:6696
  s_mov_b64 exec, -1
  s_mov_b32 s39, 4
  ds_read_b64 v[28:29], v39 offset:0
  s_waitcnt lgkmcnt(0)
  s_setpc_b64 s[100:101]
L_helper:
  s_bfe_u32 s61, s2, 0x30003
  s_lshl_b32 s48, s8, 3
  s_add_u32 s61, s61, s48
  s_cmp_lt_u32 s2, 144
  s_cselect_b32 s48, 3, 4
  s_lshr_b32 s48, s2, s48
  s_and_b32 s48, s48, 1
  s_lshl_b32 s49, s48, 1
  s_add_u32 s50, s2, 3
  s_sub_u32 s50, s50, s49
  s_and_b32 s50, s50, 7
  s_lshl_b32 s48, s48, 3
  s_or_b32 s50, s50, s48
  s_cmp_lt_u32 s2, 128
  s_cselect_b32 s61, s61, s50
  v_mov_b32 v4, -1
  v_mov_b32 v5, -1
  v_mov_b32 v6, -1
  v_mov_b32 v7, -1
  v_mov_b32 v8, 0xff800000
  v_mov_b32 v9, 0
  v_mov_b32 v10, 0xff800000
  v_lshlrev_b32 v2, 3, v1
  ds_write_b64 v2, v[8:9] offset:6912
  v_lshlrev_b32 v2, 2, v1
  ds_write_b32 v2, v4 offset:6400
  v_mov_b32 v38, 0
  v_mov_b32 v39, 0xff800000
  ds_write_b128 v38, v[4:7] offset:6656
  ds_write_b32 v38, v38 offset:6720
  v_mov_b32 v8, 128
  v_mov_b32 v9, v39
  v_mov_b32 v10, v8
  v_mov_b32 v11, v39
  ds_write_b128 v38, v[8:11] offset:6672
  v_mov_b32 v8, 1248
  v_mov_b32 v9, 0
  v_mov_b32 v10, 1024
  v_mov_b32 v11, -153
  ds_write_b128 v38, v[8:11] offset:6688
  v_mov_b32 v8, 0
  v_mov_b32 v9, 0
  v_mov_b32 v10, 0
  v_mov_b32 v11, 0
  v_lshlrev_b32 v2, 3, v0
  ds_write_b64 v2, v[8:9] offset:11008
  ds_write_b64 v2, v[8:9] offset:16128
  v_mov_b32 v8, 2
  v_mov_b32 v9, 2
  ds_write_b128 v38, v[8:11] offset:6704
  s_mov_b32 s77, 4
  s_getreg_b32 s76, hwreg(HW_REG_XCC_ID, 0, 4)
  v_lshrrev_b32 v12, 3, v0
  v_lshlrev_b32 v12, 5, v12
  v_bfe_u32 v3, v1, 2, 1
  v_lshl_add_u32 v12, v3, 10, v12
  v_and_b32 v8, 3, v1
  v_lshl_add_u32 v13, v8, 3, v12
  v_and_b32 v12, 0xffffffdf, v12
  v_lshl_add_u32 v12, v8, 4, v12
  v_bfe_u32 v8, v1, 3, 1
  v_lshl_add_u32 v12, v8, 3, v12
  v_lshl_add_u32 v12, v3, 5, v12
  s_lshl_b32 s48, s61, 7
  s_lshl_b32 s49, s5, 7
  s_add_u32 s49, s49, 64
  v_add_u32 v8, s49, v1
  s_waitcnt lgkmcnt(0)
  s_load_dword s74, s[42:43], 0
  s_cmp_eq_u32 s13, 2
  s_cbranch_scc1 L_r_q
  s_cmp_eq_u32 s13, 1
  s_cbranch_scc1 L_r_moda
  s_load_dwordx2 s[14:15], s[56:57], s3
  s_barrier
  s_waitcnt lgkmcnt(0)
  s_and_b32 s13, s14, 7
  s_bfe_u32 s61, s14, 0x80008
  s_cmp_eq_u32 s13, 1
  s_cbranch_scc1 L_r_wo
  s_cmp_eq_u32 s13, 4
  s_cbranch_scc1 L_r_modb
  s_cmp_eq_u32 s13, 2
  s_cbranch_scc1 L_r_f1
  s_cmp_eq_u32 s13, 3
  s_cbranch_scc1 L_r_f2
  s_branch L_r_none
L_r_moda:
  s_lshl_b32 s48, s61, 7
  s_lshl_b32 s58, s61, 9
  s_add_u32 s58, s58, 4096
  s_mov_b32 s44, s36
  s_mov_b32 s45, s37
  s_mov_b32 s46, 3145728
  s_mov_b32 s47, 0x20000
  global_load_dwordx2 v[14:15], v13, s[34:35]
  v_lshrrev_b32 v2, 3, v1
  v_and_b32 v3, 6, v2
  v_xor_b32 v3, v3, v1
  v_mul_u32_u24 v2, 6144, v2
  v_and_b32 v3, 7, v3
  v_lshl_add_u32 v2, v3, 4, v2
  s_mul_i32 s49, s5, 786432
  s_lshl_b32 s50, s5, 14
  s_add_u32 s49, s49, s48
  s_add_u32 s50, s50, 18432
  s_add_u32 s51, s50, 16384
L_dma_6:
  s_mov_b32 m0, s50
  s_add_u32 s50, s50, 1024
  buffer_load_dwordx4 v2, s[44:47], s49 offen nt lds
  s_add_u32 s49, s49, 49152
  s_cmp_lt_u32 s50, s51
  s_cbranch_scc1 L_dma_6
L_dmae_7:
  s_barrier
  s_waitcnt lgkmcnt(0)
  s_mul_i32 s74, s74, 0x9e3779b1
  s_add_u32 s74, s74, 0x7f4a7c15
  s_add_u32 s76, s76, s74
  s_waitcnt vmcnt(16)
  v_lshlrev_b32 v16, 16, v14
  v_and_b32 v17, s73, v14
  v_lshlrev_b32 v18, 16, v15
  v_and_b32 v19, s73, v15
  v_mul_f32 v20, 0xbfb8aa3b, v16
  v_mul_f32 v21, 0xbfb8aa3b, v17
  v_mul_f32 v22, 0xbfb8aa3b, v18
  v_mul_f32 v23, 0xbfb8aa3b, v19
  v_exp_f32 v20, v20
  v_exp_f32 v21, v21
  v_exp_f32 v22, v22
  v_exp_f32 v23, v23
  s_nop 0
  v_add_f32 v20, 1.0, v20
  v_add_f32 v21, 1.0, v21
  v_add_f32 v22, 1.0, v22
  v_add_f32 v23, 1.0, v23
  v_rcp_f32 v20, v20
  v_rcp_f32 v21, v21
  v_rcp_f32 v22, v22
  v_rcp_f32 v23, v23
  s_nop 0
  v_mul_f32 v16, v16, v20
  v_mul_f32 v17, v17, v21
  v_mul_f32 v18, v18, v22
  v_mul_f32 v19, v19, v23
  v_cvt_pk_bf16_f32 v14, v16, v17
  v_cvt_pk_bf16_f32 v15, v18, v19
  ds_write_b64 v12, v[14:15] offset:0
  v_and_b32 v13, 1, v1
  v_lshlrev_b32 v13, 6, v13
  v_lshrrev_b32 v3, 4, v1
  v_lshl_add_u32 v13, v3, 4, v13
  s_lshl_b32 s49, s5, 7
  s_add_u32 s49, s49, s58
  v_add_u32 v13, s49, v13
  v_bfe_u32 v3, v1, 1, 3
  v_lshl_add_u32 v13, v3, 13, v13
  v_add_u32 v13, 913408, v13
  v_and_b32 v14, 1, v1
  v_mul_u32_u24 v14, 1056, v14
  v_lshrrev_b32 v3, 4, v1
  v_lshl_add_u32 v14, v3, 4, v14
  v_lshrrev_b32 v2, 2, v1
  v_bfe_u32 v3, v1, 1, 1
  s_lshl_b32 s49, s5, 1
  v_or_b32 v3, s49, v3
  v_and_b32 v10, 6, v2
  v_xor_b32 v3, v3, v10
  v_lshlrev_b32 v2, 7, v2
  v_lshl_add_u32 v2, v3, 4, v2
  v_and_b32 v3, 1, v1
  v_lshl_add_u32 v2, v3, 3, v2
  v_add_u32 v2, 18432, v2
  s_waitcnt vmcnt(0) lgkmcnt(0)
  v_mov_b32 v9, 1
  s_mov_b64 exec, 1
  ds_add_u32 v38, v9 offset:6720
  s_mov_b64 exec, -1
  s_mov_b32 s70, 0
L_sn_8:
  ds_read_b32 v9, v38 offset:6720
  s_waitcnt lgkmcnt(0)
  v_cmp_gt_u32 vcc, 0x4, v9
  s_cmp_eq_u64 vcc, 0
  s_cbranch_scc1 L_snd_9
  s_add_u32 s70, s70, 1
  s_cmp_lt_u32 s70, 2097152
  s_cbranch_scc1 L_sn_8
L_snd_9:
  ds_read_b64_tr_b16 v[40:41], v2 offset:0
  ds_read_b64_tr_b16 v[42:43], v2 offset:2048
  ds_read_b128 v[104:107], v14 offset:0
  ds_read_b64_tr_b16 v[44:45], v2 offset:4096
  ds_read_b64_tr_b16 v[46:47], v2 offset:6144
  ds_read_b128 v[108:111], v14 offset:64
  ds_read_b64_tr_b16 v[48:49], v2 offset:8192
  ds_read_b64_tr_b16 v[50:51], v2 offset:10240
  ds_read_b128 v[112:115], v14 offset:128
  ds_read_b64_tr_b16 v[52:53], v2 offset:12288
  ds_read_b64_tr_b16 v[54:55], v2 offset:14336
  ds_read_b128 v[116:119], v14 offset:192
  ds_read_b64_tr_b16 v[56:57], v2 offset:16384
  ds_read_b64_tr_b16 v[58:59], v2 offset:18432
  ds_read_b128 v[120:123], v14 offset:256
  s_waitcnt lgkmcnt(12)
  v_mfma_f32_16x16x32_bf16 v[8:11], v[40:43], v[104:107], 0
  ds_read_b64_tr_b16 v[60:61], v2 offset:20480
  ds_read_b64_tr_b16 v[62:63], v2 offset:22528
  ds_read_b128 v[124:127], v14 offset:320
  s_waitcnt lgkmcnt(12)
  v_mfma_f32_16x16x32_bf16 v[8:11], v[44:47], v[108:111], v[8:11]
  ds_read_b64_tr_b16 v[64:65], v2 offset:24576
  ds_read_b64_tr_b16 v[66:67], v2 offset:26624
  ds_read_b128 v[128:131], v14 offset:384
  s_waitcnt lgkmcnt(12)
  v_mfma_f32_16x16x32_bf16 v[8:11], v[48:51], v[112:115], v[8:11]
  ds_read_b64_tr_b16 v[68:69], v2 offset:28672
  ds_read_b64_tr_b16 v[70:71], v2 offset:30720
  ds_read_b128 v[132:135], v14 offset:448
  s_waitcnt lgkmcnt(12)
  v_mfma_f32_16x16x32_bf16 v[8:11], v[52:55], v[116:119], v[8:11]
  ds_read_b64_tr_b16 v[72:73], v2 offset:32768
  ds_read_b64_tr_b16 v[74:75], v2 offset:34816
  ds_read_b128 v[136:139], v14 offset:512
  s_waitcnt lgkmcnt(12)
  v_mfma_f32_16x16x32_bf16 v[8:11], v[56:59], v[120:123], v[8:11]
  ds_read_b64_tr_b16 v[76:77], v2 offset:36864
  ds_read_b64_tr_b16 v[78:79], v2 offset:38912
  ds_read_b128 v[140:143], v14 offset:576
  s_waitcnt lgkmcnt(12)
  v_mfma_f32_16x16x32_bf16 v[8:11], v[60:63], v[124:127], v[8:11]
  ds_read_b64_tr_b16 v[80:81], v2 offset:40960
  ds_read_b64_tr_b16 v[82:83], v2 offset:43008
  ds_read_b128 v[144:147], v14 offset:640
  s_waitcnt lgkmcnt(12)
  v_mfma_f32_16x16x32_bf16 v[8:11], v[64:67], v[128:131], v[8:11]
  ds_read_b64_tr_b16 v[84:85], v2 offset:45056
  ds_read_b64_tr_b16 v[86:87], v2 offset:47104
  ds_read_b128 v[148:151], v14 offset:704
  s_waitcnt lgkmcnt(12)
  v_mfma_f32_16x16x32_bf16 v[8:11], v[68:71], v[132:135], v[8:11]
  ds_read_b64_tr_b16 v[88:89], v2 offset:49152
  ds_read_b64_tr_b16 v[90:91], v2 offset:51200
  ds_read_b128 v[152:155], v14 offset:768
  s_waitcnt lgkmcnt(12)
  v_mfma_f32_16x16x32_bf16 v[8:11], v[72:75], v[136:139], v[8:11]
  ds_read_b64_tr_b16 v[92:93], v2 offset:53248
  ds_read_b64_tr_b16 v[94:95], v2 offset:55296
  ds_read_b128 v[156:159], v14 offset:832
  s_waitcnt lgkmcnt(12)
  v_mfma_f32_16x16x32_bf16 v[8:11], v[76:79], v[140:143], v[8:11]
  ds_read_b64_tr_b16 v[96:97], v2 offset:57344
  ds_read_b64_tr_b16 v[98:99], v2 offset:59392
  ds_read_b128 v[160:163], v14 offset:896
  s_waitcnt lgkmcnt(12)
  v_mfma_f32_16x16x32_bf16 v[8:11], v[80:83], v[144:147], v[8:11]
  ds_read_b64_tr_b16 v[100:101], v2 offset:61440
  ds_read_b64_tr_b16 v[102:103], v2 offset:63488
  ds_read_b128 v[164:167], v14 offset:960
  s_waitcnt lgkmcnt(12)
  v_mfma_f32_16x16x32_bf16 v[8:11], v[84:87], v[148:151], v[8:11]
  s_waitcnt lgkmcnt(9)
  v_mfma_f32_16x16x32_bf16 v[8:11], v[88:91], v[152:155], v[8:11]
  s_waitcnt lgkmcnt(6)
  v_mfma_f32_16x16x32_bf16 v[8:11], v[92:95], v[156:159], v[8:11]
  s_waitcnt lgkmcnt(3)
  v_mfma_f32_16x16x32_bf16 v[8:11], v[96:99], v[160:163], v[8:11]
  s_waitcnt lgkmcnt(0)
  v_mfma_f32_16x16x32_bf16 v[8:11], v[100:103], v[164:167], v[8:11]
  s_nop 7
  v_cvt_pk_bf16_f32 v8, v8, v9
  v_cvt_pk_bf16_f32 v10, v10, v11
  v_mov_b32 v9, s74
  v_mov_b32 v11, s74
  s_mov_b32 exec_lo, 0xffffffff
  s_mov_b32 exec_hi, exec_lo
  global_store_dwordx4 v13, v[8:11], s[42:43] sc1
  s_mov_b64 exec, -1
  ds_write_b32 v38, v38 offset:6660
  s_mov_b32 s60, 0
  s_branch L_svc
L_r_q:
  s_lshl_b32 s58, s61, 8
  s_add_u32 s58, s58, 32768
  global_load_dwordx2 v[14:15], v13, s[16:17]
  s_mov_b32 s44, s22
  s_mov_b32 s45, s23
  s_mov_b32 s46, 4194304
  s_mov_b32 s47, 0x20000
  v_lshrrev_b32 v2, 3, v1
  v_and_b32 v3, 6, v2
  v_xor_b32 v3, v3, v1
  v_mul_u32_u24 v2, 8192, v2
  v_and_b32 v3, 7, v3
  v_lshl_add_u32 v2, v3, 4, v2
  s_mul_i32 s49, s5, 1048576
  s_lshl_b32 s50, s5, 14
  s_add_u32 s49, s49, s48
  s_add_u32 s50, s50, 18432
  s_add_u32 s51, s50, 16384
L_dma_10:
  s_mov_b32 m0, s50
  s_add_u32 s50, s50, 1024
  buffer_load_dwordx4 v2, s[44:47], s49 offen nt lds
  s_add_u32 s49, s49, 65536
  s_cmp_lt_u32 s50, s51
  s_cbranch_scc1 L_dma_10
L_dmae_11:
  s_barrier
  s_waitcnt lgkmcnt(0)
  s_mul_i32 s74, s74, 0x9e3779b1
  s_add_u32 s74, s74, 0x7f4a7c15
  s_add_u32 s76, s76, s74
  s_waitcnt vmcnt(16)
  v_bfe_u32 v6, v1, 2, 1
  v_lshlrev_b32 v6, 5, v6
  v_add_u32 v6, 7424, v6
  s_lshl_b32 s49, s5, 3
  v_add_u32 v5, s49, v6
  v_lshlrev_b32 v20, 16, v14
  v_and_b32 v21, s73, v14
  v_lshlrev_b32 v22, 16, v15
  v_and_b32 v23, s73, v15
  v_add_f32 v8, v20, v21
  v_mul_f32 v9, v20, v20
  v_add_f32 v10, v22, v23
  v_mul_f32 v11, v22, v22
  v_fmac_f32 v9, v21, v21
  v_fmac_f32 v11, v23, v23
  v_add_f32 v8, v8, v10
  v_add_f32 v9, v9, v11
  s_nop 0
  v_add_f32_dpp v8, v8, v8 quad_perm:[1,0,3,2] row_mask:0xf bank_mask:0xf
  v_add_f32_dpp v9, v9, v9 quad_perm:[1,0,3,2] row_mask:0xf bank_mask:0xf
  s_nop 0
  v_add_f32_dpp v8, v8, v8 quad_perm:[2,3,0,1] row_mask:0xf bank_mask:0xf
  v_add_f32_dpp v9, v9, v9 quad_perm:[2,3,0,1] row_mask:0xf bank_mask:0xf
  s_nop 0
  v_add_f32_dpp v8, v8, v8 row_ror:8 row_mask:0xf bank_mask:0xf
  v_add_f32_dpp v9, v9, v9 row_ror:8 row_mask:0xf bank_mask:0xf
  s_nop 0
  v_mov_b32 v10, v8
  v_mov_b32 v11, v9
  s_nop 0
  v_permlane16_swap_b32 v10, v8
  v_permlane16_swap_b32 v11, v9
  v_add_f32 v8, v8, v10
  v_add_f32 v9, v9, v11
  v_mov_b32 v10, v8
  v_mov_b32 v11, v9
  s_nop 0
  v_permlane32_swap_b32 v10, v8
  v_permlane32_swap_b32 v11, v9
  v_add_f32 v8, v8, v10
  v_add_f32 v9, v9, v11
  ds_write_b64 v5, v[8:9]
  s_waitcnt vmcnt(0) lgkmcnt(0)
  v_mov_b32 v9, 1
  s_mov_b64 exec, 1
  ds_add_u32 v38, v9 offset:6720
  s_mov_b64 exec, -1
  s_mov_b32 s70, 0
L_sn_12:
  ds_read_b32 v9, v38 offset:6720
  s_waitcnt lgkmcnt(0)
  v_cmp_gt_u32 vcc, 0x4, v9
  s_cmp_eq_u64 vcc, 0
  s_cbranch_scc1 L_snd_13
  s_sleep 1
  s_add_u32 s70, s70, 1
  s_cmp_lt_u32 s70, 2097152
  s_cbranch_scc1 L_sn_12
L_snd_13:
  ds_read_b128 v[24:27], v6
  ds_read_b128 v[28:31], v6 offset:16
  s_waitcnt lgkmcnt(0)
  v_pk_add_f32 v[24:25], v[24:25], v[26:27]
  v_pk_add_f32 v[28:29], v[28:29], v[30:31]
  v_pk_add_f32 v[24:25], v[24:25], v[28:29]
  v_mul_f32 v8, 0x3b000000, v24
  v_mul_f32 v9, 0x3b000000, v25
  v_fma_f32 v9, -v8, v8, v9
  v_cvt_pk_bf16_f32 v8, 0, v8
  v_max_f32 v9, 0, v9
  v_cvt_pk_bf16_f32 v9, 0, v9
  v_sub_f32 v20, v20, v8
  v_sub_f32 v21, v21, v8
  v_add_f32 v9, 0x3727c5ac, v9
  v_sub_f32 v22, v22, v8
  v_sub_f32 v23, v23, v8
  v_cvt_pk_bf16_f32 v9, 0, v9
  v_cvt_pk_bf16_f32 v20, 0, v20
  v_sqrt_f32 v9, v9
  v_cvt_pk_bf16_f32 v21, 0, v21
  v_cvt_pk_bf16_f32 v9, 0, v9
  v_cvt_pk_bf16_f32 v22, 0, v22
  v_rcp_f32 v9, v9
  v_cvt_pk_bf16_f32 v23, 0, v23
  v_mul_f32 v20, v20, v9
  v_mul_f32 v21, v21, v9
  v_mul_f32 v22, v22, v9
  v_mul_f32 v23, v23, v9
  v_cvt_pk_bf16_f32 v20, 0, v20
  v_cvt_pk_bf16_f32 v21, 0, v21
  v_cvt_pk_bf16_f32 v22, 0, v22
  v_cvt_pk_bf16_f32 v23, 0, v23
  v_lshlrev_b32 v15, 4, v0
  s_and_b32 s49, s2, 7
  s_lshl_b32 s49, s49, 13
  s_add_u32 s49, s49, 917504
  v_add_u32 v15, s49, v15
  v_add_u32 v36, 0x1000, v15
  s_mov_b64 s[64:65], -1
  s_mov_b64 s[66:67], -1
  s_mov_b64 exec, s[64:65]
  global_load_dwordx4 v[16:19], v15, s[42:43] sc1
  s_mov_b64 exec, s[66:67]
  global_load_dwordx4 v[32:35], v36, s[42:43] sc1
  s_mov_b64 exec, -1
  v_lshrrev_b32 v2, 2, v1
  v_bfe_u32 v3, v1, 1, 1
  s_lshl_b32 s49, s5, 1
  v_or_b32 v3, s49, v3
  v_and_b32 v10, 6, v2
  v_xor_b32 v3, v3, v10
  v_lshlrev_b32 v2, 7, v2
  v_lshl_add_u32 v2, v3, 4, v2
  v_and_b32 v3, 1, v1
  v_lshl_add_u32 v2, v3, 3, v2
  v_add_u32 v2, 18432, v2
  ds_read_b64_tr_b16 v[40:41], v2 offset:0
  ds_read_b64_tr_b16 v[42:43], v2 offset:2048
  ds_read_b64_tr_b16 v[44:45], v2 offset:4096
  ds_read_b64_tr_b16 v[46:47], v2 offset:6144
  ds_read_b64_tr_b16 v[48:49], v2 offset:8192
  ds_read_b64_tr_b16 v[50:51], v2 offset:10240
  ds_read_b64_tr_b16 v[52:53], v2 offset:12288
  ds_read_b64_tr_b16 v[54:55], v2 offset:14336
  ds_read_b64_tr_b16 v[56:57], v2 offset:16384
  ds_read_b64_tr_b16 v[58:59], v2 offset:18432
  ds_read_b64_tr_b16 v[60:61], v2 offset:20480
  ds_read_b64_tr_b16 v[62:63], v2 offset:22528
  s_waitcnt lgkmcnt(10)
  ds_read_b64_tr_b16 v[64:65], v2 offset:24576
  ds_read_b64_tr_b16 v[66:67], v2 offset:26624
  s_waitcnt lgkmcnt(10)
  ds_read_b64_tr_b16 v[68:69], v2 offset:28672
  ds_read_b64_tr_b16 v[70:71], v2 offset:30720
  s_waitcnt lgkmcnt(10)
  ds_read_b64_tr_b16 v[72:73], v2 offset:32768
  ds_read_b64_tr_b16 v[74:75], v2 offset:34816
  s_waitcnt lgkmcnt(10)
  ds_read_b64_tr_b16 v[76:77], v2 offset:36864
  ds_read_b64_tr_b16 v[78:79], v2 offset:38912
  s_waitcnt lgkmcnt(10)
  ds_read_b64_tr_b16 v[80:81], v2 offset:40960
  ds_read_b64_tr_b16 v[82:83], v2 offset:43008
  s_waitcnt lgkmcnt(10)
  ds_read_b64_tr_b16 v[84:85], v2 offset:45056
  ds_read_b64_tr_b16 v[86:87], v2 offset:47104
  s_waitcnt lgkmcnt(10)
  ds_read_b64_tr_b16 v[88:89], v2 offset:49152
  ds_read_b64_tr_b16 v[90:91], v2 offset:51200
  s_waitcnt lgkmcnt(10)
  ds_read_b64_tr_b16 v[92:93], v2 offset:53248
  ds_read_b64_tr_b16 v[94:95], v2 offset:55296
  s_waitcnt lgkmcnt(10)
  ds_read_b64_tr_b16 v[96:97], v2 offset:57344
  ds_read_b64_tr_b16 v[98:99], v2 offset:59392
  s_waitcnt lgkmcnt(10)
  ds_read_b64_tr_b16 v[100:101], v2 offset:61440
  ds_read_b64_tr_b16 v[102:103], v2 offset:63488
  s_waitcnt lgkmcnt(10)
  s_waitcnt lgkmcnt(0)
  v_and_b32 v13, 1, v1
  v_lshlrev_b32 v13, 14, v13
  v_lshrrev_b32 v3, 4, v1
  v_lshl_add_u32 v13, v3, 4, v13
  s_lshl_b32 s49, s5, 6
  s_add_u32 s49, s49, s58
  v_add_u32 v13, s49, v13
  v_and_b32 v14, 1, v1
  v_mul_u32_u24 v14, 1056, v14
  v_lshrrev_b32 v3, 4, v1
  v_lshl_add_u32 v14, v3, 4, v14
  s_mov_b32 s70, 0
  s_branch L_q_c
L_q_p:
  s_mov_b64 exec, s[64:65]
  global_load_dwordx4 v[16:19], v15, s[42:43] sc1
  s_mov_b64 exec, s[66:67]
  global_load_dwordx4 v[32:35], v36, s[42:43] sc1
  s_mov_b64 exec, -1
L_q_c:
  s_waitcnt vmcnt(0)
  v_cmp_ne_u32 s[64:65], s74, v17
  v_cmp_ne_u32 s[68:69], s74, v19
  s_or_b64 s[64:65], s[64:65], s[68:69]
  v_cmp_ne_u32 s[66:67], s74, v33
  v_cmp_ne_u32 s[68:69], s74, v35
  s_or_b64 s[66:67], s[66:67], s[68:69]
  s_or_b64 vcc, s[64:65], s[66:67]
  s_cmp_eq_u64 vcc, 0
  s_cbranch_scc1 L_q_ok
  s_add_u32 s70, s70, 1
  s_cmp_lt_u32 s70, 262144
  s_cbranch_scc1 L_q_p
L_q_ok:
  v_lshlrev_b32 v28, 16, v32
  v_and_b32 v29, s73, v32
  v_lshlrev_b32 v30, 16, v34
  v_and_b32 v31, s73, v34
  v_lshlrev_b32 v24, 16, v16
  v_and_b32 v25, s73, v16
  v_lshlrev_b32 v26, 16, v18
  v_and_b32 v27, s73, v18
  v_add_f32 v28, 1.0, v28
  v_add_f32 v29, 1.0, v29
  v_add_f32 v30, 1.0, v30
  v_add_f32 v31, 1.0, v31
  v_cvt_pk_bf16_f32 v28, 0, v28
  v_cvt_pk_bf16_f32 v29, 0, v29
  v_cvt_pk_bf16_f32 v30, 0, v30
  v_cvt_pk_bf16_f32 v31, 0, v31
  v_mul_f32 v20, v20, v28
  v_mul_f32 v21, v21, v29
  v_mul_f32 v22, v22, v30
  v_mul_f32 v23, v23, v31
  v_cvt_pk_bf16_f32 v20, 0, v20
  v_cvt_pk_bf16_f32 v21, 0, v21
  v_cvt_pk_bf16_f32 v22, 0, v22
  v_cvt_pk_bf16_f32 v23, 0, v23
  v_add_f32 v20, v20, v24
  v_add_f32 v21, v21, v25
  v_add_f32 v22, v22, v26
  v_add_f32 v23, v23, v27
  v_cvt_pk_bf16_f32 v16, v20, v21
  v_cvt_pk_bf16_f32 v17, v22, v23
  ds_write_b64 v12, v[16:17] offset:0
  v_mov_b32 v9, 1
  s_mov_b64 exec, 1
  ds_add_u32 v38, v9 offset:6720
  s_mov_b64 exec, -1
  s_mov_b32 s70, 0
L_sn_14:
  ds_read_b32 v9, v38 offset:6720
  s_waitcnt lgkmcnt(0)
  v_cmp_gt_u32 vcc, 0x8, v9
  s_cmp_eq_u64 vcc, 0
  s_cbranch_scc1 L_snd_15
  s_add_u32 s70, s70, 1
  s_cmp_lt_u32 s70, 2097152
  s_cbranch_scc1 L_sn_14
L_snd_15:
  ds_write_b32 v38, v38 offset:6660
  ds_read_b128 v[104:107], v14 offset:0
  ds_read_b128 v[108:111], v14 offset:64
  ds_read_b128 v[112:115], v14 offset:128
  ds_read_b128 v[116:119], v14 offset:192
  ds_read_b128 v[120:123], v14 offset:256
  ds_read_b128 v[124:127], v14 offset:320
  ds_read_b128 v[128:131], v14 offset:384
  ds_read_b128 v[132:135], v14 offset:448
  ds_read_b128 v[136:139], v14 offset:512
  ds_read_b128 v[140:143], v14 offset:576
  ds_read_b128 v[144:147], v14 offset:640
  ds_read_b128 v[148:151], v14 offset:704
  s_waitcnt lgkmcnt(11)
  v_mfma_f32_16x16x32_bf16 v[8:11], v[40:43], v[104:107], 0
  ds_read_b128 v[152:155], v14 offset:768
  s_waitcnt lgkmcnt(11)
  v_mfma_f32_16x16x32_bf16 v[8:11], v[44:47], v[108:111], v[8:11]
  ds_read_b128 v[156:159], v14 offset:832
  s_waitcnt lgkmcnt(11)
  v_mfma_f32_16x16x32_bf16 v[8:11], v[48:51], v[112:115], v[8:11]
  ds_read_b128 v[160:163], v14 offset:896
  s_waitcnt lgkmcnt(11)
  v_mfma_f32_16x16x32_bf16 v[8:11], v[52:55], v[116:119], v[8:11]
  ds_read_b128 v[164:167], v14 offset:960
  s_waitcnt lgkmcnt(11)
  v_mfma_f32_16x16x32_bf16 v[8:11], v[56:59], v[120:123], v[8:11]
  s_waitcnt lgkmcnt(10)
  v_mfma_f32_16x16x32_bf16 v[8:11], v[60:63], v[124:127], v[8:11]
  s_waitcnt lgkmcnt(9)
  v_mfma_f32_16x16x32_bf16 v[8:11], v[64:67], v[128:131], v[8:11]
  s_waitcnt lgkmcnt(8)
  v_mfma_f32_16x16x32_bf16 v[8:11], v[68:71], v[132:135], v[8:11]
  s_waitcnt lgkmcnt(7)
  v_mfma_f32_16x16x32_bf16 v[8:11], v[72:75], v[136:139], v[8:11]
  s_waitcnt lgkmcnt(6)
  v_mfma_f32_16x16x32_bf16 v[8:11], v[76:79], v[140:143], v[8:11]
  s_waitcnt lgkmcnt(5)
  v_mfma_f32_16x16x32_bf16 v[8:11], v[80:83], v[144:147], v[8:11]
  s_waitcnt lgkmcnt(4)
  v_mfma_f32_16x16x32_bf16 v[8:11], v[84:87], v[148:151], v[8:11]
  s_waitcnt lgkmcnt(3)
  v_mfma_f32_16x16x32_bf16 v[8:11], v[88:91], v[152:155], v[8:11]
  s_waitcnt lgkmcnt(2)
  v_mfma_f32_16x16x32_bf16 v[8:11], v[92:95], v[156:159], v[8:11]
  s_waitcnt lgkmcnt(1)
  v_mfma_f32_16x16x32_bf16 v[8:11], v[96:99], v[160:163], v[8:11]
  s_waitcnt lgkmcnt(0)
  v_mfma_f32_16x16x32_bf16 v[8:11], v[100:103], v[164:167], v[8:11]
  s_nop 7
  v_cvt_pk_bf16_f32 v8, v8, v9
  v_cvt_pk_bf16_f32 v10, v10, v11
  v_mov_b32 v9, s74
  v_mov_b32 v11, s74
  v_min_u32 v8, s72, v8
  v_min_u32 v10, s72, v10
  s_mov_b32 exec_lo, 0x00030003
  s_mov_b32 exec_hi, 0x00030003
  global_store_dwordx4 v13, v[8:11], s[42:43] sc1
  s_mov_b64 exec, -1
  s_mov_b32 s60, 0
  s_branch L_svc
L_r_modb:
  s_lshl_b32 s48, s61, 7
  s_lshl_b32 s58, s61, 9
  s_add_u32 s58, s58, 4096
  s_mov_b32 s44, s36
  s_mov_b32 s45, s37
  s_mov_b32 s46, 3145728
  s_mov_b32 s47, 0x20000
  global_load_dwordx2 v[14:15], v13, s[34:35]
  s_waitcnt lgkmcnt(0)
  s_mul_i32 s74, s74, 0x9e3779b1
  s_add_u32 s74, s74, 0x7f4a7c15
  s_add_u32 s76, s76, s74
  s_waitcnt vmcnt(0)
  v_lshlrev_b32 v16, 16, v14
  v_and_b32 v17, s73, v14
  v_lshlrev_b32 v18, 16, v15
  v_and_b32 v19, s73, v15
  v_mul_f32 v20, 0xbfb8aa3b, v16
  v_mul_f32 v21, 0xbfb8aa3b, v17
  v_mul_f32 v22, 0xbfb8aa3b, v18
  v_mul_f32 v23, 0xbfb8aa3b, v19
  v_exp_f32 v20, v20
  v_exp_f32 v21, v21
  v_exp_f32 v22, v22
  v_exp_f32 v23, v23
  s_nop 0
  v_add_f32 v20, 1.0, v20
  v_add_f32 v21, 1.0, v21
  v_add_f32 v22, 1.0, v22
  v_add_f32 v23, 1.0, v23
  v_rcp_f32 v20, v20
  v_rcp_f32 v21, v21
  v_rcp_f32 v22, v22
  v_rcp_f32 v23, v23
  s_nop 0
  v_mul_f32 v16, v16, v20
  v_mul_f32 v17, v17, v21
  v_mul_f32 v18, v18, v22
  v_mul_f32 v19, v19, v23
  v_cvt_pk_bf16_f32 v14, v16, v17
  v_cvt_pk_bf16_f32 v15, v18, v19
  ds_write_b64 v12, v[14:15] offset:0
  s_mov_b32 s60, 4
  s_sub_u32 s53, s5, 1
  s_cmp_gt_u32 s53, 1
  s_cbranch_scc1 L_sig
  v_lshrrev_b32 v2, 3, v1
  v_and_b32 v3, 6, v2
  v_xor_b32 v3, v3, v1
  v_mul_u32_u24 v2, 6144, v2
  v_and_b32 v3, 7, v3
  v_lshl_add_u32 v2, v3, 4, v2
  s_mul_i32 s49, s53, 1572864
  s_lshl_b32 s50, s53, 15
  s_add_u32 s49, s49, s48
  s_add_u32 s50, s50, 18432
  s_add_u32 s51, s50, 32768
L_dma_16:
  s_mov_b32 m0, s50
  s_add_u32 s50, s50, 1024
  buffer_load_dwordx4 v2, s[44:47], s49 offen nt lds
  s_add_u32 s49, s49, 49152
  s_waitcnt vmcnt(3)
  s_cmp_lt_u32 s50, s51
  s_cbranch_scc1 L_dma_16
L_dmae_17:
  s_branch L_sig
L_r_wo:
  s_lshl_b32 s48, s8, 19
  s_lshl_b32 s49, s61, 7
  s_add_u32 s48, s48, s49
  s_lshr_b32 s58, s8, 1
  s_mul_i32 s58, s58, 16384
  s_and_b32 s49, s8, 1
  s_lshl_b32 s49, s49, 12
  s_add_u32 s58, s58, s49
  s_lshl_b32 s49, s61, 9
  s_add_u32 s58, s58, s49
  s_add_u32 s58, s58, 262144
  s_mov_b32 s44, s24
  s_mov_b32 s45, s25
  s_mov_b32 s46, 4194304
  s_mov_b32 s47, 0x20000
  s_waitcnt lgkmcnt(0)
  s_mul_i32 s74, s74, 0x9e3779b1
  s_add_u32 s74, s74, 0x7f4a7c15
  s_add_u32 s76, s76, s74
  s_cmp_lg_u32 s5, 3
  s_cbranch_scc1 L_sig_18
  s_lshl_b32 s56, s8, 5
  s_add_u32 s56, s56, s61
  s_lshl_b32 s56, s56, 2
  v_mov_b32 v8, s56
  v_mov_b32 v9, s76
  s_mov_b64 exec, 1
  global_store_dword v8, v9, s[42:43] offset:1024 sc1
  s_mov_b64 exec, -1
L_sig_18:
  s_mov_b32 s60, 1
  s_sub_u32 s53, s5, 1
  s_cmp_gt_u32 s53, 1
  s_cbranch_scc1 L_sig
  v_lshrrev_b32 v2, 3, v1
  v_and_b32 v3, 6, v2
  v_xor_b32 v3, v3, v1
  v_mul_u32_u24 v2, 1024, v2
  v_and_b32 v3, 7, v3
  v_lshl_add_u32 v2, v3, 4, v2
  s_mul_i32 s49, s53, 262144
  s_lshl_b32 s50, s53, 15
  s_add_u32 s49, s49, s48
  s_add_u32 s50, s50, 18432
  s_add_u32 s51, s50, 32768
L_dma_19:
  s_mov_b32 m0, s50
  s_add_u32 s50, s50, 1024
  buffer_load_dwordx4 v2, s[44:47], s49 offen nt lds
  s_add_u32 s49, s49, 8192
  s_waitcnt vmcnt(3)
  s_cmp_lt_u32 s50, s51
  s_cbranch_scc1 L_dma_19
L_dmae_20:
  s_branch L_sig
L_r_f1:
  s_lshl_b32 s48, s61, 6
  s_lshl_b32 s58, s61, 7
  s_add_u32 s58, s58, 1572864
  s_waitcnt lgkmcnt(0)
  s_mul_i32 s74, s74, 0x9e3779b1
  s_add_u32 s74, s74, 0x7f4a7c15
  s_add_u32 s76, s76, s74
  s_cmp_lt_u32 s5, 2
  s_cselect_b32 s44, s28, s30
  s_cselect_b32 s45, s29, s31
  s_mov_b32 s46, 1409024
  s_mov_b32 s47, 0x20000
  s_mov_b32 s60, 2
  s_sub_u32 s53, s5, 1
  s_cmp_gt_u32 s53, 1
  s_cbranch_scc1 L_sig
  s_and_b32 s54, s61, 1
  v_lshrrev_b32 v2, 2, v1
  v_mul_u32_u24 v2, 5504, v2
  s_and_b32 s49, s5, 2
  s_or_b32 s49, s49, s54
  v_xor_b32 v3, s49, v1
  v_and_b32 v3, 3, v3
  v_lshl_add_u32 v2, v3, 4, v2
  s_mul_i32 s49, s54, 2752
  s_add_u32 s49, s49, s48
  s_lshl_b32 s50, s53, 15
  s_lshl_b32 s54, s54, 14
  s_add_u32 s50, s50, s54
  s_add_u32 s50, s50, 18432
  s_add_u32 s51, s50, 16384
L_dma_21:
  s_mov_b32 m0, s50
  s_add_u32 s50, s50, 1024
  buffer_load_dwordx4 v2, s[44:47], s49 offen  lds
  s_add_u32 s49, s49, 88064
  s_waitcnt vmcnt(3)
  s_cmp_lt_u32 s50, s51
  s_cbranch_scc1 L_dma_21
L_dmae_22:
  s_andn2_b32 s54, 1, s61
  v_lshrrev_b32 v2, 2, v1
  v_mul_u32_u24 v2, 5504, v2
  s_and_b32 s49, s5, 2
  s_or_b32 s49, s49, s54
  v_xor_b32 v3, s49, v1
  v_and_b32 v3, 3, v3
  v_lshl_add_u32 v2, v3, 4, v2
  s_mul_i32 s49, s54, 2752
  s_add_u32 s49, s49, s48
  s_lshl_b32 s50, s53, 15
  s_lshl_b32 s54, s54, 14
  s_add_u32 s50, s50, s54
  s_add_u32 s50, s50, 18432
  s_add_u32 s51, s50, 16384
L_dma_23:
  s_mov_b32 m0, s50
  s_add_u32 s50, s50, 1024
  buffer_load_dwordx4 v2, s[44:47], s49 offen nt lds
  s_add_u32 s49, s49, 88064
  s_waitcnt vmcnt(3)
  s_cmp_lt_u32 s50, s51
  s_cbranch_scc1 L_dma_23
L_dmae_24:
  s_mov_b32 s44, s32
  s_mov_b32 s45, s33
  s_mov_b32 s46, 1409024
  s_mov_b32 s47, 0x20000
  v_lshlrev_b32 v2, 4, v1
  s_lshl_b32 s49, s61, 1
  s_add_u32 s49, s49, s53
  s_lshl_b32 s49, s49, 14
  s_mul_i32 s50, s53, 16896
  s_add_u32 s50, s50, 104448
  s_add_u32 s51, s50, 16896
L_dma_25:
  s_mov_b32 m0, s50
  s_add_u32 s50, s50, 1056
  buffer_load_dwordx4 v2, s[44:47], s49 offen nt lds
  s_add_u32 s49, s49, 1024
  s_waitcnt vmcnt(5)
  s_cmp_lt_u32 s50, s51
  s_cbranch_scc1 L_dma_25
L_dmae_26:
  s_branch L_sig
L_r_f2:
  s_mov_b32 s60, 3
  s_sub_u32 s53, s5, 1
  s_cmp_gt_u32 s53, 1
  s_cbranch_scc1 L_gs_27
  s_bfe_u32 s49, s15, 0x20006
  s_cmp_ge_u32 s53, s49
  s_cbranch_scc1 L_end
  s_mul_i32 s49, s53, 5
  s_add_u32 s49, s49, 8
  s_lshr_b32 s49, s15, s49
  s_and_b32 s4, s49, 3
  s_lshl_b32 s4, s4, 18
  s_bfe_u32 s11, s49, 0x30002
  s_lshl_b32 s11, s11, 10
  s_add_u32 s9, s53, 8
  s_mov_b32 s13, -1
  s_branch L_stream
L_gs_27:
  s_cmp_lg_u32 s5, 3
  s_cbranch_scc1 L_tch_28
  s_and_b32 s49, s61, 3
  s_lshl_b32 s49, s49, 7
  v_add_u32 v8, s49, v1
  s_bfe_u32 s50, s14, 0x50003
  s_cmp_eq_u32 s50, 0
  s_cbranch_scc1 L_tchm_29
  s_lshl_b32 s50, s50, 10
  s_sub_u32 s50, s50, 640
  v_mul_u32_u24 v9, 6144, v8
  v_add_u32 v9, s50, v9
  global_load_dword v167, v9, s[36:37]
  v_add_u32 v10, 393216, v9
  global_load_dword v167, v10, s[36:37]
L_tchm_29:
  s_lshl_b32 s50, s8, 10
  s_add_u32 s50, s50, 384
  v_mul_u32_u24 v9, 8192, v8
  v_add_u32 v9, s50, v9
  global_load_dword v167, v9, s[22:23]
  v_add_u32 v10, 524288, v9
  global_load_dword v167, v10, s[22:23]
L_tch_28:
L_light:
  s_waitcnt lgkmcnt(0)
  s_mul_i32 s74, s74, 0x9e3779b1
  s_add_u32 s74, s74, 0x7f4a7c15
  s_add_u32 s76, s76, s74
  s_cmp_eq_u32 s5, 3
  s_cbranch_scc1 L_lt3
  s_bfe_u32 s49, s15, 0x20006
  s_sub_u32 s49, 0, s49
  v_mov_b32 v4, s49
  v_lshlrev_b32 v5, 6, v4
  v_mul_i32_i24 v6, -28, v4
  s_mov_b64 exec, 1
  ds_add_u32 v38, v5 offset:6680
  ds_add_u32 v38, v5 offset:6672
  ds_add_u32 v38, v4 offset:6704
  ds_add_u32 v38, v4 offset:6708
  ds_add_u32 v38, v6 offset:6688
  s_mov_b64 exec, -1
  v_mov_b32 v9, 1
  s_mov_b64 exec, 1
  ds_add_u32 v38, v9 offset:6720
  s_mov_b64 exec, -1
  s_branch L_svc
L_lt3:
  s_mov_b32 s70, 0
L_sn_30:
  ds_read_b32 v9, v38 offset:6720
  s_waitcnt lgkmcnt(0)
  v_cmp_gt_u32 vcc, 0x1, v9
  s_cmp_eq_u64 vcc, 0
  s_cbranch_scc1 L_snd_31
  s_sleep 2
  s_add_u32 s70, s70, 1
  s_cmp_lt_u32 s70, 2097152
  s_cbranch_scc1 L_sn_30
L_snd_31:
  s_branch L_svc
L_r_none:
  s_mov_b32 s60, 0
  s_sub_u32 s53, s5, 1
  s_cmp_gt_u32 s53, 1
  s_cbranch_scc1 L_gs_32
  s_bfe_u32 s49, s15, 0x20006
  s_cmp_ge_u32 s53, s49
  s_cbranch_scc1 L_end
  s_mul_i32 s49, s53, 5
  s_add_u32 s49, s49, 8
  s_lshr_b32 s49, s15, s49
  s_and_b32 s4, s49, 3
  s_lshl_b32 s4, s4, 18
  s_bfe_u32 s11, s49, 0x30002
  s_lshl_b32 s11, s11, 10
  s_add_u32 s9, s53, 8
  s_mov_b32 s13, -1
  s_branch L_stream
L_gs_32:
  s_branch L_light
L_sig:
  s_waitcnt vmcnt(0) lgkmcnt(0)
  v_mov_b32 v9, 1
  s_mov_b64 exec, 1
  ds_add_u32 v38, v9 offset:6720
  s_mov_b64 exec, -1
L_svc:
  s_cmp_eq_u32 s5, 3
  s_cbranch_scc1 L_svc3
  s_cmp_lg_u32 s5, 0
  s_cbranch_scc1 L_mid
  s_lshl_b32 s64, s6, 2
  s_add_u32 s64, s64, s7
  s_lshl_b32 s64, s64, 7
  s_add_u32 s64, s64, 65536
  v_mov_b32 v18, s64
  s_mov_b32 s70, 0
L_sn_33:
  ds_read_b64 v[8:9], v38 offset:6680
  s_waitcnt lgkmcnt(0)
  v_and_b32 v8, 0xffff, v8
  v_cmp_gt_u32 vcc, 0x280, v8
  s_cmp_eq_u64 vcc, 0
  s_cbranch_scc1 L_snd_34
  s_sleep 2
  s_add_u32 s70, s70, 1
  s_cmp_lt_u32 s70, 2097152
  s_cbranch_scc1 L_sn_33
L_snd_34:
  v_mov_b32 v8, v9
  v_mov_b32 v9, s74
  s_mov_b64 exec, 1
  global_store_dwordx2 v18, v[8:9], s[42:43] sc1
  s_mov_b64 exec, -1
  s_lshl_b32 s64, s8, 7
  s_load_dwordx8 s[20:27], s[42:43], s64 offset:1024 glc
  s_waitcnt lgkmcnt(0)
  s_xor_b32 s68, s20, s76
  s_xor_b32 s69, s21, s76
  s_or_b32 s68, s68, s69
  s_xor_b32 s69, s22, s76
  s_or_b32 s68, s68, s69
  s_xor_b32 s69, s23, s76
  s_or_b32 s68, s68, s69
  s_xor_b32 s69, s24, s76
  s_or_b32 s68, s68, s69
  s_xor_b32 s69, s25, s76
  s_or_b32 s68, s68, s69
  s_xor_b32 s69, s26, s76
  s_or_b32 s68, s68, s69
  s_xor_b32 s69, s27, s76
  s_or_b32 s68, s68, s69
  s_cselect_b32 s68, 0, 1
  v_mov_b32 v8, s68
  s_mov_b64 exec, 1
  ds_add_u32 v38, v8 offset:6712
  s_mov_b64 exec, -1
  s_branch L_mid
L_svc3:
  s_mov_b32 s70, 0
L_sn_35:
  ds_read_b32 v8, v38 offset:6680
  s_waitcnt lgkmcnt(0)
  v_cmp_gt_u32 vcc, 0x180, v8
  s_cmp_eq_u64 vcc, 0
  s_cbranch_scc1 L_snd_36
  s_sleep 4
  s_add_u32 s70, s70, 1
  s_cmp_lt_u32 s70, 2097152
  s_cbranch_scc1 L_sn_35
L_snd_36:
  s_lshl_b32 s64, s6, 9
  s_xor_b32 s54, s7, 1
  s_lshl_b32 s54, s54, 7
  s_add_u32 s54, s54, s64
  s_xor_b32 s55, s7, 2
  s_lshl_b32 s55, s55, 7
  s_add_u32 s55, s55, s64
  s_xor_b32 s56, s7, 3
  s_lshl_b32 s56, s56, 7
  s_add_u32 s56, s56, s64
  s_mov_b32 s70, 0
L_s3e:
  s_load_dwordx2 s[20:21], s[42:43], s54 offset:65536 glc
  s_load_dwordx2 s[24:25], s[42:43], s55 offset:65536 glc
  s_load_dwordx2 s[28:29], s[42:43], s56 offset:65536 glc
  s_waitcnt lgkmcnt(0)
  s_xor_b32 s68, s21, s74
  s_xor_b32 s69, s25, s74
  s_or_b32 s68, s68, s69
  s_xor_b32 s69, s29, s74
  s_or_b32 s68, s68, s69
  s_cbranch_scc0 L_s3ed
  s_sleep 2
  s_add_u32 s70, s70, 1
  s_cmp_lt_u32 s70, 262144
  s_cbranch_scc1 L_s3e
L_s3ed:
  v_mov_b32 v8, s20
  v_mov_b32 v10, s24
  v_mov_b32 v16, s28
  v_max3_f32 v18, v8, v10, v16
  v_mov_b32 v19, 0x10000
  v_med3_f32 v17, v8, v10, v16
  v_min3_f32 v16, v8, v10, v16
  s_mov_b64 exec, 1
  ds_write_b96 v38, v[16:18] offset:6736
  ds_add_u32 v38, v19 offset:6680
  s_mov_b64 exec, -1
L_mid:
  s_bfe_u32 s32, s74, 0x80000
  s_bfe_u32 s33, s74, 0x80008
  s_bfe_u32 s34, s74, 0x80010
  s_bfe_u32 s35, s74, 0x80018
  s_cmp_eq_u32 s60, 2
  s_cbranch_scc1 L_pre_f1
  s_cmp_eq_u32 s60, 3
  s_cbranch_scc1 L_pre_f2
  s_cmp_eq_u32 s60, 1
  s_cbranch_scc1 L_pre_wo
  s_cmp_lg_u32 s60, 4
  s_cbranch_scc1 L_svd
  v_and_b32 v13, 1, v1
  v_lshlrev_b32 v13, 6, v13
  v_lshrrev_b32 v3, 4, v1
  v_lshl_add_u32 v13, v3, 4, v13
  s_lshl_b32 s49, s5, 7
  s_add_u32 s49, s49, s58
  v_add_u32 v13, s49, v13
  v_and_b32 v14, 1, v1
  v_mul_u32_u24 v14, 1056, v14
  v_lshrrev_b32 v3, 4, v1
  v_lshl_add_u32 v14, v3, 4, v14
  v_lshrrev_b32 v2, 2, v1
  v_bfe_u32 v3, v1, 1, 1
  s_lshl_b32 s49, s5, 1
  v_or_b32 v3, s49, v3
  v_and_b32 v10, 6, v2
  v_xor_b32 v3, v3, v10
  v_lshlrev_b32 v2, 7, v2
  v_lshl_add_u32 v2, v3, 4, v2
  v_and_b32 v3, 1, v1
  v_lshl_add_u32 v2, v3, 3, v2
  v_add_u32 v2, 18432, v2
  s_mov_b32 s70, 0
L_sn_37:
  ds_read_b32 v9, v38 offset:6720
  s_waitcnt lgkmcnt(0)
  v_cmp_gt_u32 vcc, 0x4, v9
  s_cmp_eq_u64 vcc, 0
  s_cbranch_scc1 L_snd_38
  s_sleep 8
  s_add_u32 s70, s70, 1
  s_cmp_lt_u32 s70, 2097152
  s_cbranch_scc1 L_sn_37
L_snd_38:
  ds_read_b64_tr_b16 v[40:41], v2 offset:0
  ds_read_b64_tr_b16 v[42:43], v2 offset:2048
  ds_read_b128 v[104:107], v14 offset:0
  ds_read_b64_tr_b16 v[44:45], v2 offset:4096
  ds_read_b64_tr_b16 v[46:47], v2 offset:6144
  ds_read_b128 v[108:111], v14 offset:64
  ds_read_b64_tr_b16 v[48:49], v2 offset:8192
  ds_read_b64_tr_b16 v[50:51], v2 offset:10240
  ds_read_b128 v[112:115], v14 offset:128
  ds_read_b64_tr_b16 v[52:53], v2 offset:12288
  ds_read_b64_tr_b16 v[54:55], v2 offset:14336
  ds_read_b128 v[116:119], v14 offset:192
  ds_read_b64_tr_b16 v[56:57], v2 offset:16384
  ds_read_b64_tr_b16 v[58:59], v2 offset:18432
  ds_read_b128 v[120:123], v14 offset:256
  s_waitcnt lgkmcnt(12)
  v_mfma_f32_16x16x32_bf16 v[8:11], v[40:43], v[104:107], 0
  ds_read_b64_tr_b16 v[60:61], v2 offset:20480
  ds_read_b64_tr_b16 v[62:63], v2 offset:22528
  ds_read_b128 v[124:127], v14 offset:320
  s_waitcnt lgkmcnt(12)
  v_mfma_f32_16x16x32_bf16 v[8:11], v[44:47], v[108:111], v[8:11]
  ds_read_b64_tr_b16 v[64:65], v2 offset:24576
  ds_read_b64_tr_b16 v[66:67], v2 offset:26624
  ds_read_b128 v[128:131], v14 offset:384
  s_waitcnt lgkmcnt(12)
  v_mfma_f32_16x16x32_bf16 v[8:11], v[48:51], v[112:115], v[8:11]
  ds_read_b64_tr_b16 v[68:69], v2 offset:28672
  ds_read_b64_tr_b16 v[70:71], v2 offset:30720
  ds_read_b128 v[132:135], v14 offset:448
  s_waitcnt lgkmcnt(12)
  v_mfma_f32_16x16x32_bf16 v[8:11], v[52:55], v[116:119], v[8:11]
  ds_read_b64_tr_b16 v[72:73], v2 offset:32768
  ds_read_b64_tr_b16 v[74:75], v2 offset:34816
  ds_read_b128 v[136:139], v14 offset:512
  s_waitcnt lgkmcnt(12)
  v_mfma_f32_16x16x32_bf16 v[8:11], v[56:59], v[120:123], v[8:11]
  ds_read_b64_tr_b16 v[76:77], v2 offset:36864
  ds_read_b64_tr_b16 v[78:79], v2 offset:38912
  ds_read_b128 v[140:143], v14 offset:576
  s_waitcnt lgkmcnt(12)
  v_mfma_f32_16x16x32_bf16 v[8:11], v[60:63], v[124:127], v[8:11]
  ds_read_b64_tr_b16 v[80:81], v2 offset:40960
  ds_read_b64_tr_b16 v[82:83], v2 offset:43008
  ds_read_b128 v[144:147], v14 offset:640
  s_waitcnt lgkmcnt(12)
  v_mfma_f32_16x16x32_bf16 v[8:11], v[64:67], v[128:131], v[8:11]
  ds_read_b64_tr_b16 v[84:85], v2 offset:45056
  ds_read_b64_tr_b16 v[86:87], v2 offset:47104
  ds_read_b128 v[148:151], v14 offset:704
  s_waitcnt lgkmcnt(12)
  v_mfma_f32_16x16x32_bf16 v[8:11], v[68:71], v[132:135], v[8:11]
  ds_read_b64_tr_b16 v[88:89], v2 offset:49152
  ds_read_b64_tr_b16 v[90:91], v2 offset:51200
  ds_read_b128 v[152:155], v14 offset:768
  s_waitcnt lgkmcnt(12)
  v_mfma_f32_16x16x32_bf16 v[8:11], v[72:75], v[136:139], v[8:11]
  ds_read_b64_tr_b16 v[92:93], v2 offset:53248
  ds_read_b64_tr_b16 v[94:95], v2 offset:55296
  ds_read_b128 v[156:159], v14 offset:832
  s_waitcnt lgkmcnt(12)
  v_mfma_f32_16x16x32_bf16 v[8:11], v[76:79], v[140:143], v[8:11]
  ds_read_b64_tr_b16 v[96:97], v2 offset:57344
  ds_read_b64_tr_b16 v[98:99], v2 offset:59392
  ds_read_b128 v[160:163], v14 offset:896
  s_waitcnt lgkmcnt(12)
  v_mfma_f32_16x16x32_bf16 v[8:11], v[80:83], v[144:147], v[8:11]
  ds_read_b64_tr_b16 v[100:101], v2 offset:61440
  ds_read_b64_tr_b16 v[102:103], v2 offset:63488
  ds_read_b128 v[164:167], v14 offset:960
  s_waitcnt lgkmcnt(12)
  v_mfma_f32_16x16x32_bf16 v[8:11], v[84:87], v[148:151], v[8:11]
  s_waitcnt lgkmcnt(9)
  v_mfma_f32_16x16x32_bf16 v[8:11], v[88:91], v[152:155], v[8:11]
  s_waitcnt lgkmcnt(6)
  v_mfma_f32_16x16x32_bf16 v[8:11], v[92:95], v[156:159], v[8:11]
  s_waitcnt lgkmcnt(3)
  v_mfma_f32_16x16x32_bf16 v[8:11], v[96:99], v[160:163], v[8:11]
  s_waitcnt lgkmcnt(0)
  v_mfma_f32_16x16x32_bf16 v[8:11], v[100:103], v[164:167], v[8:11]
  s_nop 7
  v_cvt_pk_bf16_f32 v8, v8, v9
  v_cvt_pk_bf16_f32 v10, v10, v11
  v_mov_b32 v9, s74
  v_mov_b32 v11, s74
  s_mov_b32 exec_lo, 0x00030003
  s_mov_b32 exec_hi, 0x00030003
  global_store_dwordx4 v13, v[8:11], s[42:43] sc1
  s_mov_b64 exec, -1
  s_branch L_svd
L_pre_wo:
  s_mov_b32 s70, 0
L_sn_39:
  ds_read_b32 v9, v38 offset:6720
  s_waitcnt lgkmcnt(0)
  v_cmp_gt_u32 vcc, 0x4, v9
  s_cmp_eq_u64 vcc, 0
  s_cbranch_scc1 L_snd_40
  s_sleep 8
  s_add_u32 s70, s70, 1
  s_cmp_lt_u32 s70, 2097152
  s_cbranch_scc1 L_sn_39
L_snd_40:
  v_lshrrev_b32 v2, 2, v1
  v_bfe_u32 v3, v1, 1, 1
  s_lshl_b32 s49, s5, 1
  v_or_b32 v3, s49, v3
  v_and_b32 v10, 6, v2
  v_xor_b32 v3, v3, v10
  v_lshlrev_b32 v2, 7, v2
  v_lshl_add_u32 v2, v3, 4, v2
  v_and_b32 v3, 1, v1
  v_lshl_add_u32 v2, v3, 3, v2
  v_add_u32 v2, 18432, v2
  ds_read_b64_tr_b16 v[40:41], v2 offset:0
  ds_read_b64_tr_b16 v[42:43], v2 offset:2048
  ds_read_b64_tr_b16 v[44:45], v2 offset:4096
  ds_read_b64_tr_b16 v[46:47], v2 offset:6144
  ds_read_b64_tr_b16 v[48:49], v2 offset:8192
  ds_read_b64_tr_b16 v[50:51], v2 offset:10240
  ds_read_b64_tr_b16 v[52:53], v2 offset:12288
  ds_read_b64_tr_b16 v[54:55], v2 offset:14336
  ds_read_b64_tr_b16 v[56:57], v2 offset:16384
  ds_read_b64_tr_b16 v[58:59], v2 offset:18432
  ds_read_b64_tr_b16 v[60:61], v2 offset:20480
  ds_read_b64_tr_b16 v[62:63], v2 offset:22528
  s_waitcnt lgkmcnt(10)
  ds_read_b64_tr_b16 v[64:65], v2 offset:24576
  ds_read_b64_tr_b16 v[66:67], v2 offset:26624
  s_waitcnt lgkmcnt(10)
  ds_read_b64_tr_b16 v[68:69], v2 offset:28672
  ds_read_b64_tr_b16 v[70:71], v2 offset:30720
  s_waitcnt lgkmcnt(10)
  ds_read_b64_tr_b16 v[72:73], v2 offset:32768
  ds_read_b64_tr_b16 v[74:75], v2 offset:34816
  s_waitcnt lgkmcnt(10)
  ds_read_b64_tr_b16 v[76:77], v2 offset:36864
  ds_read_b64_tr_b16 v[78:79], v2 offset:38912
  s_waitcnt lgkmcnt(10)
  ds_read_b64_tr_b16 v[80:81], v2 offset:40960
  ds_read_b64_tr_b16 v[82:83], v2 offset:43008
  s_waitcnt lgkmcnt(10)
  ds_read_b64_tr_b16 v[84:85], v2 offset:45056
  ds_read_b64_tr_b16 v[86:87], v2 offset:47104
  s_waitcnt lgkmcnt(10)
  ds_read_b64_tr_b16 v[88:89], v2 offset:49152
  ds_read_b64_tr_b16 v[90:91], v2 offset:51200
  s_waitcnt lgkmcnt(10)
  ds_read_b64_tr_b16 v[92:93], v2 offset:53248
  ds_read_b64_tr_b16 v[94:95], v2 offset:55296
  s_waitcnt lgkmcnt(10)
  ds_read_b64_tr_b16 v[96:97], v2 offset:57344
  ds_read_b64_tr_b16 v[98:99], v2 offset:59392
  s_waitcnt lgkmcnt(10)
  ds_read_b64_tr_b16 v[100:101], v2 offset:61440
  ds_read_b64_tr_b16 v[102:103], v2 offset:63488
  s_waitcnt lgkmcnt(10)
  s_waitcnt lgkmcnt(0)
  s_lshl_b32 s49, s8, 2
  s_add_u32 s49, s49, s5
  s_lshl_b32 s49, s49, 11
  s_add_u32 s49, s49, 131072
  v_lshrrev_b32 v12, 5, v1
  v_and_b32 v16, 31, v1
  v_lshlrev_b32 v15, 16, v12
  v_lshl_add_u32 v15, v16, 4, v15
  v_add_u32 v15, s49, v15
  v_mul_u32_u24 v12, 1056, v12
  v_bfe_u32 v16, v1, 3, 2
  v_lshl_add_u32 v12, v16, 6, v12
  v_and_b32 v16, 3, v1
  v_lshl_add_u32 v12, v16, 4, v12
  v_bfe_u32 v16, v1, 2, 1
  v_lshl_add_u32 v12, v16, 3, v12
  s_lshl_b32 s49, s5, 8
  v_add_u32 v12, s49, v12
  v_and_b32 v14, 1, v1
  v_mul_u32_u24 v14, 1056, v14
  v_lshrrev_b32 v3, 4, v1
  v_lshl_add_u32 v14, v3, 4, v14
  v_and_b32 v13, 1, v1
  v_lshlrev_b32 v13, 6, v13
  v_lshrrev_b32 v3, 4, v1
  v_lshl_add_u32 v13, v3, 4, v13
  s_lshl_b32 s49, s5, 7
  s_add_u32 s49, s49, s58
  v_add_u32 v13, s49, v13
  v_mov_b32 v36, 0xff
  s_branch L_svd
L_pre_f1:
  v_mov_b32 v37, v13
  v_lshlrev_b32 v15, 4, v0
  v_add_u32 v39, 16384, v15
  v_add_u32 v15, 266240, v15
  v_lshrrev_b32 v5, 2, v0
  v_lshlrev_b32 v5, 3, v5
  v_add_u32 v5, 7424, v5
  v_lshlrev_b32 v7, 3, v1
  v_add_u32 v7, 7424, v7
  v_and_b32 v14, 7, v1
  v_mul_u32_u24 v14, 1056, v14
  v_lshrrev_b32 v3, 4, v1
  v_lshl_add_u32 v14, v3, 4, v14
  v_bfe_u32 v6, v1, 2, 2
  v_lshl_add_u32 v6, v3, 3, v6
  v_mul_u32_u24 v6, 1056, v6
  v_and_b32 v8, 3, v1
  v_lshl_add_u32 v6, v8, 3, v6
  s_lshl_b32 s49, s5, 8
  s_add_u32 s49, s49, 104448
  v_add_u32 v6, s49, v6
  v_lshlrev_b32 v10, 3, v0
  v_add_u32 v10, 138240, v10
  v_mov_b32 v8, 0
  v_mov_b32 v9, 0
  ds_write_b64 v10, v[8:9]
  v_and_b32 v13, 1, v1
  v_lshlrev_b32 v13, 6, v13
  v_lshrrev_b32 v3, 4, v1
  v_lshl_add_u32 v13, v3, 4, v13
  s_mul_i32 s49, s5, 131072
  s_add_u32 s49, s49, s58
  v_add_u32 v13, s49, v13
  v_bfe_u32 v3, v1, 1, 3
  v_mul_u32_u24 v3, 16384, v3
  v_add_u32 v13, v3, v13
  v_lshrrev_b32 v2, 3, v1
  v_lshlrev_b32 v2, 6, v2
  v_bfe_u32 v3, v1, 2, 1
  v_lshl_add_u32 v2, v3, 14, v2
  v_and_b32 v8, 2, v1
  v_or_b32 v3, v3, v8
  v_xor_b32 v3, s5, v3
  v_lshl_add_u32 v2, v3, 4, v2
  v_lshl_add_u32 v2, v8, 14, v2
  v_and_b32 v3, 1, v1
  v_lshl_add_u32 v2, v3, 3, v2
  v_add_u32 v2, 18432, v2
  s_branch L_svd
L_pre_f2:
  v_bfe_u32 v12, v1, 2, 1
  v_and_b32 v14, 3, v1
  s_lshl_b32 s49, s61, 5
  v_lshl_add_u32 v3, v14, 3, s49
  v_lshl_add_u32 v37, v12, 10, v3
  v_and_b32 v15, 7, v1
  s_lshl_b32 s49, s61, 7
  v_lshl_add_u32 v15, v15, 4, s49
  v_add_u32 v39, 16384, v15
  v_bfe_u32 v3, v1, 3, 1
  v_lshl_add_u32 v15, v3, 12, v15
  v_lshrrev_b32 v3, 4, v1
  v_mul_u32_u24 v3, 16384, v3
  v_add_u32 v15, v3, v15
  v_add_u32 v15, 262144, v15
  s_mul_i32 s49, s61, 16384
  s_add_u32 s49, s49, 1574912
  v_lshl_add_u32 v36, v1, 4, s49
L_svd:
  s_cmp_eq_u32 s5, 3
  s_cbranch_scc1 L_svd3
  s_cmp_lg_u32 s5, 0
  s_cbranch_scc1 L_tail
  s_lshl_b32 s64, s6, 2
  s_add_u32 s64, s64, s7
  s_lshl_b32 s64, s64, 7
  s_add_u32 s64, s64, 98304
  v_mov_b32 v18, s64
  s_mov_b32 s70, 0
L_sn_41:
  ds_read_b32 v8, v38 offset:6672
  s_waitcnt lgkmcnt(0)
  v_and_b32 v8, 0xffff, v8
  v_cmp_gt_u32 vcc, 0x280, v8
  s_cmp_eq_u64 vcc, 0
  s_cbranch_scc1 L_snd_42
  s_sleep 1
  s_add_u32 s70, s70, 1
  s_cmp_lt_u32 s70, 2097152
  s_cbranch_scc1 L_sn_41
L_snd_42:
  v_and_b32 v9, 15, v1
  v_lshlrev_b32 v9, 3, v9
  ds_read_b64 v[10:11], v9 offset:6912
  s_waitcnt lgkmcnt(0)
  v_mov_b32 v16, v10
  v_max_f32_dpp v8, v10, v10 quad_perm:[1,0,3,2] row_mask:0xf bank_mask:0xf
  s_nop 1
  v_max_f32_dpp v8, v8, v8 quad_perm:[2,3,0,1] row_mask:0xf bank_mask:0xf
  s_nop 1
  v_max_f32_dpp v8, v8, v8 row_half_mirror row_mask:0xf bank_mask:0xf
  s_nop 1
  v_max_f32_dpp v8, v8, v8 row_mirror row_mask:0xf bank_mask:0xf
  v_sub_f32 v9, v10, v8
  v_mul_f32 v9, 0x3fb8aa3b, v9
  v_exp_f32 v9, v9
  s_nop 0
  v_mul_f32 v10, v9, v11
  s_nop 1
  v_add_f32_dpp v10, v10, v10 quad_perm:[1,0,3,2] row_mask:0xf bank_mask:0xf
  s_nop 1
  v_add_f32_dpp v10, v10, v10 quad_perm:[2,3,0,1] row_mask:0xf bank_mask:0xf
  s_nop 1
  v_add_f32_dpp v10, v10, v10 row_half_mirror row_mask:0xf bank_mask:0xf
  s_nop 1
  v_add_f32_dpp v10, v10, v10 row_mirror row_mask:0xf bank_mask:0xf
  v_mov_b32 v9, s74
  v_mov_b32 v11, s76
  s_mov_b64 exec, 1
  global_store_dwordx4 v18, v[8:11], s[42:43] sc1
  ds_write_b32 v38, v8 offset:6848
  ds_write_b32 v38, v10 offset:6852
  s_mov_b64 exec, -1
  s_mov_b32 s70, 0
L_sn_43:
  ds_read_b32 v8, v38 offset:6672
  s_waitcnt lgkmcnt(0)
  v_cmp_gt_u32 vcc, 0x10000, v8
  s_cmp_eq_u64 vcc, 0
  s_cbranch_scc1 L_snd_44
  s_sleep 1
  s_add_u32 s70, s70, 1
  s_cmp_lt_u32 s70, 2097152
  s_cbranch_scc1 L_sn_43
L_snd_44:
  v_and_b32 v9, 3, v1
  v_lshlrev_b32 v9, 3, v9
  ds_read_b64 v[10:11], v9 offset:6848
  s_waitcnt lgkmcnt(0)
  v_max_f32_dpp v8, v10, v10 quad_perm:[1,0,3,2] row_mask:0xf bank_mask:0xf
  s_nop 1
  v_max_f32_dpp v8, v8, v8 quad_perm:[2,3,0,1] row_mask:0xf bank_mask:0xf
  v_sub_f32 v9, v10, v8
  v_mul_f32 v9, 0x3fb8aa3b, v9
  v_exp_f32 v9, v9
  s_nop 0
  v_mul_f32 v10, v9, v11
  s_nop 1
  v_add_f32_dpp v10, v10, v10 quad_perm:[1,0,3,2] row_mask:0xf bank_mask:0xf
  s_nop 1
  v_add_f32_dpp v10, v10, v10 quad_perm:[2,3,0,1] row_mask:0xf bank_mask:0xf
  v_sub_f32 v9, v16, v8
  v_rcp_f32 v10, v10
  v_mul_f32 v9, 0x3fb8aa3b, v9
  v_exp_f32 v9, v9
  v_lshlrev_b32 v8, 2, v1
  v_mul_f32 v9, v9, v10
  s_mov_b64 exec, 0xffff
  ds_write_b32 v8, v9 offset:6784
  s_mov_b64 exec, -1
  ds_write_b32 v38, v38 offset:6656
  s_mov_b32 s70, 0
L_sn_45:
  ds_read_b32 v8, v38 offset:6704
  s_waitcnt lgkmcnt(0)
  v_cmp_gt_u32 vcc, 0xa, v8
  s_cmp_eq_u64 vcc, 0
  s_cbranch_scc1 L_snd_46
  s_sleep 1
  s_add_u32 s70, s70, 1
  s_cmp_lt_u32 s70, 2097152
  s_cbranch_scc1 L_sn_45
L_snd_46:
  v_lshlrev_b32 v136, 3, v1
  ds_read_b32 v139, v38 offset:6712
  ds_read_b128 v[124:127], v38 offset:6784
  ds_read_b128 v[128:131], v38 offset:6800
  ds_read_b128 v[132:135], v38 offset:6816
  ds_read_b64 v[104:105], v136 offset:13056
  ds_read_b64 v[106:107], v136 offset:13568
  ds_read_b64 v[108:109], v136 offset:14080
  ds_read_b64 v[110:111], v136 offset:14592
  ds_read_b64 v[112:113], v136 offset:15104
  ds_read_b64 v[114:115], v136 offset:15616
  ds_read_b64 v[116:117], v136 offset:16128
  ds_read_b64 v[118:119], v136 offset:16640
  ds_read_b64 v[120:121], v136 offset:17152
  ds_read_b64 v[122:123], v136 offset:17664
  s_lshl_b32 s68, s6, 2
  s_add_u32 s68, s68, s7
  s_lshl_b32 s68, s68, 9
  s_add_u32 s68, s68, 131072
  v_add_u32 v136, s68, v136
  v_and_b32 v137, 1, v1
  v_lshlrev_b32 v137, 4, v137
  v_lshrrev_b32 v137, v137, s74
  v_lshrrev_b32 v138, 8, v137
  s_movk_i32 s69, 0xff
  s_waitcnt lgkmcnt(9)
  v_pk_mul_f32 v[104:105], v[104:105], v[124:125] op_sel:[0,0] op_sel_hi:[1,0]
  v_readfirstlane_b32 s75, v139
  s_waitcnt lgkmcnt(8)
  v_pk_mul_f32 v[106:107], v[106:107], v[124:125] op_sel:[0,1] op_sel_hi:[1,1]
  s_waitcnt lgkmcnt(7)
  v_pk_fma_f32 v[104:105], v[108:109], v[126:127], v[104:105] op_sel:[0,0,0] op_sel_hi:[1,0,1]
  s_waitcnt lgkmcnt(6)
  v_pk_fma_f32 v[106:107], v[110:111], v[126:127], v[106:107] op_sel:[0,1,0] op_sel_hi:[1,1,1]
  s_waitcnt lgkmcnt(5)
  v_pk_fma_f32 v[104:105], v[112:113], v[128:129], v[104:105] op_sel:[0,0,0] op_sel_hi:[1,0,1]
  s_waitcnt lgkmcnt(4)
  v_pk_fma_f32 v[106:107], v[114:115], v[128:129], v[106:107] op_sel:[0,1,0] op_sel_hi:[1,1,1]
  s_waitcnt lgkmcnt(3)
  v_pk_fma_f32 v[104:105], v[116:117], v[130:131], v[104:105] op_sel:[0,0,0] op_sel_hi:[1,0,1]
  s_waitcnt lgkmcnt(2)
  v_pk_fma_f32 v[106:107], v[118:119], v[130:131], v[106:107] op_sel:[0,1,0] op_sel_hi:[1,1,1]
  s_waitcnt lgkmcnt(1)
  v_pk_fma_f32 v[104:105], v[120:121], v[132:133], v[104:105] op_sel:[0,0,0] op_sel_hi:[1,0,1]
  s_waitcnt lgkmcnt(0)
  v_pk_fma_f32 v[106:107], v[122:123], v[132:133], v[106:107] op_sel:[0,1,0] op_sel_hi:[1,1,1]
  v_pk_add_f32 v[104:105], v[104:105], v[106:107]
  v_bfi_b32 v104, s69, v137, v104
  v_bfi_b32 v105, s69, v138, v105
  s_cmp_eq_u32 s75, 2
  s_cbranch_scc0 L_pf_47
  global_store_dwordx2 v136, v[104:105], s[42:43]
  s_branch L_pe_48
L_pf_47:
  global_store_dwordx2 v136, v[104:105], s[42:43] sc1
L_pe_48:
  s_cmp_eq_u32 s60, 1
  s_cbranch_scc1 L_tail
  s_waitcnt vmcnt(0)
  ds_write_b32 v38, v38 offset:6700
  s_branch L_tail
L_svd3:
  s_mov_b32 s70, 0
L_sn_49:
  ds_read_b32 v8, v38 offset:6672
  s_waitcnt lgkmcnt(0)
  v_cmp_gt_u32 vcc, 0x180, v8
  s_cmp_eq_u64 vcc, 0
  s_cbranch_scc1 L_snd_50
  s_sleep 4
  s_add_u32 s70, s70, 1
  s_cmp_lt_u32 s70, 2097152
  s_cbranch_scc1 L_sn_49
L_snd_50:
  s_lshl_b32 s64, s6, 9
  s_xor_b32 s54, s7, 1
  s_lshl_b32 s54, s54, 7
  s_add_u32 s54, s54, s64
  s_xor_b32 s55, s7, 2
  s_lshl_b32 s55, s55, 7
  s_add_u32 s55, s55, s64
  s_xor_b32 s56, s7, 3
  s_lshl_b32 s56, s56, 7
  s_add_u32 s56, s56, s64
  s_mov_b32 s70, 0
L_s3p:
  s_load_dwordx4 s[20:23], s[42:43], s54 offset:98304 glc
  s_load_dwordx4 s[24:27], s[42:43], s55 offset:98304 glc
  s_load_dwordx4 s[28:31], s[42:43], s56 offset:98304 glc
  s_waitcnt lgkmcnt(0)
  s_xor_b32 s68, s21, s74
  s_sub_u32 s69, s23, s74
  s_lshr_b32 s69, s69, 4
  s_or_b32 s68, s68, s69
  s_xor_b32 s69, s25, s74
  s_or_b32 s68, s68, s69
  s_sub_u32 s69, s27, s74
  s_lshr_b32 s69, s69, 4
  s_or_b32 s68, s68, s69
  s_xor_b32 s69, s29, s74
  s_or_b32 s68, s68, s69
  s_sub_u32 s69, s31, s74
  s_lshr_b32 s69, s69, 4
  s_or_b32 s68, s68, s69
  s_cbranch_scc0 L_s3pd
  s_sleep 2
  s_add_u32 s70, s70, 1
  s_cmp_lt_u32 s70, 262144
  s_cbranch_scc1 L_s3p
L_s3pd:
  v_mov_b32 v8, s20
  v_mov_b32 v10, s24
  v_mov_b32 v16, s28
  v_max3_f32 v18, v8, v10, v16
  v_mov_b32 v19, 0x10000
  v_mov_b32 v9, s22
  v_mov_b32 v11, s26
  v_mov_b32 v17, s30
  s_xor_b32 s68, s23, s76
  s_xor_b32 s69, s27, s76
  s_or_b32 s68, s68, s69
  s_xor_b32 s69, s31, s76
  s_or_b32 s68, s68, s69
  s_cselect_b32 s68, 0, 1
  v_mov_b32 v3, s68
  s_mov_b64 exec, 1
  ds_add_u32 v38, v3 offset:6712
  ds_max_f32 v38, v18 offset:6676
  ds_write_b64 v38, v[8:9] offset:6856
  ds_write_b64 v38, v[10:11] offset:6864
  ds_write_b64 v38, v[16:17] offset:6872
  ds_add_u32 v38, v19 offset:6672
  s_mov_b64 exec, -1
L_tail:
  s_cmp_eq_u32 s60, 0
  s_cbranch_scc1 L_fin
  s_cmp_lg_u32 s60, 4
  s_cbranch_scc1 L_tl2
  s_branch L_fin
L_tl2:
  s_mov_b32 s70, 0
L_sn_51:
  ds_read_b32 v8, v38 offset:6704
  s_waitcnt lgkmcnt(0)
  v_cmp_gt_u32 vcc, 0xa, v8
  s_cmp_eq_u64 vcc, 0
  s_cbranch_scc1 L_snd_52
  s_sleep 8
  s_add_u32 s70, s70, 1
  s_cmp_lt_u32 s70, 2097152
  s_cbranch_scc1 L_sn_51
L_snd_52:
  s_cmp_eq_u32 s60, 1
  s_cbranch_scc1 L_t_wo0
  s_cmp_eq_u32 s60, 3
  s_cbranch_scc1 L_t_f2
  s_mov_b32 s70, 0
L_sn_53:
  ds_read_b32 v9, v38 offset:6720
  s_waitcnt lgkmcnt(0)
  v_cmp_gt_u32 vcc, 0x4, v9
  s_cmp_eq_u64 vcc, 0
  s_cbranch_scc1 L_snd_54
  s_sleep 8
  s_add_u32 s70, s70, 1
  s_cmp_lt_u32 s70, 2097152
  s_cbranch_scc1 L_sn_53
L_snd_54:
  s_branch L_t_f1
L_t_wo0:
L_t_wo:
  s_mov_b64 s[20:21], -1
  s_mov_b64 s[22:23], -1
  s_mov_b64 s[24:25], -1
  s_mov_b64 s[26:27], -1
  s_mov_b64 exec, s[20:21]
  global_load_dwordx4 v[152:155], v15, s[42:43] offset:0 sc1
  s_mov_b64 exec, s[22:23]
  global_load_dwordx4 v[156:159], v15, s[42:43] offset:512 sc1
  s_mov_b64 exec, s[24:25]
  global_load_dwordx4 v[160:163], v15, s[42:43] offset:1024 sc1
  s_mov_b64 exec, s[26:27]
  global_load_dwordx4 v[164:167], v15, s[42:43] offset:1536 sc1
  s_mov_b64 exec, -1
  s_waitcnt vmcnt(0)
  s_mov_b32 s70, 0
  s_branch L_wo_c
L_wo_:
  s_mov_b64 exec, s[20:21]
  global_load_dwordx4 v[152:155], v15, s[42:43] offset:0 sc1
  s_mov_b64 exec, s[22:23]
  global_load_dwordx4 v[156:159], v15, s[42:43] offset:512 sc1
  s_mov_b64 exec, s[24:25]
  global_load_dwordx4 v[160:163], v15, s[42:43] offset:1024 sc1
  s_mov_b64 exec, s[26:27]
  global_load_dwordx4 v[164:167], v15, s[42:43] offset:1536 sc1
  s_mov_b64 exec, -1
  s_waitcnt vmcnt(0)
L_wo_c:
  v_xor_b32 v136, s32, v152
  v_xor_b32 v137, s33, v153
  v_xor_b32 v138, s34, v154
  v_xor_b32 v139, s35, v155
  v_xor_b32 v140, s32, v156
  v_xor_b32 v141, s33, v157
  v_xor_b32 v142, s34, v158
  v_xor_b32 v143, s35, v159
  v_xor_b32 v144, s32, v160
  v_xor_b32 v145, s33, v161
  v_xor_b32 v146, s34, v162
  v_xor_b32 v147, s35, v163
  v_xor_b32 v148, s32, v164
  v_xor_b32 v149, s33, v165
  v_xor_b32 v150, s34, v166
  v_xor_b32 v151, s35, v167
  v_or3_b32 v28, v136, v137, v138
  v_or3_b32 v29, v140, v141, v142
  v_or3_b32 v30, v144, v145, v146
  v_or3_b32 v31, v148, v149, v150
  v_or_b32 v28, v28, v139
  v_or_b32 v29, v29, v143
  v_or_b32 v30, v30, v147
  v_or_b32 v31, v31, v151
  v_cmp_ne_u32_sdwa s[20:21], v28, v38 src0_sel:BYTE_0 src1_sel:DWORD
  v_cmp_ne_u32_sdwa s[22:23], v29, v38 src0_sel:BYTE_0 src1_sel:DWORD
  v_cmp_ne_u32_sdwa s[24:25], v30, v38 src0_sel:BYTE_0 src1_sel:DWORD
  v_cmp_ne_u32_sdwa s[26:27], v31, v38 src0_sel:BYTE_0 src1_sel:DWORD
  v_or_b32 v136, 0x80, v136
  v_or_b32 v137, 0x80, v137
  v_or_b32 v138, 0x80, v138
  v_or_b32 v139, 0x80, v139
  v_or_b32 v140, 0x80, v140
  v_or_b32 v141, 0x80, v141
  v_or_b32 v142, 0x80, v142
  v_or_b32 v143, 0x80, v143
  v_or_b32 v144, 0x80, v144
  v_or_b32 v145, 0x80, v145
  v_or_b32 v146, 0x80, v146
  v_or_b32 v147, 0x80, v147
  v_or_b32 v148, 0x80, v148
  v_or_b32 v149, 0x80, v149
  v_or_b32 v150, 0x80, v150
  v_or_b32 v151, 0x80, v151
  v_pk_add_f32 v[16:17], v[136:137], v[144:145]
  v_pk_add_f32 v[18:19], v[138:139], v[146:147]
  v_pk_add_f32 v[20:21], v[140:141], v[148:149]
  v_pk_add_f32 v[22:23], v[142:143], v[150:151]
  v_pk_add_f32 v[16:17], v[16:17], v[20:21]
  v_pk_add_f32 v[18:19], v[18:19], v[22:23]
  s_mov_b64 vcc, s[20:21]
  s_or_b64 vcc, vcc, s[22:23]
  s_or_b64 vcc, vcc, s[24:25]
  s_or_b64 vcc, vcc, s[26:27]
  s_or_b32 s20, s20, 1
  s_or_b32 s22, s22, 1
  s_or_b32 s24, s24, 1
  s_or_b32 s26, s26, 1
  s_cmp_eq_u64 vcc, 0
  s_cbranch_scc1 L_wo_ok
  s_add_u32 s70, s70, 1
  s_cmp_lt_u32 s70, 262144
  s_cbranch_scc1 L_wo_
L_wo_ok:
  v_cvt_pk_bf16_f32 v8, v16, v17
  v_cvt_pk_bf16_f32 v9, v18, v19
  ds_write_b64 v12, v[8:9] offset:0
  ds_write_b32 v38, v38 offset:6700
  s_add_u32 s77, s77, 4
  v_mov_b32 v3, 1
  s_mov_b64 exec, 1
  ds_add_u32 v38, v3 offset:6720
  s_mov_b64 exec, -1
  s_mov_b32 s70, 0
L_hy_55:
  ds_read_b32 v3, v38 offset:6720
  s_waitcnt lgkmcnt(0)
  v_cmp_gt_u32 vcc, s77, v3
  s_cmp_eq_u64 vcc, 0
  s_cbranch_scc1 L_hyd_56
  s_add_u32 s70, s70, 1
  s_cmp_lt_u32 s70, 2097152
  s_cbranch_scc1 L_hy_55
L_hyd_56:
  ds_read_b128 v[104:107], v14 offset:0
  ds_read_b128 v[108:111], v14 offset:64
  ds_read_b128 v[112:115], v14 offset:128
  ds_read_b128 v[116:119], v14 offset:192
  ds_read_b128 v[120:123], v14 offset:256
  ds_read_b128 v[124:127], v14 offset:320
  ds_read_b128 v[128:131], v14 offset:384
  ds_read_b128 v[132:135], v14 offset:448
  ds_read_b128 v[136:139], v14 offset:512
  ds_read_b128 v[140:143], v14 offset:576
  ds_read_b128 v[144:147], v14 offset:640
  ds_read_b128 v[148:151], v14 offset:704
  s_waitcnt lgkmcnt(11)
  v_mfma_f32_16x16x32_bf16 v[8:11], v[40:43], v[104:107], 0
  s_waitcnt lgkmcnt(10)
  v_mfma_f32_16x16x32_bf16 v[8:11], v[44:47], v[108:111], v[8:11]
  ds_read_b128 v[104:107], v14 offset:768
  s_waitcnt lgkmcnt(10)
  v_mfma_f32_16x16x32_bf16 v[8:11], v[48:51], v[112:115], v[8:11]
  ds_read_b128 v[108:111], v14 offset:832
  s_waitcnt lgkmcnt(10)
  v_mfma_f32_16x16x32_bf16 v[8:11], v[52:55], v[116:119], v[8:11]
  ds_read_b128 v[112:115], v14 offset:896
  s_waitcnt lgkmcnt(10)
  v_mfma_f32_16x16x32_bf16 v[8:11], v[56:59], v[120:123], v[8:11]
  ds_read_b128 v[116:119], v14 offset:960
  s_waitcnt lgkmcnt(10)
  v_mfma_f32_16x16x32_bf16 v[8:11], v[60:63], v[124:127], v[8:11]
  s_waitcnt lgkmcnt(9)
  v_mfma_f32_16x16x32_bf16 v[8:11], v[64:67], v[128:131], v[8:11]
  s_waitcnt lgkmcnt(8)
  v_mfma_f32_16x16x32_bf16 v[8:11], v[68:71], v[132:135], v[8:11]
  s_waitcnt lgkmcnt(7)
  v_mfma_f32_16x16x32_bf16 v[8:11], v[72:75], v[136:139], v[8:11]
  s_waitcnt lgkmcnt(6)
  v_mfma_f32_16x16x32_bf16 v[8:11], v[76:79], v[140:143], v[8:11]
  s_waitcnt lgkmcnt(5)
  v_mfma_f32_16x16x32_bf16 v[8:11], v[80:83], v[144:147], v[8:11]
  s_waitcnt lgkmcnt(4)
  v_mfma_f32_16x16x32_bf16 v[8:11], v[84:87], v[148:151], v[8:11]
  s_waitcnt lgkmcnt(3)
  v_mfma_f32_16x16x32_bf16 v[8:11], v[88:91], v[104:107], v[8:11]
  s_waitcnt lgkmcnt(2)
  v_mfma_f32_16x16x32_bf16 v[8:11], v[92:95], v[108:111], v[8:11]
  s_waitcnt lgkmcnt(1)
  v_mfma_f32_16x16x32_bf16 v[8:11], v[96:99], v[112:115], v[8:11]
  s_waitcnt lgkmcnt(0)
  v_mfma_f32_16x16x32_bf16 v[8:11], v[100:103], v[116:119], v[8:11]
  s_nop 7
  v_bfi_b32 v8, v36, s32, v8
  v_bfi_b32 v9, v36, s33, v9
  v_bfi_b32 v10, v36, s34, v10
  v_bfi_b32 v11, v36, s35, v11
  s_mov_b32 exec_lo, 0x00030003
  s_mov_b32 exec_hi, 0x00030003
  global_store_dwordx4 v13, v[8:11], s[42:43] sc1
  s_branch L_fin
L_t_f1:
  ds_read_b64_tr_b16 v[40:41], v2 offset:0
  ds_read_b64_tr_b16 v[42:43], v2 offset:512
  ds_read_b64_tr_b16 v[44:45], v2 offset:1024
  ds_read_b64_tr_b16 v[46:47], v2 offset:1536
  ds_read_b64_tr_b16 v[48:49], v2 offset:2048
  ds_read_b64_tr_b16 v[50:51], v2 offset:2560
  ds_read_b64_tr_b16 v[52:53], v2 offset:3072
  ds_read_b64_tr_b16 v[54:55], v2 offset:3584
  ds_read_b64_tr_b16 v[56:57], v2 offset:4096
  ds_read_b64_tr_b16 v[58:59], v2 offset:4608
  ds_read_b64_tr_b16 v[60:61], v2 offset:5120
  ds_read_b64_tr_b16 v[62:63], v2 offset:5632
  s_waitcnt lgkmcnt(10)
  ds_read_b64_tr_b16 v[64:65], v2 offset:6144
  ds_read_b64_tr_b16 v[66:67], v2 offset:6656
  s_waitcnt lgkmcnt(10)
  ds_read_b64_tr_b16 v[68:69], v2 offset:7168
  ds_read_b64_tr_b16 v[70:71], v2 offset:7680
  s_waitcnt lgkmcnt(10)
  ds_read_b64_tr_b16 v[72:73], v2 offset:8192
  ds_read_b64_tr_b16 v[74:75], v2 offset:8704
  s_waitcnt lgkmcnt(10)
  ds_read_b64_tr_b16 v[76:77], v2 offset:9216
  ds_read_b64_tr_b16 v[78:79], v2 offset:9728
  s_waitcnt lgkmcnt(10)
  ds_read_b64_tr_b16 v[80:81], v2 offset:10240
  ds_read_b64_tr_b16 v[82:83], v2 offset:10752
  s_waitcnt lgkmcnt(10)
  ds_read_b64_tr_b16 v[84:85], v2 offset:11264
  ds_read_b64_tr_b16 v[86:87], v2 offset:11776
  s_waitcnt lgkmcnt(10)
  ds_read_b64_tr_b16 v[88:89], v2 offset:12288
  ds_read_b64_tr_b16 v[90:91], v2 offset:12800
  s_waitcnt lgkmcnt(10)
  ds_read_b64_tr_b16 v[92:93], v2 offset:13312
  ds_read_b64_tr_b16 v[94:95], v2 offset:13824
  s_waitcnt lgkmcnt(10)
  ds_read_b64_tr_b16 v[96:97], v2 offset:14336
  ds_read_b64_tr_b16 v[98:99], v2 offset:14848
  s_waitcnt lgkmcnt(10)
  ds_read_b64_tr_b16 v[100:101], v2 offset:15360
  ds_read_b64_tr_b16 v[102:103], v2 offset:15872
  s_waitcnt lgkmcnt(10)
  s_waitcnt lgkmcnt(0)
  v_add_u32 v4, 16384, v15
  v_add_u32 v0, 32768, v15
  v_add_u32 v36, 49152, v15
  global_load_dwordx2 v[8:9], v37, s[16:17]
  s_mov_b32 s70, 0
L_pg_57:
  global_load_dwordx4 v[136:139], v39, s[42:43] offset:-4096 sc1
  global_load_dwordx4 v[140:143], v39, s[42:43] offset:0 sc1
  v_add_u32 v3, 4096, v39
  global_load_dwordx4 v[144:147], v3, s[42:43] sc1
  s_waitcnt vmcnt(0)
  s_mov_b64 vcc, 0
  v_cmp_ne_u32 s[68:69], s74, v137
  s_or_b64 vcc, vcc, s[68:69]
  v_cmp_ne_u32 s[68:69], s74, v139
  s_or_b64 vcc, vcc, s[68:69]
  v_cmp_ne_u32 s[68:69], s74, v141
  s_or_b64 vcc, vcc, s[68:69]
  v_cmp_ne_u32 s[68:69], s74, v143
  s_or_b64 vcc, vcc, s[68:69]
  v_cmp_ne_u32 s[68:69], s74, v145
  s_or_b64 vcc, vcc, s[68:69]
  v_cmp_ne_u32 s[68:69], s74, v147
  s_or_b64 vcc, vcc, s[68:69]
  s_cmp_eq_u64 vcc, 0
  s_cbranch_scc1 L_pge_58
  s_sleep 8
  s_add_u32 s70, s70, 1
  s_cmp_lt_u32 s70, 262144
  s_cbranch_scc1 L_pg_57
L_pge_58:
  v_and_b32 v39, 1, v1
  v_lshlrev_b32 v39, 6, v39
  v_add_u32 v39, 139136, v39
  v_lshrrev_b32 v3, 4, v1
  v_lshl_add_u32 v37, v3, 4, v39
  v_bfe_u32 v3, v1, 1, 3
  v_lshlrev_b32 v3, 7, v3
  v_sub_u32 v37, v37, v3
  v_bfe_u32 v3, v1, 4, 1
  v_lshl_add_u32 v39, v3, 3, v39
  v_lshrrev_b32 v3, 5, v1
  v_lshl_add_u32 v39, v3, 2, v39
  s_lshl_b32 s49, s5, 4
  v_add_u32 v39, s49, v39
  v_lshlrev_b32 v16, 16, v8
  v_and_b32 v17, s73, v8
  v_lshlrev_b32 v18, 16, v9
  v_and_b32 v19, s73, v9
  v_lshlrev_b32 v20, 16, v136
  v_and_b32 v21, s73, v136
  v_lshlrev_b32 v22, 16, v138
  v_and_b32 v23, s73, v138
  v_lshlrev_b32 v28, 16, v144
  v_and_b32 v29, s73, v144
  v_lshlrev_b32 v30, 16, v146
  v_and_b32 v31, s73, v146
  v_add_f32 v28, 1.0, v28
  v_add_f32 v29, 1.0, v29
  v_add_f32 v30, 1.0, v30
  v_add_f32 v31, 1.0, v31
  v_cvt_pk_bf16_f32 v8, v28, v29
  v_cvt_pk_bf16_f32 v9, v30, v31
  v_mov_b32 v141, v142
  ds_write_b64 v12, v[8:9] offset:2112
  ds_write_b64 v12, v[140:141] offset:4224
  v_cvt_pk_bf16_f32 v28, 0, v28
  v_cvt_pk_bf16_f32 v29, 0, v29
  v_cvt_pk_bf16_f32 v30, 0, v30
  v_cvt_pk_bf16_f32 v31, 0, v31
  v_mul_f32 v24, v20, v28
  v_mul_f32 v25, v21, v29
  v_mul_f32 v26, v22, v30
  v_mul_f32 v27, v23, v31
  v_mul_f32 v28, v16, v28
  v_mul_f32 v29, v17, v29
  v_mul_f32 v30, v18, v30
  v_mul_f32 v31, v19, v31
  s_waitcnt lgkmcnt(0)
  ds_read_b32 v8, v38 offset:6696
  s_waitcnt lgkmcnt(0)
  v_subrev_u32 v8, 1024, v8
  v_mul_i32_i24 v8, 8, v8
  v_ashrrev_i32 v8, 4, v8
  v_add_u32 v9, 1032, v8
  s_mov_b32 s70, 0
L_af_59:
  ds_read_b32 v8, v38 offset:6696
  s_waitcnt lgkmcnt(0)
  v_cmp_lt_u32 vcc, v9, v8
  s_cmp_eq_u64 vcc, 0
  s_cbranch_scc1 L_afd_60
  s_sleep 4
  s_add_u32 s70, s70, 1
  s_cmp_lt_u32 s70, 2097152
  s_cbranch_scc1 L_af_59
L_afd_60:
  s_mov_b32 s70, 0
  s_mov_b32 s71, 15
  s_bitcmp1_b32 s71, 0
  s_cbranch_scc0 L_fl_61
  global_load_dwordx4 v[104:107], v15, s[42:43] offset:-4096 sc1
  global_load_dwordx4 v[108:111], v15, s[42:43] offset:0 sc1
L_fl_61:
  s_bitcmp1_b32 s71, 1
  s_cbranch_scc0 L_fl_62
  global_load_dwordx4 v[112:115], v4, s[42:43] offset:-4096 sc1
  global_load_dwordx4 v[116:119], v4, s[42:43] offset:0 sc1
L_fl_62:
  s_bitcmp1_b32 s71, 2
  s_cbranch_scc0 L_fl_63
  global_load_dwordx4 v[120:123], v0, s[42:43] offset:-4096 sc1
  global_load_dwordx4 v[124:127], v0, s[42:43] offset:0 sc1
L_fl_63:
  s_bitcmp1_b32 s71, 3
  s_cbranch_scc0 L_fl_64
  global_load_dwordx4 v[128:131], v36, s[42:43] offset:-4096 sc1
  global_load_dwordx4 v[132:135], v36, s[42:43] offset:0 sc1
L_fl_64:
  s_waitcnt vmcnt(0)
  s_branch L_f1_c
L_f1_p:
  s_add_u32 s70, s70, 1
  s_cmp_ge_u32 s70, 262144
  s_cbranch_scc1 L_f1_ok
  s_bitcmp1_b32 s71, 0
  s_cbranch_scc0 L_fl_65
  global_load_dwordx4 v[104:107], v15, s[42:43] offset:-4096 sc1
  global_load_dwordx4 v[108:111], v15, s[42:43] offset:0 sc1
L_fl_65:
  s_bitcmp1_b32 s71, 1
  s_cbranch_scc0 L_fl_66
  global_load_dwordx4 v[112:115], v4, s[42:43] offset:-4096 sc1
  global_load_dwordx4 v[116:119], v4, s[42:43] offset:0 sc1
L_fl_66:
  s_bitcmp1_b32 s71, 2
  s_cbranch_scc0 L_fl_67
  global_load_dwordx4 v[120:123], v0, s[42:43] offset:-4096 sc1
  global_load_dwordx4 v[124:127], v0, s[42:43] offset:0 sc1
L_fl_67:
  s_bitcmp1_b32 s71, 3
  s_cbranch_scc0 L_fl_68
  global_load_dwordx4 v[128:131], v36, s[42:43] offset:-4096 sc1
  global_load_dwordx4 v[132:135], v36, s[42:43] offset:0 sc1
L_fl_68:
  s_waitcnt vmcnt(0)
L_f1_c:
  s_bitcmp1_b32 s71, 0
  s_cbranch_scc0 L_fc_69
  v_xor_b32 v136, s32, v104
  v_xor_b32 v137, s33, v105
  v_xor_b32 v138, s34, v106
  v_xor_b32 v139, s35, v107
  v_xor_b32 v140, s32, v108
  v_xor_b32 v141, s33, v109
  v_xor_b32 v142, s34, v110
  v_xor_b32 v143, s35, v111
  v_or3_b32 v8, v136, v137, v138
  v_or3_b32 v9, v139, v140, v141
  v_or3_b32 v8, v8, v142, v143
  v_pk_add_f32 v[136:137], v[136:137], v[140:141]
  v_pk_add_f32 v[138:139], v[138:139], v[142:143]
  v_or_b32 v8, v8, v9
  v_cmp_ne_u32_sdwa vcc, v8, v38 src0_sel:BYTE_0 src1_sel:DWORD
  s_cmp_lg_u64 vcc, 0
  s_cbranch_scc1 L_fc_69
  s_bitset0_b32 s71, 0
L_fc_69:
  s_bitcmp1_b32 s71, 1
  s_cbranch_scc0 L_fc_70
  v_xor_b32 v144, s32, v112
  v_xor_b32 v145, s33, v113
  v_xor_b32 v146, s34, v114
  v_xor_b32 v147, s35, v115
  v_xor_b32 v148, s32, v116
  v_xor_b32 v149, s33, v117
  v_xor_b32 v150, s34, v118
  v_xor_b32 v151, s35, v119
  v_or3_b32 v8, v144, v145, v146
  v_or3_b32 v9, v147, v148, v149
  v_or3_b32 v8, v8, v150, v151
  v_pk_add_f32 v[144:145], v[144:145], v[148:149]
  v_pk_add_f32 v[146:147], v[146:147], v[150:151]
  v_or_b32 v8, v8, v9
  v_cmp_ne_u32_sdwa vcc, v8, v38 src0_sel:BYTE_0 src1_sel:DWORD
  s_cmp_lg_u64 vcc, 0
  s_cbranch_scc1 L_fc_70
  s_bitset0_b32 s71, 1
L_fc_70:
  s_bitcmp1_b32 s71, 2
  s_cbranch_scc0 L_fc_71
  v_xor_b32 v152, s32, v120
  v_xor_b32 v153, s33, v121
  v_xor_b32 v154, s34, v122
  v_xor_b32 v155, s35, v123
  v_xor_b32 v156, s32, v124
  v_xor_b32 v157, s33, v125
  v_xor_b32 v158, s34, v126
  v_xor_b32 v159, s35, v127
  v_or3_b32 v8, v152, v153, v154
  v_or3_b32 v9, v155, v156, v157
  v_or3_b32 v8, v8, v158, v159
  v_pk_add_f32 v[152:153], v[152:153], v[156:157]
  v_pk_add_f32 v[154:155], v[154:155], v[158:159]
  v_or_b32 v8, v8, v9
  v_cmp_ne_u32_sdwa vcc, v8, v38 src0_sel:BYTE_0 src1_sel:DWORD
  s_cmp_lg_u64 vcc, 0
  s_cbranch_scc1 L_fc_71
  s_bitset0_b32 s71, 2
L_fc_71:
  s_bitcmp1_b32 s71, 3
  s_cbranch_scc0 L_fc_72
  v_xor_b32 v160, s32, v128
  v_xor_b32 v161, s33, v129
  v_xor_b32 v162, s34, v130
  v_xor_b32 v163, s35, v131
  v_xor_b32 v164, s32, v132
  v_xor_b32 v165, s33, v133
  v_xor_b32 v166, s34, v134
  v_xor_b32 v167, s35, v135
  v_or3_b32 v8, v160, v161, v162
  v_or3_b32 v9, v163, v164, v165
  v_or3_b32 v8, v8, v166, v167
  v_pk_add_f32 v[160:161], v[160:161], v[164:165]
  v_pk_add_f32 v[162:163], v[162:163], v[166:167]
  v_or_b32 v8, v8, v9
  v_cmp_ne_u32_sdwa vcc, v8, v38 src0_sel:BYTE_0 src1_sel:DWORD
  s_cmp_lg_u64 vcc, 0
  s_cbranch_scc1 L_fc_72
  s_bitset0_b32 s71, 3
L_fc_72:
  s_cmp_lg_u32 s71, 0
  s_cbranch_scc1 L_f1_p
L_f1_ok:
  v_pk_add_f32 v[136:137], v[136:137], v[144:145]
  v_pk_add_f32 v[138:139], v[138:139], v[146:147]
  v_pk_add_f32 v[152:153], v[152:153], v[160:161]
  v_pk_add_f32 v[154:155], v[154:155], v[162:163]
  v_pk_add_f32 v[136:137], v[136:137], v[152:153]
  v_pk_add_f32 v[138:139], v[138:139], v[154:155]
  v_pk_fma_f32 v[8:9], v[136:137], v[24:25], v[28:29]
  v_pk_fma_f32 v[10:11], v[138:139], v[26:27], v[30:31]
  v_cvt_pk_bf16_f32 v8, v8, v9
  v_cvt_pk_bf16_f32 v9, v10, v11
  ds_write_b64 v12, v[8:9] offset:0
  v_pk_fma_f32 v[16:17], v[136:137], v[20:21], v[16:17]
  v_pk_fma_f32 v[18:19], v[138:139], v[22:23], v[18:19]
  v_add_f32 v24, v16, v17
  v_mul_f32 v25, v16, v16
  v_add_f32 v26, v18, v19
  v_mul_f32 v27, v18, v18
  v_fmac_f32 v25, v17, v17
  v_fmac_f32 v27, v19, v19
  v_pk_add_f32 v[24:25], v[24:25], v[26:27]
  s_nop 1
  v_add_f32_dpp v24, v24, v24 quad_perm:[1,0,3,2] row_mask:0xf bank_mask:0xf
  v_add_f32_dpp v25, v25, v25 quad_perm:[1,0,3,2] row_mask:0xf bank_mask:0xf
  s_nop 0
  v_add_f32_dpp v24, v24, v24 quad_perm:[2,3,0,1] row_mask:0xf bank_mask:0xf
  v_add_f32_dpp v25, v25, v25 quad_perm:[2,3,0,1] row_mask:0xf bank_mask:0xf
  ds_write_b64 v5, v[24:25]
  s_add_u32 s77, s77, 4
  v_mov_b32 v10, 1
  s_mov_b64 exec, 1
  ds_add_u32 v38, v10 offset:6720
  s_mov_b64 exec, -1
  s_mov_b32 s70, 0
L_hy_73:
  ds_read_b32 v10, v38 offset:6720
  ds_read_b128 v[136:139], v14 offset:0
  ds_read_b128 v[140:143], v14 offset:64
  ds_read_b128 v[144:147], v14 offset:128
  ds_read_b128 v[148:151], v14 offset:192
  s_waitcnt lgkmcnt(4)
  v_cmp_gt_u32 vcc, s77, v10
  s_cmp_eq_u64 vcc, 0
  s_cbranch_scc1 L_hyd_74
  s_waitcnt lgkmcnt(0)
  s_add_u32 s70, s70, 1
  s_cmp_lt_u32 s70, 2097152
  s_cbranch_scc1 L_hy_73
L_hyd_74:
  ds_read_b64 v[20:21], v7
  ds_read_b128 v[152:155], v14 offset:256
  ds_read_b128 v[156:159], v14 offset:320
  ds_read_b128 v[160:163], v14 offset:384
  ds_read_b128 v[164:167], v14 offset:448
  s_waitcnt lgkmcnt(8)
  v_mfma_f32_16x16x32_bf16 v[32:35], v[40:43], v[136:139], 0
  s_waitcnt lgkmcnt(7)
  v_mfma_f32_16x16x32_bf16 v[32:35], v[44:47], v[140:143], v[32:35]
  ds_read_b128 v[136:139], v14 offset:512
  s_waitcnt lgkmcnt(7)
  v_mfma_f32_16x16x32_bf16 v[32:35], v[48:51], v[144:147], v[32:35]
  ds_read_b128 v[140:143], v14 offset:576
  s_waitcnt lgkmcnt(7)
  v_mfma_f32_16x16x32_bf16 v[32:35], v[52:55], v[148:151], v[32:35]
  ds_read_b128 v[144:147], v14 offset:640
  s_waitcnt lgkmcnt(6)
  v_mfma_f32_16x16x32_bf16 v[32:35], v[56:59], v[152:155], v[32:35]
  ds_read_b128 v[148:151], v14 offset:704
  v_add_f32_dpp v20, v20, v20 quad_perm:[2,3,0,1] row_mask:0xf bank_mask:0xf
  v_add_f32_dpp v21, v21, v21 quad_perm:[2,3,0,1] row_mask:0xf bank_mask:0xf
  s_waitcnt lgkmcnt(6)
  v_mfma_f32_16x16x32_bf16 v[32:35], v[60:63], v[156:159], v[32:35]
  ds_read_b128 v[152:155], v14 offset:768
  v_add_f32_dpp v20, v20, v20 row_ror:4 row_mask:0xf bank_mask:0xf
  v_add_f32_dpp v21, v21, v21 row_ror:4 row_mask:0xf bank_mask:0xf
  s_waitcnt lgkmcnt(6)
  v_mfma_f32_16x16x32_bf16 v[32:35], v[64:67], v[160:163], v[32:35]
  ds_read_b128 v[156:159], v14 offset:832
  v_add_f32_dpp v20, v20, v20 row_ror:8 row_mask:0xf bank_mask:0xf
  v_add_f32_dpp v21, v21, v21 row_ror:8 row_mask:0xf bank_mask:0xf
  s_waitcnt lgkmcnt(6)
  v_mfma_f32_16x16x32_bf16 v[32:35], v[68:71], v[164:167], v[32:35]
  ds_read_b128 v[160:163], v14 offset:896
  v_mov_b32 v22, v20
  v_mov_b32 v23, v21
  s_waitcnt lgkmcnt(6)
  v_mfma_f32_16x16x32_bf16 v[32:35], v[72:75], v[136:139], v[32:35]
  ds_read_b128 v[164:167], v14 offset:960
  v_permlane16_swap_b32 v22, v20
  v_permlane16_swap_b32 v23, v21
  s_waitcnt lgkmcnt(6)
  v_mfma_f32_16x16x32_bf16 v[32:35], v[76:79], v[140:143], v[32:35]
  v_pk_add_f32 v[20:21], v[20:21], v[22:23]
  v_mov_b32 v22, v20
  v_mov_b32 v23, v21
  s_waitcnt lgkmcnt(5)
  v_mfma_f32_16x16x32_bf16 v[32:35], v[80:83], v[144:147], v[32:35]
  v_permlane32_swap_b32 v22, v20
  v_permlane32_swap_b32 v23, v21
  s_waitcnt lgkmcnt(4)
  v_mfma_f32_16x16x32_bf16 v[32:35], v[84:87], v[148:151], v[32:35]
  v_pk_add_f32 v[20:21], v[20:21], v[22:23]
  v_mul_f32 v20, 0xbb000000, v20
  s_waitcnt lgkmcnt(3)
  v_mfma_f32_16x16x32_bf16 v[32:35], v[88:91], v[152:155], v[32:35]
  v_mul_f32 v21, 0x3b000000, v21
  v_fma_f32 v21, -v20, v20, v21
  s_waitcnt lgkmcnt(2)
  v_mfma_f32_16x16x32_bf16 v[32:35], v[92:95], v[156:159], v[32:35]
  v_max_f32 v21, 0, v21
  v_add_f32 v21, 0x3727c5ac, v21
  s_waitcnt lgkmcnt(1)
  v_mfma_f32_16x16x32_bf16 v[32:35], v[96:99], v[160:163], v[32:35]
  v_rsq_f32 v21, v21
  s_waitcnt lgkmcnt(0)
  v_mfma_f32_16x16x32_bf16 v[32:35], v[100:103], v[164:167], v[32:35]
  ds_read_b64_tr_b16 v[40:41], v6 offset:0
  ds_read_b64_tr_b16 v[42:43], v6 offset:4224
  ds_read_b64_tr_b16 v[44:45], v6 offset:32
  ds_read_b64_tr_b16 v[46:47], v6 offset:4256
  ds_read_b64_tr_b16 v[48:49], v6 offset:64
  ds_read_b64_tr_b16 v[50:51], v6 offset:4288
  ds_read_b64_tr_b16 v[52:53], v6 offset:96
  ds_read_b64_tr_b16 v[54:55], v6 offset:4320
  v_fmac_f32_dpp v32, v32, v20 row_shl:2 row_mask:0xf bank_mask:0x1
  v_fmac_f32_dpp v33, v33, v20 row_shl:2 row_mask:0xf bank_mask:0x1
  v_fmac_f32_dpp v34, v34, v20 row_shl:2 row_mask:0xf bank_mask:0x1
  v_fmac_f32_dpp v35, v35, v20 row_shl:2 row_mask:0xf bank_mask:0x1
  v_mul_f32 v8, v32, v21
  v_mul_f32 v9, v33, v21
  v_mul_f32 v10, v34, v21
  v_mul_f32 v11, v35, v21
  v_add_f32_dpp v8, v32, v8 row_shl:4 row_mask:0xf bank_mask:0xf
  v_add_f32_dpp v9, v33, v9 row_shl:4 row_mask:0xf bank_mask:0xf
  v_add_f32_dpp v10, v34, v10 row_shl:4 row_mask:0xf bank_mask:0xf
  v_add_f32_dpp v11, v35, v11 row_shl:4 row_mask:0xf bank_mask:0xf
  s_waitcnt lgkmcnt(4)
  ds_read_b64_tr_b16 v[56:57], v6 offset:128
  ds_read_b64_tr_b16 v[58:59], v6 offset:4352
  ds_read_b64_tr_b16 v[60:61], v6 offset:160
  ds_read_b64_tr_b16 v[62:63], v6 offset:4384
  ds_read_b64_tr_b16 v[64:65], v6 offset:192
  ds_read_b64_tr_b16 v[66:67], v6 offset:4416
  ds_read_b64_tr_b16 v[68:69], v6 offset:224
  ds_read_b64_tr_b16 v[70:71], v6 offset:4448
  v_permlane32_swap_b32 v8, v10
  v_permlane32_swap_b32 v9, v11
  v_mul_f32 v20, 0xbfb8aa3b, v8
  v_mul_f32 v21, 0xbfb8aa3b, v9
  v_exp_f32 v20, v20
  v_exp_f32 v21, v21
  v_mul_f32 v8, v8, v10
  v_mul_f32 v9, v9, v11
  v_add_f32 v20, 1.0, v20
  v_add_f32 v21, 1.0, v21
  v_rcp_f32 v20, v20
  v_rcp_f32 v21, v21
  s_mov_b32 exec_lo, 0x00030003
  s_mov_b32 exec_hi, 0x00030003
  v_mul_f32 v8, v8, v20
  v_mul_f32 v9, v9, v21
  v_cvt_pk_bf16_f32 v8, v8, v9
  ds_write_b32 v39, v8
  s_mov_b64 exec, -1
  s_waitcnt lgkmcnt(4)
  s_add_u32 s77, s77, 4
  v_mov_b32 v10, 1
  s_mov_b64 exec, 1
  ds_add_u32 v38, v10 offset:6720
  s_mov_b64 exec, -1
  s_mov_b32 s70, 0
L_hy_75:
  ds_read_b32 v10, v38 offset:6720
  ds_read_b128 v[136:139], v37 offset:0
  ds_read_b128 v[140:143], v37 offset:128
  ds_read_b128 v[144:147], v37 offset:256
  ds_read_b128 v[148:151], v37 offset:384
  s_waitcnt lgkmcnt(4)
  v_cmp_gt_u32 vcc, s77, v10
  s_cmp_eq_u64 vcc, 0
  s_cbranch_scc1 L_hyd_76
  s_waitcnt lgkmcnt(0)
  s_add_u32 s70, s70, 1
  s_cmp_lt_u32 s70, 2097152
  s_cbranch_scc1 L_hy_75
L_hyd_76:
  ds_read_b128 v[152:155], v37 offset:512
  ds_read_b128 v[156:159], v37 offset:640
  ds_read_b128 v[160:163], v37 offset:768
  ds_read_b128 v[164:167], v37 offset:896
  v_mov_b32 v3, 0xff
  s_waitcnt lgkmcnt(7)
  v_mfma_f32_16x16x32_bf16 v[8:11], v[40:43], v[136:139], 0
  s_waitcnt lgkmcnt(6)
  v_mfma_f32_16x16x32_bf16 v[8:11], v[44:47], v[140:143], v[8:11]
  s_waitcnt lgkmcnt(5)
  v_mfma_f32_16x16x32_bf16 v[8:11], v[48:51], v[144:147], v[8:11]
  s_waitcnt lgkmcnt(4)
  v_mfma_f32_16x16x32_bf16 v[8:11], v[52:55], v[148:151], v[8:11]
  s_waitcnt lgkmcnt(3)
  v_mfma_f32_16x16x32_bf16 v[8:11], v[56:59], v[152:155], v[8:11]
  s_waitcnt lgkmcnt(2)
  v_mfma_f32_16x16x32_bf16 v[8:11], v[60:63], v[156:159], v[8:11]
  s_waitcnt lgkmcnt(1)
  v_mfma_f32_16x16x32_bf16 v[8:11], v[64:67], v[160:163], v[8:11]
  s_waitcnt lgkmcnt(0)
  v_mfma_f32_16x16x32_bf16 v[8:11], v[68:71], v[164:167], v[8:11]
  s_nop 7
  v_bfi_b32 v8, v3, s32, v8
  v_bfi_b32 v9, v3, s33, v9
  v_bfi_b32 v10, v3, s34, v10
  v_bfi_b32 v11, v3, s35, v11
  global_store_dwordx4 v13, v[8:11], s[42:43] sc1
  s_branch L_fin
L_t_f2:
  s_cmp_lg_u32 s5, 3
  s_cbranch_scc1 L_fin
  global_load_dword v11, v37, s[38:39]
  global_load_dwordx2 v[8:9], v37, s[16:17]
  s_mov_b32 s70, 0
L_pg_77:
  global_load_dwordx4 v[136:139], v39, s[42:43] offset:-4096 sc1
  v_add_u32 v3, 8192, v39
  global_load_dwordx4 v[140:143], v3, s[42:43] sc1
  s_waitcnt vmcnt(0)
  s_mov_b64 vcc, 0
  v_cmp_ne_u32 s[68:69], s74, v137
  s_or_b64 vcc, vcc, s[68:69]
  v_cmp_ne_u32 s[68:69], s74, v139
  s_or_b64 vcc, vcc, s[68:69]
  v_cmp_ne_u32 s[68:69], s74, v141
  s_or_b64 vcc, vcc, s[68:69]
  v_cmp_ne_u32 s[68:69], s74, v143
  s_or_b64 vcc, vcc, s[68:69]
  s_cmp_eq_u64 vcc, 0
  s_cbranch_scc1 L_pge_78
  s_sleep 8
  s_add_u32 s70, s70, 1
  s_cmp_lt_u32 s70, 262144
  s_cbranch_scc1 L_pg_77
L_pge_78:
  v_lshlrev_b32 v16, 16, v8
  v_and_b32 v17, s73, v8
  v_lshlrev_b32 v18, 16, v9
  v_and_b32 v19, s73, v9
  v_lshlrev_b32 v20, 16, v136
  v_and_b32 v21, s73, v136
  v_lshlrev_b32 v22, 16, v138
  v_and_b32 v23, s73, v138
  v_lshlrev_b32 v24, 16, v140
  v_and_b32 v25, s73, v140
  v_lshlrev_b32 v26, 16, v142
  v_and_b32 v27, s73, v142
  s_mov_b32 s70, 0
L_f2_a:
  global_load_dwordx4 v[136:139], v15, s[42:43] sc1
  s_waitcnt vmcnt(0)
  v_xor_b32 v136, s32, v136
  v_xor_b32 v137, s33, v137
  v_xor_b32 v138, s34, v138
  v_xor_b32 v139, s35, v139
  v_or3_b32 v3, v136, v137, v138
  v_or_b32 v3, v3, v139
  v_lshlrev_b32 v3, 24, v3
  v_cmp_ne_u32 vcc, 0, v3
  s_cmp_eq_u64 vcc, 0
  s_cbranch_scc1 L_f2_ad
  s_sleep 8
  s_add_u32 s70, s70, 1
  s_cmp_lt_u32 s70, 262144
  s_cbranch_scc1 L_f2_a
L_f2_ad:
  s_cmp_lg_u32 s61, 0
  s_cbranch_scc1 L_f2_e
  v_mov_b32 v10, s74
  s_mov_b64 exec, 1
  global_store_dword v38, v10, s[42:43] offset:0 sc1
  s_mov_b64 exec, -1
L_f2_e:
  s_nop 1
  v_add_f32_dpp v136, v136, v136 row_ror:8 row_mask:0xf bank_mask:0xf
  v_add_f32_dpp v137, v137, v137 row_ror:8 row_mask:0xf bank_mask:0xf
  v_add_f32_dpp v138, v138, v138 row_ror:8 row_mask:0xf bank_mask:0xf
  v_add_f32_dpp v139, v139, v139 row_ror:8 row_mask:0xf bank_mask:0xf
  v_mov_b32 v140, v136
  v_mov_b32 v141, v137
  v_mov_b32 v142, v138
  v_mov_b32 v143, v139
  v_permlane16_swap_b32 v140, v136
  v_permlane16_swap_b32 v141, v137
  v_permlane16_swap_b32 v142, v138
  v_permlane16_swap_b32 v143, v139
  v_add_f32 v136, v136, v140
  v_add_f32 v137, v137, v141
  v_add_f32 v138, v138, v142
  v_add_f32 v139, v139, v143
  v_mov_b32 v140, v136
  v_mov_b32 v141, v137
  v_mov_b32 v142, v138
  v_mov_b32 v143, v139
  v_permlane32_swap_b32 v140, v136
  v_permlane32_swap_b32 v141, v137
  v_permlane32_swap_b32 v142, v138
  v_permlane32_swap_b32 v143, v139
  v_add_f32 v136, v136, v140
  v_add_f32 v137, v137, v141
  v_add_f32 v138, v138, v142
  v_add_f32 v139, v139, v143
  v_cvt_pk_bf16_f32 v136, 0, v136
  v_cvt_pk_bf16_f32 v137, 0, v137
  v_cvt_pk_bf16_f32 v138, 0, v138
  v_cvt_pk_bf16_f32 v139, 0, v139
  v_mul_f32 v136, v136, v20
  v_mul_f32 v137, v137, v21
  v_mul_f32 v138, v138, v22
  v_mul_f32 v139, v139, v23
  v_cvt_pk_bf16_f32 v136, 0, v136
  v_cvt_pk_bf16_f32 v137, 0, v137
  v_cvt_pk_bf16_f32 v138, 0, v138
  v_cvt_pk_bf16_f32 v139, 0, v139
  v_add_f32 v16, v16, v136
  v_add_f32 v17, v17, v137
  v_add_f32 v18, v18, v138
  v_add_f32 v19, v19, v139
  v_cvt_pk_bf16_f32 v16, 0, v16
  v_cvt_pk_bf16_f32 v17, 0, v17
  v_cvt_pk_bf16_f32 v18, 0, v18
  v_cvt_pk_bf16_f32 v19, 0, v19
  v_mov_b32 v156, s32
  v_mov_b32 v157, s33
  v_mov_b32 v158, s34
  v_mov_b32 v159, s35
  s_mov_b64 s[20:21], -1
  s_mov_b64 s[22:23], -1
  s_mov_b64 s[24:25], -1
  s_mov_b64 s[26:27], -1
  s_mov_b64 s[28:29], -1
  s_mov_b64 s[30:31], 0xffffff
  s_mov_b64 exec, s[20:21]
  global_load_dwordx4 v[136:139], v36, s[42:43] offset:-2048 sc1
  s_mov_b64 exec, s[22:23]
  global_load_dwordx4 v[140:143], v36, s[42:43] offset:-1024 sc1
  s_mov_b64 exec, s[24:25]
  global_load_dwordx4 v[144:147], v36, s[42:43] offset:0 sc1
  s_mov_b64 exec, s[26:27]
  global_load_dwordx4 v[148:151], v36, s[42:43] offset:1024 sc1
  s_mov_b64 exec, s[28:29]
  global_load_dwordx4 v[152:155], v36, s[42:43] offset:2048 sc1
  s_mov_b64 exec, s[30:31]
  global_load_dwordx4 v[156:159], v36, s[42:43] offset:3072 sc1
  s_mov_b64 exec, -1
  s_waitcnt vmcnt(0)
  s_mov_b32 s70, 0
  s_branch L_f2_pc
L_f2_p:
  s_mov_b64 exec, s[20:21]
  global_load_dwordx4 v[136:139], v36, s[42:43] offset:-2048 sc1
  s_mov_b64 exec, s[22:23]
  global_load_dwordx4 v[140:143], v36, s[42:43] offset:-1024 sc1
  s_mov_b64 exec, s[24:25]
  global_load_dwordx4 v[144:147], v36, s[42:43] offset:0 sc1
  s_mov_b64 exec, s[26:27]
  global_load_dwordx4 v[148:151], v36, s[42:43] offset:1024 sc1
  s_mov_b64 exec, s[28:29]
  global_load_dwordx4 v[152:155], v36, s[42:43] offset:2048 sc1
  s_mov_b64 exec, s[30:31]
  global_load_dwordx4 v[156:159], v36, s[42:43] offset:3072 sc1
  s_mov_b64 exec, -1
  s_sleep 2
  s_waitcnt vmcnt(6)
L_f2_pc:
  v_xor_b32 v104, s32, v136
  v_xor_b32 v105, s33, v137
  v_xor_b32 v106, s34, v138
  v_xor_b32 v107, s35, v139
  v_xor_b32 v108, s32, v140
  v_xor_b32 v109, s33, v141
  v_xor_b32 v110, s34, v142
  v_xor_b32 v111, s35, v143
  v_xor_b32 v112, s32, v144
  v_xor_b32 v113, s33, v145
  v_xor_b32 v114, s34, v146
  v_xor_b32 v115, s35, v147
  v_xor_b32 v116, s32, v148
  v_xor_b32 v117, s33, v149
  v_xor_b32 v118, s34, v150
  v_xor_b32 v119, s35, v151
  v_xor_b32 v120, s32, v152
  v_xor_b32 v121, s33, v153
  v_xor_b32 v122, s34, v154
  v_xor_b32 v123, s35, v155
  v_xor_b32 v124, s32, v156
  v_xor_b32 v125, s33, v157
  v_xor_b32 v126, s34, v158
  v_xor_b32 v127, s35, v159
  v_or3_b32 v28, v104, v105, v106
  v_or3_b32 v29, v108, v109, v110
  v_or3_b32 v30, v112, v113, v114
  v_or3_b32 v31, v116, v117, v118
  v_or3_b32 v32, v120, v121, v122
  v_or3_b32 v33, v124, v125, v126
  v_or_b32 v28, v28, v107
  v_or_b32 v29, v29, v111
  v_or_b32 v30, v30, v115
  v_or_b32 v31, v31, v119
  v_or_b32 v32, v32, v123
  v_or_b32 v33, v33, v127
  v_cmp_ne_u32_sdwa s[20:21], v28, v38 src0_sel:BYTE_0 src1_sel:DWORD
  v_cmp_ne_u32_sdwa s[22:23], v29, v38 src0_sel:BYTE_0 src1_sel:DWORD
  v_cmp_ne_u32_sdwa s[24:25], v30, v38 src0_sel:BYTE_0 src1_sel:DWORD
  v_cmp_ne_u32_sdwa s[26:27], v31, v38 src0_sel:BYTE_0 src1_sel:DWORD
  v_cmp_ne_u32_sdwa s[28:29], v32, v38 src0_sel:BYTE_0 src1_sel:DWORD
  v_cmp_ne_u32_sdwa s[30:31], v33, v38 src0_sel:BYTE_0 src1_sel:DWORD
  v_pk_add_f32 v[104:105], v[104:105], v[108:109]
  v_pk_add_f32 v[106:107], v[106:107], v[110:111]
  v_pk_add_f32 v[112:113], v[112:113], v[116:117]
  v_pk_add_f32 v[114:115], v[114:115], v[118:119]
  v_pk_add_f32 v[120:121], v[120:121], v[124:125]
  v_pk_add_f32 v[122:123], v[122:123], v[126:127]
  v_pk_add_f32 v[104:105], v[104:105], v[112:113]
  v_pk_add_f32 v[106:107], v[106:107], v[114:115]
  v_pk_add_f32 v[104:105], v[104:105], v[120:121]
  v_pk_add_f32 v[106:107], v[106:107], v[122:123]
  s_mov_b64 vcc, s[20:21]
  s_or_b64 vcc, vcc, s[22:23]
  s_or_b64 vcc, vcc, s[24:25]
  s_or_b64 vcc, vcc, s[26:27]
  s_or_b64 vcc, vcc, s[28:29]
  s_or_b64 vcc, vcc, s[30:31]
  s_or_b32 s20, s20, 1
  s_or_b32 s22, s22, 1
  s_or_b32 s24, s24, 1
  s_or_b32 s26, s26, 1
  s_or_b32 s28, s28, 1
  s_or_b32 s30, s30, 1
  s_cmp_eq_u64 vcc, 0
  s_cbranch_scc1 L_f2_pok
  s_add_u32 s70, s70, 1
  s_cmp_lt_u32 s70, 262144
  s_cbranch_scc1 L_f2_p
L_f2_pok:
  s_nop 1
  v_add_f32_dpp v104, v104, v104 row_ror:8 row_mask:0xf bank_mask:0xf
  v_add_f32_dpp v105, v105, v105 row_ror:8 row_mask:0xf bank_mask:0xf
  v_add_f32_dpp v106, v106, v106 row_ror:8 row_mask:0xf bank_mask:0xf
  v_add_f32_dpp v107, v107, v107 row_ror:8 row_mask:0xf bank_mask:0xf
  v_mov_b32 v108, v104
  v_mov_b32 v109, v105
  v_mov_b32 v110, v106
  v_mov_b32 v111, v107
  v_permlane16_swap_b32 v108, v104
  v_permlane16_swap_b32 v109, v105
  v_permlane16_swap_b32 v110, v106
  v_permlane16_swap_b32 v111, v107
  v_add_f32 v104, v104, v108
  v_add_f32 v105, v105, v109
  v_add_f32 v106, v106, v110
  v_add_f32 v107, v107, v111
  v_mov_b32 v108, v104
  v_mov_b32 v109, v105
  v_mov_b32 v110, v106
  v_mov_b32 v111, v107
  v_permlane32_swap_b32 v108, v104
  v_permlane32_swap_b32 v109, v105
  v_permlane32_swap_b32 v110, v106
  v_permlane32_swap_b32 v111, v107
  v_add_f32 v104, v104, v108
  v_add_f32 v105, v105, v109
  v_add_f32 v106, v106, v110
  v_add_f32 v107, v107, v111
  v_cvt_pk_bf16_f32 v104, 0, v104
  v_cvt_pk_bf16_f32 v105, 0, v105
  v_cvt_pk_bf16_f32 v106, 0, v106
  v_cvt_pk_bf16_f32 v107, 0, v107
  v_mul_f32 v104, v104, v24
  v_mul_f32 v105, v105, v25
  v_mul_f32 v106, v106, v26
  v_mul_f32 v107, v107, v27
  v_cvt_pk_bf16_f32 v104, 0, v104
  v_cvt_pk_bf16_f32 v105, 0, v105
  v_cvt_pk_bf16_f32 v106, 0, v106
  v_cvt_pk_bf16_f32 v107, 0, v107
  v_add_f32 v8, v104, v16
  v_add_f32 v9, v105, v17
  v_add_f32 v10, v106, v18
  v_add_f32 v11, v107, v19
  v_cvt_pk_bf16_f32 v8, v8, v9
  v_cvt_pk_bf16_f32 v9, v10, v11
  s_mov_b64 exec, 0xff
  global_store_dwordx2 v37, v[8:9], s[38:39] sc1
  s_mov_b64 exec, 1
  v_mov_b32 v10, s74
  s_lshl_b32 s49, s61, 7
  s_add_u32 s49, s49, 28672
  v_mov_b32 v11, s49
  global_store_dword v11, v10, s[42:43] sc1
L_fin:
  s_cmp_lg_u32 s5, 0
  s_cbranch_scc1 L_fin2
  s_mov_b64 exec, -1
  s_mov_b32 s70, 0
L_sn_79:
  ds_read_b32 v8, v38 offset:6708
  s_waitcnt lgkmcnt(0)
  v_cmp_gt_u32 vcc, 0x4, v8
  s_cmp_eq_u64 vcc, 0
  s_cbranch_scc1 L_snd_80
  s_sleep 8
  s_add_u32 s70, s70, 1
  s_cmp_lt_u32 s70, 2097152
  s_cbranch_scc1 L_sn_79
L_snd_80:
  s_waitcnt vmcnt(0)
  v_lshlrev_b32 v72, 3, v1
  ds_read_b128 v[60:63], v38 offset:6784
  ds_read_b128 v[64:67], v38 offset:6800
  ds_read_b128 v[68:71], v38 offset:6816
  ds_read_b64 v[40:41], v72 offset:13056
  ds_read_b64 v[42:43], v72 offset:13568
  ds_read_b64 v[44:45], v72 offset:14080
  ds_read_b64 v[46:47], v72 offset:14592
  ds_read_b64 v[48:49], v72 offset:15104
  ds_read_b64 v[50:51], v72 offset:15616
  ds_read_b64 v[52:53], v72 offset:16128
  ds_read_b64 v[54:55], v72 offset:16640
  ds_read_b64 v[56:57], v72 offset:17152
  ds_read_b64 v[58:59], v72 offset:17664
  s_lshl_b32 s68, s6, 2
  s_add_u32 s68, s68, s7
  s_lshl_b32 s68, s68, 9
  s_add_u32 s68, s68, 131072
  v_add_u32 v72, s68, v72
  v_and_b32 v73, 1, v1
  v_lshlrev_b32 v73, 4, v73
  v_lshrrev_b32 v73, v73, s74
  v_lshrrev_b32 v74, 8, v73
  s_movk_i32 s69, 0xff
  s_waitcnt lgkmcnt(9)
  v_pk_mul_f32 v[40:41], v[40:41], v[60:61] op_sel:[0,0] op_sel_hi:[1,0]
  s_waitcnt lgkmcnt(8)
  v_pk_mul_f32 v[42:43], v[42:43], v[60:61] op_sel:[0,1] op_sel_hi:[1,1]
  s_waitcnt lgkmcnt(7)
  v_pk_fma_f32 v[40:41], v[44:45], v[62:63], v[40:41] op_sel:[0,0,0] op_sel_hi:[1,0,1]
  s_waitcnt lgkmcnt(6)
  v_pk_fma_f32 v[42:43], v[46:47], v[62:63], v[42:43] op_sel:[0,1,0] op_sel_hi:[1,1,1]
  s_waitcnt lgkmcnt(5)
  v_pk_fma_f32 v[40:41], v[48:49], v[64:65], v[40:41] op_sel:[0,0,0] op_sel_hi:[1,0,1]
  s_waitcnt lgkmcnt(4)
  v_pk_fma_f32 v[42:43], v[50:51], v[64:65], v[42:43] op_sel:[0,1,0] op_sel_hi:[1,1,1]
  s_waitcnt lgkmcnt(3)
  v_pk_fma_f32 v[40:41], v[52:53], v[66:67], v[40:41] op_sel:[0,0,0] op_sel_hi:[1,0,1]
  s_waitcnt lgkmcnt(2)
  v_pk_fma_f32 v[42:43], v[54:55], v[66:67], v[42:43] op_sel:[0,1,0] op_sel_hi:[1,1,1]
  s_waitcnt lgkmcnt(1)
  v_pk_fma_f32 v[40:41], v[56:57], v[68:69], v[40:41] op_sel:[0,0,0] op_sel_hi:[1,0,1]
  s_waitcnt lgkmcnt(0)
  v_pk_fma_f32 v[42:43], v[58:59], v[68:69], v[42:43] op_sel:[0,1,0] op_sel_hi:[1,1,1]
  v_pk_add_f32 v[40:41], v[40:41], v[42:43]
  v_bfi_b32 v40, s69, v73, v40
  v_bfi_b32 v41, s69, v74, v41
  global_store_dwordx2 v72, v[40:41], s[42:43] sc1
L_fin2:
L_end:
  s_endpgm
.p2align 7
L_table:
  .long 0xffda000e, 0x10000008, 0x34a34a10, 0, 0xffda0806, 0x10000008, 0x34a34a10, 0
  .long 0xffda1016, 0x10000008, 0x34a34a10, 0, 0xffda1806, 0x10000008, 0x34a34a10, 0
  .long 0xffda2006, 0x10000008, 0x34a34a10, 0, 0xffda2806, 0x10000008, 0x34a34a10, 0
  .long 0xffda3006, 0x10000008, 0x34a34a10, 0, 0xffda3806, 0x10000008, 0x34a34a10, 0
  .long 0xffda010e, 0x10000008, 0x34a34a10, 0, 0xffda0906, 0x10000008, 0x34a34a10, 0
  .long 0xffda1116, 0x10000008, 0x34a34a10, 0, 0xffda1906, 0x10000008, 0x34a34a10, 0
  .long 0xffda2106, 0x10000008, 0x34a34a10, 0, 0xffda2906, 0x10000008, 0x34a34a10, 0
  .long 0xffda3106, 0x10000008, 0x34a34a10, 0, 0xffda3906, 0x10000008, 0x34a34a10, 0
  .long 0xffda020e, 0x10000008, 0x34a34a10, 0, 0xffda0a06, 0x10000008, 0x34a34a10, 0
  .long 0xffda1216, 0x10000008, 0x34a34a10, 0, 0xffda1a06, 0x10000008, 0x34a34a10, 0
  .long 0xffda2206, 0x10000008, 0x34a34a10, 0, 0xffda2a06, 0x10000008, 0x34a34a10, 0
  .long 0xffda3206, 0x10000008, 0x34a34a10, 0, 0xffda3a06, 0x10000008, 0x34a34a10, 0
  .long 0xffda030e, 0x10000008, 0x40540510, 0, 0xffda0b06, 0x10000008, 0x40540510, 0
  .long 0xffda1316, 0x10000008, 0x40540510, 0, 0xffda1b06, 0x10000008, 0x40540510, 0
  .long 0xffda2306, 0x10000008, 0x40540510, 0, 0xffda2b06, 0x10000008, 0x40540510, 0
  .long 0xffda3306, 0x10000008, 0x40540510, 0, 0xffda3b06, 0x10000008, 0x40540510, 0
  .long 0xffda040e, 0x10000008, 0x34a34a10, 0, 0xffda0c06, 0x10000008, 0x34a34a10, 0
  .long 0xffda1416, 0x10000008, 0x34a34a10, 0, 0xffda1c06, 0x10000008, 0x34a34a10, 0
  .long 0xffda2406, 0x10000008, 0x34a34a10, 0, 0xffda2c06, 0x10000008, 0x34a34a10, 0
  .long 0xffda3406, 0x10000008, 0x34a34a10, 0, 0xffda3c06, 0x10000008, 0x34a34a10, 0
  .long 0xffda050e, 0x10000008, 0x34a34a10, 0, 0xffda0d06, 0x10000008, 0x34a34a10, 0
  .long 0xffda1516, 0x10000008, 0x34a34a10, 0, 0xffda1d06, 0x10000008, 0x34a34a10, 0
  .long 0xffda2506, 0x10000008, 0x34a34a10, 0, 0xffda2d06, 0x10000008, 0x34a34a10, 0
  .long 0xffda3506, 0x10000008, 0x34a34a10, 0, 0xffda3d06, 0x10000008, 0x34a34a10, 0
  .long 0xffda060e, 0x10000008, 0x34a34a10, 0, 0xffda0e06, 0x10000008, 0x34a34a10, 0
  .long 0xffda1616, 0x10000008, 0x34a34a10, 0, 0xffda1e06, 0x10000008, 0x34a34a10, 0
  .long 0xffda2606, 0x10000008, 0x34a34a10, 0, 0xffda2e06, 0x10000008, 0x34a34a10, 0
  .long 0xffda3606, 0x10000008, 0x34a34a10, 0, 0xffda3e06, 0x10000008, 0x34a34a10, 0
  .long 0xffda070e, 0x10000008, 0x34a34a10, 0, 0xffda0f06, 0x10000008, 0x34a34a10, 0
  .long 0xffda1716, 0x10000008, 0x34a34a10, 0, 0xffda1f06, 0x10000008, 0x34a34a10, 0
  .long 0xffda2706, 0x10000008, 0x34a34a10, 0, 0xffda2f06, 0x10000008, 0x34a34a10, 0
  .long 0xffda3706, 0x10000008, 0x34a34a10, 0, 0xffda3f06, 0x10000008, 0x34a34a10, 0
  .long 0x004d0009, 0x10000008, 0x32924310, 0, 0x004d0001, 0x10000008, 0x32924310, 0
  .long 0x004d0011, 0x10000008, 0x32924310, 0, 0x004d0001, 0x10000008, 0x32924310, 0
  .long 0x004d0001, 0x10000008, 0x32924310, 0, 0x004d0001, 0x10000008, 0x32924310, 0
  .long 0x004d0001, 0x10000008, 0x32924310, 0, 0x004d0001, 0x10000008, 0x32924310, 0
  .long 0x004d0109, 0x10000008, 0x32924310, 0, 0x004d0101, 0x10000008, 0x32924310, 0
  .long 0x004d0111, 0x10000008, 0x32924310, 0, 0x004d0101, 0x10000008, 0x32924310, 0
  .long 0x004d0101, 0x10000008, 0x32924310, 0, 0x004d0101, 0x10000008, 0x32924310, 0
  .long 0x004d0101, 0x10000008, 0x32924310, 0, 0x004d0101, 0x10000008, 0x32924310, 0
  .long 0x004d0209, 0x10000008, 0x32924310, 0, 0x004d0201, 0x10000008, 0x32924310, 0
  .long 0x004d0211, 0x10000008, 0x32924310, 0, 0x004d0201, 0x10000008, 0x32924310, 0
  .long 0x004d0201, 0x10000008, 0x32924310, 0, 0x004d0201, 0x10000008, 0x32924310, 0
  .long 0x004d0201, 0x10000008, 0x32924310, 0, 0x004d0201, 0x10000008, 0x32924310, 0
  .long 0x00330309, 0x10000008, 0x34325c10, 0, 0x00330301, 0x10000008, 0x34325c10, 0
  .long 0x00330311, 0x10000008, 0x34325c10, 0, 0x00330301, 0x10000008, 0x34325c10, 0
  .long 0x00330301, 0x10000008, 0x34325c10, 0, 0x00330301, 0x10000008, 0x34325c10, 0
  .long 0x00330301, 0x10000008, 0x34325c10, 0, 0x00330301, 0x10000008, 0x34325c10, 0
  .long 0x004d0409, 0x10000008, 0x32924310, 0, 0x004d0401, 0x10000008, 0x32924310, 0
  .long 0x004d0411, 0x10000008, 0x32924310, 0, 0x004d0401, 0x10000008, 0x32924310, 0
  .long 0x004d0401, 0x10000008, 0x32924310, 0, 0x004d0401, 0x10000008, 0x32924310, 0
  .long 0x004d0401, 0x10000008, 0x32924310, 0, 0x004d0401, 0x10000008, 0x32924310, 0
  .long 0x004d0509, 0x10000008, 0x32924310, 0, 0x004d0501, 0x10000008, 0x32924310, 0
  .long 0x004d0511, 0x10000008, 0x32924310, 0, 0x004d0501, 0x10000008, 0x32924310, 0
  .long 0x004d0501, 0x10000008, 0x32924310, 0, 0x004d0501, 0x10000008, 0x32924310, 0
  .long 0x004d0501, 0x10000008, 0x32924310, 0, 0x004d0501, 0x10000008, 0x32924310, 0
  .long 0x004d0609, 0x10000008, 0x32924310, 0, 0x004d0601, 0x10000008, 0x32924310, 0
  .long 0x004d0611, 0x10000008, 0x32924310, 0, 0x004d0601, 0x10000008, 0x32924310, 0
  .long 0x004d0601, 0x10000008, 0x32924310, 0, 0x004d0601, 0x10000008, 0x32924310, 0
  .long 0x004d0601, 0x10000008, 0x32924310, 0, 0x004d0601, 0x10000008, 0x32924310, 0
  .long 0x004d0709, 0x10000008, 0x32924310, 0, 0x004d0701, 0x10000008, 0x32924310, 0
  .long 0x004d0711, 0x10000008, 0x32924310, 0, 0x004d0701, 0x10000008, 0x32924310, 0
  .long 0x004d0701, 0x10000008, 0x32924310, 0, 0x004d0701, 0x10000008, 0x32924310, 0
  .long 0x004d0701, 0x10000008, 0x32924310, 0, 0x004d0701, 0x10000008, 0x32924310, 0
  .long 0x0000030d, 0x10000008, 0x37337310, 0, 0x00000405, 0x10000008, 0x37337310, 0
  .long 0x00000515, 0x10000008, 0x37337310, 0, 0x00000605, 0x10000008, 0x37337310, 0
  .long 0x00000705, 0x10000008, 0x37337310, 0, 0x00000005, 0x10000008, 0x37337310, 0
  .long 0x00000105, 0x10000008, 0x37337310, 0, 0x00000205, 0x10000008, 0x37337310, 0
  .long 0x0000090d, 0x10000008, 0x37337310, 0, 0x00000a05, 0x10000008, 0x37337310, 0
  .long 0x00000b15, 0x10000008, 0x37337310, 0, 0x00000c05, 0x10000008, 0x37337310, 0
  .long 0x00000d05, 0x10000008, 0x37337310, 0, 0x00000e05, 0x10000008, 0x37337310, 0
  .long 0x00000f05, 0x10000008, 0x37337310, 0, 0x00000805, 0x10000008, 0x37337310, 0
  .long 0x0000150c, 0x10000008, 0x32c24510, 0, 0x00001604, 0x10000008, 0x32c24510, 0
  .long 0x00001714, 0x10000008, 0x32c24510, 0, 0x00001004, 0x10000008, 0x32c24510, 0
  .long 0x00001104, 0x10000008, 0x32c24510, 0, 0x00001204, 0x10000008, 0x32c24510, 0
  .long 0x00001304, 0x10000008, 0x38029a10, 0, 0x00001404, 0x10000008, 0x32c24510, 0
  .long 0x00001f0c, 0x10000008, 0x32c24510, 0, 0x00001804, 0x10000008, 0x32c24510, 0
  .long 0x00001914, 0x10000008, 0x32c24510, 0, 0x00001a04, 0x10000008, 0x32c24510, 0
  .long 0x00001b04, 0x10000008, 0x38029a10, 0, 0x00001c04, 0x10000008, 0x32c24510, 0
  .long 0x00001d04, 0x10000008, 0x32c24510, 0, 0x00001e04, 0x10000008, 0x32c24510, 0
  .long 0x0000220c, 0x10000008, 0x32c24510, 0, 0x00002304, 0x10000008, 0x38029a10, 0
  .long 0x00002414, 0x10000008, 0x32c24510, 0, 0x00002504, 0x10000008, 0x32c24510, 0
  .long 0x00002604, 0x10000008, 0x32c24510, 0, 0x00002704, 0x10000008, 0x32c24510, 0
  .long 0x00002004, 0x10000008, 0x32c24510, 0, 0x00002104, 0x10000008, 0x32c24510, 0
  .long 0x00002c0c, 0x10000008, 0x32c24510, 0, 0x00002d04, 0x10000008, 0x32c24510, 0
  .long 0x00002e14, 0x10000008, 0x32c24510, 0, 0x00a60f02, 0x12503f17, 0x3bd2d710, 0
  .long 0x00002804, 0x10000008, 0x32c24510, 0, 0x00a61a02, 0x12503f17, 0x3bd2d710, 0
  .long 0x00a62002, 0x12503f17, 0x3bd2d710, 0, 0x00002b04, 0x10000008, 0x38029a10, 0
  .long 0x0180000a, 0x15503f26, 0x41a33310, 0, 0x01800502, 0x15503f26, 0x41a33310, 0
  .long 0x01800a12, 0x15503f26, 0x41a33310, 0, 0x00a61002, 0x12503f17, 0x3bd2d710, 0
  .long 0x01801502, 0x15503f26, 0x41a33310, 0, 0x00a61b02, 0x12503f17, 0x3bd2d710, 0
  .long 0x00a62102, 0x12503f17, 0x3bd2d710, 0, 0x01802602, 0x15503f26, 0x41a33310, 0
  .long 0x0033000b, 0x0cd35e8a, 0x48039a10, 0, 0x00330403, 0x0cd35e8a, 0x41a33310, 0
  .long 0x00330813, 0x0cd35e8a, 0x48039a10, 0, 0x00330c03, 0x0cd3dd8a, 0x41a33310, 0
  .long 0x00331003, 0x0cd35e8a, 0x41a33310, 0, 0x00331403, 0x0cd3dd8a, 0x41a33310, 0
  .long 0x00331803, 0x0cd3dd8a, 0x41a33310, 0, 0x00331c03, 0x0cd35e8a, 0x41a33310, 0
  .long 0x0180010a, 0x15503f26, 0x41a33310, 0, 0x01800602, 0x15503f26, 0x41a33310, 0
  .long 0x01800b12, 0x15503f26, 0x41a33310, 0, 0x01801102, 0x15503f26, 0x41a33310, 0
  .long 0x01801602, 0x15503f26, 0x41a33310, 0, 0x01801c02, 0x15503f26, 0x41a33310, 0
  .long 0x01802202, 0x15503f26, 0x41a33310, 0, 0x01802702, 0x15503f26, 0x41a33310, 0
  .long 0x0033010b, 0x0cd31c8a, 0x48039a10, 0, 0x00330503, 0x0cd31c8a, 0x41a33310, 0
  .long 0x00330913, 0x0cd31c8a, 0x48039a10, 0, 0x00330d03, 0x0cd31c8a, 0x41a33310, 0
  .long 0x00331103, 0x0cd31c8a, 0x41a33310, 0, 0x00331503, 0x0cd31c8a, 0x41a33310, 0
  .long 0x00331903, 0x0cd31c8a, 0x41a33310, 0, 0x00331d03, 0x0cd31c8a, 0x41a33310, 0
  .long 0x0180020a, 0x15503f26, 0x41a33310, 0, 0x01800702, 0x15503f26, 0x41a33310, 0
  .long 0x01800c12, 0x15503f26, 0x41a33310, 0, 0x01801202, 0x15503f26, 0x41a33310, 0
  .long 0x01801702, 0x15503f26, 0x41a33310, 0, 0x01801d02, 0x15503f26, 0x41a33310, 0
  .long 0x01802302, 0x15503f26, 0x41a33310, 0, 0x01802802, 0x15503f26, 0x41a33310, 0
  .long 0x0033020b, 0x0cd35e8a, 0x48039a10, 0, 0x00330603, 0x0cd35e8a, 0x41a33310, 0
  .long 0x00330a13, 0x0cd35e8a, 0x48039a10, 0, 0x00330e03, 0x0cd35e8a, 0x41a33310, 0
  .long 0x00331203, 0x0cd35e8a, 0x41a33310, 0, 0x00331603, 0x0cd35e8a, 0x41a33310, 0
  .long 0x00331a03, 0x0cd35e8a, 0x41a33310, 0, 0x00331e03, 0x0cd35e8a, 0x41a33310, 0
  .long 0x0180030a, 0x15503f26, 0x41a33310, 0, 0x01800802, 0x15503f26, 0x41a33310, 0
  .long 0x01800d12, 0x15503f26, 0x41a33310, 0, 0x00002f04, 0x10000008, 0x32c24510, 0
  .long 0x01801802, 0x15503f26, 0x41a33310, 0, 0x00002904, 0x10000008, 0x32c24510, 0
  .long 0x00002a04, 0x10000008, 0x32c24510, 0, 0x01802902, 0x15503f26, 0x41a33310, 0
  .long 0x0033030b, 0x0cd31c8a, 0x48039a10, 0, 0x00330703, 0x0cd31c8a, 0x41a33310, 0
  .long 0x00330b13, 0x0cd31c8a, 0x48039a10, 0, 0x00a61302, 0x12503f17, 0x3bd2d710, 0
  .long 0x00331303, 0x0cd31c8a, 0x41a33310, 0, 0x00a61e02, 0x12503f17, 0x3bd2d710, 0
  .long 0x00a62402, 0x12503f17, 0x3bd2d710, 0, 0x00331f03, 0x0cd31c8a, 0x41a33310, 0
  .long 0x0180040a, 0x15503f26, 0x41a33310, 0, 0x01800902, 0x15503f26, 0x41a33310, 0
  .long 0x01800e12, 0x15503f26, 0x41a33310, 0, 0x00a61402, 0x12503f17, 0x3bd2d710, 0
  .long 0x01801902, 0x15503f26, 0x41a33310, 0, 0x00a61f02, 0x12503f17, 0x3bd2d710, 0
  .long 0x00a62502, 0x12503f17, 0x3bd2d710, 0, 0x01802a02, 0x15503f26, 0x41a33310, 0
  .long 0x00330008, 0x0cd35e8a, 0x41a33310, 0, 0x00330000, 0x0cd35e8a, 0x41a33310, 0
  .long 0x00330010, 0x0cd35e8a, 0x41a33310, 0, 0x00330f03, 0x0cd3dd8a, 0x41a33310, 0
  .long 0x00330000, 0x0cd35e8a, 0x41a33310, 0, 0x00331703, 0x0cd3dd8a, 0x41a33310, 0
  .long 0x00331b03, 0x0cd3dd8a, 0x41a33310, 0, 0x00330000, 0x0cd35e8a, 0x41a33310, 0
.section .rodata,"a"
.p2align 6
.amdhsa_kernel adaLN_cond__sliding_block_cached__glu_gated_swiglu__decode_kernel
  .amdhsa_next_free_vgpr 168
  .amdhsa_next_free_sgpr 102
  .amdhsa_accum_offset 168
  .amdhsa_group_segment_fixed_size 0
  .amdhsa_kernarg_size 112
  .amdhsa_user_sgpr_count 2
  .amdhsa_user_sgpr_kernarg_segment_ptr 1
  .amdhsa_system_sgpr_workgroup_id_x 1
.end_amdhsa_kernel
```

```asm
; @launch grid=(256,1,1) block=(768,1,1) lds=143360
.amdgcn_target "amdgcn-amd-amdhsa--gfx950"
.text
.globl adaLN_cond__sliding_block_cached__glu_gated_swiglu__decode_kernel
.p2align 8
.type adaLN_cond__sliding_block_cached__glu_gated_swiglu__decode_kernel,@function
adaLN_cond__sliding_block_cached__glu_gated_swiglu__decode_kernel:
  s_cmp_ge_u32 s2, 256
  s_cbranch_scc1 L_end
  s_load_dwordx16 s[16:31], s[0:1], 0
  s_load_dwordx8 s[32:39], s[0:1], 64
  s_load_dwordx4 s[40:43], s[0:1], 96
  v_lshrrev_b32 v2, 6, v0
  v_and_b32 v1, 63, v0
  v_readfirstlane_b32 s13, v2
  s_bfe_u32 s7, s2, 0x20003
  s_bfe_u32 s6, s2, 0x20005
  s_and_b32 s8, s2, 7
  s_lshl2_add_u32 s6, s8, s6
  s_and_b32 s9, s2, 0x80
  s_lshr_b32 s9, s9, 2
  s_add_u32 s6, s6, s9
  s_mov_b32 s72, 0xfffffffe
  s_mov_b32 s73, 0xffff0000
  s_cmp_eq_u32 s7, 3
  s_cbranch_scc1 L_serv
  s_cmp_eq_u32 s13, 0
  s_cbranch_scc1 L_pub
L_stream:
  s_sub_u32 s9, s13, 1
  s_mul_i32 s10, s7, 3
  s_add_u32 s10, s10, s9
  s_sub_u32 s10, s10, 8
  s_cmp_ge_i32 s10, 8
  s_cbranch_scc1 L_end
  s_cmp_lt_u32 s9, 8
  s_cselect_b32 s11, s9, s10
  s_cselect_b32 s4, s7, 3
  s_lshl_b32 s11, s11, 10
  s_lshl_b32 s4, s4, 18
  s_lshl_b32 s10, s6, 22
  s_add_u32 s10, s10, s4
  s_add_u32 s10, s10, 0x300000
  v_lshl_add_u32 v0, v1, 4, s11
  s_lshr_b32 s12, s2, 3
  s_mul_i32 s12, s12, 5
  s_mul_i32 s15, s8, 3
  s_add_u32 s12, s12, s15
  s_lshl_b32 s12, s12, 13
  s_and_b32 s12, s12, 0x3ffff
  s_waitcnt lgkmcnt(0)
  s_add_u32 s44, s18, s10
  s_addc_u32 s45, s19, 0
  s_mov_b32 s46, 0x40000
  s_mov_b32 s47, 0x20000
  buffer_load_dwordx4 v[40:43], v0, s[44:47], s12 offen nt
  s_add_u32 s12, s12, 0x2000
  s_and_b32 s12, s12, 0x3ffff
  buffer_load_dwordx4 v[44:47], v0, s[44:47], s12 offen nt
  s_add_u32 s12, s12, 0x2000
  s_and_b32 s12, s12, 0x3ffff
  buffer_load_dwordx4 v[48:51], v0, s[44:47], s12 offen nt
  s_add_u32 s12, s12, 0x2000
  s_and_b32 s12, s12, 0x3ffff
  s_load_dword s74, s[42:43], 0
  s_add_u32 s48, s20, s10
  s_addc_u32 s49, s21, 0
  s_mov_b32 s50, 0x40000
  s_mov_b32 s51, 0x20000
  s_mov_b32 s52, 0xcccccccc
  s_mov_b32 s53, 0xcccccccc
  s_mov_b32 s54, 0xaaaaaaaa
  s_mov_b32 s55, 0xaaaaaaaa
  v_and_b32 v38, 15, v1
  v_lshlrev_b32 v38, 4, v38
  s_lshl_b32 s10, s9, 11
  s_add_u32 s10, s10, 12288
  v_lshl_add_u32 v3, v1, 3, s10
  v_mov_b32 v4, 0x7fff0000
  v_mov_b32 v5, 0xff800000
  ds_write_b64 v3, v[4:5] offset:0
  ds_write_b64 v3, v[4:5] offset:512
  ds_write_b64 v3, v[4:5] offset:1024
  v_lshrrev_b32 v3, 4, v1
  v_lshl_add_u32 v39, v38, 1, s10
  v_lshl_add_u32 v39, v3, 3, v39
  s_sub_u32 s68, s12, 24576
  v_bfrev_b32 v24, v1
  v_lshrrev_b32 v24, 15, v24
  v_and_b32 v24, 0x1e000, v24
  v_add_u32 v24, s68, v24
  v_and_b32 v24, 0x3e000, v24
  v_lshl_add_u32 v24, v3, 8, v24
  v_add_u32 v24, s11, v24
  v_xor_b32 v26, 0x20000, v24
  s_lshl_b32 s11, s9, 9
  s_sub_u32 s11, s11, s10
  s_mov_b32 s32, 3
  s_mul_i32 s33, s9, 96
  s_add_u32 s33, s33, 16
  s_mov_b64 s[64:65], 0
  s_mov_b64 s[66:67], 0
  s_mov_b32 s38, 0
  s_mov_b32 s39, 0
  s_mov_b32 s75, 0
  s_mov_b32 s61, 0
  s_lshl3_add_u32 s40, s6, s9
  s_lshl_b32 s40, s40, 6
  s_add_u32 s40, s40, 32768
  s_barrier
  s_waitcnt lgkmcnt(0)
  s_mov_b32 s56, s10
  s_mul_i32 s74, s74, 0x9e3779b1
  s_add_u32 s74, s74, 0x7f4a7c15
  s_cmp_eq_u32 s7, 2
  s_cselect_b32 s76, 10, 11
  s_mov_b32 s41, 5
  s_mov_b32 s34, 742
  s_mov_b32 s35, 29
  s_mov_b32 s59, 0
  s_mul_i32 s68, s76, 29
  s_add_u32 s68, s68, 1024
  v_mov_b32 v22, s68
  v_mov_b32 v23, 0
  v_mov_b32 v2, 0
  s_cmp_ge_u32 s9, 8
  s_cselect_b32 s39, 2, 0
  s_call_b64 s[62:63], L_kq
  buffer_load_dwordx4 v[52:55], v0, s[44:47], s12 offen nt
  s_add_u32 s12, s12, 0x2000
  s_and_b32 s12, s12, 0x3ffff
  s_call_b64 s[62:63], L_kq
  buffer_load_dwordx4 v[56:59], v0, s[44:47], s12 offen nt
  s_add_u32 s12, s12, 0x2000
  s_and_b32 s12, s12, 0x3ffff
  s_call_b64 s[62:63], L_kq
  buffer_load_dwordx4 v[60:63], v0, s[44:47], s12 offen nt
  s_add_u32 s12, s12, 0x2000
  s_and_b32 s12, s12, 0x3ffff
  s_call_b64 s[62:63], L_kq
  buffer_load_dwordx4 v[64:67], v0, s[44:47], s12 offen nt
  s_add_u32 s12, s12, 0x2000
  s_and_b32 s12, s12, 0x3ffff
  s_call_b64 s[62:63], L_kq
  buffer_load_dwordx4 v[68:71], v0, s[44:47], s12 offen nt
  s_add_u32 s12, s12, 0x2000
  s_and_b32 s12, s12, 0x3ffff
  s_call_b64 s[62:63], L_kq
  buffer_load_dwordx4 v[72:75], v0, s[44:47], s12 offen nt
  s_add_u32 s12, s12, 0x2000
  s_and_b32 s12, s12, 0x3ffff
  s_call_b64 s[62:63], L_kq
  buffer_load_dwordx4 v[76:79], v0, s[44:47], s12 offen nt
  s_add_u32 s12, s12, 0x2000
  s_and_b32 s12, s12, 0x3ffff
  s_call_b64 s[62:63], L_kq
  buffer_load_dwordx4 v[80:83], v0, s[44:47], s12 offen nt
  s_add_u32 s12, s12, 0x2000
  s_and_b32 s12, s12, 0x3ffff
  s_call_b64 s[62:63], L_kq
  buffer_load_dwordx4 v[84:87], v0, s[44:47], s12 offen nt
  s_add_u32 s12, s12, 0x2000
  s_and_b32 s12, s12, 0x3ffff
  s_call_b64 s[62:63], L_kq
  buffer_load_dwordx4 v[88:91], v0, s[44:47], s12 offen nt
  s_add_u32 s12, s12, 0x2000
  s_and_b32 s12, s12, 0x3ffff
  s_call_b64 s[62:63], L_ks
  buffer_load_dwordx4 v[92:95], v0, s[44:47], s12 offen nt
  s_add_u32 s12, s12, 0x2000
  s_and_b32 s12, s12, 0x3ffff
  s_call_b64 s[62:63], L_ks
  buffer_load_dwordx4 v[96:99], v0, s[44:47], s12 offen nt
  s_add_u32 s12, s12, 0x2000
  s_and_b32 s12, s12, 0x3ffff
  s_call_b64 s[62:63], L_ks
  buffer_load_dwordx4 v[100:103], v0, s[44:47], s12 offen nt
  s_add_u32 s12, s12, 0x2000
  s_and_b32 s12, s12, 0x3ffff
  s_call_b64 s[62:63], L_ks
  buffer_load_dwordx4 v[104:107], v0, s[44:47], s12 offen nt
  s_add_u32 s12, s12, 0x2000
  s_and_b32 s12, s12, 0x3ffff
  s_call_b64 s[62:63], L_ks
  buffer_load_dwordx4 v[108:111], v0, s[44:47], s12 offen nt
  s_add_u32 s12, s12, 0x2000
  s_and_b32 s12, s12, 0x3ffff
  s_call_b64 s[62:63], L_ks
  buffer_load_dwordx4 v[112:115], v0, s[44:47], s12 offen nt
  s_add_u32 s12, s12, 0x2000
  s_and_b32 s12, s12, 0x3ffff
  s_call_b64 s[62:63], L_ks
  buffer_load_dwordx4 v[116:119], v0, s[44:47], s12 offen nt
  s_add_u32 s12, s12, 0x2000
  s_and_b32 s12, s12, 0x3ffff
  s_call_b64 s[62:63], L_ks
  buffer_load_dwordx4 v[120:123], v0, s[44:47], s12 offen nt
  s_add_u32 s12, s12, 0x2000
  s_and_b32 s12, s12, 0x3ffff
  s_call_b64 s[62:63], L_ks
  buffer_load_dwordx4 v[124:127], v0, s[44:47], s12 offen nt
  s_add_u32 s12, s12, 0x2000
  s_and_b32 s12, s12, 0x3ffff
  s_call_b64 s[62:63], L_ks
  buffer_load_dwordx4 v[128:131], v0, s[44:47], s12 offen nt
  s_add_u32 s12, s12, 0x2000
  s_and_b32 s12, s12, 0x3ffff
  s_call_b64 s[62:63], L_ks
  buffer_load_dwordx4 v[132:135], v0, s[44:47], s12 offen nt
  s_add_u32 s12, s12, 0x2000
  s_and_b32 s12, s12, 0x3ffff
  s_call_b64 s[62:63], L_ks
  buffer_load_dwordx4 v[136:139], v0, s[44:47], s12 offen nt
  s_add_u32 s12, s12, 0x2000
  s_and_b32 s12, s12, 0x3ffff
  s_call_b64 s[62:63], L_ks
  buffer_load_dwordx4 v[140:143], v0, s[44:47], s12 offen nt
  s_add_u32 s12, s12, 0x2000
  s_and_b32 s12, s12, 0x3ffff
  s_call_b64 s[62:63], L_ks
  buffer_load_dwordx4 v[144:147], v0, s[44:47], s12 offen nt
  s_add_u32 s12, s12, 0x2000
  s_and_b32 s12, s12, 0x3ffff
  s_call_b64 s[62:63], L_ks
  buffer_load_dwordx4 v[148:151], v0, s[44:47], s12 offen nt
  s_add_u32 s12, s12, 0x2000
  s_and_b32 s12, s12, 0x3ffff
  s_call_b64 s[62:63], L_ks
  buffer_load_dwordx4 v[152:155], v0, s[44:47], s12 offen nt
  s_add_u32 s12, s12, 0x2000
  s_and_b32 s12, s12, 0x3ffff
  s_call_b64 s[62:63], L_ks
  buffer_load_dwordx4 v[156:159], v0, s[44:47], s12 offen nt
  s_add_u32 s12, s12, 0x2000
  s_and_b32 s12, s12, 0x3ffff
  s_call_b64 s[62:63], L_ks
  buffer_load_dwordx4 v[160:163], v0, s[44:47], s12 offen nt
  s_add_u32 s12, s12, 0x2000
  s_and_b32 s12, s12, 0x3ffff
  s_call_b64 s[62:63], L_ks
  buffer_load_dwordx4 v[164:167], v0, s[44:47], s12 offen nt
  s_add_u32 s12, s12, 0x2000
  s_and_b32 s12, s12, 0x3ffff
  s_mov_b32 s10, 0
L_kw:
  s_cmp_ge_u32 s39, 4
  s_cbranch_scc1 L_v0
  s_call_b64 s[100:101], L_work
  s_sleep 1
  s_add_u32 s10, s10, 1
  s_cmp_lt_u32 s10, 262144
  s_cbranch_scc1 L_kw
L_v0:
  s_mov_b32 s32, 0
  s_mov_b32 s37, 255
  v_mov_b32 v2, 8
  s_mov_b32 s35, s59
  ds_read_b64 v[22:23], v2 offset:288
  s_waitcnt lgkmcnt(0)
  v_readfirstlane_b32 s34, v22
  s_mul_i32 s34, s34, 64
  s_ashr_i32 s34, s34, 4
  s_add_i32 s34, s34, -4147
  s_mul_i32 s68, s34, 13
  s_ashr_i32 s68, s68, 8
  s_cmp_eq_u32 s7, 2
  s_cselect_b32 s68, s68, 0
  s_add_i32 s34, s34, s68
  s_call_b64 s[62:63], L_vs
  s_cbranch_scc1 L_nl0
  v_add_u32_dpp v3, v28, v38 row_newbcast:0 row_mask:0xf bank_mask:0xf
  buffer_load_dwordx4 v[40:43], v3, s[48:51], 0 offen nt
L_nl0:
  v_dot2_f32_bf16 v8, v104, v4, 0
  v_dot2_f32_bf16 v9, v108, v4, 0
  v_dot2_f32_bf16 v10, v112, v4, 0
  v_dot2_f32_bf16 v11, v116, v4, 0
  v_dot2_f32_bf16 v12, v120, v4, 0
  v_dot2_f32_bf16 v13, v124, v4, 0
  v_dot2_f32_bf16 v14, v128, v4, 0
  v_dot2_f32_bf16 v15, v132, v4, 0
  v_dot2_f32_bf16 v8, v105, v5, v8
  v_dot2_f32_bf16 v9, v109, v5, v9
  v_dot2_f32_bf16 v10, v113, v5, v10
  v_dot2_f32_bf16 v11, v117, v5, v11
  v_dot2_f32_bf16 v12, v121, v5, v12
  v_dot2_f32_bf16 v13, v125, v5, v13
  v_dot2_f32_bf16 v14, v129, v5, v14
  v_dot2_f32_bf16 v15, v133, v5, v15
  v_dot2_f32_bf16 v8, v106, v6, v8
  v_dot2_f32_bf16 v9, v110, v6, v9
  v_dot2_f32_bf16 v10, v114, v6, v10
  v_dot2_f32_bf16 v11, v118, v6, v11
  v_dot2_f32_bf16 v12, v122, v6, v12
  v_dot2_f32_bf16 v13, v126, v6, v13
  v_dot2_f32_bf16 v14, v130, v6, v14
  v_dot2_f32_bf16 v15, v134, v6, v15
  v_dot2_f32_bf16 v8, v107, v7, v8
  v_dot2_f32_bf16 v9, v111, v7, v9
  v_dot2_f32_bf16 v10, v115, v7, v10
  v_dot2_f32_bf16 v11, v119, v7, v11
  v_dot2_f32_bf16 v12, v123, v7, v12
  v_dot2_f32_bf16 v13, v127, v7, v13
  v_dot2_f32_bf16 v14, v131, v7, v14
  v_dot2_f32_bf16 v15, v135, v7, v15
  v_add_f32_dpp v8, v8, v8 row_ror:8 row_mask:0xf bank_mask:0x3
  v_add_f32_dpp v8, v9, v9 row_ror:8 row_mask:0xf bank_mask:0xc
  v_add_f32_dpp v10, v10, v10 row_ror:8 row_mask:0xf bank_mask:0x3
  v_add_f32_dpp v10, v11, v11 row_ror:8 row_mask:0xf bank_mask:0xc
  v_add_f32_dpp v12, v12, v12 row_ror:8 row_mask:0xf bank_mask:0x3
  v_add_f32_dpp v12, v13, v13 row_ror:8 row_mask:0xf bank_mask:0xc
  v_add_f32_dpp v14, v14, v14 row_ror:8 row_mask:0xf bank_mask:0x3
  v_add_f32_dpp v14, v15, v15 row_ror:8 row_mask:0xf bank_mask:0xc
  v_add_f32_dpp v16, v8, v8 row_shl:4 row_mask:0xf bank_mask:0x5
  v_add_f32_dpp v16, v10, v10 row_shr:4 row_mask:0xf bank_mask:0xa
  v_add_f32_dpp v17, v12, v12 row_shl:4 row_mask:0xf bank_mask:0x5
  v_add_f32_dpp v17, v14, v14 row_shr:4 row_mask:0xf bank_mask:0xa
  s_call_b64 s[62:63], L_vs
  s_cbranch_scc1 L_nl1
  v_add_u32_dpp v3, v28, v38 row_newbcast:1 row_mask:0xf bank_mask:0xf
  buffer_load_dwordx4 v[44:47], v3, s[48:51], 0 offen nt
L_nl1:
  s_call_b64 s[62:63], L_vs
  s_cbranch_scc1 L_nl2
  v_add_u32_dpp v3, v28, v38 row_newbcast:2 row_mask:0xf bank_mask:0xf
  buffer_load_dwordx4 v[48:51], v3, s[48:51], 0 offen nt
L_nl2:
  s_call_b64 s[62:63], L_vs
  s_cbranch_scc1 L_nl3
  v_add_u32_dpp v3, v28, v38 row_newbcast:3 row_mask:0xf bank_mask:0xf
  buffer_load_dwordx4 v[52:55], v3, s[48:51], 0 offen nt
L_nl3:
  s_call_b64 s[62:63], L_vs
  s_cbranch_scc1 L_nl4
  v_add_u32_dpp v3, v28, v38 row_newbcast:4 row_mask:0xf bank_mask:0xf
  buffer_load_dwordx4 v[56:59], v3, s[48:51], 0 offen nt
L_nl4:
  s_call_b64 s[62:63], L_vs
  s_cbranch_scc1 L_nl5
  v_add_u32_dpp v3, v28, v38 row_newbcast:5 row_mask:0xf bank_mask:0xf
  buffer_load_dwordx4 v[60:63], v3, s[48:51], 0 offen nt
L_nl5:
  v_dot2c_f32_bf16_dpp v8, v29, v40 row_newbcast:0 row_mask:0xf bank_mask:0xf
  v_dot2c_f32_bf16_dpp v9, v34, v40 row_newbcast:0 row_mask:0xf bank_mask:0xf
  v_dot2c_f32_bf16_dpp v10, v29, v41 row_newbcast:0 row_mask:0xf bank_mask:0xf
  v_dot2c_f32_bf16_dpp v11, v34, v41 row_newbcast:0 row_mask:0xf bank_mask:0xf
  v_dot2c_f32_bf16_dpp v12, v29, v42 row_newbcast:0 row_mask:0xf bank_mask:0xf
  v_dot2c_f32_bf16_dpp v13, v34, v42 row_newbcast:0 row_mask:0xf bank_mask:0xf
  v_dot2c_f32_bf16_dpp v14, v29, v43 row_newbcast:0 row_mask:0xf bank_mask:0xf
  v_dot2c_f32_bf16_dpp v15, v34, v43 row_newbcast:0 row_mask:0xf bank_mask:0xf
  s_cmp_eq_u32 s75, 6
  s_cbranch_scc1 L_epi
  s_call_b64 s[62:63], L_vs
  s_cbranch_scc1 L_nl6
  v_add_u32_dpp v3, v28, v38 row_newbcast:6 row_mask:0xf bank_mask:0xf
  buffer_load_dwordx4 v[64:67], v3, s[48:51], 0 offen nt
L_nl6:
  v_dot2c_f32_bf16_dpp v8, v29, v44 row_newbcast:1 row_mask:0xf bank_mask:0xf
  v_dot2c_f32_bf16_dpp v9, v34, v44 row_newbcast:1 row_mask:0xf bank_mask:0xf
  v_dot2c_f32_bf16_dpp v10, v29, v45 row_newbcast:1 row_mask:0xf bank_mask:0xf
  v_dot2c_f32_bf16_dpp v11, v34, v45 row_newbcast:1 row_mask:0xf bank_mask:0xf
  v_dot2c_f32_bf16_dpp v12, v29, v46 row_newbcast:1 row_mask:0xf bank_mask:0xf
  v_dot2c_f32_bf16_dpp v13, v34, v46 row_newbcast:1 row_mask:0xf bank_mask:0xf
  v_dot2c_f32_bf16_dpp v14, v29, v47 row_newbcast:1 row_mask:0xf bank_mask:0xf
  v_dot2c_f32_bf16_dpp v15, v34, v47 row_newbcast:1 row_mask:0xf bank_mask:0xf
  s_cmp_eq_u32 s75, 7
  s_cbranch_scc1 L_epi
  s_call_b64 s[62:63], L_vs
  s_cbranch_scc1 L_nl7
  v_add_u32_dpp v3, v28, v38 row_newbcast:7 row_mask:0xf bank_mask:0xf
  buffer_load_dwordx4 v[68:71], v3, s[48:51], 0 offen nt
L_nl7:
  v_dot2c_f32_bf16_dpp v8, v29, v48 row_newbcast:2 row_mask:0xf bank_mask:0xf
  v_dot2c_f32_bf16_dpp v9, v34, v48 row_newbcast:2 row_mask:0xf bank_mask:0xf
  v_dot2c_f32_bf16_dpp v10, v29, v49 row_newbcast:2 row_mask:0xf bank_mask:0xf
  v_dot2c_f32_bf16_dpp v11, v34, v49 row_newbcast:2 row_mask:0xf bank_mask:0xf
  v_dot2c_f32_bf16_dpp v12, v29, v50 row_newbcast:2 row_mask:0xf bank_mask:0xf
  v_dot2c_f32_bf16_dpp v13, v34, v50 row_newbcast:2 row_mask:0xf bank_mask:0xf
  v_dot2c_f32_bf16_dpp v14, v29, v51 row_newbcast:2 row_mask:0xf bank_mask:0xf
  v_dot2c_f32_bf16_dpp v15, v34, v51 row_newbcast:2 row_mask:0xf bank_mask:0xf
  s_cmp_eq_u32 s75, 8
  s_cbranch_scc1 L_epi
  s_call_b64 s[62:63], L_vs
  s_cbranch_scc1 L_nl8
  v_add_u32_dpp v3, v28, v38 row_newbcast:8 row_mask:0xf bank_mask:0xf
  buffer_load_dwordx4 v[72:75], v3, s[48:51], 0 offen nt
L_nl8:
  v_dot2c_f32_bf16_dpp v8, v29, v52 row_newbcast:3 row_mask:0xf bank_mask:0xf
  v_dot2c_f32_bf16_dpp v9, v34, v52 row_newbcast:3 row_mask:0xf bank_mask:0xf
  v_dot2c_f32_bf16_dpp v10, v29, v53 row_newbcast:3 row_mask:0xf bank_mask:0xf
  v_dot2c_f32_bf16_dpp v11, v34, v53 row_newbcast:3 row_mask:0xf bank_mask:0xf
  v_dot2c_f32_bf16_dpp v12, v29, v54 row_newbcast:3 row_mask:0xf bank_mask:0xf
  v_dot2c_f32_bf16_dpp v13, v34, v54 row_newbcast:3 row_mask:0xf bank_mask:0xf
  v_dot2c_f32_bf16_dpp v14, v29, v55 row_newbcast:3 row_mask:0xf bank_mask:0xf
  v_dot2c_f32_bf16_dpp v15, v34, v55 row_newbcast:3 row_mask:0xf bank_mask:0xf
  s_cmp_eq_u32 s75, 9
  s_cbranch_scc1 L_epi
  s_call_b64 s[62:63], L_vs
  s_cbranch_scc1 L_nl9
  v_add_u32_dpp v3, v28, v38 row_newbcast:9 row_mask:0xf bank_mask:0xf
  buffer_load_dwordx4 v[76:79], v3, s[48:51], 0 offen nt
L_nl9:
  v_dot2c_f32_bf16_dpp v8, v29, v56 row_newbcast:4 row_mask:0xf bank_mask:0xf
  v_dot2c_f32_bf16_dpp v9, v34, v56 row_newbcast:4 row_mask:0xf bank_mask:0xf
  v_dot2c_f32_bf16_dpp v10, v29, v57 row_newbcast:4 row_mask:0xf bank_mask:0xf
  v_dot2c_f32_bf16_dpp v11, v34, v57 row_newbcast:4 row_mask:0xf bank_mask:0xf
  v_dot2c_f32_bf16_dpp v12, v29, v58 row_newbcast:4 row_mask:0xf bank_mask:0xf
  v_dot2c_f32_bf16_dpp v13, v34, v58 row_newbcast:4 row_mask:0xf bank_mask:0xf
  v_dot2c_f32_bf16_dpp v14, v29, v59 row_newbcast:4 row_mask:0xf bank_mask:0xf
  v_dot2c_f32_bf16_dpp v15, v34, v59 row_newbcast:4 row_mask:0xf bank_mask:0xf
  s_cmp_eq_u32 s75, 10
  s_cbranch_scc1 L_epi
  s_call_b64 s[62:63], L_vs
  s_cbranch_scc1 L_nl10
  v_add_u32_dpp v3, v28, v38 row_newbcast:10 row_mask:0xf bank_mask:0xf
  buffer_load_dwordx4 v[80:83], v3, s[48:51], 0 offen nt
L_nl10:
  v_dot2c_f32_bf16_dpp v8, v29, v60 row_newbcast:5 row_mask:0xf bank_mask:0xf
  v_dot2c_f32_bf16_dpp v9, v34, v60 row_newbcast:5 row_mask:0xf bank_mask:0xf
  v_dot2c_f32_bf16_dpp v10, v29, v61 row_newbcast:5 row_mask:0xf bank_mask:0xf
  v_dot2c_f32_bf16_dpp v11, v34, v61 row_newbcast:5 row_mask:0xf bank_mask:0xf
  v_dot2c_f32_bf16_dpp v12, v29, v62 row_newbcast:5 row_mask:0xf bank_mask:0xf
  v_dot2c_f32_bf16_dpp v13, v34, v62 row_newbcast:5 row_mask:0xf bank_mask:0xf
  v_dot2c_f32_bf16_dpp v14, v29, v63 row_newbcast:5 row_mask:0xf bank_mask:0xf
  v_dot2c_f32_bf16_dpp v15, v34, v63 row_newbcast:5 row_mask:0xf bank_mask:0xf
  s_cmp_eq_u32 s75, 11
  s_cbranch_scc1 L_epi
  s_call_b64 s[62:63], L_vq
  s_cbranch_scc1 L_nl11
  v_add_u32_dpp v3, v28, v38 row_newbcast:11 row_mask:0xf bank_mask:0xf
  buffer_load_dwordx4 v[84:87], v3, s[48:51], 0 offen nt
L_nl11:
  v_dot2c_f32_bf16_dpp v8, v29, v64 row_newbcast:6 row_mask:0xf bank_mask:0xf
  v_dot2c_f32_bf16_dpp v9, v34, v64 row_newbcast:6 row_mask:0xf bank_mask:0xf
  v_dot2c_f32_bf16_dpp v10, v29, v65 row_newbcast:6 row_mask:0xf bank_mask:0xf
  v_dot2c_f32_bf16_dpp v11, v34, v65 row_newbcast:6 row_mask:0xf bank_mask:0xf
  v_dot2c_f32_bf16_dpp v12, v29, v66 row_newbcast:6 row_mask:0xf bank_mask:0xf
  v_dot2c_f32_bf16_dpp v13, v34, v66 row_newbcast:6 row_mask:0xf bank_mask:0xf
  v_dot2c_f32_bf16_dpp v14, v29, v67 row_newbcast:6 row_mask:0xf bank_mask:0xf
  v_dot2c_f32_bf16_dpp v15, v34, v67 row_newbcast:6 row_mask:0xf bank_mask:0xf
  s_cmp_eq_u32 s75, 12
  s_cbranch_scc1 L_epi
  s_call_b64 s[62:63], L_vq
  s_cbranch_scc1 L_nl12
  v_add_u32_dpp v3, v28, v38 row_newbcast:12 row_mask:0xf bank_mask:0xf
  buffer_load_dwordx4 v[88:91], v3, s[48:51], 0 offen nt
L_nl12:
  v_dot2c_f32_bf16_dpp v8, v29, v68 row_newbcast:7 row_mask:0xf bank_mask:0xf
  v_dot2c_f32_bf16_dpp v9, v34, v68 row_newbcast:7 row_mask:0xf bank_mask:0xf
  v_dot2c_f32_bf16_dpp v10, v29, v69 row_newbcast:7 row_mask:0xf bank_mask:0xf
  v_dot2c_f32_bf16_dpp v11, v34, v69 row_newbcast:7 row_mask:0xf bank_mask:0xf
  v_dot2c_f32_bf16_dpp v12, v29, v70 row_newbcast:7 row_mask:0xf bank_mask:0xf
  v_dot2c_f32_bf16_dpp v13, v34, v70 row_newbcast:7 row_mask:0xf bank_mask:0xf
  v_dot2c_f32_bf16_dpp v14, v29, v71 row_newbcast:7 row_mask:0xf bank_mask:0xf
  v_dot2c_f32_bf16_dpp v15, v34, v71 row_newbcast:7 row_mask:0xf bank_mask:0xf
  s_cmp_eq_u32 s75, 13
  s_cbranch_scc1 L_epi
  s_call_b64 s[62:63], L_vq
  s_cbranch_scc1 L_nl13
  v_add_u32_dpp v3, v28, v38 row_newbcast:13 row_mask:0xf bank_mask:0xf
  buffer_load_dwordx4 v[92:95], v3, s[48:51], 0 offen nt
L_nl13:
  v_dot2c_f32_bf16_dpp v8, v29, v72 row_newbcast:8 row_mask:0xf bank_mask:0xf
  v_dot2c_f32_bf16_dpp v9, v34, v72 row_newbcast:8 row_mask:0xf bank_mask:0xf
  v_dot2c_f32_bf16_dpp v10, v29, v73 row_newbcast:8 row_mask:0xf bank_mask:0xf
  v_dot2c_f32_bf16_dpp v11, v34, v73 row_newbcast:8 row_mask:0xf bank_mask:0xf
  v_dot2c_f32_bf16_dpp v12, v29, v74 row_newbcast:8 row_mask:0xf bank_mask:0xf
  v_dot2c_f32_bf16_dpp v13, v34, v74 row_newbcast:8 row_mask:0xf bank_mask:0xf
  v_dot2c_f32_bf16_dpp v14, v29, v75 row_newbcast:8 row_mask:0xf bank_mask:0xf
  v_dot2c_f32_bf16_dpp v15, v34, v75 row_newbcast:8 row_mask:0xf bank_mask:0xf
  s_cmp_eq_u32 s75, 14
  s_cbranch_scc1 L_epi
  s_call_b64 s[62:63], L_vq
  s_cbranch_scc1 L_nl14
  v_add_u32_dpp v3, v28, v38 row_newbcast:14 row_mask:0xf bank_mask:0xf
  buffer_load_dwordx4 v[96:99], v3, s[48:51], 0 offen nt
L_nl14:
  v_dot2c_f32_bf16_dpp v8, v29, v76 row_newbcast:9 row_mask:0xf bank_mask:0xf
  v_dot2c_f32_bf16_dpp v9, v34, v76 row_newbcast:9 row_mask:0xf bank_mask:0xf
  v_dot2c_f32_bf16_dpp v10, v29, v77 row_newbcast:9 row_mask:0xf bank_mask:0xf
  v_dot2c_f32_bf16_dpp v11, v34, v77 row_newbcast:9 row_mask:0xf bank_mask:0xf
  v_dot2c_f32_bf16_dpp v12, v29, v78 row_newbcast:9 row_mask:0xf bank_mask:0xf
  v_dot2c_f32_bf16_dpp v13, v34, v78 row_newbcast:9 row_mask:0xf bank_mask:0xf
  v_dot2c_f32_bf16_dpp v14, v29, v79 row_newbcast:9 row_mask:0xf bank_mask:0xf
  v_dot2c_f32_bf16_dpp v15, v34, v79 row_newbcast:9 row_mask:0xf bank_mask:0xf
  s_cmp_eq_u32 s75, 15
  s_cbranch_scc1 L_epi
  s_call_b64 s[62:63], L_vq
  s_cbranch_scc1 L_nl15
  v_add_u32_dpp v3, v28, v38 row_newbcast:15 row_mask:0xf bank_mask:0xf
  buffer_load_dwordx4 v[100:103], v3, s[48:51], 0 offen nt
L_nl15:
  v_dot2c_f32_bf16_dpp v8, v29, v80 row_newbcast:10 row_mask:0xf bank_mask:0xf
  v_dot2c_f32_bf16_dpp v9, v34, v80 row_newbcast:10 row_mask:0xf bank_mask:0xf
  v_dot2c_f32_bf16_dpp v10, v29, v81 row_newbcast:10 row_mask:0xf bank_mask:0xf
  v_dot2c_f32_bf16_dpp v11, v34, v81 row_newbcast:10 row_mask:0xf bank_mask:0xf
  v_dot2c_f32_bf16_dpp v12, v29, v82 row_newbcast:10 row_mask:0xf bank_mask:0xf
  v_dot2c_f32_bf16_dpp v13, v34, v82 row_newbcast:10 row_mask:0xf bank_mask:0xf
  v_dot2c_f32_bf16_dpp v14, v29, v83 row_newbcast:10 row_mask:0xf bank_mask:0xf
  v_dot2c_f32_bf16_dpp v15, v34, v83 row_newbcast:10 row_mask:0xf bank_mask:0xf
  s_cmp_eq_u32 s75, 16
  s_cbranch_scc1 L_epi
  s_call_b64 s[62:63], L_vq
  s_cbranch_scc1 L_nl16
  v_add_u32_dpp v3, v30, v38 row_newbcast:0 row_mask:0xf bank_mask:0xf
  buffer_load_dwordx4 v[104:107], v3, s[48:51], 0 offen nt
L_nl16:
  v_dot2c_f32_bf16_dpp v8, v29, v84 row_newbcast:11 row_mask:0xf bank_mask:0xf
  v_dot2c_f32_bf16_dpp v9, v34, v84 row_newbcast:11 row_mask:0xf bank_mask:0xf
  v_dot2c_f32_bf16_dpp v10, v29, v85 row_newbcast:11 row_mask:0xf bank_mask:0xf
  v_dot2c_f32_bf16_dpp v11, v34, v85 row_newbcast:11 row_mask:0xf bank_mask:0xf
  v_dot2c_f32_bf16_dpp v12, v29, v86 row_newbcast:11 row_mask:0xf bank_mask:0xf
  v_dot2c_f32_bf16_dpp v13, v34, v86 row_newbcast:11 row_mask:0xf bank_mask:0xf
  v_dot2c_f32_bf16_dpp v14, v29, v87 row_newbcast:11 row_mask:0xf bank_mask:0xf
  v_dot2c_f32_bf16_dpp v15, v34, v87 row_newbcast:11 row_mask:0xf bank_mask:0xf
  s_cmp_eq_u32 s75, 17
  s_cbranch_scc1 L_epi
  s_call_b64 s[62:63], L_vq
  s_cbranch_scc1 L_nl17
  v_add_u32_dpp v3, v30, v38 row_newbcast:1 row_mask:0xf bank_mask:0xf
  buffer_load_dwordx4 v[108:111], v3, s[48:51], 0 offen nt
L_nl17:
  v_dot2c_f32_bf16_dpp v8, v29, v88 row_newbcast:12 row_mask:0xf bank_mask:0xf
  v_dot2c_f32_bf16_dpp v9, v34, v88 row_newbcast:12 row_mask:0xf bank_mask:0xf
  v_dot2c_f32_bf16_dpp v10, v29, v89 row_newbcast:12 row_mask:0xf bank_mask:0xf
  v_dot2c_f32_bf16_dpp v11, v34, v89 row_newbcast:12 row_mask:0xf bank_mask:0xf
  v_dot2c_f32_bf16_dpp v12, v29, v90 row_newbcast:12 row_mask:0xf bank_mask:0xf
  v_dot2c_f32_bf16_dpp v13, v34, v90 row_newbcast:12 row_mask:0xf bank_mask:0xf
  v_dot2c_f32_bf16_dpp v14, v29, v91 row_newbcast:12 row_mask:0xf bank_mask:0xf
  v_dot2c_f32_bf16_dpp v15, v34, v91 row_newbcast:12 row_mask:0xf bank_mask:0xf
  s_cmp_eq_u32 s75, 18
  s_cbranch_scc1 L_epi
  s_call_b64 s[62:63], L_vq
  s_cbranch_scc1 L_nl18
  v_add_u32_dpp v3, v30, v38 row_newbcast:2 row_mask:0xf bank_mask:0xf
  buffer_load_dwordx4 v[112:115], v3, s[48:51], 0 offen nt
L_nl18:
  v_dot2c_f32_bf16_dpp v8, v29, v92 row_newbcast:13 row_mask:0xf bank_mask:0xf
  v_dot2c_f32_bf16_dpp v9, v34, v92 row_newbcast:13 row_mask:0xf bank_mask:0xf
  v_dot2c_f32_bf16_dpp v10, v29, v93 row_newbcast:13 row_mask:0xf bank_mask:0xf
  v_dot2c_f32_bf16_dpp v11, v34, v93 row_newbcast:13 row_mask:0xf bank_mask:0xf
  v_dot2c_f32_bf16_dpp v12, v29, v94 row_newbcast:13 row_mask:0xf bank_mask:0xf
  v_dot2c_f32_bf16_dpp v13, v34, v94 row_newbcast:13 row_mask:0xf bank_mask:0xf
  v_dot2c_f32_bf16_dpp v14, v29, v95 row_newbcast:13 row_mask:0xf bank_mask:0xf
  v_dot2c_f32_bf16_dpp v15, v34, v95 row_newbcast:13 row_mask:0xf bank_mask:0xf
  s_cmp_eq_u32 s75, 19
  s_cbranch_scc1 L_epi
  s_call_b64 s[62:63], L_vq
  s_cbranch_scc1 L_nl19
  v_add_u32_dpp v3, v30, v38 row_newbcast:3 row_mask:0xf bank_mask:0xf
  buffer_load_dwordx4 v[116:119], v3, s[48:51], 0 offen nt
L_nl19:
  v_dot2c_f32_bf16_dpp v8, v29, v96 row_newbcast:14 row_mask:0xf bank_mask:0xf
  v_dot2c_f32_bf16_dpp v9, v34, v96 row_newbcast:14 row_mask:0xf bank_mask:0xf
  v_dot2c_f32_bf16_dpp v10, v29, v97 row_newbcast:14 row_mask:0xf bank_mask:0xf
  v_dot2c_f32_bf16_dpp v11, v34, v97 row_newbcast:14 row_mask:0xf bank_mask:0xf
  v_dot2c_f32_bf16_dpp v12, v29, v98 row_newbcast:14 row_mask:0xf bank_mask:0xf
  v_dot2c_f32_bf16_dpp v13, v34, v98 row_newbcast:14 row_mask:0xf bank_mask:0xf
  v_dot2c_f32_bf16_dpp v14, v29, v99 row_newbcast:14 row_mask:0xf bank_mask:0xf
  v_dot2c_f32_bf16_dpp v15, v34, v99 row_newbcast:14 row_mask:0xf bank_mask:0xf
  s_cmp_eq_u32 s75, 20
  s_cbranch_scc1 L_epi
  s_call_b64 s[62:63], L_vq
  s_cbranch_scc1 L_nl20
  v_add_u32_dpp v3, v30, v38 row_newbcast:4 row_mask:0xf bank_mask:0xf
  buffer_load_dwordx4 v[120:123], v3, s[48:51], 0 offen nt
L_nl20:
  v_dot2c_f32_bf16_dpp v8, v29, v100 row_newbcast:15 row_mask:0xf bank_mask:0xf
  v_dot2c_f32_bf16_dpp v9, v34, v100 row_newbcast:15 row_mask:0xf bank_mask:0xf
  v_dot2c_f32_bf16_dpp v10, v29, v101 row_newbcast:15 row_mask:0xf bank_mask:0xf
  v_dot2c_f32_bf16_dpp v11, v34, v101 row_newbcast:15 row_mask:0xf bank_mask:0xf
  v_dot2c_f32_bf16_dpp v12, v29, v102 row_newbcast:15 row_mask:0xf bank_mask:0xf
  v_dot2c_f32_bf16_dpp v13, v34, v102 row_newbcast:15 row_mask:0xf bank_mask:0xf
  v_dot2c_f32_bf16_dpp v14, v29, v103 row_newbcast:15 row_mask:0xf bank_mask:0xf
  v_dot2c_f32_bf16_dpp v15, v34, v103 row_newbcast:15 row_mask:0xf bank_mask:0xf
  s_cmp_eq_u32 s75, 21
  s_cbranch_scc1 L_epi
  s_call_b64 s[62:63], L_vq
  s_cbranch_scc1 L_nl21
  v_add_u32_dpp v3, v30, v38 row_newbcast:5 row_mask:0xf bank_mask:0xf
  buffer_load_dwordx4 v[124:127], v3, s[48:51], 0 offen nt
L_nl21:
  v_dot2c_f32_bf16_dpp v8, v31, v104 row_newbcast:0 row_mask:0xf bank_mask:0xf
  v_dot2c_f32_bf16_dpp v9, v35, v104 row_newbcast:0 row_mask:0xf bank_mask:0xf
  v_dot2c_f32_bf16_dpp v10, v31, v105 row_newbcast:0 row_mask:0xf bank_mask:0xf
  v_dot2c_f32_bf16_dpp v11, v35, v105 row_newbcast:0 row_mask:0xf bank_mask:0xf
  v_dot2c_f32_bf16_dpp v12, v31, v106 row_newbcast:0 row_mask:0xf bank_mask:0xf
  v_dot2c_f32_bf16_dpp v13, v35, v106 row_newbcast:0 row_mask:0xf bank_mask:0xf
  v_dot2c_f32_bf16_dpp v14, v31, v107 row_newbcast:0 row_mask:0xf bank_mask:0xf
  v_dot2c_f32_bf16_dpp v15, v35, v107 row_newbcast:0 row_mask:0xf bank_mask:0xf
  s_cmp_eq_u32 s75, 22
  s_cbranch_scc1 L_epi
  s_call_b64 s[62:63], L_vq
  s_cbranch_scc1 L_nl22
  v_add_u32_dpp v3, v30, v38 row_newbcast:6 row_mask:0xf bank_mask:0xf
  buffer_load_dwordx4 v[128:131], v3, s[48:51], 0 offen nt
L_nl22:
  v_dot2c_f32_bf16_dpp v8, v31, v108 row_newbcast:1 row_mask:0xf bank_mask:0xf
  v_dot2c_f32_bf16_dpp v9, v35, v108 row_newbcast:1 row_mask:0xf bank_mask:0xf
  v_dot2c_f32_bf16_dpp v10, v31, v109 row_newbcast:1 row_mask:0xf bank_mask:0xf
  v_dot2c_f32_bf16_dpp v11, v35, v109 row_newbcast:1 row_mask:0xf bank_mask:0xf
  v_dot2c_f32_bf16_dpp v12, v31, v110 row_newbcast:1 row_mask:0xf bank_mask:0xf
  v_dot2c_f32_bf16_dpp v13, v35, v110 row_newbcast:1 row_mask:0xf bank_mask:0xf
  v_dot2c_f32_bf16_dpp v14, v31, v111 row_newbcast:1 row_mask:0xf bank_mask:0xf
  v_dot2c_f32_bf16_dpp v15, v35, v111 row_newbcast:1 row_mask:0xf bank_mask:0xf
  s_cmp_eq_u32 s75, 23
  s_cbranch_scc1 L_epi
  s_call_b64 s[62:63], L_vq
  s_cbranch_scc1 L_nl23
  v_add_u32_dpp v3, v30, v38 row_newbcast:7 row_mask:0xf bank_mask:0xf
  buffer_load_dwordx4 v[132:135], v3, s[48:51], 0 offen nt
L_nl23:
  v_dot2c_f32_bf16_dpp v8, v31, v112 row_newbcast:2 row_mask:0xf bank_mask:0xf
  v_dot2c_f32_bf16_dpp v9, v35, v112 row_newbcast:2 row_mask:0xf bank_mask:0xf
  v_dot2c_f32_bf16_dpp v10, v31, v113 row_newbcast:2 row_mask:0xf bank_mask:0xf
  v_dot2c_f32_bf16_dpp v11, v35, v113 row_newbcast:2 row_mask:0xf bank_mask:0xf
  v_dot2c_f32_bf16_dpp v12, v31, v114 row_newbcast:2 row_mask:0xf bank_mask:0xf
  v_dot2c_f32_bf16_dpp v13, v35, v114 row_newbcast:2 row_mask:0xf bank_mask:0xf
  v_dot2c_f32_bf16_dpp v14, v31, v115 row_newbcast:2 row_mask:0xf bank_mask:0xf
  v_dot2c_f32_bf16_dpp v15, v35, v115 row_newbcast:2 row_mask:0xf bank_mask:0xf
  s_cmp_eq_u32 s75, 24
  s_cbranch_scc1 L_epi
  s_call_b64 s[62:63], L_vq
  s_cbranch_scc1 L_nl24
  v_add_u32_dpp v3, v30, v38 row_newbcast:8 row_mask:0xf bank_mask:0xf
  buffer_load_dwordx4 v[136:139], v3, s[48:51], 0 offen nt
L_nl24:
  v_dot2c_f32_bf16_dpp v8, v31, v116 row_newbcast:3 row_mask:0xf bank_mask:0xf
  v_dot2c_f32_bf16_dpp v9, v35, v116 row_newbcast:3 row_mask:0xf bank_mask:0xf
  v_dot2c_f32_bf16_dpp v10, v31, v117 row_newbcast:3 row_mask:0xf bank_mask:0xf
  v_dot2c_f32_bf16_dpp v11, v35, v117 row_newbcast:3 row_mask:0xf bank_mask:0xf
  v_dot2c_f32_bf16_dpp v12, v31, v118 row_newbcast:3 row_mask:0xf bank_mask:0xf
  v_dot2c_f32_bf16_dpp v13, v35, v118 row_newbcast:3 row_mask:0xf bank_mask:0xf
  v_dot2c_f32_bf16_dpp v14, v31, v119 row_newbcast:3 row_mask:0xf bank_mask:0xf
  v_dot2c_f32_bf16_dpp v15, v35, v119 row_newbcast:3 row_mask:0xf bank_mask:0xf
  s_cmp_eq_u32 s75, 25
  s_cbranch_scc1 L_epi
  s_call_b64 s[62:63], L_vq
  s_cbranch_scc1 L_nl25
  v_add_u32_dpp v3, v30, v38 row_newbcast:9 row_mask:0xf bank_mask:0xf
  buffer_load_dwordx4 v[140:143], v3, s[48:51], 0 offen nt
L_nl25:
  v_dot2c_f32_bf16_dpp v8, v31, v120 row_newbcast:4 row_mask:0xf bank_mask:0xf
  v_dot2c_f32_bf16_dpp v9, v35, v120 row_newbcast:4 row_mask:0xf bank_mask:0xf
  v_dot2c_f32_bf16_dpp v10, v31, v121 row_newbcast:4 row_mask:0xf bank_mask:0xf
  v_dot2c_f32_bf16_dpp v11, v35, v121 row_newbcast:4 row_mask:0xf bank_mask:0xf
  v_dot2c_f32_bf16_dpp v12, v31, v122 row_newbcast:4 row_mask:0xf bank_mask:0xf
  v_dot2c_f32_bf16_dpp v13, v35, v122 row_newbcast:4 row_mask:0xf bank_mask:0xf
  v_dot2c_f32_bf16_dpp v14, v31, v123 row_newbcast:4 row_mask:0xf bank_mask:0xf
  v_dot2c_f32_bf16_dpp v15, v35, v123 row_newbcast:4 row_mask:0xf bank_mask:0xf
  s_cmp_eq_u32 s75, 26
  s_cbranch_scc1 L_epi
  s_call_b64 s[62:63], L_vq
  s_cbranch_scc1 L_nl26
  v_add_u32_dpp v3, v30, v38 row_newbcast:10 row_mask:0xf bank_mask:0xf
  buffer_load_dwordx4 v[144:147], v3, s[48:51], 0 offen nt
L_nl26:
  v_dot2c_f32_bf16_dpp v8, v31, v124 row_newbcast:5 row_mask:0xf bank_mask:0xf
  v_dot2c_f32_bf16_dpp v9, v35, v124 row_newbcast:5 row_mask:0xf bank_mask:0xf
  v_dot2c_f32_bf16_dpp v10, v31, v125 row_newbcast:5 row_mask:0xf bank_mask:0xf
  v_dot2c_f32_bf16_dpp v11, v35, v125 row_newbcast:5 row_mask:0xf bank_mask:0xf
  v_dot2c_f32_bf16_dpp v12, v31, v126 row_newbcast:5 row_mask:0xf bank_mask:0xf
  v_dot2c_f32_bf16_dpp v13, v35, v126 row_newbcast:5 row_mask:0xf bank_mask:0xf
  v_dot2c_f32_bf16_dpp v14, v31, v127 row_newbcast:5 row_mask:0xf bank_mask:0xf
  v_dot2c_f32_bf16_dpp v15, v35, v127 row_newbcast:5 row_mask:0xf bank_mask:0xf
  s_cmp_eq_u32 s75, 27
  s_cbranch_scc1 L_epi
  s_call_b64 s[62:63], L_vq
  s_cbranch_scc1 L_nl27
  v_add_u32_dpp v3, v30, v38 row_newbcast:11 row_mask:0xf bank_mask:0xf
  buffer_load_dwordx4 v[148:151], v3, s[48:51], 0 offen nt
L_nl27:
  v_dot2c_f32_bf16_dpp v8, v31, v128 row_newbcast:6 row_mask:0xf bank_mask:0xf
  v_dot2c_f32_bf16_dpp v9, v35, v128 row_newbcast:6 row_mask:0xf bank_mask:0xf
  v_dot2c_f32_bf16_dpp v10, v31, v129 row_newbcast:6 row_mask:0xf bank_mask:0xf
  v_dot2c_f32_bf16_dpp v11, v35, v129 row_newbcast:6 row_mask:0xf bank_mask:0xf
  v_dot2c_f32_bf16_dpp v12, v31, v130 row_newbcast:6 row_mask:0xf bank_mask:0xf
  v_dot2c_f32_bf16_dpp v13, v35, v130 row_newbcast:6 row_mask:0xf bank_mask:0xf
  v_dot2c_f32_bf16_dpp v14, v31, v131 row_newbcast:6 row_mask:0xf bank_mask:0xf
  v_dot2c_f32_bf16_dpp v15, v35, v131 row_newbcast:6 row_mask:0xf bank_mask:0xf
  s_cmp_eq_u32 s75, 28
  s_cbranch_scc1 L_epi
  s_call_b64 s[62:63], L_vq
  s_cbranch_scc1 L_nl28
  v_add_u32_dpp v3, v30, v38 row_newbcast:12 row_mask:0xf bank_mask:0xf
  buffer_load_dwordx4 v[152:155], v3, s[48:51], 0 offen nt
L_nl28:
  v_dot2c_f32_bf16_dpp v8, v31, v132 row_newbcast:7 row_mask:0xf bank_mask:0xf
  v_dot2c_f32_bf16_dpp v9, v35, v132 row_newbcast:7 row_mask:0xf bank_mask:0xf
  v_dot2c_f32_bf16_dpp v10, v31, v133 row_newbcast:7 row_mask:0xf bank_mask:0xf
  v_dot2c_f32_bf16_dpp v11, v35, v133 row_newbcast:7 row_mask:0xf bank_mask:0xf
  v_dot2c_f32_bf16_dpp v12, v31, v134 row_newbcast:7 row_mask:0xf bank_mask:0xf
  v_dot2c_f32_bf16_dpp v13, v35, v134 row_newbcast:7 row_mask:0xf bank_mask:0xf
  v_dot2c_f32_bf16_dpp v14, v31, v135 row_newbcast:7 row_mask:0xf bank_mask:0xf
  v_dot2c_f32_bf16_dpp v15, v35, v135 row_newbcast:7 row_mask:0xf bank_mask:0xf
  s_cmp_eq_u32 s75, 29
  s_cbranch_scc1 L_epi
  s_call_b64 s[62:63], L_vq
  s_cbranch_scc1 L_nl29
  v_add_u32_dpp v3, v30, v38 row_newbcast:13 row_mask:0xf bank_mask:0xf
  buffer_load_dwordx4 v[156:159], v3, s[48:51], 0 offen nt
L_nl29:
  v_dot2c_f32_bf16_dpp v8, v31, v136 row_newbcast:8 row_mask:0xf bank_mask:0xf
  v_dot2c_f32_bf16_dpp v9, v35, v136 row_newbcast:8 row_mask:0xf bank_mask:0xf
  v_dot2c_f32_bf16_dpp v10, v31, v137 row_newbcast:8 row_mask:0xf bank_mask:0xf
  v_dot2c_f32_bf16_dpp v11, v35, v137 row_newbcast:8 row_mask:0xf bank_mask:0xf
  v_dot2c_f32_bf16_dpp v12, v31, v138 row_newbcast:8 row_mask:0xf bank_mask:0xf
  v_dot2c_f32_bf16_dpp v13, v35, v138 row_newbcast:8 row_mask:0xf bank_mask:0xf
  v_dot2c_f32_bf16_dpp v14, v31, v139 row_newbcast:8 row_mask:0xf bank_mask:0xf
  v_dot2c_f32_bf16_dpp v15, v35, v139 row_newbcast:8 row_mask:0xf bank_mask:0xf
  s_cmp_eq_u32 s75, 30
  s_cbranch_scc1 L_epi
  s_call_b64 s[62:63], L_vq
  s_cbranch_scc1 L_nl30
  v_add_u32_dpp v3, v30, v38 row_newbcast:14 row_mask:0xf bank_mask:0xf
  buffer_load_dwordx4 v[160:163], v3, s[48:51], 0 offen nt
L_nl30:
  v_dot2c_f32_bf16_dpp v8, v31, v140 row_newbcast:9 row_mask:0xf bank_mask:0xf
  v_dot2c_f32_bf16_dpp v9, v35, v140 row_newbcast:9 row_mask:0xf bank_mask:0xf
  v_dot2c_f32_bf16_dpp v10, v31, v141 row_newbcast:9 row_mask:0xf bank_mask:0xf
  v_dot2c_f32_bf16_dpp v11, v35, v141 row_newbcast:9 row_mask:0xf bank_mask:0xf
  v_dot2c_f32_bf16_dpp v12, v31, v142 row_newbcast:9 row_mask:0xf bank_mask:0xf
  v_dot2c_f32_bf16_dpp v13, v35, v142 row_newbcast:9 row_mask:0xf bank_mask:0xf
  v_dot2c_f32_bf16_dpp v14, v31, v143 row_newbcast:9 row_mask:0xf bank_mask:0xf
  v_dot2c_f32_bf16_dpp v15, v35, v143 row_newbcast:9 row_mask:0xf bank_mask:0xf
  s_cmp_eq_u32 s75, 31
  s_cbranch_scc1 L_epi
  s_call_b64 s[62:63], L_vq
  s_cbranch_scc1 L_nl31
  v_add_u32_dpp v3, v30, v38 row_newbcast:15 row_mask:0xf bank_mask:0xf
  buffer_load_dwordx4 v[164:167], v3, s[48:51], 0 offen nt
L_nl31:
  v_dot2c_f32_bf16_dpp v8, v31, v144 row_newbcast:10 row_mask:0xf bank_mask:0xf
  v_dot2c_f32_bf16_dpp v9, v35, v144 row_newbcast:10 row_mask:0xf bank_mask:0xf
  v_dot2c_f32_bf16_dpp v10, v31, v145 row_newbcast:10 row_mask:0xf bank_mask:0xf
  v_dot2c_f32_bf16_dpp v11, v35, v145 row_newbcast:10 row_mask:0xf bank_mask:0xf
  v_dot2c_f32_bf16_dpp v12, v31, v146 row_newbcast:10 row_mask:0xf bank_mask:0xf
  v_dot2c_f32_bf16_dpp v13, v35, v146 row_newbcast:10 row_mask:0xf bank_mask:0xf
  v_dot2c_f32_bf16_dpp v14, v31, v147 row_newbcast:10 row_mask:0xf bank_mask:0xf
  v_dot2c_f32_bf16_dpp v15, v35, v147 row_newbcast:10 row_mask:0xf bank_mask:0xf
  s_cmp_eq_u32 s75, 32
  s_cbranch_scc1 L_epi
  s_call_b64 s[62:63], L_vq
  s_cbranch_scc1 L_nl32
  v_add_u32_dpp v3, v32, v38 row_newbcast:0 row_mask:0xf bank_mask:0xf
  buffer_load_dwordx4 v[40:43], v3, s[48:51], 0 offen nt
L_nl32:
  v_dot2c_f32_bf16_dpp v8, v31, v148 row_newbcast:11 row_mask:0xf bank_mask:0xf
  v_dot2c_f32_bf16_dpp v9, v35, v148 row_newbcast:11 row_mask:0xf bank_mask:0xf
  v_dot2c_f32_bf16_dpp v10, v31, v149 row_newbcast:11 row_mask:0xf bank_mask:0xf
  v_dot2c_f32_bf16_dpp v11, v35, v149 row_newbcast:11 row_mask:0xf bank_mask:0xf
  v_dot2c_f32_bf16_dpp v12, v31, v150 row_newbcast:11 row_mask:0xf bank_mask:0xf
  v_dot2c_f32_bf16_dpp v13, v35, v150 row_newbcast:11 row_mask:0xf bank_mask:0xf
  v_dot2c_f32_bf16_dpp v14, v31, v151 row_newbcast:11 row_mask:0xf bank_mask:0xf
  v_dot2c_f32_bf16_dpp v15, v35, v151 row_newbcast:11 row_mask:0xf bank_mask:0xf
  s_cmp_eq_u32 s75, 33
  s_cbranch_scc1 L_epi
  s_call_b64 s[62:63], L_vq
  s_cbranch_scc1 L_nl33
  v_add_u32_dpp v3, v32, v38 row_newbcast:1 row_mask:0xf bank_mask:0xf
  buffer_load_dwordx4 v[44:47], v3, s[48:51], 0 offen nt
L_nl33:
  v_dot2c_f32_bf16_dpp v8, v31, v152 row_newbcast:12 row_mask:0xf bank_mask:0xf
  v_dot2c_f32_bf16_dpp v9, v35, v152 row_newbcast:12 row_mask:0xf bank_mask:0xf
  v_dot2c_f32_bf16_dpp v10, v31, v153 row_newbcast:12 row_mask:0xf bank_mask:0xf
  v_dot2c_f32_bf16_dpp v11, v35, v153 row_newbcast:12 row_mask:0xf bank_mask:0xf
  v_dot2c_f32_bf16_dpp v12, v31, v154 row_newbcast:12 row_mask:0xf bank_mask:0xf
  v_dot2c_f32_bf16_dpp v13, v35, v154 row_newbcast:12 row_mask:0xf bank_mask:0xf
  v_dot2c_f32_bf16_dpp v14, v31, v155 row_newbcast:12 row_mask:0xf bank_mask:0xf
  v_dot2c_f32_bf16_dpp v15, v35, v155 row_newbcast:12 row_mask:0xf bank_mask:0xf
  s_cmp_eq_u32 s75, 34
  s_cbranch_scc1 L_epi
  s_call_b64 s[62:63], L_vq
  s_cbranch_scc1 L_nl34
  v_add_u32_dpp v3, v32, v38 row_newbcast:2 row_mask:0xf bank_mask:0xf
  buffer_load_dwordx4 v[48:51], v3, s[48:51], 0 offen nt
L_nl34:
  v_dot2c_f32_bf16_dpp v8, v31, v156 row_newbcast:13 row_mask:0xf bank_mask:0xf
  v_dot2c_f32_bf16_dpp v9, v35, v156 row_newbcast:13 row_mask:0xf bank_mask:0xf
  v_dot2c_f32_bf16_dpp v10, v31, v157 row_newbcast:13 row_mask:0xf bank_mask:0xf
  v_dot2c_f32_bf16_dpp v11, v35, v157 row_newbcast:13 row_mask:0xf bank_mask:0xf
  v_dot2c_f32_bf16_dpp v12, v31, v158 row_newbcast:13 row_mask:0xf bank_mask:0xf
  v_dot2c_f32_bf16_dpp v13, v35, v158 row_newbcast:13 row_mask:0xf bank_mask:0xf
  v_dot2c_f32_bf16_dpp v14, v31, v159 row_newbcast:13 row_mask:0xf bank_mask:0xf
  v_dot2c_f32_bf16_dpp v15, v35, v159 row_newbcast:13 row_mask:0xf bank_mask:0xf
  s_cmp_eq_u32 s75, 35
  s_cbranch_scc1 L_epi
  s_call_b64 s[62:63], L_vq
  s_cbranch_scc1 L_nl35
  v_add_u32_dpp v3, v32, v38 row_newbcast:3 row_mask:0xf bank_mask:0xf
  buffer_load_dwordx4 v[52:55], v3, s[48:51], 0 offen nt
L_nl35:
  v_dot2c_f32_bf16_dpp v8, v31, v160 row_newbcast:14 row_mask:0xf bank_mask:0xf
  v_dot2c_f32_bf16_dpp v9, v35, v160 row_newbcast:14 row_mask:0xf bank_mask:0xf
  v_dot2c_f32_bf16_dpp v10, v31, v161 row_newbcast:14 row_mask:0xf bank_mask:0xf
  v_dot2c_f32_bf16_dpp v11, v35, v161 row_newbcast:14 row_mask:0xf bank_mask:0xf
  v_dot2c_f32_bf16_dpp v12, v31, v162 row_newbcast:14 row_mask:0xf bank_mask:0xf
  v_dot2c_f32_bf16_dpp v13, v35, v162 row_newbcast:14 row_mask:0xf bank_mask:0xf
  v_dot2c_f32_bf16_dpp v14, v31, v163 row_newbcast:14 row_mask:0xf bank_mask:0xf
  v_dot2c_f32_bf16_dpp v15, v35, v163 row_newbcast:14 row_mask:0xf bank_mask:0xf
  s_cmp_eq_u32 s75, 36
  s_cbranch_scc1 L_epi
  s_call_b64 s[62:63], L_vq
  s_cbranch_scc1 L_nl36
  v_add_u32_dpp v3, v32, v38 row_newbcast:4 row_mask:0xf bank_mask:0xf
  buffer_load_dwordx4 v[56:59], v3, s[48:51], 0 offen nt
L_nl36:
  v_dot2c_f32_bf16_dpp v8, v31, v164 row_newbcast:15 row_mask:0xf bank_mask:0xf
  v_dot2c_f32_bf16_dpp v9, v35, v164 row_newbcast:15 row_mask:0xf bank_mask:0xf
  v_dot2c_f32_bf16_dpp v10, v31, v165 row_newbcast:15 row_mask:0xf bank_mask:0xf
  v_dot2c_f32_bf16_dpp v11, v35, v165 row_newbcast:15 row_mask:0xf bank_mask:0xf
  v_dot2c_f32_bf16_dpp v12, v31, v166 row_newbcast:15 row_mask:0xf bank_mask:0xf
  v_dot2c_f32_bf16_dpp v13, v35, v166 row_newbcast:15 row_mask:0xf bank_mask:0xf
  v_dot2c_f32_bf16_dpp v14, v31, v167 row_newbcast:15 row_mask:0xf bank_mask:0xf
  v_dot2c_f32_bf16_dpp v15, v35, v167 row_newbcast:15 row_mask:0xf bank_mask:0xf
  s_cmp_eq_u32 s75, 37
  s_cbranch_scc1 L_epi
  s_call_b64 s[62:63], L_vq
  s_cbranch_scc1 L_nl37
  v_add_u32_dpp v3, v32, v38 row_newbcast:5 row_mask:0xf bank_mask:0xf
  buffer_load_dwordx4 v[60:63], v3, s[48:51], 0 offen nt
L_nl37:
  v_dot2c_f32_bf16_dpp v8, v33, v40 row_newbcast:0 row_mask:0xf bank_mask:0xf
  v_dot2c_f32_bf16_dpp v9, v36, v40 row_newbcast:0 row_mask:0xf bank_mask:0xf
  v_dot2c_f32_bf16_dpp v10, v33, v41 row_newbcast:0 row_mask:0xf bank_mask:0xf
  v_dot2c_f32_bf16_dpp v11, v36, v41 row_newbcast:0 row_mask:0xf bank_mask:0xf
  v_dot2c_f32_bf16_dpp v12, v33, v42 row_newbcast:0 row_mask:0xf bank_mask:0xf
  v_dot2c_f32_bf16_dpp v13, v36, v42 row_newbcast:0 row_mask:0xf bank_mask:0xf
  v_dot2c_f32_bf16_dpp v14, v33, v43 row_newbcast:0 row_mask:0xf bank_mask:0xf
  v_dot2c_f32_bf16_dpp v15, v36, v43 row_newbcast:0 row_mask:0xf bank_mask:0xf
  s_cmp_eq_u32 s75, 38
  s_cbranch_scc1 L_epi
  s_call_b64 s[62:63], L_vq
  v_dot2c_f32_bf16_dpp v8, v33, v44 row_newbcast:1 row_mask:0xf bank_mask:0xf
  v_dot2c_f32_bf16_dpp v9, v36, v44 row_newbcast:1 row_mask:0xf bank_mask:0xf
  v_dot2c_f32_bf16_dpp v10, v33, v45 row_newbcast:1 row_mask:0xf bank_mask:0xf
  v_dot2c_f32_bf16_dpp v11, v36, v45 row_newbcast:1 row_mask:0xf bank_mask:0xf
  v_dot2c_f32_bf16_dpp v12, v33, v46 row_newbcast:1 row_mask:0xf bank_mask:0xf
  v_dot2c_f32_bf16_dpp v13, v36, v46 row_newbcast:1 row_mask:0xf bank_mask:0xf
  v_dot2c_f32_bf16_dpp v14, v33, v47 row_newbcast:1 row_mask:0xf bank_mask:0xf
  v_dot2c_f32_bf16_dpp v15, v36, v47 row_newbcast:1 row_mask:0xf bank_mask:0xf
  s_cmp_eq_u32 s75, 39
  s_cbranch_scc1 L_epi
  s_call_b64 s[62:63], L_vq
  v_dot2c_f32_bf16_dpp v8, v33, v48 row_newbcast:2 row_mask:0xf bank_mask:0xf
  v_dot2c_f32_bf16_dpp v9, v36, v48 row_newbcast:2 row_mask:0xf bank_mask:0xf
  v_dot2c_f32_bf16_dpp v10, v33, v49 row_newbcast:2 row_mask:0xf bank_mask:0xf
  v_dot2c_f32_bf16_dpp v11, v36, v49 row_newbcast:2 row_mask:0xf bank_mask:0xf
  v_dot2c_f32_bf16_dpp v12, v33, v50 row_newbcast:2 row_mask:0xf bank_mask:0xf
  v_dot2c_f32_bf16_dpp v13, v36, v50 row_newbcast:2 row_mask:0xf bank_mask:0xf
  v_dot2c_f32_bf16_dpp v14, v33, v51 row_newbcast:2 row_mask:0xf bank_mask:0xf
  v_dot2c_f32_bf16_dpp v15, v36, v51 row_newbcast:2 row_mask:0xf bank_mask:0xf
  s_cmp_eq_u32 s75, 40
  s_cbranch_scc1 L_epi
  s_call_b64 s[62:63], L_vq
  v_dot2c_f32_bf16_dpp v8, v33, v52 row_newbcast:3 row_mask:0xf bank_mask:0xf
  v_dot2c_f32_bf16_dpp v9, v36, v52 row_newbcast:3 row_mask:0xf bank_mask:0xf
  v_dot2c_f32_bf16_dpp v10, v33, v53 row_newbcast:3 row_mask:0xf bank_mask:0xf
  v_dot2c_f32_bf16_dpp v11, v36, v53 row_newbcast:3 row_mask:0xf bank_mask:0xf
  v_dot2c_f32_bf16_dpp v12, v33, v54 row_newbcast:3 row_mask:0xf bank_mask:0xf
  v_dot2c_f32_bf16_dpp v13, v36, v54 row_newbcast:3 row_mask:0xf bank_mask:0xf
  v_dot2c_f32_bf16_dpp v14, v33, v55 row_newbcast:3 row_mask:0xf bank_mask:0xf
  v_dot2c_f32_bf16_dpp v15, v36, v55 row_newbcast:3 row_mask:0xf bank_mask:0xf
  s_cmp_eq_u32 s75, 41
  s_cbranch_scc1 L_epi
  s_call_b64 s[62:63], L_vq
  v_dot2c_f32_bf16_dpp v8, v33, v56 row_newbcast:4 row_mask:0xf bank_mask:0xf
  v_dot2c_f32_bf16_dpp v9, v36, v56 row_newbcast:4 row_mask:0xf bank_mask:0xf
  v_dot2c_f32_bf16_dpp v10, v33, v57 row_newbcast:4 row_mask:0xf bank_mask:0xf
  v_dot2c_f32_bf16_dpp v11, v36, v57 row_newbcast:4 row_mask:0xf bank_mask:0xf
  v_dot2c_f32_bf16_dpp v12, v33, v58 row_newbcast:4 row_mask:0xf bank_mask:0xf
  v_dot2c_f32_bf16_dpp v13, v36, v58 row_newbcast:4 row_mask:0xf bank_mask:0xf
  v_dot2c_f32_bf16_dpp v14, v33, v59 row_newbcast:4 row_mask:0xf bank_mask:0xf
  v_dot2c_f32_bf16_dpp v15, v36, v59 row_newbcast:4 row_mask:0xf bank_mask:0xf
  s_cmp_eq_u32 s75, 42
  s_cbranch_scc1 L_epi
  s_call_b64 s[62:63], L_vq
  v_dot2c_f32_bf16_dpp v8, v33, v60 row_newbcast:5 row_mask:0xf bank_mask:0xf
  v_dot2c_f32_bf16_dpp v9, v36, v60 row_newbcast:5 row_mask:0xf bank_mask:0xf
  v_dot2c_f32_bf16_dpp v10, v33, v61 row_newbcast:5 row_mask:0xf bank_mask:0xf
  v_dot2c_f32_bf16_dpp v11, v36, v61 row_newbcast:5 row_mask:0xf bank_mask:0xf
  v_dot2c_f32_bf16_dpp v12, v33, v62 row_newbcast:5 row_mask:0xf bank_mask:0xf
  v_dot2c_f32_bf16_dpp v13, v36, v62 row_newbcast:5 row_mask:0xf bank_mask:0xf
  v_dot2c_f32_bf16_dpp v14, v33, v63 row_newbcast:5 row_mask:0xf bank_mask:0xf
  v_dot2c_f32_bf16_dpp v15, v36, v63 row_newbcast:5 row_mask:0xf bank_mask:0xf
  s_nop 1
L_epi:
  s_nop 0
  v_add_u32 v21, s11, v39
  v_permlane32_swap_b32 v8, v12
  v_permlane32_swap_b32 v9, v13
  v_permlane32_swap_b32 v10, v14
  v_permlane32_swap_b32 v11, v15
  v_add_f32 v8, v8, v12
  v_add_f32 v9, v9, v13
  v_add_f32 v10, v10, v14
  v_add_f32 v11, v11, v15
  v_mov_b32 v3, 1
  v_permlane16_swap_b32 v8, v10
  v_permlane16_swap_b32 v9, v11
  v_add_f32 v8, v8, v10
  v_add_f32 v9, v9, v11
  v_pk_add_f32 v[8:9], v[8:9], v[4:5]
  ds_write_b64 v21, v[8:9] offset:1024
  s_cmp_eq_u32 s21, 0
  s_cbranch_scc1 L_ep2
  ds_write_b64 v21, v[8:9] offset:6656
  s_mov_b64 exec, 1
  ds_add_u32 v1, v3 offset:304
  s_mov_b64 exec, -1
L_ep2:
  s_mov_b64 exec, 1
  ds_add_rtn_u32 v3, v1, v3 offset:308
  s_mov_b64 exec, -1
  v_mov_b32 v4, 0
  ds_read_b32 v5, v4 offset:256
  s_waitcnt lgkmcnt(0)
  v_readfirstlane_b32 s68, v3
  s_cmp_lg_u32 s68, 10
  s_cbranch_scc1 L_send
  v_cmp_eq_u32 vcc, -1, v5
  s_cmp_eq_u64 vcc, 0
  s_cbranch_scc1 L_ep3
  s_mov_b32 s70, 0
L_pl_1:
  ds_read_b32 v5, v4 offset:256
  s_waitcnt lgkmcnt(0)
  v_cmp_eq_u32 vcc, -1, v5
  s_cmp_eq_u64 vcc, 0
  s_cbranch_scc1 L_pld_2
  s_sleep 1
  s_add_u32 s70, s70, 1
  s_cmp_lt_u32 s70, 1048576
  s_cbranch_scc1 L_pl_1
L_pld_2:
L_ep3:
  v_lshlrev_b32 v74, 3, v1
  ds_read_b128 v[62:65], v4 offset:384
  ds_read_b128 v[66:69], v4 offset:400
  ds_read_b128 v[70:73], v4 offset:416
  ds_read_b64 v[40:41], v74 offset:1024
  ds_read_b64 v[42:43], v74 offset:1536
  ds_read_b64 v[44:45], v74 offset:2048
  ds_read_b64 v[46:47], v74 offset:2560
  ds_read_b64 v[48:49], v74 offset:3072
  ds_read_b64 v[50:51], v74 offset:3584
  ds_read_b64 v[52:53], v74 offset:4096
  ds_read_b64 v[54:55], v74 offset:4608
  ds_read_b64 v[56:57], v74 offset:5120
  ds_read_b64 v[58:59], v74 offset:5632
  ds_read_b64 v[60:61], v74 offset:6144
  s_lshl_b32 s68, s6, 2
  s_add_u32 s68, s68, s7
  s_lshl_b32 s68, s68, 9
  s_add_u32 s68, s68, 524288
  v_add_u32 v74, s68, v74
  v_and_b32 v75, 1, v1
  v_lshlrev_b32 v75, 4, v75
  v_lshrrev_b32 v75, v75, s74
  v_lshrrev_b32 v76, 8, v75
  s_movk_i32 s69, 0xff
  s_waitcnt lgkmcnt(10)
  v_pk_mul_f32 v[40:41], v[40:41], v[62:63] op_sel:[0,0] op_sel_hi:[1,0]
  s_waitcnt lgkmcnt(9)
  v_pk_mul_f32 v[42:43], v[42:43], v[62:63] op_sel:[0,1] op_sel_hi:[1,1]
  s_waitcnt lgkmcnt(8)
  v_pk_fma_f32 v[40:41], v[44:45], v[64:65], v[40:41] op_sel:[0,0,0] op_sel_hi:[1,0,1]
  s_waitcnt lgkmcnt(7)
  v_pk_fma_f32 v[42:43], v[46:47], v[64:65], v[42:43] op_sel:[0,1,0] op_sel_hi:[1,1,1]
  s_waitcnt lgkmcnt(6)
  v_pk_fma_f32 v[40:41], v[48:49], v[66:67], v[40:41] op_sel:[0,0,0] op_sel_hi:[1,0,1]
  s_waitcnt lgkmcnt(5)
  v_pk_fma_f32 v[42:43], v[50:51], v[66:67], v[42:43] op_sel:[0,1,0] op_sel_hi:[1,1,1]
  s_waitcnt lgkmcnt(4)
  v_pk_fma_f32 v[40:41], v[52:53], v[68:69], v[40:41] op_sel:[0,0,0] op_sel_hi:[1,0,1]
  s_waitcnt lgkmcnt(3)
  v_pk_fma_f32 v[42:43], v[54:55], v[68:69], v[42:43] op_sel:[0,1,0] op_sel_hi:[1,1,1]
  s_waitcnt lgkmcnt(2)
  v_pk_fma_f32 v[40:41], v[56:57], v[70:71], v[40:41] op_sel:[0,0,0] op_sel_hi:[1,0,1]
  s_waitcnt lgkmcnt(1)
  v_pk_fma_f32 v[42:43], v[58:59], v[70:71], v[42:43] op_sel:[0,1,0] op_sel_hi:[1,1,1]
  s_waitcnt lgkmcnt(0)
  v_pk_fma_f32 v[40:41], v[60:61], v[72:73], v[40:41] op_sel:[0,0,0] op_sel_hi:[1,0,1]
  v_pk_add_f32 v[40:41], v[40:41], v[42:43]
  v_bfi_b32 v40, s69, v75, v40
  v_bfi_b32 v41, s69, v76, v41
  global_store_dwordx2 v74, v[40:41], s[42:43] sc1
L_send:
  s_endpgm
L_ks:
  s_cmp_ge_u32 s39, 4
  s_cbranch_scc1 L_kq
  s_call_b64 s[100:101], L_work
L_kq:
  v_readfirstlane_b32 s78, v22
  v_readfirstlane_b32 s79, v23
L_ks2:
  s_add_u32 s32, s32, 1
  s_mul_i32 s68, s35, s76
  s_sub_i32 s68, s68, s78
  s_sub_u32 s35, s35, 1
  s_add_i32 s68, s68, 1024
  s_mul_i32 s68, s68, 10
  s_add_i32 s68, s68, s34
  s_add_i32 s68, s68, s79
  s_max_i32 s68, s68, 307
  s_min_i32 s68, s68, 1280
  s_add_u32 s33, s33, 32
  s_and_b32 s69, s33, 0xff
  s_add_u32 s68, s68, s69
  s_lshr_b32 s41, s68, 8
L_wait:
  s_mov_b64 exec, 1
  ds_dec_u32 v2, v39 offset:288
  ds_read_b64 v[22:23], v2 offset:288
  s_mov_b64 exec, -1
  s_cmp_lt_u32 s41, 2
  s_cbranch_scc1 L_wt1
  s_cmp_lt_u32 s41, 3
  s_cbranch_scc1 L_wt2
  s_cmp_lt_u32 s41, 4
  s_cbranch_scc1 L_wt3
  s_cmp_lt_u32 s41, 5
  s_cbranch_scc1 L_wt4
L_wt5:
  s_waitcnt vmcnt(4)
  s_setpc_b64 s[62:63]
L_wt4:
  s_cmp_lg_u32 s32, s32
  s_waitcnt vmcnt(3)
  s_setpc_b64 s[62:63]
L_wt3:
  s_cmp_lg_u32 s32, s32
  s_waitcnt vmcnt(2)
  s_setpc_b64 s[62:63]
L_wt2:
  s_cmp_lg_u32 s32, s32
  s_waitcnt vmcnt(1)
  s_setpc_b64 s[62:63]
L_wt1:
  s_cmp_lg_u32 s32, s32
  s_waitcnt vmcnt(0)
  s_setpc_b64 s[62:63]
L_vs:
  v_readfirstlane_b32 s78, v22
  v_readfirstlane_b32 s79, v23
  s_cmp_eq_u32 s61, 2
  s_cbranch_scc1 L_vs1
  s_cmp_eq_u32 s61, 1
  s_cbranch_scc1 L_x3
  s_cmp_gt_u32 s41, s32
  s_cbranch_scc1 L_ks2
L_x1:
  v_dot2_f32_bf16 v8, v136, v4, 0
  v_dot2_f32_bf16 v9, v140, v4, 0
  v_dot2_f32_bf16 v10, v144, v4, 0
  v_dot2_f32_bf16 v11, v148, v4, 0
  v_dot2_f32_bf16 v12, v152, v4, 0
  v_dot2_f32_bf16 v13, v156, v4, 0
  v_dot2_f32_bf16 v14, v160, v4, 0
  v_dot2_f32_bf16 v15, v164, v4, 0
  v_dot2_f32_bf16 v8, v137, v5, v8
  v_dot2_f32_bf16 v9, v141, v5, v9
  v_dot2_f32_bf16 v10, v145, v5, v10
  v_dot2_f32_bf16 v11, v149, v5, v11
  v_dot2_f32_bf16 v12, v153, v5, v12
  v_dot2_f32_bf16 v13, v157, v5, v13
  v_dot2_f32_bf16 v14, v161, v5, v14
  v_dot2_f32_bf16 v15, v165, v5, v15
  v_dot2_f32_bf16 v8, v138, v6, v8
  v_dot2_f32_bf16 v9, v142, v6, v9
  v_dot2_f32_bf16 v10, v146, v6, v10
  v_dot2_f32_bf16 v11, v150, v6, v11
  v_dot2_f32_bf16 v12, v154, v6, v12
  v_dot2_f32_bf16 v13, v158, v6, v13
  v_dot2_f32_bf16 v14, v162, v6, v14
  v_dot2_f32_bf16 v15, v166, v6, v15
  v_dot2_f32_bf16 v8, v139, v7, v8
  v_dot2_f32_bf16 v9, v143, v7, v9
  v_dot2_f32_bf16 v10, v147, v7, v10
  v_dot2_f32_bf16 v11, v151, v7, v11
  v_dot2_f32_bf16 v12, v155, v7, v12
  v_dot2_f32_bf16 v13, v159, v7, v13
  v_dot2_f32_bf16 v14, v163, v7, v14
  v_dot2_f32_bf16 v15, v167, v7, v15
  v_add_f32_dpp v8, v8, v8 row_ror:8 row_mask:0xf bank_mask:0x3
  v_add_f32_dpp v8, v9, v9 row_ror:8 row_mask:0xf bank_mask:0xc
  v_add_f32_dpp v10, v10, v10 row_ror:8 row_mask:0xf bank_mask:0x3
  v_add_f32_dpp v10, v11, v11 row_ror:8 row_mask:0xf bank_mask:0xc
  v_add_f32_dpp v12, v12, v12 row_ror:8 row_mask:0xf bank_mask:0x3
  v_add_f32_dpp v12, v13, v13 row_ror:8 row_mask:0xf bank_mask:0xc
  v_add_f32_dpp v14, v14, v14 row_ror:8 row_mask:0xf bank_mask:0x3
  v_add_f32_dpp v14, v15, v15 row_ror:8 row_mask:0xf bank_mask:0xc
  v_add_f32_dpp v18, v8, v8 row_shl:4 row_mask:0xf bank_mask:0x5
  v_add_f32_dpp v18, v10, v10 row_shr:4 row_mask:0xf bank_mask:0xa
  v_add_f32_dpp v19, v12, v12 row_shl:4 row_mask:0xf bank_mask:0x5
  v_add_f32_dpp v19, v14, v14 row_shr:4 row_mask:0xf bank_mask:0xa
  s_lshl_b32 s68, s20, 3
  s_add_u32 s68, s68, s56
  v_add_f32_dpp v16, v16, v16 quad_perm:[2,3,0,1] row_mask:0xf bank_mask:0xf
  v_add_f32_dpp v17, v17, v17 quad_perm:[2,3,0,1] row_mask:0xf bank_mask:0xf
  v_add_f32_dpp v18, v18, v18 quad_perm:[2,3,0,1] row_mask:0xf bank_mask:0xf
  v_add_f32_dpp v19, v19, v19 quad_perm:[2,3,0,1] row_mask:0xf bank_mask:0xf
  v_cndmask_b32 v8, v16, v17, s[52:53]
  v_cndmask_b32 v9, v18, v19, s[52:53]
  v_mov_b32 v20, 64
  v_lshlrev_b32 v21, 3, s9
  v_add_f32_dpp v8, v8, v8 quad_perm:[1,0,3,2] row_mask:0xf bank_mask:0xf
  v_add_f32_dpp v9, v9, v9 quad_perm:[1,0,3,2] row_mask:0xf bank_mask:0xf
  v_cndmask_b32 v27, v8, v9, s[54:55]
  v_cvt_pk_bf16_f32 v27, 0, v27
  v_mul_f32 v27, 0x3db504f3, v27
  v_cvt_pk_bf16_f32 v27, 0, v27
  v_max_f32 v37, v37, v27
  v_cmp_ngt_f32 vcc, s22, v27
  v_mov_b32 v4, 0
  v_max_f32_dpp v37, v37, v37 row_ror:8 row_mask:0xf bank_mask:0xf
  s_bcnt1_i32_b64 s69, vcc
  s_add_u32 s69, s69, s20
  v_max_f32_dpp v37, v37, v37 row_ror:4 row_mask:0xf bank_mask:0xf
  s_cmp_gt_u32 s69, 32
  s_cselect_b32 s21, 1, s21
  v_max_f32_dpp v37, v37, v37 row_ror:2 row_mask:0xf bank_mask:0xf
  s_cmp_eq_u32 s21, 0
  s_cselect_b64 s[66:67], vcc, 0
  s_cselect_b32 s20, s69, s20
  v_max_f32_dpp v37, v37, v37 row_ror:1 row_mask:0xf bank_mask:0xf
  v_mbcnt_lo_u32_b32 v3, s66, 0
  v_mov_b32 v8, v37
  v_mbcnt_hi_u32_b32 v3, s67, v3
  v_lshl_add_u32 v3, v3, 3, s68
  v_permlane16_swap_b32 v8, v37
  s_mov_b64 exec, s[66:67]
  ds_write_b64 v3, v[26:27] offset:1280
  s_mov_b64 exec, -1
  ds_read_b32 v32, v39 offset:1024
  v_max_f32 v37, v37, v8
  v_mov_b32 v8, v37
  v_mov_b32 v5, 0
  s_mov_b32 s18, s32
  v_permlane32_swap_b32 v8, v37
  v_max_f32 v37, v37, v8
  v_sub_f32 v17, v25, v37
  v_sub_f32 v18, v27, v37
  v_mul_f32 v17, 0x3fb8aa3b, v17
  v_mul_f32 v18, 0x3fb8aa3b, v18
  v_exp_f32 v17, v17
  v_exp_f32 v18, v18
  v_mov_b32 v16, v37
  v_add_f32 v17, v17, v18
  s_waitcnt lgkmcnt(0)
  s_cmp_le_u32 s20, 0
  s_cbranch_scc1 L_x2
  v_add_u32_dpp v3, v32, v38 row_newbcast:8 row_mask:0xf bank_mask:0xf
  buffer_load_dwordx4 v[136:139], v3, s[48:51], 0 offen nt
  s_cmp_le_u32 s20, 4
  s_cbranch_scc1 L_x2
  v_add_u32_dpp v3, v32, v38 row_newbcast:9 row_mask:0xf bank_mask:0xf
  buffer_load_dwordx4 v[140:143], v3, s[48:51], 0 offen nt
  s_cmp_le_u32 s20, 8
  s_cbranch_scc1 L_x2
  v_add_u32_dpp v3, v32, v38 row_newbcast:10 row_mask:0xf bank_mask:0xf
  buffer_load_dwordx4 v[144:147], v3, s[48:51], 0 offen nt
  s_cmp_le_u32 s20, 12
  s_cbranch_scc1 L_x2
  v_add_u32_dpp v3, v32, v38 row_newbcast:11 row_mask:0xf bank_mask:0xf
  buffer_load_dwordx4 v[148:151], v3, s[48:51], 0 offen nt
  s_cmp_le_u32 s20, 16
  s_cbranch_scc1 L_x2
  v_add_u32_dpp v3, v32, v38 row_newbcast:12 row_mask:0xf bank_mask:0xf
  buffer_load_dwordx4 v[152:155], v3, s[48:51], 0 offen nt
  s_cmp_le_u32 s20, 20
  s_cbranch_scc1 L_x2
  v_add_u32_dpp v3, v32, v38 row_newbcast:13 row_mask:0xf bank_mask:0xf
  buffer_load_dwordx4 v[156:159], v3, s[48:51], 0 offen nt
  s_cmp_le_u32 s20, 24
  s_cbranch_scc1 L_x2
  v_add_u32_dpp v3, v32, v38 row_newbcast:14 row_mask:0xf bank_mask:0xf
  buffer_load_dwordx4 v[160:163], v3, s[48:51], 0 offen nt
  s_cmp_le_u32 s20, 28
  s_cbranch_scc1 L_x2
  v_add_u32_dpp v3, v32, v38 row_newbcast:15 row_mask:0xf bank_mask:0xf
  buffer_load_dwordx4 v[164:167], v3, s[48:51], 0 offen nt
L_x2:
  s_nop 1
  v_add_f32_dpp v17, v17, v17 row_ror:8 row_mask:0xf bank_mask:0xf
  s_nop 1
  v_add_f32_dpp v17, v17, v17 row_ror:4 row_mask:0xf bank_mask:0xf
  s_nop 1
  v_add_f32_dpp v17, v17, v17 row_ror:2 row_mask:0xf bank_mask:0xf
  s_nop 1
  v_add_f32_dpp v17, v17, v17 row_ror:1 row_mask:0xf bank_mask:0xf
  v_mov_b32 v8, v17
  s_nop 1
  v_permlane16_swap_b32 v8, v17
  v_add_f32 v17, v17, v8
  v_mov_b32 v8, v17
  s_nop 1
  v_permlane32_swap_b32 v8, v17
  v_add_f32 v17, v17, v8
  s_mov_b64 exec, 1
  ds_max_f32 v1, v37 offset:276
  ds_write_b64 v21, v[16:17] offset:512
  ds_add_u32 v1, v20 offset:272
  s_mov_b64 exec, -1
  s_mov_b32 s61, 1
  s_mov_b32 s19, 1
  s_cmp_lt_u32 s32, 5
  s_cbranch_scc1 L_ks2
L_x3:
  v_max_f32 v21, s23, v37
  s_add_u32 s38, s38, 3
  s_lshr_b32 s38, s38, 2
  v_add_f32 v21, 0xc2ac0000, v21
  s_max_u32 s38, s38, s32
  s_lshl_b32 s38, s38, 2
  v_cmp_nlt_f32 vcc, v27, v21
  s_lshl_b32 s68, s38, 3
  s_add_u32 s68, s68, s56
  s_andn2_b64 s[70:71], vcc, s[66:67]
  v_mbcnt_lo_u32_b32 v3, s70, 0
  v_mbcnt_hi_u32_b32 v3, s71, v3
  s_bcnt1_i32_b64 s69, s[70:71]
  v_lshl_add_u32 v3, v3, 3, s68
  s_mov_b64 exec, s[70:71]
  ds_write_b64 v3, v[26:27]
  s_mov_b64 exec, -1
  s_or_b64 s[66:67], s[66:67], s[70:71]
  s_add_u32 s38, s38, s69
  ds_read_b64 v[28:29], v39 offset:0
  ds_read_b64 v[30:31], v39 offset:512
  ds_read_b64 v[32:33], v39 offset:1024
  v_mov_b32 v8, 0
  v_mov_b32 v9, 0
  v_mov_b32 v10, 0
  v_mov_b32 v11, 0
  v_mov_b32 v12, 0
  v_mov_b32 v13, 0
  v_mov_b32 v14, 0
  v_mov_b32 v15, 0
  s_lshr_b32 s36, s38, 2
  s_mov_b32 s61, 2
  s_add_u32 s68, s38, 8
  s_lshr_b32 s68, s68, 2
  s_sub_u32 s69, s68, s59
  s_mov_b32 s59, s68
  s_add_u32 s35, s35, s69
  s_add_u32 s78, s78, s69
  v_mov_b32 v3, s69
  s_mov_b64 exec, 1
  ds_add_u32 v1, v3 offset:296
  s_mov_b64 exec, -1
  s_waitcnt lgkmcnt(0)
  v_sub_f32 v29, v29, v37
  v_sub_f32 v31, v31, v37
  v_sub_f32 v33, v33, v37
  v_mul_f32 v29, 0x3fb8aa3b, v29
  v_mul_f32 v31, 0x3fb8aa3b, v31
  v_mul_f32 v33, 0x3fb8aa3b, v33
  v_exp_f32 v29, v29
  v_exp_f32 v31, v31
  v_exp_f32 v33, v33
  s_nop 0
  v_cvt_pk_bf16_f32 v34, 0, v29
  v_cvt_pk_bf16_f32 v35, 0, v31
  v_cvt_pk_bf16_f32 v36, 0, v33
  v_cvt_pk_bf16_f32 v29, v29, 0
  v_cvt_pk_bf16_f32 v31, v31, 0
  v_cvt_pk_bf16_f32 v33, v33, 0
  s_cmp_eq_u32 s20, 0
  s_cselect_b32 s41, 0, s41
L_vs1:
  s_cmp_eq_u32 s19, 0
  s_cbranch_scc1 L_vs1b
  s_sub_u32 s68, s32, s18
  s_cmp_le_u32 s41, s68
  s_cbranch_scc1 L_snap
  s_cmp_lg_u32 s36, s32
  s_cbranch_scc1 L_vs2
  s_waitcnt vmcnt(0)
L_snap:
  v_mov_b32 v6, 0
  v_mov_b32 v7, 0
  v_mov_b32 v16, 0
  v_mov_b32 v17, 0
  v_mov_b32 v18, 0
  v_mov_b32 v19, 0
  s_cmp_le_u32 s20, 0
  s_cbranch_scc1 L_snp2
  v_dot2c_f32_bf16_dpp v4, v33, v136 row_newbcast:8 row_mask:0xf bank_mask:0xf
  v_dot2c_f32_bf16_dpp v5, v36, v136 row_newbcast:8 row_mask:0xf bank_mask:0xf
  v_dot2c_f32_bf16_dpp v6, v33, v137 row_newbcast:8 row_mask:0xf bank_mask:0xf
  v_dot2c_f32_bf16_dpp v7, v36, v137 row_newbcast:8 row_mask:0xf bank_mask:0xf
  v_dot2c_f32_bf16_dpp v16, v33, v138 row_newbcast:8 row_mask:0xf bank_mask:0xf
  v_dot2c_f32_bf16_dpp v17, v36, v138 row_newbcast:8 row_mask:0xf bank_mask:0xf
  v_dot2c_f32_bf16_dpp v18, v33, v139 row_newbcast:8 row_mask:0xf bank_mask:0xf
  v_dot2c_f32_bf16_dpp v19, v36, v139 row_newbcast:8 row_mask:0xf bank_mask:0xf
  s_cmp_le_u32 s20, 4
  s_cbranch_scc1 L_snp2
  v_dot2c_f32_bf16_dpp v4, v33, v140 row_newbcast:9 row_mask:0xf bank_mask:0xf
  v_dot2c_f32_bf16_dpp v5, v36, v140 row_newbcast:9 row_mask:0xf bank_mask:0xf
  v_dot2c_f32_bf16_dpp v6, v33, v141 row_newbcast:9 row_mask:0xf bank_mask:0xf
  v_dot2c_f32_bf16_dpp v7, v36, v141 row_newbcast:9 row_mask:0xf bank_mask:0xf
  v_dot2c_f32_bf16_dpp v16, v33, v142 row_newbcast:9 row_mask:0xf bank_mask:0xf
  v_dot2c_f32_bf16_dpp v17, v36, v142 row_newbcast:9 row_mask:0xf bank_mask:0xf
  v_dot2c_f32_bf16_dpp v18, v33, v143 row_newbcast:9 row_mask:0xf bank_mask:0xf
  v_dot2c_f32_bf16_dpp v19, v36, v143 row_newbcast:9 row_mask:0xf bank_mask:0xf
  s_cmp_le_u32 s20, 8
  s_cbranch_scc1 L_snp2
  v_dot2c_f32_bf16_dpp v4, v33, v144 row_newbcast:10 row_mask:0xf bank_mask:0xf
  v_dot2c_f32_bf16_dpp v5, v36, v144 row_newbcast:10 row_mask:0xf bank_mask:0xf
  v_dot2c_f32_bf16_dpp v6, v33, v145 row_newbcast:10 row_mask:0xf bank_mask:0xf
  v_dot2c_f32_bf16_dpp v7, v36, v145 row_newbcast:10 row_mask:0xf bank_mask:0xf
  v_dot2c_f32_bf16_dpp v16, v33, v146 row_newbcast:10 row_mask:0xf bank_mask:0xf
  v_dot2c_f32_bf16_dpp v17, v36, v146 row_newbcast:10 row_mask:0xf bank_mask:0xf
  v_dot2c_f32_bf16_dpp v18, v33, v147 row_newbcast:10 row_mask:0xf bank_mask:0xf
  v_dot2c_f32_bf16_dpp v19, v36, v147 row_newbcast:10 row_mask:0xf bank_mask:0xf
  s_cmp_le_u32 s20, 12
  s_cbranch_scc1 L_snp2
  v_dot2c_f32_bf16_dpp v4, v33, v148 row_newbcast:11 row_mask:0xf bank_mask:0xf
  v_dot2c_f32_bf16_dpp v5, v36, v148 row_newbcast:11 row_mask:0xf bank_mask:0xf
  v_dot2c_f32_bf16_dpp v6, v33, v149 row_newbcast:11 row_mask:0xf bank_mask:0xf
  v_dot2c_f32_bf16_dpp v7, v36, v149 row_newbcast:11 row_mask:0xf bank_mask:0xf
  v_dot2c_f32_bf16_dpp v16, v33, v150 row_newbcast:11 row_mask:0xf bank_mask:0xf
  v_dot2c_f32_bf16_dpp v17, v36, v150 row_newbcast:11 row_mask:0xf bank_mask:0xf
  v_dot2c_f32_bf16_dpp v18, v33, v151 row_newbcast:11 row_mask:0xf bank_mask:0xf
  v_dot2c_f32_bf16_dpp v19, v36, v151 row_newbcast:11 row_mask:0xf bank_mask:0xf
  s_cmp_le_u32 s20, 16
  s_cbranch_scc1 L_snp2
  v_dot2c_f32_bf16_dpp v4, v33, v152 row_newbcast:12 row_mask:0xf bank_mask:0xf
  v_dot2c_f32_bf16_dpp v5, v36, v152 row_newbcast:12 row_mask:0xf bank_mask:0xf
  v_dot2c_f32_bf16_dpp v6, v33, v153 row_newbcast:12 row_mask:0xf bank_mask:0xf
  v_dot2c_f32_bf16_dpp v7, v36, v153 row_newbcast:12 row_mask:0xf bank_mask:0xf
  v_dot2c_f32_bf16_dpp v16, v33, v154 row_newbcast:12 row_mask:0xf bank_mask:0xf
  v_dot2c_f32_bf16_dpp v17, v36, v154 row_newbcast:12 row_mask:0xf bank_mask:0xf
  v_dot2c_f32_bf16_dpp v18, v33, v155 row_newbcast:12 row_mask:0xf bank_mask:0xf
  v_dot2c_f32_bf16_dpp v19, v36, v155 row_newbcast:12 row_mask:0xf bank_mask:0xf
  s_cmp_le_u32 s20, 20
  s_cbranch_scc1 L_snp2
  v_dot2c_f32_bf16_dpp v4, v33, v156 row_newbcast:13 row_mask:0xf bank_mask:0xf
  v_dot2c_f32_bf16_dpp v5, v36, v156 row_newbcast:13 row_mask:0xf bank_mask:0xf
  v_dot2c_f32_bf16_dpp v6, v33, v157 row_newbcast:13 row_mask:0xf bank_mask:0xf
  v_dot2c_f32_bf16_dpp v7, v36, v157 row_newbcast:13 row_mask:0xf bank_mask:0xf
  v_dot2c_f32_bf16_dpp v16, v33, v158 row_newbcast:13 row_mask:0xf bank_mask:0xf
  v_dot2c_f32_bf16_dpp v17, v36, v158 row_newbcast:13 row_mask:0xf bank_mask:0xf
  v_dot2c_f32_bf16_dpp v18, v33, v159 row_newbcast:13 row_mask:0xf bank_mask:0xf
  v_dot2c_f32_bf16_dpp v19, v36, v159 row_newbcast:13 row_mask:0xf bank_mask:0xf
  s_cmp_le_u32 s20, 24
  s_cbranch_scc1 L_snp2
  v_dot2c_f32_bf16_dpp v4, v33, v160 row_newbcast:14 row_mask:0xf bank_mask:0xf
  v_dot2c_f32_bf16_dpp v5, v36, v160 row_newbcast:14 row_mask:0xf bank_mask:0xf
  v_dot2c_f32_bf16_dpp v6, v33, v161 row_newbcast:14 row_mask:0xf bank_mask:0xf
  v_dot2c_f32_bf16_dpp v7, v36, v161 row_newbcast:14 row_mask:0xf bank_mask:0xf
  v_dot2c_f32_bf16_dpp v16, v33, v162 row_newbcast:14 row_mask:0xf bank_mask:0xf
  v_dot2c_f32_bf16_dpp v17, v36, v162 row_newbcast:14 row_mask:0xf bank_mask:0xf
  v_dot2c_f32_bf16_dpp v18, v33, v163 row_newbcast:14 row_mask:0xf bank_mask:0xf
  v_dot2c_f32_bf16_dpp v19, v36, v163 row_newbcast:14 row_mask:0xf bank_mask:0xf
  s_cmp_le_u32 s20, 28
  s_cbranch_scc1 L_snp2
  v_dot2c_f32_bf16_dpp v4, v33, v164 row_newbcast:15 row_mask:0xf bank_mask:0xf
  v_dot2c_f32_bf16_dpp v5, v36, v164 row_newbcast:15 row_mask:0xf bank_mask:0xf
  v_dot2c_f32_bf16_dpp v6, v33, v165 row_newbcast:15 row_mask:0xf bank_mask:0xf
  v_dot2c_f32_bf16_dpp v7, v36, v165 row_newbcast:15 row_mask:0xf bank_mask:0xf
  v_dot2c_f32_bf16_dpp v16, v33, v166 row_newbcast:15 row_mask:0xf bank_mask:0xf
  v_dot2c_f32_bf16_dpp v17, v36, v166 row_newbcast:15 row_mask:0xf bank_mask:0xf
  v_dot2c_f32_bf16_dpp v18, v33, v167 row_newbcast:15 row_mask:0xf bank_mask:0xf
  v_dot2c_f32_bf16_dpp v19, v36, v167 row_newbcast:15 row_mask:0xf bank_mask:0xf
L_snp2:
  s_nop 1
  v_add_u32 v21, s11, v39
  v_permlane32_swap_b32 v4, v16
  v_permlane32_swap_b32 v5, v17
  v_permlane32_swap_b32 v6, v18
  v_permlane32_swap_b32 v7, v19
  v_add_f32 v4, v4, v16
  v_add_f32 v5, v5, v17
  v_add_f32 v6, v6, v18
  v_add_f32 v7, v7, v19
  v_mov_b32 v3, 1
  v_permlane16_swap_b32 v4, v6
  v_permlane16_swap_b32 v5, v7
  v_add_f32 v4, v4, v6
  v_add_f32 v5, v5, v7
  s_mov_b32 s19, 0
  s_cmp_lg_u32 s21, 0
  s_cbranch_scc1 L_vs1b
  ds_write_b64 v21, v[4:5] offset:6656
  s_mov_b64 exec, 1
  ds_add_u32 v1, v3 offset:304
  s_mov_b64 exec, -1
  s_branch L_vs1b
L_vq:
  v_readfirstlane_b32 s78, v22
  v_readfirstlane_b32 s79, v23
L_vs1b:
  s_cmp_eq_u32 s36, s32
  s_cbranch_scc1 L_hand
L_vs2:
  s_cmp_lt_u32 s32, s37
  s_cbranch_scc1 L_ks2
  s_sub_u32 s41, s36, s32
  s_add_u32 s32, s32, 1
  s_cmp_gt_u32 s41, 5
  s_cbranch_scc1 L_wait
  s_waitcnt vmcnt(4)
  s_cmp_ge_u32 s41, 5
  s_cbranch_scc1 L_ret2
  s_waitcnt vmcnt(3)
  s_cmp_ge_u32 s41, 4
  s_cbranch_scc1 L_ret2
  s_waitcnt vmcnt(2)
  s_cmp_ge_u32 s41, 3
  s_cbranch_scc1 L_ret2
  s_waitcnt vmcnt(1)
  s_cmp_ge_u32 s41, 2
  s_cbranch_scc1 L_ret2
  s_waitcnt vmcnt(0)
L_ret2:
  s_cmp_eq_u32 s32, s32
  s_setpc_b64 s[62:63]
L_hand:
  v_mov_b32 v3, 0
  s_mov_b32 s70, 0
L_sn_3:
  ds_read_b64 v[18:19], v3 offset:272
  s_waitcnt lgkmcnt(0)
  v_cmp_gt_u32 vcc, 0x102c0, v18
  s_cmp_eq_u64 vcc, 0
  s_cbranch_scc1 L_snd_4
  s_sleep 1
  s_add_u32 s70, s70, 1
  s_cmp_lt_u32 s70, 2097152
  s_cbranch_scc1 L_sn_3
L_snd_4:
  v_add_f32 v21, 0xc2ba0000, v19
  v_cmp_nlt_f32 vcc, v25, v21
  s_lshl_b32 s68, s38, 3
  s_add_u32 s68, s68, s56
  s_andn2_b64 s[70:71], vcc, s[64:65]
  v_mbcnt_lo_u32_b32 v3, s70, 0
  v_mbcnt_hi_u32_b32 v3, s71, v3
  s_bcnt1_i32_b64 s69, s[70:71]
  v_lshl_add_u32 v3, v3, 3, s68
  s_mov_b64 exec, s[70:71]
  ds_write_b64 v3, v[24:25]
  s_mov_b64 exec, -1
  s_or_b64 s[64:65], s[64:65], s[70:71]
  s_add_u32 s38, s38, s69
  v_cmp_nlt_f32 vcc, v27, v21
  s_lshl_b32 s68, s38, 3
  s_add_u32 s68, s68, s56
  s_andn2_b64 s[70:71], vcc, s[66:67]
  v_mbcnt_lo_u32_b32 v3, s70, 0
  v_mbcnt_hi_u32_b32 v3, s71, v3
  s_bcnt1_i32_b64 s69, s[70:71]
  v_lshl_add_u32 v3, v3, 3, s68
  s_mov_b64 exec, s[70:71]
  ds_write_b64 v3, v[26:27]
  s_mov_b64 exec, -1
  s_or_b64 s[66:67], s[66:67], s[70:71]
  s_add_u32 s38, s38, s69
  ds_read_b64 v[28:29], v39 offset:0
  ds_read_b64 v[30:31], v39 offset:512
  ds_read_b64 v[32:33], v39 offset:1024
  s_add_u32 s36, s38, 23
  s_lshr_b32 s36, s36, 2
  s_sub_u32 s37, s36, 8
  s_max_i32 s37, s37, 0
  s_mov_b32 s75, s36
  s_add_u32 s68, s38, 3
  s_lshr_b32 s68, s68, 2
  s_sub_u32 s69, s68, s59
  s_mov_b32 s59, s68
  s_add_u32 s35, s35, s69
  s_add_u32 s78, s78, s69
  v_mov_b32 v3, s69
  s_mov_b64 exec, 1
  ds_add_u32 v1, v3 offset:296
  s_mov_b64 exec, -1
  s_waitcnt lgkmcnt(0)
  v_sub_f32 v29, v29, v37
  v_sub_f32 v31, v31, v37
  v_sub_f32 v33, v33, v37
  v_mul_f32 v29, 0x3fb8aa3b, v29
  v_mul_f32 v31, 0x3fb8aa3b, v31
  v_mul_f32 v33, 0x3fb8aa3b, v33
  v_exp_f32 v29, v29
  v_exp_f32 v31, v31
  v_exp_f32 v33, v33
  s_nop 0
  v_cvt_pk_bf16_f32 v34, 0, v29
  v_cvt_pk_bf16_f32 v35, 0, v31
  v_cvt_pk_bf16_f32 v36, 0, v33
  v_cvt_pk_bf16_f32 v29, v29, 0
  v_cvt_pk_bf16_f32 v31, v31, 0
  v_cvt_pk_bf16_f32 v33, v33, 0
  s_branch L_vs2
L_work:
  s_cmp_eq_u32 s39, 1
  s_cbranch_scc1 L_w1
  s_cmp_eq_u32 s39, 2
  s_cbranch_scc1 L_w2
  s_cmp_eq_u32 s39, 3
  s_cbranch_scc1 L_w3
L_w0:
  s_load_dwordx16 s[16:31], s[42:43], s40 glc
  s_mov_b32 s39, 1
L_wr:
  s_setpc_b64 s[100:101]
L_w1:
  s_waitcnt lgkmcnt(0)
  s_xor_b32 s68, s17, s74
  s_xor_b32 s69, s19, s74
  s_or_b32 s68, s68, s69
  s_xor_b32 s69, s21, s74
  s_or_b32 s68, s68, s69
  s_xor_b32 s69, s23, s74
  s_or_b32 s68, s68, s69
  s_xor_b32 s69, s25, s74
  s_or_b32 s68, s68, s69
  s_xor_b32 s69, s27, s74
  s_or_b32 s68, s68, s69
  s_xor_b32 s69, s29, s74
  s_or_b32 s68, s68, s69
  s_xor_b32 s69, s31, s74
  s_or_b32 s68, s68, s69
  s_cbranch_scc1 L_w0
  v_mov_b32 v8, s16
  v_mov_b32 v9, s18
  v_mov_b32 v10, s20
  v_mov_b32 v11, s22
  v_mov_b32 v12, s24
  v_mov_b32 v13, s26
  v_mov_b32 v14, s28
  v_mov_b32 v15, s30
  v_lshlrev_b32 v3, 5, s9
  s_mov_b64 exec, 1
  ds_write_b128 v3, v[8:11] offset:0
  ds_write_b128 v3, v[12:15] offset:16
  s_mov_b64 exec, -1
  s_mov_b32 s39, 2
L_w2:
  s_add_u32 s68, s41, 16
  s_cmp_lt_u32 s32, s68
  s_cbranch_scc1 L_wr
  ds_read_b128 v[4:7], v38 offset:0
  s_waitcnt lgkmcnt(0)
  v_max3_u32 v8, v4, v5, v6
  v_max_u32 v8, v8, v7
  v_cmp_eq_u32 vcc, -1, v8
  s_cmp_lg_u64 vcc, 0
  s_cbranch_scc1 L_wr
  v_dot2_f32_bf16 v8, v40, v4, 0
  v_dot2_f32_bf16 v9, v44, v4, 0
  v_dot2_f32_bf16 v10, v48, v4, 0
  v_dot2_f32_bf16 v11, v52, v4, 0
  v_dot2_f32_bf16 v12, v56, v4, 0
  v_dot2_f32_bf16 v13, v60, v4, 0
  v_dot2_f32_bf16 v14, v64, v4, 0
  v_dot2_f32_bf16 v15, v68, v4, 0
  v_dot2_f32_bf16 v8, v41, v5, v8
  v_dot2_f32_bf16 v9, v45, v5, v9
  v_dot2_f32_bf16 v10, v49, v5, v10
  v_dot2_f32_bf16 v11, v53, v5, v11
  v_dot2_f32_bf16 v12, v57, v5, v12
  v_dot2_f32_bf16 v13, v61, v5, v13
  v_dot2_f32_bf16 v14, v65, v5, v14
  v_dot2_f32_bf16 v15, v69, v5, v15
  v_dot2_f32_bf16 v8, v42, v6, v8
  v_dot2_f32_bf16 v9, v46, v6, v9
  v_dot2_f32_bf16 v10, v50, v6, v10
  v_dot2_f32_bf16 v11, v54, v6, v11
  v_dot2_f32_bf16 v12, v58, v6, v12
  v_dot2_f32_bf16 v13, v62, v6, v13
  v_dot2_f32_bf16 v14, v66, v6, v14
  v_dot2_f32_bf16 v15, v70, v6, v15
  v_dot2_f32_bf16 v8, v43, v7, v8
  v_dot2_f32_bf16 v9, v47, v7, v9
  v_dot2_f32_bf16 v10, v51, v7, v10
  v_dot2_f32_bf16 v11, v55, v7, v11
  v_dot2_f32_bf16 v12, v59, v7, v12
  v_dot2_f32_bf16 v13, v63, v7, v13
  v_dot2_f32_bf16 v14, v67, v7, v14
  v_dot2_f32_bf16 v15, v71, v7, v15
  v_add_f32_dpp v8, v8, v8 row_ror:8 row_mask:0xf bank_mask:0x3
  v_add_f32_dpp v8, v9, v9 row_ror:8 row_mask:0xf bank_mask:0xc
  v_add_f32_dpp v10, v10, v10 row_ror:8 row_mask:0xf bank_mask:0x3
  v_add_f32_dpp v10, v11, v11 row_ror:8 row_mask:0xf bank_mask:0xc
  v_add_f32_dpp v12, v12, v12 row_ror:8 row_mask:0xf bank_mask:0x3
  v_add_f32_dpp v12, v13, v13 row_ror:8 row_mask:0xf bank_mask:0xc
  v_add_f32_dpp v14, v14, v14 row_ror:8 row_mask:0xf bank_mask:0x3
  v_add_f32_dpp v14, v15, v15 row_ror:8 row_mask:0xf bank_mask:0xc
  v_add_f32_dpp v16, v8, v8 row_shl:4 row_mask:0xf bank_mask:0x5
  v_add_f32_dpp v16, v10, v10 row_shr:4 row_mask:0xf bank_mask:0xa
  v_add_f32_dpp v17, v12, v12 row_shl:4 row_mask:0xf bank_mask:0x5
  v_add_f32_dpp v17, v14, v14 row_shr:4 row_mask:0xf bank_mask:0xa
  v_dot2_f32_bf16 v8, v72, v4, 0
  v_dot2_f32_bf16 v9, v76, v4, 0
  v_dot2_f32_bf16 v10, v80, v4, 0
  v_dot2_f32_bf16 v11, v84, v4, 0
  v_dot2_f32_bf16 v12, v88, v4, 0
  v_dot2_f32_bf16 v13, v92, v4, 0
  v_dot2_f32_bf16 v14, v96, v4, 0
  v_dot2_f32_bf16 v15, v100, v4, 0
  v_dot2_f32_bf16 v8, v73, v5, v8
  v_dot2_f32_bf16 v9, v77, v5, v9
  v_dot2_f32_bf16 v10, v81, v5, v10
  v_dot2_f32_bf16 v11, v85, v5, v11
  v_dot2_f32_bf16 v12, v89, v5, v12
  v_dot2_f32_bf16 v13, v93, v5, v13
  v_dot2_f32_bf16 v14, v97, v5, v14
  v_dot2_f32_bf16 v15, v101, v5, v15
  v_dot2_f32_bf16 v8, v74, v6, v8
  v_dot2_f32_bf16 v9, v78, v6, v9
  v_dot2_f32_bf16 v10, v82, v6, v10
  v_dot2_f32_bf16 v11, v86, v6, v11
  v_dot2_f32_bf16 v12, v90, v6, v12
  v_dot2_f32_bf16 v13, v94, v6, v13
  v_dot2_f32_bf16 v14, v98, v6, v14
  v_dot2_f32_bf16 v15, v102, v6, v15
  v_dot2_f32_bf16 v8, v75, v7, v8
  v_dot2_f32_bf16 v9, v79, v7, v9
  v_dot2_f32_bf16 v10, v83, v7, v10
  v_dot2_f32_bf16 v11, v87, v7, v11
  v_dot2_f32_bf16 v12, v91, v7, v12
  v_dot2_f32_bf16 v13, v95, v7, v13
  v_dot2_f32_bf16 v14, v99, v7, v14
  v_dot2_f32_bf16 v15, v103, v7, v15
  v_add_f32_dpp v8, v8, v8 row_ror:8 row_mask:0xf bank_mask:0x3
  v_add_f32_dpp v8, v9, v9 row_ror:8 row_mask:0xf bank_mask:0xc
  v_add_f32_dpp v10, v10, v10 row_ror:8 row_mask:0xf bank_mask:0x3
  v_add_f32_dpp v10, v11, v11 row_ror:8 row_mask:0xf bank_mask:0xc
  v_add_f32_dpp v12, v12, v12 row_ror:8 row_mask:0xf bank_mask:0x3
  v_add_f32_dpp v12, v13, v13 row_ror:8 row_mask:0xf bank_mask:0xc
  v_add_f32_dpp v14, v14, v14 row_ror:8 row_mask:0xf bank_mask:0x3
  v_add_f32_dpp v14, v15, v15 row_ror:8 row_mask:0xf bank_mask:0xc
  v_add_f32_dpp v18, v8, v8 row_shl:4 row_mask:0xf bank_mask:0x5
  v_add_f32_dpp v18, v10, v10 row_shr:4 row_mask:0xf bank_mask:0xa
  v_add_f32_dpp v19, v12, v12 row_shl:4 row_mask:0xf bank_mask:0x5
  v_add_f32_dpp v19, v14, v14 row_shr:4 row_mask:0xf bank_mask:0xa
  v_mov_b32 v3, 0
  v_mov_b32 v20, 64
  v_add_f32_dpp v16, v16, v16 quad_perm:[2,3,0,1] row_mask:0xf bank_mask:0xf
  v_add_f32_dpp v17, v17, v17 quad_perm:[2,3,0,1] row_mask:0xf bank_mask:0xf
  v_add_f32_dpp v18, v18, v18 quad_perm:[2,3,0,1] row_mask:0xf bank_mask:0xf
  v_add_f32_dpp v19, v19, v19 quad_perm:[2,3,0,1] row_mask:0xf bank_mask:0xf
  v_cndmask_b32 v8, v16, v17, s[52:53]
  v_cndmask_b32 v9, v18, v19, s[52:53]
  s_nop 0
  v_lshlrev_b32 v21, 3, s9
  v_add_f32_dpp v8, v8, v8 quad_perm:[1,0,3,2] row_mask:0xf bank_mask:0xf
  v_add_f32_dpp v9, v9, v9 quad_perm:[1,0,3,2] row_mask:0xf bank_mask:0xf
  v_cndmask_b32 v25, v8, v9, s[54:55]
  v_cvt_pk_bf16_f32 v25, 0, v25
  v_mul_f32 v25, 0x3db504f3, v25
  v_cvt_pk_bf16_f32 v25, 0, v25
  v_mov_b32 v37, v25
  s_nop 1
  v_max_f32_dpp v37, v37, v37 row_ror:8 row_mask:0xf bank_mask:0xf
  s_nop 1
  v_max_f32_dpp v37, v37, v37 row_ror:4 row_mask:0xf bank_mask:0xf
  s_nop 1
  v_max_f32_dpp v37, v37, v37 row_ror:2 row_mask:0xf bank_mask:0xf
  s_nop 1
  v_max_f32_dpp v37, v37, v37 row_ror:1 row_mask:0xf bank_mask:0xf
  v_mov_b32 v8, v37
  s_nop 1
  v_permlane16_swap_b32 v8, v37
  v_max_f32 v37, v37, v8
  v_mov_b32 v8, v37
  s_nop 1
  v_permlane32_swap_b32 v8, v37
  v_max_f32 v37, v37, v8
  s_mov_b64 exec, 1
  ds_max_f32 v3, v37 offset:284
  ds_add_u32 v3, v20 offset:280
  s_mov_b64 exec, -1
  s_mov_b32 s39, 3
  s_mov_b32 s19, 0
  s_setpc_b64 s[100:101]
L_w3:
  v_mov_b32 v3, 0
  ds_read_b64 v[18:19], v3 offset:280
  s_waitcnt lgkmcnt(0)
  v_cmp_gt_u32 vcc, 0x102c0, v18
  s_cmp_lg_u64 vcc, 0
  s_cbranch_scc1 L_wr
  ds_read_b64 v[20:21], v3 offset:320
  s_waitcnt lgkmcnt(0)
  v_add_f32 v21, 0xc1c00000, v21
  v_cmp_nlt_f32 vcc, v25, v21
  v_readfirstlane_b32 s22, v21
  v_readfirstlane_b32 s23, v20
  s_mov_b32 s20, 0
  s_bcnt1_i32_b64 s68, vcc
  s_cmp_gt_u32 s68, 32
  s_cselect_b32 s21, 1, 0
  s_cbranch_scc1 L_w4
  s_mov_b32 s38, 160
  v_cmp_nlt_f32 vcc, v25, v21
  s_lshl_b32 s68, s38, 3
  s_add_u32 s68, s68, s56
  s_andn2_b64 s[70:71], vcc, s[64:65]
  v_mbcnt_lo_u32_b32 v3, s70, 0
  v_mbcnt_hi_u32_b32 v3, s71, v3
  s_bcnt1_i32_b64 s69, s[70:71]
  v_lshl_add_u32 v3, v3, 3, s68
  s_mov_b64 exec, s[70:71]
  ds_write_b64 v3, v[24:25]
  s_mov_b64 exec, -1
  s_or_b64 s[64:65], s[64:65], s[70:71]
  s_add_u32 s38, s38, s69
  s_mov_b32 s20, s69
  s_mov_b32 s38, 0
L_w4:
  v_add_f32 v21, 0xc2ac0000, v20
  v_cmp_nlt_f32 vcc, v25, v21
  s_lshl_b32 s68, s38, 3
  s_add_u32 s68, s68, s56
  s_andn2_b64 s[70:71], vcc, s[64:65]
  v_mbcnt_lo_u32_b32 v3, s70, 0
  v_mbcnt_hi_u32_b32 v3, s71, v3
  s_bcnt1_i32_b64 s69, s[70:71]
  v_lshl_add_u32 v3, v3, 3, s68
  s_mov_b64 exec, s[70:71]
  ds_write_b64 v3, v[24:25]
  s_mov_b64 exec, -1
  s_or_b64 s[64:65], s[64:65], s[70:71]
  s_add_u32 s38, s38, s69
  s_add_u32 s68, s38, 4
  s_lshr_b32 s68, s68, 1
  s_sub_u32 s69, s68, s59
  s_mov_b32 s59, s68
  v_mov_b32 v3, s69
  s_mov_b64 exec, 1
  ds_add_u32 v1, v3 offset:296
  s_mov_b64 exec, -1
  s_mov_b32 s39, 4
  ds_read_b64 v[28:29], v39 offset:0
  s_waitcnt lgkmcnt(0)
  s_setpc_b64 s[100:101]
L_pub:
  s_getpc_b64 s[56:57]
L_pct:
  s_lshr_b32 s3, s2, 3
  s_lshl_b32 s3, s3, 2
  s_add_u32 s3, s3, L_touch-L_pct
  s_load_dword s14, s[56:57], s3
  s_waitcnt lgkmcnt(0)
  s_bfe_u32 s48, s14, 0x30000
  s_lshl_b32 s48, s48, 6
  v_add_u32 v2, s48, v1
  s_bfe_u32 s48, s14, 0x30003
  s_bitcmp1_b32 s14, 7
  s_cbranch_scc1 L_te_6
  s_bitcmp1_b32 s14, 6
  s_cbranch_scc1 L_tq_5
  s_lshl1_add_u32 s48, s8, s48
  s_lshl_b32 s48, s48, 7
  v_mul_u32_u24 v2, 6144, v2
  v_add_u32 v2, s48, v2
  global_load_dword v167, v2, s[36:37]
  s_branch L_te_6
L_tq_5:
  s_lshl3_add_u32 s48, s8, s48
  s_lshl_b32 s48, s48, 7
  v_lshl_add_u32 v2, v2, 13, s48
  global_load_dword v167, v2, s[22:23]
L_te_6:
  s_bfe_u32 s48, s14, 0x30008
  s_lshl_b32 s48, s48, 6
  v_add_u32 v2, s48, v1
  s_bfe_u32 s48, s14, 0x3000b
  s_bitcmp1_b32 s14, 15
  s_cbranch_scc1 L_te_8
  s_bitcmp1_b32 s14, 14
  s_cbranch_scc1 L_tq_7
  s_lshl1_add_u32 s48, s8, s48
  s_lshl_b32 s48, s48, 7
  v_mul_u32_u24 v2, 6144, v2
  v_add_u32 v2, s48, v2
  global_load_dword v167, v2, s[36:37]
  s_branch L_te_8
L_tq_7:
  s_lshl3_add_u32 s48, s8, s48
  s_lshl_b32 s48, s48, 7
  v_lshl_add_u32 v2, v2, 13, s48
  global_load_dword v167, v2, s[22:23]
L_te_8:
  v_mov_b32 v38, 0
  v_mov_b32 v4, -1
  v_mov_b32 v8, 0xff800000
  v_mov_b32 v9, 0
  v_lshlrev_b32 v2, 3, v1
  ds_write_b64 v2, v[8:9] offset:448
  v_mov_b32 v5, 0
  v_mov_b32 v6, 0
  v_mov_b32 v7, 0
  ds_write_b64 v2, v[6:7] offset:6144
  ds_write_b64 v2, v[6:7] offset:11776
  v_lshlrev_b32 v2, 2, v1
  ds_write_b32 v2, v4 offset:0
  s_lshr_b32 s10, s7, 1
  ds_write_b128 v38, v[4:7] offset:256
  v_lshlrev_b32 v10, 6, s10
  v_mov_b32 v11, v8
  v_mov_b32 v12, v10
  v_mov_b32 v13, v8
  ds_write_b128 v38, v[10:13] offset:272
  s_mul_i32 s11, s10, 29
  s_sub_u32 s11, 1343, s11
  v_mov_b32 v10, s11
  v_mov_b32 v11, 0
  v_mov_b32 v12, 1024
  v_mov_b32 v13, 0
  ds_write_b128 v38, v[10:13] offset:288
  v_mov_b32 v4, s10
  v_mov_b32 v5, s10
  ds_write_b128 v38, v[4:7] offset:304
  s_getreg_b32 s76, hwreg(HW_REG_XCC_ID, 0, 4)
  s_waitcnt lgkmcnt(0)
  s_load_dword s74, s[42:43], 0
  s_barrier
  s_waitcnt lgkmcnt(0)
  s_mul_i32 s74, s74, 0x9e3779b1
  s_add_u32 s74, s74, 0x7f4a7c15
  s_add_u32 s76, s76, s74
  s_add_u32 s52, s7, 1
  s_cmp_eq_u32 s52, 3
  s_cselect_b32 s52, 0, s52
  s_add_u32 s53, s52, s7
  s_sub_u32 s53, 3, s53
  s_lshl2_add_u32 s54, s6, s52
  s_lshl_b32 s54, s54, 7
  s_lshl2_add_u32 s55, s6, s53
  s_lshl_b32 s55, s55, 7
  s_lshl2_add_u32 s64, s6, s7
  s_lshl_b32 s64, s64, 7
  s_add_u32 s64, s64, 65536
  v_mov_b32 v18, s64
  v_add_u32 v19, 32768, v18
  v_mov_b32 v17, 0x10000
  s_mov_b32 s70, 0
L_sn_9:
  ds_read_b64 v[8:9], v38 offset:280
  s_waitcnt lgkmcnt(0)
  v_cmp_gt_u32 vcc, 0x2c0, v8
  s_cmp_eq_u64 vcc, 0
  s_cbranch_scc1 L_snd_10
  s_sleep 2
  s_add_u32 s70, s70, 1
  s_cmp_lt_u32 s70, 2097152
  s_cbranch_scc1 L_sn_9
L_snd_10:
  s_load_dwordx2 s[20:21], s[42:43], s54 offset:65536 glc
  s_load_dwordx2 s[24:25], s[42:43], s55 offset:65536 glc
  v_mov_b32 v8, v9
  v_mov_b32 v9, s74
  s_mov_b64 exec, 1
  global_store_dwordx2 v18, v[8:9], s[42:43] sc1
  s_mov_b32 s70, 0
  s_branch L_s3ec
L_s3e:
  s_load_dwordx2 s[20:21], s[42:43], s54 offset:65536 glc
  s_load_dwordx2 s[24:25], s[42:43], s55 offset:65536 glc
L_s3ec:
  s_waitcnt lgkmcnt(0)
  s_xor_b32 s68, s21, s74
  s_xor_b32 s69, s25, s74
  s_or_b32 s68, s68, s69
  s_cbranch_scc0 L_s3ed
  s_sleep 2
  s_add_u32 s70, s70, 1
  s_cmp_lt_u32 s70, 262144
  s_cbranch_scc1 L_s3e
L_s3ed:
  v_mov_b32 v12, s20
  v_max3_f32 v10, v8, v12, s24
  v_min3_f32 v11, v8, v12, s24
  ds_write_b64 v38, v[10:11] offset:320
  ds_add_u32 v38, v17 offset:280
  s_mov_b64 exec, -1
  s_lshl_b32 s64, s8, 7
  s_load_dwordx8 s[20:27], s[42:43], s64 offset:1024 glc
  s_waitcnt lgkmcnt(0)
  s_xor_b32 s68, s20, s76
  s_xor_b32 s69, s21, s76
  s_or_b32 s68, s68, s69
  s_xor_b32 s69, s22, s76
  s_or_b32 s68, s68, s69
  s_xor_b32 s69, s23, s76
  s_or_b32 s68, s68, s69
  s_xor_b32 s69, s24, s76
  s_or_b32 s68, s68, s69
  s_xor_b32 s69, s25, s76
  s_or_b32 s68, s68, s69
  s_xor_b32 s69, s26, s76
  s_or_b32 s68, s68, s69
  s_xor_b32 s69, s27, s76
  s_or_b32 s68, s68, s69
  s_cselect_b32 s75, 0, 1
  v_lshlrev_b32 v20, 3, s7
  v_lshlrev_b32 v21, 3, s52
  v_lshlrev_b32 v22, 3, s53
  s_mov_b32 s70, 0
L_sn_11:
  ds_read_b32 v8, v38 offset:272
  s_waitcnt lgkmcnt(0)
  v_cmp_gt_u32 vcc, 0x2c0, v8
  s_cmp_eq_u64 vcc, 0
  s_cbranch_scc1 L_snd_12
  s_sleep 1
  s_add_u32 s70, s70, 1
  s_cmp_lt_u32 s70, 2097152
  s_cbranch_scc1 L_sn_11
L_snd_12:
  v_and_b32 v9, 15, v1
  v_lshlrev_b32 v9, 3, v9
  ds_read_b64 v[10:11], v9 offset:512
  s_waitcnt lgkmcnt(0)
  v_mov_b32 v16, v10
  v_max_f32_dpp v8, v10, v10 quad_perm:[1,0,3,2] row_mask:0xf bank_mask:0xf
  s_nop 1
  v_max_f32_dpp v8, v8, v8 quad_perm:[2,3,0,1] row_mask:0xf bank_mask:0xf
  s_nop 1
  v_max_f32_dpp v8, v8, v8 row_half_mirror row_mask:0xf bank_mask:0xf
  s_nop 1
  v_max_f32_dpp v8, v8, v8 row_mirror row_mask:0xf bank_mask:0xf
  v_sub_f32 v9, v10, v8
  v_mul_f32 v9, 0x3fb8aa3b, v9
  v_exp_f32 v9, v9
  s_nop 0
  v_mul_f32 v10, v9, v11
  s_nop 1
  v_add_f32_dpp v10, v10, v10 quad_perm:[1,0,3,2] row_mask:0xf bank_mask:0xf
  s_nop 1
  v_add_f32_dpp v10, v10, v10 quad_perm:[2,3,0,1] row_mask:0xf bank_mask:0xf
  s_nop 1
  v_add_f32_dpp v10, v10, v10 row_half_mirror row_mask:0xf bank_mask:0xf
  s_nop 1
  v_add_f32_dpp v10, v10, v10 row_mirror row_mask:0xf bank_mask:0xf
  s_load_dwordx4 s[20:23], s[42:43], s54 offset:98304 glc
  s_load_dwordx4 s[24:27], s[42:43], s55 offset:98304 glc
  v_mov_b32 v9, s74
  v_mov_b32 v11, s74
  s_mov_b64 exec, 1
  global_store_dwordx4 v19, v[8:11], s[42:43] sc1
  ds_write_b32 v20, v8 offset:448
  ds_write_b32 v20, v10 offset:452
  s_mov_b32 s70, 0
  s_branch L_s3pc
L_s3p:
  s_load_dwordx4 s[20:23], s[42:43], s54 offset:98304 glc
  s_load_dwordx4 s[24:27], s[42:43], s55 offset:98304 glc
L_s3pc:
  s_waitcnt lgkmcnt(0)
  s_xor_b32 s68, s21, s74
  s_xor_b32 s69, s23, s74
  s_or_b32 s68, s68, s69
  s_xor_b32 s69, s25, s74
  s_or_b32 s68, s68, s69
  s_xor_b32 s69, s27, s74
  s_or_b32 s68, s68, s69
  s_cbranch_scc0 L_s3pd
  s_sleep 2
  s_add_u32 s70, s70, 1
  s_cmp_lt_u32 s70, 262144
  s_cbranch_scc1 L_s3p
L_s3pd:
  v_mov_b32 v12, s20
  v_mov_b32 v13, s22
  v_mov_b32 v14, s24
  v_mov_b32 v15, s26
  v_max_f32 v23, v12, v14
  ds_max_f32 v38, v23 offset:276
  ds_add_u32 v38, v17 offset:272
  ds_write_b64 v21, v[12:13] offset:448
  ds_write_b64 v22, v[14:15] offset:448
  s_mov_b64 exec, -1
  v_and_b32 v9, 3, v1
  v_lshlrev_b32 v9, 3, v9
  ds_read_b64 v[10:11], v9 offset:448
  s_waitcnt lgkmcnt(0)
  v_max_f32_dpp v8, v10, v10 quad_perm:[1,0,3,2] row_mask:0xf bank_mask:0xf
  s_nop 1
  v_max_f32_dpp v8, v8, v8 quad_perm:[2,3,0,1] row_mask:0xf bank_mask:0xf
  v_sub_f32 v9, v10, v8
  v_mul_f32 v9, 0x3fb8aa3b, v9
  v_exp_f32 v9, v9
  s_nop 0
  v_mul_f32 v10, v9, v11
  s_nop 1
  v_add_f32_dpp v10, v10, v10 quad_perm:[1,0,3,2] row_mask:0xf bank_mask:0xf
  s_nop 1
  v_add_f32_dpp v10, v10, v10 quad_perm:[2,3,0,1] row_mask:0xf bank_mask:0xf
  v_sub_f32 v9, v16, v8
  v_rcp_f32 v10, v10
  v_mul_f32 v9, 0x3fb8aa3b, v9
  v_exp_f32 v9, v9
  v_lshlrev_b32 v8, 2, v1
  v_mul_f32 v9, v9, v10
  s_mov_b64 exec, 0xffff
  ds_write_b32 v8, v9 offset:384
  s_mov_b64 exec, -1
  ds_write_b32 v38, v38 offset:256
  s_mov_b32 s70, 0
L_sn_13:
  ds_read_b32 v8, v38 offset:304
  s_waitcnt lgkmcnt(0)
  v_cmp_gt_u32 vcc, 0xb, v8
  s_cmp_eq_u64 vcc, 0
  s_cbranch_scc1 L_snd_14
  s_sleep 1
  s_add_u32 s70, s70, 1
  s_cmp_lt_u32 s70, 2097152
  s_cbranch_scc1 L_sn_13
L_snd_14:
  v_lshlrev_b32 v74, 3, v1
  ds_read_b128 v[62:65], v38 offset:384
  ds_read_b128 v[66:69], v38 offset:400
  ds_read_b128 v[70:73], v38 offset:416
  ds_read_b64 v[40:41], v74 offset:6656
  ds_read_b64 v[42:43], v74 offset:7168
  ds_read_b64 v[44:45], v74 offset:7680
  ds_read_b64 v[46:47], v74 offset:8192
  ds_read_b64 v[48:49], v74 offset:8704
  ds_read_b64 v[50:51], v74 offset:9216
  ds_read_b64 v[52:53], v74 offset:9728
  ds_read_b64 v[54:55], v74 offset:10240
  ds_read_b64 v[56:57], v74 offset:10752
  ds_read_b64 v[58:59], v74 offset:11264
  ds_read_b64 v[60:61], v74 offset:11776
  s_lshl_b32 s68, s6, 2
  s_add_u32 s68, s68, s7
  s_lshl_b32 s68, s68, 9
  s_add_u32 s68, s68, 131072
  v_add_u32 v74, s68, v74
  v_and_b32 v75, 1, v1
  v_lshlrev_b32 v75, 4, v75
  v_lshrrev_b32 v75, v75, s74
  v_lshrrev_b32 v76, 8, v75
  s_movk_i32 s69, 0xff
  s_waitcnt lgkmcnt(10)
  v_pk_mul_f32 v[40:41], v[40:41], v[62:63] op_sel:[0,0] op_sel_hi:[1,0]
  s_waitcnt lgkmcnt(9)
  v_pk_mul_f32 v[42:43], v[42:43], v[62:63] op_sel:[0,1] op_sel_hi:[1,1]
  s_waitcnt lgkmcnt(8)
  v_pk_fma_f32 v[40:41], v[44:45], v[64:65], v[40:41] op_sel:[0,0,0] op_sel_hi:[1,0,1]
  s_waitcnt lgkmcnt(7)
  v_pk_fma_f32 v[42:43], v[46:47], v[64:65], v[42:43] op_sel:[0,1,0] op_sel_hi:[1,1,1]
  s_waitcnt lgkmcnt(6)
  v_pk_fma_f32 v[40:41], v[48:49], v[66:67], v[40:41] op_sel:[0,0,0] op_sel_hi:[1,0,1]
  s_waitcnt lgkmcnt(5)
  v_pk_fma_f32 v[42:43], v[50:51], v[66:67], v[42:43] op_sel:[0,1,0] op_sel_hi:[1,1,1]
  s_waitcnt lgkmcnt(4)
  v_pk_fma_f32 v[40:41], v[52:53], v[68:69], v[40:41] op_sel:[0,0,0] op_sel_hi:[1,0,1]
  s_waitcnt lgkmcnt(3)
  v_pk_fma_f32 v[42:43], v[54:55], v[68:69], v[42:43] op_sel:[0,1,0] op_sel_hi:[1,1,1]
  s_waitcnt lgkmcnt(2)
  v_pk_fma_f32 v[40:41], v[56:57], v[70:71], v[40:41] op_sel:[0,0,0] op_sel_hi:[1,0,1]
  s_waitcnt lgkmcnt(1)
  v_pk_fma_f32 v[42:43], v[58:59], v[70:71], v[42:43] op_sel:[0,1,0] op_sel_hi:[1,1,1]
  s_waitcnt lgkmcnt(0)
  v_pk_fma_f32 v[40:41], v[60:61], v[72:73], v[40:41] op_sel:[0,0,0] op_sel_hi:[1,0,1]
  v_pk_add_f32 v[40:41], v[40:41], v[42:43]
  v_bfi_b32 v40, s69, v75, v40
  v_bfi_b32 v41, s69, v76, v41
  s_cmp_eq_u32 s75, 1
  s_cbranch_scc0 L_pf_15
  global_store_dwordx2 v74, v[40:41], s[42:43]
  s_branch L_pe_16
L_pf_15:
  global_store_dwordx2 v74, v[40:41], s[42:43] sc1
L_pe_16:
  s_waitcnt vmcnt(0)
  ds_write_b32 v38, v38 offset:300
  s_mov_b32 s70, 0
L_sn_17:
  ds_read_b32 v8, v38 offset:308
  s_waitcnt lgkmcnt(0)
  v_cmp_gt_u32 vcc, 0x2, v8
  s_cmp_eq_u64 vcc, 0
  s_cbranch_scc1 L_snd_18
  s_sleep 8
  s_add_u32 s70, s70, 1
  s_cmp_lt_u32 s70, 2097152
  s_cbranch_scc1 L_sn_17
L_snd_18:
  global_store_dwordx2 v74, v[40:41], s[42:43] sc1
  s_branch L_fin
L_serv:
  s_cmp_ge_u32 s13, 4
  s_cbranch_scc1 L_team
  s_cmp_ge_u32 s13, 2
  s_cbranch_scc1 L_end
  v_mov_b32 v38, 0
  v_mov_b32 v4, -1
  v_mov_b32 v5, 0
  v_mov_b32 v6, 0
  v_mov_b32 v7, 0
  ds_write_b128 v38, v[4:7] offset:256
  ds_write_b64 v38, v[6:7] offset:312
  s_getreg_b32 s76, hwreg(HW_REG_XCC_ID, 0, 4)
  s_waitcnt lgkmcnt(0)
  s_load_dword s74, s[42:43], 0
  s_getpc_b64 s[56:57]
L_pc_19:
  s_lshr_b32 s3, s2, 5
  s_lshl3_add_u32 s3, s3, s8
  s_lshl_b32 s3, s3, 2
  s_add_u32 s3, s3, L_table-L_pc_19
  s_load_dword s14, s[56:57], s3
  s_barrier
  s_waitcnt lgkmcnt(0)
  s_mul_i32 s74, s74, 0x9e3779b1
  s_add_u32 s74, s74, 0x7f4a7c15
  s_bfe_u32 s32, s74, 0x80000
  s_bfe_u32 s33, s74, 0x80008
  s_bfe_u32 s34, s74, 0x80010
  s_bfe_u32 s35, s74, 0x80018
  s_cmp_eq_u32 s13, 0
  s_cbranch_scc1 L_chk
  s_bfe_u32 s61, s14, 0x80010
  s_cmp_ge_u32 s61, 32
  s_cbranch_scc1 L_fin
  s_mov_b32 s70, 0
L_pl_20:
  ds_read_b32 v8, v38 offset:256
  s_waitcnt lgkmcnt(0)
  v_cmp_eq_u32 vcc, -1, v8
  s_cmp_eq_u64 vcc, 0
  s_cbranch_scc1 L_pld_21
  s_sleep 16
  s_add_u32 s70, s70, 1
  s_cmp_lt_u32 s70, 1048576
  s_cbranch_scc1 L_pl_20
L_pld_21:
  s_branch L_r_f2
L_chk:
  s_add_u32 s76, s76, s74
  s_lshr_b32 s49, s2, 5
  s_lshl_b32 s50, s8, 5
  s_add_u32 s49, s49, s50
  s_lshl_b32 s49, s49, 2
  v_mov_b32 v8, s49
  v_mov_b32 v9, s76
  s_mov_b64 exec, 1
  global_store_dword v8, v9, s[42:43] offset:1024 sc1
  s_mov_b64 exec, -1
  s_lshl_b32 s54, s6, 9
  s_add_u32 s54, s54, 0
  s_lshl_b32 s55, s6, 9
  s_add_u32 s55, s55, 128
  s_lshl_b32 s56, s6, 9
  s_add_u32 s56, s56, 256
  s_mov_b32 s70, 0
L_sn_22:
  ds_read_b32 v8, v38 offset:312
  s_waitcnt lgkmcnt(0)
  v_cmp_gt_u32 vcc, 0xc, v8
  s_cmp_eq_u64 vcc, 0
  s_cbranch_scc1 L_snd_23
  s_sleep 16
  s_add_u32 s70, s70, 1
  s_cmp_lt_u32 s70, 2097152
  s_cbranch_scc1 L_sn_22
L_snd_23:
  s_load_dwordx2 s[20:21], s[42:43], s54 offset:98304 glc
  s_load_dwordx2 s[24:25], s[42:43], s55 offset:98304 glc
  s_load_dwordx2 s[28:29], s[42:43], s56 offset:98304 glc
  s_mov_b32 s70, 0
  s_branch L_s3sc
L_s3s:
  s_load_dwordx2 s[20:21], s[42:43], s54 offset:98304 glc
  s_load_dwordx2 s[24:25], s[42:43], s55 offset:98304 glc
  s_load_dwordx2 s[28:29], s[42:43], s56 offset:98304 glc
L_s3sc:
  s_waitcnt lgkmcnt(0)
  s_xor_b32 s68, s21, s74
  s_xor_b32 s69, s25, s74
  s_or_b32 s68, s68, s69
  s_xor_b32 s69, s29, s74
  s_or_b32 s68, s68, s69
  s_cbranch_scc0 L_s3sd
  s_sleep 8
  s_add_u32 s70, s70, 1
  s_cmp_lt_u32 s70, 262144
  s_cbranch_scc1 L_s3s
L_s3sd:
  ds_write_b32 v38, v38 offset:256
  v_and_b32 v160, 1, v1
  v_lshlrev_b32 v160, 4, v160
  v_lshrrev_b32 v160, v160, s74
  v_bfe_u32 v161, v160, 8, 8
  v_and_b32 v160, 0xff, v160
  s_lshl_b32 s10, s6, 11
  s_add_u32 s10, s10, 131072
  v_lshl_add_u32 v2, v1, 3, s10
  s_mov_b32 s70, 0
L_sn_24:
  ds_read_b32 v8, v38 offset:264
  s_waitcnt lgkmcnt(0)
  v_cmp_gt_u32 vcc, 0x8, v8
  s_cmp_eq_u64 vcc, 0
  s_cbranch_scc1 L_snd_25
  s_sleep 8
  s_add_u32 s70, s70, 1
  s_cmp_lt_u32 s70, 2097152
  s_cbranch_scc1 L_sn_24
L_snd_25:
  s_mov_b32 s70, 0
L_cp0:
  global_load_dwordx2 v[40:41], v2, s[42:43] offset:0 sc1
  global_load_dwordx2 v[42:43], v2, s[42:43] offset:512 sc1
  global_load_dwordx2 v[44:45], v2, s[42:43] offset:1024 sc1
  s_waitcnt vmcnt(0)
  v_xor_b32 v40, v40, v160
  v_xor_b32 v41, v41, v161
  v_xor_b32 v42, v42, v160
  v_xor_b32 v43, v43, v161
  v_xor_b32 v44, v44, v160
  v_xor_b32 v45, v45, v161
  v_or3_b32 v56, v40, v41, v42
  v_or3_b32 v57, v43, v44, v45
  v_or_b32 v40, 0x80, v40
  v_or_b32 v41, 0x80, v41
  v_or_b32 v42, 0x80, v42
  v_or_b32 v43, 0x80, v43
  v_or_b32 v44, 0x80, v44
  v_or_b32 v45, 0x80, v45
  v_or_b32 v56, v56, v57
  v_pk_add_f32 v[40:41], v[40:41], v[42:43]
  v_lshlrev_b32 v56, 24, v56
  v_pk_add_f32 v[40:41], v[40:41], v[44:45]
  v_cmp_ne_u32 vcc, 0, v56
  v_cvt_pk_bf16_f32 v40, v40, v41
  s_cmp_eq_u64 vcc, 0
  s_cbranch_scc1 L_cp0d
  s_sleep 1
  s_add_u32 s70, s70, 1
  s_cmp_lt_u32 s70, 262144
  s_cbranch_scc1 L_cp0
L_cp0d:
  v_add_u32 v2, 393216, v2
  s_mov_b32 s70, 0
L_cp1:
  global_load_dwordx2 v[48:49], v2, s[42:43] offset:0 sc1
  global_load_dwordx2 v[50:51], v2, s[42:43] offset:512 sc1
  global_load_dwordx2 v[52:53], v2, s[42:43] offset:1024 sc1
  s_waitcnt vmcnt(0)
  v_xor_b32 v48, v48, v160
  v_xor_b32 v49, v49, v161
  v_xor_b32 v50, v50, v160
  v_xor_b32 v51, v51, v161
  v_xor_b32 v52, v52, v160
  v_xor_b32 v53, v53, v161
  v_or3_b32 v56, v48, v49, v50
  v_or3_b32 v57, v51, v52, v53
  v_or_b32 v48, 0x80, v48
  v_or_b32 v49, 0x80, v49
  v_or_b32 v50, 0x80, v50
  v_or_b32 v51, 0x80, v51
  v_or_b32 v52, 0x80, v52
  v_or_b32 v53, 0x80, v53
  v_or_b32 v56, v56, v57
  v_pk_add_f32 v[48:49], v[48:49], v[50:51]
  v_lshlrev_b32 v56, 24, v56
  v_pk_add_f32 v[48:49], v[48:49], v[52:53]
  v_cmp_ne_u32 vcc, 0, v56
  v_cvt_pk_bf16_f32 v48, v48, v49
  s_cmp_eq_u64 vcc, 0
  s_cbranch_scc1 L_cp1d
  s_sleep 1
  s_add_u32 s70, s70, 1
  s_cmp_lt_u32 s70, 262144
  s_cbranch_scc1 L_cp1
L_cp1d:
  v_cmp_ne_u32 vcc, v40, v48
  s_cmp_eq_u64 vcc, 0
  s_cbranch_scc1 L_fin
L_slow:
  s_mov_b32 s47, 0x20000
  s_load_dwordx16 s[16:31], s[0:1], 0
  s_load_dwordx8 s[32:39], s[0:1], 64
  v_and_b32 v2, 31, v1
  v_lshlrev_b32 v2, 7, v2
  v_add_u32 v2, 28672, v2
  s_mov_b32 s70, 0
L_sl_d:
  global_load_dword v3, v2, s[42:43] sc1
  s_waitcnt vmcnt(0) lgkmcnt(0)
  v_cmp_ne_u32 vcc, s74, v3
  s_cmp_eq_u64 vcc, 0
  s_cbranch_scc1 L_sl_dd
  s_sleep 8
  s_add_u32 s70, s70, 1
  s_cmp_lt_u32 s70, 262144
  s_cbranch_scc1 L_sl_d
L_sl_dd:
  v_lshlrev_b32 v2, 3, v1
  v_add_u32 v2, 524288, v2
  v_lshlrev_b32 v0, 2, v1
  v_add_u32 v0, 12288, v0
  s_mov_b32 s10, 0
L_sl_h:
  s_mov_b32 s70, 0
L_sl_hp:
  global_load_dwordx2 v[40:41], v2, s[42:43] offset:0 sc1
  global_load_dwordx2 v[42:43], v2, s[42:43] offset:512 sc1
  global_load_dwordx2 v[44:45], v2, s[42:43] offset:1024 sc1
  s_waitcnt vmcnt(0)
  v_xor_b32 v40, v40, v160
  v_xor_b32 v41, v41, v161
  v_xor_b32 v42, v42, v160
  v_xor_b32 v43, v43, v161
  v_xor_b32 v44, v44, v160
  v_xor_b32 v45, v45, v161
  v_or3_b32 v48, v40, v41, v42
  v_or3_b32 v49, v43, v44, v45
  v_or_b32 v40, 0x80, v40
  v_or_b32 v41, 0x80, v41
  v_or_b32 v42, 0x80, v42
  v_or_b32 v43, 0x80, v43
  v_or_b32 v44, 0x80, v44
  v_or_b32 v45, 0x80, v45
  v_or_b32 v48, v48, v49
  v_pk_add_f32 v[40:41], v[40:41], v[42:43]
  v_lshlrev_b32 v48, 24, v48
  v_pk_add_f32 v[40:41], v[40:41], v[44:45]
  v_cmp_ne_u32 vcc, 0, v48
  v_cvt_pk_bf16_f32 v40, v40, v41
  s_cmp_eq_u64 vcc, 0
  s_cbranch_scc1 L_sl_hd
  s_sleep 8
  s_add_u32 s70, s70, 1
  s_cmp_lt_u32 s70, 262144
  s_cbranch_scc1 L_sl_hp
L_sl_hd:
  ds_write_b32 v0, v40
  v_add_u32 v2, 2048, v2
  v_add_u32 v0, 256, v0
  s_add_u32 s10, s10, 1
  s_cmp_lt_u32 s10, 64
  s_cbranch_scc1 L_sl_h
  s_mov_b32 s44, s24
  s_mov_b32 s45, s25
  s_mov_b32 s46, 4194304
  s_mov_b32 s11, 1024
  s_mov_b32 s12, 4194304
  v_mov_b32 v4, 12288
  v_mov_b32 v5, 20480
  v_lshlrev_b32 v2, 4, v1
  s_call_b64 s[62:63], L_gv
  v_lshlrev_b32 v0, 4, v1
  global_load_dwordx4 v[40:43], v0, s[16:17] offset:0
  global_load_dwordx4 v[44:47], v0, s[16:17] offset:1024
  s_waitcnt vmcnt(0)
  v_lshlrev_b32 v104, 16, v40
  v_and_b32 v105, s73, v40
  v_lshlrev_b32 v106, 16, v41
  v_and_b32 v107, s73, v41
  v_lshlrev_b32 v108, 16, v42
  v_and_b32 v109, s73, v42
  v_lshlrev_b32 v110, 16, v43
  v_and_b32 v111, s73, v43
  v_lshlrev_b32 v112, 16, v44
  v_and_b32 v113, s73, v44
  v_lshlrev_b32 v114, 16, v45
  v_and_b32 v115, s73, v45
  v_lshlrev_b32 v116, 16, v46
  v_and_b32 v117, s73, v46
  v_lshlrev_b32 v118, 16, v47
  v_and_b32 v119, s73, v47
  v_lshrrev_b32 v2, 1, v1
  v_lshlrev_b32 v2, 7, v2
  v_and_b32 v3, 1, v1
  v_lshl_add_u32 v2, v3, 5, v2
  v_add_u32 v2, 12288, v2
  global_load_dwordx4 v[40:43], v2, s[42:43] offset:0 sc1
  global_load_dwordx4 v[44:47], v2, s[42:43] offset:16 sc1
  global_load_dwordx4 v[48:51], v2, s[42:43] offset:64 sc1
  global_load_dwordx4 v[52:55], v2, s[42:43] offset:80 sc1
  s_waitcnt vmcnt(0)
  v_lshlrev_b32 v88, 16, v40
  v_and_b32 v89, s73, v40
  v_lshlrev_b32 v90, 16, v42
  v_and_b32 v91, s73, v42
  v_lshlrev_b32 v92, 16, v44
  v_and_b32 v93, s73, v44
  v_lshlrev_b32 v94, 16, v46
  v_and_b32 v95, s73, v46
  v_lshlrev_b32 v96, 16, v48
  v_and_b32 v97, s73, v48
  v_lshlrev_b32 v98, 16, v50
  v_and_b32 v99, s73, v50
  v_lshlrev_b32 v100, 16, v52
  v_and_b32 v101, s73, v52
  v_lshlrev_b32 v102, 16, v54
  v_and_b32 v103, s73, v54
  v_cvt_pk_bf16_f32 v72, 0, v72
  v_cvt_pk_bf16_f32 v73, 0, v73
  v_cvt_pk_bf16_f32 v74, 0, v74
  v_cvt_pk_bf16_f32 v75, 0, v75
  v_cvt_pk_bf16_f32 v76, 0, v76
  v_cvt_pk_bf16_f32 v77, 0, v77
  v_cvt_pk_bf16_f32 v78, 0, v78
  v_cvt_pk_bf16_f32 v79, 0, v79
  v_cvt_pk_bf16_f32 v80, 0, v80
  v_cvt_pk_bf16_f32 v81, 0, v81
  v_cvt_pk_bf16_f32 v82, 0, v82
  v_cvt_pk_bf16_f32 v83, 0, v83
  v_cvt_pk_bf16_f32 v84, 0, v84
  v_cvt_pk_bf16_f32 v85, 0, v85
  v_cvt_pk_bf16_f32 v86, 0, v86
  v_cvt_pk_bf16_f32 v87, 0, v87
  v_mul_f32 v72, v72, v88
  v_mul_f32 v73, v73, v89
  v_mul_f32 v74, v74, v90
  v_mul_f32 v75, v75, v91
  v_mul_f32 v76, v76, v92
  v_mul_f32 v77, v77, v93
  v_mul_f32 v78, v78, v94
  v_mul_f32 v79, v79, v95
  v_mul_f32 v80, v80, v96
  v_mul_f32 v81, v81, v97
  v_mul_f32 v82, v82, v98
  v_mul_f32 v83, v83, v99
  v_mul_f32 v84, v84, v100
  v_mul_f32 v85, v85, v101
  v_mul_f32 v86, v86, v102
  v_mul_f32 v87, v87, v103
  v_cvt_pk_bf16_f32 v72, 0, v72
  v_cvt_pk_bf16_f32 v73, 0, v73
  v_cvt_pk_bf16_f32 v74, 0, v74
  v_cvt_pk_bf16_f32 v75, 0, v75
  v_cvt_pk_bf16_f32 v76, 0, v76
  v_cvt_pk_bf16_f32 v77, 0, v77
  v_cvt_pk_bf16_f32 v78, 0, v78
  v_cvt_pk_bf16_f32 v79, 0, v79
  v_cvt_pk_bf16_f32 v80, 0, v80
  v_cvt_pk_bf16_f32 v81, 0, v81
  v_cvt_pk_bf16_f32 v82, 0, v82
  v_cvt_pk_bf16_f32 v83, 0, v83
  v_cvt_pk_bf16_f32 v84, 0, v84
  v_cvt_pk_bf16_f32 v85, 0, v85
  v_cvt_pk_bf16_f32 v86, 0, v86
  v_cvt_pk_bf16_f32 v87, 0, v87
  v_add_f32 v104, v104, v72
  v_add_f32 v105, v105, v73
  v_add_f32 v106, v106, v74
  v_add_f32 v107, v107, v75
  v_add_f32 v108, v108, v76
  v_add_f32 v109, v109, v77
  v_add_f32 v110, v110, v78
  v_add_f32 v111, v111, v79
  v_add_f32 v112, v112, v80
  v_add_f32 v113, v113, v81
  v_add_f32 v114, v114, v82
  v_add_f32 v115, v115, v83
  v_add_f32 v116, v116, v84
  v_add_f32 v117, v117, v85
  v_add_f32 v118, v118, v86
  v_add_f32 v119, v119, v87
  v_cvt_pk_bf16_f32 v104, 0, v104
  v_cvt_pk_bf16_f32 v105, 0, v105
  v_cvt_pk_bf16_f32 v106, 0, v106
  v_cvt_pk_bf16_f32 v107, 0, v107
  v_cvt_pk_bf16_f32 v108, 0, v108
  v_cvt_pk_bf16_f32 v109, 0, v109
  v_cvt_pk_bf16_f32 v110, 0, v110
  v_cvt_pk_bf16_f32 v111, 0, v111
  v_cvt_pk_bf16_f32 v112, 0, v112
  v_cvt_pk_bf16_f32 v113, 0, v113
  v_cvt_pk_bf16_f32 v114, 0, v114
  v_cvt_pk_bf16_f32 v115, 0, v115
  v_cvt_pk_bf16_f32 v116, 0, v116
  v_cvt_pk_bf16_f32 v117, 0, v117
  v_cvt_pk_bf16_f32 v118, 0, v118
  v_cvt_pk_bf16_f32 v119, 0, v119
  v_add_f32 v8, v104, v105
  v_add_f32 v8, v8, v106
  v_add_f32 v8, v8, v107
  v_add_f32 v8, v8, v108
  v_add_f32 v8, v8, v109
  v_add_f32 v8, v8, v110
  v_add_f32 v8, v8, v111
  s_nop 1
  v_add_f32_dpp v8, v8, v8 row_ror:8 row_mask:0xf bank_mask:0xf
  s_nop 1
  v_add_f32_dpp v8, v8, v8 row_ror:4 row_mask:0xf bank_mask:0xf
  s_nop 1
  v_add_f32_dpp v8, v8, v8 row_ror:2 row_mask:0xf bank_mask:0xf
  s_nop 1
  v_add_f32_dpp v8, v8, v8 row_ror:1 row_mask:0xf bank_mask:0xf
  v_mov_b32 v9, v8
  s_nop 1
  v_permlane16_swap_b32 v9, v8
  v_add_f32 v8, v8, v9
  v_mov_b32 v9, v8
  s_nop 1
  v_permlane32_swap_b32 v9, v8
  v_add_f32 v8, v8, v9
  v_mul_f32 v8, 0x3b000000, v8
  v_sub_f32 v72, v104, v8
  v_sub_f32 v73, v105, v8
  v_sub_f32 v74, v106, v8
  v_sub_f32 v75, v107, v8
  v_sub_f32 v76, v108, v8
  v_sub_f32 v77, v109, v8
  v_sub_f32 v78, v110, v8
  v_sub_f32 v79, v111, v8
  v_mul_f32 v10, v72, v72
  v_fmac_f32 v10, v73, v73
  v_fmac_f32 v10, v74, v74
  v_fmac_f32 v10, v75, v75
  v_fmac_f32 v10, v76, v76
  v_fmac_f32 v10, v77, v77
  v_fmac_f32 v10, v78, v78
  v_fmac_f32 v10, v79, v79
  s_nop 1
  v_add_f32_dpp v10, v10, v10 row_ror:8 row_mask:0xf bank_mask:0xf
  s_nop 1
  v_add_f32_dpp v10, v10, v10 row_ror:4 row_mask:0xf bank_mask:0xf
  s_nop 1
  v_add_f32_dpp v10, v10, v10 row_ror:2 row_mask:0xf bank_mask:0xf
  s_nop 1
  v_add_f32_dpp v10, v10, v10 row_ror:1 row_mask:0xf bank_mask:0xf
  v_mov_b32 v9, v10
  s_nop 1
  v_permlane16_swap_b32 v9, v10
  v_add_f32 v10, v10, v9
  v_mov_b32 v9, v10
  s_nop 1
  v_permlane32_swap_b32 v9, v10
  v_add_f32 v10, v10, v9
  v_mul_f32 v10, 0x3b000000, v10
  v_cvt_pk_bf16_f32 v8, 0, v8
  v_cvt_pk_bf16_f32 v10, 0, v10
  v_add_f32 v10, 0x3727c5ac, v10
  v_cvt_pk_bf16_f32 v10, 0, v10
  v_sqrt_f32 v10, v10
  v_sub_f32 v72, v104, v8
  v_sub_f32 v73, v105, v8
  v_sub_f32 v74, v106, v8
  v_sub_f32 v75, v107, v8
  v_sub_f32 v76, v108, v8
  v_sub_f32 v77, v109, v8
  v_sub_f32 v78, v110, v8
  v_sub_f32 v79, v111, v8
  v_cvt_pk_bf16_f32 v10, 0, v10
  v_cvt_pk_bf16_f32 v72, 0, v72
  v_cvt_pk_bf16_f32 v73, 0, v73
  v_cvt_pk_bf16_f32 v74, 0, v74
  v_cvt_pk_bf16_f32 v75, 0, v75
  v_cvt_pk_bf16_f32 v76, 0, v76
  v_cvt_pk_bf16_f32 v77, 0, v77
  v_cvt_pk_bf16_f32 v78, 0, v78
  v_cvt_pk_bf16_f32 v79, 0, v79
  v_rcp_f32 v10, v10
  s_nop 0
  v_mul_f32 v72, v72, v10
  v_mul_f32 v73, v73, v10
  v_mul_f32 v74, v74, v10
  v_mul_f32 v75, v75, v10
  v_mul_f32 v76, v76, v10
  v_mul_f32 v77, v77, v10
  v_mul_f32 v78, v78, v10
  v_mul_f32 v79, v79, v10
  v_cvt_pk_bf16_f32 v72, 0, v72
  v_cvt_pk_bf16_f32 v73, 0, v73
  v_cvt_pk_bf16_f32 v74, 0, v74
  v_cvt_pk_bf16_f32 v75, 0, v75
  v_cvt_pk_bf16_f32 v76, 0, v76
  v_cvt_pk_bf16_f32 v77, 0, v77
  v_cvt_pk_bf16_f32 v78, 0, v78
  v_cvt_pk_bf16_f32 v79, 0, v79
  v_add_f32 v8, v112, v113
  v_add_f32 v8, v8, v114
  v_add_f32 v8, v8, v115
  v_add_f32 v8, v8, v116
  v_add_f32 v8, v8, v117
  v_add_f32 v8, v8, v118
  v_add_f32 v8, v8, v119
  s_nop 1
  v_add_f32_dpp v8, v8, v8 row_ror:8 row_mask:0xf bank_mask:0xf
  s_nop 1
  v_add_f32_dpp v8, v8, v8 row_ror:4 row_mask:0xf bank_mask:0xf
  s_nop 1
  v_add_f32_dpp v8, v8, v8 row_ror:2 row_mask:0xf bank_mask:0xf
  s_nop 1
  v_add_f32_dpp v8, v8, v8 row_ror:1 row_mask:0xf bank_mask:0xf
  v_mov_b32 v9, v8
  s_nop 1
  v_permlane16_swap_b32 v9, v8
  v_add_f32 v8, v8, v9
  v_mov_b32 v9, v8
  s_nop 1
  v_permlane32_swap_b32 v9, v8
  v_add_f32 v8, v8, v9
  v_mul_f32 v8, 0x3b000000, v8
  v_sub_f32 v80, v112, v8
  v_sub_f32 v81, v113, v8
  v_sub_f32 v82, v114, v8
  v_sub_f32 v83, v115, v8
  v_sub_f32 v84, v116, v8
  v_sub_f32 v85, v117, v8
  v_sub_f32 v86, v118, v8
  v_sub_f32 v87, v119, v8
  v_mul_f32 v10, v80, v80
  v_fmac_f32 v10, v81, v81
  v_fmac_f32 v10, v82, v82
  v_fmac_f32 v10, v83, v83
  v_fmac_f32 v10, v84, v84
  v_fmac_f32 v10, v85, v85
  v_fmac_f32 v10, v86, v86
  v_fmac_f32 v10, v87, v87
  s_nop 1
  v_add_f32_dpp v10, v10, v10 row_ror:8 row_mask:0xf bank_mask:0xf
  s_nop 1
  v_add_f32_dpp v10, v10, v10 row_ror:4 row_mask:0xf bank_mask:0xf
  s_nop 1
  v_add_f32_dpp v10, v10, v10 row_ror:2 row_mask:0xf bank_mask:0xf
  s_nop 1
  v_add_f32_dpp v10, v10, v10 row_ror:1 row_mask:0xf bank_mask:0xf
  v_mov_b32 v9, v10
  s_nop 1
  v_permlane16_swap_b32 v9, v10
  v_add_f32 v10, v10, v9
  v_mov_b32 v9, v10
  s_nop 1
  v_permlane32_swap_b32 v9, v10
  v_add_f32 v10, v10, v9
  v_mul_f32 v10, 0x3b000000, v10
  v_cvt_pk_bf16_f32 v8, 0, v8
  v_cvt_pk_bf16_f32 v10, 0, v10
  v_add_f32 v10, 0x3727c5ac, v10
  v_cvt_pk_bf16_f32 v10, 0, v10
  v_sqrt_f32 v10, v10
  v_sub_f32 v80, v112, v8
  v_sub_f32 v81, v113, v8
  v_sub_f32 v82, v114, v8
  v_sub_f32 v83, v115, v8
  v_sub_f32 v84, v116, v8
  v_sub_f32 v85, v117, v8
  v_sub_f32 v86, v118, v8
  v_sub_f32 v87, v119, v8
  v_cvt_pk_bf16_f32 v10, 0, v10
  v_cvt_pk_bf16_f32 v80, 0, v80
  v_cvt_pk_bf16_f32 v81, 0, v81
  v_cvt_pk_bf16_f32 v82, 0, v82
  v_cvt_pk_bf16_f32 v83, 0, v83
  v_cvt_pk_bf16_f32 v84, 0, v84
  v_cvt_pk_bf16_f32 v85, 0, v85
  v_cvt_pk_bf16_f32 v86, 0, v86
  v_cvt_pk_bf16_f32 v87, 0, v87
  v_rcp_f32 v10, v10
  s_nop 0
  v_mul_f32 v80, v80, v10
  v_mul_f32 v81, v81, v10
  v_mul_f32 v82, v82, v10
  v_mul_f32 v83, v83, v10
  v_mul_f32 v84, v84, v10
  v_mul_f32 v85, v85, v10
  v_mul_f32 v86, v86, v10
  v_mul_f32 v87, v87, v10
  v_cvt_pk_bf16_f32 v80, 0, v80
  v_cvt_pk_bf16_f32 v81, 0, v81
  v_cvt_pk_bf16_f32 v82, 0, v82
  v_cvt_pk_bf16_f32 v83, 0, v83
  v_cvt_pk_bf16_f32 v84, 0, v84
  v_cvt_pk_bf16_f32 v85, 0, v85
  v_cvt_pk_bf16_f32 v86, 0, v86
  v_cvt_pk_bf16_f32 v87, 0, v87
  v_lshrrev_b32 v2, 1, v1
  v_lshlrev_b32 v2, 7, v2
  v_and_b32 v3, 1, v1
  v_lshl_add_u32 v2, v3, 5, v2
  v_add_u32 v2, 20480, v2
  global_load_dwordx4 v[40:43], v2, s[42:43] offset:0 sc1
  global_load_dwordx4 v[44:47], v2, s[42:43] offset:16 sc1
  global_load_dwordx4 v[48:51], v2, s[42:43] offset:64 sc1
  global_load_dwordx4 v[52:55], v2, s[42:43] offset:80 sc1
  s_waitcnt vmcnt(0)
  v_lshlrev_b32 v88, 16, v40
  v_and_b32 v89, s73, v40
  v_lshlrev_b32 v90, 16, v42
  v_and_b32 v91, s73, v42
  v_lshlrev_b32 v92, 16, v44
  v_and_b32 v93, s73, v44
  v_lshlrev_b32 v94, 16, v46
  v_and_b32 v95, s73, v46
  v_lshlrev_b32 v96, 16, v48
  v_and_b32 v97, s73, v48
  v_lshlrev_b32 v98, 16, v50
  v_and_b32 v99, s73, v50
  v_lshlrev_b32 v100, 16, v52
  v_and_b32 v101, s73, v52
  v_lshlrev_b32 v102, 16, v54
  v_and_b32 v103, s73, v54
  v_add_f32 v88, 1.0, v88
  v_add_f32 v89, 1.0, v89
  v_add_f32 v90, 1.0, v90
  v_add_f32 v91, 1.0, v91
  v_add_f32 v92, 1.0, v92
  v_add_f32 v93, 1.0, v93
  v_add_f32 v94, 1.0, v94
  v_add_f32 v95, 1.0, v95
  v_add_f32 v96, 1.0, v96
  v_add_f32 v97, 1.0, v97
  v_add_f32 v98, 1.0, v98
  v_add_f32 v99, 1.0, v99
  v_add_f32 v100, 1.0, v100
  v_add_f32 v101, 1.0, v101
  v_add_f32 v102, 1.0, v102
  v_add_f32 v103, 1.0, v103
  v_cvt_pk_bf16_f32 v88, 0, v88
  v_cvt_pk_bf16_f32 v89, 0, v89
  v_cvt_pk_bf16_f32 v90, 0, v90
  v_cvt_pk_bf16_f32 v91, 0, v91
  v_cvt_pk_bf16_f32 v92, 0, v92
  v_cvt_pk_bf16_f32 v93, 0, v93
  v_cvt_pk_bf16_f32 v94, 0, v94
  v_cvt_pk_bf16_f32 v95, 0, v95
  v_cvt_pk_bf16_f32 v96, 0, v96
  v_cvt_pk_bf16_f32 v97, 0, v97
  v_cvt_pk_bf16_f32 v98, 0, v98
  v_cvt_pk_bf16_f32 v99, 0, v99
  v_cvt_pk_bf16_f32 v100, 0, v100
  v_cvt_pk_bf16_f32 v101, 0, v101
  v_cvt_pk_bf16_f32 v102, 0, v102
  v_cvt_pk_bf16_f32 v103, 0, v103
  v_mul_f32 v72, v72, v88
  v_mul_f32 v73, v73, v89
  v_mul_f32 v74, v74, v90
  v_mul_f32 v75, v75, v91
  v_mul_f32 v76, v76, v92
  v_mul_f32 v77, v77, v93
  v_mul_f32 v78, v78, v94
  v_mul_f32 v79, v79, v95
  v_mul_f32 v80, v80, v96
  v_mul_f32 v81, v81, v97
  v_mul_f32 v82, v82, v98
  v_mul_f32 v83, v83, v99
  v_mul_f32 v84, v84, v100
  v_mul_f32 v85, v85, v101
  v_mul_f32 v86, v86, v102
  v_mul_f32 v87, v87, v103
  v_cvt_pk_bf16_f32 v72, 0, v72
  v_cvt_pk_bf16_f32 v73, 0, v73
  v_cvt_pk_bf16_f32 v74, 0, v74
  v_cvt_pk_bf16_f32 v75, 0, v75
  v_cvt_pk_bf16_f32 v76, 0, v76
  v_cvt_pk_bf16_f32 v77, 0, v77
  v_cvt_pk_bf16_f32 v78, 0, v78
  v_cvt_pk_bf16_f32 v79, 0, v79
  v_cvt_pk_bf16_f32 v80, 0, v80
  v_cvt_pk_bf16_f32 v81, 0, v81
  v_cvt_pk_bf16_f32 v82, 0, v82
  v_cvt_pk_bf16_f32 v83, 0, v83
  v_cvt_pk_bf16_f32 v84, 0, v84
  v_cvt_pk_bf16_f32 v85, 0, v85
  v_cvt_pk_bf16_f32 v86, 0, v86
  v_cvt_pk_bf16_f32 v87, 0, v87
  v_lshrrev_b32 v2, 1, v1
  v_lshlrev_b32 v2, 7, v2
  v_and_b32 v3, 1, v1
  v_lshl_add_u32 v2, v3, 5, v2
  v_add_u32 v2, 16384, v2
  global_load_dwordx4 v[40:43], v2, s[42:43] offset:0 sc1
  global_load_dwordx4 v[44:47], v2, s[42:43] offset:16 sc1
  global_load_dwordx4 v[48:51], v2, s[42:43] offset:64 sc1
  global_load_dwordx4 v[52:55], v2, s[42:43] offset:80 sc1
  s_waitcnt vmcnt(0)
  v_lshlrev_b32 v88, 16, v40
  v_and_b32 v89, s73, v40
  v_lshlrev_b32 v90, 16, v42
  v_and_b32 v91, s73, v42
  v_lshlrev_b32 v92, 16, v44
  v_and_b32 v93, s73, v44
  v_lshlrev_b32 v94, 16, v46
  v_and_b32 v95, s73, v46
  v_lshlrev_b32 v96, 16, v48
  v_and_b32 v97, s73, v48
  v_lshlrev_b32 v98, 16, v50
  v_and_b32 v99, s73, v50
  v_lshlrev_b32 v100, 16, v52
  v_and_b32 v101, s73, v52
  v_lshlrev_b32 v102, 16, v54
  v_and_b32 v103, s73, v54
  v_add_f32 v72, v72, v88
  v_add_f32 v73, v73, v89
  v_add_f32 v74, v74, v90
  v_add_f32 v75, v75, v91
  v_add_f32 v76, v76, v92
  v_add_f32 v77, v77, v93
  v_add_f32 v78, v78, v94
  v_add_f32 v79, v79, v95
  v_add_f32 v80, v80, v96
  v_add_f32 v81, v81, v97
  v_add_f32 v82, v82, v98
  v_add_f32 v83, v83, v99
  v_add_f32 v84, v84, v100
  v_add_f32 v85, v85, v101
  v_add_f32 v86, v86, v102
  v_add_f32 v87, v87, v103
  v_cvt_pk_bf16_f32 v40, v72, v73
  v_cvt_pk_bf16_f32 v41, v74, v75
  v_cvt_pk_bf16_f32 v42, v76, v77
  v_cvt_pk_bf16_f32 v43, v78, v79
  v_cvt_pk_bf16_f32 v44, v80, v81
  v_cvt_pk_bf16_f32 v45, v82, v83
  v_cvt_pk_bf16_f32 v46, v84, v85
  v_cvt_pk_bf16_f32 v47, v86, v87
  v_add_u32 v3, 12288, v0
  ds_write_b128 v3, v[40:43] offset:0
  ds_write_b128 v3, v[44:47] offset:1024
  s_mov_b32 s44, s28
  s_mov_b32 s45, s29
  s_mov_b32 s46, 1409024
  s_mov_b32 s11, 2752
  s_mov_b32 s12, 1409024
  v_mov_b32 v4, 12288
  v_mov_b32 v5, 13312
  v_lshlrev_b32 v2, 4, v1
  s_call_b64 s[62:63], L_gv
  v_cvt_pk_bf16_f32 v120, 0, v72
  v_cvt_pk_bf16_f32 v121, 0, v73
  v_cvt_pk_bf16_f32 v122, 0, v74
  v_cvt_pk_bf16_f32 v123, 0, v75
  v_cvt_pk_bf16_f32 v124, 0, v76
  v_cvt_pk_bf16_f32 v125, 0, v77
  v_cvt_pk_bf16_f32 v126, 0, v78
  v_cvt_pk_bf16_f32 v127, 0, v79
  v_cvt_pk_bf16_f32 v128, 0, v80
  v_cvt_pk_bf16_f32 v129, 0, v81
  v_cvt_pk_bf16_f32 v130, 0, v82
  v_cvt_pk_bf16_f32 v131, 0, v83
  v_cvt_pk_bf16_f32 v132, 0, v84
  v_cvt_pk_bf16_f32 v133, 0, v85
  v_cvt_pk_bf16_f32 v134, 0, v86
  v_cvt_pk_bf16_f32 v135, 0, v87
  s_mov_b32 s44, s30
  s_mov_b32 s45, s31
  s_mov_b32 s46, 1409024
  s_mov_b32 s11, 2752
  s_mov_b32 s12, 1409024
  v_mov_b32 v4, 12288
  v_mov_b32 v5, 13312
  v_lshlrev_b32 v2, 4, v1
  s_call_b64 s[62:63], L_gv
  v_mul_f32 v88, 0xbfb8aa3b, v120
  v_mul_f32 v89, 0xbfb8aa3b, v121
  v_mul_f32 v90, 0xbfb8aa3b, v122
  v_mul_f32 v91, 0xbfb8aa3b, v123
  v_exp_f32 v88, v88
  v_exp_f32 v89, v89
  v_exp_f32 v90, v90
  v_exp_f32 v91, v91
  s_nop 0
  v_add_f32 v88, 1.0, v88
  v_add_f32 v89, 1.0, v89
  v_add_f32 v90, 1.0, v90
  v_add_f32 v91, 1.0, v91
  v_rcp_f32 v88, v88
  v_rcp_f32 v89, v89
  v_rcp_f32 v90, v90
  v_rcp_f32 v91, v91
  s_nop 0
  v_mul_f32 v120, v120, v88
  v_mul_f32 v121, v121, v89
  v_mul_f32 v122, v122, v90
  v_mul_f32 v123, v123, v91
  v_mul_f32 v88, 0xbfb8aa3b, v124
  v_mul_f32 v89, 0xbfb8aa3b, v125
  v_mul_f32 v90, 0xbfb8aa3b, v126
  v_mul_f32 v91, 0xbfb8aa3b, v127
  v_exp_f32 v88, v88
  v_exp_f32 v89, v89
  v_exp_f32 v90, v90
  v_exp_f32 v91, v91
  s_nop 0
  v_add_f32 v88, 1.0, v88
  v_add_f32 v89, 1.0, v89
  v_add_f32 v90, 1.0, v90
  v_add_f32 v91, 1.0, v91
  v_rcp_f32 v88, v88
  v_rcp_f32 v89, v89
  v_rcp_f32 v90, v90
  v_rcp_f32 v91, v91
  s_nop 0
  v_mul_f32 v124, v124, v88
  v_mul_f32 v125, v125, v89
  v_mul_f32 v126, v126, v90
  v_mul_f32 v127, v127, v91
  v_mul_f32 v88, 0xbfb8aa3b, v128
  v_mul_f32 v89, 0xbfb8aa3b, v129
  v_mul_f32 v90, 0xbfb8aa3b, v130
  v_mul_f32 v91, 0xbfb8aa3b, v131
  v_exp_f32 v88, v88
  v_exp_f32 v89, v89
  v_exp_f32 v90, v90
  v_exp_f32 v91, v91
  s_nop 0
  v_add_f32 v88, 1.0, v88
  v_add_f32 v89, 1.0, v89
  v_add_f32 v90, 1.0, v90
  v_add_f32 v91, 1.0, v91
  v_rcp_f32 v88, v88
  v_rcp_f32 v89, v89
  v_rcp_f32 v90, v90
  v_rcp_f32 v91, v91
  s_nop 0
  v_mul_f32 v128, v128, v88
  v_mul_f32 v129, v129, v89
  v_mul_f32 v130, v130, v90
  v_mul_f32 v131, v131, v91
  v_mul_f32 v88, 0xbfb8aa3b, v132
  v_mul_f32 v89, 0xbfb8aa3b, v133
  v_mul_f32 v90, 0xbfb8aa3b, v134
  v_mul_f32 v91, 0xbfb8aa3b, v135
  v_exp_f32 v88, v88
  v_exp_f32 v89, v89
  v_exp_f32 v90, v90
  v_exp_f32 v91, v91
  s_nop 0
  v_add_f32 v88, 1.0, v88
  v_add_f32 v89, 1.0, v89
  v_add_f32 v90, 1.0, v90
  v_add_f32 v91, 1.0, v91
  v_rcp_f32 v88, v88
  v_rcp_f32 v89, v89
  v_rcp_f32 v90, v90
  v_rcp_f32 v91, v91
  s_nop 0
  v_mul_f32 v132, v132, v88
  v_mul_f32 v133, v133, v89
  v_mul_f32 v134, v134, v90
  v_mul_f32 v135, v135, v91
  v_cvt_pk_bf16_f32 v120, 0, v120
  v_cvt_pk_bf16_f32 v121, 0, v121
  v_cvt_pk_bf16_f32 v122, 0, v122
  v_cvt_pk_bf16_f32 v123, 0, v123
  v_cvt_pk_bf16_f32 v124, 0, v124
  v_cvt_pk_bf16_f32 v125, 0, v125
  v_cvt_pk_bf16_f32 v126, 0, v126
  v_cvt_pk_bf16_f32 v127, 0, v127
  v_cvt_pk_bf16_f32 v128, 0, v128
  v_cvt_pk_bf16_f32 v129, 0, v129
  v_cvt_pk_bf16_f32 v130, 0, v130
  v_cvt_pk_bf16_f32 v131, 0, v131
  v_cvt_pk_bf16_f32 v132, 0, v132
  v_cvt_pk_bf16_f32 v133, 0, v133
  v_cvt_pk_bf16_f32 v134, 0, v134
  v_cvt_pk_bf16_f32 v135, 0, v135
  v_cvt_pk_bf16_f32 v72, 0, v72
  v_cvt_pk_bf16_f32 v73, 0, v73
  v_cvt_pk_bf16_f32 v74, 0, v74
  v_cvt_pk_bf16_f32 v75, 0, v75
  v_cvt_pk_bf16_f32 v76, 0, v76
  v_cvt_pk_bf16_f32 v77, 0, v77
  v_cvt_pk_bf16_f32 v78, 0, v78
  v_cvt_pk_bf16_f32 v79, 0, v79
  v_cvt_pk_bf16_f32 v80, 0, v80
  v_cvt_pk_bf16_f32 v81, 0, v81
  v_cvt_pk_bf16_f32 v82, 0, v82
  v_cvt_pk_bf16_f32 v83, 0, v83
  v_cvt_pk_bf16_f32 v84, 0, v84
  v_cvt_pk_bf16_f32 v85, 0, v85
  v_cvt_pk_bf16_f32 v86, 0, v86
  v_cvt_pk_bf16_f32 v87, 0, v87
  v_mul_f32 v72, v72, v120
  v_mul_f32 v73, v73, v121
  v_mul_f32 v74, v74, v122
  v_mul_f32 v75, v75, v123
  v_mul_f32 v76, v76, v124
  v_mul_f32 v77, v77, v125
  v_mul_f32 v78, v78, v126
  v_mul_f32 v79, v79, v127
  v_mul_f32 v80, v80, v128
  v_mul_f32 v81, v81, v129
  v_mul_f32 v82, v82, v130
  v_mul_f32 v83, v83, v131
  v_mul_f32 v84, v84, v132
  v_mul_f32 v85, v85, v133
  v_mul_f32 v86, v86, v134
  v_mul_f32 v87, v87, v135
  v_cvt_pk_bf16_f32 v40, v72, v73
  v_cvt_pk_bf16_f32 v41, v74, v75
  v_cvt_pk_bf16_f32 v42, v76, v77
  v_cvt_pk_bf16_f32 v43, v78, v79
  v_cvt_pk_bf16_f32 v44, v80, v81
  v_cvt_pk_bf16_f32 v45, v82, v83
  v_cvt_pk_bf16_f32 v46, v84, v85
  v_cvt_pk_bf16_f32 v47, v86, v87
  v_add_u32 v3, 14336, v0
  ds_write_b128 v3, v[40:43] offset:0
  ds_write_b128 v3, v[44:47] offset:3072
  s_mov_b32 s44, s28
  s_mov_b32 s45, s29
  s_mov_b32 s46, 1409024
  s_mov_b32 s11, 2752
  s_mov_b32 s12, 1409024
  v_mov_b32 v4, 12288
  v_mov_b32 v5, 13312
  v_lshlrev_b32 v2, 4, v1
  v_add_u32 v2, 1024, v2
  s_call_b64 s[62:63], L_gv
  v_cvt_pk_bf16_f32 v120, 0, v72
  v_cvt_pk_bf16_f32 v121, 0, v73
  v_cvt_pk_bf16_f32 v122, 0, v74
  v_cvt_pk_bf16_f32 v123, 0, v75
  v_cvt_pk_bf16_f32 v124, 0, v76
  v_cvt_pk_bf16_f32 v125, 0, v77
  v_cvt_pk_bf16_f32 v126, 0, v78
  v_cvt_pk_bf16_f32 v127, 0, v79
  v_cvt_pk_bf16_f32 v128, 0, v80
  v_cvt_pk_bf16_f32 v129, 0, v81
  v_cvt_pk_bf16_f32 v130, 0, v82
  v_cvt_pk_bf16_f32 v131, 0, v83
  v_cvt_pk_bf16_f32 v132, 0, v84
  v_cvt_pk_bf16_f32 v133, 0, v85
  v_cvt_pk_bf16_f32 v134, 0, v86
  v_cvt_pk_bf16_f32 v135, 0, v87
  s_mov_b32 s44, s30
  s_mov_b32 s45, s31
  s_mov_b32 s46, 1409024
  s_mov_b32 s11, 2752
  s_mov_b32 s12, 1409024
  v_mov_b32 v4, 12288
  v_mov_b32 v5, 13312
  v_lshlrev_b32 v2, 4, v1
  v_add_u32 v2, 1024, v2
  s_call_b64 s[62:63], L_gv
  v_mul_f32 v88, 0xbfb8aa3b, v120
  v_mul_f32 v89, 0xbfb8aa3b, v121
  v_mul_f32 v90, 0xbfb8aa3b, v122
  v_mul_f32 v91, 0xbfb8aa3b, v123
  v_exp_f32 v88, v88
  v_exp_f32 v89, v89
  v_exp_f32 v90, v90
  v_exp_f32 v91, v91
  s_nop 0
  v_add_f32 v88, 1.0, v88
  v_add_f32 v89, 1.0, v89
  v_add_f32 v90, 1.0, v90
  v_add_f32 v91, 1.0, v91
  v_rcp_f32 v88, v88
  v_rcp_f32 v89, v89
  v_rcp_f32 v90, v90
  v_rcp_f32 v91, v91
  s_nop 0
  v_mul_f32 v120, v120, v88
  v_mul_f32 v121, v121, v89
  v_mul_f32 v122, v122, v90
  v_mul_f32 v123, v123, v91
  v_mul_f32 v88, 0xbfb8aa3b, v124
  v_mul_f32 v89, 0xbfb8aa3b, v125
  v_mul_f32 v90, 0xbfb8aa3b, v126
  v_mul_f32 v91, 0xbfb8aa3b, v127
  v_exp_f32 v88, v88
  v_exp_f32 v89, v89
  v_exp_f32 v90, v90
  v_exp_f32 v91, v91
  s_nop 0
  v_add_f32 v88, 1.0, v88
  v_add_f32 v89, 1.0, v89
  v_add_f32 v90, 1.0, v90
  v_add_f32 v91, 1.0, v91
  v_rcp_f32 v88, v88
  v_rcp_f32 v89, v89
  v_rcp_f32 v90, v90
  v_rcp_f32 v91, v91
  s_nop 0
  v_mul_f32 v124, v124, v88
  v_mul_f32 v125, v125, v89
  v_mul_f32 v126, v126, v90
  v_mul_f32 v127, v127, v91
  v_mul_f32 v88, 0xbfb8aa3b, v128
  v_mul_f32 v89, 0xbfb8aa3b, v129
  v_mul_f32 v90, 0xbfb8aa3b, v130
  v_mul_f32 v91, 0xbfb8aa3b, v131
  v_exp_f32 v88, v88
  v_exp_f32 v89, v89
  v_exp_f32 v90, v90
  v_exp_f32 v91, v91
  s_nop 0
  v_add_f32 v88, 1.0, v88
  v_add_f32 v89, 1.0, v89
  v_add_f32 v90, 1.0, v90
  v_add_f32 v91, 1.0, v91
  v_rcp_f32 v88, v88
  v_rcp_f32 v89, v89
  v_rcp_f32 v90, v90
  v_rcp_f32 v91, v91
  s_nop 0
  v_mul_f32 v128, v128, v88
  v_mul_f32 v129, v129, v89
  v_mul_f32 v130, v130, v90
  v_mul_f32 v131, v131, v91
  v_mul_f32 v88, 0xbfb8aa3b, v132
  v_mul_f32 v89, 0xbfb8aa3b, v133
  v_mul_f32 v90, 0xbfb8aa3b, v134
  v_mul_f32 v91, 0xbfb8aa3b, v135
  v_exp_f32 v88, v88
  v_exp_f32 v89, v89
  v_exp_f32 v90, v90
  v_exp_f32 v91, v91
  s_nop 0
  v_add_f32 v88, 1.0, v88
  v_add_f32 v89, 1.0, v89
  v_add_f32 v90, 1.0, v90
  v_add_f32 v91, 1.0, v91
  v_rcp_f32 v88, v88
  v_rcp_f32 v89, v89
  v_rcp_f32 v90, v90
  v_rcp_f32 v91, v91
  s_nop 0
  v_mul_f32 v132, v132, v88
  v_mul_f32 v133, v133, v89
  v_mul_f32 v134, v134, v90
  v_mul_f32 v135, v135, v91
  v_cvt_pk_bf16_f32 v120, 0, v120
  v_cvt_pk_bf16_f32 v121, 0, v121
  v_cvt_pk_bf16_f32 v122, 0, v122
  v_cvt_pk_bf16_f32 v123, 0, v123
  v_cvt_pk_bf16_f32 v124, 0, v124
  v_cvt_pk_bf16_f32 v125, 0, v125
  v_cvt_pk_bf16_f32 v126, 0, v126
  v_cvt_pk_bf16_f32 v127, 0, v127
  v_cvt_pk_bf16_f32 v128, 0, v128
  v_cvt_pk_bf16_f32 v129, 0, v129
  v_cvt_pk_bf16_f32 v130, 0, v130
  v_cvt_pk_bf16_f32 v131, 0, v131
  v_cvt_pk_bf16_f32 v132, 0, v132
  v_cvt_pk_bf16_f32 v133, 0, v133
  v_cvt_pk_bf16_f32 v134, 0, v134
  v_cvt_pk_bf16_f32 v135, 0, v135
  v_cvt_pk_bf16_f32 v72, 0, v72
  v_cvt_pk_bf16_f32 v73, 0, v73
  v_cvt_pk_bf16_f32 v74, 0, v74
  v_cvt_pk_bf16_f32 v75, 0, v75
  v_cvt_pk_bf16_f32 v76, 0, v76
  v_cvt_pk_bf16_f32 v77, 0, v77
  v_cvt_pk_bf16_f32 v78, 0, v78
  v_cvt_pk_bf16_f32 v79, 0, v79
  v_cvt_pk_bf16_f32 v80, 0, v80
  v_cvt_pk_bf16_f32 v81, 0, v81
  v_cvt_pk_bf16_f32 v82, 0, v82
  v_cvt_pk_bf16_f32 v83, 0, v83
  v_cvt_pk_bf16_f32 v84, 0, v84
  v_cvt_pk_bf16_f32 v85, 0, v85
  v_cvt_pk_bf16_f32 v86, 0, v86
  v_cvt_pk_bf16_f32 v87, 0, v87
  v_mul_f32 v72, v72, v120
  v_mul_f32 v73, v73, v121
  v_mul_f32 v74, v74, v122
  v_mul_f32 v75, v75, v123
  v_mul_f32 v76, v76, v124
  v_mul_f32 v77, v77, v125
  v_mul_f32 v78, v78, v126
  v_mul_f32 v79, v79, v127
  v_mul_f32 v80, v80, v128
  v_mul_f32 v81, v81, v129
  v_mul_f32 v82, v82, v130
  v_mul_f32 v83, v83, v131
  v_mul_f32 v84, v84, v132
  v_mul_f32 v85, v85, v133
  v_mul_f32 v86, v86, v134
  v_mul_f32 v87, v87, v135
  v_cvt_pk_bf16_f32 v40, v72, v73
  v_cvt_pk_bf16_f32 v41, v74, v75
  v_cvt_pk_bf16_f32 v42, v76, v77
  v_cvt_pk_bf16_f32 v43, v78, v79
  v_cvt_pk_bf16_f32 v44, v80, v81
  v_cvt_pk_bf16_f32 v45, v82, v83
  v_cvt_pk_bf16_f32 v46, v84, v85
  v_cvt_pk_bf16_f32 v47, v86, v87
  v_add_u32 v3, 15360, v0
  ds_write_b128 v3, v[40:43] offset:0
  ds_write_b128 v3, v[44:47] offset:3072
  s_mov_b32 s44, s28
  s_mov_b32 s45, s29
  s_mov_b32 s46, 1409024
  s_mov_b32 s11, 2752
  s_mov_b32 s12, 1409024
  v_mov_b32 v4, 12288
  v_mov_b32 v5, 13312
  v_lshlrev_b32 v2, 4, v1
  v_add_u32 v2, 2048, v2
  s_call_b64 s[62:63], L_gv
  v_cvt_pk_bf16_f32 v120, 0, v72
  v_cvt_pk_bf16_f32 v121, 0, v73
  v_cvt_pk_bf16_f32 v122, 0, v74
  v_cvt_pk_bf16_f32 v123, 0, v75
  v_cvt_pk_bf16_f32 v124, 0, v76
  v_cvt_pk_bf16_f32 v125, 0, v77
  v_cvt_pk_bf16_f32 v126, 0, v78
  v_cvt_pk_bf16_f32 v127, 0, v79
  v_cvt_pk_bf16_f32 v128, 0, v80
  v_cvt_pk_bf16_f32 v129, 0, v81
  v_cvt_pk_bf16_f32 v130, 0, v82
  v_cvt_pk_bf16_f32 v131, 0, v83
  v_cvt_pk_bf16_f32 v132, 0, v84
  v_cvt_pk_bf16_f32 v133, 0, v85
  v_cvt_pk_bf16_f32 v134, 0, v86
  v_cvt_pk_bf16_f32 v135, 0, v87
  s_mov_b32 s44, s30
  s_mov_b32 s45, s31
  s_mov_b32 s46, 1409024
  s_mov_b32 s11, 2752
  s_mov_b32 s12, 1409024
  v_mov_b32 v4, 12288
  v_mov_b32 v5, 13312
  v_lshlrev_b32 v2, 4, v1
  v_add_u32 v2, 2048, v2
  s_call_b64 s[62:63], L_gv
  v_mul_f32 v88, 0xbfb8aa3b, v120
  v_mul_f32 v89, 0xbfb8aa3b, v121
  v_mul_f32 v90, 0xbfb8aa3b, v122
  v_mul_f32 v91, 0xbfb8aa3b, v123
  v_exp_f32 v88, v88
  v_exp_f32 v89, v89
  v_exp_f32 v90, v90
  v_exp_f32 v91, v91
  s_nop 0
  v_add_f32 v88, 1.0, v88
  v_add_f32 v89, 1.0, v89
  v_add_f32 v90, 1.0, v90
  v_add_f32 v91, 1.0, v91
  v_rcp_f32 v88, v88
  v_rcp_f32 v89, v89
  v_rcp_f32 v90, v90
  v_rcp_f32 v91, v91
  s_nop 0
  v_mul_f32 v120, v120, v88
  v_mul_f32 v121, v121, v89
  v_mul_f32 v122, v122, v90
  v_mul_f32 v123, v123, v91
  v_mul_f32 v88, 0xbfb8aa3b, v124
  v_mul_f32 v89, 0xbfb8aa3b, v125
  v_mul_f32 v90, 0xbfb8aa3b, v126
  v_mul_f32 v91, 0xbfb8aa3b, v127
  v_exp_f32 v88, v88
  v_exp_f32 v89, v89
  v_exp_f32 v90, v90
  v_exp_f32 v91, v91
  s_nop 0
  v_add_f32 v88, 1.0, v88
  v_add_f32 v89, 1.0, v89
  v_add_f32 v90, 1.0, v90
  v_add_f32 v91, 1.0, v91
  v_rcp_f32 v88, v88
  v_rcp_f32 v89, v89
  v_rcp_f32 v90, v90
  v_rcp_f32 v91, v91
  s_nop 0
  v_mul_f32 v124, v124, v88
  v_mul_f32 v125, v125, v89
  v_mul_f32 v126, v126, v90
  v_mul_f32 v127, v127, v91
  v_mul_f32 v88, 0xbfb8aa3b, v128
  v_mul_f32 v89, 0xbfb8aa3b, v129
  v_mul_f32 v90, 0xbfb8aa3b, v130
  v_mul_f32 v91, 0xbfb8aa3b, v131
  v_exp_f32 v88, v88
  v_exp_f32 v89, v89
  v_exp_f32 v90, v90
  v_exp_f32 v91, v91
  s_nop 0
  v_add_f32 v88, 1.0, v88
  v_add_f32 v89, 1.0, v89
  v_add_f32 v90, 1.0, v90
  v_add_f32 v91, 1.0, v91
  v_rcp_f32 v88, v88
  v_rcp_f32 v89, v89
  v_rcp_f32 v90, v90
  v_rcp_f32 v91, v91
  s_nop 0
  v_mul_f32 v128, v128, v88
  v_mul_f32 v129, v129, v89
  v_mul_f32 v130, v130, v90
  v_mul_f32 v131, v131, v91
  v_mul_f32 v88, 0xbfb8aa3b, v132
  v_mul_f32 v89, 0xbfb8aa3b, v133
  v_mul_f32 v90, 0xbfb8aa3b, v134
  v_mul_f32 v91, 0xbfb8aa3b, v135
  v_exp_f32 v88, v88
  v_exp_f32 v89, v89
  v_exp_f32 v90, v90
  v_exp_f32 v91, v91
  s_nop 0
  v_add_f32 v88, 1.0, v88
  v_add_f32 v89, 1.0, v89
  v_add_f32 v90, 1.0, v90
  v_add_f32 v91, 1.0, v91
  v_rcp_f32 v88, v88
  v_rcp_f32 v89, v89
  v_rcp_f32 v90, v90
  v_rcp_f32 v91, v91
  s_nop 0
  v_mul_f32 v132, v132, v88
  v_mul_f32 v133, v133, v89
  v_mul_f32 v134, v134, v90
  v_mul_f32 v135, v135, v91
  v_cvt_pk_bf16_f32 v120, 0, v120
  v_cvt_pk_bf16_f32 v121, 0, v121
  v_cvt_pk_bf16_f32 v122, 0, v122
  v_cvt_pk_bf16_f32 v123, 0, v123
  v_cvt_pk_bf16_f32 v124, 0, v124
  v_cvt_pk_bf16_f32 v125, 0, v125
  v_cvt_pk_bf16_f32 v126, 0, v126
  v_cvt_pk_bf16_f32 v127, 0, v127
  v_cvt_pk_bf16_f32 v128, 0, v128
  v_cvt_pk_bf16_f32 v129, 0, v129
  v_cvt_pk_bf16_f32 v130, 0, v130
  v_cvt_pk_bf16_f32 v131, 0, v131
  v_cvt_pk_bf16_f32 v132, 0, v132
  v_cvt_pk_bf16_f32 v133, 0, v133
  v_cvt_pk_bf16_f32 v134, 0, v134
  v_cvt_pk_bf16_f32 v135, 0, v135
  v_cvt_pk_bf16_f32 v72, 0, v72
  v_cvt_pk_bf16_f32 v73, 0, v73
  v_cvt_pk_bf16_f32 v74, 0, v74
  v_cvt_pk_bf16_f32 v75, 0, v75
  v_cvt_pk_bf16_f32 v76, 0, v76
  v_cvt_pk_bf16_f32 v77, 0, v77
  v_cvt_pk_bf16_f32 v78, 0, v78
  v_cvt_pk_bf16_f32 v79, 0, v79
  v_cvt_pk_bf16_f32 v80, 0, v80
  v_cvt_pk_bf16_f32 v81, 0, v81
  v_cvt_pk_bf16_f32 v82, 0, v82
  v_cvt_pk_bf16_f32 v83, 0, v83
  v_cvt_pk_bf16_f32 v84, 0, v84
  v_cvt_pk_bf16_f32 v85, 0, v85
  v_cvt_pk_bf16_f32 v86, 0, v86
  v_cvt_pk_bf16_f32 v87, 0, v87
  v_mul_f32 v72, v72, v120
  v_mul_f32 v73, v73, v121
  v_mul_f32 v74, v74, v122
  v_mul_f32 v75, v75, v123
  v_mul_f32 v76, v76, v124
  v_mul_f32 v77, v77, v125
  v_mul_f32 v78, v78, v126
  v_mul_f32 v79, v79, v127
  v_mul_f32 v80, v80, v128
  v_mul_f32 v81, v81, v129
  v_mul_f32 v82, v82, v130
  v_mul_f32 v83, v83, v131
  v_mul_f32 v84, v84, v132
  v_mul_f32 v85, v85, v133
  v_mul_f32 v86, v86, v134
  v_mul_f32 v87, v87, v135
  v_cvt_pk_bf16_f32 v40, v72, v73
  v_cvt_pk_bf16_f32 v41, v74, v75
  v_cvt_pk_bf16_f32 v42, v76, v77
  v_cvt_pk_bf16_f32 v43, v78, v79
  v_cvt_pk_bf16_f32 v44, v80, v81
  v_cvt_pk_bf16_f32 v45, v82, v83
  v_cvt_pk_bf16_f32 v46, v84, v85
  v_cvt_pk_bf16_f32 v47, v86, v87
  v_add_u32 v3, 16384, v0
  ds_write_b128 v3, v[40:43] offset:0
  ds_write_b128 v3, v[44:47] offset:3072
  s_mov_b32 s44, s32
  s_mov_b32 s45, s33
  s_mov_b32 s46, 1409024
  s_mov_b32 s11, 1024
  s_mov_b32 s12, 1409024
  v_mov_b32 v4, 14336
  v_mov_b32 v5, 17408
  v_lshlrev_b32 v2, 4, v1
  s_call_b64 s[62:63], L_gv
  v_lshrrev_b32 v2, 1, v1
  v_lshlrev_b32 v2, 7, v2
  v_and_b32 v3, 1, v1
  v_lshl_add_u32 v2, v3, 5, v2
  v_add_u32 v2, 24576, v2
  global_load_dwordx4 v[40:43], v2, s[42:43] offset:0 sc1
  global_load_dwordx4 v[44:47], v2, s[42:43] offset:16 sc1
  global_load_dwordx4 v[48:51], v2, s[42:43] offset:64 sc1
  global_load_dwordx4 v[52:55], v2, s[42:43] offset:80 sc1
  s_waitcnt vmcnt(0)
  v_lshlrev_b32 v88, 16, v40
  v_and_b32 v89, s73, v40
  v_lshlrev_b32 v90, 16, v42
  v_and_b32 v91, s73, v42
  v_lshlrev_b32 v92, 16, v44
  v_and_b32 v93, s73, v44
  v_lshlrev_b32 v94, 16, v46
  v_and_b32 v95, s73, v46
  v_lshlrev_b32 v96, 16, v48
  v_and_b32 v97, s73, v48
  v_lshlrev_b32 v98, 16, v50
  v_and_b32 v99, s73, v50
  v_lshlrev_b32 v100, 16, v52
  v_and_b32 v101, s73, v52
  v_lshlrev_b32 v102, 16, v54
  v_and_b32 v103, s73, v54
  v_cvt_pk_bf16_f32 v72, 0, v72
  v_cvt_pk_bf16_f32 v73, 0, v73
  v_cvt_pk_bf16_f32 v74, 0, v74
  v_cvt_pk_bf16_f32 v75, 0, v75
  v_cvt_pk_bf16_f32 v76, 0, v76
  v_cvt_pk_bf16_f32 v77, 0, v77
  v_cvt_pk_bf16_f32 v78, 0, v78
  v_cvt_pk_bf16_f32 v79, 0, v79
  v_cvt_pk_bf16_f32 v80, 0, v80
  v_cvt_pk_bf16_f32 v81, 0, v81
  v_cvt_pk_bf16_f32 v82, 0, v82
  v_cvt_pk_bf16_f32 v83, 0, v83
  v_cvt_pk_bf16_f32 v84, 0, v84
  v_cvt_pk_bf16_f32 v85, 0, v85
  v_cvt_pk_bf16_f32 v86, 0, v86
  v_cvt_pk_bf16_f32 v87, 0, v87
  v_mul_f32 v72, v72, v88
  v_mul_f32 v73, v73, v89
  v_mul_f32 v74, v74, v90
  v_mul_f32 v75, v75, v91
  v_mul_f32 v76, v76, v92
  v_mul_f32 v77, v77, v93
  v_mul_f32 v78, v78, v94
  v_mul_f32 v79, v79, v95
  v_mul_f32 v80, v80, v96
  v_mul_f32 v81, v81, v97
  v_mul_f32 v82, v82, v98
  v_mul_f32 v83, v83, v99
  v_mul_f32 v84, v84, v100
  v_mul_f32 v85, v85, v101
  v_mul_f32 v86, v86, v102
  v_mul_f32 v87, v87, v103
  v_cvt_pk_bf16_f32 v72, 0, v72
  v_cvt_pk_bf16_f32 v73, 0, v73
  v_cvt_pk_bf16_f32 v74, 0, v74
  v_cvt_pk_bf16_f32 v75, 0, v75
  v_cvt_pk_bf16_f32 v76, 0, v76
  v_cvt_pk_bf16_f32 v77, 0, v77
  v_cvt_pk_bf16_f32 v78, 0, v78
  v_cvt_pk_bf16_f32 v79, 0, v79
  v_cvt_pk_bf16_f32 v80, 0, v80
  v_cvt_pk_bf16_f32 v81, 0, v81
  v_cvt_pk_bf16_f32 v82, 0, v82
  v_cvt_pk_bf16_f32 v83, 0, v83
  v_cvt_pk_bf16_f32 v84, 0, v84
  v_cvt_pk_bf16_f32 v85, 0, v85
  v_cvt_pk_bf16_f32 v86, 0, v86
  v_cvt_pk_bf16_f32 v87, 0, v87
  v_add_f32 v104, v104, v72
  v_add_f32 v105, v105, v73
  v_add_f32 v106, v106, v74
  v_add_f32 v107, v107, v75
  v_add_f32 v108, v108, v76
  v_add_f32 v109, v109, v77
  v_add_f32 v110, v110, v78
  v_add_f32 v111, v111, v79
  v_add_f32 v112, v112, v80
  v_add_f32 v113, v113, v81
  v_add_f32 v114, v114, v82
  v_add_f32 v115, v115, v83
  v_add_f32 v116, v116, v84
  v_add_f32 v117, v117, v85
  v_add_f32 v118, v118, v86
  v_add_f32 v119, v119, v87
  v_cvt_pk_bf16_f32 v104, 0, v104
  v_cvt_pk_bf16_f32 v105, 0, v105
  v_cvt_pk_bf16_f32 v106, 0, v106
  v_cvt_pk_bf16_f32 v107, 0, v107
  v_cvt_pk_bf16_f32 v108, 0, v108
  v_cvt_pk_bf16_f32 v109, 0, v109
  v_cvt_pk_bf16_f32 v110, 0, v110
  v_cvt_pk_bf16_f32 v111, 0, v111
  v_cvt_pk_bf16_f32 v112, 0, v112
  v_cvt_pk_bf16_f32 v113, 0, v113
  v_cvt_pk_bf16_f32 v114, 0, v114
  v_cvt_pk_bf16_f32 v115, 0, v115
  v_cvt_pk_bf16_f32 v116, 0, v116
  v_cvt_pk_bf16_f32 v117, 0, v117
  v_cvt_pk_bf16_f32 v118, 0, v118
  v_cvt_pk_bf16_f32 v119, 0, v119
  v_cvt_pk_bf16_f32 v40, v104, v105
  v_cvt_pk_bf16_f32 v41, v106, v107
  v_cvt_pk_bf16_f32 v42, v108, v109
  v_cvt_pk_bf16_f32 v43, v110, v111
  v_cvt_pk_bf16_f32 v44, v112, v113
  v_cvt_pk_bf16_f32 v45, v114, v115
  v_cvt_pk_bf16_f32 v46, v116, v117
  v_cvt_pk_bf16_f32 v47, v118, v119
  global_store_dwordx4 v0, v[40:43], s[38:39] offset:0 sc1
  global_store_dwordx4 v0, v[44:47], s[38:39] offset:1024 sc1
  s_endpgm
L_gv:
  v_mov_b32 v72, 0
  v_mov_b32 v73, 0
  v_mov_b32 v74, 0
  v_mov_b32 v75, 0
  v_mov_b32 v76, 0
  v_mov_b32 v77, 0
  v_mov_b32 v78, 0
  v_mov_b32 v79, 0
  v_mov_b32 v80, 0
  v_mov_b32 v81, 0
  v_mov_b32 v82, 0
  v_mov_b32 v83, 0
  v_mov_b32 v84, 0
  v_mov_b32 v85, 0
  v_mov_b32 v86, 0
  v_mov_b32 v87, 0
  s_mov_b32 s10, 0
L_gvl:
  buffer_load_dwordx4 v[40:43], v2, s[44:47], s10 offen
  s_add_u32 s10, s10, s11
  buffer_load_dwordx4 v[44:47], v2, s[44:47], s10 offen
  s_add_u32 s10, s10, s11
  buffer_load_dwordx4 v[48:51], v2, s[44:47], s10 offen
  s_add_u32 s10, s10, s11
  buffer_load_dwordx4 v[52:55], v2, s[44:47], s10 offen
  s_add_u32 s10, s10, s11
  buffer_load_dwordx4 v[56:59], v2, s[44:47], s10 offen
  s_add_u32 s10, s10, s11
  buffer_load_dwordx4 v[60:63], v2, s[44:47], s10 offen
  s_add_u32 s10, s10, s11
  buffer_load_dwordx4 v[64:67], v2, s[44:47], s10 offen
  s_add_u32 s10, s10, s11
  buffer_load_dwordx4 v[68:71], v2, s[44:47], s10 offen
  s_add_u32 s10, s10, s11
  ds_read_b128 v[88:91], v4
  ds_read_b128 v[92:95], v5
  v_add_u32 v4, 16, v4
  v_add_u32 v5, 16, v5
  s_waitcnt lgkmcnt(0)
  v_and_b32 v8, 0xffff, v88
  v_lshlrev_b32 v9, 16, v88
  v_and_b32 v10, 0xffff, v92
  v_lshlrev_b32 v11, 16, v92
  s_waitcnt vmcnt(7)
  v_dot2c_f32_bf16 v72, v8, v40
  v_dot2c_f32_bf16 v73, v9, v40
  v_dot2c_f32_bf16 v74, v8, v41
  v_dot2c_f32_bf16 v75, v9, v41
  v_dot2c_f32_bf16 v76, v8, v42
  v_dot2c_f32_bf16 v77, v9, v42
  v_dot2c_f32_bf16 v78, v8, v43
  v_dot2c_f32_bf16 v79, v9, v43
  v_dot2c_f32_bf16 v80, v10, v40
  v_dot2c_f32_bf16 v81, v11, v40
  v_dot2c_f32_bf16 v82, v10, v41
  v_dot2c_f32_bf16 v83, v11, v41
  v_dot2c_f32_bf16 v84, v10, v42
  v_dot2c_f32_bf16 v85, v11, v42
  v_dot2c_f32_bf16 v86, v10, v43
  v_dot2c_f32_bf16 v87, v11, v43
  v_lshrrev_b32 v8, 16, v88
  v_and_b32 v9, s73, v88
  v_lshrrev_b32 v10, 16, v92
  v_and_b32 v11, s73, v92
  s_waitcnt vmcnt(6)
  v_dot2c_f32_bf16 v72, v8, v44
  v_dot2c_f32_bf16 v73, v9, v44
  v_dot2c_f32_bf16 v74, v8, v45
  v_dot2c_f32_bf16 v75, v9, v45
  v_dot2c_f32_bf16 v76, v8, v46
  v_dot2c_f32_bf16 v77, v9, v46
  v_dot2c_f32_bf16 v78, v8, v47
  v_dot2c_f32_bf16 v79, v9, v47
  v_dot2c_f32_bf16 v80, v10, v44
  v_dot2c_f32_bf16 v81, v11, v44
  v_dot2c_f32_bf16 v82, v10, v45
  v_dot2c_f32_bf16 v83, v11, v45
  v_dot2c_f32_bf16 v84, v10, v46
  v_dot2c_f32_bf16 v85, v11, v46
  v_dot2c_f32_bf16 v86, v10, v47
  v_dot2c_f32_bf16 v87, v11, v47
  v_and_b32 v8, 0xffff, v89
  v_lshlrev_b32 v9, 16, v89
  v_and_b32 v10, 0xffff, v93
  v_lshlrev_b32 v11, 16, v93
  s_waitcnt vmcnt(5)
  v_dot2c_f32_bf16 v72, v8, v48
  v_dot2c_f32_bf16 v73, v9, v48
  v_dot2c_f32_bf16 v74, v8, v49
  v_dot2c_f32_bf16 v75, v9, v49
  v_dot2c_f32_bf16 v76, v8, v50
  v_dot2c_f32_bf16 v77, v9, v50
  v_dot2c_f32_bf16 v78, v8, v51
  v_dot2c_f32_bf16 v79, v9, v51
  v_dot2c_f32_bf16 v80, v10, v48
  v_dot2c_f32_bf16 v81, v11, v48
  v_dot2c_f32_bf16 v82, v10, v49
  v_dot2c_f32_bf16 v83, v11, v49
  v_dot2c_f32_bf16 v84, v10, v50
  v_dot2c_f32_bf16 v85, v11, v50
  v_dot2c_f32_bf16 v86, v10, v51
  v_dot2c_f32_bf16 v87, v11, v51
  v_lshrrev_b32 v8, 16, v89
  v_and_b32 v9, s73, v89
  v_lshrrev_b32 v10, 16, v93
  v_and_b32 v11, s73, v93
  s_waitcnt vmcnt(4)
  v_dot2c_f32_bf16 v72, v8, v52
  v_dot2c_f32_bf16 v73, v9, v52
  v_dot2c_f32_bf16 v74, v8, v53
  v_dot2c_f32_bf16 v75, v9, v53
  v_dot2c_f32_bf16 v76, v8, v54
  v_dot2c_f32_bf16 v77, v9, v54
  v_dot2c_f32_bf16 v78, v8, v55
  v_dot2c_f32_bf16 v79, v9, v55
  v_dot2c_f32_bf16 v80, v10, v52
  v_dot2c_f32_bf16 v81, v11, v52
  v_dot2c_f32_bf16 v82, v10, v53
  v_dot2c_f32_bf16 v83, v11, v53
  v_dot2c_f32_bf16 v84, v10, v54
  v_dot2c_f32_bf16 v85, v11, v54
  v_dot2c_f32_bf16 v86, v10, v55
  v_dot2c_f32_bf16 v87, v11, v55
  v_and_b32 v8, 0xffff, v90
  v_lshlrev_b32 v9, 16, v90
  v_and_b32 v10, 0xffff, v94
  v_lshlrev_b32 v11, 16, v94
  s_waitcnt vmcnt(3)
  v_dot2c_f32_bf16 v72, v8, v56
  v_dot2c_f32_bf16 v73, v9, v56
  v_dot2c_f32_bf16 v74, v8, v57
  v_dot2c_f32_bf16 v75, v9, v57
  v_dot2c_f32_bf16 v76, v8, v58
  v_dot2c_f32_bf16 v77, v9, v58
  v_dot2c_f32_bf16 v78, v8, v59
  v_dot2c_f32_bf16 v79, v9, v59
  v_dot2c_f32_bf16 v80, v10, v56
  v_dot2c_f32_bf16 v81, v11, v56
  v_dot2c_f32_bf16 v82, v10, v57
  v_dot2c_f32_bf16 v83, v11, v57
  v_dot2c_f32_bf16 v84, v10, v58
  v_dot2c_f32_bf16 v85, v11, v58
  v_dot2c_f32_bf16 v86, v10, v59
  v_dot2c_f32_bf16 v87, v11, v59
  v_lshrrev_b32 v8, 16, v90
  v_and_b32 v9, s73, v90
  v_lshrrev_b32 v10, 16, v94
  v_and_b32 v11, s73, v94
  s_waitcnt vmcnt(2)
  v_dot2c_f32_bf16 v72, v8, v60
  v_dot2c_f32_bf16 v73, v9, v60
  v_dot2c_f32_bf16 v74, v8, v61
  v_dot2c_f32_bf16 v75, v9, v61
  v_dot2c_f32_bf16 v76, v8, v62
  v_dot2c_f32_bf16 v77, v9, v62
  v_dot2c_f32_bf16 v78, v8, v63
  v_dot2c_f32_bf16 v79, v9, v63
  v_dot2c_f32_bf16 v80, v10, v60
  v_dot2c_f32_bf16 v81, v11, v60
  v_dot2c_f32_bf16 v82, v10, v61
  v_dot2c_f32_bf16 v83, v11, v61
  v_dot2c_f32_bf16 v84, v10, v62
  v_dot2c_f32_bf16 v85, v11, v62
  v_dot2c_f32_bf16 v86, v10, v63
  v_dot2c_f32_bf16 v87, v11, v63
  v_and_b32 v8, 0xffff, v91
  v_lshlrev_b32 v9, 16, v91
  v_and_b32 v10, 0xffff, v95
  v_lshlrev_b32 v11, 16, v95
  s_waitcnt vmcnt(1)
  v_dot2c_f32_bf16 v72, v8, v64
  v_dot2c_f32_bf16 v73, v9, v64
  v_dot2c_f32_bf16 v74, v8, v65
  v_dot2c_f32_bf16 v75, v9, v65
  v_dot2c_f32_bf16 v76, v8, v66
  v_dot2c_f32_bf16 v77, v9, v66
  v_dot2c_f32_bf16 v78, v8, v67
  v_dot2c_f32_bf16 v79, v9, v67
  v_dot2c_f32_bf16 v80, v10, v64
  v_dot2c_f32_bf16 v81, v11, v64
  v_dot2c_f32_bf16 v82, v10, v65
  v_dot2c_f32_bf16 v83, v11, v65
  v_dot2c_f32_bf16 v84, v10, v66
  v_dot2c_f32_bf16 v85, v11, v66
  v_dot2c_f32_bf16 v86, v10, v67
  v_dot2c_f32_bf16 v87, v11, v67
  v_lshrrev_b32 v8, 16, v91
  v_and_b32 v9, s73, v91
  v_lshrrev_b32 v10, 16, v95
  v_and_b32 v11, s73, v95
  s_waitcnt vmcnt(0)
  v_dot2c_f32_bf16 v72, v8, v68
  v_dot2c_f32_bf16 v73, v9, v68
  v_dot2c_f32_bf16 v74, v8, v69
  v_dot2c_f32_bf16 v75, v9, v69
  v_dot2c_f32_bf16 v76, v8, v70
  v_dot2c_f32_bf16 v77, v9, v70
  v_dot2c_f32_bf16 v78, v8, v71
  v_dot2c_f32_bf16 v79, v9, v71
  v_dot2c_f32_bf16 v80, v10, v68
  v_dot2c_f32_bf16 v81, v11, v68
  v_dot2c_f32_bf16 v82, v10, v69
  v_dot2c_f32_bf16 v83, v11, v69
  v_dot2c_f32_bf16 v84, v10, v70
  v_dot2c_f32_bf16 v85, v11, v70
  v_dot2c_f32_bf16 v86, v10, v71
  v_dot2c_f32_bf16 v87, v11, v71
  s_cmp_lt_u32 s10, s12
  s_cbranch_scc1 L_gvl
  s_nop 1
  s_setpc_b64 s[62:63]
L_team:
  s_and_b32 s5, s13, 3
  v_and_b32 v0, 0xff, v0
  v_mov_b32 v38, 0
  s_mov_b32 s77, 0
  s_lshr_b32 s60, s2, 5
  v_lshrrev_b32 v12, 3, v0
  v_lshlrev_b32 v12, 5, v12
  v_bfe_u32 v3, v1, 2, 1
  v_lshl_add_u32 v12, v3, 10, v12
  v_and_b32 v8, 3, v1
  v_lshl_add_u32 v37, v8, 3, v12
  v_and_b32 v12, 0xffffffdf, v12
  v_lshl_add_u32 v12, v8, 4, v12
  v_bfe_u32 v8, v1, 3, 1
  v_lshl_add_u32 v12, v8, 3, v12
  v_lshl_add_u32 v12, v3, 5, v12
  s_waitcnt lgkmcnt(0)
  s_load_dword s74, s[42:43], 0
  s_barrier
  s_cmp_ge_u32 s13, 8
  s_cbranch_scc1 L_r_mod
L_r_q:
  s_lshl3_add_u32 s61, s8, s60
  s_lshl_b32 s48, s61, 7
  s_lshl_b32 s58, s61, 8
  s_add_u32 s58, s58, 32768
  global_load_dwordx2 v[14:15], v37, s[16:17]
  s_mov_b32 s44, s22
  s_mov_b32 s45, s23
  s_mov_b32 s46, 4194304
  s_mov_b32 s47, 0x20000
  s_cmp_ge_u32 s60, 2
  s_cbranch_scc1 L_q_go
  s_mov_b32 s70, 0
L_sn_26:
  ds_read_b32 v8, v38 offset:268
  s_waitcnt lgkmcnt(0)
  v_cmp_gt_u32 vcc, 0x4, v8
  s_cmp_eq_u64 vcc, 0
  s_cbranch_scc1 L_snd_27
  s_sleep 1
  s_add_u32 s70, s70, 1
  s_cmp_lt_u32 s70, 2097152
  s_cbranch_scc1 L_sn_26
L_snd_27:
L_q_go:
  v_lshrrev_b32 v2, 3, v1
  v_and_b32 v3, 6, v2
  v_xor_b32 v3, v3, v1
  v_mul_u32_u24 v2, 8192, v2
  v_and_b32 v3, 7, v3
  v_lshl_add_u32 v2, v3, 4, v2
  s_mul_i32 s49, s5, 1048576
  s_lshl_b32 s50, s5, 14
  s_add_u32 s49, s49, s48
  s_add_u32 s50, s50, 12288
  s_add_u32 s51, s50, 16384
L_dma_28:
  s_mov_b32 m0, s50
  s_add_u32 s50, s50, 1024
  buffer_load_dwordx4 v2, s[44:47], s49 offen nt lds
  s_add_u32 s49, s49, 65536
  s_cmp_lt_u32 s50, s51
  s_cbranch_scc1 L_dma_28
L_dmae_29:
  v_mov_b32 v3, 1
  s_mov_b64 exec, 1
  ds_add_u32 v38, v3 offset:264
  s_mov_b64 exec, -1
  s_waitcnt lgkmcnt(0)
  s_mul_i32 s74, s74, 0x9e3779b1
  s_add_u32 s74, s74, 0x7f4a7c15
  v_bfe_u32 v6, v1, 2, 1
  v_lshlrev_b32 v6, 5, v6
  v_add_u32 v6, 3136, v6
  s_lshl_b32 s49, s5, 3
  v_add_u32 v5, s49, v6
  s_waitcnt vmcnt(16)
  v_lshlrev_b32 v20, 16, v14
  v_and_b32 v21, s73, v14
  v_lshlrev_b32 v22, 16, v15
  v_and_b32 v23, s73, v15
  v_add_f32 v8, v20, v21
  v_mul_f32 v9, v20, v20
  v_add_f32 v10, v22, v23
  v_mul_f32 v11, v22, v22
  v_fmac_f32 v9, v21, v21
  v_fmac_f32 v11, v23, v23
  v_add_f32 v8, v8, v10
  v_add_f32 v9, v9, v11
  s_nop 0
  v_add_f32_dpp v8, v8, v8 quad_perm:[1,0,3,2] row_mask:0xf bank_mask:0xf
  v_add_f32_dpp v9, v9, v9 quad_perm:[1,0,3,2] row_mask:0xf bank_mask:0xf
  s_nop 0
  v_add_f32_dpp v8, v8, v8 quad_perm:[2,3,0,1] row_mask:0xf bank_mask:0xf
  v_add_f32_dpp v9, v9, v9 quad_perm:[2,3,0,1] row_mask:0xf bank_mask:0xf
  s_nop 0
  v_add_f32_dpp v8, v8, v8 row_ror:8 row_mask:0xf bank_mask:0xf
  v_add_f32_dpp v9, v9, v9 row_ror:8 row_mask:0xf bank_mask:0xf
  s_nop 0
  v_mov_b32 v10, v8
  v_mov_b32 v11, v9
  s_nop 0
  v_permlane16_swap_b32 v10, v8
  v_permlane16_swap_b32 v11, v9
  v_add_f32 v8, v8, v10
  v_add_f32 v9, v9, v11
  v_mov_b32 v10, v8
  v_mov_b32 v11, v9
  s_nop 0
  v_permlane32_swap_b32 v10, v8
  v_permlane32_swap_b32 v11, v9
  v_add_f32 v8, v8, v10
  v_add_f32 v9, v9, v11
  ds_write_b64 v5, v[8:9]
  s_waitcnt vmcnt(0) lgkmcnt(0)
  s_add_u32 s77, s77, 4
  v_mov_b32 v9, 1
  s_mov_b64 exec, 1
  ds_add_u32 v38, v9 offset:312
  s_mov_b64 exec, -1
  s_mov_b32 s70, 0
L_hy_30:
  ds_read_b32 v9, v38 offset:312
  s_waitcnt lgkmcnt(0)
  v_cmp_gt_u32 vcc, s77, v9
  s_cmp_eq_u64 vcc, 0
  s_cbranch_scc1 L_hyd_31
  s_add_u32 s70, s70, 1
  s_cmp_lt_u32 s70, 2097152
  s_cbranch_scc1 L_hy_30
L_hyd_31:
  ds_read_b128 v[24:27], v6
  ds_read_b128 v[28:31], v6 offset:16
  s_waitcnt lgkmcnt(0)
  v_pk_add_f32 v[24:25], v[24:25], v[26:27]
  v_pk_add_f32 v[28:29], v[28:29], v[30:31]
  v_pk_add_f32 v[24:25], v[24:25], v[28:29]
  v_mul_f32 v8, 0x3b000000, v24
  v_mul_f32 v9, 0x3b000000, v25
  v_fma_f32 v9, -v8, v8, v9
  v_cvt_pk_bf16_f32 v8, 0, v8
  v_max_f32 v9, 0, v9
  v_cvt_pk_bf16_f32 v9, 0, v9
  v_sub_f32 v20, v20, v8
  v_sub_f32 v21, v21, v8
  v_add_f32 v9, 0x3727c5ac, v9
  v_sub_f32 v22, v22, v8
  v_sub_f32 v23, v23, v8
  v_cvt_pk_bf16_f32 v9, 0, v9
  v_cvt_pk_bf16_f32 v20, 0, v20
  v_sqrt_f32 v9, v9
  v_cvt_pk_bf16_f32 v21, 0, v21
  v_cvt_pk_bf16_f32 v9, 0, v9
  v_cvt_pk_bf16_f32 v22, 0, v22
  v_rcp_f32 v9, v9
  v_cvt_pk_bf16_f32 v23, 0, v23
  v_mul_f32 v20, v20, v9
  v_mul_f32 v21, v21, v9
  v_mul_f32 v22, v22, v9
  v_mul_f32 v23, v23, v9
  v_cvt_pk_bf16_f32 v20, 0, v20
  v_cvt_pk_bf16_f32 v21, 0, v21
  v_cvt_pk_bf16_f32 v22, 0, v22
  v_cvt_pk_bf16_f32 v23, 0, v23
  s_lshl_b32 s49, s8, 13
  s_add_u32 s49, s49, 917504
  v_lshl_add_u32 v15, v0, 4, s49
  v_add_u32 v36, 0x1000, v15
  s_mov_b64 s[64:65], -1
  s_mov_b64 s[66:67], -1
  s_mov_b64 exec, s[64:65]
  global_load_dwordx4 v[16:19], v15, s[42:43] sc1
  s_mov_b64 exec, s[66:67]
  global_load_dwordx4 v[32:35], v36, s[42:43] sc1
  s_mov_b64 exec, -1
  v_lshrrev_b32 v2, 2, v1
  v_bfe_u32 v3, v1, 1, 1
  s_lshl_b32 s49, s5, 1
  v_or_b32 v3, s49, v3
  v_and_b32 v10, 6, v2
  v_xor_b32 v3, v3, v10
  v_lshlrev_b32 v2, 7, v2
  v_lshl_add_u32 v2, v3, 4, v2
  v_and_b32 v3, 1, v1
  v_lshl_add_u32 v2, v3, 3, v2
  v_add_u32 v2, 12288, v2
  ds_read_b64_tr_b16 v[40:41], v2 offset:0
  ds_read_b64_tr_b16 v[42:43], v2 offset:2048
  ds_read_b64_tr_b16 v[44:45], v2 offset:4096
  ds_read_b64_tr_b16 v[46:47], v2 offset:6144
  ds_read_b64_tr_b16 v[48:49], v2 offset:8192
  ds_read_b64_tr_b16 v[50:51], v2 offset:10240
  ds_read_b64_tr_b16 v[52:53], v2 offset:12288
  ds_read_b64_tr_b16 v[54:55], v2 offset:14336
  ds_read_b64_tr_b16 v[56:57], v2 offset:16384
  ds_read_b64_tr_b16 v[58:59], v2 offset:18432
  ds_read_b64_tr_b16 v[60:61], v2 offset:20480
  ds_read_b64_tr_b16 v[62:63], v2 offset:22528
  s_waitcnt lgkmcnt(10)
  ds_read_b64_tr_b16 v[64:65], v2 offset:24576
  ds_read_b64_tr_b16 v[66:67], v2 offset:26624
  s_waitcnt lgkmcnt(10)
  ds_read_b64_tr_b16 v[68:69], v2 offset:28672
  ds_read_b64_tr_b16 v[70:71], v2 offset:30720
  s_waitcnt lgkmcnt(10)
  ds_read_b64_tr_b16 v[72:73], v2 offset:32768
  ds_read_b64_tr_b16 v[74:75], v2 offset:34816
  s_waitcnt lgkmcnt(10)
  ds_read_b64_tr_b16 v[76:77], v2 offset:36864
  ds_read_b64_tr_b16 v[78:79], v2 offset:38912
  s_waitcnt lgkmcnt(10)
  ds_read_b64_tr_b16 v[80:81], v2 offset:40960
  ds_read_b64_tr_b16 v[82:83], v2 offset:43008
  s_waitcnt lgkmcnt(10)
  ds_read_b64_tr_b16 v[84:85], v2 offset:45056
  ds_read_b64_tr_b16 v[86:87], v2 offset:47104
  s_waitcnt lgkmcnt(10)
  ds_read_b64_tr_b16 v[88:89], v2 offset:49152
  ds_read_b64_tr_b16 v[90:91], v2 offset:51200
  s_waitcnt lgkmcnt(10)
  ds_read_b64_tr_b16 v[92:93], v2 offset:53248
  ds_read_b64_tr_b16 v[94:95], v2 offset:55296
  s_waitcnt lgkmcnt(10)
  ds_read_b64_tr_b16 v[96:97], v2 offset:57344
  ds_read_b64_tr_b16 v[98:99], v2 offset:59392
  s_waitcnt lgkmcnt(10)
  ds_read_b64_tr_b16 v[100:101], v2 offset:61440
  ds_read_b64_tr_b16 v[102:103], v2 offset:63488
  s_waitcnt lgkmcnt(10)
  s_waitcnt lgkmcnt(0)
  v_and_b32 v13, 1, v1
  v_lshlrev_b32 v13, 14, v13
  v_lshrrev_b32 v3, 4, v1
  v_lshl_add_u32 v13, v3, 4, v13
  s_lshl_b32 s49, s5, 6
  s_add_u32 s49, s49, s58
  v_add_u32 v13, s49, v13
  v_and_b32 v14, 1, v1
  v_mul_u32_u24 v14, 1056, v14
  v_lshrrev_b32 v3, 4, v1
  v_lshl_add_u32 v14, v3, 4, v14
  v_add_u32 v14, 1024, v14
  s_mov_b32 s70, 0
  s_branch L_q_c
L_q_p:
  s_mov_b64 exec, s[64:65]
  global_load_dwordx4 v[16:19], v15, s[42:43] sc1
  s_mov_b64 exec, s[66:67]
  global_load_dwordx4 v[32:35], v36, s[42:43] sc1
  s_mov_b64 exec, -1
L_q_c:
  s_waitcnt vmcnt(0)
  v_cmp_ne_u32 s[64:65], s74, v17
  v_cmp_ne_u32 s[68:69], s74, v19
  s_or_b64 s[64:65], s[64:65], s[68:69]
  v_cmp_ne_u32 s[66:67], s74, v33
  v_cmp_ne_u32 s[68:69], s74, v35
  s_or_b64 s[66:67], s[66:67], s[68:69]
  s_or_b64 vcc, s[64:65], s[66:67]
  s_or_b32 s64, s64, 1
  s_or_b32 s66, s66, 1
  s_cmp_eq_u64 vcc, 0
  s_cbranch_scc1 L_q_ok
  s_sleep 2
  s_add_u32 s70, s70, 1
  s_cmp_lt_u32 s70, 262144
  s_cbranch_scc1 L_q_p
L_q_ok:
  v_lshlrev_b32 v28, 16, v32
  v_and_b32 v29, s73, v32
  v_lshlrev_b32 v30, 16, v34
  v_and_b32 v31, s73, v34
  v_lshlrev_b32 v24, 16, v16
  v_and_b32 v25, s73, v16
  v_lshlrev_b32 v26, 16, v18
  v_and_b32 v27, s73, v18
  v_add_f32 v28, 1.0, v28
  v_add_f32 v29, 1.0, v29
  v_add_f32 v30, 1.0, v30
  v_add_f32 v31, 1.0, v31
  v_cvt_pk_bf16_f32 v28, 0, v28
  v_cvt_pk_bf16_f32 v29, 0, v29
  v_cvt_pk_bf16_f32 v30, 0, v30
  v_cvt_pk_bf16_f32 v31, 0, v31
  v_mul_f32 v20, v20, v28
  v_mul_f32 v21, v21, v29
  v_mul_f32 v22, v22, v30
  v_mul_f32 v23, v23, v31
  v_cvt_pk_bf16_f32 v20, 0, v20
  v_cvt_pk_bf16_f32 v21, 0, v21
  v_cvt_pk_bf16_f32 v22, 0, v22
  v_cvt_pk_bf16_f32 v23, 0, v23
  v_add_f32 v20, v20, v24
  v_add_f32 v21, v21, v25
  v_add_f32 v22, v22, v26
  v_add_f32 v23, v23, v27
  v_cvt_pk_bf16_f32 v16, v20, v21
  v_cvt_pk_bf16_f32 v17, v22, v23
  ds_write_b64 v12, v[16:17] offset:1024
  s_add_u32 s77, s77, 4
  v_mov_b32 v9, 1
  s_mov_b64 exec, 1
  ds_add_u32 v38, v9 offset:312
  s_mov_b64 exec, -1
  s_mov_b32 s70, 0
L_hy_32:
  ds_read_b32 v9, v38 offset:312
  s_waitcnt lgkmcnt(0)
  v_cmp_gt_u32 vcc, s77, v9
  s_cmp_eq_u64 vcc, 0
  s_cbranch_scc1 L_hyd_33
  s_add_u32 s70, s70, 1
  s_cmp_lt_u32 s70, 2097152
  s_cbranch_scc1 L_hy_32
L_hyd_33:
  ds_read_b128 v[104:107], v14 offset:0
  ds_read_b128 v[108:111], v14 offset:64
  ds_read_b128 v[112:115], v14 offset:128
  ds_read_b128 v[116:119], v14 offset:192
  ds_read_b128 v[120:123], v14 offset:256
  ds_read_b128 v[124:127], v14 offset:320
  ds_read_b128 v[128:131], v14 offset:384
  ds_read_b128 v[132:135], v14 offset:448
  ds_read_b128 v[136:139], v14 offset:512
  ds_read_b128 v[140:143], v14 offset:576
  ds_read_b128 v[144:147], v14 offset:640
  ds_read_b128 v[148:151], v14 offset:704
  s_waitcnt lgkmcnt(11)
  v_mfma_f32_16x16x32_bf16 v[8:11], v[40:43], v[104:107], 0
  ds_read_b128 v[152:155], v14 offset:768
  s_waitcnt lgkmcnt(11)
  v_mfma_f32_16x16x32_bf16 v[8:11], v[44:47], v[108:111], v[8:11]
  ds_read_b128 v[156:159], v14 offset:832
  s_waitcnt lgkmcnt(11)
  v_mfma_f32_16x16x32_bf16 v[8:11], v[48:51], v[112:115], v[8:11]
  ds_read_b128 v[160:163], v14 offset:896
  s_waitcnt lgkmcnt(11)
  v_mfma_f32_16x16x32_bf16 v[8:11], v[52:55], v[116:119], v[8:11]
  ds_read_b128 v[164:167], v14 offset:960
  s_waitcnt lgkmcnt(11)
  v_mfma_f32_16x16x32_bf16 v[8:11], v[56:59], v[120:123], v[8:11]
  s_waitcnt lgkmcnt(10)
  v_mfma_f32_16x16x32_bf16 v[8:11], v[60:63], v[124:127], v[8:11]
  s_waitcnt lgkmcnt(9)
  v_mfma_f32_16x16x32_bf16 v[8:11], v[64:67], v[128:131], v[8:11]
  s_waitcnt lgkmcnt(8)
  v_mfma_f32_16x16x32_bf16 v[8:11], v[68:71], v[132:135], v[8:11]
  s_waitcnt lgkmcnt(7)
  v_mfma_f32_16x16x32_bf16 v[8:11], v[72:75], v[136:139], v[8:11]
  s_waitcnt lgkmcnt(6)
  v_mfma_f32_16x16x32_bf16 v[8:11], v[76:79], v[140:143], v[8:11]
  s_waitcnt lgkmcnt(5)
  v_mfma_f32_16x16x32_bf16 v[8:11], v[80:83], v[144:147], v[8:11]
  s_waitcnt lgkmcnt(4)
  v_mfma_f32_16x16x32_bf16 v[8:11], v[84:87], v[148:151], v[8:11]
  s_waitcnt lgkmcnt(3)
  v_mfma_f32_16x16x32_bf16 v[8:11], v[88:91], v[152:155], v[8:11]
  s_waitcnt lgkmcnt(2)
  v_mfma_f32_16x16x32_bf16 v[8:11], v[92:95], v[156:159], v[8:11]
  s_waitcnt lgkmcnt(1)
  v_mfma_f32_16x16x32_bf16 v[8:11], v[96:99], v[160:163], v[8:11]
  s_waitcnt lgkmcnt(0)
  v_mfma_f32_16x16x32_bf16 v[8:11], v[100:103], v[164:167], v[8:11]
  s_nop 7
  v_cvt_pk_bf16_f32 v8, v8, v9
  v_cvt_pk_bf16_f32 v10, v10, v11
  v_mov_b32 v9, s74
  v_mov_b32 v11, s74
  v_min_u32 v8, s72, v8
  v_min_u32 v10, s72, v10
  s_mov_b32 exec_lo, 0x00030003
  s_mov_b32 exec_hi, 0x00030003
  global_store_dwordx4 v13, v[8:11], s[42:43] sc1
  s_mov_b64 exec, -1
L_r_wo:
  s_xor_b32 s61, s60, 1
  s_lshl_b32 s48, s8, 19
  s_lshl_b32 s49, s61, 7
  s_add_u32 s48, s48, s49
  s_lshr_b32 s58, s8, 1
  s_lshl_b32 s58, s58, 14
  s_and_b32 s49, s8, 1
  s_lshl_b32 s49, s49, 12
  s_add_u32 s58, s58, s49
  s_lshl_b32 s49, s61, 9
  s_add_u32 s58, s58, s49
  s_add_u32 s58, s58, 262144
  s_mov_b32 s44, s24
  s_mov_b32 s45, s25
  s_mov_b32 s46, 4194304
  s_mov_b32 s47, 0x20000
  v_lshrrev_b32 v2, 3, v1
  v_and_b32 v3, 6, v2
  v_xor_b32 v3, v3, v1
  v_mul_u32_u24 v2, 1024, v2
  v_and_b32 v3, 7, v3
  v_lshl_add_u32 v2, v3, 4, v2
  s_mul_i32 s49, s5, 131072
  s_lshl_b32 s50, s5, 14
  s_add_u32 s49, s49, s48
  s_add_u32 s50, s50, 12288
  s_add_u32 s51, s50, 16384
L_dma_34:
  s_mov_b32 m0, s50
  s_add_u32 s50, s50, 1024
  buffer_load_dwordx4 v2, s[44:47], s49 offen nt lds
  s_add_u32 s49, s49, 8192
  s_waitcnt vmcnt(3)
  s_cmp_lt_u32 s50, s51
  s_cbranch_scc1 L_dma_34
L_dmae_35:
  s_bfe_u32 s32, s74, 0x80000
  s_bfe_u32 s33, s74, 0x80008
  s_bfe_u32 s34, s74, 0x80010
  s_bfe_u32 s35, s74, 0x80018
  s_lshl2_add_u32 s49, s8, s5
  s_lshl_b32 s49, s49, 11
  s_add_u32 s49, s49, 131072
  v_lshrrev_b32 v12, 5, v1
  v_and_b32 v16, 31, v1
  v_lshlrev_b32 v15, 16, v12
  v_lshl_add_u32 v15, v16, 4, v15
  v_add_u32 v15, s49, v15
  v_mul_u32_u24 v12, 1056, v12
  v_bfe_u32 v16, v1, 3, 2
  v_lshl_add_u32 v12, v16, 6, v12
  v_and_b32 v16, 3, v1
  v_lshl_add_u32 v12, v16, 4, v12
  v_bfe_u32 v16, v1, 2, 1
  v_lshl_add_u32 v12, v16, 3, v12
  s_lshl_b32 s49, s5, 8
  v_add_u32 v12, s49, v12
  v_and_b32 v13, 1, v1
  v_lshlrev_b32 v13, 6, v13
  v_lshrrev_b32 v3, 4, v1
  v_lshl_add_u32 v13, v3, 4, v13
  s_lshl_b32 s49, s5, 7
  s_add_u32 s49, s49, s58
  v_add_u32 v13, s49, v13
  v_mov_b32 v36, 0xff
  s_waitcnt vmcnt(0)
  s_add_u32 s77, s77, 4
  v_mov_b32 v9, 1
  s_mov_b64 exec, 1
  ds_add_u32 v38, v9 offset:312
  s_mov_b64 exec, -1
  s_mov_b32 s70, 0
L_hy_36:
  ds_read_b32 v9, v38 offset:312
  s_waitcnt lgkmcnt(0)
  v_cmp_gt_u32 vcc, s77, v9
  s_cmp_eq_u64 vcc, 0
  s_cbranch_scc1 L_hyd_37
  s_sleep 4
  s_add_u32 s70, s70, 1
  s_cmp_lt_u32 s70, 2097152
  s_cbranch_scc1 L_hy_36
L_hyd_37:
  v_lshrrev_b32 v2, 2, v1
  v_bfe_u32 v3, v1, 1, 1
  s_lshl_b32 s49, s5, 1
  v_or_b32 v3, s49, v3
  v_and_b32 v10, 6, v2
  v_xor_b32 v3, v3, v10
  v_lshlrev_b32 v2, 7, v2
  v_lshl_add_u32 v2, v3, 4, v2
  v_and_b32 v3, 1, v1
  v_lshl_add_u32 v2, v3, 3, v2
  v_add_u32 v2, 12288, v2
  ds_read_b64_tr_b16 v[40:41], v2 offset:0
  ds_read_b64_tr_b16 v[42:43], v2 offset:2048
  ds_read_b64_tr_b16 v[44:45], v2 offset:4096
  ds_read_b64_tr_b16 v[46:47], v2 offset:6144
  ds_read_b64_tr_b16 v[48:49], v2 offset:8192
  ds_read_b64_tr_b16 v[50:51], v2 offset:10240
  ds_read_b64_tr_b16 v[52:53], v2 offset:12288
  ds_read_b64_tr_b16 v[54:55], v2 offset:14336
  ds_read_b64_tr_b16 v[56:57], v2 offset:16384
  ds_read_b64_tr_b16 v[58:59], v2 offset:18432
  ds_read_b64_tr_b16 v[60:61], v2 offset:20480
  ds_read_b64_tr_b16 v[62:63], v2 offset:22528
  s_waitcnt lgkmcnt(10)
  ds_read_b64_tr_b16 v[64:65], v2 offset:24576
  ds_read_b64_tr_b16 v[66:67], v2 offset:26624
  s_waitcnt lgkmcnt(10)
  ds_read_b64_tr_b16 v[68:69], v2 offset:28672
  ds_read_b64_tr_b16 v[70:71], v2 offset:30720
  s_waitcnt lgkmcnt(10)
  ds_read_b64_tr_b16 v[72:73], v2 offset:32768
  ds_read_b64_tr_b16 v[74:75], v2 offset:34816
  s_waitcnt lgkmcnt(10)
  ds_read_b64_tr_b16 v[76:77], v2 offset:36864
  ds_read_b64_tr_b16 v[78:79], v2 offset:38912
  s_waitcnt lgkmcnt(10)
  ds_read_b64_tr_b16 v[80:81], v2 offset:40960
  ds_read_b64_tr_b16 v[82:83], v2 offset:43008
  s_waitcnt lgkmcnt(10)
  ds_read_b64_tr_b16 v[84:85], v2 offset:45056
  ds_read_b64_tr_b16 v[86:87], v2 offset:47104
  s_waitcnt lgkmcnt(10)
  ds_read_b64_tr_b16 v[88:89], v2 offset:49152
  ds_read_b64_tr_b16 v[90:91], v2 offset:51200
  s_waitcnt lgkmcnt(10)
  ds_read_b64_tr_b16 v[92:93], v2 offset:53248
  ds_read_b64_tr_b16 v[94:95], v2 offset:55296
  s_waitcnt lgkmcnt(10)
  ds_read_b64_tr_b16 v[96:97], v2 offset:57344
  ds_read_b64_tr_b16 v[98:99], v2 offset:59392
  s_waitcnt lgkmcnt(10)
  ds_read_b64_tr_b16 v[100:101], v2 offset:61440
  ds_read_b64_tr_b16 v[102:103], v2 offset:63488
  s_waitcnt lgkmcnt(10)
  s_waitcnt lgkmcnt(0)
  s_mov_b32 s70, 0
L_pl_38:
  ds_read_b32 v8, v38 offset:256
  s_waitcnt lgkmcnt(0)
  v_cmp_eq_u32 vcc, -1, v8
  s_cmp_eq_u64 vcc, 0
  s_cbranch_scc1 L_pld_39
  s_sleep 8
  s_add_u32 s70, s70, 1
  s_cmp_lt_u32 s70, 1048576
  s_cbranch_scc1 L_pl_38
L_pld_39:
  s_mov_b64 s[20:21], -1
  s_mov_b64 s[22:23], -1
  s_mov_b64 s[24:25], -1
  s_mov_b64 exec, s[20:21]
  global_load_dwordx4 v[152:155], v15, s[42:43] offset:0 sc1
  s_mov_b64 exec, s[22:23]
  global_load_dwordx4 v[156:159], v15, s[42:43] offset:512 sc1
  s_mov_b64 exec, s[24:25]
  global_load_dwordx4 v[160:163], v15, s[42:43] offset:1024 sc1
  s_mov_b64 exec, -1
  s_waitcnt vmcnt(0)
  s_mov_b32 s70, 0
  s_branch L_wo_c
L_wo_:
  s_mov_b64 exec, s[20:21]
  global_load_dwordx4 v[152:155], v15, s[42:43] offset:0 sc1
  s_mov_b64 exec, s[22:23]
  global_load_dwordx4 v[156:159], v15, s[42:43] offset:512 sc1
  s_mov_b64 exec, s[24:25]
  global_load_dwordx4 v[160:163], v15, s[42:43] offset:1024 sc1
  s_mov_b64 exec, -1
  s_waitcnt vmcnt(0)
L_wo_c:
  v_xor_b32 v136, s32, v152
  v_xor_b32 v137, s33, v153
  v_xor_b32 v138, s34, v154
  v_xor_b32 v139, s35, v155
  v_xor_b32 v140, s32, v156
  v_xor_b32 v141, s33, v157
  v_xor_b32 v142, s34, v158
  v_xor_b32 v143, s35, v159
  v_xor_b32 v144, s32, v160
  v_xor_b32 v145, s33, v161
  v_xor_b32 v146, s34, v162
  v_xor_b32 v147, s35, v163
  v_or3_b32 v28, v136, v137, v138
  v_or3_b32 v29, v140, v141, v142
  v_or3_b32 v30, v144, v145, v146
  v_or_b32 v28, v28, v139
  v_or_b32 v29, v29, v143
  v_or_b32 v30, v30, v147
  v_cmp_ne_u32_sdwa s[20:21], v28, v38 src0_sel:BYTE_0 src1_sel:DWORD
  v_cmp_ne_u32_sdwa s[22:23], v29, v38 src0_sel:BYTE_0 src1_sel:DWORD
  v_cmp_ne_u32_sdwa s[24:25], v30, v38 src0_sel:BYTE_0 src1_sel:DWORD
  v_or_b32 v136, 0x80, v136
  v_or_b32 v137, 0x80, v137
  v_or_b32 v138, 0x80, v138
  v_or_b32 v139, 0x80, v139
  v_or_b32 v140, 0x80, v140
  v_or_b32 v141, 0x80, v141
  v_or_b32 v142, 0x80, v142
  v_or_b32 v143, 0x80, v143
  v_or_b32 v144, 0x80, v144
  v_or_b32 v145, 0x80, v145
  v_or_b32 v146, 0x80, v146
  v_or_b32 v147, 0x80, v147
  v_pk_add_f32 v[16:17], v[136:137], v[140:141]
  v_pk_add_f32 v[18:19], v[138:139], v[142:143]
  v_pk_add_f32 v[16:17], v[16:17], v[144:145]
  v_pk_add_f32 v[18:19], v[18:19], v[146:147]
  s_mov_b64 vcc, s[20:21]
  s_or_b64 vcc, vcc, s[22:23]
  s_or_b64 vcc, vcc, s[24:25]
  s_or_b32 s20, s20, 1
  s_or_b32 s22, s22, 1
  s_or_b32 s24, s24, 1
  s_cmp_eq_u64 vcc, 0
  s_cbranch_scc1 L_wo_ok
  s_add_u32 s70, s70, 1
  s_cmp_lt_u32 s70, 262144
  s_cbranch_scc1 L_wo_
L_wo_ok:
  v_cvt_pk_bf16_f32 v8, v16, v17
  v_cvt_pk_bf16_f32 v9, v18, v19
  ds_write_b64 v12, v[8:9] offset:1024
  s_add_u32 s77, s77, 4
  v_mov_b32 v3, 1
  s_mov_b64 exec, 1
  ds_add_u32 v38, v3 offset:312
  s_mov_b64 exec, -1
  s_mov_b32 s70, 0
L_hy_40:
  ds_read_b32 v3, v38 offset:312
  ds_read_b128 v[104:107], v14 offset:0
  ds_read_b128 v[108:111], v14 offset:64
  ds_read_b128 v[112:115], v14 offset:128
  ds_read_b128 v[116:119], v14 offset:192
  s_waitcnt lgkmcnt(4)
  v_cmp_gt_u32 vcc, s77, v3
  s_cmp_eq_u64 vcc, 0
  s_cbranch_scc1 L_hyd_41
  s_waitcnt lgkmcnt(0)
  s_add_u32 s70, s70, 1
  s_cmp_lt_u32 s70, 2097152
  s_cbranch_scc1 L_hy_40
L_hyd_41:
  ds_read_b128 v[120:123], v14 offset:256
  ds_read_b128 v[124:127], v14 offset:320
  ds_read_b128 v[128:131], v14 offset:384
  ds_read_b128 v[132:135], v14 offset:448
  ds_read_b128 v[136:139], v14 offset:512
  ds_read_b128 v[140:143], v14 offset:576
  ds_read_b128 v[144:147], v14 offset:640
  ds_read_b128 v[148:151], v14 offset:704
  s_waitcnt lgkmcnt(11)
  v_mfma_f32_16x16x32_bf16 v[8:11], v[40:43], v[104:107], 0
  s_waitcnt lgkmcnt(10)
  v_mfma_f32_16x16x32_bf16 v[8:11], v[44:47], v[108:111], v[8:11]
  ds_read_b128 v[104:107], v14 offset:768
  s_waitcnt lgkmcnt(10)
  v_mfma_f32_16x16x32_bf16 v[8:11], v[48:51], v[112:115], v[8:11]
  ds_read_b128 v[108:111], v14 offset:832
  s_waitcnt lgkmcnt(10)
  v_mfma_f32_16x16x32_bf16 v[8:11], v[52:55], v[116:119], v[8:11]
  ds_read_b128 v[112:115], v14 offset:896
  s_waitcnt lgkmcnt(10)
  v_mfma_f32_16x16x32_bf16 v[8:11], v[56:59], v[120:123], v[8:11]
  ds_read_b128 v[116:119], v14 offset:960
  s_waitcnt lgkmcnt(10)
  v_mfma_f32_16x16x32_bf16 v[8:11], v[60:63], v[124:127], v[8:11]
  s_waitcnt lgkmcnt(9)
  v_mfma_f32_16x16x32_bf16 v[8:11], v[64:67], v[128:131], v[8:11]
  s_waitcnt lgkmcnt(8)
  v_mfma_f32_16x16x32_bf16 v[8:11], v[68:71], v[132:135], v[8:11]
  s_waitcnt lgkmcnt(7)
  v_mfma_f32_16x16x32_bf16 v[8:11], v[72:75], v[136:139], v[8:11]
  s_waitcnt lgkmcnt(6)
  v_mfma_f32_16x16x32_bf16 v[8:11], v[76:79], v[140:143], v[8:11]
  s_waitcnt lgkmcnt(5)
  v_mfma_f32_16x16x32_bf16 v[8:11], v[80:83], v[144:147], v[8:11]
  s_waitcnt lgkmcnt(4)
  v_mfma_f32_16x16x32_bf16 v[8:11], v[84:87], v[148:151], v[8:11]
  s_waitcnt lgkmcnt(3)
  v_mfma_f32_16x16x32_bf16 v[8:11], v[88:91], v[104:107], v[8:11]
  s_waitcnt lgkmcnt(2)
  v_mfma_f32_16x16x32_bf16 v[8:11], v[92:95], v[108:111], v[8:11]
  s_waitcnt lgkmcnt(1)
  v_mfma_f32_16x16x32_bf16 v[8:11], v[96:99], v[112:115], v[8:11]
  s_waitcnt lgkmcnt(0)
  v_mfma_f32_16x16x32_bf16 v[8:11], v[100:103], v[116:119], v[8:11]
  s_nop 7
  v_bfi_b32 v8, v36, s32, v8
  v_bfi_b32 v9, v36, s33, v9
  v_bfi_b32 v10, v36, s34, v10
  v_bfi_b32 v11, v36, s35, v11
  s_mov_b32 exec_lo, 0x00030003
  s_mov_b32 exec_hi, 0x00030003
  global_store_dwordx4 v13, v[8:11], s[42:43] sc1
  v_mov_b32 v3, 1
  s_mov_b64 exec, 1
  ds_add_u32 v38, v3 offset:264
  s_mov_b64 exec, -1
  s_branch L_fin
L_r_mod:
  global_load_dwordx2 v[14:15], v37, s[34:35]
  s_mov_b32 s44, s36
  s_mov_b32 s45, s37
  s_mov_b32 s46, 3145728
  s_mov_b32 s47, 0x20000
  s_cmp_ge_u32 s60, 2
  s_cbranch_scc1 L_mod2
  s_lshl1_add_u32 s61, s8, s60
  s_lshl_b32 s48, s61, 7
  s_lshl_b32 s58, s61, 9
  s_add_u32 s58, s58, 917504
  v_lshrrev_b32 v2, 3, v1
  v_and_b32 v3, 6, v2
  v_xor_b32 v3, v3, v1
  v_mul_u32_u24 v2, 6144, v2
  v_and_b32 v3, 7, v3
  v_lshl_add_u32 v2, v3, 4, v2
  s_mul_i32 s49, s5, 786432
  s_lshl_b32 s50, s5, 14
  s_add_u32 s49, s49, s48
  s_add_u32 s50, s50, 77824
  s_add_u32 s51, s50, 16384
L_dma_42:
  s_mov_b32 m0, s50
  s_add_u32 s50, s50, 1024
  buffer_load_dwordx4 v2, s[44:47], s49 offen nt lds
  s_add_u32 s49, s49, 49152
  s_cmp_lt_u32 s50, s51
  s_cbranch_scc1 L_dma_42
L_dmae_43:
  v_mov_b32 v3, 1
  s_mov_b64 exec, 1
  ds_add_u32 v38, v3 offset:268
  s_mov_b64 exec, -1
  s_getpc_b64 s[56:57]
L_pc_44:
  s_lshr_b32 s3, s2, 5
  s_lshl3_add_u32 s3, s3, s8
  s_lshl_b32 s3, s3, 2
  s_add_u32 s3, s3, L_table-L_pc_44
  s_load_dword s14, s[56:57], s3
  s_waitcnt lgkmcnt(0)
  s_mul_i32 s74, s74, 0x9e3779b1
  s_add_u32 s74, s74, 0x7f4a7c15
  s_waitcnt vmcnt(16)
  v_lshlrev_b32 v16, 16, v14
  v_and_b32 v17, s73, v14
  v_lshlrev_b32 v18, 16, v15
  v_and_b32 v19, s73, v15
  v_mul_f32 v20, 0xbfb8aa3b, v16
  v_mul_f32 v21, 0xbfb8aa3b, v17
  v_mul_f32 v22, 0xbfb8aa3b, v18
  v_mul_f32 v23, 0xbfb8aa3b, v19
  v_exp_f32 v20, v20
  v_exp_f32 v21, v21
  v_exp_f32 v22, v22
  v_exp_f32 v23, v23
  s_nop 0
  v_add_f32 v20, 1.0, v20
  v_add_f32 v21, 1.0, v21
  v_add_f32 v22, 1.0, v22
  v_add_f32 v23, 1.0, v23
  v_rcp_f32 v20, v20
  v_rcp_f32 v21, v21
  v_rcp_f32 v22, v22
  v_rcp_f32 v23, v23
  s_nop 0
  v_mul_f32 v16, v16, v20
  v_mul_f32 v17, v17, v21
  v_mul_f32 v18, v18, v22
  v_mul_f32 v19, v19, v23
  v_cvt_pk_bf16_f32 v14, v16, v17
  v_cvt_pk_bf16_f32 v15, v18, v19
  ds_write_b64 v12, v[14:15] offset:3200
  v_and_b32 v13, 1, v1
  v_lshlrev_b32 v13, 6, v13
  v_lshrrev_b32 v3, 4, v1
  v_lshl_add_u32 v13, v3, 4, v13
  s_lshl_b32 s49, s5, 7
  s_add_u32 s49, s49, s58
  v_add_u32 v13, s49, v13
  v_bfe_u32 v3, v1, 1, 3
  v_lshl_add_u32 v13, v3, 13, v13
  v_and_b32 v14, 1, v1
  v_mul_u32_u24 v14, 1056, v14
  v_lshrrev_b32 v3, 4, v1
  v_lshl_add_u32 v14, v3, 4, v14
  v_add_u32 v14, 3200, v14
  v_lshrrev_b32 v2, 2, v1
  v_bfe_u32 v3, v1, 1, 1
  s_lshl_b32 s49, s5, 1
  v_or_b32 v3, s49, v3
  v_and_b32 v10, 6, v2
  v_xor_b32 v3, v3, v10
  v_lshlrev_b32 v2, 7, v2
  v_lshl_add_u32 v2, v3, 4, v2
  v_and_b32 v3, 1, v1
  v_lshl_add_u32 v2, v3, 3, v2
  v_add_u32 v2, 77824, v2
  s_waitcnt vmcnt(0) lgkmcnt(0)
  s_add_u32 s77, s77, 4
  v_mov_b32 v9, 1
  s_mov_b64 exec, 1
  ds_add_u32 v38, v9 offset:316
  s_mov_b64 exec, -1
  s_mov_b32 s70, 0
L_hy_45:
  ds_read_b32 v9, v38 offset:316
  s_waitcnt lgkmcnt(0)
  v_cmp_gt_u32 vcc, s77, v9
  s_cmp_eq_u64 vcc, 0
  s_cbranch_scc1 L_hyd_46
  s_add_u32 s70, s70, 1
  s_cmp_lt_u32 s70, 2097152
  s_cbranch_scc1 L_hy_45
L_hyd_46:
  ds_read_b64_tr_b16 v[40:41], v2 offset:0
  ds_read_b64_tr_b16 v[42:43], v2 offset:2048
  ds_read_b128 v[104:107], v14 offset:0
  ds_read_b64_tr_b16 v[44:45], v2 offset:4096
  ds_read_b64_tr_b16 v[46:47], v2 offset:6144
  ds_read_b128 v[108:111], v14 offset:64
  ds_read_b64_tr_b16 v[48:49], v2 offset:8192
  ds_read_b64_tr_b16 v[50:51], v2 offset:10240
  ds_read_b128 v[112:115], v14 offset:128
  ds_read_b64_tr_b16 v[52:53], v2 offset:12288
  ds_read_b64_tr_b16 v[54:55], v2 offset:14336
  ds_read_b128 v[116:119], v14 offset:192
  ds_read_b64_tr_b16 v[56:57], v2 offset:16384
  ds_read_b64_tr_b16 v[58:59], v2 offset:18432
  ds_read_b128 v[120:123], v14 offset:256
  s_waitcnt lgkmcnt(12)
  v_mfma_f32_16x16x32_bf16 v[8:11], v[40:43], v[104:107], 0
  ds_read_b64_tr_b16 v[60:61], v2 offset:20480
  ds_read_b64_tr_b16 v[62:63], v2 offset:22528
  ds_read_b128 v[124:127], v14 offset:320
  s_waitcnt lgkmcnt(12)
  v_mfma_f32_16x16x32_bf16 v[8:11], v[44:47], v[108:111], v[8:11]
  ds_read_b64_tr_b16 v[64:65], v2 offset:24576
  ds_read_b64_tr_b16 v[66:67], v2 offset:26624
  ds_read_b128 v[128:131], v14 offset:384
  s_waitcnt lgkmcnt(12)
  v_mfma_f32_16x16x32_bf16 v[8:11], v[48:51], v[112:115], v[8:11]
  ds_read_b64_tr_b16 v[68:69], v2 offset:28672
  ds_read_b64_tr_b16 v[70:71], v2 offset:30720
  ds_read_b128 v[132:135], v14 offset:448
  s_waitcnt lgkmcnt(12)
  v_mfma_f32_16x16x32_bf16 v[8:11], v[52:55], v[116:119], v[8:11]
  ds_read_b64_tr_b16 v[72:73], v2 offset:32768
  ds_read_b64_tr_b16 v[74:75], v2 offset:34816
  ds_read_b128 v[136:139], v14 offset:512
  s_waitcnt lgkmcnt(12)
  v_mfma_f32_16x16x32_bf16 v[8:11], v[56:59], v[120:123], v[8:11]
  ds_read_b64_tr_b16 v[76:77], v2 offset:36864
  ds_read_b64_tr_b16 v[78:79], v2 offset:38912
  ds_read_b128 v[140:143], v14 offset:576
  s_waitcnt lgkmcnt(12)
  v_mfma_f32_16x16x32_bf16 v[8:11], v[60:63], v[124:127], v[8:11]
  ds_read_b64_tr_b16 v[80:81], v2 offset:40960
  ds_read_b64_tr_b16 v[82:83], v2 offset:43008
  ds_read_b128 v[144:147], v14 offset:640
  s_waitcnt lgkmcnt(12)
  v_mfma_f32_16x16x32_bf16 v[8:11], v[64:67], v[128:131], v[8:11]
  ds_read_b64_tr_b16 v[84:85], v2 offset:45056
  ds_read_b64_tr_b16 v[86:87], v2 offset:47104
  ds_read_b128 v[148:151], v14 offset:704
  s_waitcnt lgkmcnt(12)
  v_mfma_f32_16x16x32_bf16 v[8:11], v[68:71], v[132:135], v[8:11]
  ds_read_b64_tr_b16 v[88:89], v2 offset:49152
  ds_read_b64_tr_b16 v[90:91], v2 offset:51200
  ds_read_b128 v[152:155], v14 offset:768
  s_waitcnt lgkmcnt(12)
  v_mfma_f32_16x16x32_bf16 v[8:11], v[72:75], v[136:139], v[8:11]
  ds_read_b64_tr_b16 v[92:93], v2 offset:53248
  ds_read_b64_tr_b16 v[94:95], v2 offset:55296
  ds_read_b128 v[156:159], v14 offset:832
  s_waitcnt lgkmcnt(12)
  v_mfma_f32_16x16x32_bf16 v[8:11], v[76:79], v[140:143], v[8:11]
  ds_read_b64_tr_b16 v[96:97], v2 offset:57344
  ds_read_b64_tr_b16 v[98:99], v2 offset:59392
  ds_read_b128 v[160:163], v14 offset:896
  s_waitcnt lgkmcnt(12)
  v_mfma_f32_16x16x32_bf16 v[8:11], v[80:83], v[144:147], v[8:11]
  ds_read_b64_tr_b16 v[100:101], v2 offset:61440
  ds_read_b64_tr_b16 v[102:103], v2 offset:63488
  ds_read_b128 v[164:167], v14 offset:960
  s_waitcnt lgkmcnt(12)
  v_mfma_f32_16x16x32_bf16 v[8:11], v[84:87], v[148:151], v[8:11]
  s_waitcnt lgkmcnt(9)
  v_mfma_f32_16x16x32_bf16 v[8:11], v[88:91], v[152:155], v[8:11]
  s_waitcnt lgkmcnt(6)
  v_mfma_f32_16x16x32_bf16 v[8:11], v[92:95], v[156:159], v[8:11]
  s_waitcnt lgkmcnt(3)
  v_mfma_f32_16x16x32_bf16 v[8:11], v[96:99], v[160:163], v[8:11]
  s_waitcnt lgkmcnt(0)
  v_mfma_f32_16x16x32_bf16 v[8:11], v[100:103], v[164:167], v[8:11]
  s_nop 7
  v_cvt_pk_bf16_f32 v8, v8, v9
  v_cvt_pk_bf16_f32 v10, v10, v11
  v_mov_b32 v9, s74
  v_mov_b32 v11, s74
  global_store_dwordx4 v13, v[8:11], s[42:43] sc1
  s_mov_b64 exec, -1
  s_add_u32 s77, s77, 4
  v_mov_b32 v9, 1
  s_mov_b64 exec, 1
  ds_add_u32 v38, v9 offset:316
  s_mov_b64 exec, -1
  s_mov_b32 s70, 0
L_hy_47:
  ds_read_b32 v9, v38 offset:316
  s_waitcnt lgkmcnt(0)
  v_cmp_gt_u32 vcc, s77, v9
  s_cmp_eq_u64 vcc, 0
  s_cbranch_scc1 L_hyd_48
  s_add_u32 s70, s70, 1
  s_cmp_lt_u32 s70, 2097152
  s_cbranch_scc1 L_hy_47
L_hyd_48:
  s_branch L_mod3
L_mod2:
  s_getpc_b64 s[56:57]
L_pc_49:
  s_lshr_b32 s3, s2, 5
  s_lshl3_add_u32 s3, s3, s8
  s_lshl_b32 s3, s3, 2
  s_add_u32 s3, s3, L_table-L_pc_49
  s_load_dword s14, s[56:57], s3
  s_waitcnt lgkmcnt(0)
  s_mul_i32 s74, s74, 0x9e3779b1
  s_add_u32 s74, s74, 0x7f4a7c15
  s_waitcnt vmcnt(0)
  v_lshlrev_b32 v16, 16, v14
  v_and_b32 v17, s73, v14
  v_lshlrev_b32 v18, 16, v15
  v_and_b32 v19, s73, v15
  v_mul_f32 v20, 0xbfb8aa3b, v16
  v_mul_f32 v21, 0xbfb8aa3b, v17
  v_mul_f32 v22, 0xbfb8aa3b, v18
  v_mul_f32 v23, 0xbfb8aa3b, v19
  v_exp_f32 v20, v20
  v_exp_f32 v21, v21
  v_exp_f32 v22, v22
  v_exp_f32 v23, v23
  s_nop 0
  v_add_f32 v20, 1.0, v20
  v_add_f32 v21, 1.0, v21
  v_add_f32 v22, 1.0, v22
  v_add_f32 v23, 1.0, v23
  v_rcp_f32 v20, v20
  v_rcp_f32 v21, v21
  v_rcp_f32 v22, v22
  v_rcp_f32 v23, v23
  s_nop 0
  v_mul_f32 v16, v16, v20
  v_mul_f32 v17, v17, v21
  v_mul_f32 v18, v18, v22
  v_mul_f32 v19, v19, v23
  v_cvt_pk_bf16_f32 v14, v16, v17
  v_cvt_pk_bf16_f32 v15, v18, v19
  ds_write_b64 v12, v[14:15] offset:3200
L_mod3:
  s_mov_b32 s70, 0
L_sn_50:
  ds_read_b32 v8, v38 offset:264
  s_waitcnt lgkmcnt(0)
  v_cmp_gt_u32 vcc, 0x4, v8
  s_cmp_eq_u64 vcc, 0
  s_cbranch_scc1 L_snd_51
  s_sleep 4
  s_add_u32 s70, s70, 1
  s_cmp_lt_u32 s70, 2097152
  s_cbranch_scc1 L_sn_50
L_snd_51:
  s_and_b32 s61, s14, 0xff
  s_cmp_ge_u32 s61, 48
  s_cbranch_scc1 L_r_f1
  s_mov_b32 s70, 0
L_sn_52:
  ds_read_b32 v8, v38 offset:312
  s_waitcnt lgkmcnt(0)
  v_cmp_gt_u32 vcc, 0x8, v8
  s_cmp_eq_u64 vcc, 0
  s_cbranch_scc1 L_snd_53
  s_sleep 4
  s_add_u32 s70, s70, 1
  s_cmp_lt_u32 s70, 2097152
  s_cbranch_scc1 L_sn_52
L_snd_53:
  s_and_b32 s61, s14, 0xff
L_mod4:
  s_cmp_ge_u32 s61, 48
  s_cbranch_scc1 L_r_f1
  s_lshl_b32 s48, s61, 7
  s_lshl_b32 s58, s61, 9
  s_add_u32 s58, s58, 4096
  v_lshrrev_b32 v2, 3, v1
  v_and_b32 v3, 6, v2
  v_xor_b32 v3, v3, v1
  v_mul_u32_u24 v2, 6144, v2
  v_and_b32 v3, 7, v3
  v_lshl_add_u32 v2, v3, 4, v2
  s_mul_i32 s49, s5, 786432
  s_lshl_b32 s50, s5, 14
  s_add_u32 s49, s49, s48
  s_add_u32 s50, s50, 77824
  s_add_u32 s51, s50, 16384
L_dma_54:
  s_mov_b32 m0, s50
  s_add_u32 s50, s50, 1024
  buffer_load_dwordx4 v2, s[44:47], s49 offen nt lds
  s_add_u32 s49, s49, 49152
  s_waitcnt vmcnt(5)
  s_cmp_lt_u32 s50, s51
  s_cbranch_scc1 L_dma_54
L_dmae_55:
  v_and_b32 v13, 1, v1
  v_lshlrev_b32 v13, 6, v13
  v_lshrrev_b32 v3, 4, v1
  v_lshl_add_u32 v13, v3, 4, v13
  s_lshl_b32 s49, s5, 7
  s_add_u32 s49, s49, s58
  v_add_u32 v13, s49, v13
  v_and_b32 v14, 1, v1
  v_mul_u32_u24 v14, 1056, v14
  v_lshrrev_b32 v3, 4, v1
  v_lshl_add_u32 v14, v3, 4, v14
  v_add_u32 v14, 3200, v14
  v_lshrrev_b32 v2, 2, v1
  v_bfe_u32 v3, v1, 1, 1
  s_lshl_b32 s49, s5, 1
  v_or_b32 v3, s49, v3
  v_and_b32 v10, 6, v2
  v_xor_b32 v3, v3, v10
  v_lshlrev_b32 v2, 7, v2
  v_lshl_add_u32 v2, v3, 4, v2
  v_and_b32 v3, 1, v1
  v_lshl_add_u32 v2, v3, 3, v2
  v_add_u32 v2, 77824, v2
  s_waitcnt vmcnt(0) lgkmcnt(0)
  s_add_u32 s77, s77, 4
  v_mov_b32 v9, 1
  s_mov_b64 exec, 1
  ds_add_u32 v38, v9 offset:316
  s_mov_b64 exec, -1
  s_mov_b32 s70, 0
L_hy_56:
  ds_read_b32 v9, v38 offset:316
  s_waitcnt lgkmcnt(0)
  v_cmp_gt_u32 vcc, s77, v9
  s_cmp_eq_u64 vcc, 0
  s_cbranch_scc1 L_hyd_57
  s_sleep 4
  s_add_u32 s70, s70, 1
  s_cmp_lt_u32 s70, 2097152
  s_cbranch_scc1 L_hy_56
L_hyd_57:
  ds_read_b64_tr_b16 v[40:41], v2 offset:0
  ds_read_b64_tr_b16 v[42:43], v2 offset:2048
  ds_read_b128 v[104:107], v14 offset:0
  ds_read_b64_tr_b16 v[44:45], v2 offset:4096
  ds_read_b64_tr_b16 v[46:47], v2 offset:6144
  ds_read_b128 v[108:111], v14 offset:64
  ds_read_b64_tr_b16 v[48:49], v2 offset:8192
  ds_read_b64_tr_b16 v[50:51], v2 offset:10240
  ds_read_b128 v[112:115], v14 offset:128
  ds_read_b64_tr_b16 v[52:53], v2 offset:12288
  ds_read_b64_tr_b16 v[54:55], v2 offset:14336
  ds_read_b128 v[116:119], v14 offset:192
  ds_read_b64_tr_b16 v[56:57], v2 offset:16384
  ds_read_b64_tr_b16 v[58:59], v2 offset:18432
  ds_read_b128 v[120:123], v14 offset:256
  s_waitcnt lgkmcnt(12)
  v_mfma_f32_16x16x32_bf16 v[8:11], v[40:43], v[104:107], 0
  ds_read_b64_tr_b16 v[60:61], v2 offset:20480
  ds_read_b64_tr_b16 v[62:63], v2 offset:22528
  ds_read_b128 v[124:127], v14 offset:320
  s_waitcnt lgkmcnt(12)
  v_mfma_f32_16x16x32_bf16 v[8:11], v[44:47], v[108:111], v[8:11]
  ds_read_b64_tr_b16 v[64:65], v2 offset:24576
  ds_read_b64_tr_b16 v[66:67], v2 offset:26624
  ds_read_b128 v[128:131], v14 offset:384
  s_waitcnt lgkmcnt(12)
  v_mfma_f32_16x16x32_bf16 v[8:11], v[48:51], v[112:115], v[8:11]
  ds_read_b64_tr_b16 v[68:69], v2 offset:28672
  ds_read_b64_tr_b16 v[70:71], v2 offset:30720
  ds_read_b128 v[132:135], v14 offset:448
  s_waitcnt lgkmcnt(12)
  v_mfma_f32_16x16x32_bf16 v[8:11], v[52:55], v[116:119], v[8:11]
  ds_read_b64_tr_b16 v[72:73], v2 offset:32768
  ds_read_b64_tr_b16 v[74:75], v2 offset:34816
  ds_read_b128 v[136:139], v14 offset:512
  s_waitcnt lgkmcnt(12)
  v_mfma_f32_16x16x32_bf16 v[8:11], v[56:59], v[120:123], v[8:11]
  ds_read_b64_tr_b16 v[76:77], v2 offset:36864
  ds_read_b64_tr_b16 v[78:79], v2 offset:38912
  ds_read_b128 v[140:143], v14 offset:576
  s_waitcnt lgkmcnt(12)
  v_mfma_f32_16x16x32_bf16 v[8:11], v[60:63], v[124:127], v[8:11]
  ds_read_b64_tr_b16 v[80:81], v2 offset:40960
  ds_read_b64_tr_b16 v[82:83], v2 offset:43008
  ds_read_b128 v[144:147], v14 offset:640
  s_waitcnt lgkmcnt(12)
  v_mfma_f32_16x16x32_bf16 v[8:11], v[64:67], v[128:131], v[8:11]
  ds_read_b64_tr_b16 v[84:85], v2 offset:45056
  ds_read_b64_tr_b16 v[86:87], v2 offset:47104
  ds_read_b128 v[148:151], v14 offset:704
  s_waitcnt lgkmcnt(12)
  v_mfma_f32_16x16x32_bf16 v[8:11], v[68:71], v[132:135], v[8:11]
  ds_read_b64_tr_b16 v[88:89], v2 offset:49152
  ds_read_b64_tr_b16 v[90:91], v2 offset:51200
  ds_read_b128 v[152:155], v14 offset:768
  s_waitcnt lgkmcnt(12)
  v_mfma_f32_16x16x32_bf16 v[8:11], v[72:75], v[136:139], v[8:11]
  ds_read_b64_tr_b16 v[92:93], v2 offset:53248
  ds_read_b64_tr_b16 v[94:95], v2 offset:55296
  ds_read_b128 v[156:159], v14 offset:832
  s_waitcnt lgkmcnt(12)
  v_mfma_f32_16x16x32_bf16 v[8:11], v[76:79], v[140:143], v[8:11]
  ds_read_b64_tr_b16 v[96:97], v2 offset:57344
  ds_read_b64_tr_b16 v[98:99], v2 offset:59392
  ds_read_b128 v[160:163], v14 offset:896
  s_waitcnt lgkmcnt(12)
  v_mfma_f32_16x16x32_bf16 v[8:11], v[80:83], v[144:147], v[8:11]
  ds_read_b64_tr_b16 v[100:101], v2 offset:61440
  ds_read_b64_tr_b16 v[102:103], v2 offset:63488
  ds_read_b128 v[164:167], v14 offset:960
  s_waitcnt lgkmcnt(12)
  v_mfma_f32_16x16x32_bf16 v[8:11], v[84:87], v[148:151], v[8:11]
  s_waitcnt lgkmcnt(9)
  v_mfma_f32_16x16x32_bf16 v[8:11], v[88:91], v[152:155], v[8:11]
  s_waitcnt lgkmcnt(6)
  v_mfma_f32_16x16x32_bf16 v[8:11], v[92:95], v[156:159], v[8:11]
  s_waitcnt lgkmcnt(3)
  v_mfma_f32_16x16x32_bf16 v[8:11], v[96:99], v[160:163], v[8:11]
  s_waitcnt lgkmcnt(0)
  v_mfma_f32_16x16x32_bf16 v[8:11], v[100:103], v[164:167], v[8:11]
  s_nop 7
  v_cvt_pk_bf16_f32 v8, v8, v9
  v_cvt_pk_bf16_f32 v10, v10, v11
  v_mov_b32 v9, s74
  v_mov_b32 v11, s74
  s_mov_b32 exec_lo, 0x00030003
  s_mov_b32 exec_hi, 0x00030003
  global_store_dwordx4 v13, v[8:11], s[42:43] sc1
  s_mov_b64 exec, -1
  s_add_u32 s77, s77, 4
  v_mov_b32 v9, 1
  s_mov_b64 exec, 1
  ds_add_u32 v38, v9 offset:316
  s_mov_b64 exec, -1
  s_mov_b32 s70, 0
L_hy_58:
  ds_read_b32 v9, v38 offset:316
  s_waitcnt lgkmcnt(0)
  v_cmp_gt_u32 vcc, s77, v9
  s_cmp_eq_u64 vcc, 0
  s_cbranch_scc1 L_hyd_59
  s_add_u32 s70, s70, 1
  s_cmp_lt_u32 s70, 2097152
  s_cbranch_scc1 L_hy_58
L_hyd_59:
  s_lshr_b32 s61, s14, 24
  s_or_b32 s14, s14, 0xff000000
  s_branch L_mod4
L_r_f1:
  s_bfe_u32 s61, s14, 0x80008
  s_cmp_ge_u32 s61, 43
  s_cbranch_scc1 L_fin
  s_lshl_b32 s48, s61, 6
  s_lshl_b32 s58, s61, 7
  s_add_u32 s58, s58, 1572864
  s_cmp_lt_u32 s5, 2
  s_cselect_b32 s44, s28, s30
  s_cselect_b32 s45, s29, s31
  s_mov_b32 s46, 1409024
  s_and_b32 s54, s61, 1
  v_lshrrev_b32 v2, 2, v1
  v_mul_u32_u24 v2, 5504, v2
  s_and_b32 s49, s5, 2
  s_or_b32 s49, s49, s54
  v_xor_b32 v3, s49, v1
  v_and_b32 v3, 3, v3
  v_lshl_add_u32 v2, v3, 4, v2
  s_and_b32 s55, s5, 1
  s_mul_i32 s49, s55, 704512
  s_add_u32 s49, s49, s48
  s_mul_i32 s50, s54, 2752
  s_add_u32 s49, s49, s50
  s_lshr_b32 s50, s5, 1
  s_lshl_b32 s50, s50, 15
  s_lshl_b32 s54, s54, 14
  s_add_u32 s50, s50, s54
  s_lshl_b32 s55, s55, 13
  s_add_u32 s50, s50, s55
  s_add_u32 s50, s50, 77824
  s_mov_b32 s70, 0
L_sn_60:
  ds_read_b32 v8, v38 offset:312
  s_waitcnt lgkmcnt(0)
  v_cmp_gt_u32 vcc, 0x8, v8
  s_cmp_eq_u64 vcc, 0
  s_cbranch_scc1 L_snd_61
  s_sleep 4
  s_add_u32 s70, s70, 1
  s_cmp_lt_u32 s70, 2097152
  s_cbranch_scc1 L_sn_60
L_snd_61:
  s_add_u32 s51, s50, 8192
L_dma_62:
  s_mov_b32 m0, s50
  s_add_u32 s50, s50, 1024
  buffer_load_dwordx4 v2, s[44:47], s49 offen  lds
  s_add_u32 s49, s49, 88064
  s_waitcnt vmcnt(2)
  s_cmp_lt_u32 s50, s51
  s_cbranch_scc1 L_dma_62
L_dmae_63:
  s_andn2_b32 s54, 1, s61
  v_lshrrev_b32 v2, 2, v1
  v_mul_u32_u24 v2, 5504, v2
  s_and_b32 s49, s5, 2
  s_or_b32 s49, s49, s54
  v_xor_b32 v3, s49, v1
  v_and_b32 v3, 3, v3
  v_lshl_add_u32 v2, v3, 4, v2
  s_and_b32 s55, s5, 1
  s_mul_i32 s49, s55, 704512
  s_add_u32 s49, s49, s48
  s_mul_i32 s50, s54, 2752
  s_add_u32 s49, s49, s50
  s_lshr_b32 s50, s5, 1
  s_lshl_b32 s50, s50, 15
  s_lshl_b32 s54, s54, 14
  s_add_u32 s50, s50, s54
  s_lshl_b32 s55, s55, 13
  s_add_u32 s50, s50, s55
  s_add_u32 s50, s50, 77824
  s_add_u32 s51, s50, 8192
L_dma_64:
  s_mov_b32 m0, s50
  s_add_u32 s50, s50, 1024
  buffer_load_dwordx4 v2, s[44:47], s49 offen nt lds
  s_add_u32 s49, s49, 88064
  s_waitcnt vmcnt(2)
  s_cmp_lt_u32 s50, s51
  s_cbranch_scc1 L_dma_64
L_dmae_65:
  v_lshlrev_b32 v15, 4, v0
  v_add_u32 v39, 16384, v15
  v_add_u32 v15, 266240, v15
  v_lshrrev_b32 v5, 2, v0
  v_lshlrev_b32 v5, 3, v5
  v_add_u32 v5, 9536, v5
  v_lshlrev_b32 v7, 3, v1
  v_add_u32 v7, 9536, v7
  v_and_b32 v14, 7, v1
  v_mul_u32_u24 v14, 1056, v14
  v_lshrrev_b32 v3, 4, v1
  v_lshl_add_u32 v14, v3, 4, v14
  v_bfe_u32 v6, v1, 2, 2
  v_lshl_add_u32 v6, v3, 3, v6
  v_mul_u32_u24 v6, 1056, v6
  v_and_b32 v8, 3, v1
  v_lshl_add_u32 v6, v8, 3, v6
  s_lshl_b32 s49, s5, 8
  s_add_u32 s49, s49, 77824
  v_add_u32 v6, s49, v6
  v_lshlrev_b32 v10, 3, v0
  v_add_u32 v10, 10048, v10
  v_mov_b32 v8, 0
  v_mov_b32 v9, 0
  ds_write_b64 v10, v[8:9]
  v_and_b32 v13, 1, v1
  v_lshlrev_b32 v13, 6, v13
  v_lshrrev_b32 v3, 4, v1
  v_lshl_add_u32 v13, v3, 4, v13
  s_lshl_b32 s49, s5, 17
  s_add_u32 s49, s49, s58
  v_add_u32 v13, s49, v13
  v_bfe_u32 v3, v1, 1, 3
  v_lshl_add_u32 v13, v3, 14, v13
  v_lshrrev_b32 v2, 3, v1
  v_lshlrev_b32 v2, 6, v2
  v_bfe_u32 v3, v1, 2, 1
  v_lshl_add_u32 v2, v3, 14, v2
  v_and_b32 v8, 2, v1
  v_or_b32 v3, v3, v8
  v_xor_b32 v3, s5, v3
  v_lshl_add_u32 v2, v3, 4, v2
  v_lshl_add_u32 v2, v8, 14, v2
  v_and_b32 v3, 1, v1
  v_lshl_add_u32 v2, v3, 3, v2
  v_add_u32 v2, 77824, v2
  s_waitcnt vmcnt(0)
  s_add_u32 s77, s77, 4
  v_mov_b32 v9, 1
  s_mov_b64 exec, 1
  ds_add_u32 v38, v9 offset:316
  s_mov_b64 exec, -1
  s_mov_b32 s70, 0
L_hy_66:
  ds_read_b32 v9, v38 offset:316
  s_waitcnt lgkmcnt(0)
  v_cmp_gt_u32 vcc, s77, v9
  s_cmp_eq_u64 vcc, 0
  s_cbranch_scc1 L_hyd_67
  s_sleep 4
  s_add_u32 s70, s70, 1
  s_cmp_lt_u32 s70, 2097152
  s_cbranch_scc1 L_hy_66
L_hyd_67:
  ds_read_b64_tr_b16 v[40:41], v2 offset:0
  ds_read_b64_tr_b16 v[42:43], v2 offset:512
  ds_read_b64_tr_b16 v[44:45], v2 offset:1024
  ds_read_b64_tr_b16 v[46:47], v2 offset:1536
  ds_read_b64_tr_b16 v[48:49], v2 offset:2048
  ds_read_b64_tr_b16 v[50:51], v2 offset:2560
  ds_read_b64_tr_b16 v[52:53], v2 offset:3072
  ds_read_b64_tr_b16 v[54:55], v2 offset:3584
  ds_read_b64_tr_b16 v[56:57], v2 offset:4096
  ds_read_b64_tr_b16 v[58:59], v2 offset:4608
  ds_read_b64_tr_b16 v[60:61], v2 offset:5120
  ds_read_b64_tr_b16 v[62:63], v2 offset:5632
  s_waitcnt lgkmcnt(10)
  ds_read_b64_tr_b16 v[64:65], v2 offset:6144
  ds_read_b64_tr_b16 v[66:67], v2 offset:6656
  s_waitcnt lgkmcnt(10)
  ds_read_b64_tr_b16 v[68:69], v2 offset:7168
  ds_read_b64_tr_b16 v[70:71], v2 offset:7680
  s_waitcnt lgkmcnt(10)
  ds_read_b64_tr_b16 v[72:73], v2 offset:8192
  ds_read_b64_tr_b16 v[74:75], v2 offset:8704
  s_waitcnt lgkmcnt(10)
  ds_read_b64_tr_b16 v[76:77], v2 offset:9216
  ds_read_b64_tr_b16 v[78:79], v2 offset:9728
  s_waitcnt lgkmcnt(10)
  ds_read_b64_tr_b16 v[80:81], v2 offset:10240
  ds_read_b64_tr_b16 v[82:83], v2 offset:10752
  s_waitcnt lgkmcnt(10)
  ds_read_b64_tr_b16 v[84:85], v2 offset:11264
  ds_read_b64_tr_b16 v[86:87], v2 offset:11776
  s_waitcnt lgkmcnt(10)
  ds_read_b64_tr_b16 v[88:89], v2 offset:12288
  ds_read_b64_tr_b16 v[90:91], v2 offset:12800
  s_waitcnt lgkmcnt(10)
  ds_read_b64_tr_b16 v[92:93], v2 offset:13312
  ds_read_b64_tr_b16 v[94:95], v2 offset:13824
  s_waitcnt lgkmcnt(10)
  ds_read_b64_tr_b16 v[96:97], v2 offset:14336
  ds_read_b64_tr_b16 v[98:99], v2 offset:14848
  s_waitcnt lgkmcnt(10)
  ds_read_b64_tr_b16 v[100:101], v2 offset:15360
  ds_read_b64_tr_b16 v[102:103], v2 offset:15872
  s_waitcnt lgkmcnt(10)
  s_waitcnt lgkmcnt(0)
  s_add_u32 s77, s77, 4
  v_mov_b32 v9, 1
  s_mov_b64 exec, 1
  ds_add_u32 v38, v9 offset:316
  s_mov_b64 exec, -1
  s_mov_b32 s70, 0
L_hy_68:
  ds_read_b32 v9, v38 offset:316
  s_waitcnt lgkmcnt(0)
  v_cmp_gt_u32 vcc, s77, v9
  s_cmp_eq_u64 vcc, 0
  s_cbranch_scc1 L_hyd_69
  s_add_u32 s70, s70, 1
  s_cmp_lt_u32 s70, 2097152
  s_cbranch_scc1 L_hy_68
L_hyd_69:
  s_mov_b32 s44, s32
  s_mov_b32 s45, s33
  s_mov_b32 s46, 1409024
  s_mov_b32 s47, 0x20000
  v_lshlrev_b32 v2, 4, v1
  s_lshl2_add_u32 s49, s61, s5
  s_lshl_b32 s49, s49, 13
  s_mul_i32 s50, s5, 8448
  s_add_u32 s50, s50, 77824
  s_add_u32 s51, s50, 8448
L_dma_70:
  s_mov_b32 m0, s50
  s_add_u32 s50, s50, 1056
  buffer_load_dwordx4 v2, s[44:47], s49 offen nt lds
  s_add_u32 s49, s49, 1024
  s_waitcnt vmcnt(3)
  s_cmp_lt_u32 s50, s51
  s_cbranch_scc1 L_dma_70
L_dmae_71:
  s_bfe_u32 s32, s74, 0x80000
  s_bfe_u32 s33, s74, 0x80008
  s_bfe_u32 s34, s74, 0x80010
  s_bfe_u32 s35, s74, 0x80018
  v_add_u32 v4, 16384, v15
  v_add_u32 v0, 32768, v15
  v_add_u32 v36, 49152, v15
  global_load_dwordx2 v[8:9], v37, s[16:17]
  s_mov_b32 s70, 0
L_pg_72:
  global_load_dwordx4 v[136:139], v39, s[42:43] offset:-4096 sc1
  global_load_dwordx4 v[140:143], v39, s[42:43] offset:0 sc1
  v_add_u32 v3, 4096, v39
  global_load_dwordx4 v[144:147], v3, s[42:43] sc1
  s_waitcnt vmcnt(0)
  s_mov_b64 vcc, 0
  v_cmp_ne_u32 s[68:69], s74, v137
  s_or_b64 vcc, vcc, s[68:69]
  v_cmp_ne_u32 s[68:69], s74, v139
  s_or_b64 vcc, vcc, s[68:69]
  v_cmp_ne_u32 s[68:69], s74, v141
  s_or_b64 vcc, vcc, s[68:69]
  v_cmp_ne_u32 s[68:69], s74, v143
  s_or_b64 vcc, vcc, s[68:69]
  v_cmp_ne_u32 s[68:69], s74, v145
  s_or_b64 vcc, vcc, s[68:69]
  v_cmp_ne_u32 s[68:69], s74, v147
  s_or_b64 vcc, vcc, s[68:69]
  s_cmp_eq_u64 vcc, 0
  s_cbranch_scc1 L_pge_73
  s_sleep 8
  s_add_u32 s70, s70, 1
  s_cmp_lt_u32 s70, 262144
  s_cbranch_scc1 L_pg_72
L_pge_73:
  v_and_b32 v39, 1, v1
  v_lshlrev_b32 v39, 6, v39
  v_add_u32 v39, 10944, v39
  v_lshrrev_b32 v3, 4, v1
  v_lshl_add_u32 v37, v3, 4, v39
  v_bfe_u32 v3, v1, 1, 3
  v_lshlrev_b32 v3, 7, v3
  v_sub_u32 v37, v37, v3
  v_bfe_u32 v3, v1, 4, 1
  v_lshl_add_u32 v39, v3, 3, v39
  v_lshrrev_b32 v3, 5, v1
  v_lshl_add_u32 v39, v3, 2, v39
  s_lshl_b32 s49, s5, 4
  v_add_u32 v39, s49, v39
  v_lshlrev_b32 v16, 16, v8
  v_and_b32 v17, s73, v8
  v_lshlrev_b32 v18, 16, v9
  v_and_b32 v19, s73, v9
  v_lshlrev_b32 v20, 16, v136
  v_and_b32 v21, s73, v136
  v_lshlrev_b32 v22, 16, v138
  v_and_b32 v23, s73, v138
  v_lshlrev_b32 v28, 16, v144
  v_and_b32 v29, s73, v144
  v_lshlrev_b32 v30, 16, v146
  v_and_b32 v31, s73, v146
  v_add_f32 v28, 1.0, v28
  v_add_f32 v29, 1.0, v29
  v_add_f32 v30, 1.0, v30
  v_add_f32 v31, 1.0, v31
  v_cvt_pk_bf16_f32 v8, v28, v29
  v_cvt_pk_bf16_f32 v9, v30, v31
  v_mov_b32 v141, v142
  ds_write_b64 v12, v[8:9] offset:5312
  ds_write_b64 v12, v[140:141] offset:7424
  v_cvt_pk_bf16_f32 v28, 0, v28
  v_cvt_pk_bf16_f32 v29, 0, v29
  v_cvt_pk_bf16_f32 v30, 0, v30
  v_cvt_pk_bf16_f32 v31, 0, v31
  v_mul_f32 v24, v20, v28
  v_mul_f32 v25, v21, v29
  v_mul_f32 v26, v22, v30
  v_mul_f32 v27, v23, v31
  v_mul_f32 v28, v16, v28
  v_mul_f32 v29, v17, v29
  v_mul_f32 v30, v18, v30
  v_mul_f32 v31, v19, v31
  s_waitcnt lgkmcnt(0)
  s_waitcnt vmcnt(0)
  s_mov_b32 s70, 0
L_sn_74:
  ds_read_b32 v8, v38 offset:264
  s_waitcnt lgkmcnt(0)
  v_cmp_gt_u32 vcc, 0x8, v8
  s_cmp_eq_u64 vcc, 0
  s_cbranch_scc1 L_snd_75
  s_sleep 2
  s_add_u32 s70, s70, 1
  s_cmp_lt_u32 s70, 2097152
  s_cbranch_scc1 L_sn_74
L_snd_75:
  s_mov_b32 s70, 0
  s_mov_b32 s71, 15
  s_bitcmp1_b32 s71, 0
  s_cbranch_scc0 L_fl_76
  global_load_dwordx4 v[104:107], v15, s[42:43] offset:-4096 sc1
  global_load_dwordx4 v[108:111], v15, s[42:43] offset:0 sc1
L_fl_76:
  s_bitcmp1_b32 s71, 1
  s_cbranch_scc0 L_fl_77
  global_load_dwordx4 v[112:115], v4, s[42:43] offset:-4096 sc1
  global_load_dwordx4 v[116:119], v4, s[42:43] offset:0 sc1
L_fl_77:
  s_bitcmp1_b32 s71, 2
  s_cbranch_scc0 L_fl_78
  global_load_dwordx4 v[120:123], v0, s[42:43] offset:-4096 sc1
  global_load_dwordx4 v[124:127], v0, s[42:43] offset:0 sc1
L_fl_78:
  s_bitcmp1_b32 s71, 3
  s_cbranch_scc0 L_fl_79
  global_load_dwordx4 v[128:131], v36, s[42:43] offset:-4096 sc1
  global_load_dwordx4 v[132:135], v36, s[42:43] offset:0 sc1
L_fl_79:
  s_waitcnt vmcnt(0)
  s_branch L_f1_c
L_f1_p:
  s_add_u32 s70, s70, 1
  s_cmp_ge_u32 s70, 262144
  s_cbranch_scc1 L_f1_ok
  s_bitcmp1_b32 s71, 0
  s_cbranch_scc0 L_fl_80
  global_load_dwordx4 v[104:107], v15, s[42:43] offset:-4096 sc1
  global_load_dwordx4 v[108:111], v15, s[42:43] offset:0 sc1
L_fl_80:
  s_bitcmp1_b32 s71, 1
  s_cbranch_scc0 L_fl_81
  global_load_dwordx4 v[112:115], v4, s[42:43] offset:-4096 sc1
  global_load_dwordx4 v[116:119], v4, s[42:43] offset:0 sc1
L_fl_81:
  s_bitcmp1_b32 s71, 2
  s_cbranch_scc0 L_fl_82
  global_load_dwordx4 v[120:123], v0, s[42:43] offset:-4096 sc1
  global_load_dwordx4 v[124:127], v0, s[42:43] offset:0 sc1
L_fl_82:
  s_bitcmp1_b32 s71, 3
  s_cbranch_scc0 L_fl_83
  global_load_dwordx4 v[128:131], v36, s[42:43] offset:-4096 sc1
  global_load_dwordx4 v[132:135], v36, s[42:43] offset:0 sc1
L_fl_83:
  s_waitcnt vmcnt(0)
L_f1_c:
  s_bitcmp1_b32 s71, 0
  s_cbranch_scc0 L_fc_84
  v_xor_b32 v136, s32, v104
  v_xor_b32 v137, s33, v105
  v_xor_b32 v138, s34, v106
  v_xor_b32 v139, s35, v107
  v_xor_b32 v140, s32, v108
  v_xor_b32 v141, s33, v109
  v_xor_b32 v142, s34, v110
  v_xor_b32 v143, s35, v111
  v_or3_b32 v8, v136, v137, v138
  v_or3_b32 v9, v139, v140, v141
  v_or3_b32 v8, v8, v142, v143
  v_pk_add_f32 v[136:137], v[136:137], v[140:141]
  v_pk_add_f32 v[138:139], v[138:139], v[142:143]
  v_or_b32 v8, v8, v9
  v_cmp_ne_u32_sdwa vcc, v8, v38 src0_sel:BYTE_0 src1_sel:DWORD
  s_cmp_lg_u64 vcc, 0
  s_cbranch_scc1 L_fc_84
  s_bitset0_b32 s71, 0
L_fc_84:
  s_bitcmp1_b32 s71, 1
  s_cbranch_scc0 L_fc_85
  v_xor_b32 v144, s32, v112
  v_xor_b32 v145, s33, v113
  v_xor_b32 v146, s34, v114
  v_xor_b32 v147, s35, v115
  v_xor_b32 v148, s32, v116
  v_xor_b32 v149, s33, v117
  v_xor_b32 v150, s34, v118
  v_xor_b32 v151, s35, v119
  v_or3_b32 v8, v144, v145, v146
  v_or3_b32 v9, v147, v148, v149
  v_or3_b32 v8, v8, v150, v151
  v_pk_add_f32 v[144:145], v[144:145], v[148:149]
  v_pk_add_f32 v[146:147], v[146:147], v[150:151]
  v_or_b32 v8, v8, v9
  v_cmp_ne_u32_sdwa vcc, v8, v38 src0_sel:BYTE_0 src1_sel:DWORD
  s_cmp_lg_u64 vcc, 0
  s_cbranch_scc1 L_fc_85
  s_bitset0_b32 s71, 1
L_fc_85:
  s_bitcmp1_b32 s71, 2
  s_cbranch_scc0 L_fc_86
  v_xor_b32 v152, s32, v120
  v_xor_b32 v153, s33, v121
  v_xor_b32 v154, s34, v122
  v_xor_b32 v155, s35, v123
  v_xor_b32 v156, s32, v124
  v_xor_b32 v157, s33, v125
  v_xor_b32 v158, s34, v126
  v_xor_b32 v159, s35, v127
  v_or3_b32 v8, v152, v153, v154
  v_or3_b32 v9, v155, v156, v157
  v_or3_b32 v8, v8, v158, v159
  v_pk_add_f32 v[152:153], v[152:153], v[156:157]
  v_pk_add_f32 v[154:155], v[154:155], v[158:159]
  v_or_b32 v8, v8, v9
  v_cmp_ne_u32_sdwa vcc, v8, v38 src0_sel:BYTE_0 src1_sel:DWORD
  s_cmp_lg_u64 vcc, 0
  s_cbranch_scc1 L_fc_86
  s_bitset0_b32 s71, 2
L_fc_86:
  s_bitcmp1_b32 s71, 3
  s_cbranch_scc0 L_fc_87
  v_xor_b32 v160, s32, v128
  v_xor_b32 v161, s33, v129
  v_xor_b32 v162, s34, v130
  v_xor_b32 v163, s35, v131
  v_xor_b32 v164, s32, v132
  v_xor_b32 v165, s33, v133
  v_xor_b32 v166, s34, v134
  v_xor_b32 v167, s35, v135
  v_or3_b32 v8, v160, v161, v162
  v_or3_b32 v9, v163, v164, v165
  v_or3_b32 v8, v8, v166, v167
  v_pk_add_f32 v[160:161], v[160:161], v[164:165]
  v_pk_add_f32 v[162:163], v[162:163], v[166:167]
  v_or_b32 v8, v8, v9
  v_cmp_ne_u32_sdwa vcc, v8, v38 src0_sel:BYTE_0 src1_sel:DWORD
  s_cmp_lg_u64 vcc, 0
  s_cbranch_scc1 L_fc_87
  s_bitset0_b32 s71, 3
L_fc_87:
  s_cmp_lg_u32 s71, 0
  s_cbranch_scc1 L_f1_p
L_f1_ok:
  v_pk_add_f32 v[136:137], v[136:137], v[144:145]
  v_pk_add_f32 v[138:139], v[138:139], v[146:147]
  v_pk_add_f32 v[152:153], v[152:153], v[160:161]
  v_pk_add_f32 v[154:155], v[154:155], v[162:163]
  v_pk_add_f32 v[136:137], v[136:137], v[152:153]
  v_pk_add_f32 v[138:139], v[138:139], v[154:155]
  v_pk_fma_f32 v[8:9], v[136:137], v[24:25], v[28:29]
  v_pk_fma_f32 v[10:11], v[138:139], v[26:27], v[30:31]
  v_cvt_pk_bf16_f32 v8, v8, v9
  v_cvt_pk_bf16_f32 v9, v10, v11
  ds_write_b64 v12, v[8:9] offset:3200
  v_pk_fma_f32 v[16:17], v[136:137], v[20:21], v[16:17]
  v_pk_fma_f32 v[18:19], v[138:139], v[22:23], v[18:19]
  v_add_f32 v24, v16, v17
  v_mul_f32 v25, v16, v16
  v_add_f32 v26, v18, v19
  v_mul_f32 v27, v18, v18
  v_fmac_f32 v25, v17, v17
  v_fmac_f32 v27, v19, v19
  v_pk_add_f32 v[24:25], v[24:25], v[26:27]
  s_nop 1
  v_add_f32_dpp v24, v24, v24 quad_perm:[1,0,3,2] row_mask:0xf bank_mask:0xf
  v_add_f32_dpp v25, v25, v25 quad_perm:[1,0,3,2] row_mask:0xf bank_mask:0xf
  s_nop 0
  v_add_f32_dpp v24, v24, v24 quad_perm:[2,3,0,1] row_mask:0xf bank_mask:0xf
  v_add_f32_dpp v25, v25, v25 quad_perm:[2,3,0,1] row_mask:0xf bank_mask:0xf
  ds_write_b64 v5, v[24:25]
  s_add_u32 s77, s77, 4
  v_mov_b32 v10, 1
  s_mov_b64 exec, 1
  ds_add_u32 v38, v10 offset:316
  s_mov_b64 exec, -1
  s_mov_b32 s70, 0
L_hy_88:
  ds_read_b32 v10, v38 offset:316
  ds_read_b128 v[136:139], v14 offset:3200
  ds_read_b128 v[140:143], v14 offset:3264
  ds_read_b128 v[144:147], v14 offset:3328
  ds_read_b128 v[148:151], v14 offset:3392
  s_waitcnt lgkmcnt(4)
  v_cmp_gt_u32 vcc, s77, v10
  s_cmp_eq_u64 vcc, 0
  s_cbranch_scc1 L_hyd_89
  s_waitcnt lgkmcnt(0)
  s_add_u32 s70, s70, 1
  s_cmp_lt_u32 s70, 2097152
  s_cbranch_scc1 L_hy_88
L_hyd_89:
  ds_read_b64 v[20:21], v7
  ds_read_b128 v[152:155], v14 offset:3456
  ds_read_b128 v[156:159], v14 offset:3520
  ds_read_b128 v[160:163], v14 offset:3584
  ds_read_b128 v[164:167], v14 offset:3648
  s_waitcnt lgkmcnt(8)
  v_mfma_f32_16x16x32_bf16 v[32:35], v[40:43], v[136:139], 0
  s_waitcnt lgkmcnt(7)
  v_mfma_f32_16x16x32_bf16 v[32:35], v[44:47], v[140:143], v[32:35]
  ds_read_b128 v[136:139], v14 offset:3712
  s_waitcnt lgkmcnt(7)
  v_mfma_f32_16x16x32_bf16 v[32:35], v[48:51], v[144:147], v[32:35]
  ds_read_b128 v[140:143], v14 offset:3776
  s_waitcnt lgkmcnt(7)
  v_mfma_f32_16x16x32_bf16 v[32:35], v[52:55], v[148:151], v[32:35]
  ds_read_b128 v[144:147], v14 offset:3840
  s_waitcnt lgkmcnt(6)
  v_mfma_f32_16x16x32_bf16 v[32:35], v[56:59], v[152:155], v[32:35]
  ds_read_b128 v[148:151], v14 offset:3904
  v_add_f32_dpp v20, v20, v20 quad_perm:[2,3,0,1] row_mask:0xf bank_mask:0xf
  v_add_f32_dpp v21, v21, v21 quad_perm:[2,3,0,1] row_mask:0xf bank_mask:0xf
  s_waitcnt lgkmcnt(6)
  v_mfma_f32_16x16x32_bf16 v[32:35], v[60:63], v[156:159], v[32:35]
  ds_read_b128 v[152:155], v14 offset:3968
  v_add_f32_dpp v20, v20, v20 row_ror:4 row_mask:0xf bank_mask:0xf
  v_add_f32_dpp v21, v21, v21 row_ror:4 row_mask:0xf bank_mask:0xf
  s_waitcnt lgkmcnt(6)
  v_mfma_f32_16x16x32_bf16 v[32:35], v[64:67], v[160:163], v[32:35]
  ds_read_b128 v[156:159], v14 offset:4032
  v_add_f32_dpp v20, v20, v20 row_ror:8 row_mask:0xf bank_mask:0xf
  v_add_f32_dpp v21, v21, v21 row_ror:8 row_mask:0xf bank_mask:0xf
  s_waitcnt lgkmcnt(6)
  v_mfma_f32_16x16x32_bf16 v[32:35], v[68:71], v[164:167], v[32:35]
  ds_read_b128 v[160:163], v14 offset:4096
  v_mov_b32 v22, v20
  v_mov_b32 v23, v21
  s_waitcnt lgkmcnt(6)
  v_mfma_f32_16x16x32_bf16 v[32:35], v[72:75], v[136:139], v[32:35]
  ds_read_b128 v[164:167], v14 offset:4160
  v_permlane16_swap_b32 v22, v20
  v_permlane16_swap_b32 v23, v21
  s_waitcnt lgkmcnt(6)
  v_mfma_f32_16x16x32_bf16 v[32:35], v[76:79], v[140:143], v[32:35]
  v_pk_add_f32 v[20:21], v[20:21], v[22:23]
  v_mov_b32 v22, v20
  v_mov_b32 v23, v21
  s_waitcnt lgkmcnt(5)
  v_mfma_f32_16x16x32_bf16 v[32:35], v[80:83], v[144:147], v[32:35]
  v_permlane32_swap_b32 v22, v20
  v_permlane32_swap_b32 v23, v21
  s_waitcnt lgkmcnt(4)
  v_mfma_f32_16x16x32_bf16 v[32:35], v[84:87], v[148:151], v[32:35]
  v_pk_add_f32 v[20:21], v[20:21], v[22:23]
  v_mul_f32 v20, 0xbb000000, v20
  s_waitcnt lgkmcnt(3)
  v_mfma_f32_16x16x32_bf16 v[32:35], v[88:91], v[152:155], v[32:35]
  v_mul_f32 v21, 0x3b000000, v21
  v_fma_f32 v21, -v20, v20, v21
  s_waitcnt lgkmcnt(2)
  v_mfma_f32_16x16x32_bf16 v[32:35], v[92:95], v[156:159], v[32:35]
  v_max_f32 v21, 0, v21
  v_add_f32 v21, 0x3727c5ac, v21
  s_waitcnt lgkmcnt(1)
  v_mfma_f32_16x16x32_bf16 v[32:35], v[96:99], v[160:163], v[32:35]
  v_rsq_f32 v21, v21
  s_waitcnt lgkmcnt(0)
  v_mfma_f32_16x16x32_bf16 v[32:35], v[100:103], v[164:167], v[32:35]
  ds_read_b64_tr_b16 v[40:41], v6 offset:0
  ds_read_b64_tr_b16 v[42:43], v6 offset:4224
  ds_read_b64_tr_b16 v[44:45], v6 offset:32
  ds_read_b64_tr_b16 v[46:47], v6 offset:4256
  ds_read_b64_tr_b16 v[48:49], v6 offset:64
  ds_read_b64_tr_b16 v[50:51], v6 offset:4288
  ds_read_b64_tr_b16 v[52:53], v6 offset:96
  ds_read_b64_tr_b16 v[54:55], v6 offset:4320
  v_fmac_f32_dpp v32, v32, v20 row_shl:2 row_mask:0xf bank_mask:0x1
  v_fmac_f32_dpp v33, v33, v20 row_shl:2 row_mask:0xf bank_mask:0x1
  v_fmac_f32_dpp v34, v34, v20 row_shl:2 row_mask:0xf bank_mask:0x1
  v_fmac_f32_dpp v35, v35, v20 row_shl:2 row_mask:0xf bank_mask:0x1
  v_mul_f32 v8, v32, v21
  v_mul_f32 v9, v33, v21
  v_mul_f32 v10, v34, v21
  v_mul_f32 v11, v35, v21
  v_add_f32_dpp v8, v32, v8 row_shl:4 row_mask:0xf bank_mask:0xf
  v_add_f32_dpp v9, v33, v9 row_shl:4 row_mask:0xf bank_mask:0xf
  v_add_f32_dpp v10, v34, v10 row_shl:4 row_mask:0xf bank_mask:0xf
  v_add_f32_dpp v11, v35, v11 row_shl:4 row_mask:0xf bank_mask:0xf
  s_waitcnt lgkmcnt(4)
  ds_read_b64_tr_b16 v[56:57], v6 offset:128
  ds_read_b64_tr_b16 v[58:59], v6 offset:4352
  ds_read_b64_tr_b16 v[60:61], v6 offset:160
  ds_read_b64_tr_b16 v[62:63], v6 offset:4384
  ds_read_b64_tr_b16 v[64:65], v6 offset:192
  ds_read_b64_tr_b16 v[66:67], v6 offset:4416
  ds_read_b64_tr_b16 v[68:69], v6 offset:224
  ds_read_b64_tr_b16 v[70:71], v6 offset:4448
  v_permlane32_swap_b32 v8, v10
  v_permlane32_swap_b32 v9, v11
  v_mul_f32 v20, 0xbfb8aa3b, v8
  v_mul_f32 v21, 0xbfb8aa3b, v9
  v_exp_f32 v20, v20
  v_exp_f32 v21, v21
  v_mul_f32 v8, v8, v10
  v_mul_f32 v9, v9, v11
  v_add_f32 v20, 1.0, v20
  v_add_f32 v21, 1.0, v21
  v_rcp_f32 v20, v20
  v_rcp_f32 v21, v21
  s_mov_b32 exec_lo, 0x00030003
  s_mov_b32 exec_hi, 0x00030003
  v_mul_f32 v8, v8, v20
  v_mul_f32 v9, v9, v21
  v_cvt_pk_bf16_f32 v8, v8, v9
  ds_write_b32 v39, v8
  s_mov_b64 exec, -1
  s_waitcnt lgkmcnt(4)
  s_add_u32 s77, s77, 4
  v_mov_b32 v10, 1
  s_mov_b64 exec, 1
  ds_add_u32 v38, v10 offset:316
  s_mov_b64 exec, -1
  s_mov_b32 s70, 0
L_hy_90:
  ds_read_b32 v10, v38 offset:316
  ds_read_b128 v[136:139], v37 offset:0
  ds_read_b128 v[140:143], v37 offset:128
  ds_read_b128 v[144:147], v37 offset:256
  ds_read_b128 v[148:151], v37 offset:384
  s_waitcnt lgkmcnt(4)
  v_cmp_gt_u32 vcc, s77, v10
  s_cmp_eq_u64 vcc, 0
  s_cbranch_scc1 L_hyd_91
  s_waitcnt lgkmcnt(0)
  s_add_u32 s70, s70, 1
  s_cmp_lt_u32 s70, 2097152
  s_cbranch_scc1 L_hy_90
L_hyd_91:
  ds_read_b128 v[152:155], v37 offset:512
  ds_read_b128 v[156:159], v37 offset:640
  ds_read_b128 v[160:163], v37 offset:768
  ds_read_b128 v[164:167], v37 offset:896
  v_mov_b32 v3, 0xff
  s_waitcnt lgkmcnt(7)
  v_mfma_f32_16x16x32_bf16 v[8:11], v[40:43], v[136:139], 0
  s_waitcnt lgkmcnt(6)
  v_mfma_f32_16x16x32_bf16 v[8:11], v[44:47], v[140:143], v[8:11]
  s_waitcnt lgkmcnt(5)
  v_mfma_f32_16x16x32_bf16 v[8:11], v[48:51], v[144:147], v[8:11]
  s_waitcnt lgkmcnt(4)
  v_mfma_f32_16x16x32_bf16 v[8:11], v[52:55], v[148:151], v[8:11]
  s_waitcnt lgkmcnt(3)
  v_mfma_f32_16x16x32_bf16 v[8:11], v[56:59], v[152:155], v[8:11]
  s_waitcnt lgkmcnt(2)
  v_mfma_f32_16x16x32_bf16 v[8:11], v[60:63], v[156:159], v[8:11]
  s_waitcnt lgkmcnt(1)
  v_mfma_f32_16x16x32_bf16 v[8:11], v[64:67], v[160:163], v[8:11]
  s_waitcnt lgkmcnt(0)
  v_mfma_f32_16x16x32_bf16 v[8:11], v[68:71], v[164:167], v[8:11]
  s_nop 7
  v_bfi_b32 v8, v3, s32, v8
  v_bfi_b32 v9, v3, s33, v9
  v_bfi_b32 v10, v3, s34, v10
  v_bfi_b32 v11, v3, s35, v11
  global_store_dwordx4 v13, v[8:11], s[42:43] sc1
  s_branch L_fin
L_r_f2:
  v_bfe_u32 v12, v1, 2, 1
  v_and_b32 v14, 3, v1
  s_lshl_b32 s49, s61, 5
  v_lshl_add_u32 v3, v14, 3, s49
  v_lshl_add_u32 v37, v12, 10, v3
  v_and_b32 v15, 7, v1
  s_lshl_b32 s49, s61, 7
  v_lshl_add_u32 v15, v15, 4, s49
  v_add_u32 v39, 16384, v15
  v_bfe_u32 v3, v1, 3, 1
  v_lshl_add_u32 v15, v3, 12, v15
  v_lshrrev_b32 v3, 4, v1
  v_lshl_add_u32 v15, v3, 14, v15
  v_add_u32 v15, 262144, v15
  s_lshl_b32 s49, s61, 14
  s_add_u32 s49, s49, 1574912
  v_lshl_add_u32 v36, v1, 4, s49
  global_load_dword v11, v37, s[38:39]
  global_load_dwordx2 v[8:9], v37, s[16:17]
  s_mov_b32 s70, 0
L_pg_92:
  global_load_dwordx4 v[136:139], v39, s[42:43] offset:-4096 sc1
  v_add_u32 v3, 8192, v39
  global_load_dwordx4 v[140:143], v3, s[42:43] sc1
  s_waitcnt vmcnt(0)
  s_mov_b64 vcc, 0
  v_cmp_ne_u32 s[68:69], s74, v137
  s_or_b64 vcc, vcc, s[68:69]
  v_cmp_ne_u32 s[68:69], s74, v139
  s_or_b64 vcc, vcc, s[68:69]
  v_cmp_ne_u32 s[68:69], s74, v141
  s_or_b64 vcc, vcc, s[68:69]
  v_cmp_ne_u32 s[68:69], s74, v143
  s_or_b64 vcc, vcc, s[68:69]
  s_cmp_eq_u64 vcc, 0
  s_cbranch_scc1 L_pge_93
  s_sleep 8
  s_add_u32 s70, s70, 1
  s_cmp_lt_u32 s70, 262144
  s_cbranch_scc1 L_pg_92
L_pge_93:
  v_lshlrev_b32 v16, 16, v8
  v_and_b32 v17, s73, v8
  v_lshlrev_b32 v18, 16, v9
  v_and_b32 v19, s73, v9
  v_lshlrev_b32 v20, 16, v136
  v_and_b32 v21, s73, v136
  v_lshlrev_b32 v22, 16, v138
  v_and_b32 v23, s73, v138
  v_lshlrev_b32 v24, 16, v140
  v_and_b32 v25, s73, v140
  v_lshlrev_b32 v26, 16, v142
  v_and_b32 v27, s73, v142
  s_mov_b32 s70, 0
L_sn_94:
  ds_read_b32 v8, v38 offset:264
  s_waitcnt lgkmcnt(0)
  v_cmp_gt_u32 vcc, 0x8, v8
  s_cmp_eq_u64 vcc, 0
  s_cbranch_scc1 L_snd_95
  s_sleep 2
  s_add_u32 s70, s70, 1
  s_cmp_lt_u32 s70, 2097152
  s_cbranch_scc1 L_sn_94
L_snd_95:
  s_mov_b32 s70, 0
L_f2_a:
  global_load_dwordx4 v[136:139], v15, s[42:43] sc1
  s_waitcnt vmcnt(0)
  v_xor_b32 v136, s32, v136
  v_xor_b32 v137, s33, v137
  v_xor_b32 v138, s34, v138
  v_xor_b32 v139, s35, v139
  v_or3_b32 v3, v136, v137, v138
  v_or_b32 v3, v3, v139
  v_lshlrev_b32 v3, 24, v3
  v_cmp_ne_u32 vcc, 0, v3
  s_cmp_eq_u64 vcc, 0
  s_cbranch_scc1 L_f2_ad
  s_sleep 4
  s_add_u32 s70, s70, 1
  s_cmp_lt_u32 s70, 262144
  s_cbranch_scc1 L_f2_a
L_f2_ad:
  s_cmp_lg_u32 s61, 0
  s_cbranch_scc1 L_f2_e
  v_mov_b32 v10, s74
  s_mov_b64 exec, 1
  global_store_dword v38, v10, s[42:43] offset:0 sc1
  s_mov_b64 exec, -1
L_f2_e:
  s_nop 1
  v_add_f32_dpp v136, v136, v136 row_ror:8 row_mask:0xf bank_mask:0xf
  v_add_f32_dpp v137, v137, v137 row_ror:8 row_mask:0xf bank_mask:0xf
  v_add_f32_dpp v138, v138, v138 row_ror:8 row_mask:0xf bank_mask:0xf
  v_add_f32_dpp v139, v139, v139 row_ror:8 row_mask:0xf bank_mask:0xf
  v_mov_b32 v140, v136
  v_mov_b32 v141, v137
  v_mov_b32 v142, v138
  v_mov_b32 v143, v139
  v_permlane16_swap_b32 v140, v136
  v_permlane16_swap_b32 v141, v137
  v_permlane16_swap_b32 v142, v138
  v_permlane16_swap_b32 v143, v139
  v_add_f32 v136, v136, v140
  v_add_f32 v137, v137, v141
  v_add_f32 v138, v138, v142
  v_add_f32 v139, v139, v143
  v_mov_b32 v140, v136
  v_mov_b32 v141, v137
  v_mov_b32 v142, v138
  v_mov_b32 v143, v139
  v_permlane32_swap_b32 v140, v136
  v_permlane32_swap_b32 v141, v137
  v_permlane32_swap_b32 v142, v138
  v_permlane32_swap_b32 v143, v139
  v_add_f32 v136, v136, v140
  v_add_f32 v137, v137, v141
  v_add_f32 v138, v138, v142
  v_add_f32 v139, v139, v143
  v_cvt_pk_bf16_f32 v136, 0, v136
  v_cvt_pk_bf16_f32 v137, 0, v137
  v_cvt_pk_bf16_f32 v138, 0, v138
  v_cvt_pk_bf16_f32 v139, 0, v139
  v_mul_f32 v136, v136, v20
  v_mul_f32 v137, v137, v21
  v_mul_f32 v138, v138, v22
  v_mul_f32 v139, v139, v23
  v_cvt_pk_bf16_f32 v136, 0, v136
  v_cvt_pk_bf16_f32 v137, 0, v137
  v_cvt_pk_bf16_f32 v138, 0, v138
  v_cvt_pk_bf16_f32 v139, 0, v139
  v_add_f32 v16, v16, v136
  v_add_f32 v17, v17, v137
  v_add_f32 v18, v18, v138
  v_add_f32 v19, v19, v139
  v_cvt_pk_bf16_f32 v16, 0, v16
  v_cvt_pk_bf16_f32 v17, 0, v17
  v_cvt_pk_bf16_f32 v18, 0, v18
  v_cvt_pk_bf16_f32 v19, 0, v19
  v_mov_b32 v156, s32
  v_mov_b32 v157, s33
  v_mov_b32 v158, s34
  v_mov_b32 v159, s35
  s_mov_b64 s[20:21], -1
  s_mov_b64 s[22:23], -1
  s_mov_b64 s[24:25], -1
  s_mov_b64 s[26:27], -1
  s_mov_b64 s[28:29], -1
  s_mov_b64 s[30:31], 0xffffff
  s_mov_b64 exec, s[20:21]
  global_load_dwordx4 v[136:139], v36, s[42:43] offset:-2048 sc1
  s_mov_b64 exec, s[22:23]
  global_load_dwordx4 v[140:143], v36, s[42:43] offset:-1024 sc1
  s_mov_b64 exec, s[24:25]
  global_load_dwordx4 v[144:147], v36, s[42:43] offset:0 sc1
  s_mov_b64 exec, s[26:27]
  global_load_dwordx4 v[148:151], v36, s[42:43] offset:1024 sc1
  s_mov_b64 exec, s[28:29]
  global_load_dwordx4 v[152:155], v36, s[42:43] offset:2048 sc1
  s_mov_b64 exec, s[30:31]
  global_load_dwordx4 v[156:159], v36, s[42:43] offset:3072 sc1
  s_mov_b64 exec, -1
  s_waitcnt vmcnt(0)
  s_mov_b32 s70, 0
  s_branch L_f2_pc
L_f2_p:
  s_mov_b64 exec, s[20:21]
  global_load_dwordx4 v[136:139], v36, s[42:43] offset:-2048 sc1
  s_mov_b64 exec, s[22:23]
  global_load_dwordx4 v[140:143], v36, s[42:43] offset:-1024 sc1
  s_mov_b64 exec, s[24:25]
  global_load_dwordx4 v[144:147], v36, s[42:43] offset:0 sc1
  s_mov_b64 exec, s[26:27]
  global_load_dwordx4 v[148:151], v36, s[42:43] offset:1024 sc1
  s_mov_b64 exec, s[28:29]
  global_load_dwordx4 v[152:155], v36, s[42:43] offset:2048 sc1
  s_mov_b64 exec, s[30:31]
  global_load_dwordx4 v[156:159], v36, s[42:43] offset:3072 sc1
  s_mov_b64 exec, -1
  s_sleep 2
  s_waitcnt vmcnt(6)
L_f2_pc:
  v_xor_b32 v104, s32, v136
  v_xor_b32 v105, s33, v137
  v_xor_b32 v106, s34, v138
  v_xor_b32 v107, s35, v139
  v_xor_b32 v108, s32, v140
  v_xor_b32 v109, s33, v141
  v_xor_b32 v110, s34, v142
  v_xor_b32 v111, s35, v143
  v_xor_b32 v112, s32, v144
  v_xor_b32 v113, s33, v145
  v_xor_b32 v114, s34, v146
  v_xor_b32 v115, s35, v147
  v_xor_b32 v116, s32, v148
  v_xor_b32 v117, s33, v149
  v_xor_b32 v118, s34, v150
  v_xor_b32 v119, s35, v151
  v_xor_b32 v120, s32, v152
  v_xor_b32 v121, s33, v153
  v_xor_b32 v122, s34, v154
  v_xor_b32 v123, s35, v155
  v_xor_b32 v124, s32, v156
  v_xor_b32 v125, s33, v157
  v_xor_b32 v126, s34, v158
  v_xor_b32 v127, s35, v159
  v_or3_b32 v28, v104, v105, v106
  v_or3_b32 v29, v108, v109, v110
  v_or3_b32 v30, v112, v113, v114
  v_or3_b32 v31, v116, v117, v118
  v_or3_b32 v32, v120, v121, v122
  v_or3_b32 v33, v124, v125, v126
  v_or_b32 v28, v28, v107
  v_or_b32 v29, v29, v111
  v_or_b32 v30, v30, v115
  v_or_b32 v31, v31, v119
  v_or_b32 v32, v32, v123
  v_or_b32 v33, v33, v127
  v_cmp_ne_u32_sdwa s[20:21], v28, v38 src0_sel:BYTE_0 src1_sel:DWORD
  v_cmp_ne_u32_sdwa s[22:23], v29, v38 src0_sel:BYTE_0 src1_sel:DWORD
  v_cmp_ne_u32_sdwa s[24:25], v30, v38 src0_sel:BYTE_0 src1_sel:DWORD
  v_cmp_ne_u32_sdwa s[26:27], v31, v38 src0_sel:BYTE_0 src1_sel:DWORD
  v_cmp_ne_u32_sdwa s[28:29], v32, v38 src0_sel:BYTE_0 src1_sel:DWORD
  v_cmp_ne_u32_sdwa s[30:31], v33, v38 src0_sel:BYTE_0 src1_sel:DWORD
  v_pk_add_f32 v[104:105], v[104:105], v[108:109]
  v_pk_add_f32 v[106:107], v[106:107], v[110:111]
  v_pk_add_f32 v[112:113], v[112:113], v[116:117]
  v_pk_add_f32 v[114:115], v[114:115], v[118:119]
  v_pk_add_f32 v[120:121], v[120:121], v[124:125]
  v_pk_add_f32 v[122:123], v[122:123], v[126:127]
  v_pk_add_f32 v[104:105], v[104:105], v[112:113]
  v_pk_add_f32 v[106:107], v[106:107], v[114:115]
  v_pk_add_f32 v[104:105], v[104:105], v[120:121]
  v_pk_add_f32 v[106:107], v[106:107], v[122:123]
  s_mov_b64 vcc, s[20:21]
  s_or_b64 vcc, vcc, s[22:23]
  s_or_b64 vcc, vcc, s[24:25]
  s_or_b64 vcc, vcc, s[26:27]
  s_or_b64 vcc, vcc, s[28:29]
  s_or_b64 vcc, vcc, s[30:31]
  s_or_b32 s20, s20, 1
  s_or_b32 s22, s22, 1
  s_or_b32 s24, s24, 1
  s_or_b32 s26, s26, 1
  s_or_b32 s28, s28, 1
  s_or_b32 s30, s30, 1
  s_cmp_eq_u64 vcc, 0
  s_cbranch_scc1 L_f2_pok
  s_add_u32 s70, s70, 1
  s_cmp_lt_u32 s70, 262144
  s_cbranch_scc1 L_f2_p
L_f2_pok:
  s_nop 1
  v_add_f32_dpp v104, v104, v104 row_ror:8 row_mask:0xf bank_mask:0xf
  v_add_f32_dpp v105, v105, v105 row_ror:8 row_mask:0xf bank_mask:0xf
  v_add_f32_dpp v106, v106, v106 row_ror:8 row_mask:0xf bank_mask:0xf
  v_add_f32_dpp v107, v107, v107 row_ror:8 row_mask:0xf bank_mask:0xf
  v_mov_b32 v108, v104
  v_mov_b32 v109, v105
  v_mov_b32 v110, v106
  v_mov_b32 v111, v107
  v_permlane16_swap_b32 v108, v104
  v_permlane16_swap_b32 v109, v105
  v_permlane16_swap_b32 v110, v106
  v_permlane16_swap_b32 v111, v107
  v_add_f32 v104, v104, v108
  v_add_f32 v105, v105, v109
  v_add_f32 v106, v106, v110
  v_add_f32 v107, v107, v111
  v_mov_b32 v108, v104
  v_mov_b32 v109, v105
  v_mov_b32 v110, v106
  v_mov_b32 v111, v107
  v_permlane32_swap_b32 v108, v104
  v_permlane32_swap_b32 v109, v105
  v_permlane32_swap_b32 v110, v106
  v_permlane32_swap_b32 v111, v107
  v_add_f32 v104, v104, v108
  v_add_f32 v105, v105, v109
  v_add_f32 v106, v106, v110
  v_add_f32 v107, v107, v111
  v_cvt_pk_bf16_f32 v104, 0, v104
  v_cvt_pk_bf16_f32 v105, 0, v105
  v_cvt_pk_bf16_f32 v106, 0, v106
  v_cvt_pk_bf16_f32 v107, 0, v107
  v_mul_f32 v104, v104, v24
  v_mul_f32 v105, v105, v25
  v_mul_f32 v106, v106, v26
  v_mul_f32 v107, v107, v27
  v_cvt_pk_bf16_f32 v104, 0, v104
  v_cvt_pk_bf16_f32 v105, 0, v105
  v_cvt_pk_bf16_f32 v106, 0, v106
  v_cvt_pk_bf16_f32 v107, 0, v107
  v_add_f32 v8, v104, v16
  v_add_f32 v9, v105, v17
  v_add_f32 v10, v106, v18
  v_add_f32 v11, v107, v19
  v_cvt_pk_bf16_f32 v8, v8, v9
  v_cvt_pk_bf16_f32 v9, v10, v11
  s_mov_b64 exec, 0xff
  global_store_dwordx2 v37, v[8:9], s[38:39] sc1
  s_mov_b64 exec, 1
  v_mov_b32 v10, s74
  s_lshl_b32 s49, s61, 7
  s_add_u32 s49, s49, 28672
  v_mov_b32 v11, s49
  global_store_dword v11, v10, s[42:43] sc1
L_fin:
L_end:
  s_endpgm
.p2align 7
L_table:
  .long 0xff00ff13, 0x1504ff14, 0xff08ff1b, 0x1d0cff1c, 0xff10ff23, 0xff14ff24, 0xff18ff2b, 0x2d1cff2c
  .long 0xff01ff10, 0x1705ff16, 0xff09ff18, 0x1f0dff1e, 0xff11ff20, 0xff15ff25, 0xff19ff28, 0x2f1dff2e
  .long 0x1202ff11, 0xff0605ff, 0x1a0aff19, 0xff0e10ff, 0x2212ff21, 0x2716ff26, 0x2a1aff29, 0xff1e25ff
  .long 0xffff00ff, 0xffff06ff, 0xffff0bff, 0xffff11ff, 0xffff16ff, 0xffff1bff, 0xffff20ff, 0xffff26ff
  .long 0xffff01ff, 0xffff07ff, 0xffff0cff, 0xffff12ff, 0xffff17ff, 0xffff1cff, 0xffff21ff, 0xffff27ff
  .long 0xffff02ff, 0xffff08ff, 0xffff0dff, 0xffff13ff, 0xffff18ff, 0xffff1dff, 0xffff22ff, 0xffff28ff
  .long 0xffff03ff, 0xffff09ff, 0xffff0eff, 0xffff14ff, 0xffff19ff, 0xffff1eff, 0xffff23ff, 0xffff29ff
  .long 0xff0304ff, 0xff070aff, 0xff0b0fff, 0xff0f15ff, 0xff131aff, 0xff171fff, 0xff1b24ff, 0xff1f2aff
L_touch:
  .long 0x80804101, 0x80804909, 0x80804303, 0x80808080, 0x80804b0b, 0x80804505, 0x80804d0d, 0x80808080
  .long 0x80804707, 0x80804f0f, 0x80805900, 0x80808080, 0x80805b08, 0x80805d02, 0x80805f0a, 0x80808080
  .long 0x80805804, 0x80805a0c, 0x80805c06, 0x80808080, 0x80805e0e, 0x80805140, 0x80806148, 0x80808080
  .long 0x80806942, 0x8080714a, 0x80807944, 0x80808080, 0x8080534c, 0x80806346, 0x80806b4e, 0x80808080
.section .rodata,"a"
.p2align 6
.amdhsa_kernel adaLN_cond__sliding_block_cached__glu_gated_swiglu__decode_kernel
  .amdhsa_next_free_vgpr 168
  .amdhsa_next_free_sgpr 102
  .amdhsa_accum_offset 168
  .amdhsa_group_segment_fixed_size 0
  .amdhsa_kernarg_size 112
  .amdhsa_user_sgpr_count 2
  .amdhsa_user_sgpr_kernarg_segment_ptr 1
  .amdhsa_system_sgpr_workgroup_id_x 1
.end_amdhsa_kernel
```

```asm
; @launch grid=(256,1,1) block=(768,1,1) lds=143360
.amdgcn_target "amdgcn-amd-amdhsa--gfx950"
.text
.globl adaLN_cond__sliding_block_cached__glu_gated_swiglu__decode_kernel
.p2align 8
.type adaLN_cond__sliding_block_cached__glu_gated_swiglu__decode_kernel,@function
adaLN_cond__sliding_block_cached__glu_gated_swiglu__decode_kernel:
  s_cmp_ge_u32 s2, 256
  s_cbranch_scc1 L_end
  s_load_dwordx16 s[16:31], s[0:1], 0
  s_load_dwordx8 s[32:39], s[0:1], 64
  s_load_dwordx4 s[40:43], s[0:1], 96
  v_lshrrev_b32 v2, 6, v0
  v_and_b32 v1, 63, v0
  v_readfirstlane_b32 s13, v2
  s_bfe_u32 s7, s2, 0x20003
  s_bfe_u32 s6, s2, 0x20005
  s_and_b32 s8, s2, 7
  s_lshl2_add_u32 s6, s8, s6
  s_and_b32 s9, s2, 0x80
  s_lshr_b32 s9, s9, 2
  s_add_u32 s6, s6, s9
  s_mov_b32 s72, 0xfffffffe
  s_mov_b32 s73, 0xffff0000
  s_cmp_eq_u32 s7, 3
  s_cbranch_scc1 L_serv
  s_cmp_eq_u32 s13, 0
  s_cbranch_scc1 L_pub
L_stream:
  s_sub_u32 s9, s13, 1
  s_mul_i32 s10, s7, 3
  s_add_u32 s10, s10, s9
  s_sub_u32 s10, s10, 8
  s_cmp_ge_i32 s10, 8
  s_cbranch_scc1 L_end
  s_cmp_lt_u32 s9, 8
  s_cselect_b32 s11, s9, s10
  s_cselect_b32 s4, s7, 3
  s_lshl_b32 s11, s11, 10
  s_lshl_b32 s4, s4, 18
  s_lshl_b32 s10, s6, 22
  s_add_u32 s10, s10, s4
  s_add_u32 s10, s10, 0x300000
  v_lshl_add_u32 v0, v1, 4, s11
  s_lshr_b32 s12, s2, 3
  s_mul_i32 s12, s12, 5
  s_mul_i32 s15, s8, 3
  s_add_u32 s12, s12, s15
  s_lshl_b32 s12, s12, 13
  s_and_b32 s12, s12, 0x3ffff
  s_waitcnt lgkmcnt(0)
  s_add_u32 s44, s18, s10
  s_addc_u32 s45, s19, 0
  s_mov_b32 s46, 0x40000
  s_mov_b32 s47, 0x20000
  buffer_load_dwordx4 v[40:43], v0, s[44:47], s12 offen nt
  s_add_u32 s12, s12, 0x2000
  s_and_b32 s12, s12, 0x3ffff
  buffer_load_dwordx4 v[44:47], v0, s[44:47], s12 offen nt
  s_add_u32 s12, s12, 0x2000
  s_and_b32 s12, s12, 0x3ffff
  buffer_load_dwordx4 v[48:51], v0, s[44:47], s12 offen nt
  s_add_u32 s12, s12, 0x2000
  s_and_b32 s12, s12, 0x3ffff
  s_load_dword s74, s[42:43], 0
  s_add_u32 s48, s20, s10
  s_addc_u32 s49, s21, 0
  s_mov_b32 s50, 0x40000
  s_mov_b32 s51, 0x20000
  s_mov_b32 s52, 0xcccccccc
  s_mov_b32 s53, 0xcccccccc
  s_mov_b32 s54, 0xaaaaaaaa
  s_mov_b32 s55, 0xaaaaaaaa
  v_and_b32 v38, 15, v1
  v_lshlrev_b32 v38, 4, v38
  s_lshl_b32 s10, s9, 11
  s_add_u32 s10, s10, 12288
  v_lshl_add_u32 v3, v1, 3, s10
  v_mov_b32 v4, 0x7fff0000
  v_mov_b32 v5, 0xff800000
  ds_write_b64 v3, v[4:5] offset:0
  ds_write_b64 v3, v[4:5] offset:512
  ds_write_b64 v3, v[4:5] offset:1024
  v_lshrrev_b32 v3, 4, v1
  v_lshl_add_u32 v39, v38, 1, s10
  v_lshl_add_u32 v39, v3, 3, v39
  s_sub_u32 s68, s12, 24576
  v_bfrev_b32 v24, v1
  v_lshrrev_b32 v24, 15, v24
  v_and_b32 v24, 0x1e000, v24
  v_add_u32 v24, s68, v24
  v_and_b32 v24, 0x3e000, v24
  v_lshl_add_u32 v24, v3, 8, v24
  v_add_u32 v24, s11, v24
  v_xor_b32 v26, 0x20000, v24
  s_lshl_b32 s11, s9, 9
  s_sub_u32 s11, s11, s10
  s_mov_b32 s32, 3
  s_mul_i32 s33, s9, 0x60000000
  s_add_u32 s33, s33, 0x10000000
  s_mov_b64 s[64:65], 0
  s_mov_b64 s[66:67], 0
  s_mov_b32 s38, 0
  s_mov_b32 s39, 0
  s_mov_b32 s75, 0
  s_mov_b32 s61, 0
  s_lshl3_add_u32 s40, s6, s9
  s_lshl_b32 s40, s40, 6
  s_add_u32 s40, s40, 32768
  s_barrier
  s_waitcnt lgkmcnt(0)
  s_mov_b32 s56, s10
  s_mul_i32 s74, s74, 0x9e3779b1
  s_add_u32 s74, s74, 0x7f4a7c15
  s_cmp_eq_u32 s7, 2
  s_cselect_b32 s76, 10, 11
  s_mov_b32 s41, 5
  s_mov_b32 s34, 174694
  s_mov_b32 s77, 0
  s_mov_b32 s35, 29
  s_mov_b32 s59, 0
  s_mul_i32 s68, s76, 29
  s_add_u32 s68, s68, 1024
  v_mov_b32 v22, s68
  v_mov_b32 v23, 0
  v_mov_b32 v2, 0
  s_cmp_ge_u32 s9, 8
  s_cselect_b32 s39, 2, 0
  s_call_b64 s[62:63], L_kq
  buffer_load_dwordx4 v[52:55], v0, s[44:47], s12 offen nt
  s_add_u32 s12, s12, 0x2000
  s_and_b32 s12, s12, 0x3ffff
  s_call_b64 s[62:63], L_kq
  buffer_load_dwordx4 v[56:59], v0, s[44:47], s12 offen nt
  s_add_u32 s12, s12, 0x2000
  s_and_b32 s12, s12, 0x3ffff
  s_call_b64 s[62:63], L_kq
  buffer_load_dwordx4 v[60:63], v0, s[44:47], s12 offen nt
  s_add_u32 s12, s12, 0x2000
  s_and_b32 s12, s12, 0x3ffff
  s_call_b64 s[62:63], L_kq
  buffer_load_dwordx4 v[64:67], v0, s[44:47], s12 offen nt
  s_add_u32 s12, s12, 0x2000
  s_and_b32 s12, s12, 0x3ffff
  s_call_b64 s[62:63], L_kq
  buffer_load_dwordx4 v[68:71], v0, s[44:47], s12 offen nt
  s_add_u32 s12, s12, 0x2000
  s_and_b32 s12, s12, 0x3ffff
  s_call_b64 s[62:63], L_kq
  buffer_load_dwordx4 v[72:75], v0, s[44:47], s12 offen nt
  s_add_u32 s12, s12, 0x2000
  s_and_b32 s12, s12, 0x3ffff
  s_call_b64 s[62:63], L_kq
  buffer_load_dwordx4 v[76:79], v0, s[44:47], s12 offen nt
  s_add_u32 s12, s12, 0x2000
  s_and_b32 s12, s12, 0x3ffff
  s_call_b64 s[62:63], L_kq
  buffer_load_dwordx4 v[80:83], v0, s[44:47], s12 offen nt
  s_add_u32 s12, s12, 0x2000
  s_and_b32 s12, s12, 0x3ffff
  s_call_b64 s[62:63], L_kq
  buffer_load_dwordx4 v[84:87], v0, s[44:47], s12 offen nt
  s_add_u32 s12, s12, 0x2000
  s_and_b32 s12, s12, 0x3ffff
  s_call_b64 s[62:63], L_kq
  buffer_load_dwordx4 v[88:91], v0, s[44:47], s12 offen nt
  s_add_u32 s12, s12, 0x2000
  s_and_b32 s12, s12, 0x3ffff
  s_call_b64 s[62:63], L_ks
  buffer_load_dwordx4 v[92:95], v0, s[44:47], s12 offen nt
  s_add_u32 s12, s12, 0x2000
  s_and_b32 s12, s12, 0x3ffff
  s_call_b64 s[62:63], L_ks
  buffer_load_dwordx4 v[96:99], v0, s[44:47], s12 offen nt
  s_add_u32 s12, s12, 0x2000
  s_and_b32 s12, s12, 0x3ffff
  s_call_b64 s[62:63], L_ks
  buffer_load_dwordx4 v[100:103], v0, s[44:47], s12 offen nt
  s_add_u32 s12, s12, 0x2000
  s_and_b32 s12, s12, 0x3ffff
  s_call_b64 s[62:63], L_ks
  buffer_load_dwordx4 v[104:107], v0, s[44:47], s12 offen nt
  s_add_u32 s12, s12, 0x2000
  s_and_b32 s12, s12, 0x3ffff
  s_call_b64 s[62:63], L_ks
  buffer_load_dwordx4 v[108:111], v0, s[44:47], s12 offen nt
  s_add_u32 s12, s12, 0x2000
  s_and_b32 s12, s12, 0x3ffff
  s_call_b64 s[62:63], L_ks
  buffer_load_dwordx4 v[112:115], v0, s[44:47], s12 offen nt
  s_add_u32 s12, s12, 0x2000
  s_and_b32 s12, s12, 0x3ffff
  s_call_b64 s[62:63], L_ks
  buffer_load_dwordx4 v[116:119], v0, s[44:47], s12 offen nt
  s_add_u32 s12, s12, 0x2000
  s_and_b32 s12, s12, 0x3ffff
  s_call_b64 s[62:63], L_ks
  buffer_load_dwordx4 v[120:123], v0, s[44:47], s12 offen nt
  s_add_u32 s12, s12, 0x2000
  s_and_b32 s12, s12, 0x3ffff
  s_call_b64 s[62:63], L_ks
  buffer_load_dwordx4 v[124:127], v0, s[44:47], s12 offen nt
  s_add_u32 s12, s12, 0x2000
  s_and_b32 s12, s12, 0x3ffff
  s_call_b64 s[62:63], L_ks
  buffer_load_dwordx4 v[128:131], v0, s[44:47], s12 offen nt
  s_add_u32 s12, s12, 0x2000
  s_and_b32 s12, s12, 0x3ffff
  s_call_b64 s[62:63], L_ks
  buffer_load_dwordx4 v[132:135], v0, s[44:47], s12 offen nt
  s_add_u32 s12, s12, 0x2000
  s_and_b32 s12, s12, 0x3ffff
  s_call_b64 s[62:63], L_ks
  buffer_load_dwordx4 v[136:139], v0, s[44:47], s12 offen nt
  s_add_u32 s12, s12, 0x2000
  s_and_b32 s12, s12, 0x3ffff
  s_call_b64 s[62:63], L_ks
  buffer_load_dwordx4 v[140:143], v0, s[44:47], s12 offen nt
  s_add_u32 s12, s12, 0x2000
  s_and_b32 s12, s12, 0x3ffff
  s_call_b64 s[62:63], L_ks
  buffer_load_dwordx4 v[144:147], v0, s[44:47], s12 offen nt
  s_add_u32 s12, s12, 0x2000
  s_and_b32 s12, s12, 0x3ffff
  s_call_b64 s[62:63], L_ks
  buffer_load_dwordx4 v[148:151], v0, s[44:47], s12 offen nt
  s_add_u32 s12, s12, 0x2000
  s_and_b32 s12, s12, 0x3ffff
  s_call_b64 s[62:63], L_ks
  buffer_load_dwordx4 v[152:155], v0, s[44:47], s12 offen nt
  s_add_u32 s12, s12, 0x2000
  s_and_b32 s12, s12, 0x3ffff
  s_call_b64 s[62:63], L_ks
  buffer_load_dwordx4 v[156:159], v0, s[44:47], s12 offen nt
  s_add_u32 s12, s12, 0x2000
  s_and_b32 s12, s12, 0x3ffff
  s_call_b64 s[62:63], L_ks
  buffer_load_dwordx4 v[160:163], v0, s[44:47], s12 offen nt
  s_add_u32 s12, s12, 0x2000
  s_and_b32 s12, s12, 0x3ffff
  s_call_b64 s[62:63], L_ks
  buffer_load_dwordx4 v[164:167], v0, s[44:47], s12 offen nt
  s_add_u32 s12, s12, 0x2000
  s_and_b32 s12, s12, 0x3ffff
  s_mov_b32 s10, 0
L_kw:
  s_cmp_ge_u32 s39, 4
  s_cbranch_scc1 L_v0
  s_call_b64 s[100:101], L_work
  s_sleep 1
  s_add_u32 s10, s10, 1
  s_cmp_lt_u32 s10, 262144
  s_cbranch_scc1 L_kw
L_v0:
  s_mov_b32 s32, 0
  v_mov_b32 v2, 8
  s_mov_b32 s35, s59
  ds_read_b64 v[22:23], v2 offset:288
  s_waitcnt lgkmcnt(0)
  v_and_b32 v3, 1, v1
  v_lshlrev_b32 v3, 4, v3
  v_mov_b32 v20, 0xffff
  v_lshlrev_b32 v3, v3, v20
  v_bfe_u32 v20, v1, 1, 3
  v_cmp_eq_u32 vcc, 0, v20
  s_nop 1
  v_cndmask_b32 v34, 0, v3, vcc
  v_cmp_eq_u32 vcc, 1, v20
  s_nop 1
  v_cndmask_b32 v35, 0, v3, vcc
  v_cmp_eq_u32 vcc, 2, v20
  s_nop 1
  v_cndmask_b32 v36, 0, v3, vcc
  v_cmp_eq_u32 vcc, 3, v20
  s_nop 1
  v_cndmask_b32 v0, 0, v3, vcc
  s_cmp_eq_u32 s7, 2
  s_mov_b32 s77, 64
  s_cselect_b32 s77, 67, s77
  s_mov_b32 s34, 163021
  s_cselect_b32 s34, 162980, s34
  s_call_b64 s[62:63], L_vs
  v_add_u32_dpp v3, v28, v38 row_newbcast:0 row_mask:0xf bank_mask:0xf
  buffer_load_dwordx4 v[40:43], v3, s[48:51], 0 offen nt
  v_dot2_f32_bf16 v8, v104, v4, 0
  v_dot2_f32_bf16 v9, v108, v4, 0
  v_dot2_f32_bf16 v10, v112, v4, 0
  v_dot2_f32_bf16 v11, v116, v4, 0
  v_dot2_f32_bf16 v12, v120, v4, 0
  v_dot2_f32_bf16 v13, v124, v4, 0
  v_dot2_f32_bf16 v14, v128, v4, 0
  v_dot2_f32_bf16 v15, v132, v4, 0
  v_dot2_f32_bf16 v8, v105, v5, v8
  v_dot2_f32_bf16 v9, v109, v5, v9
  v_dot2_f32_bf16 v10, v113, v5, v10
  v_dot2_f32_bf16 v11, v117, v5, v11
  v_dot2_f32_bf16 v12, v121, v5, v12
  v_dot2_f32_bf16 v13, v125, v5, v13
  v_dot2_f32_bf16 v14, v129, v5, v14
  v_dot2_f32_bf16 v15, v133, v5, v15
  v_dot2_f32_bf16 v8, v106, v6, v8
  v_dot2_f32_bf16 v9, v110, v6, v9
  v_dot2_f32_bf16 v10, v114, v6, v10
  v_dot2_f32_bf16 v11, v118, v6, v11
  v_dot2_f32_bf16 v12, v122, v6, v12
  v_dot2_f32_bf16 v13, v126, v6, v13
  v_dot2_f32_bf16 v14, v130, v6, v14
  v_dot2_f32_bf16 v15, v134, v6, v15
  v_dot2_f32_bf16 v8, v107, v7, v8
  v_dot2_f32_bf16 v9, v111, v7, v9
  v_dot2_f32_bf16 v10, v115, v7, v10
  v_dot2_f32_bf16 v11, v119, v7, v11
  v_dot2_f32_bf16 v12, v123, v7, v12
  v_dot2_f32_bf16 v13, v127, v7, v13
  v_dot2_f32_bf16 v14, v131, v7, v14
  v_dot2_f32_bf16 v15, v135, v7, v15
  v_add_f32_dpp v8, v8, v8 row_ror:8 row_mask:0xf bank_mask:0x3
  v_add_f32_dpp v8, v9, v9 row_ror:8 row_mask:0xf bank_mask:0xc
  v_add_f32_dpp v10, v10, v10 row_ror:8 row_mask:0xf bank_mask:0x3
  v_add_f32_dpp v10, v11, v11 row_ror:8 row_mask:0xf bank_mask:0xc
  v_add_f32_dpp v12, v12, v12 row_ror:8 row_mask:0xf bank_mask:0x3
  v_add_f32_dpp v12, v13, v13 row_ror:8 row_mask:0xf bank_mask:0xc
  v_add_f32_dpp v14, v14, v14 row_ror:8 row_mask:0xf bank_mask:0x3
  v_add_f32_dpp v14, v15, v15 row_ror:8 row_mask:0xf bank_mask:0xc
  v_add_f32_dpp v16, v8, v8 row_shl:4 row_mask:0xf bank_mask:0x5
  v_add_f32_dpp v16, v10, v10 row_shr:4 row_mask:0xf bank_mask:0xa
  v_add_f32_dpp v17, v12, v12 row_shl:4 row_mask:0xf bank_mask:0x5
  v_add_f32_dpp v17, v14, v14 row_shr:4 row_mask:0xf bank_mask:0xa
  s_call_b64 s[62:63], L_vs
  s_cbranch_scc0 L_dr5
  v_add_u32_dpp v3, v28, v38 row_newbcast:1 row_mask:0xf bank_mask:0xf
  buffer_load_dwordx4 v[44:47], v3, s[48:51], 0 offen nt
  s_call_b64 s[62:63], L_vs
  s_cbranch_scc0 L_dr5
  v_add_u32_dpp v3, v28, v38 row_newbcast:2 row_mask:0xf bank_mask:0xf
  buffer_load_dwordx4 v[48:51], v3, s[48:51], 0 offen nt
  s_call_b64 s[62:63], L_vs
  s_cbranch_scc0 L_dr5
  v_add_u32_dpp v3, v28, v38 row_newbcast:3 row_mask:0xf bank_mask:0xf
  buffer_load_dwordx4 v[52:55], v3, s[48:51], 0 offen nt
  s_call_b64 s[62:63], L_vs
  s_cbranch_scc0 L_dr5
  v_add_u32_dpp v3, v28, v38 row_newbcast:4 row_mask:0xf bank_mask:0xf
  buffer_load_dwordx4 v[56:59], v3, s[48:51], 0 offen nt
  s_call_b64 s[62:63], L_vs
  s_cbranch_scc0 L_dr5
  v_add_u32_dpp v3, v28, v38 row_newbcast:5 row_mask:0xf bank_mask:0xf
  buffer_load_dwordx4 v[60:63], v3, s[48:51], 0 offen nt
  v_and_b32_dpp v12, v29, v34 row_newbcast:0 row_mask:0xf bank_mask:0xf
  v_and_b32_dpp v13, v29, v35 row_newbcast:0 row_mask:0xf bank_mask:0xf
  v_and_b32_dpp v14, v29, v36 row_newbcast:0 row_mask:0xf bank_mask:0xf
  v_and_b32_dpp v15, v29, v0 row_newbcast:0 row_mask:0xf bank_mask:0xf
  s_nop 1
  v_mfma_f32_16x16x32_bf16 v[8:11], v[12:15], v[40:43], v[8:11]
  s_call_b64 s[62:63], L_vs
  s_cbranch_scc0 L_dr6
  v_add_u32_dpp v3, v28, v38 row_newbcast:6 row_mask:0xf bank_mask:0xf
  buffer_load_dwordx4 v[64:67], v3, s[48:51], 0 offen nt
  v_and_b32_dpp v12, v29, v34 row_newbcast:1 row_mask:0xf bank_mask:0xf
  v_and_b32_dpp v13, v29, v35 row_newbcast:1 row_mask:0xf bank_mask:0xf
  v_and_b32_dpp v14, v29, v36 row_newbcast:1 row_mask:0xf bank_mask:0xf
  v_and_b32_dpp v15, v29, v0 row_newbcast:1 row_mask:0xf bank_mask:0xf
  s_nop 1
  v_mfma_f32_16x16x32_bf16 v[8:11], v[12:15], v[44:47], v[8:11]
  s_call_b64 s[62:63], L_vs
  s_cbranch_scc0 L_dr7
  v_add_u32_dpp v3, v28, v38 row_newbcast:7 row_mask:0xf bank_mask:0xf
  buffer_load_dwordx4 v[68:71], v3, s[48:51], 0 offen nt
  v_and_b32_dpp v12, v29, v34 row_newbcast:2 row_mask:0xf bank_mask:0xf
  v_and_b32_dpp v13, v29, v35 row_newbcast:2 row_mask:0xf bank_mask:0xf
  v_and_b32_dpp v14, v29, v36 row_newbcast:2 row_mask:0xf bank_mask:0xf
  v_and_b32_dpp v15, v29, v0 row_newbcast:2 row_mask:0xf bank_mask:0xf
  s_nop 1
  v_mfma_f32_16x16x32_bf16 v[8:11], v[12:15], v[48:51], v[8:11]
  s_call_b64 s[62:63], L_vs
  s_cbranch_scc0 L_dr8
  v_add_u32_dpp v3, v28, v38 row_newbcast:8 row_mask:0xf bank_mask:0xf
  buffer_load_dwordx4 v[72:75], v3, s[48:51], 0 offen nt
  v_and_b32_dpp v12, v29, v34 row_newbcast:3 row_mask:0xf bank_mask:0xf
  v_and_b32_dpp v13, v29, v35 row_newbcast:3 row_mask:0xf bank_mask:0xf
  v_and_b32_dpp v14, v29, v36 row_newbcast:3 row_mask:0xf bank_mask:0xf
  v_and_b32_dpp v15, v29, v0 row_newbcast:3 row_mask:0xf bank_mask:0xf
  s_nop 1
  v_mfma_f32_16x16x32_bf16 v[8:11], v[12:15], v[52:55], v[8:11]
  s_call_b64 s[62:63], L_vs
  s_cbranch_scc0 L_dr9
  v_add_u32_dpp v3, v28, v38 row_newbcast:9 row_mask:0xf bank_mask:0xf
  buffer_load_dwordx4 v[76:79], v3, s[48:51], 0 offen nt
  v_and_b32_dpp v12, v29, v34 row_newbcast:4 row_mask:0xf bank_mask:0xf
  v_and_b32_dpp v13, v29, v35 row_newbcast:4 row_mask:0xf bank_mask:0xf
  v_and_b32_dpp v14, v29, v36 row_newbcast:4 row_mask:0xf bank_mask:0xf
  v_and_b32_dpp v15, v29, v0 row_newbcast:4 row_mask:0xf bank_mask:0xf
  s_nop 1
  v_mfma_f32_16x16x32_bf16 v[8:11], v[12:15], v[56:59], v[8:11]
  s_call_b64 s[62:63], L_vs
  s_cbranch_scc0 L_dr10
  v_add_u32_dpp v3, v28, v38 row_newbcast:10 row_mask:0xf bank_mask:0xf
  buffer_load_dwordx4 v[80:83], v3, s[48:51], 0 offen nt
  v_and_b32_dpp v12, v29, v34 row_newbcast:5 row_mask:0xf bank_mask:0xf
  v_and_b32_dpp v13, v29, v35 row_newbcast:5 row_mask:0xf bank_mask:0xf
  v_and_b32_dpp v14, v29, v36 row_newbcast:5 row_mask:0xf bank_mask:0xf
  v_and_b32_dpp v15, v29, v0 row_newbcast:5 row_mask:0xf bank_mask:0xf
  s_nop 1
  v_mfma_f32_16x16x32_bf16 v[8:11], v[12:15], v[60:63], v[8:11]
  s_call_b64 s[62:63], L_vq
  s_cbranch_scc0 L_dr11
  v_add_u32_dpp v3, v28, v38 row_newbcast:11 row_mask:0xf bank_mask:0xf
  buffer_load_dwordx4 v[84:87], v3, s[48:51], 0 offen nt
  v_and_b32_dpp v12, v29, v34 row_newbcast:6 row_mask:0xf bank_mask:0xf
  v_and_b32_dpp v13, v29, v35 row_newbcast:6 row_mask:0xf bank_mask:0xf
  v_and_b32_dpp v14, v29, v36 row_newbcast:6 row_mask:0xf bank_mask:0xf
  v_and_b32_dpp v15, v29, v0 row_newbcast:6 row_mask:0xf bank_mask:0xf
  s_nop 1
  v_mfma_f32_16x16x32_bf16 v[8:11], v[12:15], v[64:67], v[8:11]
  s_call_b64 s[62:63], L_vq
  s_cbranch_scc0 L_dr12
  v_add_u32_dpp v3, v28, v38 row_newbcast:12 row_mask:0xf bank_mask:0xf
  buffer_load_dwordx4 v[88:91], v3, s[48:51], 0 offen nt
  v_and_b32_dpp v12, v29, v34 row_newbcast:7 row_mask:0xf bank_mask:0xf
  v_and_b32_dpp v13, v29, v35 row_newbcast:7 row_mask:0xf bank_mask:0xf
  v_and_b32_dpp v14, v29, v36 row_newbcast:7 row_mask:0xf bank_mask:0xf
  v_and_b32_dpp v15, v29, v0 row_newbcast:7 row_mask:0xf bank_mask:0xf
  s_nop 1
  v_mfma_f32_16x16x32_bf16 v[8:11], v[12:15], v[68:71], v[8:11]
  s_call_b64 s[62:63], L_vq
  s_cbranch_scc0 L_dr13
  v_add_u32_dpp v3, v28, v38 row_newbcast:13 row_mask:0xf bank_mask:0xf
  buffer_load_dwordx4 v[92:95], v3, s[48:51], 0 offen nt
  v_and_b32_dpp v12, v29, v34 row_newbcast:8 row_mask:0xf bank_mask:0xf
  v_and_b32_dpp v13, v29, v35 row_newbcast:8 row_mask:0xf bank_mask:0xf
  v_and_b32_dpp v14, v29, v36 row_newbcast:8 row_mask:0xf bank_mask:0xf
  v_and_b32_dpp v15, v29, v0 row_newbcast:8 row_mask:0xf bank_mask:0xf
  s_nop 1
  v_mfma_f32_16x16x32_bf16 v[8:11], v[12:15], v[72:75], v[8:11]
  s_call_b64 s[62:63], L_vq
  s_cbranch_scc0 L_dr14
  v_add_u32_dpp v3, v28, v38 row_newbcast:14 row_mask:0xf bank_mask:0xf
  buffer_load_dwordx4 v[96:99], v3, s[48:51], 0 offen nt
  v_and_b32_dpp v12, v29, v34 row_newbcast:9 row_mask:0xf bank_mask:0xf
  v_and_b32_dpp v13, v29, v35 row_newbcast:9 row_mask:0xf bank_mask:0xf
  v_and_b32_dpp v14, v29, v36 row_newbcast:9 row_mask:0xf bank_mask:0xf
  v_and_b32_dpp v15, v29, v0 row_newbcast:9 row_mask:0xf bank_mask:0xf
  s_nop 1
  v_mfma_f32_16x16x32_bf16 v[8:11], v[12:15], v[76:79], v[8:11]
  s_call_b64 s[62:63], L_vq
  s_cbranch_scc0 L_dr15
  v_add_u32_dpp v3, v28, v38 row_newbcast:15 row_mask:0xf bank_mask:0xf
  buffer_load_dwordx4 v[100:103], v3, s[48:51], 0 offen nt
  v_and_b32_dpp v12, v29, v34 row_newbcast:10 row_mask:0xf bank_mask:0xf
  v_and_b32_dpp v13, v29, v35 row_newbcast:10 row_mask:0xf bank_mask:0xf
  v_and_b32_dpp v14, v29, v36 row_newbcast:10 row_mask:0xf bank_mask:0xf
  v_and_b32_dpp v15, v29, v0 row_newbcast:10 row_mask:0xf bank_mask:0xf
  s_nop 1
  v_mfma_f32_16x16x32_bf16 v[8:11], v[12:15], v[80:83], v[8:11]
  s_call_b64 s[62:63], L_vq
  s_cbranch_scc0 L_dr16
  v_add_u32_dpp v3, v30, v38 row_newbcast:0 row_mask:0xf bank_mask:0xf
  buffer_load_dwordx4 v[104:107], v3, s[48:51], 0 offen nt
  v_and_b32_dpp v12, v29, v34 row_newbcast:11 row_mask:0xf bank_mask:0xf
  v_and_b32_dpp v13, v29, v35 row_newbcast:11 row_mask:0xf bank_mask:0xf
  v_and_b32_dpp v14, v29, v36 row_newbcast:11 row_mask:0xf bank_mask:0xf
  v_and_b32_dpp v15, v29, v0 row_newbcast:11 row_mask:0xf bank_mask:0xf
  s_nop 1
  v_mfma_f32_16x16x32_bf16 v[8:11], v[12:15], v[84:87], v[8:11]
  s_call_b64 s[62:63], L_vq
  s_cbranch_scc0 L_dr17
  v_add_u32_dpp v3, v30, v38 row_newbcast:1 row_mask:0xf bank_mask:0xf
  buffer_load_dwordx4 v[108:111], v3, s[48:51], 0 offen nt
  v_and_b32_dpp v12, v29, v34 row_newbcast:12 row_mask:0xf bank_mask:0xf
  v_and_b32_dpp v13, v29, v35 row_newbcast:12 row_mask:0xf bank_mask:0xf
  v_and_b32_dpp v14, v29, v36 row_newbcast:12 row_mask:0xf bank_mask:0xf
  v_and_b32_dpp v15, v29, v0 row_newbcast:12 row_mask:0xf bank_mask:0xf
  s_nop 1
  v_mfma_f32_16x16x32_bf16 v[8:11], v[12:15], v[88:91], v[8:11]
  s_call_b64 s[62:63], L_vq
  s_cbranch_scc0 L_dr18
  v_add_u32_dpp v3, v30, v38 row_newbcast:2 row_mask:0xf bank_mask:0xf
  buffer_load_dwordx4 v[112:115], v3, s[48:51], 0 offen nt
  v_and_b32_dpp v12, v29, v34 row_newbcast:13 row_mask:0xf bank_mask:0xf
  v_and_b32_dpp v13, v29, v35 row_newbcast:13 row_mask:0xf bank_mask:0xf
  v_and_b32_dpp v14, v29, v36 row_newbcast:13 row_mask:0xf bank_mask:0xf
  v_and_b32_dpp v15, v29, v0 row_newbcast:13 row_mask:0xf bank_mask:0xf
  s_nop 1
  v_mfma_f32_16x16x32_bf16 v[8:11], v[12:15], v[92:95], v[8:11]
  s_call_b64 s[62:63], L_vq
  s_cbranch_scc0 L_dr19
  v_add_u32_dpp v3, v30, v38 row_newbcast:3 row_mask:0xf bank_mask:0xf
  buffer_load_dwordx4 v[116:119], v3, s[48:51], 0 offen nt
  v_and_b32_dpp v12, v29, v34 row_newbcast:14 row_mask:0xf bank_mask:0xf
  v_and_b32_dpp v13, v29, v35 row_newbcast:14 row_mask:0xf bank_mask:0xf
  v_and_b32_dpp v14, v29, v36 row_newbcast:14 row_mask:0xf bank_mask:0xf
  v_and_b32_dpp v15, v29, v0 row_newbcast:14 row_mask:0xf bank_mask:0xf
  s_nop 1
  v_mfma_f32_16x16x32_bf16 v[8:11], v[12:15], v[96:99], v[8:11]
  s_call_b64 s[62:63], L_vq
  s_cbranch_scc0 L_dr20
  v_add_u32_dpp v3, v30, v38 row_newbcast:4 row_mask:0xf bank_mask:0xf
  buffer_load_dwordx4 v[120:123], v3, s[48:51], 0 offen nt
  v_and_b32_dpp v12, v29, v34 row_newbcast:15 row_mask:0xf bank_mask:0xf
  v_and_b32_dpp v13, v29, v35 row_newbcast:15 row_mask:0xf bank_mask:0xf
  v_and_b32_dpp v14, v29, v36 row_newbcast:15 row_mask:0xf bank_mask:0xf
  v_and_b32_dpp v15, v29, v0 row_newbcast:15 row_mask:0xf bank_mask:0xf
  s_nop 1
  v_mfma_f32_16x16x32_bf16 v[8:11], v[12:15], v[100:103], v[8:11]
  s_call_b64 s[62:63], L_vq
  s_cbranch_scc0 L_dr21
  v_add_u32_dpp v3, v30, v38 row_newbcast:5 row_mask:0xf bank_mask:0xf
  buffer_load_dwordx4 v[124:127], v3, s[48:51], 0 offen nt
  v_and_b32_dpp v12, v31, v34 row_newbcast:0 row_mask:0xf bank_mask:0xf
  v_and_b32_dpp v13, v31, v35 row_newbcast:0 row_mask:0xf bank_mask:0xf
  v_and_b32_dpp v14, v31, v36 row_newbcast:0 row_mask:0xf bank_mask:0xf
  v_and_b32_dpp v15, v31, v0 row_newbcast:0 row_mask:0xf bank_mask:0xf
  s_nop 1
  v_mfma_f32_16x16x32_bf16 v[8:11], v[12:15], v[104:107], v[8:11]
  s_call_b64 s[62:63], L_vq
  s_cbranch_scc0 L_dr22
  v_add_u32_dpp v3, v30, v38 row_newbcast:6 row_mask:0xf bank_mask:0xf
  buffer_load_dwordx4 v[128:131], v3, s[48:51], 0 offen nt
  v_and_b32_dpp v12, v31, v34 row_newbcast:1 row_mask:0xf bank_mask:0xf
  v_and_b32_dpp v13, v31, v35 row_newbcast:1 row_mask:0xf bank_mask:0xf
  v_and_b32_dpp v14, v31, v36 row_newbcast:1 row_mask:0xf bank_mask:0xf
  v_and_b32_dpp v15, v31, v0 row_newbcast:1 row_mask:0xf bank_mask:0xf
  s_nop 1
  v_mfma_f32_16x16x32_bf16 v[8:11], v[12:15], v[108:111], v[8:11]
  s_call_b64 s[62:63], L_vq
  s_cbranch_scc0 L_dr23
  v_add_u32_dpp v3, v30, v38 row_newbcast:7 row_mask:0xf bank_mask:0xf
  buffer_load_dwordx4 v[132:135], v3, s[48:51], 0 offen nt
  v_and_b32_dpp v12, v31, v34 row_newbcast:2 row_mask:0xf bank_mask:0xf
  v_and_b32_dpp v13, v31, v35 row_newbcast:2 row_mask:0xf bank_mask:0xf
  v_and_b32_dpp v14, v31, v36 row_newbcast:2 row_mask:0xf bank_mask:0xf
  v_and_b32_dpp v15, v31, v0 row_newbcast:2 row_mask:0xf bank_mask:0xf
  s_nop 1
  v_mfma_f32_16x16x32_bf16 v[8:11], v[12:15], v[112:115], v[8:11]
  s_call_b64 s[62:63], L_vq
  s_cbranch_scc0 L_dr24
  v_add_u32_dpp v3, v30, v38 row_newbcast:8 row_mask:0xf bank_mask:0xf
  buffer_load_dwordx4 v[136:139], v3, s[48:51], 0 offen nt
  v_and_b32_dpp v12, v31, v34 row_newbcast:3 row_mask:0xf bank_mask:0xf
  v_and_b32_dpp v13, v31, v35 row_newbcast:3 row_mask:0xf bank_mask:0xf
  v_and_b32_dpp v14, v31, v36 row_newbcast:3 row_mask:0xf bank_mask:0xf
  v_and_b32_dpp v15, v31, v0 row_newbcast:3 row_mask:0xf bank_mask:0xf
  s_nop 1
  v_mfma_f32_16x16x32_bf16 v[8:11], v[12:15], v[116:119], v[8:11]
  s_call_b64 s[62:63], L_vq
  s_cbranch_scc0 L_dr25
  v_add_u32_dpp v3, v30, v38 row_newbcast:9 row_mask:0xf bank_mask:0xf
  buffer_load_dwordx4 v[140:143], v3, s[48:51], 0 offen nt
  v_and_b32_dpp v12, v31, v34 row_newbcast:4 row_mask:0xf bank_mask:0xf
  v_and_b32_dpp v13, v31, v35 row_newbcast:4 row_mask:0xf bank_mask:0xf
  v_and_b32_dpp v14, v31, v36 row_newbcast:4 row_mask:0xf bank_mask:0xf
  v_and_b32_dpp v15, v31, v0 row_newbcast:4 row_mask:0xf bank_mask:0xf
  s_nop 1
  v_mfma_f32_16x16x32_bf16 v[8:11], v[12:15], v[120:123], v[8:11]
  s_call_b64 s[62:63], L_vq
  s_cbranch_scc0 L_dr26
  v_add_u32_dpp v3, v30, v38 row_newbcast:10 row_mask:0xf bank_mask:0xf
  buffer_load_dwordx4 v[144:147], v3, s[48:51], 0 offen nt
  v_and_b32_dpp v12, v31, v34 row_newbcast:5 row_mask:0xf bank_mask:0xf
  v_and_b32_dpp v13, v31, v35 row_newbcast:5 row_mask:0xf bank_mask:0xf
  v_and_b32_dpp v14, v31, v36 row_newbcast:5 row_mask:0xf bank_mask:0xf
  v_and_b32_dpp v15, v31, v0 row_newbcast:5 row_mask:0xf bank_mask:0xf
  s_nop 1
  v_mfma_f32_16x16x32_bf16 v[8:11], v[12:15], v[124:127], v[8:11]
  s_call_b64 s[62:63], L_vq
  s_cbranch_scc0 L_dr27
  v_add_u32_dpp v3, v30, v38 row_newbcast:11 row_mask:0xf bank_mask:0xf
  buffer_load_dwordx4 v[148:151], v3, s[48:51], 0 offen nt
  v_and_b32_dpp v12, v31, v34 row_newbcast:6 row_mask:0xf bank_mask:0xf
  v_and_b32_dpp v13, v31, v35 row_newbcast:6 row_mask:0xf bank_mask:0xf
  v_and_b32_dpp v14, v31, v36 row_newbcast:6 row_mask:0xf bank_mask:0xf
  v_and_b32_dpp v15, v31, v0 row_newbcast:6 row_mask:0xf bank_mask:0xf
  s_nop 1
  v_mfma_f32_16x16x32_bf16 v[8:11], v[12:15], v[128:131], v[8:11]
  s_call_b64 s[62:63], L_vq
  s_cbranch_scc0 L_dr28
  v_add_u32_dpp v3, v30, v38 row_newbcast:12 row_mask:0xf bank_mask:0xf
  buffer_load_dwordx4 v[152:155], v3, s[48:51], 0 offen nt
  v_and_b32_dpp v12, v31, v34 row_newbcast:7 row_mask:0xf bank_mask:0xf
  v_and_b32_dpp v13, v31, v35 row_newbcast:7 row_mask:0xf bank_mask:0xf
  v_and_b32_dpp v14, v31, v36 row_newbcast:7 row_mask:0xf bank_mask:0xf
  v_and_b32_dpp v15, v31, v0 row_newbcast:7 row_mask:0xf bank_mask:0xf
  s_nop 1
  v_mfma_f32_16x16x32_bf16 v[8:11], v[12:15], v[132:135], v[8:11]
  s_call_b64 s[62:63], L_vq
  s_cbranch_scc0 L_dr29
  v_add_u32_dpp v3, v30, v38 row_newbcast:13 row_mask:0xf bank_mask:0xf
  buffer_load_dwordx4 v[156:159], v3, s[48:51], 0 offen nt
  v_and_b32_dpp v12, v31, v34 row_newbcast:8 row_mask:0xf bank_mask:0xf
  v_and_b32_dpp v13, v31, v35 row_newbcast:8 row_mask:0xf bank_mask:0xf
  v_and_b32_dpp v14, v31, v36 row_newbcast:8 row_mask:0xf bank_mask:0xf
  v_and_b32_dpp v15, v31, v0 row_newbcast:8 row_mask:0xf bank_mask:0xf
  s_nop 1
  v_mfma_f32_16x16x32_bf16 v[8:11], v[12:15], v[136:139], v[8:11]
  s_call_b64 s[62:63], L_vq
  s_cbranch_scc0 L_dr30
  v_add_u32_dpp v3, v30, v38 row_newbcast:14 row_mask:0xf bank_mask:0xf
  buffer_load_dwordx4 v[160:163], v3, s[48:51], 0 offen nt
  v_and_b32_dpp v12, v31, v34 row_newbcast:9 row_mask:0xf bank_mask:0xf
  v_and_b32_dpp v13, v31, v35 row_newbcast:9 row_mask:0xf bank_mask:0xf
  v_and_b32_dpp v14, v31, v36 row_newbcast:9 row_mask:0xf bank_mask:0xf
  v_and_b32_dpp v15, v31, v0 row_newbcast:9 row_mask:0xf bank_mask:0xf
  s_nop 1
  v_mfma_f32_16x16x32_bf16 v[8:11], v[12:15], v[140:143], v[8:11]
  s_call_b64 s[62:63], L_vq
  s_cbranch_scc0 L_dr31
  v_add_u32_dpp v3, v30, v38 row_newbcast:15 row_mask:0xf bank_mask:0xf
  buffer_load_dwordx4 v[164:167], v3, s[48:51], 0 offen nt
  v_and_b32_dpp v12, v31, v34 row_newbcast:10 row_mask:0xf bank_mask:0xf
  v_and_b32_dpp v13, v31, v35 row_newbcast:10 row_mask:0xf bank_mask:0xf
  v_and_b32_dpp v14, v31, v36 row_newbcast:10 row_mask:0xf bank_mask:0xf
  v_and_b32_dpp v15, v31, v0 row_newbcast:10 row_mask:0xf bank_mask:0xf
  s_nop 1
  v_mfma_f32_16x16x32_bf16 v[8:11], v[12:15], v[144:147], v[8:11]
  s_call_b64 s[62:63], L_vq
  s_cbranch_scc0 L_dr32
  v_add_u32_dpp v3, v32, v38 row_newbcast:0 row_mask:0xf bank_mask:0xf
  buffer_load_dwordx4 v[40:43], v3, s[48:51], 0 offen nt
  v_and_b32_dpp v12, v31, v34 row_newbcast:11 row_mask:0xf bank_mask:0xf
  v_and_b32_dpp v13, v31, v35 row_newbcast:11 row_mask:0xf bank_mask:0xf
  v_and_b32_dpp v14, v31, v36 row_newbcast:11 row_mask:0xf bank_mask:0xf
  v_and_b32_dpp v15, v31, v0 row_newbcast:11 row_mask:0xf bank_mask:0xf
  s_nop 1
  v_mfma_f32_16x16x32_bf16 v[8:11], v[12:15], v[148:151], v[8:11]
  s_call_b64 s[62:63], L_vq
  s_cbranch_scc0 L_dr33
  v_add_u32_dpp v3, v32, v38 row_newbcast:1 row_mask:0xf bank_mask:0xf
  buffer_load_dwordx4 v[44:47], v3, s[48:51], 0 offen nt
  v_and_b32_dpp v12, v31, v34 row_newbcast:12 row_mask:0xf bank_mask:0xf
  v_and_b32_dpp v13, v31, v35 row_newbcast:12 row_mask:0xf bank_mask:0xf
  v_and_b32_dpp v14, v31, v36 row_newbcast:12 row_mask:0xf bank_mask:0xf
  v_and_b32_dpp v15, v31, v0 row_newbcast:12 row_mask:0xf bank_mask:0xf
  s_nop 1
  v_mfma_f32_16x16x32_bf16 v[8:11], v[12:15], v[152:155], v[8:11]
  s_call_b64 s[62:63], L_vq
  s_cbranch_scc0 L_dr34
  v_add_u32_dpp v3, v32, v38 row_newbcast:2 row_mask:0xf bank_mask:0xf
  buffer_load_dwordx4 v[48:51], v3, s[48:51], 0 offen nt
  v_and_b32_dpp v12, v31, v34 row_newbcast:13 row_mask:0xf bank_mask:0xf
  v_and_b32_dpp v13, v31, v35 row_newbcast:13 row_mask:0xf bank_mask:0xf
  v_and_b32_dpp v14, v31, v36 row_newbcast:13 row_mask:0xf bank_mask:0xf
  v_and_b32_dpp v15, v31, v0 row_newbcast:13 row_mask:0xf bank_mask:0xf
  s_nop 1
  v_mfma_f32_16x16x32_bf16 v[8:11], v[12:15], v[156:159], v[8:11]
  s_call_b64 s[62:63], L_vq
  s_cbranch_scc0 L_dr35
  v_add_u32_dpp v3, v32, v38 row_newbcast:3 row_mask:0xf bank_mask:0xf
  buffer_load_dwordx4 v[52:55], v3, s[48:51], 0 offen nt
  v_and_b32_dpp v12, v31, v34 row_newbcast:14 row_mask:0xf bank_mask:0xf
  v_and_b32_dpp v13, v31, v35 row_newbcast:14 row_mask:0xf bank_mask:0xf
  v_and_b32_dpp v14, v31, v36 row_newbcast:14 row_mask:0xf bank_mask:0xf
  v_and_b32_dpp v15, v31, v0 row_newbcast:14 row_mask:0xf bank_mask:0xf
  s_nop 1
  v_mfma_f32_16x16x32_bf16 v[8:11], v[12:15], v[160:163], v[8:11]
  s_call_b64 s[62:63], L_vq
  s_cbranch_scc0 L_dr36
  v_add_u32_dpp v3, v32, v38 row_newbcast:4 row_mask:0xf bank_mask:0xf
  buffer_load_dwordx4 v[56:59], v3, s[48:51], 0 offen nt
  v_and_b32_dpp v12, v31, v34 row_newbcast:15 row_mask:0xf bank_mask:0xf
  v_and_b32_dpp v13, v31, v35 row_newbcast:15 row_mask:0xf bank_mask:0xf
  v_and_b32_dpp v14, v31, v36 row_newbcast:15 row_mask:0xf bank_mask:0xf
  v_and_b32_dpp v15, v31, v0 row_newbcast:15 row_mask:0xf bank_mask:0xf
  s_nop 1
  v_mfma_f32_16x16x32_bf16 v[8:11], v[12:15], v[164:167], v[8:11]
  s_call_b64 s[62:63], L_vq
  s_cbranch_scc0 L_dr37
  v_add_u32_dpp v3, v32, v38 row_newbcast:5 row_mask:0xf bank_mask:0xf
  buffer_load_dwordx4 v[60:63], v3, s[48:51], 0 offen nt
  v_and_b32_dpp v12, v33, v34 row_newbcast:0 row_mask:0xf bank_mask:0xf
  v_and_b32_dpp v13, v33, v35 row_newbcast:0 row_mask:0xf bank_mask:0xf
  v_and_b32_dpp v14, v33, v36 row_newbcast:0 row_mask:0xf bank_mask:0xf
  v_and_b32_dpp v15, v33, v0 row_newbcast:0 row_mask:0xf bank_mask:0xf
  s_nop 1
  v_mfma_f32_16x16x32_bf16 v[8:11], v[12:15], v[40:43], v[8:11]
  s_call_b64 s[62:63], L_vq
  s_branch L_dr38
L_dr5:
  v_and_b32_dpp v12, v29, v34 row_newbcast:0 row_mask:0xf bank_mask:0xf
  v_and_b32_dpp v13, v29, v35 row_newbcast:0 row_mask:0xf bank_mask:0xf
  v_and_b32_dpp v14, v29, v36 row_newbcast:0 row_mask:0xf bank_mask:0xf
  v_and_b32_dpp v15, v29, v0 row_newbcast:0 row_mask:0xf bank_mask:0xf
  s_nop 1
  v_mfma_f32_16x16x32_bf16 v[8:11], v[12:15], v[40:43], v[8:11]
  s_cmp_eq_u32 s75, 6
  s_cbranch_scc1 L_epi
L_dr6:
  v_and_b32_dpp v12, v29, v34 row_newbcast:1 row_mask:0xf bank_mask:0xf
  v_and_b32_dpp v13, v29, v35 row_newbcast:1 row_mask:0xf bank_mask:0xf
  v_and_b32_dpp v14, v29, v36 row_newbcast:1 row_mask:0xf bank_mask:0xf
  v_and_b32_dpp v15, v29, v0 row_newbcast:1 row_mask:0xf bank_mask:0xf
  s_nop 1
  v_mfma_f32_16x16x32_bf16 v[8:11], v[12:15], v[44:47], v[8:11]
  s_cmp_eq_u32 s75, 7
  s_cbranch_scc1 L_epi
L_dr7:
  v_and_b32_dpp v12, v29, v34 row_newbcast:2 row_mask:0xf bank_mask:0xf
  v_and_b32_dpp v13, v29, v35 row_newbcast:2 row_mask:0xf bank_mask:0xf
  v_and_b32_dpp v14, v29, v36 row_newbcast:2 row_mask:0xf bank_mask:0xf
  v_and_b32_dpp v15, v29, v0 row_newbcast:2 row_mask:0xf bank_mask:0xf
  s_nop 1
  v_mfma_f32_16x16x32_bf16 v[8:11], v[12:15], v[48:51], v[8:11]
  s_cmp_eq_u32 s75, 8
  s_cbranch_scc1 L_epi
L_dr8:
  v_and_b32_dpp v12, v29, v34 row_newbcast:3 row_mask:0xf bank_mask:0xf
  v_and_b32_dpp v13, v29, v35 row_newbcast:3 row_mask:0xf bank_mask:0xf
  v_and_b32_dpp v14, v29, v36 row_newbcast:3 row_mask:0xf bank_mask:0xf
  v_and_b32_dpp v15, v29, v0 row_newbcast:3 row_mask:0xf bank_mask:0xf
  s_nop 1
  v_mfma_f32_16x16x32_bf16 v[8:11], v[12:15], v[52:55], v[8:11]
  s_cmp_eq_u32 s75, 9
  s_cbranch_scc1 L_epi
L_dr9:
  v_and_b32_dpp v12, v29, v34 row_newbcast:4 row_mask:0xf bank_mask:0xf
  v_and_b32_dpp v13, v29, v35 row_newbcast:4 row_mask:0xf bank_mask:0xf
  v_and_b32_dpp v14, v29, v36 row_newbcast:4 row_mask:0xf bank_mask:0xf
  v_and_b32_dpp v15, v29, v0 row_newbcast:4 row_mask:0xf bank_mask:0xf
  s_nop 1
  v_mfma_f32_16x16x32_bf16 v[8:11], v[12:15], v[56:59], v[8:11]
  s_cmp_eq_u32 s75, 10
  s_cbranch_scc1 L_epi
L_dr10:
  v_and_b32_dpp v12, v29, v34 row_newbcast:5 row_mask:0xf bank_mask:0xf
  v_and_b32_dpp v13, v29, v35 row_newbcast:5 row_mask:0xf bank_mask:0xf
  v_and_b32_dpp v14, v29, v36 row_newbcast:5 row_mask:0xf bank_mask:0xf
  v_and_b32_dpp v15, v29, v0 row_newbcast:5 row_mask:0xf bank_mask:0xf
  s_nop 1
  v_mfma_f32_16x16x32_bf16 v[8:11], v[12:15], v[60:63], v[8:11]
  s_cmp_eq_u32 s75, 11
  s_cbranch_scc1 L_epi
L_dr11:
  v_and_b32_dpp v12, v29, v34 row_newbcast:6 row_mask:0xf bank_mask:0xf
  v_and_b32_dpp v13, v29, v35 row_newbcast:6 row_mask:0xf bank_mask:0xf
  v_and_b32_dpp v14, v29, v36 row_newbcast:6 row_mask:0xf bank_mask:0xf
  v_and_b32_dpp v15, v29, v0 row_newbcast:6 row_mask:0xf bank_mask:0xf
  s_nop 1
  v_mfma_f32_16x16x32_bf16 v[8:11], v[12:15], v[64:67], v[8:11]
  s_cmp_eq_u32 s75, 12
  s_cbranch_scc1 L_epi
L_dr12:
  v_and_b32_dpp v12, v29, v34 row_newbcast:7 row_mask:0xf bank_mask:0xf
  v_and_b32_dpp v13, v29, v35 row_newbcast:7 row_mask:0xf bank_mask:0xf
  v_and_b32_dpp v14, v29, v36 row_newbcast:7 row_mask:0xf bank_mask:0xf
  v_and_b32_dpp v15, v29, v0 row_newbcast:7 row_mask:0xf bank_mask:0xf
  s_nop 1
  v_mfma_f32_16x16x32_bf16 v[8:11], v[12:15], v[68:71], v[8:11]
  s_cmp_eq_u32 s75, 13
  s_cbranch_scc1 L_epi
L_dr13:
  v_and_b32_dpp v12, v29, v34 row_newbcast:8 row_mask:0xf bank_mask:0xf
  v_and_b32_dpp v13, v29, v35 row_newbcast:8 row_mask:0xf bank_mask:0xf
  v_and_b32_dpp v14, v29, v36 row_newbcast:8 row_mask:0xf bank_mask:0xf
  v_and_b32_dpp v15, v29, v0 row_newbcast:8 row_mask:0xf bank_mask:0xf
  s_nop 1
  v_mfma_f32_16x16x32_bf16 v[8:11], v[12:15], v[72:75], v[8:11]
  s_cmp_eq_u32 s75, 14
  s_cbranch_scc1 L_epi
L_dr14:
  v_and_b32_dpp v12, v29, v34 row_newbcast:9 row_mask:0xf bank_mask:0xf
  v_and_b32_dpp v13, v29, v35 row_newbcast:9 row_mask:0xf bank_mask:0xf
  v_and_b32_dpp v14, v29, v36 row_newbcast:9 row_mask:0xf bank_mask:0xf
  v_and_b32_dpp v15, v29, v0 row_newbcast:9 row_mask:0xf bank_mask:0xf
  s_nop 1
  v_mfma_f32_16x16x32_bf16 v[8:11], v[12:15], v[76:79], v[8:11]
  s_cmp_eq_u32 s75, 15
  s_cbranch_scc1 L_epi
L_dr15:
  v_and_b32_dpp v12, v29, v34 row_newbcast:10 row_mask:0xf bank_mask:0xf
  v_and_b32_dpp v13, v29, v35 row_newbcast:10 row_mask:0xf bank_mask:0xf
  v_and_b32_dpp v14, v29, v36 row_newbcast:10 row_mask:0xf bank_mask:0xf
  v_and_b32_dpp v15, v29, v0 row_newbcast:10 row_mask:0xf bank_mask:0xf
  s_nop 1
  v_mfma_f32_16x16x32_bf16 v[8:11], v[12:15], v[80:83], v[8:11]
  s_cmp_eq_u32 s75, 16
  s_cbranch_scc1 L_epi
L_dr16:
  v_and_b32_dpp v12, v29, v34 row_newbcast:11 row_mask:0xf bank_mask:0xf
  v_and_b32_dpp v13, v29, v35 row_newbcast:11 row_mask:0xf bank_mask:0xf
  v_and_b32_dpp v14, v29, v36 row_newbcast:11 row_mask:0xf bank_mask:0xf
  v_and_b32_dpp v15, v29, v0 row_newbcast:11 row_mask:0xf bank_mask:0xf
  s_nop 1
  v_mfma_f32_16x16x32_bf16 v[8:11], v[12:15], v[84:87], v[8:11]
  s_cmp_eq_u32 s75, 17
  s_cbranch_scc1 L_epi
L_dr17:
  v_and_b32_dpp v12, v29, v34 row_newbcast:12 row_mask:0xf bank_mask:0xf
  v_and_b32_dpp v13, v29, v35 row_newbcast:12 row_mask:0xf bank_mask:0xf
  v_and_b32_dpp v14, v29, v36 row_newbcast:12 row_mask:0xf bank_mask:0xf
  v_and_b32_dpp v15, v29, v0 row_newbcast:12 row_mask:0xf bank_mask:0xf
  s_nop 1
  v_mfma_f32_16x16x32_bf16 v[8:11], v[12:15], v[88:91], v[8:11]
  s_cmp_eq_u32 s75, 18
  s_cbranch_scc1 L_epi
L_dr18:
  v_and_b32_dpp v12, v29, v34 row_newbcast:13 row_mask:0xf bank_mask:0xf
  v_and_b32_dpp v13, v29, v35 row_newbcast:13 row_mask:0xf bank_mask:0xf
  v_and_b32_dpp v14, v29, v36 row_newbcast:13 row_mask:0xf bank_mask:0xf
  v_and_b32_dpp v15, v29, v0 row_newbcast:13 row_mask:0xf bank_mask:0xf
  s_nop 1
  v_mfma_f32_16x16x32_bf16 v[8:11], v[12:15], v[92:95], v[8:11]
  s_cmp_eq_u32 s75, 19
  s_cbranch_scc1 L_epi
L_dr19:
  v_and_b32_dpp v12, v29, v34 row_newbcast:14 row_mask:0xf bank_mask:0xf
  v_and_b32_dpp v13, v29, v35 row_newbcast:14 row_mask:0xf bank_mask:0xf
  v_and_b32_dpp v14, v29, v36 row_newbcast:14 row_mask:0xf bank_mask:0xf
  v_and_b32_dpp v15, v29, v0 row_newbcast:14 row_mask:0xf bank_mask:0xf
  s_nop 1
  v_mfma_f32_16x16x32_bf16 v[8:11], v[12:15], v[96:99], v[8:11]
  s_cmp_eq_u32 s75, 20
  s_cbranch_scc1 L_epi
L_dr20:
  v_and_b32_dpp v12, v29, v34 row_newbcast:15 row_mask:0xf bank_mask:0xf
  v_and_b32_dpp v13, v29, v35 row_newbcast:15 row_mask:0xf bank_mask:0xf
  v_and_b32_dpp v14, v29, v36 row_newbcast:15 row_mask:0xf bank_mask:0xf
  v_and_b32_dpp v15, v29, v0 row_newbcast:15 row_mask:0xf bank_mask:0xf
  s_nop 1
  v_mfma_f32_16x16x32_bf16 v[8:11], v[12:15], v[100:103], v[8:11]
  s_cmp_eq_u32 s75, 21
  s_cbranch_scc1 L_epi
L_dr21:
  v_and_b32_dpp v12, v31, v34 row_newbcast:0 row_mask:0xf bank_mask:0xf
  v_and_b32_dpp v13, v31, v35 row_newbcast:0 row_mask:0xf bank_mask:0xf
  v_and_b32_dpp v14, v31, v36 row_newbcast:0 row_mask:0xf bank_mask:0xf
  v_and_b32_dpp v15, v31, v0 row_newbcast:0 row_mask:0xf bank_mask:0xf
  s_nop 1
  v_mfma_f32_16x16x32_bf16 v[8:11], v[12:15], v[104:107], v[8:11]
  s_cmp_eq_u32 s75, 22
  s_cbranch_scc1 L_epi
L_dr22:
  v_and_b32_dpp v12, v31, v34 row_newbcast:1 row_mask:0xf bank_mask:0xf
  v_and_b32_dpp v13, v31, v35 row_newbcast:1 row_mask:0xf bank_mask:0xf
  v_and_b32_dpp v14, v31, v36 row_newbcast:1 row_mask:0xf bank_mask:0xf
  v_and_b32_dpp v15, v31, v0 row_newbcast:1 row_mask:0xf bank_mask:0xf
  s_nop 1
  v_mfma_f32_16x16x32_bf16 v[8:11], v[12:15], v[108:111], v[8:11]
  s_cmp_eq_u32 s75, 23
  s_cbranch_scc1 L_epi
L_dr23:
  v_and_b32_dpp v12, v31, v34 row_newbcast:2 row_mask:0xf bank_mask:0xf
  v_and_b32_dpp v13, v31, v35 row_newbcast:2 row_mask:0xf bank_mask:0xf
  v_and_b32_dpp v14, v31, v36 row_newbcast:2 row_mask:0xf bank_mask:0xf
  v_and_b32_dpp v15, v31, v0 row_newbcast:2 row_mask:0xf bank_mask:0xf
  s_nop 1
  v_mfma_f32_16x16x32_bf16 v[8:11], v[12:15], v[112:115], v[8:11]
  s_cmp_eq_u32 s75, 24
  s_cbranch_scc1 L_epi
L_dr24:
  v_and_b32_dpp v12, v31, v34 row_newbcast:3 row_mask:0xf bank_mask:0xf
  v_and_b32_dpp v13, v31, v35 row_newbcast:3 row_mask:0xf bank_mask:0xf
  v_and_b32_dpp v14, v31, v36 row_newbcast:3 row_mask:0xf bank_mask:0xf
  v_and_b32_dpp v15, v31, v0 row_newbcast:3 row_mask:0xf bank_mask:0xf
  s_nop 1
  v_mfma_f32_16x16x32_bf16 v[8:11], v[12:15], v[116:119], v[8:11]
  s_cmp_eq_u32 s75, 25
  s_cbranch_scc1 L_epi
L_dr25:
  v_and_b32_dpp v12, v31, v34 row_newbcast:4 row_mask:0xf bank_mask:0xf
  v_and_b32_dpp v13, v31, v35 row_newbcast:4 row_mask:0xf bank_mask:0xf
  v_and_b32_dpp v14, v31, v36 row_newbcast:4 row_mask:0xf bank_mask:0xf
  v_and_b32_dpp v15, v31, v0 row_newbcast:4 row_mask:0xf bank_mask:0xf
  s_nop 1
  v_mfma_f32_16x16x32_bf16 v[8:11], v[12:15], v[120:123], v[8:11]
  s_cmp_eq_u32 s75, 26
  s_cbranch_scc1 L_epi
L_dr26:
  v_and_b32_dpp v12, v31, v34 row_newbcast:5 row_mask:0xf bank_mask:0xf
  v_and_b32_dpp v13, v31, v35 row_newbcast:5 row_mask:0xf bank_mask:0xf
  v_and_b32_dpp v14, v31, v36 row_newbcast:5 row_mask:0xf bank_mask:0xf
  v_and_b32_dpp v15, v31, v0 row_newbcast:5 row_mask:0xf bank_mask:0xf
  s_nop 1
  v_mfma_f32_16x16x32_bf16 v[8:11], v[12:15], v[124:127], v[8:11]
  s_cmp_eq_u32 s75, 27
  s_cbranch_scc1 L_epi
L_dr27:
  v_and_b32_dpp v12, v31, v34 row_newbcast:6 row_mask:0xf bank_mask:0xf
  v_and_b32_dpp v13, v31, v35 row_newbcast:6 row_mask:0xf bank_mask:0xf
  v_and_b32_dpp v14, v31, v36 row_newbcast:6 row_mask:0xf bank_mask:0xf
  v_and_b32_dpp v15, v31, v0 row_newbcast:6 row_mask:0xf bank_mask:0xf
  s_nop 1
  v_mfma_f32_16x16x32_bf16 v[8:11], v[12:15], v[128:131], v[8:11]
  s_cmp_eq_u32 s75, 28
  s_cbranch_scc1 L_epi
L_dr28:
  v_and_b32_dpp v12, v31, v34 row_newbcast:7 row_mask:0xf bank_mask:0xf
  v_and_b32_dpp v13, v31, v35 row_newbcast:7 row_mask:0xf bank_mask:0xf
  v_and_b32_dpp v14, v31, v36 row_newbcast:7 row_mask:0xf bank_mask:0xf
  v_and_b32_dpp v15, v31, v0 row_newbcast:7 row_mask:0xf bank_mask:0xf
  s_nop 1
  v_mfma_f32_16x16x32_bf16 v[8:11], v[12:15], v[132:135], v[8:11]
  s_cmp_eq_u32 s75, 29
  s_cbranch_scc1 L_epi
L_dr29:
  v_and_b32_dpp v12, v31, v34 row_newbcast:8 row_mask:0xf bank_mask:0xf
  v_and_b32_dpp v13, v31, v35 row_newbcast:8 row_mask:0xf bank_mask:0xf
  v_and_b32_dpp v14, v31, v36 row_newbcast:8 row_mask:0xf bank_mask:0xf
  v_and_b32_dpp v15, v31, v0 row_newbcast:8 row_mask:0xf bank_mask:0xf
  s_nop 1
  v_mfma_f32_16x16x32_bf16 v[8:11], v[12:15], v[136:139], v[8:11]
  s_cmp_eq_u32 s75, 30
  s_cbranch_scc1 L_epi
L_dr30:
  v_and_b32_dpp v12, v31, v34 row_newbcast:9 row_mask:0xf bank_mask:0xf
  v_and_b32_dpp v13, v31, v35 row_newbcast:9 row_mask:0xf bank_mask:0xf
  v_and_b32_dpp v14, v31, v36 row_newbcast:9 row_mask:0xf bank_mask:0xf
  v_and_b32_dpp v15, v31, v0 row_newbcast:9 row_mask:0xf bank_mask:0xf
  s_nop 1
  v_mfma_f32_16x16x32_bf16 v[8:11], v[12:15], v[140:143], v[8:11]
  s_cmp_eq_u32 s75, 31
  s_cbranch_scc1 L_epi
L_dr31:
  v_and_b32_dpp v12, v31, v34 row_newbcast:10 row_mask:0xf bank_mask:0xf
  v_and_b32_dpp v13, v31, v35 row_newbcast:10 row_mask:0xf bank_mask:0xf
  v_and_b32_dpp v14, v31, v36 row_newbcast:10 row_mask:0xf bank_mask:0xf
  v_and_b32_dpp v15, v31, v0 row_newbcast:10 row_mask:0xf bank_mask:0xf
  s_nop 1
  v_mfma_f32_16x16x32_bf16 v[8:11], v[12:15], v[144:147], v[8:11]
  s_cmp_eq_u32 s75, 32
  s_cbranch_scc1 L_epi
L_dr32:
  v_and_b32_dpp v12, v31, v34 row_newbcast:11 row_mask:0xf bank_mask:0xf
  v_and_b32_dpp v13, v31, v35 row_newbcast:11 row_mask:0xf bank_mask:0xf
  v_and_b32_dpp v14, v31, v36 row_newbcast:11 row_mask:0xf bank_mask:0xf
  v_and_b32_dpp v15, v31, v0 row_newbcast:11 row_mask:0xf bank_mask:0xf
  s_nop 1
  v_mfma_f32_16x16x32_bf16 v[8:11], v[12:15], v[148:151], v[8:11]
  s_cmp_eq_u32 s75, 33
  s_cbranch_scc1 L_epi
L_dr33:
  v_and_b32_dpp v12, v31, v34 row_newbcast:12 row_mask:0xf bank_mask:0xf
  v_and_b32_dpp v13, v31, v35 row_newbcast:12 row_mask:0xf bank_mask:0xf
  v_and_b32_dpp v14, v31, v36 row_newbcast:12 row_mask:0xf bank_mask:0xf
  v_and_b32_dpp v15, v31, v0 row_newbcast:12 row_mask:0xf bank_mask:0xf
  s_nop 1
  v_mfma_f32_16x16x32_bf16 v[8:11], v[12:15], v[152:155], v[8:11]
  s_cmp_eq_u32 s75, 34
  s_cbranch_scc1 L_epi
L_dr34:
  v_and_b32_dpp v12, v31, v34 row_newbcast:13 row_mask:0xf bank_mask:0xf
  v_and_b32_dpp v13, v31, v35 row_newbcast:13 row_mask:0xf bank_mask:0xf
  v_and_b32_dpp v14, v31, v36 row_newbcast:13 row_mask:0xf bank_mask:0xf
  v_and_b32_dpp v15, v31, v0 row_newbcast:13 row_mask:0xf bank_mask:0xf
  s_nop 1
  v_mfma_f32_16x16x32_bf16 v[8:11], v[12:15], v[156:159], v[8:11]
  s_cmp_eq_u32 s75, 35
  s_cbranch_scc1 L_epi
L_dr35:
  v_and_b32_dpp v12, v31, v34 row_newbcast:14 row_mask:0xf bank_mask:0xf
  v_and_b32_dpp v13, v31, v35 row_newbcast:14 row_mask:0xf bank_mask:0xf
  v_and_b32_dpp v14, v31, v36 row_newbcast:14 row_mask:0xf bank_mask:0xf
  v_and_b32_dpp v15, v31, v0 row_newbcast:14 row_mask:0xf bank_mask:0xf
  s_nop 1
  v_mfma_f32_16x16x32_bf16 v[8:11], v[12:15], v[160:163], v[8:11]
  s_cmp_eq_u32 s75, 36
  s_cbranch_scc1 L_epi
L_dr36:
  v_and_b32_dpp v12, v31, v34 row_newbcast:15 row_mask:0xf bank_mask:0xf
  v_and_b32_dpp v13, v31, v35 row_newbcast:15 row_mask:0xf bank_mask:0xf
  v_and_b32_dpp v14, v31, v36 row_newbcast:15 row_mask:0xf bank_mask:0xf
  v_and_b32_dpp v15, v31, v0 row_newbcast:15 row_mask:0xf bank_mask:0xf
  s_nop 1
  v_mfma_f32_16x16x32_bf16 v[8:11], v[12:15], v[164:167], v[8:11]
  s_cmp_eq_u32 s75, 37
  s_cbranch_scc1 L_epi
L_dr37:
  v_and_b32_dpp v12, v33, v34 row_newbcast:0 row_mask:0xf bank_mask:0xf
  v_and_b32_dpp v13, v33, v35 row_newbcast:0 row_mask:0xf bank_mask:0xf
  v_and_b32_dpp v14, v33, v36 row_newbcast:0 row_mask:0xf bank_mask:0xf
  v_and_b32_dpp v15, v33, v0 row_newbcast:0 row_mask:0xf bank_mask:0xf
  s_nop 1
  v_mfma_f32_16x16x32_bf16 v[8:11], v[12:15], v[40:43], v[8:11]
  s_cmp_eq_u32 s75, 38
  s_cbranch_scc1 L_epi
L_dr38:
  v_and_b32_dpp v12, v33, v34 row_newbcast:1 row_mask:0xf bank_mask:0xf
  v_and_b32_dpp v13, v33, v35 row_newbcast:1 row_mask:0xf bank_mask:0xf
  v_and_b32_dpp v14, v33, v36 row_newbcast:1 row_mask:0xf bank_mask:0xf
  v_and_b32_dpp v15, v33, v0 row_newbcast:1 row_mask:0xf bank_mask:0xf
  s_nop 1
  v_mfma_f32_16x16x32_bf16 v[8:11], v[12:15], v[44:47], v[8:11]
  s_cmp_eq_u32 s75, 39
  s_cbranch_scc1 L_epi
L_dr39:
  v_and_b32_dpp v12, v33, v34 row_newbcast:2 row_mask:0xf bank_mask:0xf
  v_and_b32_dpp v13, v33, v35 row_newbcast:2 row_mask:0xf bank_mask:0xf
  v_and_b32_dpp v14, v33, v36 row_newbcast:2 row_mask:0xf bank_mask:0xf
  v_and_b32_dpp v15, v33, v0 row_newbcast:2 row_mask:0xf bank_mask:0xf
  s_nop 1
  v_mfma_f32_16x16x32_bf16 v[8:11], v[12:15], v[48:51], v[8:11]
  s_cmp_eq_u32 s75, 40
  s_cbranch_scc1 L_epi
L_dr40:
  v_and_b32_dpp v12, v33, v34 row_newbcast:3 row_mask:0xf bank_mask:0xf
  v_and_b32_dpp v13, v33, v35 row_newbcast:3 row_mask:0xf bank_mask:0xf
  v_and_b32_dpp v14, v33, v36 row_newbcast:3 row_mask:0xf bank_mask:0xf
  v_and_b32_dpp v15, v33, v0 row_newbcast:3 row_mask:0xf bank_mask:0xf
  s_nop 1
  v_mfma_f32_16x16x32_bf16 v[8:11], v[12:15], v[52:55], v[8:11]
  s_cmp_eq_u32 s75, 41
  s_cbranch_scc1 L_epi
L_dr41:
  v_and_b32_dpp v12, v33, v34 row_newbcast:4 row_mask:0xf bank_mask:0xf
  v_and_b32_dpp v13, v33, v35 row_newbcast:4 row_mask:0xf bank_mask:0xf
  v_and_b32_dpp v14, v33, v36 row_newbcast:4 row_mask:0xf bank_mask:0xf
  v_and_b32_dpp v15, v33, v0 row_newbcast:4 row_mask:0xf bank_mask:0xf
  s_nop 1
  v_mfma_f32_16x16x32_bf16 v[8:11], v[12:15], v[56:59], v[8:11]
  s_cmp_eq_u32 s75, 42
  s_cbranch_scc1 L_epi
L_dr42:
  v_and_b32_dpp v12, v33, v34 row_newbcast:5 row_mask:0xf bank_mask:0xf
  v_and_b32_dpp v13, v33, v35 row_newbcast:5 row_mask:0xf bank_mask:0xf
  v_and_b32_dpp v14, v33, v36 row_newbcast:5 row_mask:0xf bank_mask:0xf
  v_and_b32_dpp v15, v33, v0 row_newbcast:5 row_mask:0xf bank_mask:0xf
  s_nop 1
  v_mfma_f32_16x16x32_bf16 v[8:11], v[12:15], v[60:63], v[8:11]
  s_cmp_eq_u32 s75, 43
  s_cbranch_scc1 L_epi
L_epi:
  v_lshrrev_b32 v3, 4, v1
  v_lshl_add_u32 v21, v3, 3, v39
  v_add_u32 v21, s11, v21
  v_mov_b32 v3, 1
  s_nop 3
  v_pk_add_f32 v[8:9], v[8:9], v[4:5]
  v_pk_add_f32 v[10:11], v[10:11], v[6:7]
  s_mov_b32 exec_hi, 0
  ds_write_b128 v21, v[8:11] offset:1024
  s_cmp_eq_u32 s21, 0
  s_cbranch_scc1 L_ep2
  s_mov_b32 exec_hi, 0
  ds_write_b128 v21, v[8:11] offset:6656
  s_mov_b64 exec, 1
  ds_add_u32 v1, v3 offset:304
  s_mov_b64 exec, -1
L_ep2:
  s_mov_b64 exec, 1
  ds_add_rtn_u32 v3, v1, v3 offset:308
  s_mov_b64 exec, -1
  v_mov_b32 v4, 0
  ds_read_b32 v5, v4 offset:256
  s_waitcnt lgkmcnt(0)
  v_readfirstlane_b32 s68, v3
  s_cmp_lg_u32 s68, 10
  s_cbranch_scc1 L_send
  s_cmp_eq_u32 s7, 2
  s_cbranch_scc1 L_send
  v_cmp_eq_u32 vcc, -1, v5
  s_cmp_eq_u64 vcc, 0
  s_cbranch_scc1 L_ep3
  s_mov_b32 s70, 0
L_pl_1:
  ds_read_b32 v5, v4 offset:256
  s_waitcnt lgkmcnt(0)
  v_cmp_eq_u32 vcc, -1, v5
  s_cmp_eq_u64 vcc, 0
  s_cbranch_scc1 L_pld_2
  s_sleep 1
  s_add_u32 s70, s70, 1
  s_cmp_lt_u32 s70, 1048576
  s_cbranch_scc1 L_pl_1
L_pld_2:
L_ep3:
  v_lshlrev_b32 v74, 3, v1
  ds_read_b128 v[62:65], v4 offset:384
  ds_read_b128 v[66:69], v4 offset:400
  ds_read_b128 v[70:73], v4 offset:416
  ds_read_b64 v[40:41], v74 offset:1024
  ds_read_b64 v[42:43], v74 offset:1536
  ds_read_b64 v[44:45], v74 offset:2048
  ds_read_b64 v[46:47], v74 offset:2560
  ds_read_b64 v[48:49], v74 offset:3072
  ds_read_b64 v[50:51], v74 offset:3584
  ds_read_b64 v[52:53], v74 offset:4096
  ds_read_b64 v[54:55], v74 offset:4608
  ds_read_b64 v[56:57], v74 offset:5120
  ds_read_b64 v[58:59], v74 offset:5632
  ds_read_b64 v[60:61], v74 offset:6144
  s_lshl_b32 s68, s6, 2
  s_add_u32 s68, s68, s7
  s_lshl_b32 s68, s68, 9
  s_add_u32 s68, s68, 524288
  v_add_u32 v74, s68, v74
  v_and_b32 v75, 1, v1
  v_lshlrev_b32 v75, 4, v75
  v_lshrrev_b32 v75, v75, s74
  v_lshrrev_b32 v76, 8, v75
  s_movk_i32 s69, 0xff
  s_waitcnt lgkmcnt(10)
  v_pk_mul_f32 v[40:41], v[40:41], v[62:63] op_sel:[0,0] op_sel_hi:[1,0]
  s_waitcnt lgkmcnt(9)
  v_pk_mul_f32 v[42:43], v[42:43], v[62:63] op_sel:[0,1] op_sel_hi:[1,1]
  s_waitcnt lgkmcnt(8)
  v_pk_fma_f32 v[40:41], v[44:45], v[64:65], v[40:41] op_sel:[0,0,0] op_sel_hi:[1,0,1]
  s_waitcnt lgkmcnt(7)
  v_pk_fma_f32 v[42:43], v[46:47], v[64:65], v[42:43] op_sel:[0,1,0] op_sel_hi:[1,1,1]
  s_waitcnt lgkmcnt(6)
  v_pk_fma_f32 v[40:41], v[48:49], v[66:67], v[40:41] op_sel:[0,0,0] op_sel_hi:[1,0,1]
  s_waitcnt lgkmcnt(5)
  v_pk_fma_f32 v[42:43], v[50:51], v[66:67], v[42:43] op_sel:[0,1,0] op_sel_hi:[1,1,1]
  s_waitcnt lgkmcnt(4)
  v_pk_fma_f32 v[40:41], v[52:53], v[68:69], v[40:41] op_sel:[0,0,0] op_sel_hi:[1,0,1]
  s_waitcnt lgkmcnt(3)
  v_pk_fma_f32 v[42:43], v[54:55], v[68:69], v[42:43] op_sel:[0,1,0] op_sel_hi:[1,1,1]
  s_waitcnt lgkmcnt(2)
  v_pk_fma_f32 v[40:41], v[56:57], v[70:71], v[40:41] op_sel:[0,0,0] op_sel_hi:[1,0,1]
  s_waitcnt lgkmcnt(1)
  v_pk_fma_f32 v[42:43], v[58:59], v[70:71], v[42:43] op_sel:[0,1,0] op_sel_hi:[1,1,1]
  s_waitcnt lgkmcnt(0)
  v_pk_fma_f32 v[40:41], v[60:61], v[72:73], v[40:41] op_sel:[0,0,0] op_sel_hi:[1,0,1]
  v_pk_add_f32 v[40:41], v[40:41], v[42:43]
  v_bfi_b32 v40, s69, v75, v40
  v_bfi_b32 v41, s69, v76, v41
  global_store_dwordx2 v74, v[40:41], s[42:43] sc1
L_send:
  s_endpgm
L_ks:
  s_cmp_ge_u32 s39, 4
  s_cbranch_scc1 L_kq
  s_call_b64 s[100:101], L_work
L_kq:
  v_readfirstlane_b32 s78, v22
  v_readfirstlane_b32 s79, v23
L_ks2:
  s_mov_b64 exec, 1
  ds_dec_u32 v2, v39 offset:288
  ds_read_b64 v[22:23], v2 offset:288
  s_mov_b64 exec, -1
  s_mul_i32 s68, s35, s76
  s_and_b32 s69, s79, 0xffff
  s_sub_i32 s68, s68, s78
  s_mul_i32 s69, s69, s77
  s_mul_i32 s68, s68, 160
  s_sub_u32 s35, s35, 1
  s_add_i32 s68, s68, s69
  s_add_i32 s68, s68, s34
  s_max_i32 s68, s68, 4915
  s_min_i32 s68, s68, 20480
  s_lshr_b32 s37, s68, 12
  s_lshl_b32 s58, s68, 20
L_kl:
  s_add_u32 s32, s32, 1
  s_add_u32 s33, s33, 0x20000000
  s_add_u32 s68, s33, s58
  s_addc_u32 s41, s37, 0
  s_cmp_eq_u32 s41, 3
  s_cbranch_scc1 L_wt3
  s_cmp_eq_u32 s41, 2
  s_cbranch_scc1 L_wt2
  s_cmp_eq_u32 s41, 4
  s_cbranch_scc1 L_wt4
  s_cmp_eq_u32 s41, 1
  s_cbranch_scc1 L_wt1
L_wtx:
  s_cmp_eq_u32 s32, s32
L_wt5:
  s_waitcnt vmcnt(4)
  s_setpc_b64 s[62:63]
L_wt3:
  s_waitcnt vmcnt(2)
  s_setpc_b64 s[62:63]
L_wt2:
  s_waitcnt vmcnt(1)
  s_setpc_b64 s[62:63]
L_wt4:
  s_waitcnt vmcnt(3)
  s_setpc_b64 s[62:63]
L_wt1:
  s_waitcnt vmcnt(0)
  s_setpc_b64 s[62:63]
L_kq2:
  v_readfirstlane_b32 s78, v22
  v_readfirstlane_b32 s79, v23
L_ks3:
  s_mov_b64 exec, 1
  ds_dec_u32 v2, v39 offset:288
  ds_dec_u32 v2, v39 offset:288
  ds_read_b64 v[22:23], v2 offset:288
  s_mov_b64 exec, -1
  s_mul_i32 s68, s35, s76
  s_and_b32 s69, s79, 0xffff
  s_sub_i32 s68, s68, s78
  s_mul_i32 s69, s69, s77
  s_mul_i32 s68, s68, 160
  s_sub_u32 s35, s35, 2
  s_add_i32 s68, s68, s69
  s_add_i32 s68, s68, s34
  s_max_i32 s68, s68, 4915
  s_min_i32 s68, s68, 20480
  s_lshr_b32 s37, s68, 12
  s_lshl_b32 s58, s68, 20
  s_branch L_kl
L_vl:
  s_cmp_lt_u32 s32, s36
  s_cbranch_scc1 L_kl
  s_branch L_ev
L_vq2:
  v_readfirstlane_b32 s78, v22
  v_readfirstlane_b32 s79, v23
  s_cmp_lt_u32 s32, s36
  s_cbranch_scc1 L_ks3
  s_branch L_ev
L_vs:
  v_readfirstlane_b32 s78, v22
  v_readfirstlane_b32 s79, v23
  s_cmp_eq_u32 s61, 2
  s_cbranch_scc1 L_vs1
  s_cmp_eq_u32 s61, 1
  s_cbranch_scc1 L_x3
  s_cmp_gt_u32 s41, s32
  s_cbranch_scc1 L_ks2
L_x1:
  v_dot2_f32_bf16 v8, v136, v4, 0
  v_dot2_f32_bf16 v9, v140, v4, 0
  v_dot2_f32_bf16 v10, v144, v4, 0
  v_dot2_f32_bf16 v11, v148, v4, 0
  v_dot2_f32_bf16 v12, v152, v4, 0
  v_dot2_f32_bf16 v13, v156, v4, 0
  v_dot2_f32_bf16 v14, v160, v4, 0
  v_dot2_f32_bf16 v15, v164, v4, 0
  v_dot2_f32_bf16 v8, v137, v5, v8
  v_dot2_f32_bf16 v9, v141, v5, v9
  v_dot2_f32_bf16 v10, v145, v5, v10
  v_dot2_f32_bf16 v11, v149, v5, v11
  v_dot2_f32_bf16 v12, v153, v5, v12
  v_dot2_f32_bf16 v13, v157, v5, v13
  v_dot2_f32_bf16 v14, v161, v5, v14
  v_dot2_f32_bf16 v15, v165, v5, v15
  v_dot2_f32_bf16 v8, v138, v6, v8
  v_dot2_f32_bf16 v9, v142, v6, v9
  v_dot2_f32_bf16 v10, v146, v6, v10
  v_dot2_f32_bf16 v11, v150, v6, v11
  v_dot2_f32_bf16 v12, v154, v6, v12
  v_dot2_f32_bf16 v13, v158, v6, v13
  v_dot2_f32_bf16 v14, v162, v6, v14
  v_dot2_f32_bf16 v15, v166, v6, v15
  v_dot2_f32_bf16 v8, v139, v7, v8
  v_dot2_f32_bf16 v9, v143, v7, v9
  v_dot2_f32_bf16 v10, v147, v7, v10
  v_dot2_f32_bf16 v11, v151, v7, v11
  v_dot2_f32_bf16 v12, v155, v7, v12
  v_dot2_f32_bf16 v13, v159, v7, v13
  v_dot2_f32_bf16 v14, v163, v7, v14
  v_dot2_f32_bf16 v15, v167, v7, v15
  v_add_f32_dpp v8, v8, v8 row_ror:8 row_mask:0xf bank_mask:0x3
  v_add_f32_dpp v8, v9, v9 row_ror:8 row_mask:0xf bank_mask:0xc
  v_add_f32_dpp v10, v10, v10 row_ror:8 row_mask:0xf bank_mask:0x3
  v_add_f32_dpp v10, v11, v11 row_ror:8 row_mask:0xf bank_mask:0xc
  v_add_f32_dpp v12, v12, v12 row_ror:8 row_mask:0xf bank_mask:0x3
  v_add_f32_dpp v12, v13, v13 row_ror:8 row_mask:0xf bank_mask:0xc
  v_add_f32_dpp v14, v14, v14 row_ror:8 row_mask:0xf bank_mask:0x3
  v_add_f32_dpp v14, v15, v15 row_ror:8 row_mask:0xf bank_mask:0xc
  v_add_f32_dpp v18, v8, v8 row_shl:4 row_mask:0xf bank_mask:0x5
  v_add_f32_dpp v18, v10, v10 row_shr:4 row_mask:0xf bank_mask:0xa
  v_add_f32_dpp v19, v12, v12 row_shl:4 row_mask:0xf bank_mask:0x5
  v_add_f32_dpp v19, v14, v14 row_shr:4 row_mask:0xf bank_mask:0xa
  s_lshl_b32 s68, s20, 3
  s_add_u32 s68, s68, s56
  v_add_f32_dpp v16, v16, v16 quad_perm:[2,3,0,1] row_mask:0xf bank_mask:0xf
  v_add_f32_dpp v17, v17, v17 quad_perm:[2,3,0,1] row_mask:0xf bank_mask:0xf
  v_add_f32_dpp v18, v18, v18 quad_perm:[2,3,0,1] row_mask:0xf bank_mask:0xf
  v_add_f32_dpp v19, v19, v19 quad_perm:[2,3,0,1] row_mask:0xf bank_mask:0xf
  v_cndmask_b32 v8, v16, v17, s[52:53]
  v_cndmask_b32 v9, v18, v19, s[52:53]
  v_mov_b32 v20, 64
  v_lshlrev_b32 v21, 3, s9
  v_add_f32_dpp v8, v8, v8 quad_perm:[1,0,3,2] row_mask:0xf bank_mask:0xf
  v_add_f32_dpp v9, v9, v9 quad_perm:[1,0,3,2] row_mask:0xf bank_mask:0xf
  v_cndmask_b32 v27, v8, v9, s[54:55]
  v_cvt_pk_bf16_f32 v27, 0, v27
  v_mul_f32 v27, 0x3db504f3, v27
  v_cvt_pk_bf16_f32 v27, 0, v27
  v_max_f32 v37, v37, v27
  v_cmp_ngt_f32 vcc, s22, v27
  v_mov_b32 v4, 0
  v_max_f32_dpp v37, v37, v37 row_ror:8 row_mask:0xf bank_mask:0xf
  s_bcnt1_i32_b64 s69, vcc
  s_add_u32 s69, s69, s20
  v_max_f32_dpp v37, v37, v37 row_ror:4 row_mask:0xf bank_mask:0xf
  s_cmp_gt_u32 s69, 32
  s_cselect_b32 s21, 1, s21
  v_max_f32_dpp v37, v37, v37 row_ror:2 row_mask:0xf bank_mask:0xf
  s_cmp_eq_u32 s21, 0
  s_cselect_b64 s[66:67], vcc, 0
  s_cselect_b32 s20, s69, s20
  v_max_f32_dpp v37, v37, v37 row_ror:1 row_mask:0xf bank_mask:0xf
  v_mbcnt_lo_u32_b32 v3, s66, 0
  v_mov_b32 v8, v37
  v_mbcnt_hi_u32_b32 v3, s67, v3
  v_lshl_add_u32 v3, v3, 3, s68
  v_permlane16_swap_b32 v8, v37
  s_mov_b64 exec, s[66:67]
  ds_write_b64 v3, v[26:27] offset:1280
  s_mov_b64 exec, -1
  ds_read_b32 v32, v39 offset:1024
  v_max_f32 v37, v37, v8
  v_mov_b32 v8, v37
  v_mov_b32 v5, 0
  s_mov_b32 s18, s32
  v_permlane32_swap_b32 v8, v37
  v_max_f32 v37, v37, v8
  v_sub_f32 v17, v25, v37
  v_sub_f32 v18, v27, v37
  v_mul_f32 v17, 0x3fb8aa3b, v17
  v_mul_f32 v18, 0x3fb8aa3b, v18
  v_exp_f32 v17, v17
  v_exp_f32 v18, v18
  v_mov_b32 v16, v37
  v_add_f32 v17, v17, v18
  s_waitcnt lgkmcnt(0)
  s_cmp_le_u32 s20, 0
  s_cbranch_scc1 L_x2
  v_add_u32_dpp v3, v32, v38 row_newbcast:8 row_mask:0xf bank_mask:0xf
  buffer_load_dwordx4 v[136:139], v3, s[48:51], 0 offen nt
  s_cmp_le_u32 s20, 4
  s_cbranch_scc1 L_x2
  v_add_u32_dpp v3, v32, v38 row_newbcast:9 row_mask:0xf bank_mask:0xf
  buffer_load_dwordx4 v[140:143], v3, s[48:51], 0 offen nt
  s_cmp_le_u32 s20, 8
  s_cbranch_scc1 L_x2
  v_add_u32_dpp v3, v32, v38 row_newbcast:10 row_mask:0xf bank_mask:0xf
  buffer_load_dwordx4 v[144:147], v3, s[48:51], 0 offen nt
  s_cmp_le_u32 s20, 12
  s_cbranch_scc1 L_x2
  v_add_u32_dpp v3, v32, v38 row_newbcast:11 row_mask:0xf bank_mask:0xf
  buffer_load_dwordx4 v[148:151], v3, s[48:51], 0 offen nt
  s_cmp_le_u32 s20, 16
  s_cbranch_scc1 L_x2
  v_add_u32_dpp v3, v32, v38 row_newbcast:12 row_mask:0xf bank_mask:0xf
  buffer_load_dwordx4 v[152:155], v3, s[48:51], 0 offen nt
  s_cmp_le_u32 s20, 20
  s_cbranch_scc1 L_x2
  v_add_u32_dpp v3, v32, v38 row_newbcast:13 row_mask:0xf bank_mask:0xf
  buffer_load_dwordx4 v[156:159], v3, s[48:51], 0 offen nt
  s_cmp_le_u32 s20, 24
  s_cbranch_scc1 L_x2
  v_add_u32_dpp v3, v32, v38 row_newbcast:14 row_mask:0xf bank_mask:0xf
  buffer_load_dwordx4 v[160:163], v3, s[48:51], 0 offen nt
  s_cmp_le_u32 s20, 28
  s_cbranch_scc1 L_x2
  v_add_u32_dpp v3, v32, v38 row_newbcast:15 row_mask:0xf bank_mask:0xf
  buffer_load_dwordx4 v[164:167], v3, s[48:51], 0 offen nt
L_x2:
  s_nop 1
  v_add_f32_dpp v17, v17, v17 row_ror:8 row_mask:0xf bank_mask:0xf
  s_nop 1
  v_add_f32_dpp v17, v17, v17 row_ror:4 row_mask:0xf bank_mask:0xf
  s_nop 1
  v_add_f32_dpp v17, v17, v17 row_ror:2 row_mask:0xf bank_mask:0xf
  s_nop 1
  v_add_f32_dpp v17, v17, v17 row_ror:1 row_mask:0xf bank_mask:0xf
  v_mov_b32 v8, v17
  s_nop 1
  v_permlane16_swap_b32 v8, v17
  v_add_f32 v17, v17, v8
  v_mov_b32 v8, v17
  s_nop 1
  v_permlane32_swap_b32 v8, v17
  v_add_f32 v17, v17, v8
  s_mov_b64 exec, 1
  ds_max_f32 v1, v37 offset:276
  ds_write_b64 v21, v[16:17] offset:512
  ds_add_u32 v1, v20 offset:272
  s_mov_b64 exec, -1
  s_mov_b32 s61, 1
  s_mov_b32 s19, 1
  s_cmp_lt_u32 s32, 5
  s_cbranch_scc1 L_ks2
L_x3:
  v_max_f32 v21, s23, v37
  s_add_u32 s38, s38, 3
  s_lshr_b32 s38, s38, 2
  v_add_f32 v21, 0xc2ac0000, v21
  s_max_u32 s38, s38, s32
  s_lshl_b32 s38, s38, 2
  v_cmp_nlt_f32 vcc, v27, v21
  s_lshl_b32 s68, s38, 3
  s_add_u32 s68, s68, s56
  s_andn2_b64 s[70:71], vcc, s[66:67]
  v_mbcnt_lo_u32_b32 v3, s70, 0
  v_mbcnt_hi_u32_b32 v3, s71, v3
  s_bcnt1_i32_b64 s69, s[70:71]
  v_lshl_add_u32 v3, v3, 3, s68
  s_mov_b64 exec, s[70:71]
  ds_write_b64 v3, v[26:27]
  s_mov_b64 exec, -1
  s_or_b64 s[66:67], s[66:67], s[70:71]
  s_add_u32 s38, s38, s69
  ds_read_b64 v[28:29], v39 offset:0
  ds_read_b64 v[30:31], v39 offset:512
  ds_read_b64 v[32:33], v39 offset:1024
  v_mov_b32 v8, 0
  v_mov_b32 v9, 0
  v_mov_b32 v10, 0
  v_mov_b32 v11, 0
  v_mov_b32 v6, 0
  v_mov_b32 v7, 0
  s_lshr_b32 s36, s38, 2
  s_mov_b32 s61, 2
  s_add_u32 s68, s38, 8
  s_lshr_b32 s68, s68, 2
  s_sub_u32 s69, s68, s59
  s_mov_b32 s59, s68
  s_add_u32 s35, s35, s69
  s_add_u32 s78, s78, s69
  v_mov_b32 v3, s69
  s_mov_b64 exec, 1
  ds_add_u32 v1, v3 offset:296
  ds_add_u32 v1, v3 offset:300
  s_mov_b64 exec, -1
  s_waitcnt lgkmcnt(0)
  v_sub_f32 v29, v29, v37
  v_sub_f32 v31, v31, v37
  v_sub_f32 v33, v33, v37
  v_mul_f32 v29, 0x3fb8aa3b, v29
  v_mul_f32 v31, 0x3fb8aa3b, v31
  v_mul_f32 v33, 0x3fb8aa3b, v33
  v_exp_f32 v29, v29
  v_exp_f32 v31, v31
  v_exp_f32 v33, v33
  s_nop 0
  v_cvt_pk_bf16_f32 v29, v29, v29
  v_cvt_pk_bf16_f32 v31, v31, v31
  v_cvt_pk_bf16_f32 v33, v33, v33
  s_cmp_eq_u32 s20, 0
  s_cselect_b32 s41, 0, s41
L_vs1:
  s_cmp_eq_u32 s19, 0
  s_cbranch_scc1 L_vs1b
  s_sub_u32 s68, s32, s18
  s_cmp_le_u32 s41, s68
  s_cbranch_scc1 L_snap
  s_cmp_lt_u32 s32, s36
  s_cbranch_scc1 L_ks2
  s_waitcnt vmcnt(0)
L_snap:
  s_cmp_le_u32 s20, 0
  s_cbranch_scc1 L_snp2
  v_and_b32_dpp v12, v33, v34 row_newbcast:8 row_mask:0xf bank_mask:0xf
  v_and_b32_dpp v13, v33, v35 row_newbcast:8 row_mask:0xf bank_mask:0xf
  v_and_b32_dpp v14, v33, v36 row_newbcast:8 row_mask:0xf bank_mask:0xf
  v_and_b32_dpp v15, v33, v0 row_newbcast:8 row_mask:0xf bank_mask:0xf
  s_nop 1
  v_mfma_f32_16x16x32_bf16 v[4:7], v[12:15], v[136:139], v[4:7]
  s_cmp_le_u32 s20, 4
  s_cbranch_scc1 L_snp2
  v_and_b32_dpp v12, v33, v34 row_newbcast:9 row_mask:0xf bank_mask:0xf
  v_and_b32_dpp v13, v33, v35 row_newbcast:9 row_mask:0xf bank_mask:0xf
  v_and_b32_dpp v14, v33, v36 row_newbcast:9 row_mask:0xf bank_mask:0xf
  v_and_b32_dpp v15, v33, v0 row_newbcast:9 row_mask:0xf bank_mask:0xf
  s_nop 1
  v_mfma_f32_16x16x32_bf16 v[4:7], v[12:15], v[140:143], v[4:7]
  s_cmp_le_u32 s20, 8
  s_cbranch_scc1 L_snp2
  v_and_b32_dpp v12, v33, v34 row_newbcast:10 row_mask:0xf bank_mask:0xf
  v_and_b32_dpp v13, v33, v35 row_newbcast:10 row_mask:0xf bank_mask:0xf
  v_and_b32_dpp v14, v33, v36 row_newbcast:10 row_mask:0xf bank_mask:0xf
  v_and_b32_dpp v15, v33, v0 row_newbcast:10 row_mask:0xf bank_mask:0xf
  s_nop 1
  v_mfma_f32_16x16x32_bf16 v[4:7], v[12:15], v[144:147], v[4:7]
  s_cmp_le_u32 s20, 12
  s_cbranch_scc1 L_snp2
  v_and_b32_dpp v12, v33, v34 row_newbcast:11 row_mask:0xf bank_mask:0xf
  v_and_b32_dpp v13, v33, v35 row_newbcast:11 row_mask:0xf bank_mask:0xf
  v_and_b32_dpp v14, v33, v36 row_newbcast:11 row_mask:0xf bank_mask:0xf
  v_and_b32_dpp v15, v33, v0 row_newbcast:11 row_mask:0xf bank_mask:0xf
  s_nop 1
  v_mfma_f32_16x16x32_bf16 v[4:7], v[12:15], v[148:151], v[4:7]
  s_cmp_le_u32 s20, 16
  s_cbranch_scc1 L_snp2
  v_and_b32_dpp v12, v33, v34 row_newbcast:12 row_mask:0xf bank_mask:0xf
  v_and_b32_dpp v13, v33, v35 row_newbcast:12 row_mask:0xf bank_mask:0xf
  v_and_b32_dpp v14, v33, v36 row_newbcast:12 row_mask:0xf bank_mask:0xf
  v_and_b32_dpp v15, v33, v0 row_newbcast:12 row_mask:0xf bank_mask:0xf
  s_nop 1
  v_mfma_f32_16x16x32_bf16 v[4:7], v[12:15], v[152:155], v[4:7]
  s_cmp_le_u32 s20, 20
  s_cbranch_scc1 L_snp2
  v_and_b32_dpp v12, v33, v34 row_newbcast:13 row_mask:0xf bank_mask:0xf
  v_and_b32_dpp v13, v33, v35 row_newbcast:13 row_mask:0xf bank_mask:0xf
  v_and_b32_dpp v14, v33, v36 row_newbcast:13 row_mask:0xf bank_mask:0xf
  v_and_b32_dpp v15, v33, v0 row_newbcast:13 row_mask:0xf bank_mask:0xf
  s_nop 1
  v_mfma_f32_16x16x32_bf16 v[4:7], v[12:15], v[156:159], v[4:7]
  s_cmp_le_u32 s20, 24
  s_cbranch_scc1 L_snp2
  v_and_b32_dpp v12, v33, v34 row_newbcast:14 row_mask:0xf bank_mask:0xf
  v_and_b32_dpp v13, v33, v35 row_newbcast:14 row_mask:0xf bank_mask:0xf
  v_and_b32_dpp v14, v33, v36 row_newbcast:14 row_mask:0xf bank_mask:0xf
  v_and_b32_dpp v15, v33, v0 row_newbcast:14 row_mask:0xf bank_mask:0xf
  s_nop 1
  v_mfma_f32_16x16x32_bf16 v[4:7], v[12:15], v[160:163], v[4:7]
  s_cmp_le_u32 s20, 28
  s_cbranch_scc1 L_snp2
  v_and_b32_dpp v12, v33, v34 row_newbcast:15 row_mask:0xf bank_mask:0xf
  v_and_b32_dpp v13, v33, v35 row_newbcast:15 row_mask:0xf bank_mask:0xf
  v_and_b32_dpp v14, v33, v36 row_newbcast:15 row_mask:0xf bank_mask:0xf
  v_and_b32_dpp v15, v33, v0 row_newbcast:15 row_mask:0xf bank_mask:0xf
  s_nop 1
  v_mfma_f32_16x16x32_bf16 v[4:7], v[12:15], v[164:167], v[4:7]
L_snp2:
  v_lshrrev_b32 v3, 4, v1
  v_lshl_add_u32 v21, v3, 3, v39
  v_add_u32 v21, s11, v21
  v_mov_b32 v3, 1
  s_nop 0
  s_mov_b32 s19, 0
  s_cmp_lg_u32 s21, 0
  s_cbranch_scc1 L_vs1b
  s_mov_b32 exec_hi, 0
  ds_write_b128 v21, v[4:7] offset:6656
  s_mov_b64 exec, 1
  ds_add_u32 v1, v3 offset:304
  s_mov_b64 exec, -1
  s_branch L_vs1b
L_vq:
  v_readfirstlane_b32 s78, v22
  v_readfirstlane_b32 s79, v23
L_vs1b:
L_vs2:
  s_cmp_lt_u32 s32, s36
  s_cbranch_scc1 L_ks2
L_ev:
  s_cmp_eq_u32 s75, 0
  s_cbranch_scc1 L_hand
  s_add_u32 s68, s32, 5
  s_cmp_lt_u32 s68, s75
  s_cbranch_scc0 L_wt1
  s_add_u32 s32, s32, 1
  s_mov_b64 exec, 1
  ds_dec_u32 v2, v39 offset:288
  s_mov_b64 exec, -1
  s_branch L_wtx
L_hand:
  v_mov_b32 v3, 0
  s_mov_b32 s70, 0
L_sn_3:
  ds_read_b64 v[18:19], v3 offset:272
  s_waitcnt lgkmcnt(0)
  v_cmp_gt_u32 vcc, 0x102c0, v18
  s_cmp_eq_u64 vcc, 0
  s_cbranch_scc1 L_snd_4
  s_sleep 1
  s_add_u32 s70, s70, 1
  s_cmp_lt_u32 s70, 2097152
  s_cbranch_scc1 L_sn_3
L_snd_4:
  v_add_f32 v21, 0xc2ba0000, v19
  v_cmp_nlt_f32 vcc, v25, v21
  s_lshl_b32 s68, s38, 3
  s_add_u32 s68, s68, s56
  s_andn2_b64 s[70:71], vcc, s[64:65]
  v_mbcnt_lo_u32_b32 v3, s70, 0
  v_mbcnt_hi_u32_b32 v3, s71, v3
  s_bcnt1_i32_b64 s69, s[70:71]
  v_lshl_add_u32 v3, v3, 3, s68
  s_mov_b64 exec, s[70:71]
  ds_write_b64 v3, v[24:25]
  s_mov_b64 exec, -1
  s_or_b64 s[64:65], s[64:65], s[70:71]
  s_add_u32 s38, s38, s69
  v_cmp_nlt_f32 vcc, v27, v21
  s_lshl_b32 s68, s38, 3
  s_add_u32 s68, s68, s56
  s_andn2_b64 s[70:71], vcc, s[66:67]
  v_mbcnt_lo_u32_b32 v3, s70, 0
  v_mbcnt_hi_u32_b32 v3, s71, v3
  s_bcnt1_i32_b64 s69, s[70:71]
  v_lshl_add_u32 v3, v3, 3, s68
  s_mov_b64 exec, s[70:71]
  ds_write_b64 v3, v[26:27]
  s_mov_b64 exec, -1
  s_or_b64 s[66:67], s[66:67], s[70:71]
  s_add_u32 s38, s38, s69
  ds_read_b64 v[28:29], v39 offset:0
  ds_read_b64 v[30:31], v39 offset:512
  ds_read_b64 v[32:33], v39 offset:1024
  s_add_u32 s75, s38, 23
  s_lshr_b32 s75, s75, 2
  s_sub_u32 s36, s75, 8
  s_max_i32 s36, s36, 0
  s_add_u32 s68, s38, 3
  s_lshr_b32 s68, s68, 2
  s_sub_u32 s69, s68, s59
  s_mov_b32 s59, s68
  s_add_u32 s35, s35, s69
  s_add_u32 s78, s78, s69
  v_mov_b32 v3, s69
  s_mov_b64 exec, 1
  ds_add_u32 v1, v3 offset:296
  ds_add_u32 v1, v3 offset:300
  s_mov_b64 exec, -1
  s_waitcnt lgkmcnt(0)
  v_sub_f32 v29, v29, v37
  v_sub_f32 v31, v31, v37
  v_sub_f32 v33, v33, v37
  v_mul_f32 v29, 0x3fb8aa3b, v29
  v_mul_f32 v31, 0x3fb8aa3b, v31
  v_mul_f32 v33, 0x3fb8aa3b, v33
  v_exp_f32 v29, v29
  v_exp_f32 v31, v31
  v_exp_f32 v33, v33
  s_nop 0
  v_cvt_pk_bf16_f32 v29, v29, v29
  v_cvt_pk_bf16_f32 v31, v31, v31
  v_cvt_pk_bf16_f32 v33, v33, v33
  s_branch L_vs2
L_work:
  s_cmp_eq_u32 s39, 1
  s_cbranch_scc1 L_w1
  s_cmp_eq_u32 s39, 2
  s_cbranch_scc1 L_w2
  s_cmp_eq_u32 s39, 3
  s_cbranch_scc1 L_w3
L_w0:
  s_load_dwordx16 s[16:31], s[42:43], s40 glc
  s_mov_b32 s39, 1
L_wr:
  s_setpc_b64 s[100:101]
L_w1:
  s_waitcnt lgkmcnt(0)
  s_xor_b32 s68, s17, s74
  s_xor_b32 s69, s19, s74
  s_or_b32 s68, s68, s69
  s_xor_b32 s69, s21, s74
  s_or_b32 s68, s68, s69
  s_xor_b32 s69, s23, s74
  s_or_b32 s68, s68, s69
  s_xor_b32 s69, s25, s74
  s_or_b32 s68, s68, s69
  s_xor_b32 s69, s27, s74
  s_or_b32 s68, s68, s69
  s_xor_b32 s69, s29, s74
  s_or_b32 s68, s68, s69
  s_xor_b32 s69, s31, s74
  s_or_b32 s68, s68, s69
  s_cbranch_scc1 L_w0
  v_mov_b32 v8, s16
  v_mov_b32 v9, s18
  v_mov_b32 v10, s20
  v_mov_b32 v11, s22
  v_mov_b32 v12, s24
  v_mov_b32 v13, s26
  v_mov_b32 v14, s28
  v_mov_b32 v15, s30
  v_lshlrev_b32 v3, 5, s9
  s_mov_b64 exec, 1
  ds_write_b128 v3, v[8:11] offset:0
  ds_write_b128 v3, v[12:15] offset:16
  s_mov_b64 exec, -1
  s_mov_b32 s39, 2
L_w2:
  s_add_u32 s68, s41, 16
  s_cmp_lt_u32 s32, s68
  s_cbranch_scc1 L_wr
  ds_read_b128 v[4:7], v38 offset:0
  s_waitcnt lgkmcnt(0)
  v_max3_u32 v8, v4, v5, v6
  v_max_u32 v8, v8, v7
  v_cmp_eq_u32 vcc, -1, v8
  s_cmp_lg_u64 vcc, 0
  s_cbranch_scc1 L_wr
  v_dot2_f32_bf16 v8, v40, v4, 0
  v_dot2_f32_bf16 v9, v44, v4, 0
  v_dot2_f32_bf16 v10, v48, v4, 0
  v_dot2_f32_bf16 v11, v52, v4, 0
  v_dot2_f32_bf16 v12, v56, v4, 0
  v_dot2_f32_bf16 v13, v60, v4, 0
  v_dot2_f32_bf16 v14, v64, v4, 0
  v_dot2_f32_bf16 v15, v68, v4, 0
  v_dot2_f32_bf16 v8, v41, v5, v8
  v_dot2_f32_bf16 v9, v45, v5, v9
  v_dot2_f32_bf16 v10, v49, v5, v10
  v_dot2_f32_bf16 v11, v53, v5, v11
  v_dot2_f32_bf16 v12, v57, v5, v12
  v_dot2_f32_bf16 v13, v61, v5, v13
  v_dot2_f32_bf16 v14, v65, v5, v14
  v_dot2_f32_bf16 v15, v69, v5, v15
  v_dot2_f32_bf16 v8, v42, v6, v8
  v_dot2_f32_bf16 v9, v46, v6, v9
  v_dot2_f32_bf16 v10, v50, v6, v10
  v_dot2_f32_bf16 v11, v54, v6, v11
  v_dot2_f32_bf16 v12, v58, v6, v12
  v_dot2_f32_bf16 v13, v62, v6, v13
  v_dot2_f32_bf16 v14, v66, v6, v14
  v_dot2_f32_bf16 v15, v70, v6, v15
  v_dot2_f32_bf16 v8, v43, v7, v8
  v_dot2_f32_bf16 v9, v47, v7, v9
  v_dot2_f32_bf16 v10, v51, v7, v10
  v_dot2_f32_bf16 v11, v55, v7, v11
  v_dot2_f32_bf16 v12, v59, v7, v12
  v_dot2_f32_bf16 v13, v63, v7, v13
  v_dot2_f32_bf16 v14, v67, v7, v14
  v_dot2_f32_bf16 v15, v71, v7, v15
  v_add_f32_dpp v8, v8, v8 row_ror:8 row_mask:0xf bank_mask:0x3
  v_add_f32_dpp v8, v9, v9 row_ror:8 row_mask:0xf bank_mask:0xc
  v_add_f32_dpp v10, v10, v10 row_ror:8 row_mask:0xf bank_mask:0x3
  v_add_f32_dpp v10, v11, v11 row_ror:8 row_mask:0xf bank_mask:0xc
  v_add_f32_dpp v12, v12, v12 row_ror:8 row_mask:0xf bank_mask:0x3
  v_add_f32_dpp v12, v13, v13 row_ror:8 row_mask:0xf bank_mask:0xc
  v_add_f32_dpp v14, v14, v14 row_ror:8 row_mask:0xf bank_mask:0x3
  v_add_f32_dpp v14, v15, v15 row_ror:8 row_mask:0xf bank_mask:0xc
  v_add_f32_dpp v16, v8, v8 row_shl:4 row_mask:0xf bank_mask:0x5
  v_add_f32_dpp v16, v10, v10 row_shr:4 row_mask:0xf bank_mask:0xa
  v_add_f32_dpp v17, v12, v12 row_shl:4 row_mask:0xf bank_mask:0x5
  v_add_f32_dpp v17, v14, v14 row_shr:4 row_mask:0xf bank_mask:0xa
  v_dot2_f32_bf16 v8, v72, v4, 0
  v_dot2_f32_bf16 v9, v76, v4, 0
  v_dot2_f32_bf16 v10, v80, v4, 0
  v_dot2_f32_bf16 v11, v84, v4, 0
  v_dot2_f32_bf16 v12, v88, v4, 0
  v_dot2_f32_bf16 v13, v92, v4, 0
  v_dot2_f32_bf16 v14, v96, v4, 0
  v_dot2_f32_bf16 v15, v100, v4, 0
  v_dot2_f32_bf16 v8, v73, v5, v8
  v_dot2_f32_bf16 v9, v77, v5, v9
  v_dot2_f32_bf16 v10, v81, v5, v10
  v_dot2_f32_bf16 v11, v85, v5, v11
  v_dot2_f32_bf16 v12, v89, v5, v12
  v_dot2_f32_bf16 v13, v93, v5, v13
  v_dot2_f32_bf16 v14, v97, v5, v14
  v_dot2_f32_bf16 v15, v101, v5, v15
  v_dot2_f32_bf16 v8, v74, v6, v8
  v_dot2_f32_bf16 v9, v78, v6, v9
  v_dot2_f32_bf16 v10, v82, v6, v10
  v_dot2_f32_bf16 v11, v86, v6, v11
  v_dot2_f32_bf16 v12, v90, v6, v12
  v_dot2_f32_bf16 v13, v94, v6, v13
  v_dot2_f32_bf16 v14, v98, v6, v14
  v_dot2_f32_bf16 v15, v102, v6, v15
  v_dot2_f32_bf16 v8, v75, v7, v8
  v_dot2_f32_bf16 v9, v79, v7, v9
  v_dot2_f32_bf16 v10, v83, v7, v10
  v_dot2_f32_bf16 v11, v87, v7, v11
  v_dot2_f32_bf16 v12, v91, v7, v12
  v_dot2_f32_bf16 v13, v95, v7, v13
  v_dot2_f32_bf16 v14, v99, v7, v14
  v_dot2_f32_bf16 v15, v103, v7, v15
  v_add_f32_dpp v8, v8, v8 row_ror:8 row_mask:0xf bank_mask:0x3
  v_add_f32_dpp v8, v9, v9 row_ror:8 row_mask:0xf bank_mask:0xc
  v_add_f32_dpp v10, v10, v10 row_ror:8 row_mask:0xf bank_mask:0x3
  v_add_f32_dpp v10, v11, v11 row_ror:8 row_mask:0xf bank_mask:0xc
  v_add_f32_dpp v12, v12, v12 row_ror:8 row_mask:0xf bank_mask:0x3
  v_add_f32_dpp v12, v13, v13 row_ror:8 row_mask:0xf bank_mask:0xc
  v_add_f32_dpp v14, v14, v14 row_ror:8 row_mask:0xf bank_mask:0x3
  v_add_f32_dpp v14, v15, v15 row_ror:8 row_mask:0xf bank_mask:0xc
  v_add_f32_dpp v18, v8, v8 row_shl:4 row_mask:0xf bank_mask:0x5
  v_add_f32_dpp v18, v10, v10 row_shr:4 row_mask:0xf bank_mask:0xa
  v_add_f32_dpp v19, v12, v12 row_shl:4 row_mask:0xf bank_mask:0x5
  v_add_f32_dpp v19, v14, v14 row_shr:4 row_mask:0xf bank_mask:0xa
  v_mov_b32 v3, 0
  v_mov_b32 v20, 64
  v_add_f32_dpp v16, v16, v16 quad_perm:[2,3,0,1] row_mask:0xf bank_mask:0xf
  v_add_f32_dpp v17, v17, v17 quad_perm:[2,3,0,1] row_mask:0xf bank_mask:0xf
  v_add_f32_dpp v18, v18, v18 quad_perm:[2,3,0,1] row_mask:0xf bank_mask:0xf
  v_add_f32_dpp v19, v19, v19 quad_perm:[2,3,0,1] row_mask:0xf bank_mask:0xf
  v_cndmask_b32 v8, v16, v17, s[52:53]
  v_cndmask_b32 v9, v18, v19, s[52:53]
  s_nop 0
  v_lshlrev_b32 v21, 3, s9
  v_add_f32_dpp v8, v8, v8 quad_perm:[1,0,3,2] row_mask:0xf bank_mask:0xf
  v_add_f32_dpp v9, v9, v9 quad_perm:[1,0,3,2] row_mask:0xf bank_mask:0xf
  v_cndmask_b32 v25, v8, v9, s[54:55]
  v_cvt_pk_bf16_f32 v25, 0, v25
  v_mul_f32 v25, 0x3db504f3, v25
  v_cvt_pk_bf16_f32 v25, 0, v25
  v_mov_b32 v37, v25
  s_nop 1
  v_max_f32_dpp v37, v37, v37 row_ror:8 row_mask:0xf bank_mask:0xf
  s_nop 1
  v_max_f32_dpp v37, v37, v37 row_ror:4 row_mask:0xf bank_mask:0xf
  s_nop 1
  v_max_f32_dpp v37, v37, v37 row_ror:2 row_mask:0xf bank_mask:0xf
  s_nop 1
  v_max_f32_dpp v37, v37, v37 row_ror:1 row_mask:0xf bank_mask:0xf
  v_mov_b32 v8, v37
  s_nop 1
  v_permlane16_swap_b32 v8, v37
  v_max_f32 v37, v37, v8
  v_mov_b32 v8, v37
  s_nop 1
  v_permlane32_swap_b32 v8, v37
  v_max_f32 v37, v37, v8
  s_mov_b64 exec, 1
  ds_max_f32 v3, v37 offset:284
  ds_add_u32 v3, v20 offset:280
  s_mov_b64 exec, -1
  s_mov_b32 s39, 3
  s_mov_b32 s19, 0
  s_setpc_b64 s[100:101]
L_w3:
  v_mov_b32 v3, 0
  ds_read_b64 v[18:19], v3 offset:280
  s_waitcnt lgkmcnt(0)
  v_cmp_gt_u32 vcc, 0x102c0, v18
  s_cmp_lg_u64 vcc, 0
  s_cbranch_scc1 L_wr
  ds_read_b64 v[20:21], v3 offset:320
  s_waitcnt lgkmcnt(0)
  v_add_f32 v21, 0xc1c00000, v21
  v_cmp_nlt_f32 vcc, v25, v21
  v_readfirstlane_b32 s22, v21
  v_readfirstlane_b32 s23, v20
  s_mov_b32 s20, 0
  s_bcnt1_i32_b64 s68, vcc
  s_cmp_gt_u32 s68, 32
  s_cselect_b32 s21, 1, 0
  s_cbranch_scc1 L_w4
  s_mov_b32 s38, 160
  v_cmp_nlt_f32 vcc, v25, v21
  s_lshl_b32 s68, s38, 3
  s_add_u32 s68, s68, s56
  s_andn2_b64 s[70:71], vcc, s[64:65]
  v_mbcnt_lo_u32_b32 v3, s70, 0
  v_mbcnt_hi_u32_b32 v3, s71, v3
  s_bcnt1_i32_b64 s69, s[70:71]
  v_lshl_add_u32 v3, v3, 3, s68
  s_mov_b64 exec, s[70:71]
  ds_write_b64 v3, v[24:25]
  s_mov_b64 exec, -1
  s_or_b64 s[64:65], s[64:65], s[70:71]
  s_add_u32 s38, s38, s69
  s_mov_b32 s20, s69
  s_mov_b32 s38, 0
L_w4:
  v_add_f32 v21, 0xc2ac0000, v20
  v_cmp_nlt_f32 vcc, v25, v21
  s_lshl_b32 s68, s38, 3
  s_add_u32 s68, s68, s56
  s_andn2_b64 s[70:71], vcc, s[64:65]
  v_mbcnt_lo_u32_b32 v3, s70, 0
  v_mbcnt_hi_u32_b32 v3, s71, v3
  s_bcnt1_i32_b64 s69, s[70:71]
  v_lshl_add_u32 v3, v3, 3, s68
  s_mov_b64 exec, s[70:71]
  ds_write_b64 v3, v[24:25]
  s_mov_b64 exec, -1
  s_or_b64 s[64:65], s[64:65], s[70:71]
  s_add_u32 s38, s38, s69
  s_add_u32 s68, s38, 4
  s_lshr_b32 s68, s68, 1
  s_sub_u32 s69, s68, s59
  s_mov_b32 s59, s68
  v_mov_b32 v3, s69
  s_mov_b64 exec, 1
  ds_add_u32 v1, v3 offset:296
  ds_add_u32 v1, v3 offset:300
  s_mov_b64 exec, -1
  s_sub_i32 s68, s59, 20
  s_max_i32 s68, s68, -4
  s_mul_i32 s68, s68, 245
  s_add_i32 s34, s34, s68
  s_mov_b32 s39, 4
  ds_read_b64 v[28:29], v39 offset:0
  s_waitcnt lgkmcnt(0)
  s_setpc_b64 s[100:101]
L_pub:
  s_getpc_b64 s[56:57]
L_pct:
  s_lshr_b32 s3, s2, 3
  s_lshl_b32 s3, s3, 2
  s_add_u32 s3, s3, L_touch-L_pct
  s_load_dword s14, s[56:57], s3
  s_waitcnt lgkmcnt(0)
  s_bfe_u32 s48, s14, 0x30000
  s_lshl_b32 s48, s48, 6
  v_add_u32 v2, s48, v1
  s_bfe_u32 s48, s14, 0x30003
  s_bitcmp1_b32 s14, 7
  s_cbranch_scc1 L_te_6
  s_bitcmp1_b32 s14, 6
  s_cbranch_scc1 L_tq_5
  s_lshl1_add_u32 s48, s8, s48
  s_lshl_b32 s48, s48, 7
  v_mul_u32_u24 v2, 6144, v2
  v_add_u32 v2, s48, v2
  global_load_dword v167, v2, s[36:37]
  s_branch L_te_6
L_tq_5:
  s_lshl3_add_u32 s48, s8, s48
  s_lshl_b32 s48, s48, 7
  v_lshl_add_u32 v2, v2, 13, s48
  global_load_dword v167, v2, s[22:23]
L_te_6:
  s_bfe_u32 s48, s14, 0x30008
  s_lshl_b32 s48, s48, 6
  v_add_u32 v2, s48, v1
  s_bfe_u32 s48, s14, 0x3000b
  s_bitcmp1_b32 s14, 15
  s_cbranch_scc1 L_te_8
  s_bitcmp1_b32 s14, 14
  s_cbranch_scc1 L_tq_7
  s_lshl1_add_u32 s48, s8, s48
  s_lshl_b32 s48, s48, 7
  v_mul_u32_u24 v2, 6144, v2
  v_add_u32 v2, s48, v2
  global_load_dword v167, v2, s[36:37]
  s_branch L_te_8
L_tq_7:
  s_lshl3_add_u32 s48, s8, s48
  s_lshl_b32 s48, s48, 7
  v_lshl_add_u32 v2, v2, 13, s48
  global_load_dword v167, v2, s[22:23]
L_te_8:
  v_mov_b32 v38, 0
  v_mov_b32 v4, -1
  v_mov_b32 v8, 0xff800000
  v_mov_b32 v9, 0
  v_lshlrev_b32 v2, 3, v1
  ds_write_b64 v2, v[8:9] offset:448
  v_mov_b32 v5, 0
  v_mov_b32 v6, 0
  v_mov_b32 v7, 0
  ds_write_b64 v2, v[6:7] offset:6144
  ds_write_b64 v2, v[6:7] offset:11776
  v_lshlrev_b32 v2, 2, v1
  ds_write_b32 v2, v4 offset:0
  s_lshr_b32 s10, s7, 1
  ds_write_b128 v38, v[4:7] offset:256
  v_lshlrev_b32 v10, 6, s10
  v_mov_b32 v11, v8
  v_mov_b32 v12, v10
  v_mov_b32 v13, v8
  ds_write_b128 v38, v[10:13] offset:272
  s_mul_i32 s11, s10, 29
  s_sub_u32 s11, 1343, s11
  v_mov_b32 v10, s11
  v_mov_b32 v11, 0
  v_mov_b32 v12, 1024
  v_mov_b32 v13, 0
  ds_write_b128 v38, v[10:13] offset:288
  v_mov_b32 v4, s10
  v_mov_b32 v5, s10
  ds_write_b128 v38, v[4:7] offset:304
  s_getreg_b32 s76, hwreg(HW_REG_XCC_ID, 0, 4)
  s_waitcnt lgkmcnt(0)
  s_load_dword s74, s[42:43], 0
  s_barrier
  s_waitcnt lgkmcnt(0)
  s_mul_i32 s74, s74, 0x9e3779b1
  s_add_u32 s74, s74, 0x7f4a7c15
  s_add_u32 s76, s76, s74
  s_add_u32 s52, s7, 1
  s_cmp_eq_u32 s52, 3
  s_cselect_b32 s52, 0, s52
  s_add_u32 s53, s52, s7
  s_sub_u32 s53, 3, s53
  s_lshl2_add_u32 s54, s6, s52
  s_lshl_b32 s54, s54, 7
  s_lshl2_add_u32 s55, s6, s53
  s_lshl_b32 s55, s55, 7
  s_lshl2_add_u32 s64, s6, s7
  s_lshl_b32 s64, s64, 7
  s_add_u32 s64, s64, 65536
  v_mov_b32 v18, s64
  v_add_u32 v19, 32768, v18
  v_mov_b32 v17, 0x10000
  s_lshl2_add_u32 s49, s6, s7
  s_lshl_b32 s49, s49, 9
  s_add_u32 s49, s49, 131072
  v_and_b32 v10, 3, v1
  v_lshl_add_u32 v10, v10, 7, s49
  v_bfe_u32 v11, v1, 2, 1
  v_mul_u32_u24 v11, 393216, v11
  v_add_u32 v10, v10, v11
  s_mov_b64 exec, 0xff
  global_load_dword v166, v10, s[42:43] sc1
  s_mov_b64 exec, 1
  global_load_dword v166, v18, s[42:43] sc1
  global_load_dword v166, v19, s[42:43] sc1
  s_mov_b64 exec, -1
  s_mov_b32 s70, 0
L_sn_9:
  ds_read_b64 v[8:9], v38 offset:280
  s_waitcnt lgkmcnt(0)
  v_cmp_gt_u32 vcc, 0x2c0, v8
  s_cmp_eq_u64 vcc, 0
  s_cbranch_scc1 L_snd_10
  s_sleep 2
  s_add_u32 s70, s70, 1
  s_cmp_lt_u32 s70, 2097152
  s_cbranch_scc1 L_sn_9
L_snd_10:
  s_load_dwordx2 s[20:21], s[42:43], s54 offset:65536 glc
  s_load_dwordx2 s[24:25], s[42:43], s55 offset:65536 glc
  v_mov_b32 v8, v9
  v_mov_b32 v9, s74
  s_mov_b64 exec, 1
  global_store_dwordx2 v18, v[8:9], s[42:43] sc1
  s_mov_b32 s70, 0
  s_branch L_s3ec
L_s3e:
  s_load_dwordx2 s[20:21], s[42:43], s54 offset:65536 glc
  s_load_dwordx2 s[24:25], s[42:43], s55 offset:65536 glc
L_s3ec:
  s_waitcnt lgkmcnt(0)
  s_xor_b32 s68, s21, s74
  s_xor_b32 s69, s25, s74
  s_or_b32 s68, s68, s69
  s_cbranch_scc0 L_s3ed
  s_sleep 2
  s_add_u32 s70, s70, 1
  s_cmp_lt_u32 s70, 262144
  s_cbranch_scc1 L_s3e
L_s3ed:
  v_mov_b32 v12, s20
  v_max3_f32 v10, v8, v12, s24
  v_min3_f32 v11, v8, v12, s24
  ds_write_b64 v38, v[10:11] offset:320
  ds_add_u32 v38, v17 offset:280
  s_mov_b64 exec, -1
  s_lshl_b32 s64, s8, 7
  s_load_dwordx8 s[20:27], s[42:43], s64 offset:1024 glc
  s_waitcnt lgkmcnt(0)
  s_xor_b32 s68, s20, s76
  s_xor_b32 s69, s21, s76
  s_or_b32 s68, s68, s69
  s_xor_b32 s69, s22, s76
  s_or_b32 s68, s68, s69
  s_xor_b32 s69, s23, s76
  s_or_b32 s68, s68, s69
  s_xor_b32 s69, s24, s76
  s_or_b32 s68, s68, s69
  s_xor_b32 s69, s25, s76
  s_or_b32 s68, s68, s69
  s_xor_b32 s69, s26, s76
  s_or_b32 s68, s68, s69
  s_xor_b32 s69, s27, s76
  s_or_b32 s68, s68, s69
  s_cselect_b32 s75, 0, 1
  v_lshlrev_b32 v20, 3, s7
  v_lshlrev_b32 v21, 3, s52
  v_lshlrev_b32 v22, 3, s53
  s_mov_b32 s70, 0
L_sn_11:
  ds_read_b32 v8, v38 offset:272
  s_waitcnt lgkmcnt(0)
  v_cmp_gt_u32 vcc, 0x2c0, v8
  s_cmp_eq_u64 vcc, 0
  s_cbranch_scc1 L_snd_12
  s_sleep 1
  s_add_u32 s70, s70, 1
  s_cmp_lt_u32 s70, 2097152
  s_cbranch_scc1 L_sn_11
L_snd_12:
  v_and_b32 v9, 15, v1
  v_lshlrev_b32 v9, 3, v9
  ds_read_b64 v[10:11], v9 offset:512
  s_waitcnt lgkmcnt(0)
  v_mov_b32 v16, v10
  v_max_f32_dpp v8, v10, v10 quad_perm:[1,0,3,2] row_mask:0xf bank_mask:0xf
  s_nop 1
  v_max_f32_dpp v8, v8, v8 quad_perm:[2,3,0,1] row_mask:0xf bank_mask:0xf
  s_nop 1
  v_max_f32_dpp v8, v8, v8 row_half_mirror row_mask:0xf bank_mask:0xf
  s_nop 1
  v_max_f32_dpp v8, v8, v8 row_mirror row_mask:0xf bank_mask:0xf
  v_sub_f32 v9, v10, v8
  v_mul_f32 v9, 0x3fb8aa3b, v9
  v_exp_f32 v9, v9
  s_nop 0
  v_mul_f32 v10, v9, v11
  s_nop 1
  v_add_f32_dpp v10, v10, v10 quad_perm:[1,0,3,2] row_mask:0xf bank_mask:0xf
  s_nop 1
  v_add_f32_dpp v10, v10, v10 quad_perm:[2,3,0,1] row_mask:0xf bank_mask:0xf
  s_nop 1
  v_add_f32_dpp v10, v10, v10 row_half_mirror row_mask:0xf bank_mask:0xf
  s_nop 1
  v_add_f32_dpp v10, v10, v10 row_mirror row_mask:0xf bank_mask:0xf
  s_load_dwordx4 s[20:23], s[42:43], s54 offset:98304 glc
  s_load_dwordx4 s[24:27], s[42:43], s55 offset:98304 glc
  v_mov_b32 v9, s74
  v_mov_b32 v11, s74
  s_mov_b64 exec, 1
  global_store_dwordx4 v19, v[8:11], s[42:43] sc1
  ds_write_b32 v20, v8 offset:448
  ds_write_b32 v20, v10 offset:452
  s_mov_b32 s70, 0
  s_branch L_s3pc
L_s3p:
  s_load_dwordx4 s[20:23], s[42:43], s54 offset:98304 glc
  s_load_dwordx4 s[24:27], s[42:43], s55 offset:98304 glc
L_s3pc:
  s_waitcnt lgkmcnt(0)
  s_xor_b32 s68, s21, s74
  s_xor_b32 s69, s23, s74
  s_or_b32 s68, s68, s69
  s_xor_b32 s69, s25, s74
  s_or_b32 s68, s68, s69
  s_xor_b32 s69, s27, s74
  s_or_b32 s68, s68, s69
  s_cbranch_scc0 L_s3pd
  s_sleep 2
  s_add_u32 s70, s70, 1
  s_cmp_lt_u32 s70, 262144
  s_cbranch_scc1 L_s3p
L_s3pd:
  v_mov_b32 v12, s20
  v_mov_b32 v13, s22
  v_mov_b32 v14, s24
  v_mov_b32 v15, s26
  v_max_f32 v23, v12, v14
  ds_max_f32 v38, v23 offset:276
  ds_add_u32 v38, v17 offset:272
  ds_add_u32 v38, v17 offset:300
  ds_write_b64 v21, v[12:13] offset:448
  ds_write_b64 v22, v[14:15] offset:448
  s_mov_b64 exec, -1
  v_and_b32 v9, 3, v1
  v_lshlrev_b32 v9, 3, v9
  ds_read_b64 v[10:11], v9 offset:448
  s_waitcnt lgkmcnt(0)
  v_max_f32_dpp v8, v10, v10 quad_perm:[1,0,3,2] row_mask:0xf bank_mask:0xf
  s_nop 1
  v_max_f32_dpp v8, v8, v8 quad_perm:[2,3,0,1] row_mask:0xf bank_mask:0xf
  v_sub_f32 v9, v10, v8
  v_mul_f32 v9, 0x3fb8aa3b, v9
  v_exp_f32 v9, v9
  s_nop 0
  v_mul_f32 v10, v9, v11
  s_nop 1
  v_add_f32_dpp v10, v10, v10 quad_perm:[1,0,3,2] row_mask:0xf bank_mask:0xf
  s_nop 1
  v_add_f32_dpp v10, v10, v10 quad_perm:[2,3,0,1] row_mask:0xf bank_mask:0xf
  v_sub_f32 v9, v16, v8
  v_rcp_f32 v10, v10
  v_mul_f32 v9, 0x3fb8aa3b, v9
  v_exp_f32 v9, v9
  v_lshlrev_b32 v8, 2, v1
  v_mul_f32 v9, v9, v10
  s_mov_b64 exec, 0xffff
  ds_write_b32 v8, v9 offset:384
  s_mov_b64 exec, -1
  ds_write_b32 v38, v38 offset:256
  s_mov_b32 s70, 0
L_sn_13:
  ds_read_b32 v8, v38 offset:304
  s_waitcnt lgkmcnt(0)
  v_cmp_gt_u32 vcc, 0xb, v8
  s_cmp_eq_u64 vcc, 0
  s_cbranch_scc1 L_snd_14
  s_sleep 1
  s_add_u32 s70, s70, 1
  s_cmp_lt_u32 s70, 2097152
  s_cbranch_scc1 L_sn_13
L_snd_14:
  v_lshlrev_b32 v74, 3, v1
  ds_read_b128 v[62:65], v38 offset:384
  ds_read_b128 v[66:69], v38 offset:400
  ds_read_b128 v[70:73], v38 offset:416
  ds_read_b64 v[40:41], v74 offset:6656
  ds_read_b64 v[42:43], v74 offset:7168
  ds_read_b64 v[44:45], v74 offset:7680
  ds_read_b64 v[46:47], v74 offset:8192
  ds_read_b64 v[48:49], v74 offset:8704
  ds_read_b64 v[50:51], v74 offset:9216
  ds_read_b64 v[52:53], v74 offset:9728
  ds_read_b64 v[54:55], v74 offset:10240
  ds_read_b64 v[56:57], v74 offset:10752
  ds_read_b64 v[58:59], v74 offset:11264
  ds_read_b64 v[60:61], v74 offset:11776
  s_lshl_b32 s68, s6, 2
  s_add_u32 s68, s68, s7
  s_lshl_b32 s68, s68, 9
  s_add_u32 s68, s68, 131072
  v_add_u32 v74, s68, v74
  v_and_b32 v75, 1, v1
  v_lshlrev_b32 v75, 4, v75
  v_lshrrev_b32 v75, v75, s74
  v_lshrrev_b32 v76, 8, v75
  s_movk_i32 s69, 0xff
  s_waitcnt lgkmcnt(10)
  v_pk_mul_f32 v[40:41], v[40:41], v[62:63] op_sel:[0,0] op_sel_hi:[1,0]
  s_waitcnt lgkmcnt(9)
  v_pk_mul_f32 v[42:43], v[42:43], v[62:63] op_sel:[0,1] op_sel_hi:[1,1]
  s_waitcnt lgkmcnt(8)
  v_pk_fma_f32 v[40:41], v[44:45], v[64:65], v[40:41] op_sel:[0,0,0] op_sel_hi:[1,0,1]
  s_waitcnt lgkmcnt(7)
  v_pk_fma_f32 v[42:43], v[46:47], v[64:65], v[42:43] op_sel:[0,1,0] op_sel_hi:[1,1,1]
  s_waitcnt lgkmcnt(6)
  v_pk_fma_f32 v[40:41], v[48:49], v[66:67], v[40:41] op_sel:[0,0,0] op_sel_hi:[1,0,1]
  s_waitcnt lgkmcnt(5)
  v_pk_fma_f32 v[42:43], v[50:51], v[66:67], v[42:43] op_sel:[0,1,0] op_sel_hi:[1,1,1]
  s_waitcnt lgkmcnt(4)
  v_pk_fma_f32 v[40:41], v[52:53], v[68:69], v[40:41] op_sel:[0,0,0] op_sel_hi:[1,0,1]
  s_waitcnt lgkmcnt(3)
  v_pk_fma_f32 v[42:43], v[54:55], v[68:69], v[42:43] op_sel:[0,1,0] op_sel_hi:[1,1,1]
  s_waitcnt lgkmcnt(2)
  v_pk_fma_f32 v[40:41], v[56:57], v[70:71], v[40:41] op_sel:[0,0,0] op_sel_hi:[1,0,1]
  s_waitcnt lgkmcnt(1)
  v_pk_fma_f32 v[42:43], v[58:59], v[70:71], v[42:43] op_sel:[0,1,0] op_sel_hi:[1,1,1]
  s_waitcnt lgkmcnt(0)
  v_pk_fma_f32 v[40:41], v[60:61], v[72:73], v[40:41] op_sel:[0,0,0] op_sel_hi:[1,0,1]
  v_pk_add_f32 v[40:41], v[40:41], v[42:43]
  v_bfi_b32 v40, s69, v75, v40
  v_bfi_b32 v41, s69, v76, v41
  s_cmp_eq_u32 s75, 1
  s_cbranch_scc0 L_pf_15
  global_store_dwordx2 v74, v[40:41], s[42:43]
  s_branch L_pe_16
L_pf_15:
  global_store_dwordx2 v74, v[40:41], s[42:43] sc1
L_pe_16:
  s_waitcnt vmcnt(0)
  s_mov_b32 s70, 0
L_sn_17:
  ds_read_b32 v8, v38 offset:308
  s_waitcnt lgkmcnt(0)
  v_cmp_gt_u32 vcc, 0x2, v8
  s_cmp_eq_u64 vcc, 0
  s_cbranch_scc1 L_snd_18
  s_sleep 8
  s_add_u32 s70, s70, 1
  s_cmp_lt_u32 s70, 2097152
  s_cbranch_scc1 L_sn_17
L_snd_18:
  global_store_dwordx2 v74, v[40:41], s[42:43] sc1
  s_cmp_lg_u32 s7, 2
  s_cbranch_scc1 L_fin
L_chk:
  v_and_b32 v160, 0xff, v75
  v_and_b32 v161, 0xff, v76
  s_lshl_b32 s10, s6, 11
  s_add_u32 s10, s10, 131072
  v_lshl_add_u32 v2, v1, 3, s10
  global_load_dwordx2 v[136:137], v2, s[42:43] offset:0 sc1
  global_load_dwordx2 v[138:139], v2, s[42:43] offset:512 sc1
  s_mov_b32 s70, 0
L_sn_19:
  ds_read_b32 v8, v38 offset:308
  s_waitcnt lgkmcnt(0)
  v_cmp_gt_u32 vcc, 0xb, v8
  s_cmp_eq_u64 vcc, 0
  s_cbranch_scc1 L_snd_20
  s_add_u32 s70, s70, 1
  s_cmp_lt_u32 s70, 2097152
  s_cbranch_scc1 L_sn_19
L_snd_20:
  v_add_u32 v3, 393216, v2
  global_load_dwordx2 v[144:145], v3, s[42:43] offset:0 sc1
  global_load_dwordx2 v[146:147], v3, s[42:43] offset:512 sc1
  v_lshlrev_b32 v114, 3, v1
  ds_read_b128 v[102:105], v38 offset:384
  ds_read_b128 v[106:109], v38 offset:400
  ds_read_b128 v[110:113], v38 offset:416
  ds_read_b64 v[80:81], v114 offset:1024
  ds_read_b64 v[82:83], v114 offset:1536
  ds_read_b64 v[84:85], v114 offset:2048
  ds_read_b64 v[86:87], v114 offset:2560
  ds_read_b64 v[88:89], v114 offset:3072
  ds_read_b64 v[90:91], v114 offset:3584
  ds_read_b64 v[92:93], v114 offset:4096
  ds_read_b64 v[94:95], v114 offset:4608
  ds_read_b64 v[96:97], v114 offset:5120
  ds_read_b64 v[98:99], v114 offset:5632
  ds_read_b64 v[100:101], v114 offset:6144
  s_lshl_b32 s68, s6, 2
  s_add_u32 s68, s68, s7
  s_lshl_b32 s68, s68, 9
  s_add_u32 s68, s68, 524288
  v_add_u32 v114, s68, v114
  v_and_b32 v115, 1, v1
  v_lshlrev_b32 v115, 4, v115
  v_lshrrev_b32 v115, v115, s74
  v_lshrrev_b32 v116, 8, v115
  s_movk_i32 s69, 0xff
  s_waitcnt lgkmcnt(10)
  v_pk_mul_f32 v[80:81], v[80:81], v[102:103] op_sel:[0,0] op_sel_hi:[1,0]
  s_waitcnt lgkmcnt(9)
  v_pk_mul_f32 v[82:83], v[82:83], v[102:103] op_sel:[0,1] op_sel_hi:[1,1]
  s_waitcnt lgkmcnt(8)
  v_pk_fma_f32 v[80:81], v[84:85], v[104:105], v[80:81] op_sel:[0,0,0] op_sel_hi:[1,0,1]
  s_waitcnt lgkmcnt(7)
  v_pk_fma_f32 v[82:83], v[86:87], v[104:105], v[82:83] op_sel:[0,1,0] op_sel_hi:[1,1,1]
  s_waitcnt lgkmcnt(6)
  v_pk_fma_f32 v[80:81], v[88:89], v[106:107], v[80:81] op_sel:[0,0,0] op_sel_hi:[1,0,1]
  s_waitcnt lgkmcnt(5)
  v_pk_fma_f32 v[82:83], v[90:91], v[106:107], v[82:83] op_sel:[0,1,0] op_sel_hi:[1,1,1]
  s_waitcnt lgkmcnt(4)
  v_pk_fma_f32 v[80:81], v[92:93], v[108:109], v[80:81] op_sel:[0,0,0] op_sel_hi:[1,0,1]
  s_waitcnt lgkmcnt(3)
  v_pk_fma_f32 v[82:83], v[94:95], v[108:109], v[82:83] op_sel:[0,1,0] op_sel_hi:[1,1,1]
  s_waitcnt lgkmcnt(2)
  v_pk_fma_f32 v[80:81], v[96:97], v[110:111], v[80:81] op_sel:[0,0,0] op_sel_hi:[1,0,1]
  s_waitcnt lgkmcnt(1)
  v_pk_fma_f32 v[82:83], v[98:99], v[110:111], v[82:83] op_sel:[0,1,0] op_sel_hi:[1,1,1]
  s_waitcnt lgkmcnt(0)
  v_pk_fma_f32 v[80:81], v[100:101], v[112:113], v[80:81] op_sel:[0,0,0] op_sel_hi:[1,0,1]
  v_pk_add_f32 v[80:81], v[80:81], v[82:83]
  v_bfi_b32 v80, s69, v115, v80
  v_bfi_b32 v81, s69, v116, v81
  global_store_dwordx2 v114, v[80:81], s[42:43] sc1
  s_waitcnt vmcnt(1)
  s_mov_b32 s70, 0
  s_branch L_cp0c
L_cp0:
  global_load_dwordx2 v[136:137], v2, s[42:43] offset:0 sc1
  global_load_dwordx2 v[138:139], v2, s[42:43] offset:512 sc1
  s_waitcnt vmcnt(0)
L_cp0c:
  v_mov_b32 v140, v40
  v_mov_b32 v141, v41
  v_xor_b32 v136, v136, v160
  v_xor_b32 v137, v137, v161
  v_xor_b32 v138, v138, v160
  v_xor_b32 v139, v139, v161
  v_xor_b32 v140, v140, v160
  v_xor_b32 v141, v141, v161
  v_or3_b32 v152, v136, v137, v138
  v_or3_b32 v153, v139, v140, v141
  v_or_b32 v136, 0x80, v136
  v_or_b32 v137, 0x80, v137
  v_or_b32 v138, 0x80, v138
  v_or_b32 v139, 0x80, v139
  v_or_b32 v140, 0x80, v140
  v_or_b32 v141, 0x80, v141
  v_or_b32 v152, v152, v153
  v_pk_add_f32 v[136:137], v[136:137], v[138:139]
  v_lshlrev_b32 v152, 24, v152
  v_pk_add_f32 v[136:137], v[136:137], v[140:141]
  v_cmp_ne_u32 vcc, 0, v152
  v_cvt_pk_bf16_f32 v136, v136, v137
  s_cmp_eq_u64 vcc, 0
  s_cbranch_scc1 L_cp0d
  s_sleep 4
  s_add_u32 s70, s70, 1
  s_cmp_lt_u32 s70, 262144
  s_cbranch_scc1 L_cp0
L_cp0d:
  v_add_u32 v2, 393216, v2
  s_mov_b32 s70, 0
  s_branch L_cp1c
L_cp1:
  global_load_dwordx2 v[144:145], v2, s[42:43] offset:0 sc1
  global_load_dwordx2 v[146:147], v2, s[42:43] offset:512 sc1
  s_waitcnt vmcnt(0)
L_cp1c:
  v_mov_b32 v148, v80
  v_mov_b32 v149, v81
  v_xor_b32 v144, v144, v160
  v_xor_b32 v145, v145, v161
  v_xor_b32 v146, v146, v160
  v_xor_b32 v147, v147, v161
  v_xor_b32 v148, v148, v160
  v_xor_b32 v149, v149, v161
  v_or3_b32 v152, v144, v145, v146
  v_or3_b32 v153, v147, v148, v149
  v_or_b32 v144, 0x80, v144
  v_or_b32 v145, 0x80, v145
  v_or_b32 v146, 0x80, v146
  v_or_b32 v147, 0x80, v147
  v_or_b32 v148, 0x80, v148
  v_or_b32 v149, 0x80, v149
  v_or_b32 v152, v152, v153
  v_pk_add_f32 v[144:145], v[144:145], v[146:147]
  v_lshlrev_b32 v152, 24, v152
  v_pk_add_f32 v[144:145], v[144:145], v[148:149]
  v_cmp_ne_u32 vcc, 0, v152
  v_cvt_pk_bf16_f32 v144, v144, v145
  s_cmp_eq_u64 vcc, 0
  s_cbranch_scc1 L_cp1d
  s_add_u32 s70, s70, 1
  s_cmp_lt_u32 s70, 262144
  s_cbranch_scc1 L_cp1
L_cp1d:
  v_cmp_ne_u32 vcc, v136, v144
  s_cmp_eq_u64 vcc, 0
  s_cbranch_scc1 L_fin
L_slow:
  s_mov_b32 s47, 0x20000
  s_load_dwordx16 s[16:31], s[0:1], 0
  s_load_dwordx8 s[32:39], s[0:1], 64
  v_and_b32 v2, 31, v1
  v_lshlrev_b32 v2, 7, v2
  v_add_u32 v2, 28672, v2
  s_mov_b32 s70, 0
L_sl_d:
  global_load_dword v3, v2, s[42:43] sc1
  s_waitcnt vmcnt(0) lgkmcnt(0)
  v_cmp_ne_u32 vcc, s74, v3
  s_cmp_eq_u64 vcc, 0
  s_cbranch_scc1 L_sl_dd
  s_sleep 8
  s_add_u32 s70, s70, 1
  s_cmp_lt_u32 s70, 262144
  s_cbranch_scc1 L_sl_d
L_sl_dd:
  v_lshlrev_b32 v2, 3, v1
  v_add_u32 v2, 524288, v2
  v_lshlrev_b32 v0, 2, v1
  v_add_u32 v0, 12288, v0
  s_mov_b32 s10, 0
L_sl_h:
  s_mov_b32 s70, 0
L_sl_hp:
  global_load_dwordx2 v[40:41], v2, s[42:43] offset:0 sc1
  global_load_dwordx2 v[42:43], v2, s[42:43] offset:512 sc1
  global_load_dwordx2 v[44:45], v2, s[42:43] offset:1024 sc1
  s_waitcnt vmcnt(0)
  v_xor_b32 v40, v40, v160
  v_xor_b32 v41, v41, v161
  v_xor_b32 v42, v42, v160
  v_xor_b32 v43, v43, v161
  v_xor_b32 v44, v44, v160
  v_xor_b32 v45, v45, v161
  v_or3_b32 v48, v40, v41, v42
  v_or3_b32 v49, v43, v44, v45
  v_or_b32 v40, 0x80, v40
  v_or_b32 v41, 0x80, v41
  v_or_b32 v42, 0x80, v42
  v_or_b32 v43, 0x80, v43
  v_or_b32 v44, 0x80, v44
  v_or_b32 v45, 0x80, v45
  v_or_b32 v48, v48, v49
  v_pk_add_f32 v[40:41], v[40:41], v[42:43]
  v_lshlrev_b32 v48, 24, v48
  v_pk_add_f32 v[40:41], v[40:41], v[44:45]
  v_cmp_ne_u32 vcc, 0, v48
  v_cvt_pk_bf16_f32 v40, v40, v41
  s_cmp_eq_u64 vcc, 0
  s_cbranch_scc1 L_sl_hd
  s_sleep 8
  s_add_u32 s70, s70, 1
  s_cmp_lt_u32 s70, 262144
  s_cbranch_scc1 L_sl_hp
L_sl_hd:
  ds_write_b32 v0, v40
  v_add_u32 v2, 2048, v2
  v_add_u32 v0, 256, v0
  s_add_u32 s10, s10, 1
  s_cmp_lt_u32 s10, 64
  s_cbranch_scc1 L_sl_h
  s_mov_b32 s44, s24
  s_mov_b32 s45, s25
  s_mov_b32 s46, 4194304
  s_mov_b32 s11, 1024
  s_mov_b32 s12, 4194304
  v_mov_b32 v4, 12288
  v_mov_b32 v5, 20480
  v_lshlrev_b32 v2, 4, v1
  s_call_b64 s[62:63], L_gv
  v_lshlrev_b32 v0, 4, v1
  global_load_dwordx4 v[40:43], v0, s[16:17] offset:0
  global_load_dwordx4 v[44:47], v0, s[16:17] offset:1024
  s_waitcnt vmcnt(0)
  v_lshlrev_b32 v104, 16, v40
  v_and_b32 v105, s73, v40
  v_lshlrev_b32 v106, 16, v41
  v_and_b32 v107, s73, v41
  v_lshlrev_b32 v108, 16, v42
  v_and_b32 v109, s73, v42
  v_lshlrev_b32 v110, 16, v43
  v_and_b32 v111, s73, v43
  v_lshlrev_b32 v112, 16, v44
  v_and_b32 v113, s73, v44
  v_lshlrev_b32 v114, 16, v45
  v_and_b32 v115, s73, v45
  v_lshlrev_b32 v116, 16, v46
  v_and_b32 v117, s73, v46
  v_lshlrev_b32 v118, 16, v47
  v_and_b32 v119, s73, v47
  v_lshrrev_b32 v2, 1, v1
  v_lshlrev_b32 v2, 7, v2
  v_and_b32 v3, 1, v1
  v_lshl_add_u32 v2, v3, 5, v2
  v_add_u32 v2, 12288, v2
  global_load_dwordx4 v[40:43], v2, s[42:43] offset:0 sc1
  global_load_dwordx4 v[44:47], v2, s[42:43] offset:16 sc1
  global_load_dwordx4 v[48:51], v2, s[42:43] offset:64 sc1
  global_load_dwordx4 v[52:55], v2, s[42:43] offset:80 sc1
  s_waitcnt vmcnt(0)
  v_lshlrev_b32 v88, 16, v40
  v_and_b32 v89, s73, v40
  v_lshlrev_b32 v90, 16, v42
  v_and_b32 v91, s73, v42
  v_lshlrev_b32 v92, 16, v44
  v_and_b32 v93, s73, v44
  v_lshlrev_b32 v94, 16, v46
  v_and_b32 v95, s73, v46
  v_lshlrev_b32 v96, 16, v48
  v_and_b32 v97, s73, v48
  v_lshlrev_b32 v98, 16, v50
  v_and_b32 v99, s73, v50
  v_lshlrev_b32 v100, 16, v52
  v_and_b32 v101, s73, v52
  v_lshlrev_b32 v102, 16, v54
  v_and_b32 v103, s73, v54
  v_cvt_pk_bf16_f32 v72, 0, v72
  v_cvt_pk_bf16_f32 v73, 0, v73
  v_cvt_pk_bf16_f32 v74, 0, v74
  v_cvt_pk_bf16_f32 v75, 0, v75
  v_cvt_pk_bf16_f32 v76, 0, v76
  v_cvt_pk_bf16_f32 v77, 0, v77
  v_cvt_pk_bf16_f32 v78, 0, v78
  v_cvt_pk_bf16_f32 v79, 0, v79
  v_cvt_pk_bf16_f32 v80, 0, v80
  v_cvt_pk_bf16_f32 v81, 0, v81
  v_cvt_pk_bf16_f32 v82, 0, v82
  v_cvt_pk_bf16_f32 v83, 0, v83
  v_cvt_pk_bf16_f32 v84, 0, v84
  v_cvt_pk_bf16_f32 v85, 0, v85
  v_cvt_pk_bf16_f32 v86, 0, v86
  v_cvt_pk_bf16_f32 v87, 0, v87
  v_mul_f32 v72, v72, v88
  v_mul_f32 v73, v73, v89
  v_mul_f32 v74, v74, v90
  v_mul_f32 v75, v75, v91
  v_mul_f32 v76, v76, v92
  v_mul_f32 v77, v77, v93
  v_mul_f32 v78, v78, v94
  v_mul_f32 v79, v79, v95
  v_mul_f32 v80, v80, v96
  v_mul_f32 v81, v81, v97
  v_mul_f32 v82, v82, v98
  v_mul_f32 v83, v83, v99
  v_mul_f32 v84, v84, v100
  v_mul_f32 v85, v85, v101
  v_mul_f32 v86, v86, v102
  v_mul_f32 v87, v87, v103
  v_cvt_pk_bf16_f32 v72, 0, v72
  v_cvt_pk_bf16_f32 v73, 0, v73
  v_cvt_pk_bf16_f32 v74, 0, v74
  v_cvt_pk_bf16_f32 v75, 0, v75
  v_cvt_pk_bf16_f32 v76, 0, v76
  v_cvt_pk_bf16_f32 v77, 0, v77
  v_cvt_pk_bf16_f32 v78, 0, v78
  v_cvt_pk_bf16_f32 v79, 0, v79
  v_cvt_pk_bf16_f32 v80, 0, v80
  v_cvt_pk_bf16_f32 v81, 0, v81
  v_cvt_pk_bf16_f32 v82, 0, v82
  v_cvt_pk_bf16_f32 v83, 0, v83
  v_cvt_pk_bf16_f32 v84, 0, v84
  v_cvt_pk_bf16_f32 v85, 0, v85
  v_cvt_pk_bf16_f32 v86, 0, v86
  v_cvt_pk_bf16_f32 v87, 0, v87
  v_add_f32 v104, v104, v72
  v_add_f32 v105, v105, v73
  v_add_f32 v106, v106, v74
  v_add_f32 v107, v107, v75
  v_add_f32 v108, v108, v76
  v_add_f32 v109, v109, v77
  v_add_f32 v110, v110, v78
  v_add_f32 v111, v111, v79
  v_add_f32 v112, v112, v80
  v_add_f32 v113, v113, v81
  v_add_f32 v114, v114, v82
  v_add_f32 v115, v115, v83
  v_add_f32 v116, v116, v84
  v_add_f32 v117, v117, v85
  v_add_f32 v118, v118, v86
  v_add_f32 v119, v119, v87
  v_cvt_pk_bf16_f32 v104, 0, v104
  v_cvt_pk_bf16_f32 v105, 0, v105
  v_cvt_pk_bf16_f32 v106, 0, v106
  v_cvt_pk_bf16_f32 v107, 0, v107
  v_cvt_pk_bf16_f32 v108, 0, v108
  v_cvt_pk_bf16_f32 v109, 0, v109
  v_cvt_pk_bf16_f32 v110, 0, v110
  v_cvt_pk_bf16_f32 v111, 0, v111
  v_cvt_pk_bf16_f32 v112, 0, v112
  v_cvt_pk_bf16_f32 v113, 0, v113
  v_cvt_pk_bf16_f32 v114, 0, v114
  v_cvt_pk_bf16_f32 v115, 0, v115
  v_cvt_pk_bf16_f32 v116, 0, v116
  v_cvt_pk_bf16_f32 v117, 0, v117
  v_cvt_pk_bf16_f32 v118, 0, v118
  v_cvt_pk_bf16_f32 v119, 0, v119
  v_add_f32 v8, v104, v105
  v_add_f32 v8, v8, v106
  v_add_f32 v8, v8, v107
  v_add_f32 v8, v8, v108
  v_add_f32 v8, v8, v109
  v_add_f32 v8, v8, v110
  v_add_f32 v8, v8, v111
  s_nop 1
  v_add_f32_dpp v8, v8, v8 row_ror:8 row_mask:0xf bank_mask:0xf
  s_nop 1
  v_add_f32_dpp v8, v8, v8 row_ror:4 row_mask:0xf bank_mask:0xf
  s_nop 1
  v_add_f32_dpp v8, v8, v8 row_ror:2 row_mask:0xf bank_mask:0xf
  s_nop 1
  v_add_f32_dpp v8, v8, v8 row_ror:1 row_mask:0xf bank_mask:0xf
  v_mov_b32 v9, v8
  s_nop 1
  v_permlane16_swap_b32 v9, v8
  v_add_f32 v8, v8, v9
  v_mov_b32 v9, v8
  s_nop 1
  v_permlane32_swap_b32 v9, v8
  v_add_f32 v8, v8, v9
  v_mul_f32 v8, 0x3b000000, v8
  v_sub_f32 v72, v104, v8
  v_sub_f32 v73, v105, v8
  v_sub_f32 v74, v106, v8
  v_sub_f32 v75, v107, v8
  v_sub_f32 v76, v108, v8
  v_sub_f32 v77, v109, v8
  v_sub_f32 v78, v110, v8
  v_sub_f32 v79, v111, v8
  v_mul_f32 v10, v72, v72
  v_fmac_f32 v10, v73, v73
  v_fmac_f32 v10, v74, v74
  v_fmac_f32 v10, v75, v75
  v_fmac_f32 v10, v76, v76
  v_fmac_f32 v10, v77, v77
  v_fmac_f32 v10, v78, v78
  v_fmac_f32 v10, v79, v79
  s_nop 1
  v_add_f32_dpp v10, v10, v10 row_ror:8 row_mask:0xf bank_mask:0xf
  s_nop 1
  v_add_f32_dpp v10, v10, v10 row_ror:4 row_mask:0xf bank_mask:0xf
  s_nop 1
  v_add_f32_dpp v10, v10, v10 row_ror:2 row_mask:0xf bank_mask:0xf
  s_nop 1
  v_add_f32_dpp v10, v10, v10 row_ror:1 row_mask:0xf bank_mask:0xf
  v_mov_b32 v9, v10
  s_nop 1
  v_permlane16_swap_b32 v9, v10
  v_add_f32 v10, v10, v9
  v_mov_b32 v9, v10
  s_nop 1
  v_permlane32_swap_b32 v9, v10
  v_add_f32 v10, v10, v9
  v_mul_f32 v10, 0x3b000000, v10
  v_cvt_pk_bf16_f32 v8, 0, v8
  v_cvt_pk_bf16_f32 v10, 0, v10
  v_add_f32 v10, 0x3727c5ac, v10
  v_cvt_pk_bf16_f32 v10, 0, v10
  v_sqrt_f32 v10, v10
  v_sub_f32 v72, v104, v8
  v_sub_f32 v73, v105, v8
  v_sub_f32 v74, v106, v8
  v_sub_f32 v75, v107, v8
  v_sub_f32 v76, v108, v8
  v_sub_f32 v77, v109, v8
  v_sub_f32 v78, v110, v8
  v_sub_f32 v79, v111, v8
  v_cvt_pk_bf16_f32 v10, 0, v10
  v_cvt_pk_bf16_f32 v72, 0, v72
  v_cvt_pk_bf16_f32 v73, 0, v73
  v_cvt_pk_bf16_f32 v74, 0, v74
  v_cvt_pk_bf16_f32 v75, 0, v75
  v_cvt_pk_bf16_f32 v76, 0, v76
  v_cvt_pk_bf16_f32 v77, 0, v77
  v_cvt_pk_bf16_f32 v78, 0, v78
  v_cvt_pk_bf16_f32 v79, 0, v79
  v_rcp_f32 v10, v10
  s_nop 0
  v_mul_f32 v72, v72, v10
  v_mul_f32 v73, v73, v10
  v_mul_f32 v74, v74, v10
  v_mul_f32 v75, v75, v10
  v_mul_f32 v76, v76, v10
  v_mul_f32 v77, v77, v10
  v_mul_f32 v78, v78, v10
  v_mul_f32 v79, v79, v10
  v_cvt_pk_bf16_f32 v72, 0, v72
  v_cvt_pk_bf16_f32 v73, 0, v73
  v_cvt_pk_bf16_f32 v74, 0, v74
  v_cvt_pk_bf16_f32 v75, 0, v75
  v_cvt_pk_bf16_f32 v76, 0, v76
  v_cvt_pk_bf16_f32 v77, 0, v77
  v_cvt_pk_bf16_f32 v78, 0, v78
  v_cvt_pk_bf16_f32 v79, 0, v79
  v_add_f32 v8, v112, v113
  v_add_f32 v8, v8, v114
  v_add_f32 v8, v8, v115
  v_add_f32 v8, v8, v116
  v_add_f32 v8, v8, v117
  v_add_f32 v8, v8, v118
  v_add_f32 v8, v8, v119
  s_nop 1
  v_add_f32_dpp v8, v8, v8 row_ror:8 row_mask:0xf bank_mask:0xf
  s_nop 1
  v_add_f32_dpp v8, v8, v8 row_ror:4 row_mask:0xf bank_mask:0xf
  s_nop 1
  v_add_f32_dpp v8, v8, v8 row_ror:2 row_mask:0xf bank_mask:0xf
  s_nop 1
  v_add_f32_dpp v8, v8, v8 row_ror:1 row_mask:0xf bank_mask:0xf
  v_mov_b32 v9, v8
  s_nop 1
  v_permlane16_swap_b32 v9, v8
  v_add_f32 v8, v8, v9
  v_mov_b32 v9, v8
  s_nop 1
  v_permlane32_swap_b32 v9, v8
  v_add_f32 v8, v8, v9
  v_mul_f32 v8, 0x3b000000, v8
  v_sub_f32 v80, v112, v8
  v_sub_f32 v81, v113, v8
  v_sub_f32 v82, v114, v8
  v_sub_f32 v83, v115, v8
  v_sub_f32 v84, v116, v8
  v_sub_f32 v85, v117, v8
  v_sub_f32 v86, v118, v8
  v_sub_f32 v87, v119, v8
  v_mul_f32 v10, v80, v80
  v_fmac_f32 v10, v81, v81
  v_fmac_f32 v10, v82, v82
  v_fmac_f32 v10, v83, v83
  v_fmac_f32 v10, v84, v84
  v_fmac_f32 v10, v85, v85
  v_fmac_f32 v10, v86, v86
  v_fmac_f32 v10, v87, v87
  s_nop 1
  v_add_f32_dpp v10, v10, v10 row_ror:8 row_mask:0xf bank_mask:0xf
  s_nop 1
  v_add_f32_dpp v10, v10, v10 row_ror:4 row_mask:0xf bank_mask:0xf
  s_nop 1
  v_add_f32_dpp v10, v10, v10 row_ror:2 row_mask:0xf bank_mask:0xf
  s_nop 1
  v_add_f32_dpp v10, v10, v10 row_ror:1 row_mask:0xf bank_mask:0xf
  v_mov_b32 v9, v10
  s_nop 1
  v_permlane16_swap_b32 v9, v10
  v_add_f32 v10, v10, v9
  v_mov_b32 v9, v10
  s_nop 1
  v_permlane32_swap_b32 v9, v10
  v_add_f32 v10, v10, v9
  v_mul_f32 v10, 0x3b000000, v10
  v_cvt_pk_bf16_f32 v8, 0, v8
  v_cvt_pk_bf16_f32 v10, 0, v10
  v_add_f32 v10, 0x3727c5ac, v10
  v_cvt_pk_bf16_f32 v10, 0, v10
  v_sqrt_f32 v10, v10
  v_sub_f32 v80, v112, v8
  v_sub_f32 v81, v113, v8
  v_sub_f32 v82, v114, v8
  v_sub_f32 v83, v115, v8
  v_sub_f32 v84, v116, v8
  v_sub_f32 v85, v117, v8
  v_sub_f32 v86, v118, v8
  v_sub_f32 v87, v119, v8
  v_cvt_pk_bf16_f32 v10, 0, v10
  v_cvt_pk_bf16_f32 v80, 0, v80
  v_cvt_pk_bf16_f32 v81, 0, v81
  v_cvt_pk_bf16_f32 v82, 0, v82
  v_cvt_pk_bf16_f32 v83, 0, v83
  v_cvt_pk_bf16_f32 v84, 0, v84
  v_cvt_pk_bf16_f32 v85, 0, v85
  v_cvt_pk_bf16_f32 v86, 0, v86
  v_cvt_pk_bf16_f32 v87, 0, v87
  v_rcp_f32 v10, v10
  s_nop 0
  v_mul_f32 v80, v80, v10
  v_mul_f32 v81, v81, v10
  v_mul_f32 v82, v82, v10
  v_mul_f32 v83, v83, v10
  v_mul_f32 v84, v84, v10
  v_mul_f32 v85, v85, v10
  v_mul_f32 v86, v86, v10
  v_mul_f32 v87, v87, v10
  v_cvt_pk_bf16_f32 v80, 0, v80
  v_cvt_pk_bf16_f32 v81, 0, v81
  v_cvt_pk_bf16_f32 v82, 0, v82
  v_cvt_pk_bf16_f32 v83, 0, v83
  v_cvt_pk_bf16_f32 v84, 0, v84
  v_cvt_pk_bf16_f32 v85, 0, v85
  v_cvt_pk_bf16_f32 v86, 0, v86
  v_cvt_pk_bf16_f32 v87, 0, v87
  v_lshrrev_b32 v2, 1, v1
  v_lshlrev_b32 v2, 7, v2
  v_and_b32 v3, 1, v1
  v_lshl_add_u32 v2, v3, 5, v2
  v_add_u32 v2, 20480, v2
  global_load_dwordx4 v[40:43], v2, s[42:43] offset:0 sc1
  global_load_dwordx4 v[44:47], v2, s[42:43] offset:16 sc1
  global_load_dwordx4 v[48:51], v2, s[42:43] offset:64 sc1
  global_load_dwordx4 v[52:55], v2, s[42:43] offset:80 sc1
  s_waitcnt vmcnt(0)
  v_lshlrev_b32 v88, 16, v40
  v_and_b32 v89, s73, v40
  v_lshlrev_b32 v90, 16, v42
  v_and_b32 v91, s73, v42
  v_lshlrev_b32 v92, 16, v44
  v_and_b32 v93, s73, v44
  v_lshlrev_b32 v94, 16, v46
  v_and_b32 v95, s73, v46
  v_lshlrev_b32 v96, 16, v48
  v_and_b32 v97, s73, v48
  v_lshlrev_b32 v98, 16, v50
  v_and_b32 v99, s73, v50
  v_lshlrev_b32 v100, 16, v52
  v_and_b32 v101, s73, v52
  v_lshlrev_b32 v102, 16, v54
  v_and_b32 v103, s73, v54
  v_add_f32 v88, 1.0, v88
  v_add_f32 v89, 1.0, v89
  v_add_f32 v90, 1.0, v90
  v_add_f32 v91, 1.0, v91
  v_add_f32 v92, 1.0, v92
  v_add_f32 v93, 1.0, v93
  v_add_f32 v94, 1.0, v94
  v_add_f32 v95, 1.0, v95
  v_add_f32 v96, 1.0, v96
  v_add_f32 v97, 1.0, v97
  v_add_f32 v98, 1.0, v98
  v_add_f32 v99, 1.0, v99
  v_add_f32 v100, 1.0, v100
  v_add_f32 v101, 1.0, v101
  v_add_f32 v102, 1.0, v102
  v_add_f32 v103, 1.0, v103
  v_cvt_pk_bf16_f32 v88, 0, v88
  v_cvt_pk_bf16_f32 v89, 0, v89
  v_cvt_pk_bf16_f32 v90, 0, v90
  v_cvt_pk_bf16_f32 v91, 0, v91
  v_cvt_pk_bf16_f32 v92, 0, v92
  v_cvt_pk_bf16_f32 v93, 0, v93
  v_cvt_pk_bf16_f32 v94, 0, v94
  v_cvt_pk_bf16_f32 v95, 0, v95
  v_cvt_pk_bf16_f32 v96, 0, v96
  v_cvt_pk_bf16_f32 v97, 0, v97
  v_cvt_pk_bf16_f32 v98, 0, v98
  v_cvt_pk_bf16_f32 v99, 0, v99
  v_cvt_pk_bf16_f32 v100, 0, v100
  v_cvt_pk_bf16_f32 v101, 0, v101
  v_cvt_pk_bf16_f32 v102, 0, v102
  v_cvt_pk_bf16_f32 v103, 0, v103
  v_mul_f32 v72, v72, v88
  v_mul_f32 v73, v73, v89
  v_mul_f32 v74, v74, v90
  v_mul_f32 v75, v75, v91
  v_mul_f32 v76, v76, v92
  v_mul_f32 v77, v77, v93
  v_mul_f32 v78, v78, v94
  v_mul_f32 v79, v79, v95
  v_mul_f32 v80, v80, v96
  v_mul_f32 v81, v81, v97
  v_mul_f32 v82, v82, v98
  v_mul_f32 v83, v83, v99
  v_mul_f32 v84, v84, v100
  v_mul_f32 v85, v85, v101
  v_mul_f32 v86, v86, v102
  v_mul_f32 v87, v87, v103
  v_cvt_pk_bf16_f32 v72, 0, v72
  v_cvt_pk_bf16_f32 v73, 0, v73
  v_cvt_pk_bf16_f32 v74, 0, v74
  v_cvt_pk_bf16_f32 v75, 0, v75
  v_cvt_pk_bf16_f32 v76, 0, v76
  v_cvt_pk_bf16_f32 v77, 0, v77
  v_cvt_pk_bf16_f32 v78, 0, v78
  v_cvt_pk_bf16_f32 v79, 0, v79
  v_cvt_pk_bf16_f32 v80, 0, v80
  v_cvt_pk_bf16_f32 v81, 0, v81
  v_cvt_pk_bf16_f32 v82, 0, v82
  v_cvt_pk_bf16_f32 v83, 0, v83
  v_cvt_pk_bf16_f32 v84, 0, v84
  v_cvt_pk_bf16_f32 v85, 0, v85
  v_cvt_pk_bf16_f32 v86, 0, v86
  v_cvt_pk_bf16_f32 v87, 0, v87
  v_lshrrev_b32 v2, 1, v1
  v_lshlrev_b32 v2, 7, v2
  v_and_b32 v3, 1, v1
  v_lshl_add_u32 v2, v3, 5, v2
  v_add_u32 v2, 16384, v2
  global_load_dwordx4 v[40:43], v2, s[42:43] offset:0 sc1
  global_load_dwordx4 v[44:47], v2, s[42:43] offset:16 sc1
  global_load_dwordx4 v[48:51], v2, s[42:43] offset:64 sc1
  global_load_dwordx4 v[52:55], v2, s[42:43] offset:80 sc1
  s_waitcnt vmcnt(0)
  v_lshlrev_b32 v88, 16, v40
  v_and_b32 v89, s73, v40
  v_lshlrev_b32 v90, 16, v42
  v_and_b32 v91, s73, v42
  v_lshlrev_b32 v92, 16, v44
  v_and_b32 v93, s73, v44
  v_lshlrev_b32 v94, 16, v46
  v_and_b32 v95, s73, v46
  v_lshlrev_b32 v96, 16, v48
  v_and_b32 v97, s73, v48
  v_lshlrev_b32 v98, 16, v50
  v_and_b32 v99, s73, v50
  v_lshlrev_b32 v100, 16, v52
  v_and_b32 v101, s73, v52
  v_lshlrev_b32 v102, 16, v54
  v_and_b32 v103, s73, v54
  v_add_f32 v72, v72, v88
  v_add_f32 v73, v73, v89
  v_add_f32 v74, v74, v90
  v_add_f32 v75, v75, v91
  v_add_f32 v76, v76, v92
  v_add_f32 v77, v77, v93
  v_add_f32 v78, v78, v94
  v_add_f32 v79, v79, v95
  v_add_f32 v80, v80, v96
  v_add_f32 v81, v81, v97
  v_add_f32 v82, v82, v98
  v_add_f32 v83, v83, v99
  v_add_f32 v84, v84, v100
  v_add_f32 v85, v85, v101
  v_add_f32 v86, v86, v102
  v_add_f32 v87, v87, v103
  v_cvt_pk_bf16_f32 v40, v72, v73
  v_cvt_pk_bf16_f32 v41, v74, v75
  v_cvt_pk_bf16_f32 v42, v76, v77
  v_cvt_pk_bf16_f32 v43, v78, v79
  v_cvt_pk_bf16_f32 v44, v80, v81
  v_cvt_pk_bf16_f32 v45, v82, v83
  v_cvt_pk_bf16_f32 v46, v84, v85
  v_cvt_pk_bf16_f32 v47, v86, v87
  v_add_u32 v3, 12288, v0
  ds_write_b128 v3, v[40:43] offset:0
  ds_write_b128 v3, v[44:47] offset:1024
  s_mov_b32 s44, s28
  s_mov_b32 s45, s29
  s_mov_b32 s46, 1409024
  s_mov_b32 s11, 2752
  s_mov_b32 s12, 1409024
  v_mov_b32 v4, 12288
  v_mov_b32 v5, 13312
  v_lshlrev_b32 v2, 4, v1
  s_call_b64 s[62:63], L_gv
  v_cvt_pk_bf16_f32 v120, 0, v72
  v_cvt_pk_bf16_f32 v121, 0, v73
  v_cvt_pk_bf16_f32 v122, 0, v74
  v_cvt_pk_bf16_f32 v123, 0, v75
  v_cvt_pk_bf16_f32 v124, 0, v76
  v_cvt_pk_bf16_f32 v125, 0, v77
  v_cvt_pk_bf16_f32 v126, 0, v78
  v_cvt_pk_bf16_f32 v127, 0, v79
  v_cvt_pk_bf16_f32 v128, 0, v80
  v_cvt_pk_bf16_f32 v129, 0, v81
  v_cvt_pk_bf16_f32 v130, 0, v82
  v_cvt_pk_bf16_f32 v131, 0, v83
  v_cvt_pk_bf16_f32 v132, 0, v84
  v_cvt_pk_bf16_f32 v133, 0, v85
  v_cvt_pk_bf16_f32 v134, 0, v86
  v_cvt_pk_bf16_f32 v135, 0, v87
  s_mov_b32 s44, s30
  s_mov_b32 s45, s31
  s_mov_b32 s46, 1409024
  s_mov_b32 s11, 2752
  s_mov_b32 s12, 1409024
  v_mov_b32 v4, 12288
  v_mov_b32 v5, 13312
  v_lshlrev_b32 v2, 4, v1
  s_call_b64 s[62:63], L_gv
  v_mul_f32 v88, 0xbfb8aa3b, v120
  v_mul_f32 v89, 0xbfb8aa3b, v121
  v_mul_f32 v90, 0xbfb8aa3b, v122
  v_mul_f32 v91, 0xbfb8aa3b, v123
  v_exp_f32 v88, v88
  v_exp_f32 v89, v89
  v_exp_f32 v90, v90
  v_exp_f32 v91, v91
  s_nop 0
  v_add_f32 v88, 1.0, v88
  v_add_f32 v89, 1.0, v89
  v_add_f32 v90, 1.0, v90
  v_add_f32 v91, 1.0, v91
  v_rcp_f32 v88, v88
  v_rcp_f32 v89, v89
  v_rcp_f32 v90, v90
  v_rcp_f32 v91, v91
  s_nop 0
  v_mul_f32 v120, v120, v88
  v_mul_f32 v121, v121, v89
  v_mul_f32 v122, v122, v90
  v_mul_f32 v123, v123, v91
  v_mul_f32 v88, 0xbfb8aa3b, v124
  v_mul_f32 v89, 0xbfb8aa3b, v125
  v_mul_f32 v90, 0xbfb8aa3b, v126
  v_mul_f32 v91, 0xbfb8aa3b, v127
  v_exp_f32 v88, v88
  v_exp_f32 v89, v89
  v_exp_f32 v90, v90
  v_exp_f32 v91, v91
  s_nop 0
  v_add_f32 v88, 1.0, v88
  v_add_f32 v89, 1.0, v89
  v_add_f32 v90, 1.0, v90
  v_add_f32 v91, 1.0, v91
  v_rcp_f32 v88, v88
  v_rcp_f32 v89, v89
  v_rcp_f32 v90, v90
  v_rcp_f32 v91, v91
  s_nop 0
  v_mul_f32 v124, v124, v88
  v_mul_f32 v125, v125, v89
  v_mul_f32 v126, v126, v90
  v_mul_f32 v127, v127, v91
  v_mul_f32 v88, 0xbfb8aa3b, v128
  v_mul_f32 v89, 0xbfb8aa3b, v129
  v_mul_f32 v90, 0xbfb8aa3b, v130
  v_mul_f32 v91, 0xbfb8aa3b, v131
  v_exp_f32 v88, v88
  v_exp_f32 v89, v89
  v_exp_f32 v90, v90
  v_exp_f32 v91, v91
  s_nop 0
  v_add_f32 v88, 1.0, v88
  v_add_f32 v89, 1.0, v89
  v_add_f32 v90, 1.0, v90
  v_add_f32 v91, 1.0, v91
  v_rcp_f32 v88, v88
  v_rcp_f32 v89, v89
  v_rcp_f32 v90, v90
  v_rcp_f32 v91, v91
  s_nop 0
  v_mul_f32 v128, v128, v88
  v_mul_f32 v129, v129, v89
  v_mul_f32 v130, v130, v90
  v_mul_f32 v131, v131, v91
  v_mul_f32 v88, 0xbfb8aa3b, v132
  v_mul_f32 v89, 0xbfb8aa3b, v133
  v_mul_f32 v90, 0xbfb8aa3b, v134
  v_mul_f32 v91, 0xbfb8aa3b, v135
  v_exp_f32 v88, v88
  v_exp_f32 v89, v89
  v_exp_f32 v90, v90
  v_exp_f32 v91, v91
  s_nop 0
  v_add_f32 v88, 1.0, v88
  v_add_f32 v89, 1.0, v89
  v_add_f32 v90, 1.0, v90
  v_add_f32 v91, 1.0, v91
  v_rcp_f32 v88, v88
  v_rcp_f32 v89, v89
  v_rcp_f32 v90, v90
  v_rcp_f32 v91, v91
  s_nop 0
  v_mul_f32 v132, v132, v88
  v_mul_f32 v133, v133, v89
  v_mul_f32 v134, v134, v90
  v_mul_f32 v135, v135, v91
  v_cvt_pk_bf16_f32 v120, 0, v120
  v_cvt_pk_bf16_f32 v121, 0, v121
  v_cvt_pk_bf16_f32 v122, 0, v122
  v_cvt_pk_bf16_f32 v123, 0, v123
  v_cvt_pk_bf16_f32 v124, 0, v124
  v_cvt_pk_bf16_f32 v125, 0, v125
  v_cvt_pk_bf16_f32 v126, 0, v126
  v_cvt_pk_bf16_f32 v127, 0, v127
  v_cvt_pk_bf16_f32 v128, 0, v128
  v_cvt_pk_bf16_f32 v129, 0, v129
  v_cvt_pk_bf16_f32 v130, 0, v130
  v_cvt_pk_bf16_f32 v131, 0, v131
  v_cvt_pk_bf16_f32 v132, 0, v132
  v_cvt_pk_bf16_f32 v133, 0, v133
  v_cvt_pk_bf16_f32 v134, 0, v134
  v_cvt_pk_bf16_f32 v135, 0, v135
  v_cvt_pk_bf16_f32 v72, 0, v72
  v_cvt_pk_bf16_f32 v73, 0, v73
  v_cvt_pk_bf16_f32 v74, 0, v74
  v_cvt_pk_bf16_f32 v75, 0, v75
  v_cvt_pk_bf16_f32 v76, 0, v76
  v_cvt_pk_bf16_f32 v77, 0, v77
  v_cvt_pk_bf16_f32 v78, 0, v78
  v_cvt_pk_bf16_f32 v79, 0, v79
  v_cvt_pk_bf16_f32 v80, 0, v80
  v_cvt_pk_bf16_f32 v81, 0, v81
  v_cvt_pk_bf16_f32 v82, 0, v82
  v_cvt_pk_bf16_f32 v83, 0, v83
  v_cvt_pk_bf16_f32 v84, 0, v84
  v_cvt_pk_bf16_f32 v85, 0, v85
  v_cvt_pk_bf16_f32 v86, 0, v86
  v_cvt_pk_bf16_f32 v87, 0, v87
  v_mul_f32 v72, v72, v120
  v_mul_f32 v73, v73, v121
  v_mul_f32 v74, v74, v122
  v_mul_f32 v75, v75, v123
  v_mul_f32 v76, v76, v124
  v_mul_f32 v77, v77, v125
  v_mul_f32 v78, v78, v126
  v_mul_f32 v79, v79, v127
  v_mul_f32 v80, v80, v128
  v_mul_f32 v81, v81, v129
  v_mul_f32 v82, v82, v130
  v_mul_f32 v83, v83, v131
  v_mul_f32 v84, v84, v132
  v_mul_f32 v85, v85, v133
  v_mul_f32 v86, v86, v134
  v_mul_f32 v87, v87, v135
  v_cvt_pk_bf16_f32 v40, v72, v73
  v_cvt_pk_bf16_f32 v41, v74, v75
  v_cvt_pk_bf16_f32 v42, v76, v77
  v_cvt_pk_bf16_f32 v43, v78, v79
  v_cvt_pk_bf16_f32 v44, v80, v81
  v_cvt_pk_bf16_f32 v45, v82, v83
  v_cvt_pk_bf16_f32 v46, v84, v85
  v_cvt_pk_bf16_f32 v47, v86, v87
  v_add_u32 v3, 14336, v0
  ds_write_b128 v3, v[40:43] offset:0
  ds_write_b128 v3, v[44:47] offset:3072
  s_mov_b32 s44, s28
  s_mov_b32 s45, s29
  s_mov_b32 s46, 1409024
  s_mov_b32 s11, 2752
  s_mov_b32 s12, 1409024
  v_mov_b32 v4, 12288
  v_mov_b32 v5, 13312
  v_lshlrev_b32 v2, 4, v1
  v_add_u32 v2, 1024, v2
  s_call_b64 s[62:63], L_gv
  v_cvt_pk_bf16_f32 v120, 0, v72
  v_cvt_pk_bf16_f32 v121, 0, v73
  v_cvt_pk_bf16_f32 v122, 0, v74
  v_cvt_pk_bf16_f32 v123, 0, v75
  v_cvt_pk_bf16_f32 v124, 0, v76
  v_cvt_pk_bf16_f32 v125, 0, v77
  v_cvt_pk_bf16_f32 v126, 0, v78
  v_cvt_pk_bf16_f32 v127, 0, v79
  v_cvt_pk_bf16_f32 v128, 0, v80
  v_cvt_pk_bf16_f32 v129, 0, v81
  v_cvt_pk_bf16_f32 v130, 0, v82
  v_cvt_pk_bf16_f32 v131, 0, v83
  v_cvt_pk_bf16_f32 v132, 0, v84
  v_cvt_pk_bf16_f32 v133, 0, v85
  v_cvt_pk_bf16_f32 v134, 0, v86
  v_cvt_pk_bf16_f32 v135, 0, v87
  s_mov_b32 s44, s30
  s_mov_b32 s45, s31
  s_mov_b32 s46, 1409024
  s_mov_b32 s11, 2752
  s_mov_b32 s12, 1409024
  v_mov_b32 v4, 12288
  v_mov_b32 v5, 13312
  v_lshlrev_b32 v2, 4, v1
  v_add_u32 v2, 1024, v2
  s_call_b64 s[62:63], L_gv
  v_mul_f32 v88, 0xbfb8aa3b, v120
  v_mul_f32 v89, 0xbfb8aa3b, v121
  v_mul_f32 v90, 0xbfb8aa3b, v122
  v_mul_f32 v91, 0xbfb8aa3b, v123
  v_exp_f32 v88, v88
  v_exp_f32 v89, v89
  v_exp_f32 v90, v90
  v_exp_f32 v91, v91
  s_nop 0
  v_add_f32 v88, 1.0, v88
  v_add_f32 v89, 1.0, v89
  v_add_f32 v90, 1.0, v90
  v_add_f32 v91, 1.0, v91
  v_rcp_f32 v88, v88
  v_rcp_f32 v89, v89
  v_rcp_f32 v90, v90
  v_rcp_f32 v91, v91
  s_nop 0
  v_mul_f32 v120, v120, v88
  v_mul_f32 v121, v121, v89
  v_mul_f32 v122, v122, v90
  v_mul_f32 v123, v123, v91
  v_mul_f32 v88, 0xbfb8aa3b, v124
  v_mul_f32 v89, 0xbfb8aa3b, v125
  v_mul_f32 v90, 0xbfb8aa3b, v126
  v_mul_f32 v91, 0xbfb8aa3b, v127
  v_exp_f32 v88, v88
  v_exp_f32 v89, v89
  v_exp_f32 v90, v90
  v_exp_f32 v91, v91
  s_nop 0
  v_add_f32 v88, 1.0, v88
  v_add_f32 v89, 1.0, v89
  v_add_f32 v90, 1.0, v90
  v_add_f32 v91, 1.0, v91
  v_rcp_f32 v88, v88
  v_rcp_f32 v89, v89
  v_rcp_f32 v90, v90
  v_rcp_f32 v91, v91
  s_nop 0
  v_mul_f32 v124, v124, v88
  v_mul_f32 v125, v125, v89
  v_mul_f32 v126, v126, v90
  v_mul_f32 v127, v127, v91
  v_mul_f32 v88, 0xbfb8aa3b, v128
  v_mul_f32 v89, 0xbfb8aa3b, v129
  v_mul_f32 v90, 0xbfb8aa3b, v130
  v_mul_f32 v91, 0xbfb8aa3b, v131
  v_exp_f32 v88, v88
  v_exp_f32 v89, v89
  v_exp_f32 v90, v90
  v_exp_f32 v91, v91
  s_nop 0
  v_add_f32 v88, 1.0, v88
  v_add_f32 v89, 1.0, v89
  v_add_f32 v90, 1.0, v90
  v_add_f32 v91, 1.0, v91
  v_rcp_f32 v88, v88
  v_rcp_f32 v89, v89
  v_rcp_f32 v90, v90
  v_rcp_f32 v91, v91
  s_nop 0
  v_mul_f32 v128, v128, v88
  v_mul_f32 v129, v129, v89
  v_mul_f32 v130, v130, v90
  v_mul_f32 v131, v131, v91
  v_mul_f32 v88, 0xbfb8aa3b, v132
  v_mul_f32 v89, 0xbfb8aa3b, v133
  v_mul_f32 v90, 0xbfb8aa3b, v134
  v_mul_f32 v91, 0xbfb8aa3b, v135
  v_exp_f32 v88, v88
  v_exp_f32 v89, v89
  v_exp_f32 v90, v90
  v_exp_f32 v91, v91
  s_nop 0
  v_add_f32 v88, 1.0, v88
  v_add_f32 v89, 1.0, v89
  v_add_f32 v90, 1.0, v90
  v_add_f32 v91, 1.0, v91
  v_rcp_f32 v88, v88
  v_rcp_f32 v89, v89
  v_rcp_f32 v90, v90
  v_rcp_f32 v91, v91
  s_nop 0
  v_mul_f32 v132, v132, v88
  v_mul_f32 v133, v133, v89
  v_mul_f32 v134, v134, v90
  v_mul_f32 v135, v135, v91
  v_cvt_pk_bf16_f32 v120, 0, v120
  v_cvt_pk_bf16_f32 v121, 0, v121
  v_cvt_pk_bf16_f32 v122, 0, v122
  v_cvt_pk_bf16_f32 v123, 0, v123
  v_cvt_pk_bf16_f32 v124, 0, v124
  v_cvt_pk_bf16_f32 v125, 0, v125
  v_cvt_pk_bf16_f32 v126, 0, v126
  v_cvt_pk_bf16_f32 v127, 0, v127
  v_cvt_pk_bf16_f32 v128, 0, v128
  v_cvt_pk_bf16_f32 v129, 0, v129
  v_cvt_pk_bf16_f32 v130, 0, v130
  v_cvt_pk_bf16_f32 v131, 0, v131
  v_cvt_pk_bf16_f32 v132, 0, v132
  v_cvt_pk_bf16_f32 v133, 0, v133
  v_cvt_pk_bf16_f32 v134, 0, v134
  v_cvt_pk_bf16_f32 v135, 0, v135
  v_cvt_pk_bf16_f32 v72, 0, v72
  v_cvt_pk_bf16_f32 v73, 0, v73
  v_cvt_pk_bf16_f32 v74, 0, v74
  v_cvt_pk_bf16_f32 v75, 0, v75
  v_cvt_pk_bf16_f32 v76, 0, v76
  v_cvt_pk_bf16_f32 v77, 0, v77
  v_cvt_pk_bf16_f32 v78, 0, v78
  v_cvt_pk_bf16_f32 v79, 0, v79
  v_cvt_pk_bf16_f32 v80, 0, v80
  v_cvt_pk_bf16_f32 v81, 0, v81
  v_cvt_pk_bf16_f32 v82, 0, v82
  v_cvt_pk_bf16_f32 v83, 0, v83
  v_cvt_pk_bf16_f32 v84, 0, v84
  v_cvt_pk_bf16_f32 v85, 0, v85
  v_cvt_pk_bf16_f32 v86, 0, v86
  v_cvt_pk_bf16_f32 v87, 0, v87
  v_mul_f32 v72, v72, v120
  v_mul_f32 v73, v73, v121
  v_mul_f32 v74, v74, v122
  v_mul_f32 v75, v75, v123
  v_mul_f32 v76, v76, v124
  v_mul_f32 v77, v77, v125
  v_mul_f32 v78, v78, v126
  v_mul_f32 v79, v79, v127
  v_mul_f32 v80, v80, v128
  v_mul_f32 v81, v81, v129
  v_mul_f32 v82, v82, v130
  v_mul_f32 v83, v83, v131
  v_mul_f32 v84, v84, v132
  v_mul_f32 v85, v85, v133
  v_mul_f32 v86, v86, v134
  v_mul_f32 v87, v87, v135
  v_cvt_pk_bf16_f32 v40, v72, v73
  v_cvt_pk_bf16_f32 v41, v74, v75
  v_cvt_pk_bf16_f32 v42, v76, v77
  v_cvt_pk_bf16_f32 v43, v78, v79
  v_cvt_pk_bf16_f32 v44, v80, v81
  v_cvt_pk_bf16_f32 v45, v82, v83
  v_cvt_pk_bf16_f32 v46, v84, v85
  v_cvt_pk_bf16_f32 v47, v86, v87
  v_add_u32 v3, 15360, v0
  ds_write_b128 v3, v[40:43] offset:0
  ds_write_b128 v3, v[44:47] offset:3072
  s_mov_b32 s44, s28
  s_mov_b32 s45, s29
  s_mov_b32 s46, 1409024
  s_mov_b32 s11, 2752
  s_mov_b32 s12, 1409024
  v_mov_b32 v4, 12288
  v_mov_b32 v5, 13312
  v_lshlrev_b32 v2, 4, v1
  v_add_u32 v2, 2048, v2
  s_call_b64 s[62:63], L_gv
  v_cvt_pk_bf16_f32 v120, 0, v72
  v_cvt_pk_bf16_f32 v121, 0, v73
  v_cvt_pk_bf16_f32 v122, 0, v74
  v_cvt_pk_bf16_f32 v123, 0, v75
  v_cvt_pk_bf16_f32 v124, 0, v76
  v_cvt_pk_bf16_f32 v125, 0, v77
  v_cvt_pk_bf16_f32 v126, 0, v78
  v_cvt_pk_bf16_f32 v127, 0, v79
  v_cvt_pk_bf16_f32 v128, 0, v80
  v_cvt_pk_bf16_f32 v129, 0, v81
  v_cvt_pk_bf16_f32 v130, 0, v82
  v_cvt_pk_bf16_f32 v131, 0, v83
  v_cvt_pk_bf16_f32 v132, 0, v84
  v_cvt_pk_bf16_f32 v133, 0, v85
  v_cvt_pk_bf16_f32 v134, 0, v86
  v_cvt_pk_bf16_f32 v135, 0, v87
  s_mov_b32 s44, s30
  s_mov_b32 s45, s31
  s_mov_b32 s46, 1409024
  s_mov_b32 s11, 2752
  s_mov_b32 s12, 1409024
  v_mov_b32 v4, 12288
  v_mov_b32 v5, 13312
  v_lshlrev_b32 v2, 4, v1
  v_add_u32 v2, 2048, v2
  s_call_b64 s[62:63], L_gv
  v_mul_f32 v88, 0xbfb8aa3b, v120
  v_mul_f32 v89, 0xbfb8aa3b, v121
  v_mul_f32 v90, 0xbfb8aa3b, v122
  v_mul_f32 v91, 0xbfb8aa3b, v123
  v_exp_f32 v88, v88
  v_exp_f32 v89, v89
  v_exp_f32 v90, v90
  v_exp_f32 v91, v91
  s_nop 0
  v_add_f32 v88, 1.0, v88
  v_add_f32 v89, 1.0, v89
  v_add_f32 v90, 1.0, v90
  v_add_f32 v91, 1.0, v91
  v_rcp_f32 v88, v88
  v_rcp_f32 v89, v89
  v_rcp_f32 v90, v90
  v_rcp_f32 v91, v91
  s_nop 0
  v_mul_f32 v120, v120, v88
  v_mul_f32 v121, v121, v89
  v_mul_f32 v122, v122, v90
  v_mul_f32 v123, v123, v91
  v_mul_f32 v88, 0xbfb8aa3b, v124
  v_mul_f32 v89, 0xbfb8aa3b, v125
  v_mul_f32 v90, 0xbfb8aa3b, v126
  v_mul_f32 v91, 0xbfb8aa3b, v127
  v_exp_f32 v88, v88
  v_exp_f32 v89, v89
  v_exp_f32 v90, v90
  v_exp_f32 v91, v91
  s_nop 0
  v_add_f32 v88, 1.0, v88
  v_add_f32 v89, 1.0, v89
  v_add_f32 v90, 1.0, v90
  v_add_f32 v91, 1.0, v91
  v_rcp_f32 v88, v88
  v_rcp_f32 v89, v89
  v_rcp_f32 v90, v90
  v_rcp_f32 v91, v91
  s_nop 0
  v_mul_f32 v124, v124, v88
  v_mul_f32 v125, v125, v89
  v_mul_f32 v126, v126, v90
  v_mul_f32 v127, v127, v91
  v_mul_f32 v88, 0xbfb8aa3b, v128
  v_mul_f32 v89, 0xbfb8aa3b, v129
  v_mul_f32 v90, 0xbfb8aa3b, v130
  v_mul_f32 v91, 0xbfb8aa3b, v131
  v_exp_f32 v88, v88
  v_exp_f32 v89, v89
  v_exp_f32 v90, v90
  v_exp_f32 v91, v91
  s_nop 0
  v_add_f32 v88, 1.0, v88
  v_add_f32 v89, 1.0, v89
  v_add_f32 v90, 1.0, v90
  v_add_f32 v91, 1.0, v91
  v_rcp_f32 v88, v88
  v_rcp_f32 v89, v89
  v_rcp_f32 v90, v90
  v_rcp_f32 v91, v91
  s_nop 0
  v_mul_f32 v128, v128, v88
  v_mul_f32 v129, v129, v89
  v_mul_f32 v130, v130, v90
  v_mul_f32 v131, v131, v91
  v_mul_f32 v88, 0xbfb8aa3b, v132
  v_mul_f32 v89, 0xbfb8aa3b, v133
  v_mul_f32 v90, 0xbfb8aa3b, v134
  v_mul_f32 v91, 0xbfb8aa3b, v135
  v_exp_f32 v88, v88
  v_exp_f32 v89, v89
  v_exp_f32 v90, v90
  v_exp_f32 v91, v91
  s_nop 0
  v_add_f32 v88, 1.0, v88
  v_add_f32 v89, 1.0, v89
  v_add_f32 v90, 1.0, v90
  v_add_f32 v91, 1.0, v91
  v_rcp_f32 v88, v88
  v_rcp_f32 v89, v89
  v_rcp_f32 v90, v90
  v_rcp_f32 v91, v91
  s_nop 0
  v_mul_f32 v132, v132, v88
  v_mul_f32 v133, v133, v89
  v_mul_f32 v134, v134, v90
  v_mul_f32 v135, v135, v91
  v_cvt_pk_bf16_f32 v120, 0, v120
  v_cvt_pk_bf16_f32 v121, 0, v121
  v_cvt_pk_bf16_f32 v122, 0, v122
  v_cvt_pk_bf16_f32 v123, 0, v123
  v_cvt_pk_bf16_f32 v124, 0, v124
  v_cvt_pk_bf16_f32 v125, 0, v125
  v_cvt_pk_bf16_f32 v126, 0, v126
  v_cvt_pk_bf16_f32 v127, 0, v127
  v_cvt_pk_bf16_f32 v128, 0, v128
  v_cvt_pk_bf16_f32 v129, 0, v129
  v_cvt_pk_bf16_f32 v130, 0, v130
  v_cvt_pk_bf16_f32 v131, 0, v131
  v_cvt_pk_bf16_f32 v132, 0, v132
  v_cvt_pk_bf16_f32 v133, 0, v133
  v_cvt_pk_bf16_f32 v134, 0, v134
  v_cvt_pk_bf16_f32 v135, 0, v135
  v_cvt_pk_bf16_f32 v72, 0, v72
  v_cvt_pk_bf16_f32 v73, 0, v73
  v_cvt_pk_bf16_f32 v74, 0, v74
  v_cvt_pk_bf16_f32 v75, 0, v75
  v_cvt_pk_bf16_f32 v76, 0, v76
  v_cvt_pk_bf16_f32 v77, 0, v77
  v_cvt_pk_bf16_f32 v78, 0, v78
  v_cvt_pk_bf16_f32 v79, 0, v79
  v_cvt_pk_bf16_f32 v80, 0, v80
  v_cvt_pk_bf16_f32 v81, 0, v81
  v_cvt_pk_bf16_f32 v82, 0, v82
  v_cvt_pk_bf16_f32 v83, 0, v83
  v_cvt_pk_bf16_f32 v84, 0, v84
  v_cvt_pk_bf16_f32 v85, 0, v85
  v_cvt_pk_bf16_f32 v86, 0, v86
  v_cvt_pk_bf16_f32 v87, 0, v87
  v_mul_f32 v72, v72, v120
  v_mul_f32 v73, v73, v121
  v_mul_f32 v74, v74, v122
  v_mul_f32 v75, v75, v123
  v_mul_f32 v76, v76, v124
  v_mul_f32 v77, v77, v125
  v_mul_f32 v78, v78, v126
  v_mul_f32 v79, v79, v127
  v_mul_f32 v80, v80, v128
  v_mul_f32 v81, v81, v129
  v_mul_f32 v82, v82, v130
  v_mul_f32 v83, v83, v131
  v_mul_f32 v84, v84, v132
  v_mul_f32 v85, v85, v133
  v_mul_f32 v86, v86, v134
  v_mul_f32 v87, v87, v135
  v_cvt_pk_bf16_f32 v40, v72, v73
  v_cvt_pk_bf16_f32 v41, v74, v75
  v_cvt_pk_bf16_f32 v42, v76, v77
  v_cvt_pk_bf16_f32 v43, v78, v79
  v_cvt_pk_bf16_f32 v44, v80, v81
  v_cvt_pk_bf16_f32 v45, v82, v83
  v_cvt_pk_bf16_f32 v46, v84, v85
  v_cvt_pk_bf16_f32 v47, v86, v87
  v_add_u32 v3, 16384, v0
  ds_write_b128 v3, v[40:43] offset:0
  ds_write_b128 v3, v[44:47] offset:3072
  s_mov_b32 s44, s32
  s_mov_b32 s45, s33
  s_mov_b32 s46, 1409024
  s_mov_b32 s11, 1024
  s_mov_b32 s12, 1409024
  v_mov_b32 v4, 14336
  v_mov_b32 v5, 17408
  v_lshlrev_b32 v2, 4, v1
  s_call_b64 s[62:63], L_gv
  v_lshrrev_b32 v2, 1, v1
  v_lshlrev_b32 v2, 7, v2
  v_and_b32 v3, 1, v1
  v_lshl_add_u32 v2, v3, 5, v2
  v_add_u32 v2, 24576, v2
  global_load_dwordx4 v[40:43], v2, s[42:43] offset:0 sc1
  global_load_dwordx4 v[44:47], v2, s[42:43] offset:16 sc1
  global_load_dwordx4 v[48:51], v2, s[42:43] offset:64 sc1
  global_load_dwordx4 v[52:55], v2, s[42:43] offset:80 sc1
  s_waitcnt vmcnt(0)
  v_lshlrev_b32 v88, 16, v40
  v_and_b32 v89, s73, v40
  v_lshlrev_b32 v90, 16, v42
  v_and_b32 v91, s73, v42
  v_lshlrev_b32 v92, 16, v44
  v_and_b32 v93, s73, v44
  v_lshlrev_b32 v94, 16, v46
  v_and_b32 v95, s73, v46
  v_lshlrev_b32 v96, 16, v48
  v_and_b32 v97, s73, v48
  v_lshlrev_b32 v98, 16, v50
  v_and_b32 v99, s73, v50
  v_lshlrev_b32 v100, 16, v52
  v_and_b32 v101, s73, v52
  v_lshlrev_b32 v102, 16, v54
  v_and_b32 v103, s73, v54
  v_cvt_pk_bf16_f32 v72, 0, v72
  v_cvt_pk_bf16_f32 v73, 0, v73
  v_cvt_pk_bf16_f32 v74, 0, v74
  v_cvt_pk_bf16_f32 v75, 0, v75
  v_cvt_pk_bf16_f32 v76, 0, v76
  v_cvt_pk_bf16_f32 v77, 0, v77
  v_cvt_pk_bf16_f32 v78, 0, v78
  v_cvt_pk_bf16_f32 v79, 0, v79
  v_cvt_pk_bf16_f32 v80, 0, v80
  v_cvt_pk_bf16_f32 v81, 0, v81
  v_cvt_pk_bf16_f32 v82, 0, v82
  v_cvt_pk_bf16_f32 v83, 0, v83
  v_cvt_pk_bf16_f32 v84, 0, v84
  v_cvt_pk_bf16_f32 v85, 0, v85
  v_cvt_pk_bf16_f32 v86, 0, v86
  v_cvt_pk_bf16_f32 v87, 0, v87
  v_mul_f32 v72, v72, v88
  v_mul_f32 v73, v73, v89
  v_mul_f32 v74, v74, v90
  v_mul_f32 v75, v75, v91
  v_mul_f32 v76, v76, v92
  v_mul_f32 v77, v77, v93
  v_mul_f32 v78, v78, v94
  v_mul_f32 v79, v79, v95
  v_mul_f32 v80, v80, v96
  v_mul_f32 v81, v81, v97
  v_mul_f32 v82, v82, v98
  v_mul_f32 v83, v83, v99
  v_mul_f32 v84, v84, v100
  v_mul_f32 v85, v85, v101
  v_mul_f32 v86, v86, v102
  v_mul_f32 v87, v87, v103
  v_cvt_pk_bf16_f32 v72, 0, v72
  v_cvt_pk_bf16_f32 v73, 0, v73
  v_cvt_pk_bf16_f32 v74, 0, v74
  v_cvt_pk_bf16_f32 v75, 0, v75
  v_cvt_pk_bf16_f32 v76, 0, v76
  v_cvt_pk_bf16_f32 v77, 0, v77
  v_cvt_pk_bf16_f32 v78, 0, v78
  v_cvt_pk_bf16_f32 v79, 0, v79
  v_cvt_pk_bf16_f32 v80, 0, v80
  v_cvt_pk_bf16_f32 v81, 0, v81
  v_cvt_pk_bf16_f32 v82, 0, v82
  v_cvt_pk_bf16_f32 v83, 0, v83
  v_cvt_pk_bf16_f32 v84, 0, v84
  v_cvt_pk_bf16_f32 v85, 0, v85
  v_cvt_pk_bf16_f32 v86, 0, v86
  v_cvt_pk_bf16_f32 v87, 0, v87
  v_add_f32 v104, v104, v72
  v_add_f32 v105, v105, v73
  v_add_f32 v106, v106, v74
  v_add_f32 v107, v107, v75
  v_add_f32 v108, v108, v76
  v_add_f32 v109, v109, v77
  v_add_f32 v110, v110, v78
  v_add_f32 v111, v111, v79
  v_add_f32 v112, v112, v80
  v_add_f32 v113, v113, v81
  v_add_f32 v114, v114, v82
  v_add_f32 v115, v115, v83
  v_add_f32 v116, v116, v84
  v_add_f32 v117, v117, v85
  v_add_f32 v118, v118, v86
  v_add_f32 v119, v119, v87
  v_cvt_pk_bf16_f32 v104, 0, v104
  v_cvt_pk_bf16_f32 v105, 0, v105
  v_cvt_pk_bf16_f32 v106, 0, v106
  v_cvt_pk_bf16_f32 v107, 0, v107
  v_cvt_pk_bf16_f32 v108, 0, v108
  v_cvt_pk_bf16_f32 v109, 0, v109
  v_cvt_pk_bf16_f32 v110, 0, v110
  v_cvt_pk_bf16_f32 v111, 0, v111
  v_cvt_pk_bf16_f32 v112, 0, v112
  v_cvt_pk_bf16_f32 v113, 0, v113
  v_cvt_pk_bf16_f32 v114, 0, v114
  v_cvt_pk_bf16_f32 v115, 0, v115
  v_cvt_pk_bf16_f32 v116, 0, v116
  v_cvt_pk_bf16_f32 v117, 0, v117
  v_cvt_pk_bf16_f32 v118, 0, v118
  v_cvt_pk_bf16_f32 v119, 0, v119
  v_cvt_pk_bf16_f32 v40, v104, v105
  v_cvt_pk_bf16_f32 v41, v106, v107
  v_cvt_pk_bf16_f32 v42, v108, v109
  v_cvt_pk_bf16_f32 v43, v110, v111
  v_cvt_pk_bf16_f32 v44, v112, v113
  v_cvt_pk_bf16_f32 v45, v114, v115
  v_cvt_pk_bf16_f32 v46, v116, v117
  v_cvt_pk_bf16_f32 v47, v118, v119
  global_store_dwordx4 v0, v[40:43], s[38:39] offset:0 sc1
  global_store_dwordx4 v0, v[44:47], s[38:39] offset:1024 sc1
  s_endpgm
L_gv:
  v_mov_b32 v72, 0
  v_mov_b32 v73, 0
  v_mov_b32 v74, 0
  v_mov_b32 v75, 0
  v_mov_b32 v76, 0
  v_mov_b32 v77, 0
  v_mov_b32 v78, 0
  v_mov_b32 v79, 0
  v_mov_b32 v80, 0
  v_mov_b32 v81, 0
  v_mov_b32 v82, 0
  v_mov_b32 v83, 0
  v_mov_b32 v84, 0
  v_mov_b32 v85, 0
  v_mov_b32 v86, 0
  v_mov_b32 v87, 0
  s_mov_b32 s10, 0
L_gvl:
  buffer_load_dwordx4 v[40:43], v2, s[44:47], s10 offen
  s_add_u32 s10, s10, s11
  buffer_load_dwordx4 v[44:47], v2, s[44:47], s10 offen
  s_add_u32 s10, s10, s11
  buffer_load_dwordx4 v[48:51], v2, s[44:47], s10 offen
  s_add_u32 s10, s10, s11
  buffer_load_dwordx4 v[52:55], v2, s[44:47], s10 offen
  s_add_u32 s10, s10, s11
  buffer_load_dwordx4 v[56:59], v2, s[44:47], s10 offen
  s_add_u32 s10, s10, s11
  buffer_load_dwordx4 v[60:63], v2, s[44:47], s10 offen
  s_add_u32 s10, s10, s11
  buffer_load_dwordx4 v[64:67], v2, s[44:47], s10 offen
  s_add_u32 s10, s10, s11
  buffer_load_dwordx4 v[68:71], v2, s[44:47], s10 offen
  s_add_u32 s10, s10, s11
  ds_read_b128 v[88:91], v4
  ds_read_b128 v[92:95], v5
  v_add_u32 v4, 16, v4
  v_add_u32 v5, 16, v5
  s_waitcnt lgkmcnt(0)
  v_and_b32 v8, 0xffff, v88
  v_lshlrev_b32 v9, 16, v88
  v_and_b32 v10, 0xffff, v92
  v_lshlrev_b32 v11, 16, v92
  s_waitcnt vmcnt(7)
  v_dot2c_f32_bf16 v72, v8, v40
  v_dot2c_f32_bf16 v73, v9, v40
  v_dot2c_f32_bf16 v74, v8, v41
  v_dot2c_f32_bf16 v75, v9, v41
  v_dot2c_f32_bf16 v76, v8, v42
  v_dot2c_f32_bf16 v77, v9, v42
  v_dot2c_f32_bf16 v78, v8, v43
  v_dot2c_f32_bf16 v79, v9, v43
  v_dot2c_f32_bf16 v80, v10, v40
  v_dot2c_f32_bf16 v81, v11, v40
  v_dot2c_f32_bf16 v82, v10, v41
  v_dot2c_f32_bf16 v83, v11, v41
  v_dot2c_f32_bf16 v84, v10, v42
  v_dot2c_f32_bf16 v85, v11, v42
  v_dot2c_f32_bf16 v86, v10, v43
  v_dot2c_f32_bf16 v87, v11, v43
  v_lshrrev_b32 v8, 16, v88
  v_and_b32 v9, s73, v88
  v_lshrrev_b32 v10, 16, v92
  v_and_b32 v11, s73, v92
  s_waitcnt vmcnt(6)
  v_dot2c_f32_bf16 v72, v8, v44
  v_dot2c_f32_bf16 v73, v9, v44
  v_dot2c_f32_bf16 v74, v8, v45
  v_dot2c_f32_bf16 v75, v9, v45
  v_dot2c_f32_bf16 v76, v8, v46
  v_dot2c_f32_bf16 v77, v9, v46
  v_dot2c_f32_bf16 v78, v8, v47
  v_dot2c_f32_bf16 v79, v9, v47
  v_dot2c_f32_bf16 v80, v10, v44
  v_dot2c_f32_bf16 v81, v11, v44
  v_dot2c_f32_bf16 v82, v10, v45
  v_dot2c_f32_bf16 v83, v11, v45
  v_dot2c_f32_bf16 v84, v10, v46
  v_dot2c_f32_bf16 v85, v11, v46
  v_dot2c_f32_bf16 v86, v10, v47
  v_dot2c_f32_bf16 v87, v11, v47
  v_and_b32 v8, 0xffff, v89
  v_lshlrev_b32 v9, 16, v89
  v_and_b32 v10, 0xffff, v93
  v_lshlrev_b32 v11, 16, v93
  s_waitcnt vmcnt(5)
  v_dot2c_f32_bf16 v72, v8, v48
  v_dot2c_f32_bf16 v73, v9, v48
  v_dot2c_f32_bf16 v74, v8, v49
  v_dot2c_f32_bf16 v75, v9, v49
  v_dot2c_f32_bf16 v76, v8, v50
  v_dot2c_f32_bf16 v77, v9, v50
  v_dot2c_f32_bf16 v78, v8, v51
  v_dot2c_f32_bf16 v79, v9, v51
  v_dot2c_f32_bf16 v80, v10, v48
  v_dot2c_f32_bf16 v81, v11, v48
  v_dot2c_f32_bf16 v82, v10, v49
  v_dot2c_f32_bf16 v83, v11, v49
  v_dot2c_f32_bf16 v84, v10, v50
  v_dot2c_f32_bf16 v85, v11, v50
  v_dot2c_f32_bf16 v86, v10, v51
  v_dot2c_f32_bf16 v87, v11, v51
  v_lshrrev_b32 v8, 16, v89
  v_and_b32 v9, s73, v89
  v_lshrrev_b32 v10, 16, v93
  v_and_b32 v11, s73, v93
  s_waitcnt vmcnt(4)
  v_dot2c_f32_bf16 v72, v8, v52
  v_dot2c_f32_bf16 v73, v9, v52
  v_dot2c_f32_bf16 v74, v8, v53
  v_dot2c_f32_bf16 v75, v9, v53
  v_dot2c_f32_bf16 v76, v8, v54
  v_dot2c_f32_bf16 v77, v9, v54
  v_dot2c_f32_bf16 v78, v8, v55
  v_dot2c_f32_bf16 v79, v9, v55
  v_dot2c_f32_bf16 v80, v10, v52
  v_dot2c_f32_bf16 v81, v11, v52
  v_dot2c_f32_bf16 v82, v10, v53
  v_dot2c_f32_bf16 v83, v11, v53
  v_dot2c_f32_bf16 v84, v10, v54
  v_dot2c_f32_bf16 v85, v11, v54
  v_dot2c_f32_bf16 v86, v10, v55
  v_dot2c_f32_bf16 v87, v11, v55
  v_and_b32 v8, 0xffff, v90
  v_lshlrev_b32 v9, 16, v90
  v_and_b32 v10, 0xffff, v94
  v_lshlrev_b32 v11, 16, v94
  s_waitcnt vmcnt(3)
  v_dot2c_f32_bf16 v72, v8, v56
  v_dot2c_f32_bf16 v73, v9, v56
  v_dot2c_f32_bf16 v74, v8, v57
  v_dot2c_f32_bf16 v75, v9, v57
  v_dot2c_f32_bf16 v76, v8, v58
  v_dot2c_f32_bf16 v77, v9, v58
  v_dot2c_f32_bf16 v78, v8, v59
  v_dot2c_f32_bf16 v79, v9, v59
  v_dot2c_f32_bf16 v80, v10, v56
  v_dot2c_f32_bf16 v81, v11, v56
  v_dot2c_f32_bf16 v82, v10, v57
  v_dot2c_f32_bf16 v83, v11, v57
  v_dot2c_f32_bf16 v84, v10, v58
  v_dot2c_f32_bf16 v85, v11, v58
  v_dot2c_f32_bf16 v86, v10, v59
  v_dot2c_f32_bf16 v87, v11, v59
  v_lshrrev_b32 v8, 16, v90
  v_and_b32 v9, s73, v90
  v_lshrrev_b32 v10, 16, v94
  v_and_b32 v11, s73, v94
  s_waitcnt vmcnt(2)
  v_dot2c_f32_bf16 v72, v8, v60
  v_dot2c_f32_bf16 v73, v9, v60
  v_dot2c_f32_bf16 v74, v8, v61
  v_dot2c_f32_bf16 v75, v9, v61
  v_dot2c_f32_bf16 v76, v8, v62
  v_dot2c_f32_bf16 v77, v9, v62
  v_dot2c_f32_bf16 v78, v8, v63
  v_dot2c_f32_bf16 v79, v9, v63
  v_dot2c_f32_bf16 v80, v10, v60
  v_dot2c_f32_bf16 v81, v11, v60
  v_dot2c_f32_bf16 v82, v10, v61
  v_dot2c_f32_bf16 v83, v11, v61
  v_dot2c_f32_bf16 v84, v10, v62
  v_dot2c_f32_bf16 v85, v11, v62
  v_dot2c_f32_bf16 v86, v10, v63
  v_dot2c_f32_bf16 v87, v11, v63
  v_and_b32 v8, 0xffff, v91
  v_lshlrev_b32 v9, 16, v91
  v_and_b32 v10, 0xffff, v95
  v_lshlrev_b32 v11, 16, v95
  s_waitcnt vmcnt(1)
  v_dot2c_f32_bf16 v72, v8, v64
  v_dot2c_f32_bf16 v73, v9, v64
  v_dot2c_f32_bf16 v74, v8, v65
  v_dot2c_f32_bf16 v75, v9, v65
  v_dot2c_f32_bf16 v76, v8, v66
  v_dot2c_f32_bf16 v77, v9, v66
  v_dot2c_f32_bf16 v78, v8, v67
  v_dot2c_f32_bf16 v79, v9, v67
  v_dot2c_f32_bf16 v80, v10, v64
  v_dot2c_f32_bf16 v81, v11, v64
  v_dot2c_f32_bf16 v82, v10, v65
  v_dot2c_f32_bf16 v83, v11, v65
  v_dot2c_f32_bf16 v84, v10, v66
  v_dot2c_f32_bf16 v85, v11, v66
  v_dot2c_f32_bf16 v86, v10, v67
  v_dot2c_f32_bf16 v87, v11, v67
  v_lshrrev_b32 v8, 16, v91
  v_and_b32 v9, s73, v91
  v_lshrrev_b32 v10, 16, v95
  v_and_b32 v11, s73, v95
  s_waitcnt vmcnt(0)
  v_dot2c_f32_bf16 v72, v8, v68
  v_dot2c_f32_bf16 v73, v9, v68
  v_dot2c_f32_bf16 v74, v8, v69
  v_dot2c_f32_bf16 v75, v9, v69
  v_dot2c_f32_bf16 v76, v8, v70
  v_dot2c_f32_bf16 v77, v9, v70
  v_dot2c_f32_bf16 v78, v8, v71
  v_dot2c_f32_bf16 v79, v9, v71
  v_dot2c_f32_bf16 v80, v10, v68
  v_dot2c_f32_bf16 v81, v11, v68
  v_dot2c_f32_bf16 v82, v10, v69
  v_dot2c_f32_bf16 v83, v11, v69
  v_dot2c_f32_bf16 v84, v10, v70
  v_dot2c_f32_bf16 v85, v11, v70
  v_dot2c_f32_bf16 v86, v10, v71
  v_dot2c_f32_bf16 v87, v11, v71
  s_cmp_lt_u32 s10, s12
  s_cbranch_scc1 L_gvl
  s_nop 1
  s_setpc_b64 s[62:63]
L_serv:
  s_cmp_ge_u32 s13, 4
  s_cbranch_scc1 L_team
  s_cmp_ge_u32 s13, 2
  s_cbranch_scc1 L_end
  v_mov_b32 v38, 0
  v_mov_b32 v4, -1
  v_mov_b32 v5, 0
  v_mov_b32 v6, 0
  v_mov_b32 v7, 0
  ds_write_b128 v38, v[4:7] offset:256
  ds_write_b64 v38, v[6:7] offset:312
  s_getreg_b32 s76, hwreg(HW_REG_XCC_ID, 0, 4)
  s_waitcnt lgkmcnt(0)
  s_load_dword s74, s[42:43], 0
  s_getpc_b64 s[56:57]
L_pc_21:
  s_lshr_b32 s3, s2, 5
  s_lshl3_add_u32 s3, s3, s8
  s_lshl_b32 s3, s3, 2
  s_add_u32 s3, s3, L_table-L_pc_21
  s_load_dword s14, s[56:57], s3
  s_barrier
  s_waitcnt lgkmcnt(0)
  s_mul_i32 s74, s74, 0x9e3779b1
  s_add_u32 s74, s74, 0x7f4a7c15
  s_bfe_u32 s32, s74, 0x80000
  s_bfe_u32 s33, s74, 0x80008
  s_bfe_u32 s34, s74, 0x80010
  s_bfe_u32 s35, s74, 0x80018
  s_cmp_eq_u32 s13, 0
  s_cbranch_scc1 L_sv0
  s_bfe_u32 s61, s14, 0x80010
  s_cmp_ge_u32 s61, 32
  s_cbranch_scc1 L_fin
  s_mov_b32 s70, 0
L_pl_22:
  ds_read_b32 v8, v38 offset:256
  s_waitcnt lgkmcnt(0)
  v_cmp_eq_u32 vcc, -1, v8
  s_cmp_eq_u64 vcc, 0
  s_cbranch_scc1 L_pld_23
  s_sleep 16
  s_add_u32 s70, s70, 1
  s_cmp_lt_u32 s70, 1048576
  s_cbranch_scc1 L_pl_22
L_pld_23:
  s_branch L_r_f2
L_sv0:
  s_add_u32 s76, s76, s74
  s_lshr_b32 s49, s2, 5
  s_lshl_b32 s50, s8, 5
  s_add_u32 s49, s49, s50
  s_lshl_b32 s49, s49, 2
  v_mov_b32 v8, s49
  v_mov_b32 v9, s76
  s_mov_b64 exec, 1
  global_store_dword v8, v9, s[42:43] offset:1024 sc1
  s_mov_b64 exec, -1
  s_lshl_b32 s54, s6, 9
  s_add_u32 s54, s54, 0
  s_lshl_b32 s55, s6, 9
  s_add_u32 s55, s55, 128
  s_lshl_b32 s56, s6, 9
  s_add_u32 s56, s56, 256
  s_mov_b32 s70, 0
L_sn_24:
  ds_read_b32 v8, v38 offset:312
  s_waitcnt lgkmcnt(0)
  v_cmp_gt_u32 vcc, 0xc, v8
  s_cmp_eq_u64 vcc, 0
  s_cbranch_scc1 L_snd_25
  s_sleep 16
  s_add_u32 s70, s70, 1
  s_cmp_lt_u32 s70, 2097152
  s_cbranch_scc1 L_sn_24
L_snd_25:
  s_load_dwordx2 s[20:21], s[42:43], s54 offset:98304 glc
  s_load_dwordx2 s[24:25], s[42:43], s55 offset:98304 glc
  s_load_dwordx2 s[28:29], s[42:43], s56 offset:98304 glc
  s_mov_b32 s70, 0
  s_branch L_s3sc
L_s3s:
  s_load_dwordx2 s[20:21], s[42:43], s54 offset:98304 glc
  s_load_dwordx2 s[24:25], s[42:43], s55 offset:98304 glc
  s_load_dwordx2 s[28:29], s[42:43], s56 offset:98304 glc
L_s3sc:
  s_waitcnt lgkmcnt(0)
  s_xor_b32 s68, s21, s74
  s_xor_b32 s69, s25, s74
  s_or_b32 s68, s68, s69
  s_xor_b32 s69, s29, s74
  s_or_b32 s68, s68, s69
  s_cbranch_scc0 L_s3sd
  s_sleep 8
  s_add_u32 s70, s70, 1
  s_cmp_lt_u32 s70, 262144
  s_cbranch_scc1 L_s3s
L_s3sd:
  ds_write_b32 v38, v38 offset:256
  s_branch L_fin
L_team:
  s_and_b32 s5, s13, 3
  v_and_b32 v0, 0xff, v0
  v_mov_b32 v38, 0
  s_mov_b32 s77, 0
  s_lshr_b32 s60, s2, 5
  v_lshrrev_b32 v12, 3, v0
  v_lshlrev_b32 v12, 5, v12
  v_bfe_u32 v3, v1, 2, 1
  v_lshl_add_u32 v12, v3, 10, v12
  v_and_b32 v8, 3, v1
  v_lshl_add_u32 v37, v8, 3, v12
  v_and_b32 v12, 0xffffffdf, v12
  v_lshl_add_u32 v12, v8, 4, v12
  v_bfe_u32 v8, v1, 3, 1
  v_lshl_add_u32 v12, v8, 3, v12
  v_lshl_add_u32 v12, v3, 5, v12
  s_waitcnt lgkmcnt(0)
  s_load_dword s74, s[42:43], 0
  s_barrier
  s_cmp_ge_u32 s13, 8
  s_cbranch_scc1 L_r_mod
L_r_q:
  s_lshl3_add_u32 s61, s8, s60
  s_lshl_b32 s48, s61, 7
  s_lshl_b32 s58, s61, 8
  s_add_u32 s58, s58, 32768
  global_load_dwordx2 v[14:15], v37, s[16:17]
  s_mov_b32 s44, s22
  s_mov_b32 s45, s23
  s_mov_b32 s46, 4194304
  s_mov_b32 s47, 0x20000
  s_cmp_ge_u32 s60, 2
  s_cbranch_scc1 L_q_go
  s_mov_b32 s70, 0
L_sn_26:
  ds_read_b32 v8, v38 offset:268
  s_waitcnt lgkmcnt(0)
  v_cmp_gt_u32 vcc, 0x4, v8
  s_cmp_eq_u64 vcc, 0
  s_cbranch_scc1 L_snd_27
  s_sleep 1
  s_add_u32 s70, s70, 1
  s_cmp_lt_u32 s70, 2097152
  s_cbranch_scc1 L_sn_26
L_snd_27:
L_q_go:
  v_lshrrev_b32 v2, 3, v1
  v_and_b32 v3, 6, v2
  v_xor_b32 v3, v3, v1
  v_mul_u32_u24 v2, 8192, v2
  v_and_b32 v3, 7, v3
  v_lshl_add_u32 v2, v3, 4, v2
  s_mul_i32 s49, s5, 1048576
  s_lshl_b32 s50, s5, 14
  s_add_u32 s49, s49, s48
  s_add_u32 s50, s50, 12288
  s_add_u32 s51, s50, 16384
L_dma_28:
  s_mov_b32 m0, s50
  s_add_u32 s50, s50, 1024
  buffer_load_dwordx4 v2, s[44:47], s49 offen nt lds
  s_add_u32 s49, s49, 65536
  s_cmp_lt_u32 s50, s51
  s_cbranch_scc1 L_dma_28
L_dmae_29:
  v_mov_b32 v3, 1
  s_mov_b64 exec, 1
  ds_add_u32 v38, v3 offset:264
  s_mov_b64 exec, -1
  s_waitcnt lgkmcnt(0)
  s_mul_i32 s74, s74, 0x9e3779b1
  s_add_u32 s74, s74, 0x7f4a7c15
  v_bfe_u32 v6, v1, 2, 1
  v_lshlrev_b32 v6, 5, v6
  v_add_u32 v6, 3136, v6
  s_lshl_b32 s49, s5, 3
  v_add_u32 v5, s49, v6
  s_waitcnt vmcnt(16)
  v_lshlrev_b32 v20, 16, v14
  v_and_b32 v21, s73, v14
  v_lshlrev_b32 v22, 16, v15
  v_and_b32 v23, s73, v15
  v_add_f32 v8, v20, v21
  v_mul_f32 v9, v20, v20
  v_add_f32 v10, v22, v23
  v_mul_f32 v11, v22, v22
  v_fmac_f32 v9, v21, v21
  v_fmac_f32 v11, v23, v23
  v_add_f32 v8, v8, v10
  v_add_f32 v9, v9, v11
  s_nop 0
  v_add_f32_dpp v8, v8, v8 quad_perm:[1,0,3,2] row_mask:0xf bank_mask:0xf
  v_add_f32_dpp v9, v9, v9 quad_perm:[1,0,3,2] row_mask:0xf bank_mask:0xf
  s_nop 0
  v_add_f32_dpp v8, v8, v8 quad_perm:[2,3,0,1] row_mask:0xf bank_mask:0xf
  v_add_f32_dpp v9, v9, v9 quad_perm:[2,3,0,1] row_mask:0xf bank_mask:0xf
  s_nop 0
  v_add_f32_dpp v8, v8, v8 row_ror:8 row_mask:0xf bank_mask:0xf
  v_add_f32_dpp v9, v9, v9 row_ror:8 row_mask:0xf bank_mask:0xf
  s_nop 0
  v_mov_b32 v10, v8
  v_mov_b32 v11, v9
  s_nop 0
  v_permlane16_swap_b32 v10, v8
  v_permlane16_swap_b32 v11, v9
  v_add_f32 v8, v8, v10
  v_add_f32 v9, v9, v11
  v_mov_b32 v10, v8
  v_mov_b32 v11, v9
  s_nop 0
  v_permlane32_swap_b32 v10, v8
  v_permlane32_swap_b32 v11, v9
  v_add_f32 v8, v8, v10
  v_add_f32 v9, v9, v11
  ds_write_b64 v5, v[8:9]
  s_waitcnt vmcnt(0) lgkmcnt(0)
  s_add_u32 s77, s77, 4
  v_mov_b32 v9, 1
  s_mov_b64 exec, 1
  ds_add_u32 v38, v9 offset:312
  s_mov_b64 exec, -1
  s_mov_b32 s70, 0
L_hy_30:
  ds_read_b32 v9, v38 offset:312
  s_waitcnt lgkmcnt(0)
  v_cmp_gt_u32 vcc, s77, v9
  s_cmp_eq_u64 vcc, 0
  s_cbranch_scc1 L_hyd_31
  s_add_u32 s70, s70, 1
  s_cmp_lt_u32 s70, 2097152
  s_cbranch_scc1 L_hy_30
L_hyd_31:
  ds_read_b128 v[24:27], v6
  ds_read_b128 v[28:31], v6 offset:16
  s_waitcnt lgkmcnt(0)
  v_pk_add_f32 v[24:25], v[24:25], v[26:27]
  v_pk_add_f32 v[28:29], v[28:29], v[30:31]
  v_pk_add_f32 v[24:25], v[24:25], v[28:29]
  v_mul_f32 v8, 0x3b000000, v24
  v_mul_f32 v9, 0x3b000000, v25
  v_fma_f32 v9, -v8, v8, v9
  v_cvt_pk_bf16_f32 v8, 0, v8
  v_max_f32 v9, 0, v9
  v_cvt_pk_bf16_f32 v9, 0, v9
  v_sub_f32 v20, v20, v8
  v_sub_f32 v21, v21, v8
  v_add_f32 v9, 0x3727c5ac, v9
  v_sub_f32 v22, v22, v8
  v_sub_f32 v23, v23, v8
  v_cvt_pk_bf16_f32 v9, 0, v9
  v_cvt_pk_bf16_f32 v20, 0, v20
  v_sqrt_f32 v9, v9
  v_cvt_pk_bf16_f32 v21, 0, v21
  v_cvt_pk_bf16_f32 v9, 0, v9
  v_cvt_pk_bf16_f32 v22, 0, v22
  v_rcp_f32 v9, v9
  v_cvt_pk_bf16_f32 v23, 0, v23
  v_mul_f32 v20, v20, v9
  v_mul_f32 v21, v21, v9
  v_mul_f32 v22, v22, v9
  v_mul_f32 v23, v23, v9
  v_cvt_pk_bf16_f32 v20, 0, v20
  v_cvt_pk_bf16_f32 v21, 0, v21
  v_cvt_pk_bf16_f32 v22, 0, v22
  v_cvt_pk_bf16_f32 v23, 0, v23
  s_lshl_b32 s49, s8, 13
  s_add_u32 s49, s49, 917504
  v_lshl_add_u32 v15, v0, 4, s49
  v_add_u32 v36, 0x1000, v15
  s_mov_b64 s[64:65], -1
  s_mov_b64 s[66:67], -1
  s_mov_b64 exec, s[64:65]
  global_load_dwordx4 v[16:19], v15, s[42:43] sc1
  s_mov_b64 exec, s[66:67]
  global_load_dwordx4 v[32:35], v36, s[42:43] sc1
  s_mov_b64 exec, -1
  v_lshrrev_b32 v2, 2, v1
  v_bfe_u32 v3, v1, 1, 1
  s_lshl_b32 s49, s5, 1
  v_or_b32 v3, s49, v3
  v_and_b32 v10, 6, v2
  v_xor_b32 v3, v3, v10
  v_lshlrev_b32 v2, 7, v2
  v_lshl_add_u32 v2, v3, 4, v2
  v_and_b32 v3, 1, v1
  v_lshl_add_u32 v2, v3, 3, v2
  v_add_u32 v2, 12288, v2
  ds_read_b64_tr_b16 v[40:41], v2 offset:0
  ds_read_b64_tr_b16 v[42:43], v2 offset:2048
  ds_read_b64_tr_b16 v[44:45], v2 offset:4096
  ds_read_b64_tr_b16 v[46:47], v2 offset:6144
  ds_read_b64_tr_b16 v[48:49], v2 offset:8192
  ds_read_b64_tr_b16 v[50:51], v2 offset:10240
  ds_read_b64_tr_b16 v[52:53], v2 offset:12288
  ds_read_b64_tr_b16 v[54:55], v2 offset:14336
  ds_read_b64_tr_b16 v[56:57], v2 offset:16384
  ds_read_b64_tr_b16 v[58:59], v2 offset:18432
  ds_read_b64_tr_b16 v[60:61], v2 offset:20480
  ds_read_b64_tr_b16 v[62:63], v2 offset:22528
  s_waitcnt lgkmcnt(10)
  ds_read_b64_tr_b16 v[64:65], v2 offset:24576
  ds_read_b64_tr_b16 v[66:67], v2 offset:26624
  s_waitcnt lgkmcnt(10)
  ds_read_b64_tr_b16 v[68:69], v2 offset:28672
  ds_read_b64_tr_b16 v[70:71], v2 offset:30720
  s_waitcnt lgkmcnt(10)
  ds_read_b64_tr_b16 v[72:73], v2 offset:32768
  ds_read_b64_tr_b16 v[74:75], v2 offset:34816
  s_waitcnt lgkmcnt(10)
  ds_read_b64_tr_b16 v[76:77], v2 offset:36864
  ds_read_b64_tr_b16 v[78:79], v2 offset:38912
  s_waitcnt lgkmcnt(10)
  ds_read_b64_tr_b16 v[80:81], v2 offset:40960
  ds_read_b64_tr_b16 v[82:83], v2 offset:43008
  s_waitcnt lgkmcnt(10)
  ds_read_b64_tr_b16 v[84:85], v2 offset:45056
  ds_read_b64_tr_b16 v[86:87], v2 offset:47104
  s_waitcnt lgkmcnt(10)
  ds_read_b64_tr_b16 v[88:89], v2 offset:49152
  ds_read_b64_tr_b16 v[90:91], v2 offset:51200
  s_waitcnt lgkmcnt(10)
  ds_read_b64_tr_b16 v[92:93], v2 offset:53248
  ds_read_b64_tr_b16 v[94:95], v2 offset:55296
  s_waitcnt lgkmcnt(10)
  ds_read_b64_tr_b16 v[96:97], v2 offset:57344
  ds_read_b64_tr_b16 v[98:99], v2 offset:59392
  s_waitcnt lgkmcnt(10)
  ds_read_b64_tr_b16 v[100:101], v2 offset:61440
  ds_read_b64_tr_b16 v[102:103], v2 offset:63488
  s_waitcnt lgkmcnt(10)
  s_waitcnt lgkmcnt(0)
  v_and_b32 v13, 1, v1
  v_lshlrev_b32 v13, 14, v13
  v_lshrrev_b32 v3, 4, v1
  v_lshl_add_u32 v13, v3, 4, v13
  s_lshl_b32 s49, s5, 6
  s_add_u32 s49, s49, s58
  v_add_u32 v13, s49, v13
  v_and_b32 v14, 1, v1
  v_mul_u32_u24 v14, 1056, v14
  v_lshrrev_b32 v3, 4, v1
  v_lshl_add_u32 v14, v3, 4, v14
  v_add_u32 v14, 1024, v14
  s_mov_b32 s70, 0
  s_branch L_q_c
L_q_p:
  s_mov_b64 exec, s[64:65]
  global_load_dwordx4 v[16:19], v15, s[42:43] sc1
  s_mov_b64 exec, s[66:67]
  global_load_dwordx4 v[32:35], v36, s[42:43] sc1
  s_mov_b64 exec, -1
L_q_c:
  s_waitcnt vmcnt(0)
  v_cmp_ne_u32 s[64:65], s74, v17
  v_cmp_ne_u32 s[68:69], s74, v19
  s_or_b64 s[64:65], s[64:65], s[68:69]
  v_cmp_ne_u32 s[66:67], s74, v33
  v_cmp_ne_u32 s[68:69], s74, v35
  s_or_b64 s[66:67], s[66:67], s[68:69]
  s_or_b64 vcc, s[64:65], s[66:67]
  s_or_b32 s64, s64, 1
  s_or_b32 s66, s66, 1
  s_cmp_eq_u64 vcc, 0
  s_cbranch_scc1 L_q_ok
  s_sleep 2
  s_add_u32 s70, s70, 1
  s_cmp_lt_u32 s70, 262144
  s_cbranch_scc1 L_q_p
L_q_ok:
  v_lshlrev_b32 v28, 16, v32
  v_and_b32 v29, s73, v32
  v_lshlrev_b32 v30, 16, v34
  v_and_b32 v31, s73, v34
  v_lshlrev_b32 v24, 16, v16
  v_and_b32 v25, s73, v16
  v_lshlrev_b32 v26, 16, v18
  v_and_b32 v27, s73, v18
  v_add_f32 v28, 1.0, v28
  v_add_f32 v29, 1.0, v29
  v_add_f32 v30, 1.0, v30
  v_add_f32 v31, 1.0, v31
  v_cvt_pk_bf16_f32 v28, 0, v28
  v_cvt_pk_bf16_f32 v29, 0, v29
  v_cvt_pk_bf16_f32 v30, 0, v30
  v_cvt_pk_bf16_f32 v31, 0, v31
  v_mul_f32 v20, v20, v28
  v_mul_f32 v21, v21, v29
  v_mul_f32 v22, v22, v30
  v_mul_f32 v23, v23, v31
  v_cvt_pk_bf16_f32 v20, 0, v20
  v_cvt_pk_bf16_f32 v21, 0, v21
  v_cvt_pk_bf16_f32 v22, 0, v22
  v_cvt_pk_bf16_f32 v23, 0, v23
  v_add_f32 v20, v20, v24
  v_add_f32 v21, v21, v25
  v_add_f32 v22, v22, v26
  v_add_f32 v23, v23, v27
  v_cvt_pk_bf16_f32 v16, v20, v21
  v_cvt_pk_bf16_f32 v17, v22, v23
  ds_write_b64 v12, v[16:17] offset:1024
  s_add_u32 s77, s77, 4
  v_mov_b32 v9, 1
  s_mov_b64 exec, 1
  ds_add_u32 v38, v9 offset:312
  s_mov_b64 exec, -1
  s_mov_b32 s70, 0
L_hy_32:
  ds_read_b32 v9, v38 offset:312
  s_waitcnt lgkmcnt(0)
  v_cmp_gt_u32 vcc, s77, v9
  s_cmp_eq_u64 vcc, 0
  s_cbranch_scc1 L_hyd_33
  s_add_u32 s70, s70, 1
  s_cmp_lt_u32 s70, 2097152
  s_cbranch_scc1 L_hy_32
L_hyd_33:
  ds_read_b128 v[104:107], v14 offset:0
  ds_read_b128 v[108:111], v14 offset:64
  ds_read_b128 v[112:115], v14 offset:128
  ds_read_b128 v[116:119], v14 offset:192
  ds_read_b128 v[120:123], v14 offset:256
  ds_read_b128 v[124:127], v14 offset:320
  ds_read_b128 v[128:131], v14 offset:384
  ds_read_b128 v[132:135], v14 offset:448
  ds_read_b128 v[136:139], v14 offset:512
  ds_read_b128 v[140:143], v14 offset:576
  ds_read_b128 v[144:147], v14 offset:640
  ds_read_b128 v[148:151], v14 offset:704
  s_waitcnt lgkmcnt(11)
  v_mfma_f32_16x16x32_bf16 v[8:11], v[40:43], v[104:107], 0
  ds_read_b128 v[152:155], v14 offset:768
  s_waitcnt lgkmcnt(11)
  v_mfma_f32_16x16x32_bf16 v[8:11], v[44:47], v[108:111], v[8:11]
  ds_read_b128 v[156:159], v14 offset:832
  s_waitcnt lgkmcnt(11)
  v_mfma_f32_16x16x32_bf16 v[8:11], v[48:51], v[112:115], v[8:11]
  ds_read_b128 v[160:163], v14 offset:896
  s_waitcnt lgkmcnt(11)
  v_mfma_f32_16x16x32_bf16 v[8:11], v[52:55], v[116:119], v[8:11]
  ds_read_b128 v[164:167], v14 offset:960
  s_waitcnt lgkmcnt(11)
  v_mfma_f32_16x16x32_bf16 v[8:11], v[56:59], v[120:123], v[8:11]
  s_waitcnt lgkmcnt(10)
  v_mfma_f32_16x16x32_bf16 v[8:11], v[60:63], v[124:127], v[8:11]
  s_waitcnt lgkmcnt(9)
  v_mfma_f32_16x16x32_bf16 v[8:11], v[64:67], v[128:131], v[8:11]
  s_waitcnt lgkmcnt(8)
  v_mfma_f32_16x16x32_bf16 v[8:11], v[68:71], v[132:135], v[8:11]
  s_waitcnt lgkmcnt(7)
  v_mfma_f32_16x16x32_bf16 v[8:11], v[72:75], v[136:139], v[8:11]
  s_waitcnt lgkmcnt(6)
  v_mfma_f32_16x16x32_bf16 v[8:11], v[76:79], v[140:143], v[8:11]
  s_waitcnt lgkmcnt(5)
  v_mfma_f32_16x16x32_bf16 v[8:11], v[80:83], v[144:147], v[8:11]
  s_waitcnt lgkmcnt(4)
  v_mfma_f32_16x16x32_bf16 v[8:11], v[84:87], v[148:151], v[8:11]
  s_waitcnt lgkmcnt(3)
  v_mfma_f32_16x16x32_bf16 v[8:11], v[88:91], v[152:155], v[8:11]
  s_waitcnt lgkmcnt(2)
  v_mfma_f32_16x16x32_bf16 v[8:11], v[92:95], v[156:159], v[8:11]
  s_waitcnt lgkmcnt(1)
  v_mfma_f32_16x16x32_bf16 v[8:11], v[96:99], v[160:163], v[8:11]
  s_waitcnt lgkmcnt(0)
  v_mfma_f32_16x16x32_bf16 v[8:11], v[100:103], v[164:167], v[8:11]
  s_nop 7
  v_cvt_pk_bf16_f32 v8, v8, v9
  v_cvt_pk_bf16_f32 v10, v10, v11
  v_mov_b32 v9, s74
  v_mov_b32 v11, s74
  v_min_u32 v8, s72, v8
  v_min_u32 v10, s72, v10
  s_mov_b32 exec_lo, 0x00030003
  s_mov_b32 exec_hi, 0x00030003
  global_store_dwordx4 v13, v[8:11], s[42:43] sc1
  s_mov_b64 exec, -1
L_r_wo:
  s_xor_b32 s61, s60, 1
  s_lshl_b32 s48, s8, 19
  s_lshl_b32 s49, s61, 7
  s_add_u32 s48, s48, s49
  s_lshr_b32 s58, s8, 1
  s_lshl_b32 s58, s58, 14
  s_and_b32 s49, s8, 1
  s_lshl_b32 s49, s49, 12
  s_add_u32 s58, s58, s49
  s_lshl_b32 s49, s61, 9
  s_add_u32 s58, s58, s49
  s_add_u32 s58, s58, 262144
  s_mov_b32 s44, s24
  s_mov_b32 s45, s25
  s_mov_b32 s46, 4194304
  s_mov_b32 s47, 0x20000
  v_lshrrev_b32 v2, 3, v1
  v_and_b32 v3, 6, v2
  v_xor_b32 v3, v3, v1
  v_mul_u32_u24 v2, 1024, v2
  v_and_b32 v3, 7, v3
  v_lshl_add_u32 v2, v3, 4, v2
  s_mul_i32 s49, s5, 131072
  s_lshl_b32 s50, s5, 14
  s_add_u32 s49, s49, s48
  s_add_u32 s50, s50, 12288
  s_add_u32 s51, s50, 16384
L_dma_34:
  s_mov_b32 m0, s50
  s_add_u32 s50, s50, 1024
  buffer_load_dwordx4 v2, s[44:47], s49 offen nt lds
  s_add_u32 s49, s49, 8192
  s_waitcnt vmcnt(3)
  s_cmp_lt_u32 s50, s51
  s_cbranch_scc1 L_dma_34
L_dmae_35:
  s_bfe_u32 s32, s74, 0x80000
  s_bfe_u32 s33, s74, 0x80008
  s_bfe_u32 s34, s74, 0x80010
  s_bfe_u32 s35, s74, 0x80018
  s_lshl2_add_u32 s49, s8, s5
  s_lshl_b32 s49, s49, 11
  s_add_u32 s49, s49, 131072
  v_lshrrev_b32 v12, 5, v1
  v_and_b32 v16, 31, v1
  v_lshlrev_b32 v15, 16, v12
  v_lshl_add_u32 v15, v16, 4, v15
  v_add_u32 v15, s49, v15
  v_mul_u32_u24 v12, 1056, v12
  v_bfe_u32 v16, v1, 3, 2
  v_lshl_add_u32 v12, v16, 6, v12
  v_and_b32 v16, 3, v1
  v_lshl_add_u32 v12, v16, 4, v12
  v_bfe_u32 v16, v1, 2, 1
  v_lshl_add_u32 v12, v16, 3, v12
  s_lshl_b32 s49, s5, 8
  v_add_u32 v12, s49, v12
  v_and_b32 v13, 1, v1
  v_lshlrev_b32 v13, 6, v13
  v_lshrrev_b32 v3, 4, v1
  v_lshl_add_u32 v13, v3, 4, v13
  s_lshl_b32 s49, s5, 7
  s_add_u32 s49, s49, s58
  v_add_u32 v13, s49, v13
  v_mov_b32 v36, 0xff
  global_load_dword v11, v13, s[42:43] sc1
  s_waitcnt vmcnt(0)
  s_add_u32 s77, s77, 4
  v_mov_b32 v9, 1
  s_mov_b64 exec, 1
  ds_add_u32 v38, v9 offset:312
  s_mov_b64 exec, -1
  s_mov_b32 s70, 0
L_hy_36:
  ds_read_b32 v9, v38 offset:312
  s_waitcnt lgkmcnt(0)
  v_cmp_gt_u32 vcc, s77, v9
  s_cmp_eq_u64 vcc, 0
  s_cbranch_scc1 L_hyd_37
  s_sleep 4
  s_add_u32 s70, s70, 1
  s_cmp_lt_u32 s70, 2097152
  s_cbranch_scc1 L_hy_36
L_hyd_37:
  v_lshrrev_b32 v2, 2, v1
  v_bfe_u32 v3, v1, 1, 1
  s_lshl_b32 s49, s5, 1
  v_or_b32 v3, s49, v3
  v_and_b32 v10, 6, v2
  v_xor_b32 v3, v3, v10
  v_lshlrev_b32 v2, 7, v2
  v_lshl_add_u32 v2, v3, 4, v2
  v_and_b32 v3, 1, v1
  v_lshl_add_u32 v2, v3, 3, v2
  v_add_u32 v2, 12288, v2
  ds_read_b64_tr_b16 v[40:41], v2 offset:0
  ds_read_b64_tr_b16 v[42:43], v2 offset:2048
  ds_read_b64_tr_b16 v[44:45], v2 offset:4096
  ds_read_b64_tr_b16 v[46:47], v2 offset:6144
  ds_read_b64_tr_b16 v[48:49], v2 offset:8192
  ds_read_b64_tr_b16 v[50:51], v2 offset:10240
  ds_read_b64_tr_b16 v[52:53], v2 offset:12288
  ds_read_b64_tr_b16 v[54:55], v2 offset:14336
  ds_read_b64_tr_b16 v[56:57], v2 offset:16384
  ds_read_b64_tr_b16 v[58:59], v2 offset:18432
  ds_read_b64_tr_b16 v[60:61], v2 offset:20480
  ds_read_b64_tr_b16 v[62:63], v2 offset:22528
  s_waitcnt lgkmcnt(10)
  ds_read_b64_tr_b16 v[64:65], v2 offset:24576
  ds_read_b64_tr_b16 v[66:67], v2 offset:26624
  s_waitcnt lgkmcnt(10)
  ds_read_b64_tr_b16 v[68:69], v2 offset:28672
  ds_read_b64_tr_b16 v[70:71], v2 offset:30720
  s_waitcnt lgkmcnt(10)
  ds_read_b64_tr_b16 v[72:73], v2 offset:32768
  ds_read_b64_tr_b16 v[74:75], v2 offset:34816
  s_waitcnt lgkmcnt(10)
  ds_read_b64_tr_b16 v[76:77], v2 offset:36864
  ds_read_b64_tr_b16 v[78:79], v2 offset:38912
  s_waitcnt lgkmcnt(10)
  ds_read_b64_tr_b16 v[80:81], v2 offset:40960
  ds_read_b64_tr_b16 v[82:83], v2 offset:43008
  s_waitcnt lgkmcnt(10)
  ds_read_b64_tr_b16 v[84:85], v2 offset:45056
  ds_read_b64_tr_b16 v[86:87], v2 offset:47104
  s_waitcnt lgkmcnt(10)
  ds_read_b64_tr_b16 v[88:89], v2 offset:49152
  ds_read_b64_tr_b16 v[90:91], v2 offset:51200
  s_waitcnt lgkmcnt(10)
  ds_read_b64_tr_b16 v[92:93], v2 offset:53248
  ds_read_b64_tr_b16 v[94:95], v2 offset:55296
  s_waitcnt lgkmcnt(10)
  ds_read_b64_tr_b16 v[96:97], v2 offset:57344
  ds_read_b64_tr_b16 v[98:99], v2 offset:59392
  s_waitcnt lgkmcnt(10)
  ds_read_b64_tr_b16 v[100:101], v2 offset:61440
  ds_read_b64_tr_b16 v[102:103], v2 offset:63488
  s_waitcnt lgkmcnt(10)
  s_waitcnt lgkmcnt(0)
  s_mov_b32 s70, 0
L_pl_38:
  ds_read_b32 v8, v38 offset:256
  s_waitcnt lgkmcnt(0)
  v_cmp_eq_u32 vcc, -1, v8
  s_cmp_eq_u64 vcc, 0
  s_cbranch_scc1 L_pld_39
  s_sleep 8
  s_add_u32 s70, s70, 1
  s_cmp_lt_u32 s70, 1048576
  s_cbranch_scc1 L_pl_38
L_pld_39:
  s_mov_b64 s[20:21], -1
  s_mov_b64 s[22:23], -1
  s_mov_b64 s[24:25], -1
  s_mov_b64 exec, s[20:21]
  global_load_dwordx4 v[152:155], v15, s[42:43] offset:0 sc1
  s_mov_b64 exec, s[22:23]
  global_load_dwordx4 v[156:159], v15, s[42:43] offset:512 sc1
  s_mov_b64 exec, s[24:25]
  global_load_dwordx4 v[160:163], v15, s[42:43] offset:1024 sc1
  s_mov_b64 exec, -1
  s_waitcnt vmcnt(0)
  s_mov_b32 s70, 0
  s_branch L_wo_c
L_wo_:
  s_mov_b64 exec, s[20:21]
  global_load_dwordx4 v[152:155], v15, s[42:43] offset:0 sc1
  s_mov_b64 exec, s[22:23]
  global_load_dwordx4 v[156:159], v15, s[42:43] offset:512 sc1
  s_mov_b64 exec, s[24:25]
  global_load_dwordx4 v[160:163], v15, s[42:43] offset:1024 sc1
  s_mov_b64 exec, -1
  s_waitcnt vmcnt(0)
L_wo_c:
  v_xor_b32 v136, s32, v152
  v_xor_b32 v137, s33, v153
  v_xor_b32 v138, s34, v154
  v_xor_b32 v139, s35, v155
  v_xor_b32 v140, s32, v156
  v_xor_b32 v141, s33, v157
  v_xor_b32 v142, s34, v158
  v_xor_b32 v143, s35, v159
  v_xor_b32 v144, s32, v160
  v_xor_b32 v145, s33, v161
  v_xor_b32 v146, s34, v162
  v_xor_b32 v147, s35, v163
  v_or3_b32 v28, v136, v137, v138
  v_or3_b32 v29, v140, v141, v142
  v_or3_b32 v30, v144, v145, v146
  v_or_b32 v28, v28, v139
  v_or_b32 v29, v29, v143
  v_or_b32 v30, v30, v147
  v_cmp_ne_u32_sdwa s[20:21], v28, v38 src0_sel:BYTE_0 src1_sel:DWORD
  v_cmp_ne_u32_sdwa s[22:23], v29, v38 src0_sel:BYTE_0 src1_sel:DWORD
  v_cmp_ne_u32_sdwa s[24:25], v30, v38 src0_sel:BYTE_0 src1_sel:DWORD
  v_or_b32 v136, 0x80, v136
  v_or_b32 v137, 0x80, v137
  v_or_b32 v138, 0x80, v138
  v_or_b32 v139, 0x80, v139
  v_or_b32 v140, 0x80, v140
  v_or_b32 v141, 0x80, v141
  v_or_b32 v142, 0x80, v142
  v_or_b32 v143, 0x80, v143
  v_or_b32 v144, 0x80, v144
  v_or_b32 v145, 0x80, v145
  v_or_b32 v146, 0x80, v146
  v_or_b32 v147, 0x80, v147
  v_pk_add_f32 v[16:17], v[136:137], v[140:141]
  v_pk_add_f32 v[18:19], v[138:139], v[142:143]
  v_pk_add_f32 v[16:17], v[16:17], v[144:145]
  v_pk_add_f32 v[18:19], v[18:19], v[146:147]
  s_mov_b64 vcc, s[20:21]
  s_or_b64 vcc, vcc, s[22:23]
  s_or_b64 vcc, vcc, s[24:25]
  s_or_b32 s20, s20, 1
  s_or_b32 s22, s22, 1
  s_or_b32 s24, s24, 1
  s_cmp_eq_u64 vcc, 0
  s_cbranch_scc1 L_wo_ok
  s_add_u32 s70, s70, 1
  s_cmp_lt_u32 s70, 262144
  s_cbranch_scc1 L_wo_
L_wo_ok:
  v_cvt_pk_bf16_f32 v8, v16, v17
  v_cvt_pk_bf16_f32 v9, v18, v19
  ds_write_b64 v12, v[8:9] offset:1024
  s_add_u32 s77, s77, 4
  v_mov_b32 v3, 1
  s_mov_b64 exec, 1
  ds_add_u32 v38, v3 offset:312
  s_mov_b64 exec, -1
  s_mov_b32 s70, 0
L_hy_40:
  ds_read_b32 v3, v38 offset:312
  ds_read_b128 v[104:107], v14 offset:0
  ds_read_b128 v[108:111], v14 offset:64
  ds_read_b128 v[112:115], v14 offset:128
  ds_read_b128 v[116:119], v14 offset:192
  s_waitcnt lgkmcnt(4)
  v_cmp_gt_u32 vcc, s77, v3
  s_cmp_eq_u64 vcc, 0
  s_cbranch_scc1 L_hyd_41
  s_waitcnt lgkmcnt(0)
  s_add_u32 s70, s70, 1
  s_cmp_lt_u32 s70, 2097152
  s_cbranch_scc1 L_hy_40
L_hyd_41:
  ds_read_b128 v[120:123], v14 offset:256
  ds_read_b128 v[124:127], v14 offset:320
  ds_read_b128 v[128:131], v14 offset:384
  ds_read_b128 v[132:135], v14 offset:448
  ds_read_b128 v[136:139], v14 offset:512
  ds_read_b128 v[140:143], v14 offset:576
  ds_read_b128 v[144:147], v14 offset:640
  ds_read_b128 v[148:151], v14 offset:704
  s_waitcnt lgkmcnt(11)
  v_mfma_f32_16x16x32_bf16 v[8:11], v[40:43], v[104:107], 0
  s_waitcnt lgkmcnt(10)
  v_mfma_f32_16x16x32_bf16 v[8:11], v[44:47], v[108:111], v[8:11]
  ds_read_b128 v[104:107], v14 offset:768
  s_waitcnt lgkmcnt(10)
  v_mfma_f32_16x16x32_bf16 v[8:11], v[48:51], v[112:115], v[8:11]
  ds_read_b128 v[108:111], v14 offset:832
  s_waitcnt lgkmcnt(10)
  v_mfma_f32_16x16x32_bf16 v[8:11], v[52:55], v[116:119], v[8:11]
  ds_read_b128 v[112:115], v14 offset:896
  s_waitcnt lgkmcnt(10)
  v_mfma_f32_16x16x32_bf16 v[8:11], v[56:59], v[120:123], v[8:11]
  ds_read_b128 v[116:119], v14 offset:960
  s_waitcnt lgkmcnt(10)
  v_mfma_f32_16x16x32_bf16 v[8:11], v[60:63], v[124:127], v[8:11]
  s_waitcnt lgkmcnt(9)
  v_mfma_f32_16x16x32_bf16 v[8:11], v[64:67], v[128:131], v[8:11]
  s_waitcnt lgkmcnt(8)
  v_mfma_f32_16x16x32_bf16 v[8:11], v[68:71], v[132:135], v[8:11]
  s_waitcnt lgkmcnt(7)
  v_mfma_f32_16x16x32_bf16 v[8:11], v[72:75], v[136:139], v[8:11]
  s_waitcnt lgkmcnt(6)
  v_mfma_f32_16x16x32_bf16 v[8:11], v[76:79], v[140:143], v[8:11]
  s_waitcnt lgkmcnt(5)
  v_mfma_f32_16x16x32_bf16 v[8:11], v[80:83], v[144:147], v[8:11]
  s_waitcnt lgkmcnt(4)
  v_mfma_f32_16x16x32_bf16 v[8:11], v[84:87], v[148:151], v[8:11]
  s_waitcnt lgkmcnt(3)
  v_mfma_f32_16x16x32_bf16 v[8:11], v[88:91], v[104:107], v[8:11]
  s_waitcnt lgkmcnt(2)
  v_mfma_f32_16x16x32_bf16 v[8:11], v[92:95], v[108:111], v[8:11]
  s_waitcnt lgkmcnt(1)
  v_mfma_f32_16x16x32_bf16 v[8:11], v[96:99], v[112:115], v[8:11]
  s_waitcnt lgkmcnt(0)
  v_mfma_f32_16x16x32_bf16 v[8:11], v[100:103], v[116:119], v[8:11]
  s_nop 7
  v_bfi_b32 v8, v36, s32, v8
  v_bfi_b32 v9, v36, s33, v9
  v_bfi_b32 v10, v36, s34, v10
  v_bfi_b32 v11, v36, s35, v11
  s_mov_b32 exec_lo, 0x00030003
  s_mov_b32 exec_hi, 0x00030003
  global_store_dwordx4 v13, v[8:11], s[42:43] sc1
  v_mov_b32 v3, 1
  s_mov_b64 exec, 1
  ds_add_u32 v38, v3 offset:264
  s_mov_b64 exec, -1
  s_branch L_fin
L_r_mod:
  global_load_dwordx2 v[14:15], v37, s[34:35]
  s_mov_b32 s44, s36
  s_mov_b32 s45, s37
  s_mov_b32 s46, 3145728
  s_mov_b32 s47, 0x20000
  s_cmp_ge_u32 s60, 2
  s_cbranch_scc1 L_mod2
  s_lshl1_add_u32 s61, s8, s60
  s_lshl_b32 s48, s61, 7
  s_lshl_b32 s58, s61, 9
  s_add_u32 s58, s58, 917504
  v_lshrrev_b32 v2, 3, v1
  v_and_b32 v3, 6, v2
  v_xor_b32 v3, v3, v1
  v_mul_u32_u24 v2, 6144, v2
  v_and_b32 v3, 7, v3
  v_lshl_add_u32 v2, v3, 4, v2
  s_mul_i32 s49, s5, 786432
  s_lshl_b32 s50, s5, 14
  s_add_u32 s49, s49, s48
  s_add_u32 s50, s50, 77824
  s_add_u32 s51, s50, 16384
L_dma_42:
  s_mov_b32 m0, s50
  s_add_u32 s50, s50, 1024
  buffer_load_dwordx4 v2, s[44:47], s49 offen nt lds
  s_add_u32 s49, s49, 49152
  s_cmp_lt_u32 s50, s51
  s_cbranch_scc1 L_dma_42
L_dmae_43:
  v_mov_b32 v3, 1
  s_mov_b64 exec, 1
  ds_add_u32 v38, v3 offset:268
  s_mov_b64 exec, -1
  s_getpc_b64 s[56:57]
L_pc_44:
  s_lshr_b32 s3, s2, 5
  s_lshl3_add_u32 s3, s3, s8
  s_lshl_b32 s3, s3, 2
  s_add_u32 s3, s3, L_table-L_pc_44
  s_load_dword s14, s[56:57], s3
  s_waitcnt lgkmcnt(0)
  s_mul_i32 s74, s74, 0x9e3779b1
  s_add_u32 s74, s74, 0x7f4a7c15
  s_waitcnt vmcnt(16)
  v_lshlrev_b32 v16, 16, v14
  v_and_b32 v17, s73, v14
  v_lshlrev_b32 v18, 16, v15
  v_and_b32 v19, s73, v15
  v_mul_f32 v20, 0xbfb8aa3b, v16
  v_mul_f32 v21, 0xbfb8aa3b, v17
  v_mul_f32 v22, 0xbfb8aa3b, v18
  v_mul_f32 v23, 0xbfb8aa3b, v19
  v_exp_f32 v20, v20
  v_exp_f32 v21, v21
  v_exp_f32 v22, v22
  v_exp_f32 v23, v23
  s_nop 0
  v_add_f32 v20, 1.0, v20
  v_add_f32 v21, 1.0, v21
  v_add_f32 v22, 1.0, v22
  v_add_f32 v23, 1.0, v23
  v_rcp_f32 v20, v20
  v_rcp_f32 v21, v21
  v_rcp_f32 v22, v22
  v_rcp_f32 v23, v23
  s_nop 0
  v_mul_f32 v16, v16, v20
  v_mul_f32 v17, v17, v21
  v_mul_f32 v18, v18, v22
  v_mul_f32 v19, v19, v23
  v_cvt_pk_bf16_f32 v14, v16, v17
  v_cvt_pk_bf16_f32 v15, v18, v19
  ds_write_b64 v12, v[14:15] offset:3200
  v_and_b32 v13, 1, v1
  v_lshlrev_b32 v13, 6, v13
  v_lshrrev_b32 v3, 4, v1
  v_lshl_add_u32 v13, v3, 4, v13
  s_lshl_b32 s49, s5, 7
  s_add_u32 s49, s49, s58
  v_add_u32 v13, s49, v13
  v_bfe_u32 v3, v1, 1, 3
  v_lshl_add_u32 v13, v3, 13, v13
  v_and_b32 v14, 1, v1
  v_mul_u32_u24 v14, 1056, v14
  v_lshrrev_b32 v3, 4, v1
  v_lshl_add_u32 v14, v3, 4, v14
  v_add_u32 v14, 3200, v14
  v_lshrrev_b32 v2, 2, v1
  v_bfe_u32 v3, v1, 1, 1
  s_lshl_b32 s49, s5, 1
  v_or_b32 v3, s49, v3
  v_and_b32 v10, 6, v2
  v_xor_b32 v3, v3, v10
  v_lshlrev_b32 v2, 7, v2
  v_lshl_add_u32 v2, v3, 4, v2
  v_and_b32 v3, 1, v1
  v_lshl_add_u32 v2, v3, 3, v2
  v_add_u32 v2, 77824, v2
  s_waitcnt vmcnt(0) lgkmcnt(0)
  s_add_u32 s77, s77, 4
  v_mov_b32 v9, 1
  s_mov_b64 exec, 1
  ds_add_u32 v38, v9 offset:316
  s_mov_b64 exec, -1
  s_mov_b32 s70, 0
L_hy_45:
  ds_read_b32 v9, v38 offset:316
  s_waitcnt lgkmcnt(0)
  v_cmp_gt_u32 vcc, s77, v9
  s_cmp_eq_u64 vcc, 0
  s_cbranch_scc1 L_hyd_46
  s_add_u32 s70, s70, 1
  s_cmp_lt_u32 s70, 2097152
  s_cbranch_scc1 L_hy_45
L_hyd_46:
  ds_read_b64_tr_b16 v[40:41], v2 offset:0
  ds_read_b64_tr_b16 v[42:43], v2 offset:2048
  ds_read_b128 v[104:107], v14 offset:0
  ds_read_b64_tr_b16 v[44:45], v2 offset:4096
  ds_read_b64_tr_b16 v[46:47], v2 offset:6144
  ds_read_b128 v[108:111], v14 offset:64
  ds_read_b64_tr_b16 v[48:49], v2 offset:8192
  ds_read_b64_tr_b16 v[50:51], v2 offset:10240
  ds_read_b128 v[112:115], v14 offset:128
  ds_read_b64_tr_b16 v[52:53], v2 offset:12288
  ds_read_b64_tr_b16 v[54:55], v2 offset:14336
  ds_read_b128 v[116:119], v14 offset:192
  ds_read_b64_tr_b16 v[56:57], v2 offset:16384
  ds_read_b64_tr_b16 v[58:59], v2 offset:18432
  ds_read_b128 v[120:123], v14 offset:256
  s_waitcnt lgkmcnt(12)
  v_mfma_f32_16x16x32_bf16 v[8:11], v[40:43], v[104:107], 0
  ds_read_b64_tr_b16 v[60:61], v2 offset:20480
  ds_read_b64_tr_b16 v[62:63], v2 offset:22528
  ds_read_b128 v[124:127], v14 offset:320
  s_waitcnt lgkmcnt(12)
  v_mfma_f32_16x16x32_bf16 v[8:11], v[44:47], v[108:111], v[8:11]
  ds_read_b64_tr_b16 v[64:65], v2 offset:24576
  ds_read_b64_tr_b16 v[66:67], v2 offset:26624
  ds_read_b128 v[128:131], v14 offset:384
  s_waitcnt lgkmcnt(12)
  v_mfma_f32_16x16x32_bf16 v[8:11], v[48:51], v[112:115], v[8:11]
  ds_read_b64_tr_b16 v[68:69], v2 offset:28672
  ds_read_b64_tr_b16 v[70:71], v2 offset:30720
  ds_read_b128 v[132:135], v14 offset:448
  s_waitcnt lgkmcnt(12)
  v_mfma_f32_16x16x32_bf16 v[8:11], v[52:55], v[116:119], v[8:11]
  ds_read_b64_tr_b16 v[72:73], v2 offset:32768
  ds_read_b64_tr_b16 v[74:75], v2 offset:34816
  ds_read_b128 v[136:139], v14 offset:512
  s_waitcnt lgkmcnt(12)
  v_mfma_f32_16x16x32_bf16 v[8:11], v[56:59], v[120:123], v[8:11]
  ds_read_b64_tr_b16 v[76:77], v2 offset:36864
  ds_read_b64_tr_b16 v[78:79], v2 offset:38912
  ds_read_b128 v[140:143], v14 offset:576
  s_waitcnt lgkmcnt(12)
  v_mfma_f32_16x16x32_bf16 v[8:11], v[60:63], v[124:127], v[8:11]
  ds_read_b64_tr_b16 v[80:81], v2 offset:40960
  ds_read_b64_tr_b16 v[82:83], v2 offset:43008
  ds_read_b128 v[144:147], v14 offset:640
  s_waitcnt lgkmcnt(12)
  v_mfma_f32_16x16x32_bf16 v[8:11], v[64:67], v[128:131], v[8:11]
  ds_read_b64_tr_b16 v[84:85], v2 offset:45056
  ds_read_b64_tr_b16 v[86:87], v2 offset:47104
  ds_read_b128 v[148:151], v14 offset:704
  s_waitcnt lgkmcnt(12)
  v_mfma_f32_16x16x32_bf16 v[8:11], v[68:71], v[132:135], v[8:11]
  ds_read_b64_tr_b16 v[88:89], v2 offset:49152
  ds_read_b64_tr_b16 v[90:91], v2 offset:51200
  ds_read_b128 v[152:155], v14 offset:768
  s_waitcnt lgkmcnt(12)
  v_mfma_f32_16x16x32_bf16 v[8:11], v[72:75], v[136:139], v[8:11]
  ds_read_b64_tr_b16 v[92:93], v2 offset:53248
  ds_read_b64_tr_b16 v[94:95], v2 offset:55296
  ds_read_b128 v[156:159], v14 offset:832
  s_waitcnt lgkmcnt(12)
  v_mfma_f32_16x16x32_bf16 v[8:11], v[76:79], v[140:143], v[8:11]
  ds_read_b64_tr_b16 v[96:97], v2 offset:57344
  ds_read_b64_tr_b16 v[98:99], v2 offset:59392
  ds_read_b128 v[160:163], v14 offset:896
  s_waitcnt lgkmcnt(12)
  v_mfma_f32_16x16x32_bf16 v[8:11], v[80:83], v[144:147], v[8:11]
  ds_read_b64_tr_b16 v[100:101], v2 offset:61440
  ds_read_b64_tr_b16 v[102:103], v2 offset:63488
  ds_read_b128 v[164:167], v14 offset:960
  s_waitcnt lgkmcnt(12)
  v_mfma_f32_16x16x32_bf16 v[8:11], v[84:87], v[148:151], v[8:11]
  s_waitcnt lgkmcnt(9)
  v_mfma_f32_16x16x32_bf16 v[8:11], v[88:91], v[152:155], v[8:11]
  s_waitcnt lgkmcnt(6)
  v_mfma_f32_16x16x32_bf16 v[8:11], v[92:95], v[156:159], v[8:11]
  s_waitcnt lgkmcnt(3)
  v_mfma_f32_16x16x32_bf16 v[8:11], v[96:99], v[160:163], v[8:11]
  s_waitcnt lgkmcnt(0)
  v_mfma_f32_16x16x32_bf16 v[8:11], v[100:103], v[164:167], v[8:11]
  s_nop 7
  v_cvt_pk_bf16_f32 v8, v8, v9
  v_cvt_pk_bf16_f32 v10, v10, v11
  v_mov_b32 v9, s74
  v_mov_b32 v11, s74
  global_store_dwordx4 v13, v[8:11], s[42:43] sc1
  s_mov_b64 exec, -1
  s_add_u32 s77, s77, 4
  v_mov_b32 v9, 1
  s_mov_b64 exec, 1
  ds_add_u32 v38, v9 offset:316
  s_mov_b64 exec, -1
  s_mov_b32 s70, 0
L_hy_47:
  ds_read_b32 v9, v38 offset:316
  s_waitcnt lgkmcnt(0)
  v_cmp_gt_u32 vcc, s77, v9
  s_cmp_eq_u64 vcc, 0
  s_cbranch_scc1 L_hyd_48
  s_add_u32 s70, s70, 1
  s_cmp_lt_u32 s70, 2097152
  s_cbranch_scc1 L_hy_47
L_hyd_48:
  s_branch L_mod3
L_mod2:
  s_getpc_b64 s[56:57]
L_pc_49:
  s_lshr_b32 s3, s2, 5
  s_lshl3_add_u32 s3, s3, s8
  s_lshl_b32 s3, s3, 2
  s_add_u32 s3, s3, L_table-L_pc_49
  s_load_dword s14, s[56:57], s3
  s_waitcnt lgkmcnt(0)
  s_mul_i32 s74, s74, 0x9e3779b1
  s_add_u32 s74, s74, 0x7f4a7c15
  s_waitcnt vmcnt(0)
  v_lshlrev_b32 v16, 16, v14
  v_and_b32 v17, s73, v14
  v_lshlrev_b32 v18, 16, v15
  v_and_b32 v19, s73, v15
  v_mul_f32 v20, 0xbfb8aa3b, v16
  v_mul_f32 v21, 0xbfb8aa3b, v17
  v_mul_f32 v22, 0xbfb8aa3b, v18
  v_mul_f32 v23, 0xbfb8aa3b, v19
  v_exp_f32 v20, v20
  v_exp_f32 v21, v21
  v_exp_f32 v22, v22
  v_exp_f32 v23, v23
  s_nop 0
  v_add_f32 v20, 1.0, v20
  v_add_f32 v21, 1.0, v21
  v_add_f32 v22, 1.0, v22
  v_add_f32 v23, 1.0, v23
  v_rcp_f32 v20, v20
  v_rcp_f32 v21, v21
  v_rcp_f32 v22, v22
  v_rcp_f32 v23, v23
  s_nop 0
  v_mul_f32 v16, v16, v20
  v_mul_f32 v17, v17, v21
  v_mul_f32 v18, v18, v22
  v_mul_f32 v19, v19, v23
  v_cvt_pk_bf16_f32 v14, v16, v17
  v_cvt_pk_bf16_f32 v15, v18, v19
  ds_write_b64 v12, v[14:15] offset:3200
L_mod3:
  s_mov_b32 s70, 0
L_sn_50:
  ds_read_b32 v8, v38 offset:264
  s_waitcnt lgkmcnt(0)
  v_cmp_gt_u32 vcc, 0x4, v8
  s_cmp_eq_u64 vcc, 0
  s_cbranch_scc1 L_snd_51
  s_sleep 4
  s_add_u32 s70, s70, 1
  s_cmp_lt_u32 s70, 2097152
  s_cbranch_scc1 L_sn_50
L_snd_51:
  s_and_b32 s61, s14, 0xff
  s_cmp_ge_u32 s61, 48
  s_cbranch_scc1 L_r_f1
  s_mov_b32 s70, 0
L_sn_52:
  ds_read_b32 v8, v38 offset:312
  s_waitcnt lgkmcnt(0)
  v_cmp_gt_u32 vcc, 0x8, v8
  s_cmp_eq_u64 vcc, 0
  s_cbranch_scc1 L_snd_53
  s_sleep 4
  s_add_u32 s70, s70, 1
  s_cmp_lt_u32 s70, 2097152
  s_cbranch_scc1 L_sn_52
L_snd_53:
  s_and_b32 s61, s14, 0xff
L_mod4:
  s_cmp_ge_u32 s61, 48
  s_cbranch_scc1 L_r_f1
  s_lshl_b32 s48, s61, 7
  s_lshl_b32 s58, s61, 9
  s_add_u32 s58, s58, 4096
  v_lshrrev_b32 v2, 3, v1
  v_and_b32 v3, 6, v2
  v_xor_b32 v3, v3, v1
  v_mul_u32_u24 v2, 6144, v2
  v_and_b32 v3, 7, v3
  v_lshl_add_u32 v2, v3, 4, v2
  s_mul_i32 s49, s5, 786432
  s_lshl_b32 s50, s5, 14
  s_add_u32 s49, s49, s48
  s_add_u32 s50, s50, 77824
  s_add_u32 s51, s50, 16384
L_dma_54:
  s_mov_b32 m0, s50
  s_add_u32 s50, s50, 1024
  buffer_load_dwordx4 v2, s[44:47], s49 offen nt lds
  s_add_u32 s49, s49, 49152
  s_waitcnt vmcnt(5)
  s_cmp_lt_u32 s50, s51
  s_cbranch_scc1 L_dma_54
L_dmae_55:
  v_and_b32 v13, 1, v1
  v_lshlrev_b32 v13, 6, v13
  v_lshrrev_b32 v3, 4, v1
  v_lshl_add_u32 v13, v3, 4, v13
  s_lshl_b32 s49, s5, 7
  s_add_u32 s49, s49, s58
  v_add_u32 v13, s49, v13
  v_and_b32 v14, 1, v1
  v_mul_u32_u24 v14, 1056, v14
  v_lshrrev_b32 v3, 4, v1
  v_lshl_add_u32 v14, v3, 4, v14
  v_add_u32 v14, 3200, v14
  v_lshrrev_b32 v2, 2, v1
  v_bfe_u32 v3, v1, 1, 1
  s_lshl_b32 s49, s5, 1
  v_or_b32 v3, s49, v3
  v_and_b32 v10, 6, v2
  v_xor_b32 v3, v3, v10
  v_lshlrev_b32 v2, 7, v2
  v_lshl_add_u32 v2, v3, 4, v2
  v_and_b32 v3, 1, v1
  v_lshl_add_u32 v2, v3, 3, v2
  v_add_u32 v2, 77824, v2
  s_waitcnt vmcnt(0) lgkmcnt(0)
  s_add_u32 s77, s77, 4
  v_mov_b32 v9, 1
  s_mov_b64 exec, 1
  ds_add_u32 v38, v9 offset:316
  s_mov_b64 exec, -1
  s_mov_b32 s70, 0
L_hy_56:
  ds_read_b32 v9, v38 offset:316
  s_waitcnt lgkmcnt(0)
  v_cmp_gt_u32 vcc, s77, v9
  s_cmp_eq_u64 vcc, 0
  s_cbranch_scc1 L_hyd_57
  s_sleep 4
  s_add_u32 s70, s70, 1
  s_cmp_lt_u32 s70, 2097152
  s_cbranch_scc1 L_hy_56
L_hyd_57:
  ds_read_b64_tr_b16 v[40:41], v2 offset:0
  ds_read_b64_tr_b16 v[42:43], v2 offset:2048
  ds_read_b128 v[104:107], v14 offset:0
  ds_read_b64_tr_b16 v[44:45], v2 offset:4096
  ds_read_b64_tr_b16 v[46:47], v2 offset:6144
  ds_read_b128 v[108:111], v14 offset:64
  ds_read_b64_tr_b16 v[48:49], v2 offset:8192
  ds_read_b64_tr_b16 v[50:51], v2 offset:10240
  ds_read_b128 v[112:115], v14 offset:128
  ds_read_b64_tr_b16 v[52:53], v2 offset:12288
  ds_read_b64_tr_b16 v[54:55], v2 offset:14336
  ds_read_b128 v[116:119], v14 offset:192
  ds_read_b64_tr_b16 v[56:57], v2 offset:16384
  ds_read_b64_tr_b16 v[58:59], v2 offset:18432
  ds_read_b128 v[120:123], v14 offset:256
  s_waitcnt lgkmcnt(12)
  v_mfma_f32_16x16x32_bf16 v[8:11], v[40:43], v[104:107], 0
  ds_read_b64_tr_b16 v[60:61], v2 offset:20480
  ds_read_b64_tr_b16 v[62:63], v2 offset:22528
  ds_read_b128 v[124:127], v14 offset:320
  s_waitcnt lgkmcnt(12)
  v_mfma_f32_16x16x32_bf16 v[8:11], v[44:47], v[108:111], v[8:11]
  ds_read_b64_tr_b16 v[64:65], v2 offset:24576
  ds_read_b64_tr_b16 v[66:67], v2 offset:26624
  ds_read_b128 v[128:131], v14 offset:384
  s_waitcnt lgkmcnt(12)
  v_mfma_f32_16x16x32_bf16 v[8:11], v[48:51], v[112:115], v[8:11]
  ds_read_b64_tr_b16 v[68:69], v2 offset:28672
  ds_read_b64_tr_b16 v[70:71], v2 offset:30720
  ds_read_b128 v[132:135], v14 offset:448
  s_waitcnt lgkmcnt(12)
  v_mfma_f32_16x16x32_bf16 v[8:11], v[52:55], v[116:119], v[8:11]
  ds_read_b64_tr_b16 v[72:73], v2 offset:32768
  ds_read_b64_tr_b16 v[74:75], v2 offset:34816
  ds_read_b128 v[136:139], v14 offset:512
  s_waitcnt lgkmcnt(12)
  v_mfma_f32_16x16x32_bf16 v[8:11], v[56:59], v[120:123], v[8:11]
  ds_read_b64_tr_b16 v[76:77], v2 offset:36864
  ds_read_b64_tr_b16 v[78:79], v2 offset:38912
  ds_read_b128 v[140:143], v14 offset:576
  s_waitcnt lgkmcnt(12)
  v_mfma_f32_16x16x32_bf16 v[8:11], v[60:63], v[124:127], v[8:11]
  ds_read_b64_tr_b16 v[80:81], v2 offset:40960
  ds_read_b64_tr_b16 v[82:83], v2 offset:43008
  ds_read_b128 v[144:147], v14 offset:640
  s_waitcnt lgkmcnt(12)
  v_mfma_f32_16x16x32_bf16 v[8:11], v[64:67], v[128:131], v[8:11]
  ds_read_b64_tr_b16 v[84:85], v2 offset:45056
  ds_read_b64_tr_b16 v[86:87], v2 offset:47104
  ds_read_b128 v[148:151], v14 offset:704
  s_waitcnt lgkmcnt(12)
  v_mfma_f32_16x16x32_bf16 v[8:11], v[68:71], v[132:135], v[8:11]
  ds_read_b64_tr_b16 v[88:89], v2 offset:49152
  ds_read_b64_tr_b16 v[90:91], v2 offset:51200
  ds_read_b128 v[152:155], v14 offset:768
  s_waitcnt lgkmcnt(12)
  v_mfma_f32_16x16x32_bf16 v[8:11], v[72:75], v[136:139], v[8:11]
  ds_read_b64_tr_b16 v[92:93], v2 offset:53248
  ds_read_b64_tr_b16 v[94:95], v2 offset:55296
  ds_read_b128 v[156:159], v14 offset:832
  s_waitcnt lgkmcnt(12)
  v_mfma_f32_16x16x32_bf16 v[8:11], v[76:79], v[140:143], v[8:11]
  ds_read_b64_tr_b16 v[96:97], v2 offset:57344
  ds_read_b64_tr_b16 v[98:99], v2 offset:59392
  ds_read_b128 v[160:163], v14 offset:896
  s_waitcnt lgkmcnt(12)
  v_mfma_f32_16x16x32_bf16 v[8:11], v[80:83], v[144:147], v[8:11]
  ds_read_b64_tr_b16 v[100:101], v2 offset:61440
  ds_read_b64_tr_b16 v[102:103], v2 offset:63488
  ds_read_b128 v[164:167], v14 offset:960
  s_waitcnt lgkmcnt(12)
  v_mfma_f32_16x16x32_bf16 v[8:11], v[84:87], v[148:151], v[8:11]
  s_waitcnt lgkmcnt(9)
  v_mfma_f32_16x16x32_bf16 v[8:11], v[88:91], v[152:155], v[8:11]
  s_waitcnt lgkmcnt(6)
  v_mfma_f32_16x16x32_bf16 v[8:11], v[92:95], v[156:159], v[8:11]
  s_waitcnt lgkmcnt(3)
  v_mfma_f32_16x16x32_bf16 v[8:11], v[96:99], v[160:163], v[8:11]
  s_waitcnt lgkmcnt(0)
  v_mfma_f32_16x16x32_bf16 v[8:11], v[100:103], v[164:167], v[8:11]
  s_nop 7
  v_cvt_pk_bf16_f32 v8, v8, v9
  v_cvt_pk_bf16_f32 v10, v10, v11
  v_mov_b32 v9, s74
  v_mov_b32 v11, s74
  s_mov_b32 exec_lo, 0x00030003
  s_mov_b32 exec_hi, 0x00030003
  global_store_dwordx4 v13, v[8:11], s[42:43] sc1
  s_mov_b64 exec, -1
  s_add_u32 s77, s77, 4
  v_mov_b32 v9, 1
  s_mov_b64 exec, 1
  ds_add_u32 v38, v9 offset:316
  s_mov_b64 exec, -1
  s_mov_b32 s70, 0
L_hy_58:
  ds_read_b32 v9, v38 offset:316
  s_waitcnt lgkmcnt(0)
  v_cmp_gt_u32 vcc, s77, v9
  s_cmp_eq_u64 vcc, 0
  s_cbranch_scc1 L_hyd_59
  s_add_u32 s70, s70, 1
  s_cmp_lt_u32 s70, 2097152
  s_cbranch_scc1 L_hy_58
L_hyd_59:
  s_lshr_b32 s61, s14, 24
  s_or_b32 s14, s14, 0xff000000
  s_branch L_mod4
L_r_f1:
  s_bfe_u32 s61, s14, 0x80008
  s_cmp_ge_u32 s61, 43
  s_cbranch_scc1 L_fin
  s_lshl_b32 s48, s61, 6
  s_lshl_b32 s58, s61, 7
  s_add_u32 s58, s58, 1572864
  s_cmp_lt_u32 s5, 2
  s_cselect_b32 s44, s28, s30
  s_cselect_b32 s45, s29, s31
  s_mov_b32 s46, 1409024
  s_and_b32 s54, s61, 1
  v_lshrrev_b32 v2, 2, v1
  v_mul_u32_u24 v2, 5504, v2
  s_and_b32 s49, s5, 2
  s_or_b32 s49, s49, s54
  v_xor_b32 v3, s49, v1
  v_and_b32 v3, 3, v3
  v_lshl_add_u32 v2, v3, 4, v2
  s_and_b32 s55, s5, 1
  s_mul_i32 s49, s55, 704512
  s_add_u32 s49, s49, s48
  s_mul_i32 s50, s54, 2752
  s_add_u32 s49, s49, s50
  s_lshr_b32 s50, s5, 1
  s_lshl_b32 s50, s50, 15
  s_lshl_b32 s54, s54, 14
  s_add_u32 s50, s50, s54
  s_lshl_b32 s55, s55, 13
  s_add_u32 s50, s50, s55
  s_add_u32 s50, s50, 77824
  s_mov_b32 s70, 0
L_sn_60:
  ds_read_b32 v8, v38 offset:312
  s_waitcnt lgkmcnt(0)
  v_cmp_gt_u32 vcc, 0x8, v8
  s_cmp_eq_u64 vcc, 0
  s_cbranch_scc1 L_snd_61
  s_sleep 4
  s_add_u32 s70, s70, 1
  s_cmp_lt_u32 s70, 2097152
  s_cbranch_scc1 L_sn_60
L_snd_61:
  s_add_u32 s51, s50, 8192
L_dma_62:
  s_mov_b32 m0, s50
  s_add_u32 s50, s50, 1024
  buffer_load_dwordx4 v2, s[44:47], s49 offen  lds
  s_add_u32 s49, s49, 88064
  s_waitcnt vmcnt(2)
  s_cmp_lt_u32 s50, s51
  s_cbranch_scc1 L_dma_62
L_dmae_63:
  s_andn2_b32 s54, 1, s61
  v_lshrrev_b32 v2, 2, v1
  v_mul_u32_u24 v2, 5504, v2
  s_and_b32 s49, s5, 2
  s_or_b32 s49, s49, s54
  v_xor_b32 v3, s49, v1
  v_and_b32 v3, 3, v3
  v_lshl_add_u32 v2, v3, 4, v2
  s_and_b32 s55, s5, 1
  s_mul_i32 s49, s55, 704512
  s_add_u32 s49, s49, s48
  s_mul_i32 s50, s54, 2752
  s_add_u32 s49, s49, s50
  s_lshr_b32 s50, s5, 1
  s_lshl_b32 s50, s50, 15
  s_lshl_b32 s54, s54, 14
  s_add_u32 s50, s50, s54
  s_lshl_b32 s55, s55, 13
  s_add_u32 s50, s50, s55
  s_add_u32 s50, s50, 77824
  s_add_u32 s51, s50, 8192
L_dma_64:
  s_mov_b32 m0, s50
  s_add_u32 s50, s50, 1024
  buffer_load_dwordx4 v2, s[44:47], s49 offen nt lds
  s_add_u32 s49, s49, 88064
  s_waitcnt vmcnt(2)
  s_cmp_lt_u32 s50, s51
  s_cbranch_scc1 L_dma_64
L_dmae_65:
  v_lshlrev_b32 v15, 4, v0
  v_add_u32 v39, 16384, v15
  v_add_u32 v15, 266240, v15
  v_lshrrev_b32 v5, 2, v0
  v_lshlrev_b32 v5, 3, v5
  v_add_u32 v5, 9536, v5
  v_lshlrev_b32 v7, 3, v1
  v_add_u32 v7, 9536, v7
  v_and_b32 v14, 7, v1
  v_mul_u32_u24 v14, 1056, v14
  v_lshrrev_b32 v3, 4, v1
  v_lshl_add_u32 v14, v3, 4, v14
  v_bfe_u32 v6, v1, 2, 2
  v_lshl_add_u32 v6, v3, 3, v6
  v_mul_u32_u24 v6, 1056, v6
  v_and_b32 v8, 3, v1
  v_lshl_add_u32 v6, v8, 3, v6
  s_lshl_b32 s49, s5, 8
  s_add_u32 s49, s49, 77824
  v_add_u32 v6, s49, v6
  v_lshlrev_b32 v10, 3, v0
  v_add_u32 v10, 10048, v10
  v_mov_b32 v8, 0
  v_mov_b32 v9, 0
  ds_write_b64 v10, v[8:9]
  v_and_b32 v13, 1, v1
  v_lshlrev_b32 v13, 6, v13
  v_lshrrev_b32 v3, 4, v1
  v_lshl_add_u32 v13, v3, 4, v13
  s_lshl_b32 s49, s5, 17
  s_add_u32 s49, s49, s58
  v_add_u32 v13, s49, v13
  v_bfe_u32 v3, v1, 1, 3
  v_lshl_add_u32 v13, v3, 14, v13
  v_lshrrev_b32 v2, 3, v1
  v_lshlrev_b32 v2, 6, v2
  v_bfe_u32 v3, v1, 2, 1
  v_lshl_add_u32 v2, v3, 14, v2
  v_and_b32 v8, 2, v1
  v_or_b32 v3, v3, v8
  v_xor_b32 v3, s5, v3
  v_lshl_add_u32 v2, v3, 4, v2
  v_lshl_add_u32 v2, v8, 14, v2
  v_and_b32 v3, 1, v1
  v_lshl_add_u32 v2, v3, 3, v2
  v_add_u32 v2, 77824, v2
  s_waitcnt vmcnt(0)
  s_add_u32 s77, s77, 4
  v_mov_b32 v9, 1
  s_mov_b64 exec, 1
  ds_add_u32 v38, v9 offset:316
  s_mov_b64 exec, -1
  s_mov_b32 s70, 0
L_hy_66:
  ds_read_b32 v9, v38 offset:316
  s_waitcnt lgkmcnt(0)
  v_cmp_gt_u32 vcc, s77, v9
  s_cmp_eq_u64 vcc, 0
  s_cbranch_scc1 L_hyd_67
  s_sleep 4
  s_add_u32 s70, s70, 1
  s_cmp_lt_u32 s70, 2097152
  s_cbranch_scc1 L_hy_66
L_hyd_67:
  ds_read_b64_tr_b16 v[40:41], v2 offset:0
  ds_read_b64_tr_b16 v[42:43], v2 offset:512
  ds_read_b64_tr_b16 v[44:45], v2 offset:1024
  ds_read_b64_tr_b16 v[46:47], v2 offset:1536
  ds_read_b64_tr_b16 v[48:49], v2 offset:2048
  ds_read_b64_tr_b16 v[50:51], v2 offset:2560
  ds_read_b64_tr_b16 v[52:53], v2 offset:3072
  ds_read_b64_tr_b16 v[54:55], v2 offset:3584
  ds_read_b64_tr_b16 v[56:57], v2 offset:4096
  ds_read_b64_tr_b16 v[58:59], v2 offset:4608
  ds_read_b64_tr_b16 v[60:61], v2 offset:5120
  ds_read_b64_tr_b16 v[62:63], v2 offset:5632
  s_waitcnt lgkmcnt(10)
  ds_read_b64_tr_b16 v[64:65], v2 offset:6144
  ds_read_b64_tr_b16 v[66:67], v2 offset:6656
  s_waitcnt lgkmcnt(10)
  ds_read_b64_tr_b16 v[68:69], v2 offset:7168
  ds_read_b64_tr_b16 v[70:71], v2 offset:7680
  s_waitcnt lgkmcnt(10)
  ds_read_b64_tr_b16 v[72:73], v2 offset:8192
  ds_read_b64_tr_b16 v[74:75], v2 offset:8704
  s_waitcnt lgkmcnt(10)
  ds_read_b64_tr_b16 v[76:77], v2 offset:9216
  ds_read_b64_tr_b16 v[78:79], v2 offset:9728
  s_waitcnt lgkmcnt(10)
  ds_read_b64_tr_b16 v[80:81], v2 offset:10240
  ds_read_b64_tr_b16 v[82:83], v2 offset:10752
  s_waitcnt lgkmcnt(10)
  ds_read_b64_tr_b16 v[84:85], v2 offset:11264
  ds_read_b64_tr_b16 v[86:87], v2 offset:11776
  s_waitcnt lgkmcnt(10)
  ds_read_b64_tr_b16 v[88:89], v2 offset:12288
  ds_read_b64_tr_b16 v[90:91], v2 offset:12800
  s_waitcnt lgkmcnt(10)
  ds_read_b64_tr_b16 v[92:93], v2 offset:13312
  ds_read_b64_tr_b16 v[94:95], v2 offset:13824
  s_waitcnt lgkmcnt(10)
  ds_read_b64_tr_b16 v[96:97], v2 offset:14336
  ds_read_b64_tr_b16 v[98:99], v2 offset:14848
  s_waitcnt lgkmcnt(10)
  ds_read_b64_tr_b16 v[100:101], v2 offset:15360
  ds_read_b64_tr_b16 v[102:103], v2 offset:15872
  s_waitcnt lgkmcnt(10)
  s_waitcnt lgkmcnt(0)
  s_add_u32 s77, s77, 4
  v_mov_b32 v9, 1
  s_mov_b64 exec, 1
  ds_add_u32 v38, v9 offset:316
  s_mov_b64 exec, -1
  s_mov_b32 s70, 0
L_hy_68:
  ds_read_b32 v9, v38 offset:316
  s_waitcnt lgkmcnt(0)
  v_cmp_gt_u32 vcc, s77, v9
  s_cmp_eq_u64 vcc, 0
  s_cbranch_scc1 L_hyd_69
  s_add_u32 s70, s70, 1
  s_cmp_lt_u32 s70, 2097152
  s_cbranch_scc1 L_hy_68
L_hyd_69:
  s_mov_b32 s44, s32
  s_mov_b32 s45, s33
  s_mov_b32 s46, 1409024
  s_mov_b32 s47, 0x20000
  v_lshlrev_b32 v2, 4, v1
  s_lshl2_add_u32 s49, s61, s5
  s_lshl_b32 s49, s49, 13
  s_mul_i32 s50, s5, 8448
  s_add_u32 s50, s50, 77824
  s_add_u32 s51, s50, 8448
L_dma_70:
  s_mov_b32 m0, s50
  s_add_u32 s50, s50, 1056
  buffer_load_dwordx4 v2, s[44:47], s49 offen nt lds
  s_add_u32 s49, s49, 1024
  s_waitcnt vmcnt(3)
  s_cmp_lt_u32 s50, s51
  s_cbranch_scc1 L_dma_70
L_dmae_71:
  s_bfe_u32 s32, s74, 0x80000
  s_bfe_u32 s33, s74, 0x80008
  s_bfe_u32 s34, s74, 0x80010
  s_bfe_u32 s35, s74, 0x80018
  v_add_u32 v4, 16384, v15
  v_add_u32 v0, 32768, v15
  v_add_u32 v36, 49152, v15
  global_load_dwordx2 v[8:9], v37, s[16:17]
  s_mov_b32 s70, 0
L_pg_72:
  global_load_dwordx4 v[136:139], v39, s[42:43] offset:-4096 sc1
  global_load_dwordx4 v[140:143], v39, s[42:43] offset:0 sc1
  v_add_u32 v3, 4096, v39
  global_load_dwordx4 v[144:147], v3, s[42:43] sc1
  s_waitcnt vmcnt(0)
  s_mov_b64 vcc, 0
  v_cmp_ne_u32 s[68:69], s74, v137
  s_or_b64 vcc, vcc, s[68:69]
  v_cmp_ne_u32 s[68:69], s74, v139
  s_or_b64 vcc, vcc, s[68:69]
  v_cmp_ne_u32 s[68:69], s74, v141
  s_or_b64 vcc, vcc, s[68:69]
  v_cmp_ne_u32 s[68:69], s74, v143
  s_or_b64 vcc, vcc, s[68:69]
  v_cmp_ne_u32 s[68:69], s74, v145
  s_or_b64 vcc, vcc, s[68:69]
  v_cmp_ne_u32 s[68:69], s74, v147
  s_or_b64 vcc, vcc, s[68:69]
  s_cmp_eq_u64 vcc, 0
  s_cbranch_scc1 L_pge_73
  s_sleep 8
  s_add_u32 s70, s70, 1
  s_cmp_lt_u32 s70, 262144
  s_cbranch_scc1 L_pg_72
L_pge_73:
  v_and_b32 v39, 1, v1
  v_lshlrev_b32 v39, 6, v39
  v_add_u32 v39, 10944, v39
  v_lshrrev_b32 v3, 4, v1
  v_lshl_add_u32 v37, v3, 4, v39
  v_bfe_u32 v3, v1, 1, 3
  v_lshlrev_b32 v3, 7, v3
  v_sub_u32 v37, v37, v3
  v_bfe_u32 v3, v1, 4, 1
  v_lshl_add_u32 v39, v3, 3, v39
  v_lshrrev_b32 v3, 5, v1
  v_lshl_add_u32 v39, v3, 2, v39
  s_lshl_b32 s49, s5, 4
  v_add_u32 v39, s49, v39
  v_lshlrev_b32 v16, 16, v8
  v_and_b32 v17, s73, v8
  v_lshlrev_b32 v18, 16, v9
  v_and_b32 v19, s73, v9
  v_lshlrev_b32 v20, 16, v136
  v_and_b32 v21, s73, v136
  v_lshlrev_b32 v22, 16, v138
  v_and_b32 v23, s73, v138
  v_lshlrev_b32 v28, 16, v144
  v_and_b32 v29, s73, v144
  v_lshlrev_b32 v30, 16, v146
  v_and_b32 v31, s73, v146
  v_add_f32 v28, 1.0, v28
  v_add_f32 v29, 1.0, v29
  v_add_f32 v30, 1.0, v30
  v_add_f32 v31, 1.0, v31
  v_cvt_pk_bf16_f32 v8, v28, v29
  v_cvt_pk_bf16_f32 v9, v30, v31
  v_mov_b32 v141, v142
  ds_write_b64 v12, v[8:9] offset:5312
  ds_write_b64 v12, v[140:141] offset:7424
  v_cvt_pk_bf16_f32 v28, 0, v28
  v_cvt_pk_bf16_f32 v29, 0, v29
  v_cvt_pk_bf16_f32 v30, 0, v30
  v_cvt_pk_bf16_f32 v31, 0, v31
  v_mul_f32 v24, v20, v28
  v_mul_f32 v25, v21, v29
  v_mul_f32 v26, v22, v30
  v_mul_f32 v27, v23, v31
  v_mul_f32 v28, v16, v28
  v_mul_f32 v29, v17, v29
  v_mul_f32 v30, v18, v30
  v_mul_f32 v31, v19, v31
  s_waitcnt lgkmcnt(0)
  s_waitcnt vmcnt(0)
  s_mov_b32 s70, 0
L_sn_74:
  ds_read_b32 v8, v38 offset:264
  s_waitcnt lgkmcnt(0)
  v_cmp_gt_u32 vcc, 0x8, v8
  s_cmp_eq_u64 vcc, 0
  s_cbranch_scc1 L_snd_75
  s_sleep 2
  s_add_u32 s70, s70, 1
  s_cmp_lt_u32 s70, 2097152
  s_cbranch_scc1 L_sn_74
L_snd_75:
  s_mov_b32 s70, 0
  s_mov_b32 s71, 15
  s_bitcmp1_b32 s71, 0
  s_cbranch_scc0 L_fl_76
  global_load_dwordx4 v[104:107], v15, s[42:43] offset:-4096 sc1
  global_load_dwordx4 v[108:111], v15, s[42:43] offset:0 sc1
L_fl_76:
  s_bitcmp1_b32 s71, 1
  s_cbranch_scc0 L_fl_77
  global_load_dwordx4 v[112:115], v4, s[42:43] offset:-4096 sc1
  global_load_dwordx4 v[116:119], v4, s[42:43] offset:0 sc1
L_fl_77:
  s_bitcmp1_b32 s71, 2
  s_cbranch_scc0 L_fl_78
  global_load_dwordx4 v[120:123], v0, s[42:43] offset:-4096 sc1
  global_load_dwordx4 v[124:127], v0, s[42:43] offset:0 sc1
L_fl_78:
  s_bitcmp1_b32 s71, 3
  s_cbranch_scc0 L_fl_79
  global_load_dwordx4 v[128:131], v36, s[42:43] offset:-4096 sc1
  global_load_dwordx4 v[132:135], v36, s[42:43] offset:0 sc1
L_fl_79:
  s_waitcnt vmcnt(0)
  s_branch L_f1_c
L_f1_p:
  s_add_u32 s70, s70, 1
  s_cmp_ge_u32 s70, 262144
  s_cbranch_scc1 L_f1_ok
  s_bitcmp1_b32 s71, 0
  s_cbranch_scc0 L_fl_80
  global_load_dwordx4 v[104:107], v15, s[42:43] offset:-4096 sc1
  global_load_dwordx4 v[108:111], v15, s[42:43] offset:0 sc1
L_fl_80:
  s_bitcmp1_b32 s71, 1
  s_cbranch_scc0 L_fl_81
  global_load_dwordx4 v[112:115], v4, s[42:43] offset:-4096 sc1
  global_load_dwordx4 v[116:119], v4, s[42:43] offset:0 sc1
L_fl_81:
  s_bitcmp1_b32 s71, 2
  s_cbranch_scc0 L_fl_82
  global_load_dwordx4 v[120:123], v0, s[42:43] offset:-4096 sc1
  global_load_dwordx4 v[124:127], v0, s[42:43] offset:0 sc1
L_fl_82:
  s_bitcmp1_b32 s71, 3
  s_cbranch_scc0 L_fl_83
  global_load_dwordx4 v[128:131], v36, s[42:43] offset:-4096 sc1
  global_load_dwordx4 v[132:135], v36, s[42:43] offset:0 sc1
L_fl_83:
  s_waitcnt vmcnt(0)
L_f1_c:
  s_bitcmp1_b32 s71, 0
  s_cbranch_scc0 L_fc_84
  v_xor_b32 v136, s32, v104
  v_xor_b32 v137, s33, v105
  v_xor_b32 v138, s34, v106
  v_xor_b32 v139, s35, v107
  v_xor_b32 v140, s32, v108
  v_xor_b32 v141, s33, v109
  v_xor_b32 v142, s34, v110
  v_xor_b32 v143, s35, v111
  v_or3_b32 v8, v136, v137, v138
  v_or3_b32 v9, v139, v140, v141
  v_or3_b32 v8, v8, v142, v143
  v_pk_add_f32 v[136:137], v[136:137], v[140:141]
  v_pk_add_f32 v[138:139], v[138:139], v[142:143]
  v_or_b32 v8, v8, v9
  v_cmp_ne_u32_sdwa vcc, v8, v38 src0_sel:BYTE_0 src1_sel:DWORD
  s_cmp_lg_u64 vcc, 0
  s_cbranch_scc1 L_fc_84
  s_bitset0_b32 s71, 0
L_fc_84:
  s_bitcmp1_b32 s71, 1
  s_cbranch_scc0 L_fc_85
  v_xor_b32 v144, s32, v112
  v_xor_b32 v145, s33, v113
  v_xor_b32 v146, s34, v114
  v_xor_b32 v147, s35, v115
  v_xor_b32 v148, s32, v116
  v_xor_b32 v149, s33, v117
  v_xor_b32 v150, s34, v118
  v_xor_b32 v151, s35, v119
  v_or3_b32 v8, v144, v145, v146
  v_or3_b32 v9, v147, v148, v149
  v_or3_b32 v8, v8, v150, v151
  v_pk_add_f32 v[144:145], v[144:145], v[148:149]
  v_pk_add_f32 v[146:147], v[146:147], v[150:151]
  v_or_b32 v8, v8, v9
  v_cmp_ne_u32_sdwa vcc, v8, v38 src0_sel:BYTE_0 src1_sel:DWORD
  s_cmp_lg_u64 vcc, 0
  s_cbranch_scc1 L_fc_85
  s_bitset0_b32 s71, 1
L_fc_85:
  s_bitcmp1_b32 s71, 2
  s_cbranch_scc0 L_fc_86
  v_xor_b32 v152, s32, v120
  v_xor_b32 v153, s33, v121
  v_xor_b32 v154, s34, v122
  v_xor_b32 v155, s35, v123
  v_xor_b32 v156, s32, v124
  v_xor_b32 v157, s33, v125
  v_xor_b32 v158, s34, v126
  v_xor_b32 v159, s35, v127
  v_or3_b32 v8, v152, v153, v154
  v_or3_b32 v9, v155, v156, v157
  v_or3_b32 v8, v8, v158, v159
  v_pk_add_f32 v[152:153], v[152:153], v[156:157]
  v_pk_add_f32 v[154:155], v[154:155], v[158:159]
  v_or_b32 v8, v8, v9
  v_cmp_ne_u32_sdwa vcc, v8, v38 src0_sel:BYTE_0 src1_sel:DWORD
  s_cmp_lg_u64 vcc, 0
  s_cbranch_scc1 L_fc_86
  s_bitset0_b32 s71, 2
L_fc_86:
  s_bitcmp1_b32 s71, 3
  s_cbranch_scc0 L_fc_87
  v_xor_b32 v160, s32, v128
  v_xor_b32 v161, s33, v129
  v_xor_b32 v162, s34, v130
  v_xor_b32 v163, s35, v131
  v_xor_b32 v164, s32, v132
  v_xor_b32 v165, s33, v133
  v_xor_b32 v166, s34, v134
  v_xor_b32 v167, s35, v135
  v_or3_b32 v8, v160, v161, v162
  v_or3_b32 v9, v163, v164, v165
  v_or3_b32 v8, v8, v166, v167
  v_pk_add_f32 v[160:161], v[160:161], v[164:165]
  v_pk_add_f32 v[162:163], v[162:163], v[166:167]
  v_or_b32 v8, v8, v9
  v_cmp_ne_u32_sdwa vcc, v8, v38 src0_sel:BYTE_0 src1_sel:DWORD
  s_cmp_lg_u64 vcc, 0
  s_cbranch_scc1 L_fc_87
  s_bitset0_b32 s71, 3
L_fc_87:
  s_cmp_lg_u32 s71, 0
  s_cbranch_scc1 L_f1_p
L_f1_ok:
  v_pk_add_f32 v[136:137], v[136:137], v[144:145]
  v_pk_add_f32 v[138:139], v[138:139], v[146:147]
  v_pk_add_f32 v[152:153], v[152:153], v[160:161]
  v_pk_add_f32 v[154:155], v[154:155], v[162:163]
  v_pk_add_f32 v[136:137], v[136:137], v[152:153]
  v_pk_add_f32 v[138:139], v[138:139], v[154:155]
  v_pk_fma_f32 v[8:9], v[136:137], v[24:25], v[28:29]
  v_pk_fma_f32 v[10:11], v[138:139], v[26:27], v[30:31]
  v_cvt_pk_bf16_f32 v8, v8, v9
  v_cvt_pk_bf16_f32 v9, v10, v11
  ds_write_b64 v12, v[8:9] offset:3200
  v_pk_fma_f32 v[16:17], v[136:137], v[20:21], v[16:17]
  v_pk_fma_f32 v[18:19], v[138:139], v[22:23], v[18:19]
  v_add_f32 v24, v16, v17
  v_mul_f32 v25, v16, v16
  v_add_f32 v26, v18, v19
  v_mul_f32 v27, v18, v18
  v_fmac_f32 v25, v17, v17
  v_fmac_f32 v27, v19, v19
  v_pk_add_f32 v[24:25], v[24:25], v[26:27]
  s_nop 1
  v_add_f32_dpp v24, v24, v24 quad_perm:[1,0,3,2] row_mask:0xf bank_mask:0xf
  v_add_f32_dpp v25, v25, v25 quad_perm:[1,0,3,2] row_mask:0xf bank_mask:0xf
  s_nop 0
  v_add_f32_dpp v24, v24, v24 quad_perm:[2,3,0,1] row_mask:0xf bank_mask:0xf
  v_add_f32_dpp v25, v25, v25 quad_perm:[2,3,0,1] row_mask:0xf bank_mask:0xf
  ds_write_b64 v5, v[24:25]
  s_add_u32 s77, s77, 4
  v_mov_b32 v10, 1
  s_mov_b64 exec, 1
  ds_add_u32 v38, v10 offset:316
  s_mov_b64 exec, -1
  s_mov_b32 s70, 0
L_hy_88:
  ds_read_b32 v10, v38 offset:316
  ds_read_b128 v[136:139], v14 offset:3200
  ds_read_b128 v[140:143], v14 offset:3264
  ds_read_b128 v[144:147], v14 offset:3328
  ds_read_b128 v[148:151], v14 offset:3392
  s_waitcnt lgkmcnt(4)
  v_cmp_gt_u32 vcc, s77, v10
  s_cmp_eq_u64 vcc, 0
  s_cbranch_scc1 L_hyd_89
  s_waitcnt lgkmcnt(0)
  s_add_u32 s70, s70, 1
  s_cmp_lt_u32 s70, 2097152
  s_cbranch_scc1 L_hy_88
L_hyd_89:
  ds_read_b64 v[20:21], v7
  ds_read_b128 v[152:155], v14 offset:3456
  ds_read_b128 v[156:159], v14 offset:3520
  ds_read_b128 v[160:163], v14 offset:3584
  ds_read_b128 v[164:167], v14 offset:3648
  s_waitcnt lgkmcnt(8)
  v_mfma_f32_16x16x32_bf16 v[32:35], v[40:43], v[136:139], 0
  s_waitcnt lgkmcnt(7)
  v_mfma_f32_16x16x32_bf16 v[32:35], v[44:47], v[140:143], v[32:35]
  ds_read_b128 v[136:139], v14 offset:3712
  s_waitcnt lgkmcnt(7)
  v_mfma_f32_16x16x32_bf16 v[32:35], v[48:51], v[144:147], v[32:35]
  ds_read_b128 v[140:143], v14 offset:3776
  s_waitcnt lgkmcnt(7)
  v_mfma_f32_16x16x32_bf16 v[32:35], v[52:55], v[148:151], v[32:35]
  ds_read_b128 v[144:147], v14 offset:3840
  s_waitcnt lgkmcnt(6)
  v_mfma_f32_16x16x32_bf16 v[32:35], v[56:59], v[152:155], v[32:35]
  ds_read_b128 v[148:151], v14 offset:3904
  v_add_f32_dpp v20, v20, v20 quad_perm:[2,3,0,1] row_mask:0xf bank_mask:0xf
  v_add_f32_dpp v21, v21, v21 quad_perm:[2,3,0,1] row_mask:0xf bank_mask:0xf
  s_waitcnt lgkmcnt(6)
  v_mfma_f32_16x16x32_bf16 v[32:35], v[60:63], v[156:159], v[32:35]
  ds_read_b128 v[152:155], v14 offset:3968
  v_add_f32_dpp v20, v20, v20 row_ror:4 row_mask:0xf bank_mask:0xf
  v_add_f32_dpp v21, v21, v21 row_ror:4 row_mask:0xf bank_mask:0xf
  s_waitcnt lgkmcnt(6)
  v_mfma_f32_16x16x32_bf16 v[32:35], v[64:67], v[160:163], v[32:35]
  ds_read_b128 v[156:159], v14 offset:4032
  v_add_f32_dpp v20, v20, v20 row_ror:8 row_mask:0xf bank_mask:0xf
  v_add_f32_dpp v21, v21, v21 row_ror:8 row_mask:0xf bank_mask:0xf
  s_waitcnt lgkmcnt(6)
  v_mfma_f32_16x16x32_bf16 v[32:35], v[68:71], v[164:167], v[32:35]
  ds_read_b128 v[160:163], v14 offset:4096
  v_mov_b32 v22, v20
  v_mov_b32 v23, v21
  s_waitcnt lgkmcnt(6)
  v_mfma_f32_16x16x32_bf16 v[32:35], v[72:75], v[136:139], v[32:35]
  ds_read_b128 v[164:167], v14 offset:4160
  v_permlane16_swap_b32 v22, v20
  v_permlane16_swap_b32 v23, v21
  s_waitcnt lgkmcnt(6)
  v_mfma_f32_16x16x32_bf16 v[32:35], v[76:79], v[140:143], v[32:35]
  v_pk_add_f32 v[20:21], v[20:21], v[22:23]
  v_mov_b32 v22, v20
  v_mov_b32 v23, v21
  s_waitcnt lgkmcnt(5)
  v_mfma_f32_16x16x32_bf16 v[32:35], v[80:83], v[144:147], v[32:35]
  v_permlane32_swap_b32 v22, v20
  v_permlane32_swap_b32 v23, v21
  s_waitcnt lgkmcnt(4)
  v_mfma_f32_16x16x32_bf16 v[32:35], v[84:87], v[148:151], v[32:35]
  v_pk_add_f32 v[20:21], v[20:21], v[22:23]
  v_mul_f32 v20, 0xbb000000, v20
  s_waitcnt lgkmcnt(3)
  v_mfma_f32_16x16x32_bf16 v[32:35], v[88:91], v[152:155], v[32:35]
  v_mul_f32 v21, 0x3b000000, v21
  v_fma_f32 v21, -v20, v20, v21
  s_waitcnt lgkmcnt(2)
  v_mfma_f32_16x16x32_bf16 v[32:35], v[92:95], v[156:159], v[32:35]
  v_max_f32 v21, 0, v21
  v_add_f32 v21, 0x3727c5ac, v21
  s_waitcnt lgkmcnt(1)
  v_mfma_f32_16x16x32_bf16 v[32:35], v[96:99], v[160:163], v[32:35]
  v_rsq_f32 v21, v21
  s_waitcnt lgkmcnt(0)
  v_mfma_f32_16x16x32_bf16 v[32:35], v[100:103], v[164:167], v[32:35]
  ds_read_b64_tr_b16 v[40:41], v6 offset:0
  ds_read_b64_tr_b16 v[42:43], v6 offset:4224
  ds_read_b64_tr_b16 v[44:45], v6 offset:32
  ds_read_b64_tr_b16 v[46:47], v6 offset:4256
  ds_read_b64_tr_b16 v[48:49], v6 offset:64
  ds_read_b64_tr_b16 v[50:51], v6 offset:4288
  ds_read_b64_tr_b16 v[52:53], v6 offset:96
  ds_read_b64_tr_b16 v[54:55], v6 offset:4320
  v_fmac_f32_dpp v32, v32, v20 row_shl:2 row_mask:0xf bank_mask:0x1
  v_fmac_f32_dpp v33, v33, v20 row_shl:2 row_mask:0xf bank_mask:0x1
  v_fmac_f32_dpp v34, v34, v20 row_shl:2 row_mask:0xf bank_mask:0x1
  v_fmac_f32_dpp v35, v35, v20 row_shl:2 row_mask:0xf bank_mask:0x1
  v_mul_f32 v8, v32, v21
  v_mul_f32 v9, v33, v21
  v_mul_f32 v10, v34, v21
  v_mul_f32 v11, v35, v21
  v_add_f32_dpp v8, v32, v8 row_shl:4 row_mask:0xf bank_mask:0xf
  v_add_f32_dpp v9, v33, v9 row_shl:4 row_mask:0xf bank_mask:0xf
  v_add_f32_dpp v10, v34, v10 row_shl:4 row_mask:0xf bank_mask:0xf
  v_add_f32_dpp v11, v35, v11 row_shl:4 row_mask:0xf bank_mask:0xf
  s_waitcnt lgkmcnt(4)
  ds_read_b64_tr_b16 v[56:57], v6 offset:128
  ds_read_b64_tr_b16 v[58:59], v6 offset:4352
  ds_read_b64_tr_b16 v[60:61], v6 offset:160
  ds_read_b64_tr_b16 v[62:63], v6 offset:4384
  ds_read_b64_tr_b16 v[64:65], v6 offset:192
  ds_read_b64_tr_b16 v[66:67], v6 offset:4416
  ds_read_b64_tr_b16 v[68:69], v6 offset:224
  ds_read_b64_tr_b16 v[70:71], v6 offset:4448
  v_permlane32_swap_b32 v8, v10
  v_permlane32_swap_b32 v9, v11
  v_mul_f32 v20, 0xbfb8aa3b, v8
  v_mul_f32 v21, 0xbfb8aa3b, v9
  v_exp_f32 v20, v20
  v_exp_f32 v21, v21
  v_mul_f32 v8, v8, v10
  v_mul_f32 v9, v9, v11
  v_add_f32 v20, 1.0, v20
  v_add_f32 v21, 1.0, v21
  v_rcp_f32 v20, v20
  v_rcp_f32 v21, v21
  s_mov_b32 exec_lo, 0x00030003
  s_mov_b32 exec_hi, 0x00030003
  v_mul_f32 v8, v8, v20
  v_mul_f32 v9, v9, v21
  v_cvt_pk_bf16_f32 v8, v8, v9
  ds_write_b32 v39, v8
  s_mov_b64 exec, -1
  s_waitcnt lgkmcnt(4)
  s_add_u32 s77, s77, 4
  v_mov_b32 v10, 1
  s_mov_b64 exec, 1
  ds_add_u32 v38, v10 offset:316
  s_mov_b64 exec, -1
  s_mov_b32 s70, 0
L_hy_90:
  ds_read_b32 v10, v38 offset:316
  ds_read_b128 v[136:139], v37 offset:0
  ds_read_b128 v[140:143], v37 offset:128
  ds_read_b128 v[144:147], v37 offset:256
  ds_read_b128 v[148:151], v37 offset:384
  s_waitcnt lgkmcnt(4)
  v_cmp_gt_u32 vcc, s77, v10
  s_cmp_eq_u64 vcc, 0
  s_cbranch_scc1 L_hyd_91
  s_waitcnt lgkmcnt(0)
  s_add_u32 s70, s70, 1
  s_cmp_lt_u32 s70, 2097152
  s_cbranch_scc1 L_hy_90
L_hyd_91:
  ds_read_b128 v[152:155], v37 offset:512
  ds_read_b128 v[156:159], v37 offset:640
  ds_read_b128 v[160:163], v37 offset:768
  ds_read_b128 v[164:167], v37 offset:896
  v_mov_b32 v3, 0xff
  s_waitcnt lgkmcnt(7)
  v_mfma_f32_16x16x32_bf16 v[8:11], v[40:43], v[136:139], 0
  s_waitcnt lgkmcnt(6)
  v_mfma_f32_16x16x32_bf16 v[8:11], v[44:47], v[140:143], v[8:11]
  s_waitcnt lgkmcnt(5)
  v_mfma_f32_16x16x32_bf16 v[8:11], v[48:51], v[144:147], v[8:11]
  s_waitcnt lgkmcnt(4)
  v_mfma_f32_16x16x32_bf16 v[8:11], v[52:55], v[148:151], v[8:11]
  s_waitcnt lgkmcnt(3)
  v_mfma_f32_16x16x32_bf16 v[8:11], v[56:59], v[152:155], v[8:11]
  s_waitcnt lgkmcnt(2)
  v_mfma_f32_16x16x32_bf16 v[8:11], v[60:63], v[156:159], v[8:11]
  s_waitcnt lgkmcnt(1)
  v_mfma_f32_16x16x32_bf16 v[8:11], v[64:67], v[160:163], v[8:11]
  s_waitcnt lgkmcnt(0)
  v_mfma_f32_16x16x32_bf16 v[8:11], v[68:71], v[164:167], v[8:11]
  s_nop 7
  v_bfi_b32 v8, v3, s32, v8
  v_bfi_b32 v9, v3, s33, v9
  v_bfi_b32 v10, v3, s34, v10
  v_bfi_b32 v11, v3, s35, v11
  global_store_dwordx4 v13, v[8:11], s[42:43] sc1
  s_branch L_fin
L_r_f2:
  v_bfe_u32 v12, v1, 2, 1
  v_and_b32 v14, 3, v1
  s_lshl_b32 s49, s61, 5
  v_lshl_add_u32 v3, v14, 3, s49
  v_lshl_add_u32 v37, v12, 10, v3
  v_and_b32 v15, 7, v1
  s_lshl_b32 s49, s61, 7
  v_lshl_add_u32 v15, v15, 4, s49
  v_add_u32 v39, 16384, v15
  v_bfe_u32 v3, v1, 3, 1
  v_lshl_add_u32 v15, v3, 12, v15
  v_lshrrev_b32 v3, 4, v1
  v_lshl_add_u32 v15, v3, 14, v15
  v_add_u32 v15, 262144, v15
  s_lshl_b32 s49, s61, 14
  s_add_u32 s49, s49, 1574912
  v_lshl_add_u32 v36, v1, 4, s49
  global_load_dword v11, v37, s[38:39]
  s_lshl_b32 s49, s61, 14
  s_add_u32 s49, s49, 1572864
  v_min_u32 v10, 42, v1
  v_lshl_add_u32 v10, v10, 7, s49
  global_load_dword v11, v10, s[42:43] sc1
  s_lshl_b32 s49, s61, 7
  s_add_u32 s49, s49, 28672
  v_mov_b32 v10, s49
  global_load_dword v11, v10, s[42:43] sc1
  global_load_dwordx2 v[8:9], v37, s[16:17]
  s_mov_b32 s70, 0
L_pg_92:
  global_load_dwordx4 v[136:139], v39, s[42:43] offset:-4096 sc1
  v_add_u32 v3, 8192, v39
  global_load_dwordx4 v[140:143], v3, s[42:43] sc1
  s_waitcnt vmcnt(0)
  s_mov_b64 vcc, 0
  v_cmp_ne_u32 s[68:69], s74, v137
  s_or_b64 vcc, vcc, s[68:69]
  v_cmp_ne_u32 s[68:69], s74, v139
  s_or_b64 vcc, vcc, s[68:69]
  v_cmp_ne_u32 s[68:69], s74, v141
  s_or_b64 vcc, vcc, s[68:69]
  v_cmp_ne_u32 s[68:69], s74, v143
  s_or_b64 vcc, vcc, s[68:69]
  s_cmp_eq_u64 vcc, 0
  s_cbranch_scc1 L_pge_93
  s_sleep 8
  s_add_u32 s70, s70, 1
  s_cmp_lt_u32 s70, 262144
  s_cbranch_scc1 L_pg_92
L_pge_93:
  v_lshlrev_b32 v16, 16, v8
  v_and_b32 v17, s73, v8
  v_lshlrev_b32 v18, 16, v9
  v_and_b32 v19, s73, v9
  v_lshlrev_b32 v20, 16, v136
  v_and_b32 v21, s73, v136
  v_lshlrev_b32 v22, 16, v138
  v_and_b32 v23, s73, v138
  v_lshlrev_b32 v24, 16, v140
  v_and_b32 v25, s73, v140
  v_lshlrev_b32 v26, 16, v142
  v_and_b32 v27, s73, v142
  s_mov_b32 s70, 0
L_sn_94:
  ds_read_b32 v8, v38 offset:264
  s_waitcnt lgkmcnt(0)
  v_cmp_gt_u32 vcc, 0x8, v8
  s_cmp_eq_u64 vcc, 0
  s_cbranch_scc1 L_snd_95
  s_sleep 2
  s_add_u32 s70, s70, 1
  s_cmp_lt_u32 s70, 2097152
  s_cbranch_scc1 L_sn_94
L_snd_95:
  s_mov_b32 s70, 0
L_f2_a:
  global_load_dwordx4 v[136:139], v15, s[42:43] sc1
  s_waitcnt vmcnt(0)
  v_xor_b32 v136, s32, v136
  v_xor_b32 v137, s33, v137
  v_xor_b32 v138, s34, v138
  v_xor_b32 v139, s35, v139
  v_or3_b32 v3, v136, v137, v138
  v_or_b32 v3, v3, v139
  v_lshlrev_b32 v3, 24, v3
  v_cmp_ne_u32 vcc, 0, v3
  s_cmp_eq_u64 vcc, 0
  s_cbranch_scc1 L_f2_ad
  s_sleep 4
  s_add_u32 s70, s70, 1
  s_cmp_lt_u32 s70, 262144
  s_cbranch_scc1 L_f2_a
L_f2_ad:
  s_cmp_lg_u32 s61, 0
  s_cbranch_scc1 L_f2_e
  v_mov_b32 v10, s74
  s_mov_b64 exec, 1
  global_store_dword v38, v10, s[42:43] offset:0 sc1
  s_mov_b64 exec, -1
L_f2_e:
  s_nop 1
  v_add_f32_dpp v136, v136, v136 row_ror:8 row_mask:0xf bank_mask:0xf
  v_add_f32_dpp v137, v137, v137 row_ror:8 row_mask:0xf bank_mask:0xf
  v_add_f32_dpp v138, v138, v138 row_ror:8 row_mask:0xf bank_mask:0xf
  v_add_f32_dpp v139, v139, v139 row_ror:8 row_mask:0xf bank_mask:0xf
  v_mov_b32 v140, v136
  v_mov_b32 v141, v137
  v_mov_b32 v142, v138
  v_mov_b32 v143, v139
  v_permlane16_swap_b32 v140, v136
  v_permlane16_swap_b32 v141, v137
  v_permlane16_swap_b32 v142, v138
  v_permlane16_swap_b32 v143, v139
  v_add_f32 v136, v136, v140
  v_add_f32 v137, v137, v141
  v_add_f32 v138, v138, v142
  v_add_f32 v139, v139, v143
  v_mov_b32 v140, v136
  v_mov_b32 v141, v137
  v_mov_b32 v142, v138
  v_mov_b32 v143, v139
  v_permlane32_swap_b32 v140, v136
  v_permlane32_swap_b32 v141, v137
  v_permlane32_swap_b32 v142, v138
  v_permlane32_swap_b32 v143, v139
  v_add_f32 v136, v136, v140
  v_add_f32 v137, v137, v141
  v_add_f32 v138, v138, v142
  v_add_f32 v139, v139, v143
  v_cvt_pk_bf16_f32 v136, 0, v136
  v_cvt_pk_bf16_f32 v137, 0, v137
  v_cvt_pk_bf16_f32 v138, 0, v138
  v_cvt_pk_bf16_f32 v139, 0, v139
  v_mul_f32 v136, v136, v20
  v_mul_f32 v137, v137, v21
  v_mul_f32 v138, v138, v22
  v_mul_f32 v139, v139, v23
  v_cvt_pk_bf16_f32 v136, 0, v136
  v_cvt_pk_bf16_f32 v137, 0, v137
  v_cvt_pk_bf16_f32 v138, 0, v138
  v_cvt_pk_bf16_f32 v139, 0, v139
  v_add_f32 v16, v16, v136
  v_add_f32 v17, v17, v137
  v_add_f32 v18, v18, v138
  v_add_f32 v19, v19, v139
  v_cvt_pk_bf16_f32 v16, 0, v16
  v_cvt_pk_bf16_f32 v17, 0, v17
  v_cvt_pk_bf16_f32 v18, 0, v18
  v_cvt_pk_bf16_f32 v19, 0, v19
  v_mov_b32 v156, s32
  v_mov_b32 v157, s33
  v_mov_b32 v158, s34
  v_mov_b32 v159, s35
  s_mov_b64 s[20:21], -1
  s_mov_b64 s[22:23], -1
  s_mov_b64 s[24:25], -1
  s_mov_b64 s[26:27], -1
  s_mov_b64 s[28:29], -1
  s_mov_b64 s[30:31], 0xffffff
  s_mov_b64 exec, s[20:21]
  global_load_dwordx4 v[136:139], v36, s[42:43] offset:-2048 sc1
  s_mov_b64 exec, s[22:23]
  global_load_dwordx4 v[140:143], v36, s[42:43] offset:-1024 sc1
  s_mov_b64 exec, s[24:25]
  global_load_dwordx4 v[144:147], v36, s[42:43] offset:0 sc1
  s_mov_b64 exec, s[26:27]
  global_load_dwordx4 v[148:151], v36, s[42:43] offset:1024 sc1
  s_mov_b64 exec, s[28:29]
  global_load_dwordx4 v[152:155], v36, s[42:43] offset:2048 sc1
  s_mov_b64 exec, s[30:31]
  global_load_dwordx4 v[156:159], v36, s[42:43] offset:3072 sc1
  s_mov_b64 exec, -1
  s_waitcnt vmcnt(0)
  s_mov_b32 s70, 0
  s_branch L_f2_pc
L_f2_p:
  s_mov_b64 exec, s[20:21]
  global_load_dwordx4 v[136:139], v36, s[42:43] offset:-2048 sc1
  s_mov_b64 exec, s[22:23]
  global_load_dwordx4 v[140:143], v36, s[42:43] offset:-1024 sc1
  s_mov_b64 exec, s[24:25]
  global_load_dwordx4 v[144:147], v36, s[42:43] offset:0 sc1
  s_mov_b64 exec, s[26:27]
  global_load_dwordx4 v[148:151], v36, s[42:43] offset:1024 sc1
  s_mov_b64 exec, s[28:29]
  global_load_dwordx4 v[152:155], v36, s[42:43] offset:2048 sc1
  s_mov_b64 exec, s[30:31]
  global_load_dwordx4 v[156:159], v36, s[42:43] offset:3072 sc1
  s_mov_b64 exec, -1
  s_sleep 2
  s_waitcnt vmcnt(6)
L_f2_pc:
  v_xor_b32 v104, s32, v136
  v_xor_b32 v105, s33, v137
  v_xor_b32 v106, s34, v138
  v_xor_b32 v107, s35, v139
  v_xor_b32 v108, s32, v140
  v_xor_b32 v109, s33, v141
  v_xor_b32 v110, s34, v142
  v_xor_b32 v111, s35, v143
  v_xor_b32 v112, s32, v144
  v_xor_b32 v113, s33, v145
  v_xor_b32 v114, s34, v146
  v_xor_b32 v115, s35, v147
  v_xor_b32 v116, s32, v148
  v_xor_b32 v117, s33, v149
  v_xor_b32 v118, s34, v150
  v_xor_b32 v119, s35, v151
  v_xor_b32 v120, s32, v152
  v_xor_b32 v121, s33, v153
  v_xor_b32 v122, s34, v154
  v_xor_b32 v123, s35, v155
  v_xor_b32 v124, s32, v156
  v_xor_b32 v125, s33, v157
  v_xor_b32 v126, s34, v158
  v_xor_b32 v127, s35, v159
  v_or3_b32 v28, v104, v105, v106
  v_or3_b32 v29, v108, v109, v110
  v_or3_b32 v30, v112, v113, v114
  v_or3_b32 v31, v116, v117, v118
  v_or3_b32 v32, v120, v121, v122
  v_or3_b32 v33, v124, v125, v126
  v_or_b32 v28, v28, v107
  v_or_b32 v29, v29, v111
  v_or_b32 v30, v30, v115
  v_or_b32 v31, v31, v119
  v_or_b32 v32, v32, v123
  v_or_b32 v33, v33, v127
  v_cmp_ne_u32_sdwa s[20:21], v28, v38 src0_sel:BYTE_0 src1_sel:DWORD
  v_cmp_ne_u32_sdwa s[22:23], v29, v38 src0_sel:BYTE_0 src1_sel:DWORD
  v_cmp_ne_u32_sdwa s[24:25], v30, v38 src0_sel:BYTE_0 src1_sel:DWORD
  v_cmp_ne_u32_sdwa s[26:27], v31, v38 src0_sel:BYTE_0 src1_sel:DWORD
  v_cmp_ne_u32_sdwa s[28:29], v32, v38 src0_sel:BYTE_0 src1_sel:DWORD
  v_cmp_ne_u32_sdwa s[30:31], v33, v38 src0_sel:BYTE_0 src1_sel:DWORD
  v_pk_add_f32 v[104:105], v[104:105], v[108:109]
  v_pk_add_f32 v[106:107], v[106:107], v[110:111]
  v_pk_add_f32 v[112:113], v[112:113], v[116:117]
  v_pk_add_f32 v[114:115], v[114:115], v[118:119]
  v_pk_add_f32 v[120:121], v[120:121], v[124:125]
  v_pk_add_f32 v[122:123], v[122:123], v[126:127]
  v_pk_add_f32 v[104:105], v[104:105], v[112:113]
  v_pk_add_f32 v[106:107], v[106:107], v[114:115]
  v_pk_add_f32 v[104:105], v[104:105], v[120:121]
  v_pk_add_f32 v[106:107], v[106:107], v[122:123]
  s_mov_b64 vcc, s[20:21]
  s_or_b64 vcc, vcc, s[22:23]
  s_or_b64 vcc, vcc, s[24:25]
  s_or_b64 vcc, vcc, s[26:27]
  s_or_b64 vcc, vcc, s[28:29]
  s_or_b64 vcc, vcc, s[30:31]
  s_or_b32 s20, s20, 1
  s_or_b32 s22, s22, 1
  s_or_b32 s24, s24, 1
  s_or_b32 s26, s26, 1
  s_or_b32 s28, s28, 1
  s_or_b32 s30, s30, 1
  s_cmp_eq_u64 vcc, 0
  s_cbranch_scc1 L_f2_pok
  s_add_u32 s70, s70, 1
  s_cmp_lt_u32 s70, 262144
  s_cbranch_scc1 L_f2_p
L_f2_pok:
  s_nop 1
  v_add_f32_dpp v104, v104, v104 row_ror:8 row_mask:0xf bank_mask:0xf
  v_add_f32_dpp v105, v105, v105 row_ror:8 row_mask:0xf bank_mask:0xf
  v_add_f32_dpp v106, v106, v106 row_ror:8 row_mask:0xf bank_mask:0xf
  v_add_f32_dpp v107, v107, v107 row_ror:8 row_mask:0xf bank_mask:0xf
  v_mov_b32 v108, v104
  v_mov_b32 v109, v105
  v_mov_b32 v110, v106
  v_mov_b32 v111, v107
  v_permlane16_swap_b32 v108, v104
  v_permlane16_swap_b32 v109, v105
  v_permlane16_swap_b32 v110, v106
  v_permlane16_swap_b32 v111, v107
  v_add_f32 v104, v104, v108
  v_add_f32 v105, v105, v109
  v_add_f32 v106, v106, v110
  v_add_f32 v107, v107, v111
  v_mov_b32 v108, v104
  v_mov_b32 v109, v105
  v_mov_b32 v110, v106
  v_mov_b32 v111, v107
  v_permlane32_swap_b32 v108, v104
  v_permlane32_swap_b32 v109, v105
  v_permlane32_swap_b32 v110, v106
  v_permlane32_swap_b32 v111, v107
  v_add_f32 v104, v104, v108
  v_add_f32 v105, v105, v109
  v_add_f32 v106, v106, v110
  v_add_f32 v107, v107, v111
  v_cvt_pk_bf16_f32 v104, 0, v104
  v_cvt_pk_bf16_f32 v105, 0, v105
  v_cvt_pk_bf16_f32 v106, 0, v106
  v_cvt_pk_bf16_f32 v107, 0, v107
  v_mul_f32 v104, v104, v24
  v_mul_f32 v105, v105, v25
  v_mul_f32 v106, v106, v26
  v_mul_f32 v107, v107, v27
  v_cvt_pk_bf16_f32 v104, 0, v104
  v_cvt_pk_bf16_f32 v105, 0, v105
  v_cvt_pk_bf16_f32 v106, 0, v106
  v_cvt_pk_bf16_f32 v107, 0, v107
  v_add_f32 v8, v104, v16
  v_add_f32 v9, v105, v17
  v_add_f32 v10, v106, v18
  v_add_f32 v11, v107, v19
  v_cvt_pk_bf16_f32 v8, v8, v9
  v_cvt_pk_bf16_f32 v9, v10, v11
  s_mov_b64 exec, 0xff
  global_store_dwordx2 v37, v[8:9], s[38:39] sc1
  s_mov_b64 exec, 1
  v_mov_b32 v10, s74
  s_lshl_b32 s49, s61, 7
  s_add_u32 s49, s49, 28672
  v_mov_b32 v11, s49
  global_store_dword v11, v10, s[42:43] sc1
L_fin:
L_end:
  s_endpgm
.p2align 7
L_table:
  .long 0xff00ff13, 0x1504ff14, 0xff08ff1b, 0x1d0cff1c, 0xff10ff23, 0xff14ff24, 0xff18ff2b, 0x2d1cff2c
  .long 0xff01ff10, 0x1705ff16, 0xff09ff18, 0x1f0dff1e, 0xff11ff20, 0xff15ff25, 0xff19ff28, 0x2f1dff2e
  .long 0x1202ff11, 0xff0605ff, 0x1a0aff19, 0xff0e10ff, 0x2212ff21, 0x2716ff26, 0x2a1aff29, 0xff1e25ff
  .long 0xffff00ff, 0xffff06ff, 0xffff0bff, 0xffff11ff, 0xffff16ff, 0xffff1bff, 0xffff20ff, 0xffff26ff
  .long 0xffff01ff, 0xffff07ff, 0xffff0cff, 0xffff12ff, 0xffff17ff, 0xffff1cff, 0xffff21ff, 0xffff27ff
  .long 0xffff02ff, 0xffff08ff, 0xffff0dff, 0xffff13ff, 0xffff18ff, 0xffff1dff, 0xffff22ff, 0xffff28ff
  .long 0xffff03ff, 0xffff09ff, 0xffff0eff, 0xffff14ff, 0xffff19ff, 0xffff1eff, 0xffff23ff, 0xffff29ff
  .long 0xff0304ff, 0xff070aff, 0xff0b0fff, 0xff0f15ff, 0xff131aff, 0xff171fff, 0xff1b24ff, 0xff1f2aff
L_touch:
  .long 0x80804101, 0x80804909, 0x80804303, 0x80808080, 0x80804b0b, 0x80804505, 0x80804d0d, 0x80808080
  .long 0x80804707, 0x80804f0f, 0x80805900, 0x80808080, 0x80805b08, 0x80805d02, 0x80805f0a, 0x80808080
  .long 0x80805804, 0x80805a0c, 0x80805c06, 0x80808080, 0x80805e0e, 0x80805140, 0x80806148, 0x80808080
  .long 0x80806942, 0x8080714a, 0x80807944, 0x80808080, 0x8080534c, 0x80806346, 0x80806b4e, 0x80808080
.section .rodata,"a"
.p2align 6
.amdhsa_kernel adaLN_cond__sliding_block_cached__glu_gated_swiglu__decode_kernel
  .amdhsa_next_free_vgpr 168
  .amdhsa_next_free_sgpr 102
  .amdhsa_accum_offset 168
  .amdhsa_group_segment_fixed_size 0
  .amdhsa_kernarg_size 112
  .amdhsa_user_sgpr_count 2
  .amdhsa_user_sgpr_kernarg_segment_ptr 1
  .amdhsa_system_sgpr_workgroup_id_x 1
.end_amdhsa_kernel
```

```asm
; @launch grid=(256,1,1) block=(768,1,1) lds=143360
.amdgcn_target "amdgcn-amd-amdhsa--gfx950"
.text
.globl adaLN_cond__sliding_block_cached__glu_gated_swiglu__decode_kernel
.p2align 8
.type adaLN_cond__sliding_block_cached__glu_gated_swiglu__decode_kernel,@function
adaLN_cond__sliding_block_cached__glu_gated_swiglu__decode_kernel:
  s_cmp_ge_u32 s2, 256
  s_cbranch_scc1 L_end
  s_load_dwordx16 s[16:31], s[0:1], 0
  s_load_dwordx8 s[32:39], s[0:1], 64
  s_load_dwordx4 s[40:43], s[0:1], 96
  v_lshrrev_b32 v2, 6, v0
  v_and_b32 v1, 63, v0
  v_readfirstlane_b32 s13, v2
  s_bfe_u32 s7, s2, 0x20003
  s_bfe_u32 s6, s2, 0x20005
  s_and_b32 s8, s2, 7
  s_lshl2_add_u32 s6, s8, s6
  s_and_b32 s9, s2, 0x80
  s_lshr_b32 s9, s9, 2
  s_add_u32 s6, s6, s9
  s_mov_b32 s72, 0xfffffffe
  s_mov_b32 s73, 0xffff0000
  s_cmp_eq_u32 s7, 3
  s_cbranch_scc1 L_serv
  s_cmp_eq_u32 s13, 0
  s_cbranch_scc1 L_pub
L_stream:
  s_sub_u32 s9, s13, 1
  s_mul_i32 s10, s7, 3
  s_add_u32 s10, s10, s9
  s_sub_u32 s10, s10, 8
  s_cmp_ge_i32 s10, 8
  s_cbranch_scc1 L_end
  s_cmp_lt_u32 s9, 8
  s_cselect_b32 s11, s9, s10
  s_cselect_b32 s4, s7, 3
  s_lshl_b32 s11, s11, 10
  s_lshl_b32 s4, s4, 18
  s_lshl_b32 s10, s6, 22
  s_add_u32 s10, s10, s4
  s_add_u32 s10, s10, 0x300000
  v_lshl_add_u32 v0, v1, 4, s11
  s_lshr_b32 s12, s2, 3
  s_mul_i32 s12, s12, 5
  s_mul_i32 s15, s8, 3
  s_add_u32 s12, s12, s15
  s_lshl_b32 s12, s12, 13
  s_and_b32 s12, s12, 0x3ffff
  s_waitcnt lgkmcnt(0)
  s_add_u32 s44, s18, s10
  s_addc_u32 s45, s19, 0
  s_mov_b32 s46, 0x40000
  s_mov_b32 s47, 0x20000
  buffer_load_dwordx4 v[40:43], v0, s[44:47], s12 offen nt
  s_add_u32 s12, s12, 0x2000
  s_and_b32 s12, s12, 0x3ffff
  buffer_load_dwordx4 v[44:47], v0, s[44:47], s12 offen nt
  s_add_u32 s12, s12, 0x2000
  s_and_b32 s12, s12, 0x3ffff
  buffer_load_dwordx4 v[48:51], v0, s[44:47], s12 offen nt
  s_add_u32 s12, s12, 0x2000
  s_and_b32 s12, s12, 0x3ffff
  s_load_dword s74, s[42:43], 0
  s_add_u32 s48, s20, s10
  s_addc_u32 s49, s21, 0
  s_mov_b32 s50, 0x40000
  s_mov_b32 s51, 0x20000
  s_mov_b32 s52, 0xcccccccc
  s_mov_b32 s53, 0xcccccccc
  s_mov_b32 s54, 0xaaaaaaaa
  s_mov_b32 s55, 0xaaaaaaaa
  v_and_b32 v38, 15, v1
  v_lshlrev_b32 v38, 4, v38
  s_lshl_b32 s10, s9, 11
  s_add_u32 s10, s10, 12288
  v_lshl_add_u32 v3, v1, 3, s10
  v_mov_b32 v4, 0x7fff0000
  v_mov_b32 v5, 0xff800000
  ds_write_b64 v3, v[4:5] offset:0
  ds_write_b64 v3, v[4:5] offset:512
  ds_write_b64 v3, v[4:5] offset:1024
  v_lshrrev_b32 v3, 4, v1
  v_lshl_add_u32 v39, v38, 1, s10
  v_lshl_add_u32 v39, v3, 3, v39
  s_sub_u32 s68, s12, 24576
  v_bfrev_b32 v24, v1
  v_lshrrev_b32 v24, 15, v24
  v_and_b32 v24, 0x1e000, v24
  v_add_u32 v24, s68, v24
  v_and_b32 v24, 0x3e000, v24
  v_lshl_add_u32 v24, v3, 8, v24
  v_add_u32 v24, s11, v24
  v_xor_b32 v26, 0x20000, v24
  s_lshl_b32 s11, s9, 9
  s_sub_u32 s11, s11, s10
  s_mov_b32 s32, 3
  s_mul_i32 s33, s9, 0x60000000
  s_add_u32 s33, s33, 0x10000000
  s_mov_b64 s[64:65], 0
  s_mov_b64 s[66:67], 0
  s_mov_b32 s38, 0
  s_mov_b32 s39, 0
  s_mov_b32 s75, 0
  s_mov_b32 s61, 0
  s_lshl3_add_u32 s40, s6, s9
  s_lshl_b32 s40, s40, 6
  s_add_u32 s40, s40, 32768
  s_barrier
  s_waitcnt lgkmcnt(0)
  s_mov_b32 s56, s10
  s_mul_i32 s74, s74, 0x9e3779b1
  s_add_u32 s74, s74, 0x7f4a7c15
  s_cmp_eq_u32 s7, 2
  s_cselect_b32 s76, 10, 11
  s_mov_b32 s41, 5
  s_mov_b32 s57, 0
  s_mov_b32 s34, 174899
  s_mov_b32 s77, 0
  s_mov_b32 s35, 29
  s_mov_b32 s59, 0
  s_mul_i32 s68, s76, 29
  s_add_u32 s68, s68, 1024
  v_mov_b32 v22, s68
  v_mov_b32 v23, 0
  v_mov_b32 v2, 0
  s_cmp_ge_u32 s9, 8
  s_cselect_b32 s39, 2, 0
  s_call_b64 s[62:63], L_kq
  buffer_load_dwordx4 v[52:55], v0, s[44:47], s12 offen nt
  s_add_u32 s12, s12, 0x2000
  s_and_b32 s12, s12, 0x3ffff
  s_call_b64 s[62:63], L_kq
  buffer_load_dwordx4 v[56:59], v0, s[44:47], s12 offen nt
  s_add_u32 s12, s12, 0x2000
  s_and_b32 s12, s12, 0x3ffff
  s_call_b64 s[62:63], L_kq
  buffer_load_dwordx4 v[60:63], v0, s[44:47], s12 offen nt
  s_add_u32 s12, s12, 0x2000
  s_and_b32 s12, s12, 0x3ffff
  s_call_b64 s[62:63], L_kq
  buffer_load_dwordx4 v[64:67], v0, s[44:47], s12 offen nt
  s_add_u32 s12, s12, 0x2000
  s_and_b32 s12, s12, 0x3ffff
  s_call_b64 s[62:63], L_kq
  buffer_load_dwordx4 v[68:71], v0, s[44:47], s12 offen nt
  s_add_u32 s12, s12, 0x2000
  s_and_b32 s12, s12, 0x3ffff
  s_call_b64 s[62:63], L_kq
  buffer_load_dwordx4 v[72:75], v0, s[44:47], s12 offen nt
  s_add_u32 s12, s12, 0x2000
  s_and_b32 s12, s12, 0x3ffff
  s_call_b64 s[62:63], L_kq
  buffer_load_dwordx4 v[76:79], v0, s[44:47], s12 offen nt
  s_add_u32 s12, s12, 0x2000
  s_and_b32 s12, s12, 0x3ffff
  s_call_b64 s[62:63], L_kq
  buffer_load_dwordx4 v[80:83], v0, s[44:47], s12 offen nt
  s_add_u32 s12, s12, 0x2000
  s_and_b32 s12, s12, 0x3ffff
  s_call_b64 s[62:63], L_kq
  buffer_load_dwordx4 v[84:87], v0, s[44:47], s12 offen nt
  s_add_u32 s12, s12, 0x2000
  s_and_b32 s12, s12, 0x3ffff
  s_call_b64 s[62:63], L_kq
  buffer_load_dwordx4 v[88:91], v0, s[44:47], s12 offen nt
  s_add_u32 s12, s12, 0x2000
  s_and_b32 s12, s12, 0x3ffff
  s_call_b64 s[62:63], L_ks
  buffer_load_dwordx4 v[92:95], v0, s[44:47], s12 offen nt
  s_add_u32 s12, s12, 0x2000
  s_and_b32 s12, s12, 0x3ffff
  s_call_b64 s[62:63], L_ks
  buffer_load_dwordx4 v[96:99], v0, s[44:47], s12 offen nt
  s_add_u32 s12, s12, 0x2000
  s_and_b32 s12, s12, 0x3ffff
  s_call_b64 s[62:63], L_ks
  buffer_load_dwordx4 v[100:103], v0, s[44:47], s12 offen nt
  s_add_u32 s12, s12, 0x2000
  s_and_b32 s12, s12, 0x3ffff
  s_call_b64 s[62:63], L_ks
  buffer_load_dwordx4 v[104:107], v0, s[44:47], s12 offen nt
  s_add_u32 s12, s12, 0x2000
  s_and_b32 s12, s12, 0x3ffff
  s_call_b64 s[62:63], L_ks
  buffer_load_dwordx4 v[108:111], v0, s[44:47], s12 offen nt
  s_add_u32 s12, s12, 0x2000
  s_and_b32 s12, s12, 0x3ffff
  s_call_b64 s[62:63], L_ks
  buffer_load_dwordx4 v[112:115], v0, s[44:47], s12 offen nt
  s_add_u32 s12, s12, 0x2000
  s_and_b32 s12, s12, 0x3ffff
  s_call_b64 s[62:63], L_ks
  buffer_load_dwordx4 v[116:119], v0, s[44:47], s12 offen nt
  s_add_u32 s12, s12, 0x2000
  s_and_b32 s12, s12, 0x3ffff
  s_call_b64 s[62:63], L_ks
  buffer_load_dwordx4 v[120:123], v0, s[44:47], s12 offen nt
  s_add_u32 s12, s12, 0x2000
  s_and_b32 s12, s12, 0x3ffff
  s_call_b64 s[62:63], L_ks
  buffer_load_dwordx4 v[124:127], v0, s[44:47], s12 offen nt
  s_add_u32 s12, s12, 0x2000
  s_and_b32 s12, s12, 0x3ffff
  s_call_b64 s[62:63], L_ks
  buffer_load_dwordx4 v[128:131], v0, s[44:47], s12 offen nt
  s_add_u32 s12, s12, 0x2000
  s_and_b32 s12, s12, 0x3ffff
  s_call_b64 s[62:63], L_ks
  buffer_load_dwordx4 v[132:135], v0, s[44:47], s12 offen nt
  s_add_u32 s12, s12, 0x2000
  s_and_b32 s12, s12, 0x3ffff
  s_call_b64 s[62:63], L_ks
  buffer_load_dwordx4 v[136:139], v0, s[44:47], s12 offen nt
  s_add_u32 s12, s12, 0x2000
  s_and_b32 s12, s12, 0x3ffff
  s_call_b64 s[62:63], L_ks
  buffer_load_dwordx4 v[140:143], v0, s[44:47], s12 offen nt
  s_add_u32 s12, s12, 0x2000
  s_and_b32 s12, s12, 0x3ffff
  s_call_b64 s[62:63], L_ks
  buffer_load_dwordx4 v[144:147], v0, s[44:47], s12 offen nt
  s_add_u32 s12, s12, 0x2000
  s_and_b32 s12, s12, 0x3ffff
  s_call_b64 s[62:63], L_ks
  buffer_load_dwordx4 v[148:151], v0, s[44:47], s12 offen nt
  s_add_u32 s12, s12, 0x2000
  s_and_b32 s12, s12, 0x3ffff
  s_call_b64 s[62:63], L_ks
  buffer_load_dwordx4 v[152:155], v0, s[44:47], s12 offen nt
  s_add_u32 s12, s12, 0x2000
  s_and_b32 s12, s12, 0x3ffff
  s_call_b64 s[62:63], L_ks
  buffer_load_dwordx4 v[156:159], v0, s[44:47], s12 offen nt
  s_add_u32 s12, s12, 0x2000
  s_and_b32 s12, s12, 0x3ffff
  s_call_b64 s[62:63], L_ks
  buffer_load_dwordx4 v[160:163], v0, s[44:47], s12 offen nt
  s_add_u32 s12, s12, 0x2000
  s_and_b32 s12, s12, 0x3ffff
  s_call_b64 s[62:63], L_ks
  buffer_load_dwordx4 v[164:167], v0, s[44:47], s12 offen nt
  s_add_u32 s12, s12, 0x2000
  s_and_b32 s12, s12, 0x3ffff
  s_mov_b32 s10, 0
L_kw:
  s_cmp_ge_u32 s39, 6
  s_cbranch_scc1 L_v0
  s_call_b64 s[100:101], L_work
  s_sleep 1
  s_add_u32 s10, s10, 1
  s_cmp_lt_u32 s10, 262144
  s_cbranch_scc1 L_kw
L_v0:
  s_mov_b32 s32, 0
  v_mov_b32 v2, 8
  s_mov_b32 s35, s59
  ds_read_b64 v[22:23], v2 offset:288
  s_waitcnt lgkmcnt(0)
  v_and_b32 v3, 1, v1
  v_lshlrev_b32 v3, 4, v3
  v_mov_b32 v20, 0xffff
  v_lshlrev_b32 v3, v3, v20
  v_bfe_u32 v20, v1, 1, 3
  v_cmp_eq_u32 vcc, 0, v20
  s_nop 1
  v_cndmask_b32 v34, 0, v3, vcc
  v_cmp_eq_u32 vcc, 1, v20
  s_nop 1
  v_cndmask_b32 v35, 0, v3, vcc
  v_cmp_eq_u32 vcc, 2, v20
  s_nop 1
  v_cndmask_b32 v36, 0, v3, vcc
  v_cmp_eq_u32 vcc, 3, v20
  s_nop 1
  v_cndmask_b32 v0, 0, v3, vcc
  s_cmp_eq_u32 s7, 2
  s_mov_b32 s77, 61
  s_cselect_b32 s77, 64, s77
  s_mov_b32 s34, 163021
  s_cselect_b32 s34, 162980, s34
  s_call_b64 s[62:63], L_vs
  v_add_u32_dpp v3, v28, v38 row_newbcast:0 row_mask:0xf bank_mask:0xf
  buffer_load_dwordx4 v[40:43], v3, s[48:51], 0 offen nt
  v_dot2_f32_bf16 v8, v136, v4, 0
  v_dot2_f32_bf16 v9, v140, v4, 0
  v_dot2_f32_bf16 v10, v144, v4, 0
  v_dot2_f32_bf16 v11, v148, v4, 0
  v_dot2_f32_bf16 v8, v137, v5, v8
  v_dot2_f32_bf16 v9, v141, v5, v9
  v_dot2_f32_bf16 v10, v145, v5, v10
  v_dot2_f32_bf16 v11, v149, v5, v11
  v_dot2_f32_bf16 v8, v138, v6, v8
  v_dot2_f32_bf16 v9, v142, v6, v9
  v_dot2_f32_bf16 v10, v146, v6, v10
  v_dot2_f32_bf16 v11, v150, v6, v11
  v_dot2_f32_bf16 v8, v139, v7, v8
  v_dot2_f32_bf16 v9, v143, v7, v9
  v_dot2_f32_bf16 v10, v147, v7, v10
  v_dot2_f32_bf16 v11, v151, v7, v11
  v_add_f32_dpp v8, v8, v8 row_ror:8 row_mask:0xf bank_mask:0x3
  v_add_f32_dpp v8, v9, v9 row_ror:8 row_mask:0xf bank_mask:0xc
  v_add_f32_dpp v10, v10, v10 row_ror:8 row_mask:0xf bank_mask:0x3
  v_add_f32_dpp v10, v11, v11 row_ror:8 row_mask:0xf bank_mask:0xc
  s_nop 0
  v_add_f32_dpp v18, v8, v8 row_shl:4 row_mask:0xf bank_mask:0x5
  v_add_f32_dpp v18, v10, v10 row_shr:4 row_mask:0xf bank_mask:0xa
  s_call_b64 s[62:63], L_vs
  s_cbranch_scc0 L_dr5
  v_add_u32_dpp v3, v28, v38 row_newbcast:1 row_mask:0xf bank_mask:0xf
  buffer_load_dwordx4 v[44:47], v3, s[48:51], 0 offen nt
  s_call_b64 s[62:63], L_vs
  s_cbranch_scc0 L_dr5
  v_add_u32_dpp v3, v28, v38 row_newbcast:2 row_mask:0xf bank_mask:0xf
  buffer_load_dwordx4 v[48:51], v3, s[48:51], 0 offen nt
  s_call_b64 s[62:63], L_vs
  s_cbranch_scc0 L_dr5
  v_add_u32_dpp v3, v28, v38 row_newbcast:3 row_mask:0xf bank_mask:0xf
  buffer_load_dwordx4 v[52:55], v3, s[48:51], 0 offen nt
  s_call_b64 s[62:63], L_vs
  s_cbranch_scc0 L_dr5
  v_add_u32_dpp v3, v28, v38 row_newbcast:4 row_mask:0xf bank_mask:0xf
  buffer_load_dwordx4 v[56:59], v3, s[48:51], 0 offen nt
  s_call_b64 s[62:63], L_vs
  s_cbranch_scc0 L_dr5
  v_add_u32_dpp v3, v28, v38 row_newbcast:5 row_mask:0xf bank_mask:0xf
  buffer_load_dwordx4 v[60:63], v3, s[48:51], 0 offen nt
  v_and_b32_dpp v12, v29, v34 row_newbcast:0 row_mask:0xf bank_mask:0xf
  v_and_b32_dpp v13, v29, v35 row_newbcast:0 row_mask:0xf bank_mask:0xf
  v_and_b32_dpp v14, v29, v36 row_newbcast:0 row_mask:0xf bank_mask:0xf
  v_and_b32_dpp v15, v29, v0 row_newbcast:0 row_mask:0xf bank_mask:0xf
  s_nop 1
  v_mfma_f32_16x16x32_bf16 v[8:11], v[12:15], v[40:43], v[8:11]
  s_call_b64 s[62:63], L_vs
  s_cbranch_scc0 L_dr6
  v_add_u32_dpp v3, v28, v38 row_newbcast:6 row_mask:0xf bank_mask:0xf
  buffer_load_dwordx4 v[64:67], v3, s[48:51], 0 offen nt
  v_and_b32_dpp v12, v29, v34 row_newbcast:1 row_mask:0xf bank_mask:0xf
  v_and_b32_dpp v13, v29, v35 row_newbcast:1 row_mask:0xf bank_mask:0xf
  v_and_b32_dpp v14, v29, v36 row_newbcast:1 row_mask:0xf bank_mask:0xf
  v_and_b32_dpp v15, v29, v0 row_newbcast:1 row_mask:0xf bank_mask:0xf
  s_nop 1
  v_mfma_f32_16x16x32_bf16 v[8:11], v[12:15], v[44:47], v[8:11]
  s_call_b64 s[62:63], L_vs
  s_cbranch_scc0 L_dr7
  v_add_u32_dpp v3, v28, v38 row_newbcast:7 row_mask:0xf bank_mask:0xf
  buffer_load_dwordx4 v[68:71], v3, s[48:51], 0 offen nt
  v_and_b32_dpp v12, v29, v34 row_newbcast:2 row_mask:0xf bank_mask:0xf
  v_and_b32_dpp v13, v29, v35 row_newbcast:2 row_mask:0xf bank_mask:0xf
  v_and_b32_dpp v14, v29, v36 row_newbcast:2 row_mask:0xf bank_mask:0xf
  v_and_b32_dpp v15, v29, v0 row_newbcast:2 row_mask:0xf bank_mask:0xf
  s_nop 1
  v_mfma_f32_16x16x32_bf16 v[8:11], v[12:15], v[48:51], v[8:11]
  s_call_b64 s[62:63], L_vs
  s_cbranch_scc0 L_dr8
  v_add_u32_dpp v3, v28, v38 row_newbcast:8 row_mask:0xf bank_mask:0xf
  buffer_load_dwordx4 v[72:75], v3, s[48:51], 0 offen nt
  v_and_b32_dpp v12, v29, v34 row_newbcast:3 row_mask:0xf bank_mask:0xf
  v_and_b32_dpp v13, v29, v35 row_newbcast:3 row_mask:0xf bank_mask:0xf
  v_and_b32_dpp v14, v29, v36 row_newbcast:3 row_mask:0xf bank_mask:0xf
  v_and_b32_dpp v15, v29, v0 row_newbcast:3 row_mask:0xf bank_mask:0xf
  s_nop 1
  v_mfma_f32_16x16x32_bf16 v[8:11], v[12:15], v[52:55], v[8:11]
  s_call_b64 s[62:63], L_vs
  s_cbranch_scc0 L_dr9
  v_add_u32_dpp v3, v28, v38 row_newbcast:9 row_mask:0xf bank_mask:0xf
  buffer_load_dwordx4 v[76:79], v3, s[48:51], 0 offen nt
  v_and_b32_dpp v12, v29, v34 row_newbcast:4 row_mask:0xf bank_mask:0xf
  v_and_b32_dpp v13, v29, v35 row_newbcast:4 row_mask:0xf bank_mask:0xf
  v_and_b32_dpp v14, v29, v36 row_newbcast:4 row_mask:0xf bank_mask:0xf
  v_and_b32_dpp v15, v29, v0 row_newbcast:4 row_mask:0xf bank_mask:0xf
  s_nop 1
  v_mfma_f32_16x16x32_bf16 v[8:11], v[12:15], v[56:59], v[8:11]
  s_call_b64 s[62:63], L_vs
  s_cbranch_scc0 L_dr10
  v_add_u32_dpp v3, v28, v38 row_newbcast:10 row_mask:0xf bank_mask:0xf
  buffer_load_dwordx4 v[80:83], v3, s[48:51], 0 offen nt
  v_and_b32_dpp v12, v29, v34 row_newbcast:5 row_mask:0xf bank_mask:0xf
  v_and_b32_dpp v13, v29, v35 row_newbcast:5 row_mask:0xf bank_mask:0xf
  v_and_b32_dpp v14, v29, v36 row_newbcast:5 row_mask:0xf bank_mask:0xf
  v_and_b32_dpp v15, v29, v0 row_newbcast:5 row_mask:0xf bank_mask:0xf
  s_nop 1
  v_mfma_f32_16x16x32_bf16 v[8:11], v[12:15], v[60:63], v[8:11]
  s_call_b64 s[62:63], L_vq
  s_cbranch_scc0 L_dr11
  v_add_u32_dpp v3, v28, v38 row_newbcast:11 row_mask:0xf bank_mask:0xf
  buffer_load_dwordx4 v[84:87], v3, s[48:51], 0 offen nt
  v_and_b32_dpp v12, v29, v34 row_newbcast:6 row_mask:0xf bank_mask:0xf
  v_and_b32_dpp v13, v29, v35 row_newbcast:6 row_mask:0xf bank_mask:0xf
  v_and_b32_dpp v14, v29, v36 row_newbcast:6 row_mask:0xf bank_mask:0xf
  v_and_b32_dpp v15, v29, v0 row_newbcast:6 row_mask:0xf bank_mask:0xf
  s_nop 1
  v_mfma_f32_16x16x32_bf16 v[8:11], v[12:15], v[64:67], v[8:11]
  s_call_b64 s[62:63], L_vq
  s_cbranch_scc0 L_dr12
  v_add_u32_dpp v3, v28, v38 row_newbcast:12 row_mask:0xf bank_mask:0xf
  buffer_load_dwordx4 v[88:91], v3, s[48:51], 0 offen nt
  v_and_b32_dpp v12, v29, v34 row_newbcast:7 row_mask:0xf bank_mask:0xf
  v_and_b32_dpp v13, v29, v35 row_newbcast:7 row_mask:0xf bank_mask:0xf
  v_and_b32_dpp v14, v29, v36 row_newbcast:7 row_mask:0xf bank_mask:0xf
  v_and_b32_dpp v15, v29, v0 row_newbcast:7 row_mask:0xf bank_mask:0xf
  s_nop 1
  v_mfma_f32_16x16x32_bf16 v[8:11], v[12:15], v[68:71], v[8:11]
  s_call_b64 s[62:63], L_vq
  s_cbranch_scc0 L_dr13
  v_add_u32_dpp v3, v28, v38 row_newbcast:13 row_mask:0xf bank_mask:0xf
  buffer_load_dwordx4 v[92:95], v3, s[48:51], 0 offen nt
  v_and_b32_dpp v12, v29, v34 row_newbcast:8 row_mask:0xf bank_mask:0xf
  v_and_b32_dpp v13, v29, v35 row_newbcast:8 row_mask:0xf bank_mask:0xf
  v_and_b32_dpp v14, v29, v36 row_newbcast:8 row_mask:0xf bank_mask:0xf
  v_and_b32_dpp v15, v29, v0 row_newbcast:8 row_mask:0xf bank_mask:0xf
  s_nop 1
  v_mfma_f32_16x16x32_bf16 v[8:11], v[12:15], v[72:75], v[8:11]
  s_call_b64 s[62:63], L_vq
  s_cbranch_scc0 L_dr14
  v_add_u32_dpp v3, v28, v38 row_newbcast:14 row_mask:0xf bank_mask:0xf
  buffer_load_dwordx4 v[96:99], v3, s[48:51], 0 offen nt
  v_and_b32_dpp v12, v29, v34 row_newbcast:9 row_mask:0xf bank_mask:0xf
  v_and_b32_dpp v13, v29, v35 row_newbcast:9 row_mask:0xf bank_mask:0xf
  v_and_b32_dpp v14, v29, v36 row_newbcast:9 row_mask:0xf bank_mask:0xf
  v_and_b32_dpp v15, v29, v0 row_newbcast:9 row_mask:0xf bank_mask:0xf
  s_nop 1
  v_mfma_f32_16x16x32_bf16 v[8:11], v[12:15], v[76:79], v[8:11]
  s_call_b64 s[62:63], L_vq
  s_cbranch_scc0 L_dr15
  v_add_u32_dpp v3, v28, v38 row_newbcast:15 row_mask:0xf bank_mask:0xf
  buffer_load_dwordx4 v[100:103], v3, s[48:51], 0 offen nt
  v_and_b32_dpp v12, v29, v34 row_newbcast:10 row_mask:0xf bank_mask:0xf
  v_and_b32_dpp v13, v29, v35 row_newbcast:10 row_mask:0xf bank_mask:0xf
  v_and_b32_dpp v14, v29, v36 row_newbcast:10 row_mask:0xf bank_mask:0xf
  v_and_b32_dpp v15, v29, v0 row_newbcast:10 row_mask:0xf bank_mask:0xf
  s_nop 1
  v_mfma_f32_16x16x32_bf16 v[8:11], v[12:15], v[80:83], v[8:11]
  s_call_b64 s[62:63], L_vq
  s_cbranch_scc0 L_dr16
  v_add_u32_dpp v3, v30, v38 row_newbcast:0 row_mask:0xf bank_mask:0xf
  buffer_load_dwordx4 v[104:107], v3, s[48:51], 0 offen nt
  v_and_b32_dpp v12, v29, v34 row_newbcast:11 row_mask:0xf bank_mask:0xf
  v_and_b32_dpp v13, v29, v35 row_newbcast:11 row_mask:0xf bank_mask:0xf
  v_and_b32_dpp v14, v29, v36 row_newbcast:11 row_mask:0xf bank_mask:0xf
  v_and_b32_dpp v15, v29, v0 row_newbcast:11 row_mask:0xf bank_mask:0xf
  s_nop 1
  v_mfma_f32_16x16x32_bf16 v[8:11], v[12:15], v[84:87], v[8:11]
  s_call_b64 s[62:63], L_vq
  s_cbranch_scc0 L_dr17
  v_add_u32_dpp v3, v30, v38 row_newbcast:1 row_mask:0xf bank_mask:0xf
  buffer_load_dwordx4 v[108:111], v3, s[48:51], 0 offen nt
  v_and_b32_dpp v12, v29, v34 row_newbcast:12 row_mask:0xf bank_mask:0xf
  v_and_b32_dpp v13, v29, v35 row_newbcast:12 row_mask:0xf bank_mask:0xf
  v_and_b32_dpp v14, v29, v36 row_newbcast:12 row_mask:0xf bank_mask:0xf
  v_and_b32_dpp v15, v29, v0 row_newbcast:12 row_mask:0xf bank_mask:0xf
  s_nop 1
  v_mfma_f32_16x16x32_bf16 v[8:11], v[12:15], v[88:91], v[8:11]
  s_call_b64 s[62:63], L_vq
  s_cbranch_scc0 L_dr18
  v_add_u32_dpp v3, v30, v38 row_newbcast:2 row_mask:0xf bank_mask:0xf
  buffer_load_dwordx4 v[112:115], v3, s[48:51], 0 offen nt
  v_and_b32_dpp v12, v29, v34 row_newbcast:13 row_mask:0xf bank_mask:0xf
  v_and_b32_dpp v13, v29, v35 row_newbcast:13 row_mask:0xf bank_mask:0xf
  v_and_b32_dpp v14, v29, v36 row_newbcast:13 row_mask:0xf bank_mask:0xf
  v_and_b32_dpp v15, v29, v0 row_newbcast:13 row_mask:0xf bank_mask:0xf
  s_nop 1
  v_mfma_f32_16x16x32_bf16 v[8:11], v[12:15], v[92:95], v[8:11]
  s_call_b64 s[62:63], L_vq
  s_cbranch_scc0 L_dr19
  v_add_u32_dpp v3, v30, v38 row_newbcast:3 row_mask:0xf bank_mask:0xf
  buffer_load_dwordx4 v[116:119], v3, s[48:51], 0 offen nt
  v_and_b32_dpp v12, v29, v34 row_newbcast:14 row_mask:0xf bank_mask:0xf
  v_and_b32_dpp v13, v29, v35 row_newbcast:14 row_mask:0xf bank_mask:0xf
  v_and_b32_dpp v14, v29, v36 row_newbcast:14 row_mask:0xf bank_mask:0xf
  v_and_b32_dpp v15, v29, v0 row_newbcast:14 row_mask:0xf bank_mask:0xf
  s_nop 1
  v_mfma_f32_16x16x32_bf16 v[8:11], v[12:15], v[96:99], v[8:11]
  s_call_b64 s[62:63], L_vq
  s_cbranch_scc0 L_dr20
  v_add_u32_dpp v3, v30, v38 row_newbcast:4 row_mask:0xf bank_mask:0xf
  buffer_load_dwordx4 v[120:123], v3, s[48:51], 0 offen nt
  v_and_b32_dpp v12, v29, v34 row_newbcast:15 row_mask:0xf bank_mask:0xf
  v_and_b32_dpp v13, v29, v35 row_newbcast:15 row_mask:0xf bank_mask:0xf
  v_and_b32_dpp v14, v29, v36 row_newbcast:15 row_mask:0xf bank_mask:0xf
  v_and_b32_dpp v15, v29, v0 row_newbcast:15 row_mask:0xf bank_mask:0xf
  s_nop 1
  v_mfma_f32_16x16x32_bf16 v[8:11], v[12:15], v[100:103], v[8:11]
  s_call_b64 s[62:63], L_vq
  s_cbranch_scc0 L_dr21
  v_add_u32_dpp v3, v30, v38 row_newbcast:5 row_mask:0xf bank_mask:0xf
  buffer_load_dwordx4 v[124:127], v3, s[48:51], 0 offen nt
  v_and_b32_dpp v12, v31, v34 row_newbcast:0 row_mask:0xf bank_mask:0xf
  v_and_b32_dpp v13, v31, v35 row_newbcast:0 row_mask:0xf bank_mask:0xf
  v_and_b32_dpp v14, v31, v36 row_newbcast:0 row_mask:0xf bank_mask:0xf
  v_and_b32_dpp v15, v31, v0 row_newbcast:0 row_mask:0xf bank_mask:0xf
  s_nop 1
  v_mfma_f32_16x16x32_bf16 v[8:11], v[12:15], v[104:107], v[8:11]
  s_call_b64 s[62:63], L_vq
  s_cbranch_scc0 L_dr22
  v_add_u32_dpp v3, v30, v38 row_newbcast:6 row_mask:0xf bank_mask:0xf
  buffer_load_dwordx4 v[128:131], v3, s[48:51], 0 offen nt
  v_and_b32_dpp v12, v31, v34 row_newbcast:1 row_mask:0xf bank_mask:0xf
  v_and_b32_dpp v13, v31, v35 row_newbcast:1 row_mask:0xf bank_mask:0xf
  v_and_b32_dpp v14, v31, v36 row_newbcast:1 row_mask:0xf bank_mask:0xf
  v_and_b32_dpp v15, v31, v0 row_newbcast:1 row_mask:0xf bank_mask:0xf
  s_nop 1
  v_mfma_f32_16x16x32_bf16 v[8:11], v[12:15], v[108:111], v[8:11]
  s_call_b64 s[62:63], L_vq
  s_cbranch_scc0 L_dr23
  v_add_u32_dpp v3, v30, v38 row_newbcast:7 row_mask:0xf bank_mask:0xf
  buffer_load_dwordx4 v[132:135], v3, s[48:51], 0 offen nt
  v_and_b32_dpp v12, v31, v34 row_newbcast:2 row_mask:0xf bank_mask:0xf
  v_and_b32_dpp v13, v31, v35 row_newbcast:2 row_mask:0xf bank_mask:0xf
  v_and_b32_dpp v14, v31, v36 row_newbcast:2 row_mask:0xf bank_mask:0xf
  v_and_b32_dpp v15, v31, v0 row_newbcast:2 row_mask:0xf bank_mask:0xf
  s_nop 1
  v_mfma_f32_16x16x32_bf16 v[8:11], v[12:15], v[112:115], v[8:11]
  s_call_b64 s[62:63], L_vq
  s_cbranch_scc0 L_dr24
  v_add_u32_dpp v3, v30, v38 row_newbcast:8 row_mask:0xf bank_mask:0xf
  buffer_load_dwordx4 v[136:139], v3, s[48:51], 0 offen nt
  v_and_b32_dpp v12, v31, v34 row_newbcast:3 row_mask:0xf bank_mask:0xf
  v_and_b32_dpp v13, v31, v35 row_newbcast:3 row_mask:0xf bank_mask:0xf
  v_and_b32_dpp v14, v31, v36 row_newbcast:3 row_mask:0xf bank_mask:0xf
  v_and_b32_dpp v15, v31, v0 row_newbcast:3 row_mask:0xf bank_mask:0xf
  s_nop 1
  v_mfma_f32_16x16x32_bf16 v[8:11], v[12:15], v[116:119], v[8:11]
  s_call_b64 s[62:63], L_vq
  s_cbranch_scc0 L_dr25
  v_add_u32_dpp v3, v30, v38 row_newbcast:9 row_mask:0xf bank_mask:0xf
  buffer_load_dwordx4 v[140:143], v3, s[48:51], 0 offen nt
  v_and_b32_dpp v12, v31, v34 row_newbcast:4 row_mask:0xf bank_mask:0xf
  v_and_b32_dpp v13, v31, v35 row_newbcast:4 row_mask:0xf bank_mask:0xf
  v_and_b32_dpp v14, v31, v36 row_newbcast:4 row_mask:0xf bank_mask:0xf
  v_and_b32_dpp v15, v31, v0 row_newbcast:4 row_mask:0xf bank_mask:0xf
  s_nop 1
  v_mfma_f32_16x16x32_bf16 v[8:11], v[12:15], v[120:123], v[8:11]
  s_call_b64 s[62:63], L_vq
  s_cbranch_scc0 L_dr26
  v_add_u32_dpp v3, v30, v38 row_newbcast:10 row_mask:0xf bank_mask:0xf
  buffer_load_dwordx4 v[144:147], v3, s[48:51], 0 offen nt
  v_and_b32_dpp v12, v31, v34 row_newbcast:5 row_mask:0xf bank_mask:0xf
  v_and_b32_dpp v13, v31, v35 row_newbcast:5 row_mask:0xf bank_mask:0xf
  v_and_b32_dpp v14, v31, v36 row_newbcast:5 row_mask:0xf bank_mask:0xf
  v_and_b32_dpp v15, v31, v0 row_newbcast:5 row_mask:0xf bank_mask:0xf
  s_nop 1
  v_mfma_f32_16x16x32_bf16 v[8:11], v[12:15], v[124:127], v[8:11]
  s_call_b64 s[62:63], L_vq
  s_cbranch_scc0 L_dr27
  v_add_u32_dpp v3, v30, v38 row_newbcast:11 row_mask:0xf bank_mask:0xf
  buffer_load_dwordx4 v[148:151], v3, s[48:51], 0 offen nt
  v_and_b32_dpp v12, v31, v34 row_newbcast:6 row_mask:0xf bank_mask:0xf
  v_and_b32_dpp v13, v31, v35 row_newbcast:6 row_mask:0xf bank_mask:0xf
  v_and_b32_dpp v14, v31, v36 row_newbcast:6 row_mask:0xf bank_mask:0xf
  v_and_b32_dpp v15, v31, v0 row_newbcast:6 row_mask:0xf bank_mask:0xf
  s_nop 1
  v_mfma_f32_16x16x32_bf16 v[8:11], v[12:15], v[128:131], v[8:11]
  s_call_b64 s[62:63], L_vq
  s_cbranch_scc0 L_dr28
  v_add_u32_dpp v3, v30, v38 row_newbcast:12 row_mask:0xf bank_mask:0xf
  buffer_load_dwordx4 v[152:155], v3, s[48:51], 0 offen nt
  v_and_b32_dpp v12, v31, v34 row_newbcast:7 row_mask:0xf bank_mask:0xf
  v_and_b32_dpp v13, v31, v35 row_newbcast:7 row_mask:0xf bank_mask:0xf
  v_and_b32_dpp v14, v31, v36 row_newbcast:7 row_mask:0xf bank_mask:0xf
  v_and_b32_dpp v15, v31, v0 row_newbcast:7 row_mask:0xf bank_mask:0xf
  s_nop 1
  v_mfma_f32_16x16x32_bf16 v[8:11], v[12:15], v[132:135], v[8:11]
  s_call_b64 s[62:63], L_vq
  s_cbranch_scc0 L_dr29
  v_add_u32_dpp v3, v30, v38 row_newbcast:13 row_mask:0xf bank_mask:0xf
  buffer_load_dwordx4 v[156:159], v3, s[48:51], 0 offen nt
  v_and_b32_dpp v12, v31, v34 row_newbcast:8 row_mask:0xf bank_mask:0xf
  v_and_b32_dpp v13, v31, v35 row_newbcast:8 row_mask:0xf bank_mask:0xf
  v_and_b32_dpp v14, v31, v36 row_newbcast:8 row_mask:0xf bank_mask:0xf
  v_and_b32_dpp v15, v31, v0 row_newbcast:8 row_mask:0xf bank_mask:0xf
  s_nop 1
  v_mfma_f32_16x16x32_bf16 v[8:11], v[12:15], v[136:139], v[8:11]
  s_call_b64 s[62:63], L_vq
  s_cbranch_scc0 L_dr30
  v_add_u32_dpp v3, v30, v38 row_newbcast:14 row_mask:0xf bank_mask:0xf
  buffer_load_dwordx4 v[160:163], v3, s[48:51], 0 offen nt
  v_and_b32_dpp v12, v31, v34 row_newbcast:9 row_mask:0xf bank_mask:0xf
  v_and_b32_dpp v13, v31, v35 row_newbcast:9 row_mask:0xf bank_mask:0xf
  v_and_b32_dpp v14, v31, v36 row_newbcast:9 row_mask:0xf bank_mask:0xf
  v_and_b32_dpp v15, v31, v0 row_newbcast:9 row_mask:0xf bank_mask:0xf
  s_nop 1
  v_mfma_f32_16x16x32_bf16 v[8:11], v[12:15], v[140:143], v[8:11]
  s_call_b64 s[62:63], L_vq
  s_cbranch_scc0 L_dr31
  v_add_u32_dpp v3, v30, v38 row_newbcast:15 row_mask:0xf bank_mask:0xf
  buffer_load_dwordx4 v[164:167], v3, s[48:51], 0 offen nt
  v_and_b32_dpp v12, v31, v34 row_newbcast:10 row_mask:0xf bank_mask:0xf
  v_and_b32_dpp v13, v31, v35 row_newbcast:10 row_mask:0xf bank_mask:0xf
  v_and_b32_dpp v14, v31, v36 row_newbcast:10 row_mask:0xf bank_mask:0xf
  v_and_b32_dpp v15, v31, v0 row_newbcast:10 row_mask:0xf bank_mask:0xf
  s_nop 1
  v_mfma_f32_16x16x32_bf16 v[8:11], v[12:15], v[144:147], v[8:11]
  s_call_b64 s[62:63], L_vq
  s_cbranch_scc0 L_dr32
  v_add_u32_dpp v3, v32, v38 row_newbcast:0 row_mask:0xf bank_mask:0xf
  buffer_load_dwordx4 v[40:43], v3, s[48:51], 0 offen nt
  v_and_b32_dpp v12, v31, v34 row_newbcast:11 row_mask:0xf bank_mask:0xf
  v_and_b32_dpp v13, v31, v35 row_newbcast:11 row_mask:0xf bank_mask:0xf
  v_and_b32_dpp v14, v31, v36 row_newbcast:11 row_mask:0xf bank_mask:0xf
  v_and_b32_dpp v15, v31, v0 row_newbcast:11 row_mask:0xf bank_mask:0xf
  s_nop 1
  v_mfma_f32_16x16x32_bf16 v[8:11], v[12:15], v[148:151], v[8:11]
  s_call_b64 s[62:63], L_vq
  s_cbranch_scc0 L_dr33
  v_add_u32_dpp v3, v32, v38 row_newbcast:1 row_mask:0xf bank_mask:0xf
  buffer_load_dwordx4 v[44:47], v3, s[48:51], 0 offen nt
  v_and_b32_dpp v12, v31, v34 row_newbcast:12 row_mask:0xf bank_mask:0xf
  v_and_b32_dpp v13, v31, v35 row_newbcast:12 row_mask:0xf bank_mask:0xf
  v_and_b32_dpp v14, v31, v36 row_newbcast:12 row_mask:0xf bank_mask:0xf
  v_and_b32_dpp v15, v31, v0 row_newbcast:12 row_mask:0xf bank_mask:0xf
  s_nop 1
  v_mfma_f32_16x16x32_bf16 v[8:11], v[12:15], v[152:155], v[8:11]
  s_call_b64 s[62:63], L_vq
  s_cbranch_scc0 L_dr34
  v_add_u32_dpp v3, v32, v38 row_newbcast:2 row_mask:0xf bank_mask:0xf
  buffer_load_dwordx4 v[48:51], v3, s[48:51], 0 offen nt
  v_and_b32_dpp v12, v31, v34 row_newbcast:13 row_mask:0xf bank_mask:0xf
  v_and_b32_dpp v13, v31, v35 row_newbcast:13 row_mask:0xf bank_mask:0xf
  v_and_b32_dpp v14, v31, v36 row_newbcast:13 row_mask:0xf bank_mask:0xf
  v_and_b32_dpp v15, v31, v0 row_newbcast:13 row_mask:0xf bank_mask:0xf
  s_nop 1
  v_mfma_f32_16x16x32_bf16 v[8:11], v[12:15], v[156:159], v[8:11]
  s_call_b64 s[62:63], L_vq
  s_cbranch_scc0 L_dr35
  v_add_u32_dpp v3, v32, v38 row_newbcast:3 row_mask:0xf bank_mask:0xf
  buffer_load_dwordx4 v[52:55], v3, s[48:51], 0 offen nt
  v_and_b32_dpp v12, v31, v34 row_newbcast:14 row_mask:0xf bank_mask:0xf
  v_and_b32_dpp v13, v31, v35 row_newbcast:14 row_mask:0xf bank_mask:0xf
  v_and_b32_dpp v14, v31, v36 row_newbcast:14 row_mask:0xf bank_mask:0xf
  v_and_b32_dpp v15, v31, v0 row_newbcast:14 row_mask:0xf bank_mask:0xf
  s_nop 1
  v_mfma_f32_16x16x32_bf16 v[8:11], v[12:15], v[160:163], v[8:11]
  s_call_b64 s[62:63], L_vq
  s_cbranch_scc0 L_dr36
  v_add_u32_dpp v3, v32, v38 row_newbcast:4 row_mask:0xf bank_mask:0xf
  buffer_load_dwordx4 v[56:59], v3, s[48:51], 0 offen nt
  v_and_b32_dpp v12, v31, v34 row_newbcast:15 row_mask:0xf bank_mask:0xf
  v_and_b32_dpp v13, v31, v35 row_newbcast:15 row_mask:0xf bank_mask:0xf
  v_and_b32_dpp v14, v31, v36 row_newbcast:15 row_mask:0xf bank_mask:0xf
  v_and_b32_dpp v15, v31, v0 row_newbcast:15 row_mask:0xf bank_mask:0xf
  s_nop 1
  v_mfma_f32_16x16x32_bf16 v[8:11], v[12:15], v[164:167], v[8:11]
  s_call_b64 s[62:63], L_vq
  s_cbranch_scc0 L_dr37
  v_add_u32_dpp v3, v32, v38 row_newbcast:5 row_mask:0xf bank_mask:0xf
  buffer_load_dwordx4 v[60:63], v3, s[48:51], 0 offen nt
  v_and_b32_dpp v12, v33, v34 row_newbcast:0 row_mask:0xf bank_mask:0xf
  v_and_b32_dpp v13, v33, v35 row_newbcast:0 row_mask:0xf bank_mask:0xf
  v_and_b32_dpp v14, v33, v36 row_newbcast:0 row_mask:0xf bank_mask:0xf
  v_and_b32_dpp v15, v33, v0 row_newbcast:0 row_mask:0xf bank_mask:0xf
  s_nop 1
  v_mfma_f32_16x16x32_bf16 v[8:11], v[12:15], v[40:43], v[8:11]
  s_call_b64 s[62:63], L_vq
  s_branch L_dr38
L_dr5:
  v_and_b32_dpp v12, v29, v34 row_newbcast:0 row_mask:0xf bank_mask:0xf
  v_and_b32_dpp v13, v29, v35 row_newbcast:0 row_mask:0xf bank_mask:0xf
  v_and_b32_dpp v14, v29, v36 row_newbcast:0 row_mask:0xf bank_mask:0xf
  v_and_b32_dpp v15, v29, v0 row_newbcast:0 row_mask:0xf bank_mask:0xf
  s_nop 1
  v_mfma_f32_16x16x32_bf16 v[8:11], v[12:15], v[40:43], v[8:11]
  s_cmp_eq_u32 s75, 6
  s_cbranch_scc1 L_epi
L_dr6:
  v_and_b32_dpp v12, v29, v34 row_newbcast:1 row_mask:0xf bank_mask:0xf
  v_and_b32_dpp v13, v29, v35 row_newbcast:1 row_mask:0xf bank_mask:0xf
  v_and_b32_dpp v14, v29, v36 row_newbcast:1 row_mask:0xf bank_mask:0xf
  v_and_b32_dpp v15, v29, v0 row_newbcast:1 row_mask:0xf bank_mask:0xf
  s_nop 1
  v_mfma_f32_16x16x32_bf16 v[8:11], v[12:15], v[44:47], v[8:11]
  s_cmp_eq_u32 s75, 7
  s_cbranch_scc1 L_epi
L_dr7:
  v_and_b32_dpp v12, v29, v34 row_newbcast:2 row_mask:0xf bank_mask:0xf
  v_and_b32_dpp v13, v29, v35 row_newbcast:2 row_mask:0xf bank_mask:0xf
  v_and_b32_dpp v14, v29, v36 row_newbcast:2 row_mask:0xf bank_mask:0xf
  v_and_b32_dpp v15, v29, v0 row_newbcast:2 row_mask:0xf bank_mask:0xf
  s_nop 1
  v_mfma_f32_16x16x32_bf16 v[8:11], v[12:15], v[48:51], v[8:11]
  s_cmp_eq_u32 s75, 8
  s_cbranch_scc1 L_epi
L_dr8:
  v_and_b32_dpp v12, v29, v34 row_newbcast:3 row_mask:0xf bank_mask:0xf
  v_and_b32_dpp v13, v29, v35 row_newbcast:3 row_mask:0xf bank_mask:0xf
  v_and_b32_dpp v14, v29, v36 row_newbcast:3 row_mask:0xf bank_mask:0xf
  v_and_b32_dpp v15, v29, v0 row_newbcast:3 row_mask:0xf bank_mask:0xf
  s_nop 1
  v_mfma_f32_16x16x32_bf16 v[8:11], v[12:15], v[52:55], v[8:11]
  s_cmp_eq_u32 s75, 9
  s_cbranch_scc1 L_epi
L_dr9:
  v_and_b32_dpp v12, v29, v34 row_newbcast:4 row_mask:0xf bank_mask:0xf
  v_and_b32_dpp v13, v29, v35 row_newbcast:4 row_mask:0xf bank_mask:0xf
  v_and_b32_dpp v14, v29, v36 row_newbcast:4 row_mask:0xf bank_mask:0xf
  v_and_b32_dpp v15, v29, v0 row_newbcast:4 row_mask:0xf bank_mask:0xf
  s_nop 1
  v_mfma_f32_16x16x32_bf16 v[8:11], v[12:15], v[56:59], v[8:11]
  s_cmp_eq_u32 s75, 10
  s_cbranch_scc1 L_epi
L_dr10:
  v_and_b32_dpp v12, v29, v34 row_newbcast:5 row_mask:0xf bank_mask:0xf
  v_and_b32_dpp v13, v29, v35 row_newbcast:5 row_mask:0xf bank_mask:0xf
  v_and_b32_dpp v14, v29, v36 row_newbcast:5 row_mask:0xf bank_mask:0xf
  v_and_b32_dpp v15, v29, v0 row_newbcast:5 row_mask:0xf bank_mask:0xf
  s_nop 1
  v_mfma_f32_16x16x32_bf16 v[8:11], v[12:15], v[60:63], v[8:11]
  s_cmp_eq_u32 s75, 11
  s_cbranch_scc1 L_epi
L_dr11:
  v_and_b32_dpp v12, v29, v34 row_newbcast:6 row_mask:0xf bank_mask:0xf
  v_and_b32_dpp v13, v29, v35 row_newbcast:6 row_mask:0xf bank_mask:0xf
  v_and_b32_dpp v14, v29, v36 row_newbcast:6 row_mask:0xf bank_mask:0xf
  v_and_b32_dpp v15, v29, v0 row_newbcast:6 row_mask:0xf bank_mask:0xf
  s_nop 1
  v_mfma_f32_16x16x32_bf16 v[8:11], v[12:15], v[64:67], v[8:11]
  s_cmp_eq_u32 s75, 12
  s_cbranch_scc1 L_epi
L_dr12:
  v_and_b32_dpp v12, v29, v34 row_newbcast:7 row_mask:0xf bank_mask:0xf
  v_and_b32_dpp v13, v29, v35 row_newbcast:7 row_mask:0xf bank_mask:0xf
  v_and_b32_dpp v14, v29, v36 row_newbcast:7 row_mask:0xf bank_mask:0xf
  v_and_b32_dpp v15, v29, v0 row_newbcast:7 row_mask:0xf bank_mask:0xf
  s_nop 1
  v_mfma_f32_16x16x32_bf16 v[8:11], v[12:15], v[68:71], v[8:11]
  s_cmp_eq_u32 s75, 13
  s_cbranch_scc1 L_epi
L_dr13:
  v_and_b32_dpp v12, v29, v34 row_newbcast:8 row_mask:0xf bank_mask:0xf
  v_and_b32_dpp v13, v29, v35 row_newbcast:8 row_mask:0xf bank_mask:0xf
  v_and_b32_dpp v14, v29, v36 row_newbcast:8 row_mask:0xf bank_mask:0xf
  v_and_b32_dpp v15, v29, v0 row_newbcast:8 row_mask:0xf bank_mask:0xf
  s_nop 1
  v_mfma_f32_16x16x32_bf16 v[8:11], v[12:15], v[72:75], v[8:11]
  s_cmp_eq_u32 s75, 14
  s_cbranch_scc1 L_epi
L_dr14:
  v_and_b32_dpp v12, v29, v34 row_newbcast:9 row_mask:0xf bank_mask:0xf
  v_and_b32_dpp v13, v29, v35 row_newbcast:9 row_mask:0xf bank_mask:0xf
  v_and_b32_dpp v14, v29, v36 row_newbcast:9 row_mask:0xf bank_mask:0xf
  v_and_b32_dpp v15, v29, v0 row_newbcast:9 row_mask:0xf bank_mask:0xf
  s_nop 1
  v_mfma_f32_16x16x32_bf16 v[8:11], v[12:15], v[76:79], v[8:11]
  s_cmp_eq_u32 s75, 15
  s_cbranch_scc1 L_epi
L_dr15:
  v_and_b32_dpp v12, v29, v34 row_newbcast:10 row_mask:0xf bank_mask:0xf
  v_and_b32_dpp v13, v29, v35 row_newbcast:10 row_mask:0xf bank_mask:0xf
  v_and_b32_dpp v14, v29, v36 row_newbcast:10 row_mask:0xf bank_mask:0xf
  v_and_b32_dpp v15, v29, v0 row_newbcast:10 row_mask:0xf bank_mask:0xf
  s_nop 1
  v_mfma_f32_16x16x32_bf16 v[8:11], v[12:15], v[80:83], v[8:11]
  s_cmp_eq_u32 s75, 16
  s_cbranch_scc1 L_epi
L_dr16:
  v_and_b32_dpp v12, v29, v34 row_newbcast:11 row_mask:0xf bank_mask:0xf
  v_and_b32_dpp v13, v29, v35 row_newbcast:11 row_mask:0xf bank_mask:0xf
  v_and_b32_dpp v14, v29, v36 row_newbcast:11 row_mask:0xf bank_mask:0xf
  v_and_b32_dpp v15, v29, v0 row_newbcast:11 row_mask:0xf bank_mask:0xf
  s_nop 1
  v_mfma_f32_16x16x32_bf16 v[8:11], v[12:15], v[84:87], v[8:11]
  s_cmp_eq_u32 s75, 17
  s_cbranch_scc1 L_epi
L_dr17:
  v_and_b32_dpp v12, v29, v34 row_newbcast:12 row_mask:0xf bank_mask:0xf
  v_and_b32_dpp v13, v29, v35 row_newbcast:12 row_mask:0xf bank_mask:0xf
  v_and_b32_dpp v14, v29, v36 row_newbcast:12 row_mask:0xf bank_mask:0xf
  v_and_b32_dpp v15, v29, v0 row_newbcast:12 row_mask:0xf bank_mask:0xf
  s_nop 1
  v_mfma_f32_16x16x32_bf16 v[8:11], v[12:15], v[88:91], v[8:11]
  s_cmp_eq_u32 s75, 18
  s_cbranch_scc1 L_epi
L_dr18:
  v_and_b32_dpp v12, v29, v34 row_newbcast:13 row_mask:0xf bank_mask:0xf
  v_and_b32_dpp v13, v29, v35 row_newbcast:13 row_mask:0xf bank_mask:0xf
  v_and_b32_dpp v14, v29, v36 row_newbcast:13 row_mask:0xf bank_mask:0xf
  v_and_b32_dpp v15, v29, v0 row_newbcast:13 row_mask:0xf bank_mask:0xf
  s_nop 1
  v_mfma_f32_16x16x32_bf16 v[8:11], v[12:15], v[92:95], v[8:11]
  s_cmp_eq_u32 s75, 19
  s_cbranch_scc1 L_epi
L_dr19:
  v_and_b32_dpp v12, v29, v34 row_newbcast:14 row_mask:0xf bank_mask:0xf
  v_and_b32_dpp v13, v29, v35 row_newbcast:14 row_mask:0xf bank_mask:0xf
  v_and_b32_dpp v14, v29, v36 row_newbcast:14 row_mask:0xf bank_mask:0xf
  v_and_b32_dpp v15, v29, v0 row_newbcast:14 row_mask:0xf bank_mask:0xf
  s_nop 1
  v_mfma_f32_16x16x32_bf16 v[8:11], v[12:15], v[96:99], v[8:11]
  s_cmp_eq_u32 s75, 20
  s_cbranch_scc1 L_epi
L_dr20:
  v_and_b32_dpp v12, v29, v34 row_newbcast:15 row_mask:0xf bank_mask:0xf
  v_and_b32_dpp v13, v29, v35 row_newbcast:15 row_mask:0xf bank_mask:0xf
  v_and_b32_dpp v14, v29, v36 row_newbcast:15 row_mask:0xf bank_mask:0xf
  v_and_b32_dpp v15, v29, v0 row_newbcast:15 row_mask:0xf bank_mask:0xf
  s_nop 1
  v_mfma_f32_16x16x32_bf16 v[8:11], v[12:15], v[100:103], v[8:11]
  s_cmp_eq_u32 s75, 21
  s_cbranch_scc1 L_epi
L_dr21:
  v_and_b32_dpp v12, v31, v34 row_newbcast:0 row_mask:0xf bank_mask:0xf
  v_and_b32_dpp v13, v31, v35 row_newbcast:0 row_mask:0xf bank_mask:0xf
  v_and_b32_dpp v14, v31, v36 row_newbcast:0 row_mask:0xf bank_mask:0xf
  v_and_b32_dpp v15, v31, v0 row_newbcast:0 row_mask:0xf bank_mask:0xf
  s_nop 1
  v_mfma_f32_16x16x32_bf16 v[8:11], v[12:15], v[104:107], v[8:11]
  s_cmp_eq_u32 s75, 22
  s_cbranch_scc1 L_epi
L_dr22:
  v_and_b32_dpp v12, v31, v34 row_newbcast:1 row_mask:0xf bank_mask:0xf
  v_and_b32_dpp v13, v31, v35 row_newbcast:1 row_mask:0xf bank_mask:0xf
  v_and_b32_dpp v14, v31, v36 row_newbcast:1 row_mask:0xf bank_mask:0xf
  v_and_b32_dpp v15, v31, v0 row_newbcast:1 row_mask:0xf bank_mask:0xf
  s_nop 1
  v_mfma_f32_16x16x32_bf16 v[8:11], v[12:15], v[108:111], v[8:11]
  s_cmp_eq_u32 s75, 23
  s_cbranch_scc1 L_epi
L_dr23:
  v_and_b32_dpp v12, v31, v34 row_newbcast:2 row_mask:0xf bank_mask:0xf
  v_and_b32_dpp v13, v31, v35 row_newbcast:2 row_mask:0xf bank_mask:0xf
  v_and_b32_dpp v14, v31, v36 row_newbcast:2 row_mask:0xf bank_mask:0xf
  v_and_b32_dpp v15, v31, v0 row_newbcast:2 row_mask:0xf bank_mask:0xf
  s_nop 1
  v_mfma_f32_16x16x32_bf16 v[8:11], v[12:15], v[112:115], v[8:11]
  s_cmp_eq_u32 s75, 24
  s_cbranch_scc1 L_epi
L_dr24:
  v_and_b32_dpp v12, v31, v34 row_newbcast:3 row_mask:0xf bank_mask:0xf
  v_and_b32_dpp v13, v31, v35 row_newbcast:3 row_mask:0xf bank_mask:0xf
  v_and_b32_dpp v14, v31, v36 row_newbcast:3 row_mask:0xf bank_mask:0xf
  v_and_b32_dpp v15, v31, v0 row_newbcast:3 row_mask:0xf bank_mask:0xf
  s_nop 1
  v_mfma_f32_16x16x32_bf16 v[8:11], v[12:15], v[116:119], v[8:11]
  s_cmp_eq_u32 s75, 25
  s_cbranch_scc1 L_epi
L_dr25:
  v_and_b32_dpp v12, v31, v34 row_newbcast:4 row_mask:0xf bank_mask:0xf
  v_and_b32_dpp v13, v31, v35 row_newbcast:4 row_mask:0xf bank_mask:0xf
  v_and_b32_dpp v14, v31, v36 row_newbcast:4 row_mask:0xf bank_mask:0xf
  v_and_b32_dpp v15, v31, v0 row_newbcast:4 row_mask:0xf bank_mask:0xf
  s_nop 1
  v_mfma_f32_16x16x32_bf16 v[8:11], v[12:15], v[120:123], v[8:11]
  s_cmp_eq_u32 s75, 26
  s_cbranch_scc1 L_epi
L_dr26:
  v_and_b32_dpp v12, v31, v34 row_newbcast:5 row_mask:0xf bank_mask:0xf
  v_and_b32_dpp v13, v31, v35 row_newbcast:5 row_mask:0xf bank_mask:0xf
  v_and_b32_dpp v14, v31, v36 row_newbcast:5 row_mask:0xf bank_mask:0xf
  v_and_b32_dpp v15, v31, v0 row_newbcast:5 row_mask:0xf bank_mask:0xf
  s_nop 1
  v_mfma_f32_16x16x32_bf16 v[8:11], v[12:15], v[124:127], v[8:11]
  s_cmp_eq_u32 s75, 27
  s_cbranch_scc1 L_epi
L_dr27:
  v_and_b32_dpp v12, v31, v34 row_newbcast:6 row_mask:0xf bank_mask:0xf
  v_and_b32_dpp v13, v31, v35 row_newbcast:6 row_mask:0xf bank_mask:0xf
  v_and_b32_dpp v14, v31, v36 row_newbcast:6 row_mask:0xf bank_mask:0xf
  v_and_b32_dpp v15, v31, v0 row_newbcast:6 row_mask:0xf bank_mask:0xf
  s_nop 1
  v_mfma_f32_16x16x32_bf16 v[8:11], v[12:15], v[128:131], v[8:11]
  s_cmp_eq_u32 s75, 28
  s_cbranch_scc1 L_epi
L_dr28:
  v_and_b32_dpp v12, v31, v34 row_newbcast:7 row_mask:0xf bank_mask:0xf
  v_and_b32_dpp v13, v31, v35 row_newbcast:7 row_mask:0xf bank_mask:0xf
  v_and_b32_dpp v14, v31, v36 row_newbcast:7 row_mask:0xf bank_mask:0xf
  v_and_b32_dpp v15, v31, v0 row_newbcast:7 row_mask:0xf bank_mask:0xf
  s_nop 1
  v_mfma_f32_16x16x32_bf16 v[8:11], v[12:15], v[132:135], v[8:11]
  s_cmp_eq_u32 s75, 29
  s_cbranch_scc1 L_epi
L_dr29:
  v_and_b32_dpp v12, v31, v34 row_newbcast:8 row_mask:0xf bank_mask:0xf
  v_and_b32_dpp v13, v31, v35 row_newbcast:8 row_mask:0xf bank_mask:0xf
  v_and_b32_dpp v14, v31, v36 row_newbcast:8 row_mask:0xf bank_mask:0xf
  v_and_b32_dpp v15, v31, v0 row_newbcast:8 row_mask:0xf bank_mask:0xf
  s_nop 1
  v_mfma_f32_16x16x32_bf16 v[8:11], v[12:15], v[136:139], v[8:11]
  s_cmp_eq_u32 s75, 30
  s_cbranch_scc1 L_epi
L_dr30:
  v_and_b32_dpp v12, v31, v34 row_newbcast:9 row_mask:0xf bank_mask:0xf
  v_and_b32_dpp v13, v31, v35 row_newbcast:9 row_mask:0xf bank_mask:0xf
  v_and_b32_dpp v14, v31, v36 row_newbcast:9 row_mask:0xf bank_mask:0xf
  v_and_b32_dpp v15, v31, v0 row_newbcast:9 row_mask:0xf bank_mask:0xf
  s_nop 1
  v_mfma_f32_16x16x32_bf16 v[8:11], v[12:15], v[140:143], v[8:11]
  s_cmp_eq_u32 s75, 31
  s_cbranch_scc1 L_epi
L_dr31:
  v_and_b32_dpp v12, v31, v34 row_newbcast:10 row_mask:0xf bank_mask:0xf
  v_and_b32_dpp v13, v31, v35 row_newbcast:10 row_mask:0xf bank_mask:0xf
  v_and_b32_dpp v14, v31, v36 row_newbcast:10 row_mask:0xf bank_mask:0xf
  v_and_b32_dpp v15, v31, v0 row_newbcast:10 row_mask:0xf bank_mask:0xf
  s_nop 1
  v_mfma_f32_16x16x32_bf16 v[8:11], v[12:15], v[144:147], v[8:11]
  s_cmp_eq_u32 s75, 32
  s_cbranch_scc1 L_epi
L_dr32:
  v_and_b32_dpp v12, v31, v34 row_newbcast:11 row_mask:0xf bank_mask:0xf
  v_and_b32_dpp v13, v31, v35 row_newbcast:11 row_mask:0xf bank_mask:0xf
  v_and_b32_dpp v14, v31, v36 row_newbcast:11 row_mask:0xf bank_mask:0xf
  v_and_b32_dpp v15, v31, v0 row_newbcast:11 row_mask:0xf bank_mask:0xf
  s_nop 1
  v_mfma_f32_16x16x32_bf16 v[8:11], v[12:15], v[148:151], v[8:11]
  s_cmp_eq_u32 s75, 33
  s_cbranch_scc1 L_epi
L_dr33:
  v_and_b32_dpp v12, v31, v34 row_newbcast:12 row_mask:0xf bank_mask:0xf
  v_and_b32_dpp v13, v31, v35 row_newbcast:12 row_mask:0xf bank_mask:0xf
  v_and_b32_dpp v14, v31, v36 row_newbcast:12 row_mask:0xf bank_mask:0xf
  v_and_b32_dpp v15, v31, v0 row_newbcast:12 row_mask:0xf bank_mask:0xf
  s_nop 1
  v_mfma_f32_16x16x32_bf16 v[8:11], v[12:15], v[152:155], v[8:11]
  s_cmp_eq_u32 s75, 34
  s_cbranch_scc1 L_epi
L_dr34:
  v_and_b32_dpp v12, v31, v34 row_newbcast:13 row_mask:0xf bank_mask:0xf
  v_and_b32_dpp v13, v31, v35 row_newbcast:13 row_mask:0xf bank_mask:0xf
  v_and_b32_dpp v14, v31, v36 row_newbcast:13 row_mask:0xf bank_mask:0xf
  v_and_b32_dpp v15, v31, v0 row_newbcast:13 row_mask:0xf bank_mask:0xf
  s_nop 1
  v_mfma_f32_16x16x32_bf16 v[8:11], v[12:15], v[156:159], v[8:11]
  s_cmp_eq_u32 s75, 35
  s_cbranch_scc1 L_epi
L_dr35:
  v_and_b32_dpp v12, v31, v34 row_newbcast:14 row_mask:0xf bank_mask:0xf
  v_and_b32_dpp v13, v31, v35 row_newbcast:14 row_mask:0xf bank_mask:0xf
  v_and_b32_dpp v14, v31, v36 row_newbcast:14 row_mask:0xf bank_mask:0xf
  v_and_b32_dpp v15, v31, v0 row_newbcast:14 row_mask:0xf bank_mask:0xf
  s_nop 1
  v_mfma_f32_16x16x32_bf16 v[8:11], v[12:15], v[160:163], v[8:11]
  s_cmp_eq_u32 s75, 36
  s_cbranch_scc1 L_epi
L_dr36:
  v_and_b32_dpp v12, v31, v34 row_newbcast:15 row_mask:0xf bank_mask:0xf
  v_and_b32_dpp v13, v31, v35 row_newbcast:15 row_mask:0xf bank_mask:0xf
  v_and_b32_dpp v14, v31, v36 row_newbcast:15 row_mask:0xf bank_mask:0xf
  v_and_b32_dpp v15, v31, v0 row_newbcast:15 row_mask:0xf bank_mask:0xf
  s_nop 1
  v_mfma_f32_16x16x32_bf16 v[8:11], v[12:15], v[164:167], v[8:11]
  s_cmp_eq_u32 s75, 37
  s_cbranch_scc1 L_epi
L_dr37:
  v_and_b32_dpp v12, v33, v34 row_newbcast:0 row_mask:0xf bank_mask:0xf
  v_and_b32_dpp v13, v33, v35 row_newbcast:0 row_mask:0xf bank_mask:0xf
  v_and_b32_dpp v14, v33, v36 row_newbcast:0 row_mask:0xf bank_mask:0xf
  v_and_b32_dpp v15, v33, v0 row_newbcast:0 row_mask:0xf bank_mask:0xf
  s_nop 1
  v_mfma_f32_16x16x32_bf16 v[8:11], v[12:15], v[40:43], v[8:11]
  s_cmp_eq_u32 s75, 38
  s_cbranch_scc1 L_epi
L_dr38:
  v_and_b32_dpp v12, v33, v34 row_newbcast:1 row_mask:0xf bank_mask:0xf
  v_and_b32_dpp v13, v33, v35 row_newbcast:1 row_mask:0xf bank_mask:0xf
  v_and_b32_dpp v14, v33, v36 row_newbcast:1 row_mask:0xf bank_mask:0xf
  v_and_b32_dpp v15, v33, v0 row_newbcast:1 row_mask:0xf bank_mask:0xf
  s_nop 1
  v_mfma_f32_16x16x32_bf16 v[8:11], v[12:15], v[44:47], v[8:11]
  s_cmp_eq_u32 s75, 39
  s_cbranch_scc1 L_epi
L_dr39:
  v_and_b32_dpp v12, v33, v34 row_newbcast:2 row_mask:0xf bank_mask:0xf
  v_and_b32_dpp v13, v33, v35 row_newbcast:2 row_mask:0xf bank_mask:0xf
  v_and_b32_dpp v14, v33, v36 row_newbcast:2 row_mask:0xf bank_mask:0xf
  v_and_b32_dpp v15, v33, v0 row_newbcast:2 row_mask:0xf bank_mask:0xf
  s_nop 1
  v_mfma_f32_16x16x32_bf16 v[8:11], v[12:15], v[48:51], v[8:11]
  s_cmp_eq_u32 s75, 40
  s_cbranch_scc1 L_epi
L_dr40:
  v_and_b32_dpp v12, v33, v34 row_newbcast:3 row_mask:0xf bank_mask:0xf
  v_and_b32_dpp v13, v33, v35 row_newbcast:3 row_mask:0xf bank_mask:0xf
  v_and_b32_dpp v14, v33, v36 row_newbcast:3 row_mask:0xf bank_mask:0xf
  v_and_b32_dpp v15, v33, v0 row_newbcast:3 row_mask:0xf bank_mask:0xf
  s_nop 1
  v_mfma_f32_16x16x32_bf16 v[8:11], v[12:15], v[52:55], v[8:11]
  s_cmp_eq_u32 s75, 41
  s_cbranch_scc1 L_epi
L_dr41:
  v_and_b32_dpp v12, v33, v34 row_newbcast:4 row_mask:0xf bank_mask:0xf
  v_and_b32_dpp v13, v33, v35 row_newbcast:4 row_mask:0xf bank_mask:0xf
  v_and_b32_dpp v14, v33, v36 row_newbcast:4 row_mask:0xf bank_mask:0xf
  v_and_b32_dpp v15, v33, v0 row_newbcast:4 row_mask:0xf bank_mask:0xf
  s_nop 1
  v_mfma_f32_16x16x32_bf16 v[8:11], v[12:15], v[56:59], v[8:11]
  s_cmp_eq_u32 s75, 42
  s_cbranch_scc1 L_epi
L_dr42:
  v_and_b32_dpp v12, v33, v34 row_newbcast:5 row_mask:0xf bank_mask:0xf
  v_and_b32_dpp v13, v33, v35 row_newbcast:5 row_mask:0xf bank_mask:0xf
  v_and_b32_dpp v14, v33, v36 row_newbcast:5 row_mask:0xf bank_mask:0xf
  v_and_b32_dpp v15, v33, v0 row_newbcast:5 row_mask:0xf bank_mask:0xf
  s_nop 1
  v_mfma_f32_16x16x32_bf16 v[8:11], v[12:15], v[60:63], v[8:11]
  s_cmp_eq_u32 s75, 43
  s_cbranch_scc1 L_epi
L_epi:
  v_lshrrev_b32 v3, 4, v1
  v_lshl_add_u32 v21, v3, 3, v39
  v_add_u32 v21, s11, v21
  v_mov_b32 v3, 1
  s_nop 3
  v_pk_add_f32 v[8:9], v[8:9], v[4:5]
  v_pk_add_f32 v[10:11], v[10:11], v[6:7]
  s_mov_b32 exec_hi, 0
  ds_write_b128 v21, v[8:11] offset:1024
  s_cmp_eq_u32 s21, 0
  s_cbranch_scc1 L_ep2
  s_mov_b32 exec_hi, 0
  ds_write_b128 v21, v[8:11] offset:6656
  s_mov_b64 exec, 1
  ds_add_u32 v1, v3 offset:304
  s_mov_b64 exec, -1
L_ep2:
  s_mov_b64 exec, 1
  ds_add_u32 v1, v3 offset:308
L_send:
  s_endpgm
L_ks:
  s_cmp_lt_u32 s32, s57
  s_cbranch_scc1 L_kq
  s_call_b64 s[100:101], L_work
L_kq:
  v_readfirstlane_b32 s78, v22
  v_readfirstlane_b32 s79, v23
L_ks2:
  s_mov_b64 exec, 1
  ds_dec_u32 v2, v39 offset:288
  ds_read_b64 v[22:23], v2 offset:288
  s_mov_b64 exec, -1
  s_mul_i32 s68, s35, s76
  s_and_b32 s69, s79, 0xffff
  s_sub_i32 s68, s68, s78
  s_mul_i32 s69, s69, s77
  s_mul_i32 s68, s68, 160
  s_sub_u32 s35, s35, 1
  s_add_i32 s68, s68, s69
  s_add_i32 s68, s68, s34
  s_max_i32 s68, s68, 4915
  s_min_i32 s68, s68, 20480
  s_lshr_b32 s37, s68, 12
  s_lshl_b32 s58, s68, 20
L_kl:
  s_add_u32 s32, s32, 1
  s_add_u32 s33, s33, 0x20000000
  s_add_u32 s68, s33, s58
  s_addc_u32 s41, s37, 0
  s_cmp_eq_u32 s41, 3
  s_cbranch_scc1 L_wt3
  s_cmp_eq_u32 s41, 2
  s_cbranch_scc1 L_wt2
  s_cmp_eq_u32 s41, 4
  s_cbranch_scc1 L_wt4
  s_cmp_eq_u32 s41, 1
  s_cbranch_scc1 L_wt1
L_wtx:
  s_cmp_eq_u32 s32, s32
L_wt5:
  s_waitcnt vmcnt(4)
  s_setpc_b64 s[62:63]
L_wt3:
  s_waitcnt vmcnt(2)
  s_setpc_b64 s[62:63]
L_wt2:
  s_waitcnt vmcnt(1)
  s_setpc_b64 s[62:63]
L_wt4:
  s_waitcnt vmcnt(3)
  s_setpc_b64 s[62:63]
L_wt1:
  s_waitcnt vmcnt(0)
  s_setpc_b64 s[62:63]
L_kq2:
  v_readfirstlane_b32 s78, v22
  v_readfirstlane_b32 s79, v23
L_ks3:
  s_mov_b64 exec, 1
  ds_dec_u32 v2, v39 offset:288
  ds_dec_u32 v2, v39 offset:288
  ds_read_b64 v[22:23], v2 offset:288
  s_mov_b64 exec, -1
  s_mul_i32 s68, s35, s76
  s_and_b32 s69, s79, 0xffff
  s_sub_i32 s68, s68, s78
  s_mul_i32 s69, s69, s77
  s_mul_i32 s68, s68, 160
  s_sub_u32 s35, s35, 2
  s_add_i32 s68, s68, s69
  s_add_i32 s68, s68, s34
  s_max_i32 s68, s68, 4915
  s_min_i32 s68, s68, 20480
  s_lshr_b32 s37, s68, 12
  s_lshl_b32 s58, s68, 20
  s_branch L_kl
L_vl:
  s_cmp_lt_u32 s32, s36
  s_cbranch_scc1 L_kl
  s_branch L_ev
L_vq2:
  v_readfirstlane_b32 s78, v22
  v_readfirstlane_b32 s79, v23
  s_cmp_lt_u32 s32, s36
  s_cbranch_scc1 L_ks3
  s_branch L_ev
L_vs:
  v_readfirstlane_b32 s78, v22
  v_readfirstlane_b32 s79, v23
  s_cmp_eq_u32 s61, 2
  s_cbranch_scc1 L_vs1
  s_cmp_eq_u32 s61, 1
  s_cbranch_scc1 L_x3
  s_cmp_gt_u32 s41, s32
  s_cbranch_scc1 L_ks2
L_x1:
  v_dot2_f32_bf16 v12, v152, v4, 0
  v_dot2_f32_bf16 v13, v156, v4, 0
  v_dot2_f32_bf16 v14, v160, v4, 0
  v_dot2_f32_bf16 v15, v164, v4, 0
  v_dot2_f32_bf16 v12, v153, v5, v12
  v_dot2_f32_bf16 v13, v157, v5, v13
  v_dot2_f32_bf16 v14, v161, v5, v14
  v_dot2_f32_bf16 v15, v165, v5, v15
  v_dot2_f32_bf16 v12, v154, v6, v12
  v_dot2_f32_bf16 v13, v158, v6, v13
  v_dot2_f32_bf16 v14, v162, v6, v14
  v_dot2_f32_bf16 v15, v166, v6, v15
  v_dot2_f32_bf16 v12, v155, v7, v12
  v_dot2_f32_bf16 v13, v159, v7, v13
  v_dot2_f32_bf16 v14, v163, v7, v14
  v_dot2_f32_bf16 v15, v167, v7, v15
  v_add_f32_dpp v12, v12, v12 row_ror:8 row_mask:0xf bank_mask:0x3
  v_add_f32_dpp v12, v13, v13 row_ror:8 row_mask:0xf bank_mask:0xc
  v_add_f32_dpp v14, v14, v14 row_ror:8 row_mask:0xf bank_mask:0x3
  v_add_f32_dpp v14, v15, v15 row_ror:8 row_mask:0xf bank_mask:0xc
  s_nop 0
  v_add_f32_dpp v19, v12, v12 row_shl:4 row_mask:0xf bank_mask:0x5
  v_add_f32_dpp v19, v14, v14 row_shr:4 row_mask:0xf bank_mask:0xa
  s_lshl_b32 s68, s20, 3
  s_add_u32 s68, s68, s56
  v_add_f32_dpp v16, v16, v16 quad_perm:[2,3,0,1] row_mask:0xf bank_mask:0xf
  v_add_f32_dpp v17, v17, v17 quad_perm:[2,3,0,1] row_mask:0xf bank_mask:0xf
  v_add_f32_dpp v18, v18, v18 quad_perm:[2,3,0,1] row_mask:0xf bank_mask:0xf
  v_add_f32_dpp v19, v19, v19 quad_perm:[2,3,0,1] row_mask:0xf bank_mask:0xf
  v_cndmask_b32 v8, v16, v17, s[52:53]
  v_cndmask_b32 v9, v18, v19, s[52:53]
  v_mov_b32 v20, 64
  v_lshlrev_b32 v21, 3, s9
  v_add_f32_dpp v8, v8, v8 quad_perm:[1,0,3,2] row_mask:0xf bank_mask:0xf
  v_add_f32_dpp v9, v9, v9 quad_perm:[1,0,3,2] row_mask:0xf bank_mask:0xf
  v_cndmask_b32 v27, v8, v9, s[54:55]
  v_cvt_pk_bf16_f32 v27, 0, v27
  v_mul_f32 v27, 0x3db504f3, v27
  v_cvt_pk_bf16_f32 v27, 0, v27
  v_max_f32 v37, v37, v27
  v_cmp_ngt_f32 vcc, s22, v27
  v_mov_b32 v4, 0
  v_max_f32_dpp v37, v37, v37 row_ror:8 row_mask:0xf bank_mask:0xf
  s_bcnt1_i32_b64 s69, vcc
  s_add_u32 s69, s69, s20
  v_max_f32_dpp v37, v37, v37 row_ror:4 row_mask:0xf bank_mask:0xf
  s_cmp_gt_u32 s69, 32
  s_cselect_b32 s21, 1, s21
  v_max_f32_dpp v37, v37, v37 row_ror:2 row_mask:0xf bank_mask:0xf
  s_cmp_eq_u32 s21, 0
  s_cselect_b64 s[66:67], vcc, 0
  s_cselect_b32 s20, s69, s20
  v_max_f32_dpp v37, v37, v37 row_ror:1 row_mask:0xf bank_mask:0xf
  v_mbcnt_lo_u32_b32 v3, s66, 0
  v_mov_b32 v8, v37
  v_mbcnt_hi_u32_b32 v3, s67, v3
  v_lshl_add_u32 v3, v3, 3, s68
  v_permlane16_swap_b32 v8, v37
  s_mov_b64 exec, s[66:67]
  ds_write_b64 v3, v[26:27] offset:1280
  s_mov_b64 exec, -1
  ds_read_b32 v32, v39 offset:1024
  v_max_f32 v37, v37, v8
  v_mov_b32 v8, v37
  v_mov_b32 v5, 0
  s_mov_b32 s18, s32
  v_permlane32_swap_b32 v8, v37
  v_max_f32 v37, v37, v8
  v_sub_f32 v17, v25, v37
  v_sub_f32 v18, v27, v37
  v_mul_f32 v17, 0x3fb8aa3b, v17
  v_mul_f32 v18, 0x3fb8aa3b, v18
  v_exp_f32 v17, v17
  v_exp_f32 v18, v18
  v_mov_b32 v16, v37
  v_add_f32 v17, v17, v18
  s_waitcnt lgkmcnt(0)
  s_cmp_le_u32 s20, 0
  s_cbranch_scc1 L_x2
  v_add_u32_dpp v3, v32, v38 row_newbcast:8 row_mask:0xf bank_mask:0xf
  buffer_load_dwordx4 v[136:139], v3, s[48:51], 0 offen nt
  s_cmp_le_u32 s20, 4
  s_cbranch_scc1 L_x2
  v_add_u32_dpp v3, v32, v38 row_newbcast:9 row_mask:0xf bank_mask:0xf
  buffer_load_dwordx4 v[140:143], v3, s[48:51], 0 offen nt
  s_cmp_le_u32 s20, 8
  s_cbranch_scc1 L_x2
  v_add_u32_dpp v3, v32, v38 row_newbcast:10 row_mask:0xf bank_mask:0xf
  buffer_load_dwordx4 v[144:147], v3, s[48:51], 0 offen nt
  s_cmp_le_u32 s20, 12
  s_cbranch_scc1 L_x2
  v_add_u32_dpp v3, v32, v38 row_newbcast:11 row_mask:0xf bank_mask:0xf
  buffer_load_dwordx4 v[148:151], v3, s[48:51], 0 offen nt
  s_cmp_le_u32 s20, 16
  s_cbranch_scc1 L_x2
  v_add_u32_dpp v3, v32, v38 row_newbcast:12 row_mask:0xf bank_mask:0xf
  buffer_load_dwordx4 v[152:155], v3, s[48:51], 0 offen nt
  s_cmp_le_u32 s20, 20
  s_cbranch_scc1 L_x2
  v_add_u32_dpp v3, v32, v38 row_newbcast:13 row_mask:0xf bank_mask:0xf
  buffer_load_dwordx4 v[156:159], v3, s[48:51], 0 offen nt
  s_cmp_le_u32 s20, 24
  s_cbranch_scc1 L_x2
  v_add_u32_dpp v3, v32, v38 row_newbcast:14 row_mask:0xf bank_mask:0xf
  buffer_load_dwordx4 v[160:163], v3, s[48:51], 0 offen nt
  s_cmp_le_u32 s20, 28
  s_cbranch_scc1 L_x2
  v_add_u32_dpp v3, v32, v38 row_newbcast:15 row_mask:0xf bank_mask:0xf
  buffer_load_dwordx4 v[164:167], v3, s[48:51], 0 offen nt
L_x2:
  s_nop 1
  v_add_f32_dpp v17, v17, v17 row_ror:8 row_mask:0xf bank_mask:0xf
  s_nop 1
  v_add_f32_dpp v17, v17, v17 row_ror:4 row_mask:0xf bank_mask:0xf
  s_nop 1
  v_add_f32_dpp v17, v17, v17 row_ror:2 row_mask:0xf bank_mask:0xf
  s_nop 1
  v_add_f32_dpp v17, v17, v17 row_ror:1 row_mask:0xf bank_mask:0xf
  v_mov_b32 v8, v17
  s_nop 1
  v_permlane16_swap_b32 v8, v17
  v_add_f32 v17, v17, v8
  v_mov_b32 v8, v17
  s_nop 1
  v_permlane32_swap_b32 v8, v17
  v_add_f32 v17, v17, v8
  s_mov_b64 exec, 1
  ds_max_f32 v1, v37 offset:276
  ds_write_b64 v21, v[16:17] offset:512
  ds_add_u32 v1, v20 offset:272
  s_mov_b64 exec, -1
  s_mov_b32 s61, 1
  s_mov_b32 s19, 1
  s_cmp_lt_u32 s32, 5
  s_cbranch_scc1 L_ks2
L_x3:
  v_max_f32 v21, s23, v37
  s_add_u32 s38, s38, 3
  s_lshr_b32 s38, s38, 2
  v_add_f32 v21, 0xc2ac0000, v21
  s_max_u32 s38, s38, s32
  s_lshl_b32 s38, s38, 2
  v_cmp_nlt_f32 vcc, v27, v21
  s_lshl_b32 s68, s38, 3
  s_add_u32 s68, s68, s56
  s_andn2_b64 s[70:71], vcc, s[66:67]
  v_mbcnt_lo_u32_b32 v3, s70, 0
  v_mbcnt_hi_u32_b32 v3, s71, v3
  s_bcnt1_i32_b64 s69, s[70:71]
  v_lshl_add_u32 v3, v3, 3, s68
  s_mov_b64 exec, s[70:71]
  ds_write_b64 v3, v[26:27]
  s_mov_b64 exec, -1
  s_or_b64 s[66:67], s[66:67], s[70:71]
  s_add_u32 s38, s38, s69
  ds_read_b64 v[28:29], v39 offset:0
  ds_read_b64 v[30:31], v39 offset:512
  ds_read_b64 v[32:33], v39 offset:1024
  v_mov_b32 v8, 0
  v_mov_b32 v9, 0
  v_mov_b32 v10, 0
  v_mov_b32 v11, 0
  v_mov_b32 v6, 0
  v_mov_b32 v7, 0
  s_lshr_b32 s36, s38, 2
  s_mov_b32 s61, 2
  s_add_u32 s68, s38, 8
  s_lshr_b32 s68, s68, 2
  s_sub_u32 s69, s68, s59
  s_mov_b32 s59, s68
  s_add_u32 s35, s35, s69
  s_add_u32 s78, s78, s69
  v_mov_b32 v3, s69
  s_mov_b64 exec, 1
  ds_add_u32 v1, v3 offset:296
  ds_add_u32 v1, v3 offset:300
  s_mov_b64 exec, -1
  s_waitcnt lgkmcnt(0)
  v_sub_f32 v29, v29, v37
  v_sub_f32 v31, v31, v37
  v_sub_f32 v33, v33, v37
  v_mul_f32 v29, 0x3fb8aa3b, v29
  v_mul_f32 v31, 0x3fb8aa3b, v31
  v_mul_f32 v33, 0x3fb8aa3b, v33
  v_exp_f32 v29, v29
  v_exp_f32 v31, v31
  v_exp_f32 v33, v33
  s_nop 0
  v_cvt_pk_bf16_f32 v29, v29, v29
  v_cvt_pk_bf16_f32 v31, v31, v31
  v_cvt_pk_bf16_f32 v33, v33, v33
  s_cmp_eq_u32 s20, 0
  s_cselect_b32 s41, 0, s41
L_vs1:
  s_cmp_eq_u32 s19, 0
  s_cbranch_scc1 L_vs1b
  s_sub_u32 s68, s32, s18
  s_cmp_le_u32 s41, s68
  s_cbranch_scc1 L_snap
  s_cmp_lt_u32 s32, s36
  s_cbranch_scc1 L_ks2
  s_waitcnt vmcnt(0)
L_snap:
  s_cmp_le_u32 s20, 0
  s_cbranch_scc1 L_snp2
  v_and_b32_dpp v12, v33, v34 row_newbcast:8 row_mask:0xf bank_mask:0xf
  v_and_b32_dpp v13, v33, v35 row_newbcast:8 row_mask:0xf bank_mask:0xf
  v_and_b32_dpp v14, v33, v36 row_newbcast:8 row_mask:0xf bank_mask:0xf
  v_and_b32_dpp v15, v33, v0 row_newbcast:8 row_mask:0xf bank_mask:0xf
  s_nop 1
  v_mfma_f32_16x16x32_bf16 v[4:7], v[12:15], v[136:139], v[4:7]
  s_cmp_le_u32 s20, 4
  s_cbranch_scc1 L_snp2
  v_and_b32_dpp v12, v33, v34 row_newbcast:9 row_mask:0xf bank_mask:0xf
  v_and_b32_dpp v13, v33, v35 row_newbcast:9 row_mask:0xf bank_mask:0xf
  v_and_b32_dpp v14, v33, v36 row_newbcast:9 row_mask:0xf bank_mask:0xf
  v_and_b32_dpp v15, v33, v0 row_newbcast:9 row_mask:0xf bank_mask:0xf
  s_nop 1
  v_mfma_f32_16x16x32_bf16 v[4:7], v[12:15], v[140:143], v[4:7]
  s_cmp_le_u32 s20, 8
  s_cbranch_scc1 L_snp2
  v_and_b32_dpp v12, v33, v34 row_newbcast:10 row_mask:0xf bank_mask:0xf
  v_and_b32_dpp v13, v33, v35 row_newbcast:10 row_mask:0xf bank_mask:0xf
  v_and_b32_dpp v14, v33, v36 row_newbcast:10 row_mask:0xf bank_mask:0xf
  v_and_b32_dpp v15, v33, v0 row_newbcast:10 row_mask:0xf bank_mask:0xf
  s_nop 1
  v_mfma_f32_16x16x32_bf16 v[4:7], v[12:15], v[144:147], v[4:7]
  s_cmp_le_u32 s20, 12
  s_cbranch_scc1 L_snp2
  v_and_b32_dpp v12, v33, v34 row_newbcast:11 row_mask:0xf bank_mask:0xf
  v_and_b32_dpp v13, v33, v35 row_newbcast:11 row_mask:0xf bank_mask:0xf
  v_and_b32_dpp v14, v33, v36 row_newbcast:11 row_mask:0xf bank_mask:0xf
  v_and_b32_dpp v15, v33, v0 row_newbcast:11 row_mask:0xf bank_mask:0xf
  s_nop 1
  v_mfma_f32_16x16x32_bf16 v[4:7], v[12:15], v[148:151], v[4:7]
  s_cmp_le_u32 s20, 16
  s_cbranch_scc1 L_snp2
  v_and_b32_dpp v12, v33, v34 row_newbcast:12 row_mask:0xf bank_mask:0xf
  v_and_b32_dpp v13, v33, v35 row_newbcast:12 row_mask:0xf bank_mask:0xf
  v_and_b32_dpp v14, v33, v36 row_newbcast:12 row_mask:0xf bank_mask:0xf
  v_and_b32_dpp v15, v33, v0 row_newbcast:12 row_mask:0xf bank_mask:0xf
  s_nop 1
  v_mfma_f32_16x16x32_bf16 v[4:7], v[12:15], v[152:155], v[4:7]
  s_cmp_le_u32 s20, 20
  s_cbranch_scc1 L_snp2
  v_and_b32_dpp v12, v33, v34 row_newbcast:13 row_mask:0xf bank_mask:0xf
  v_and_b32_dpp v13, v33, v35 row_newbcast:13 row_mask:0xf bank_mask:0xf
  v_and_b32_dpp v14, v33, v36 row_newbcast:13 row_mask:0xf bank_mask:0xf
  v_and_b32_dpp v15, v33, v0 row_newbcast:13 row_mask:0xf bank_mask:0xf
  s_nop 1
  v_mfma_f32_16x16x32_bf16 v[4:7], v[12:15], v[156:159], v[4:7]
  s_cmp_le_u32 s20, 24
  s_cbranch_scc1 L_snp2
  v_and_b32_dpp v12, v33, v34 row_newbcast:14 row_mask:0xf bank_mask:0xf
  v_and_b32_dpp v13, v33, v35 row_newbcast:14 row_mask:0xf bank_mask:0xf
  v_and_b32_dpp v14, v33, v36 row_newbcast:14 row_mask:0xf bank_mask:0xf
  v_and_b32_dpp v15, v33, v0 row_newbcast:14 row_mask:0xf bank_mask:0xf
  s_nop 1
  v_mfma_f32_16x16x32_bf16 v[4:7], v[12:15], v[160:163], v[4:7]
  s_cmp_le_u32 s20, 28
  s_cbranch_scc1 L_snp2
  v_and_b32_dpp v12, v33, v34 row_newbcast:15 row_mask:0xf bank_mask:0xf
  v_and_b32_dpp v13, v33, v35 row_newbcast:15 row_mask:0xf bank_mask:0xf
  v_and_b32_dpp v14, v33, v36 row_newbcast:15 row_mask:0xf bank_mask:0xf
  v_and_b32_dpp v15, v33, v0 row_newbcast:15 row_mask:0xf bank_mask:0xf
  s_nop 1
  v_mfma_f32_16x16x32_bf16 v[4:7], v[12:15], v[164:167], v[4:7]
L_snp2:
  v_lshrrev_b32 v3, 4, v1
  v_lshl_add_u32 v21, v3, 3, v39
  v_add_u32 v21, s11, v21
  v_mov_b32 v3, 1
  s_nop 0
  s_mov_b32 s19, 0
  s_cmp_lg_u32 s21, 0
  s_cbranch_scc1 L_vs1b
  s_mov_b32 exec_hi, 0
  ds_write_b128 v21, v[4:7] offset:6656
  s_mov_b64 exec, 1
  ds_add_u32 v1, v3 offset:304
  s_mov_b64 exec, -1
  s_branch L_vs1b
L_vq:
  v_readfirstlane_b32 s78, v22
  v_readfirstlane_b32 s79, v23
L_vs1b:
L_vs2:
  s_cmp_lt_u32 s32, s36
  s_cbranch_scc1 L_ks2
L_ev:
  s_cmp_eq_u32 s75, 0
  s_cbranch_scc1 L_hand
  s_add_u32 s68, s32, 5
  s_cmp_lt_u32 s68, s75
  s_cbranch_scc0 L_wt1
  s_add_u32 s32, s32, 1
  s_mov_b64 exec, 1
  ds_dec_u32 v2, v39 offset:288
  s_mov_b64 exec, -1
  s_branch L_wtx
L_hand:
  v_mov_b32 v3, 0
  s_mov_b32 s70, 0
L_sn_1:
  ds_read_b64 v[18:19], v3 offset:272
  s_waitcnt lgkmcnt(0)
  v_cmp_gt_u32 vcc, 0x102c0, v18
  s_cmp_eq_u64 vcc, 0
  s_cbranch_scc1 L_snd_2
  s_sleep 1
  s_add_u32 s70, s70, 1
  s_cmp_lt_u32 s70, 2097152
  s_cbranch_scc1 L_sn_1
L_snd_2:
  v_add_f32 v21, 0xc2ba0000, v19
  v_cmp_nlt_f32 vcc, v25, v21
  s_lshl_b32 s68, s38, 3
  s_add_u32 s68, s68, s56
  s_andn2_b64 s[70:71], vcc, s[64:65]
  v_mbcnt_lo_u32_b32 v3, s70, 0
  v_mbcnt_hi_u32_b32 v3, s71, v3
  s_bcnt1_i32_b64 s69, s[70:71]
  v_lshl_add_u32 v3, v3, 3, s68
  s_mov_b64 exec, s[70:71]
  ds_write_b64 v3, v[24:25]
  s_mov_b64 exec, -1
  s_or_b64 s[64:65], s[64:65], s[70:71]
  s_add_u32 s38, s38, s69
  v_cmp_nlt_f32 vcc, v27, v21
  s_lshl_b32 s68, s38, 3
  s_add_u32 s68, s68, s56
  s_andn2_b64 s[70:71], vcc, s[66:67]
  v_mbcnt_lo_u32_b32 v3, s70, 0
  v_mbcnt_hi_u32_b32 v3, s71, v3
  s_bcnt1_i32_b64 s69, s[70:71]
  v_lshl_add_u32 v3, v3, 3, s68
  s_mov_b64 exec, s[70:71]
  ds_write_b64 v3, v[26:27]
  s_mov_b64 exec, -1
  s_or_b64 s[66:67], s[66:67], s[70:71]
  s_add_u32 s38, s38, s69
  ds_read_b64 v[28:29], v39 offset:0
  ds_read_b64 v[30:31], v39 offset:512
  ds_read_b64 v[32:33], v39 offset:1024
  s_add_u32 s75, s38, 23
  s_lshr_b32 s75, s75, 2
  s_sub_u32 s36, s75, 8
  s_max_i32 s36, s36, 0
  s_add_u32 s68, s38, 3
  s_lshr_b32 s68, s68, 2
  s_sub_u32 s69, s68, s59
  s_mov_b32 s59, s68
  s_add_u32 s35, s35, s69
  s_add_u32 s78, s78, s69
  v_mov_b32 v3, s69
  s_mov_b64 exec, 1
  ds_add_u32 v1, v3 offset:296
  ds_add_u32 v1, v3 offset:300
  s_mov_b64 exec, -1
  s_waitcnt lgkmcnt(0)
  v_sub_f32 v29, v29, v37
  v_sub_f32 v31, v31, v37
  v_sub_f32 v33, v33, v37
  v_mul_f32 v29, 0x3fb8aa3b, v29
  v_mul_f32 v31, 0x3fb8aa3b, v31
  v_mul_f32 v33, 0x3fb8aa3b, v33
  v_exp_f32 v29, v29
  v_exp_f32 v31, v31
  v_exp_f32 v33, v33
  s_nop 0
  v_cvt_pk_bf16_f32 v29, v29, v29
  v_cvt_pk_bf16_f32 v31, v31, v31
  v_cvt_pk_bf16_f32 v33, v33, v33
  s_branch L_vs2
L_work:
  s_cmp_eq_u32 s39, 4
  s_cbranch_scc1 L_w3
  s_cmp_eq_u32 s39, 3
  s_cbranch_scc1 L_w2b
  s_cmp_eq_u32 s39, 5
  s_cbranch_scc1 L_w5
  s_cmp_eq_u32 s39, 2
  s_cbranch_scc1 L_w2
  s_cmp_eq_u32 s39, 1
  s_cbranch_scc1 L_w1
L_w0:
  s_load_dwordx16 s[16:31], s[42:43], s40 glc
  s_mov_b32 s39, 1
L_wr:
  s_setpc_b64 s[100:101]
L_w1:
  s_waitcnt lgkmcnt(0)
  s_xor_b32 s68, s17, s74
  s_xor_b32 s69, s19, s74
  s_or_b32 s68, s68, s69
  s_xor_b32 s69, s21, s74
  s_or_b32 s68, s68, s69
  s_xor_b32 s69, s23, s74
  s_or_b32 s68, s68, s69
  s_xor_b32 s69, s25, s74
  s_or_b32 s68, s68, s69
  s_xor_b32 s69, s27, s74
  s_or_b32 s68, s68, s69
  s_xor_b32 s69, s29, s74
  s_or_b32 s68, s68, s69
  s_xor_b32 s69, s31, s74
  s_or_b32 s68, s68, s69
  s_cbranch_scc1 L_w0
  v_mov_b32 v8, s16
  v_mov_b32 v9, s18
  v_mov_b32 v10, s20
  v_mov_b32 v11, s22
  v_mov_b32 v12, s24
  v_mov_b32 v13, s26
  v_mov_b32 v14, s28
  v_mov_b32 v15, s30
  v_lshlrev_b32 v3, 5, s9
  s_mov_b64 exec, 1
  ds_write_b128 v3, v[8:11] offset:0
  ds_write_b128 v3, v[12:15] offset:16
  s_mov_b64 exec, -1
  s_mov_b32 s39, 2
L_w2:
  ds_read_b128 v[4:7], v38 offset:0
  s_waitcnt lgkmcnt(0)
  v_max3_u32 v8, v4, v5, v6
  v_max_u32 v8, v8, v7
  v_cmp_eq_u32 vcc, -1, v8
  s_cmp_lg_u64 vcc, 0
  s_cbranch_scc1 L_wr
  v_dot2_f32_bf16 v8, v40, v4, 0
  v_dot2_f32_bf16 v9, v44, v4, 0
  v_dot2_f32_bf16 v10, v48, v4, 0
  v_dot2_f32_bf16 v11, v52, v4, 0
  v_dot2_f32_bf16 v12, v56, v4, 0
  v_dot2_f32_bf16 v13, v60, v4, 0
  v_dot2_f32_bf16 v14, v64, v4, 0
  v_dot2_f32_bf16 v15, v68, v4, 0
  v_dot2_f32_bf16 v8, v41, v5, v8
  v_dot2_f32_bf16 v9, v45, v5, v9
  v_dot2_f32_bf16 v10, v49, v5, v10
  v_dot2_f32_bf16 v11, v53, v5, v11
  v_dot2_f32_bf16 v12, v57, v5, v12
  v_dot2_f32_bf16 v13, v61, v5, v13
  v_dot2_f32_bf16 v14, v65, v5, v14
  v_dot2_f32_bf16 v15, v69, v5, v15
  v_dot2_f32_bf16 v8, v42, v6, v8
  v_dot2_f32_bf16 v9, v46, v6, v9
  v_dot2_f32_bf16 v10, v50, v6, v10
  v_dot2_f32_bf16 v11, v54, v6, v11
  v_dot2_f32_bf16 v12, v58, v6, v12
  v_dot2_f32_bf16 v13, v62, v6, v13
  v_dot2_f32_bf16 v14, v66, v6, v14
  v_dot2_f32_bf16 v15, v70, v6, v15
  v_dot2_f32_bf16 v8, v43, v7, v8
  v_dot2_f32_bf16 v9, v47, v7, v9
  v_dot2_f32_bf16 v10, v51, v7, v10
  v_dot2_f32_bf16 v11, v55, v7, v11
  v_dot2_f32_bf16 v12, v59, v7, v12
  v_dot2_f32_bf16 v13, v63, v7, v13
  v_dot2_f32_bf16 v14, v67, v7, v14
  v_dot2_f32_bf16 v15, v71, v7, v15
  v_add_f32_dpp v8, v8, v8 row_ror:8 row_mask:0xf bank_mask:0x3
  v_add_f32_dpp v8, v9, v9 row_ror:8 row_mask:0xf bank_mask:0xc
  v_add_f32_dpp v10, v10, v10 row_ror:8 row_mask:0xf bank_mask:0x3
  v_add_f32_dpp v10, v11, v11 row_ror:8 row_mask:0xf bank_mask:0xc
  v_add_f32_dpp v12, v12, v12 row_ror:8 row_mask:0xf bank_mask:0x3
  v_add_f32_dpp v12, v13, v13 row_ror:8 row_mask:0xf bank_mask:0xc
  v_add_f32_dpp v14, v14, v14 row_ror:8 row_mask:0xf bank_mask:0x3
  v_add_f32_dpp v14, v15, v15 row_ror:8 row_mask:0xf bank_mask:0xc
  v_add_f32_dpp v16, v8, v8 row_shl:4 row_mask:0xf bank_mask:0x5
  v_add_f32_dpp v16, v10, v10 row_shr:4 row_mask:0xf bank_mask:0xa
  v_add_f32_dpp v17, v12, v12 row_shl:4 row_mask:0xf bank_mask:0x5
  v_add_f32_dpp v17, v14, v14 row_shr:4 row_mask:0xf bank_mask:0xa
  s_mov_b32 s39, 3
  s_mov_b32 s57, 17
  s_setpc_b64 s[100:101]
L_w2b:
  s_add_u32 s68, s41, 16
  s_cmp_lt_u32 s32, s68
  s_cbranch_scc1 L_wr
  v_dot2_f32_bf16 v8, v72, v4, 0
  v_dot2_f32_bf16 v9, v76, v4, 0
  v_dot2_f32_bf16 v10, v80, v4, 0
  v_dot2_f32_bf16 v11, v84, v4, 0
  v_dot2_f32_bf16 v12, v88, v4, 0
  v_dot2_f32_bf16 v13, v92, v4, 0
  v_dot2_f32_bf16 v14, v96, v4, 0
  v_dot2_f32_bf16 v15, v100, v4, 0
  v_dot2_f32_bf16 v8, v73, v5, v8
  v_dot2_f32_bf16 v9, v77, v5, v9
  v_dot2_f32_bf16 v10, v81, v5, v10
  v_dot2_f32_bf16 v11, v85, v5, v11
  v_dot2_f32_bf16 v12, v89, v5, v12
  v_dot2_f32_bf16 v13, v93, v5, v13
  v_dot2_f32_bf16 v14, v97, v5, v14
  v_dot2_f32_bf16 v15, v101, v5, v15
  v_dot2_f32_bf16 v8, v74, v6, v8
  v_dot2_f32_bf16 v9, v78, v6, v9
  v_dot2_f32_bf16 v10, v82, v6, v10
  v_dot2_f32_bf16 v11, v86, v6, v11
  v_dot2_f32_bf16 v12, v90, v6, v12
  v_dot2_f32_bf16 v13, v94, v6, v13
  v_dot2_f32_bf16 v14, v98, v6, v14
  v_dot2_f32_bf16 v15, v102, v6, v15
  v_dot2_f32_bf16 v8, v75, v7, v8
  v_dot2_f32_bf16 v9, v79, v7, v9
  v_dot2_f32_bf16 v10, v83, v7, v10
  v_dot2_f32_bf16 v11, v87, v7, v11
  v_dot2_f32_bf16 v12, v91, v7, v12
  v_dot2_f32_bf16 v13, v95, v7, v13
  v_dot2_f32_bf16 v14, v99, v7, v14
  v_dot2_f32_bf16 v15, v103, v7, v15
  v_add_f32_dpp v8, v8, v8 row_ror:8 row_mask:0xf bank_mask:0x3
  v_add_f32_dpp v8, v9, v9 row_ror:8 row_mask:0xf bank_mask:0xc
  v_add_f32_dpp v10, v10, v10 row_ror:8 row_mask:0xf bank_mask:0x3
  v_add_f32_dpp v10, v11, v11 row_ror:8 row_mask:0xf bank_mask:0xc
  v_add_f32_dpp v12, v12, v12 row_ror:8 row_mask:0xf bank_mask:0x3
  v_add_f32_dpp v12, v13, v13 row_ror:8 row_mask:0xf bank_mask:0xc
  v_add_f32_dpp v14, v14, v14 row_ror:8 row_mask:0xf bank_mask:0x3
  v_add_f32_dpp v14, v15, v15 row_ror:8 row_mask:0xf bank_mask:0xc
  v_add_f32_dpp v18, v8, v8 row_shl:4 row_mask:0xf bank_mask:0x5
  v_add_f32_dpp v18, v10, v10 row_shr:4 row_mask:0xf bank_mask:0xa
  v_add_f32_dpp v19, v12, v12 row_shl:4 row_mask:0xf bank_mask:0x5
  v_add_f32_dpp v19, v14, v14 row_shr:4 row_mask:0xf bank_mask:0xa
  v_mov_b32 v3, 0
  v_mov_b32 v20, 64
  v_add_f32_dpp v16, v16, v16 quad_perm:[2,3,0,1] row_mask:0xf bank_mask:0xf
  v_add_f32_dpp v17, v17, v17 quad_perm:[2,3,0,1] row_mask:0xf bank_mask:0xf
  v_add_f32_dpp v18, v18, v18 quad_perm:[2,3,0,1] row_mask:0xf bank_mask:0xf
  v_add_f32_dpp v19, v19, v19 quad_perm:[2,3,0,1] row_mask:0xf bank_mask:0xf
  v_cndmask_b32 v8, v16, v17, s[52:53]
  v_cndmask_b32 v9, v18, v19, s[52:53]
  s_nop 0
  v_lshlrev_b32 v21, 3, s9
  v_add_f32_dpp v8, v8, v8 quad_perm:[1,0,3,2] row_mask:0xf bank_mask:0xf
  v_add_f32_dpp v9, v9, v9 quad_perm:[1,0,3,2] row_mask:0xf bank_mask:0xf
  v_cndmask_b32 v25, v8, v9, s[54:55]
  v_cvt_pk_bf16_f32 v25, 0, v25
  v_mul_f32 v25, 0x3db504f3, v25
  v_cvt_pk_bf16_f32 v25, 0, v25
  v_mov_b32 v37, v25
  s_nop 1
  v_max_f32_dpp v37, v37, v37 row_ror:8 row_mask:0xf bank_mask:0xf
  s_nop 1
  v_max_f32_dpp v37, v37, v37 row_ror:4 row_mask:0xf bank_mask:0xf
  s_nop 1
  v_max_f32_dpp v37, v37, v37 row_ror:2 row_mask:0xf bank_mask:0xf
  s_nop 1
  v_max_f32_dpp v37, v37, v37 row_ror:1 row_mask:0xf bank_mask:0xf
  v_mov_b32 v8, v37
  s_nop 1
  v_permlane16_swap_b32 v8, v37
  v_max_f32 v37, v37, v8
  v_mov_b32 v8, v37
  s_nop 1
  v_permlane32_swap_b32 v8, v37
  v_max_f32 v37, v37, v8
  s_mov_b64 exec, 1
  ds_max_f32 v3, v37 offset:284
  ds_add_u32 v3, v20 offset:280
  s_mov_b64 exec, -1
  s_mov_b32 s39, 4
  s_mov_b32 s19, 0
  s_setpc_b64 s[100:101]
L_w5:
  s_add_u32 s68, s41, 24
  s_cmp_lt_u32 s32, s68
  s_cbranch_scc1 L_wr
  v_dot2_f32_bf16 v8, v104, v4, 0
  v_dot2_f32_bf16 v9, v108, v4, 0
  v_dot2_f32_bf16 v10, v112, v4, 0
  v_dot2_f32_bf16 v11, v116, v4, 0
  v_dot2_f32_bf16 v12, v120, v4, 0
  v_dot2_f32_bf16 v13, v124, v4, 0
  v_dot2_f32_bf16 v14, v128, v4, 0
  v_dot2_f32_bf16 v15, v132, v4, 0
  v_dot2_f32_bf16 v8, v105, v5, v8
  v_dot2_f32_bf16 v9, v109, v5, v9
  v_dot2_f32_bf16 v10, v113, v5, v10
  v_dot2_f32_bf16 v11, v117, v5, v11
  v_dot2_f32_bf16 v12, v121, v5, v12
  v_dot2_f32_bf16 v13, v125, v5, v13
  v_dot2_f32_bf16 v14, v129, v5, v14
  v_dot2_f32_bf16 v15, v133, v5, v15
  v_dot2_f32_bf16 v8, v106, v6, v8
  v_dot2_f32_bf16 v9, v110, v6, v9
  v_dot2_f32_bf16 v10, v114, v6, v10
  v_dot2_f32_bf16 v11, v118, v6, v11
  v_dot2_f32_bf16 v12, v122, v6, v12
  v_dot2_f32_bf16 v13, v126, v6, v13
  v_dot2_f32_bf16 v14, v130, v6, v14
  v_dot2_f32_bf16 v15, v134, v6, v15
  v_dot2_f32_bf16 v8, v107, v7, v8
  v_dot2_f32_bf16 v9, v111, v7, v9
  v_dot2_f32_bf16 v10, v115, v7, v10
  v_dot2_f32_bf16 v11, v119, v7, v11
  v_dot2_f32_bf16 v12, v123, v7, v12
  v_dot2_f32_bf16 v13, v127, v7, v13
  v_dot2_f32_bf16 v14, v131, v7, v14
  v_dot2_f32_bf16 v15, v135, v7, v15
  v_add_f32_dpp v8, v8, v8 row_ror:8 row_mask:0xf bank_mask:0x3
  v_add_f32_dpp v8, v9, v9 row_ror:8 row_mask:0xf bank_mask:0xc
  v_add_f32_dpp v10, v10, v10 row_ror:8 row_mask:0xf bank_mask:0x3
  v_add_f32_dpp v10, v11, v11 row_ror:8 row_mask:0xf bank_mask:0xc
  v_add_f32_dpp v12, v12, v12 row_ror:8 row_mask:0xf bank_mask:0x3
  v_add_f32_dpp v12, v13, v13 row_ror:8 row_mask:0xf bank_mask:0xc
  v_add_f32_dpp v14, v14, v14 row_ror:8 row_mask:0xf bank_mask:0x3
  v_add_f32_dpp v14, v15, v15 row_ror:8 row_mask:0xf bank_mask:0xc
  v_add_f32_dpp v16, v8, v8 row_shl:4 row_mask:0xf bank_mask:0x5
  v_add_f32_dpp v16, v10, v10 row_shr:4 row_mask:0xf bank_mask:0xa
  v_add_f32_dpp v17, v12, v12 row_shl:4 row_mask:0xf bank_mask:0x5
  v_add_f32_dpp v17, v14, v14 row_shr:4 row_mask:0xf bank_mask:0xa
  s_mov_b32 s39, 6
  s_mov_b32 s57, 99
  s_setpc_b64 s[100:101]
L_w3:
  v_mov_b32 v3, 0
  ds_read_b64 v[18:19], v3 offset:280
  s_waitcnt lgkmcnt(0)
  v_cmp_gt_u32 vcc, 0x102c0, v18
  s_cmp_lg_u64 vcc, 0
  s_cbranch_scc1 L_wr
  ds_read_b64 v[20:21], v3 offset:320
  s_waitcnt lgkmcnt(0)
  v_add_f32 v21, 0xc1c00000, v21
  v_cmp_nlt_f32 vcc, v25, v21
  v_readfirstlane_b32 s22, v21
  v_readfirstlane_b32 s23, v20
  s_mov_b32 s20, 0
  s_bcnt1_i32_b64 s68, vcc
  s_cmp_gt_u32 s68, 32
  s_cselect_b32 s21, 1, 0
  s_cbranch_scc1 L_w4
  s_mov_b32 s38, 160
  v_cmp_nlt_f32 vcc, v25, v21
  s_lshl_b32 s68, s38, 3
  s_add_u32 s68, s68, s56
  s_andn2_b64 s[70:71], vcc, s[64:65]
  v_mbcnt_lo_u32_b32 v3, s70, 0
  v_mbcnt_hi_u32_b32 v3, s71, v3
  s_bcnt1_i32_b64 s69, s[70:71]
  v_lshl_add_u32 v3, v3, 3, s68
  s_mov_b64 exec, s[70:71]
  ds_write_b64 v3, v[24:25]
  s_mov_b64 exec, -1
  s_or_b64 s[64:65], s[64:65], s[70:71]
  s_add_u32 s38, s38, s69
  s_mov_b32 s20, s69
  s_mov_b32 s38, 0
L_w4:
  v_add_f32 v21, 0xc2ac0000, v20
  v_cmp_nlt_f32 vcc, v25, v21
  s_lshl_b32 s68, s38, 3
  s_add_u32 s68, s68, s56
  s_andn2_b64 s[70:71], vcc, s[64:65]
  v_mbcnt_lo_u32_b32 v3, s70, 0
  v_mbcnt_hi_u32_b32 v3, s71, v3
  s_bcnt1_i32_b64 s69, s[70:71]
  v_lshl_add_u32 v3, v3, 3, s68
  s_mov_b64 exec, s[70:71]
  ds_write_b64 v3, v[24:25]
  s_mov_b64 exec, -1
  s_or_b64 s[64:65], s[64:65], s[70:71]
  s_add_u32 s38, s38, s69
  s_add_u32 s68, s38, 4
  s_lshr_b32 s68, s68, 1
  s_sub_u32 s69, s68, s59
  s_mov_b32 s59, s68
  v_mov_b32 v3, s69
  s_mov_b64 exec, 1
  ds_add_u32 v1, v3 offset:296
  ds_add_u32 v1, v3 offset:300
  s_mov_b64 exec, -1
  s_sub_i32 s68, s59, 20
  s_max_i32 s68, s68, -4
  s_mul_i32 s68, s68, 245
  s_add_i32 s34, s34, s68
  s_mov_b32 s39, 5
  s_mov_b32 s57, 25
  ds_read_b64 v[28:29], v39 offset:0
  s_waitcnt lgkmcnt(0)
  s_setpc_b64 s[100:101]
L_pub:
  s_getpc_b64 s[56:57]
L_pct:
  s_lshr_b32 s3, s2, 3
  s_lshl_b32 s3, s3, 2
  s_add_u32 s3, s3, L_touch-L_pct
  s_load_dword s14, s[56:57], s3
  s_waitcnt lgkmcnt(0)
  s_bfe_u32 s48, s14, 0x30000
  s_lshl_b32 s48, s48, 6
  v_add_u32 v2, s48, v1
  s_bfe_u32 s48, s14, 0x30003
  s_bitcmp1_b32 s14, 7
  s_cbranch_scc1 L_te_4
  s_bitcmp1_b32 s14, 6
  s_cbranch_scc1 L_tq_3
  s_lshl1_add_u32 s48, s8, s48
  s_lshl_b32 s48, s48, 7
  v_mul_u32_u24 v2, 6144, v2
  v_add_u32 v2, s48, v2
  global_load_dword v167, v2, s[36:37]
  s_branch L_te_4
L_tq_3:
  s_lshl3_add_u32 s48, s8, s48
  s_lshl_b32 s48, s48, 7
  v_lshl_add_u32 v2, v2, 13, s48
  global_load_dword v167, v2, s[22:23]
L_te_4:
  s_bfe_u32 s48, s14, 0x30008
  s_lshl_b32 s48, s48, 6
  v_add_u32 v2, s48, v1
  s_bfe_u32 s48, s14, 0x3000b
  s_bitcmp1_b32 s14, 15
  s_cbranch_scc1 L_te_6
  s_bitcmp1_b32 s14, 14
  s_cbranch_scc1 L_tq_5
  s_lshl1_add_u32 s48, s8, s48
  s_lshl_b32 s48, s48, 7
  v_mul_u32_u24 v2, 6144, v2
  v_add_u32 v2, s48, v2
  global_load_dword v167, v2, s[36:37]
  s_branch L_te_6
L_tq_5:
  s_lshl3_add_u32 s48, s8, s48
  s_lshl_b32 s48, s48, 7
  v_lshl_add_u32 v2, v2, 13, s48
  global_load_dword v167, v2, s[22:23]
L_te_6:
  v_mov_b32 v38, 0
  v_mov_b32 v4, -1
  v_mov_b32 v8, 0xff800000
  v_mov_b32 v9, 0
  v_lshlrev_b32 v2, 3, v1
  ds_write_b64 v2, v[8:9] offset:448
  v_mov_b32 v5, 0
  v_mov_b32 v6, 0
  v_mov_b32 v7, 0
  ds_write_b64 v2, v[6:7] offset:6144
  ds_write_b64 v2, v[6:7] offset:11776
  v_lshlrev_b32 v2, 2, v1
  ds_write_b32 v2, v4 offset:0
  s_lshr_b32 s10, s7, 1
  ds_write_b128 v38, v[4:7] offset:256
  v_lshlrev_b32 v10, 6, s10
  v_mov_b32 v11, v8
  v_mov_b32 v12, v10
  v_mov_b32 v13, v8
  ds_write_b128 v38, v[10:13] offset:272
  s_mul_i32 s11, s10, 29
  s_sub_u32 s11, 1343, s11
  v_mov_b32 v10, s11
  v_mov_b32 v11, 0
  v_mov_b32 v12, 1024
  v_mov_b32 v13, 0
  ds_write_b128 v38, v[10:13] offset:288
  v_mov_b32 v4, s10
  v_mov_b32 v5, s10
  ds_write_b128 v38, v[4:7] offset:304
  s_getreg_b32 s76, hwreg(HW_REG_XCC_ID, 0, 4)
  s_waitcnt lgkmcnt(0)
  s_load_dword s74, s[42:43], 0
  s_barrier
  s_waitcnt lgkmcnt(0)
  s_mul_i32 s74, s74, 0x9e3779b1
  s_add_u32 s74, s74, 0x7f4a7c15
  s_add_u32 s76, s76, s74
  s_add_u32 s52, s7, 1
  s_cmp_eq_u32 s52, 3
  s_cselect_b32 s52, 0, s52
  s_add_u32 s53, s52, s7
  s_sub_u32 s53, 3, s53
  s_lshl2_add_u32 s54, s6, s52
  s_lshl_b32 s54, s54, 7
  s_lshl2_add_u32 s55, s6, s53
  s_lshl_b32 s55, s55, 7
  s_lshl2_add_u32 s64, s6, s7
  s_lshl_b32 s64, s64, 7
  s_add_u32 s64, s64, 65536
  v_mov_b32 v18, s64
  v_add_u32 v19, 32768, v18
  v_mov_b32 v17, 0x10000
  s_lshl2_add_u32 s49, s6, s7
  s_lshl_b32 s49, s49, 9
  s_add_u32 s49, s49, 131072
  v_and_b32 v10, 3, v1
  v_lshl_add_u32 v10, v10, 7, s49
  v_bfe_u32 v11, v1, 2, 1
  v_mul_u32_u24 v11, 393216, v11
  v_add_u32 v10, v10, v11
  s_mov_b64 exec, 0xff
  global_load_dword v166, v10, s[42:43] sc1
  s_mov_b64 exec, 1
  global_load_dword v166, v18, s[42:43] sc1
  global_load_dword v166, v19, s[42:43] sc1
  s_mov_b64 exec, -1
  s_mov_b32 s70, 0
L_sn_7:
  ds_read_b64 v[8:9], v38 offset:280
  s_waitcnt lgkmcnt(0)
  v_cmp_gt_u32 vcc, 0x2c0, v8
  s_cmp_eq_u64 vcc, 0
  s_cbranch_scc1 L_snd_8
  s_sleep 2
  s_add_u32 s70, s70, 1
  s_cmp_lt_u32 s70, 2097152
  s_cbranch_scc1 L_sn_7
L_snd_8:
  s_load_dwordx2 s[20:21], s[42:43], s54 offset:65536 glc
  s_load_dwordx2 s[24:25], s[42:43], s55 offset:65536 glc
  v_mov_b32 v8, v9
  v_mov_b32 v9, s74
  s_mov_b64 exec, 1
  global_store_dwordx2 v18, v[8:9], s[42:43] sc1
  s_mov_b32 s70, 0
  s_branch L_s3ec
L_s3e:
  s_load_dwordx2 s[20:21], s[42:43], s54 offset:65536 glc
  s_load_dwordx2 s[24:25], s[42:43], s55 offset:65536 glc
L_s3ec:
  s_waitcnt lgkmcnt(0)
  s_xor_b32 s68, s21, s74
  s_xor_b32 s69, s25, s74
  s_or_b32 s68, s68, s69
  s_cbranch_scc0 L_s3ed
  s_sleep 2
  s_add_u32 s70, s70, 1
  s_cmp_lt_u32 s70, 262144
  s_cbranch_scc1 L_s3e
L_s3ed:
  v_mov_b32 v12, s20
  v_max3_f32 v10, v8, v12, s24
  v_min3_f32 v11, v8, v12, s24
  ds_write_b64 v38, v[10:11] offset:320
  ds_add_u32 v38, v17 offset:280
  s_mov_b64 exec, -1
  s_lshl_b32 s64, s8, 7
  s_load_dwordx8 s[20:27], s[42:43], s64 offset:1024 glc
  s_waitcnt lgkmcnt(0)
  s_xor_b32 s68, s20, s76
  s_xor_b32 s69, s21, s76
  s_or_b32 s68, s68, s69
  s_xor_b32 s69, s22, s76
  s_or_b32 s68, s68, s69
  s_xor_b32 s69, s23, s76
  s_or_b32 s68, s68, s69
  s_xor_b32 s69, s24, s76
  s_or_b32 s68, s68, s69
  s_xor_b32 s69, s25, s76
  s_or_b32 s68, s68, s69
  s_xor_b32 s69, s26, s76
  s_or_b32 s68, s68, s69
  s_xor_b32 s69, s27, s76
  s_or_b32 s68, s68, s69
  s_cselect_b32 s75, 0, 1
  v_lshlrev_b32 v20, 3, s7
  v_lshlrev_b32 v21, 3, s52
  v_lshlrev_b32 v22, 3, s53
  s_mov_b32 s70, 0
L_sn_9:
  ds_read_b32 v8, v38 offset:272
  s_waitcnt lgkmcnt(0)
  v_cmp_gt_u32 vcc, 0x2c0, v8
  s_cmp_eq_u64 vcc, 0
  s_cbranch_scc1 L_snd_10
  s_sleep 1
  s_add_u32 s70, s70, 1
  s_cmp_lt_u32 s70, 2097152
  s_cbranch_scc1 L_sn_9
L_snd_10:
  v_and_b32 v9, 15, v1
  v_lshlrev_b32 v9, 3, v9
  ds_read_b64 v[10:11], v9 offset:512
  s_waitcnt lgkmcnt(0)
  v_mov_b32 v16, v10
  v_max_f32_dpp v8, v10, v10 quad_perm:[1,0,3,2] row_mask:0xf bank_mask:0xf
  s_nop 1
  v_max_f32_dpp v8, v8, v8 quad_perm:[2,3,0,1] row_mask:0xf bank_mask:0xf
  s_nop 1
  v_max_f32_dpp v8, v8, v8 row_half_mirror row_mask:0xf bank_mask:0xf
  s_nop 1
  v_max_f32_dpp v8, v8, v8 row_mirror row_mask:0xf bank_mask:0xf
  v_sub_f32 v9, v10, v8
  v_mul_f32 v9, 0x3fb8aa3b, v9
  v_exp_f32 v9, v9
  s_nop 0
  v_mul_f32 v10, v9, v11
  s_nop 1
  v_add_f32_dpp v10, v10, v10 quad_perm:[1,0,3,2] row_mask:0xf bank_mask:0xf
  s_nop 1
  v_add_f32_dpp v10, v10, v10 quad_perm:[2,3,0,1] row_mask:0xf bank_mask:0xf
  s_nop 1
  v_add_f32_dpp v10, v10, v10 row_half_mirror row_mask:0xf bank_mask:0xf
  s_nop 1
  v_add_f32_dpp v10, v10, v10 row_mirror row_mask:0xf bank_mask:0xf
  s_load_dwordx4 s[20:23], s[42:43], s54 offset:98304 glc
  s_load_dwordx4 s[24:27], s[42:43], s55 offset:98304 glc
  v_mov_b32 v9, s74
  v_mov_b32 v11, s74
  s_mov_b64 exec, 1
  global_store_dwordx4 v19, v[8:11], s[42:43] sc1
  ds_write_b32 v20, v8 offset:448
  ds_write_b32 v20, v10 offset:452
  s_mov_b32 s70, 0
  s_branch L_s3pc
L_s3p:
  s_load_dwordx4 s[20:23], s[42:43], s54 offset:98304 glc
  s_load_dwordx4 s[24:27], s[42:43], s55 offset:98304 glc
L_s3pc:
  s_waitcnt lgkmcnt(0)
  s_xor_b32 s68, s21, s74
  s_xor_b32 s69, s23, s74
  s_or_b32 s68, s68, s69
  s_xor_b32 s69, s25, s74
  s_or_b32 s68, s68, s69
  s_xor_b32 s69, s27, s74
  s_or_b32 s68, s68, s69
  s_cbranch_scc0 L_s3pd
  s_sleep 2
  s_add_u32 s70, s70, 1
  s_cmp_lt_u32 s70, 262144
  s_cbranch_scc1 L_s3p
L_s3pd:
  v_mov_b32 v12, s20
  v_mov_b32 v13, s22
  v_mov_b32 v14, s24
  v_mov_b32 v15, s26
  v_max_f32 v23, v12, v14
  ds_max_f32 v38, v23 offset:276
  ds_add_u32 v38, v17 offset:272
  ds_add_u32 v38, v17 offset:300
  ds_write_b64 v21, v[12:13] offset:448
  ds_write_b64 v22, v[14:15] offset:448
  s_mov_b64 exec, -1
  v_and_b32 v9, 3, v1
  v_lshlrev_b32 v9, 3, v9
  ds_read_b64 v[10:11], v9 offset:448
  s_waitcnt lgkmcnt(0)
  v_max_f32_dpp v8, v10, v10 quad_perm:[1,0,3,2] row_mask:0xf bank_mask:0xf
  s_nop 1
  v_max_f32_dpp v8, v8, v8 quad_perm:[2,3,0,1] row_mask:0xf bank_mask:0xf
  v_sub_f32 v9, v10, v8
  v_mul_f32 v9, 0x3fb8aa3b, v9
  v_exp_f32 v9, v9
  s_nop 0
  v_mul_f32 v10, v9, v11
  s_nop 1
  v_add_f32_dpp v10, v10, v10 quad_perm:[1,0,3,2] row_mask:0xf bank_mask:0xf
  s_nop 1
  v_add_f32_dpp v10, v10, v10 quad_perm:[2,3,0,1] row_mask:0xf bank_mask:0xf
  v_sub_f32 v9, v16, v8
  v_rcp_f32 v10, v10
  v_mul_f32 v9, 0x3fb8aa3b, v9
  v_exp_f32 v9, v9
  v_lshlrev_b32 v8, 2, v1
  v_mul_f32 v9, v9, v10
  s_mov_b64 exec, 0xffff
  ds_write_b32 v8, v9 offset:384
  s_mov_b64 exec, -1
  ds_write_b32 v38, v38 offset:256
  ds_read_b128 v[62:65], v38 offset:384
  ds_read_b128 v[66:69], v38 offset:400
  ds_read_b128 v[70:73], v38 offset:416
  v_lshlrev_b32 v77, 3, v1
  s_lshl2_add_u32 s68, s6, s7
  s_lshl_b32 s68, s68, 9
  s_add_u32 s68, s68, 131072
  v_add_u32 v74, s68, v77
  v_and_b32 v75, 1, v1
  v_lshlrev_b32 v75, 4, v75
  v_lshrrev_b32 v75, v75, s74
  v_lshrrev_b32 v76, 8, v75
  s_mov_b32 s70, 0
L_sn_11:
  ds_read_b32 v8, v38 offset:304
  s_waitcnt lgkmcnt(0)
  v_cmp_gt_u32 vcc, 0xa, v8
  s_cmp_eq_u64 vcc, 0
  s_cbranch_scc1 L_snd_12
  s_sleep 1
  s_add_u32 s70, s70, 1
  s_cmp_lt_u32 s70, 2097152
  s_cbranch_scc1 L_sn_11
L_snd_12:
  s_mov_b32 s70, 0
L_wt_13:
  ds_read_b32 v8, v38 offset:304
  ds_read_b64 v[40:41], v77 offset:6656
  ds_read_b64 v[42:43], v77 offset:7168
  ds_read_b64 v[44:45], v77 offset:7680
  ds_read_b64 v[46:47], v77 offset:8192
  ds_read_b64 v[48:49], v77 offset:8704
  ds_read_b64 v[50:51], v77 offset:9216
  ds_read_b64 v[52:53], v77 offset:9728
  ds_read_b64 v[54:55], v77 offset:10240
  ds_read_b64 v[56:57], v77 offset:10752
  ds_read_b64 v[58:59], v77 offset:11264
  ds_read_b64 v[60:61], v77 offset:11776
  s_waitcnt lgkmcnt(11)
  v_cmp_gt_u32 vcc, 11, v8
  s_cmp_eq_u64 vcc, 0
  s_cbranch_scc1 L_wtd_14
  s_waitcnt lgkmcnt(0)
  s_add_u32 s70, s70, 1
  s_cmp_lt_u32 s70, 2097152
  s_cbranch_scc1 L_wt_13
L_wtd_14:
  s_movk_i32 s69, 0xff
  s_waitcnt lgkmcnt(10)
  v_pk_mul_f32 v[40:41], v[40:41], v[62:63] op_sel:[0,0] op_sel_hi:[1,0]
  s_waitcnt lgkmcnt(9)
  v_pk_mul_f32 v[42:43], v[42:43], v[62:63] op_sel:[0,1] op_sel_hi:[1,1]
  s_waitcnt lgkmcnt(8)
  v_pk_fma_f32 v[40:41], v[44:45], v[64:65], v[40:41] op_sel:[0,0,0] op_sel_hi:[1,0,1]
  s_waitcnt lgkmcnt(7)
  v_pk_fma_f32 v[42:43], v[46:47], v[64:65], v[42:43] op_sel:[0,1,0] op_sel_hi:[1,1,1]
  s_waitcnt lgkmcnt(6)
  v_pk_fma_f32 v[40:41], v[48:49], v[66:67], v[40:41] op_sel:[0,0,0] op_sel_hi:[1,0,1]
  s_waitcnt lgkmcnt(5)
  v_pk_fma_f32 v[42:43], v[50:51], v[66:67], v[42:43] op_sel:[0,1,0] op_sel_hi:[1,1,1]
  s_waitcnt lgkmcnt(4)
  v_pk_fma_f32 v[40:41], v[52:53], v[68:69], v[40:41] op_sel:[0,0,0] op_sel_hi:[1,0,1]
  s_waitcnt lgkmcnt(3)
  v_pk_fma_f32 v[42:43], v[54:55], v[68:69], v[42:43] op_sel:[0,1,0] op_sel_hi:[1,1,1]
  s_waitcnt lgkmcnt(2)
  v_pk_fma_f32 v[40:41], v[56:57], v[70:71], v[40:41] op_sel:[0,0,0] op_sel_hi:[1,0,1]
  s_waitcnt lgkmcnt(1)
  v_pk_fma_f32 v[42:43], v[58:59], v[70:71], v[42:43] op_sel:[0,1,0] op_sel_hi:[1,1,1]
  s_waitcnt lgkmcnt(0)
  v_pk_fma_f32 v[40:41], v[60:61], v[72:73], v[40:41] op_sel:[0,0,0] op_sel_hi:[1,0,1]
  v_pk_add_f32 v[40:41], v[40:41], v[42:43]
  v_bfi_b32 v40, s69, v75, v40
  v_bfi_b32 v41, s69, v76, v41
  s_cmp_eq_u32 s75, 1
  s_cbranch_scc0 L_pf_15
  global_store_dwordx2 v74, v[40:41], s[42:43]
  s_branch L_pe_16
L_pf_15:
  global_store_dwordx2 v74, v[40:41], s[42:43] sc1
L_pe_16:
  ds_read_b128 v[102:105], v38 offset:384
  ds_read_b128 v[106:109], v38 offset:400
  ds_read_b128 v[110:113], v38 offset:416
  v_lshlrev_b32 v117, 3, v1
  s_lshl2_add_u32 s68, s6, s7
  s_lshl_b32 s68, s68, 9
  s_add_u32 s68, s68, 524288
  v_add_u32 v114, s68, v117
  v_and_b32 v115, 1, v1
  v_lshlrev_b32 v115, 4, v115
  v_lshrrev_b32 v115, v115, s74
  v_lshrrev_b32 v116, 8, v115
  s_waitcnt vmcnt(0)
  s_mov_b32 s70, 0
L_sn_17:
  ds_read_b32 v8, v38 offset:308
  s_waitcnt lgkmcnt(0)
  v_cmp_gt_u32 vcc, 0x2, v8
  s_cmp_eq_u64 vcc, 0
  s_cbranch_scc1 L_snd_18
  s_sleep 4
  s_add_u32 s70, s70, 1
  s_cmp_lt_u32 s70, 2097152
  s_cbranch_scc1 L_sn_17
L_snd_18:
  global_store_dwordx2 v74, v[40:41], s[42:43] sc1
  s_cmp_eq_u32 s7, 2
  s_cbranch_scc1 L_chk
  s_mov_b32 s70, 0
L_sn_19:
  ds_read_b32 v8, v38 offset:308
  s_waitcnt lgkmcnt(0)
  v_cmp_gt_u32 vcc, 0xa, v8
  s_cmp_eq_u64 vcc, 0
  s_cbranch_scc1 L_snd_20
  s_sleep 1
  s_add_u32 s70, s70, 1
  s_cmp_lt_u32 s70, 2097152
  s_cbranch_scc1 L_sn_19
L_snd_20:
  s_mov_b32 s70, 0
L_wt_21:
  ds_read_b32 v8, v38 offset:308
  ds_read_b64 v[80:81], v117 offset:1024
  ds_read_b64 v[82:83], v117 offset:1536
  ds_read_b64 v[84:85], v117 offset:2048
  ds_read_b64 v[86:87], v117 offset:2560
  ds_read_b64 v[88:89], v117 offset:3072
  ds_read_b64 v[90:91], v117 offset:3584
  ds_read_b64 v[92:93], v117 offset:4096
  ds_read_b64 v[94:95], v117 offset:4608
  ds_read_b64 v[96:97], v117 offset:5120
  ds_read_b64 v[98:99], v117 offset:5632
  ds_read_b64 v[100:101], v117 offset:6144
  s_waitcnt lgkmcnt(11)
  v_cmp_gt_u32 vcc, 11, v8
  s_cmp_eq_u64 vcc, 0
  s_cbranch_scc1 L_wtd_22
  s_waitcnt lgkmcnt(0)
  s_add_u32 s70, s70, 1
  s_cmp_lt_u32 s70, 2097152
  s_cbranch_scc1 L_wt_21
L_wtd_22:
  s_movk_i32 s69, 0xff
  s_waitcnt lgkmcnt(10)
  v_pk_mul_f32 v[80:81], v[80:81], v[102:103] op_sel:[0,0] op_sel_hi:[1,0]
  s_waitcnt lgkmcnt(9)
  v_pk_mul_f32 v[82:83], v[82:83], v[102:103] op_sel:[0,1] op_sel_hi:[1,1]
  s_waitcnt lgkmcnt(8)
  v_pk_fma_f32 v[80:81], v[84:85], v[104:105], v[80:81] op_sel:[0,0,0] op_sel_hi:[1,0,1]
  s_waitcnt lgkmcnt(7)
  v_pk_fma_f32 v[82:83], v[86:87], v[104:105], v[82:83] op_sel:[0,1,0] op_sel_hi:[1,1,1]
  s_waitcnt lgkmcnt(6)
  v_pk_fma_f32 v[80:81], v[88:89], v[106:107], v[80:81] op_sel:[0,0,0] op_sel_hi:[1,0,1]
  s_waitcnt lgkmcnt(5)
  v_pk_fma_f32 v[82:83], v[90:91], v[106:107], v[82:83] op_sel:[0,1,0] op_sel_hi:[1,1,1]
  s_waitcnt lgkmcnt(4)
  v_pk_fma_f32 v[80:81], v[92:93], v[108:109], v[80:81] op_sel:[0,0,0] op_sel_hi:[1,0,1]
  s_waitcnt lgkmcnt(3)
  v_pk_fma_f32 v[82:83], v[94:95], v[108:109], v[82:83] op_sel:[0,1,0] op_sel_hi:[1,1,1]
  s_waitcnt lgkmcnt(2)
  v_pk_fma_f32 v[80:81], v[96:97], v[110:111], v[80:81] op_sel:[0,0,0] op_sel_hi:[1,0,1]
  s_waitcnt lgkmcnt(1)
  v_pk_fma_f32 v[82:83], v[98:99], v[110:111], v[82:83] op_sel:[0,1,0] op_sel_hi:[1,1,1]
  s_waitcnt lgkmcnt(0)
  v_pk_fma_f32 v[80:81], v[100:101], v[112:113], v[80:81] op_sel:[0,0,0] op_sel_hi:[1,0,1]
  v_pk_add_f32 v[80:81], v[80:81], v[82:83]
  v_bfi_b32 v80, s69, v115, v80
  v_bfi_b32 v81, s69, v116, v81
  global_store_dwordx2 v114, v[80:81], s[42:43] sc1
  s_branch L_fin
L_chk:
  v_and_b32 v160, 0xff, v75
  v_and_b32 v161, 0xff, v76
  s_lshl_b32 s10, s6, 11
  s_add_u32 s10, s10, 131072
  v_lshl_add_u32 v2, v1, 3, s10
  global_load_dwordx2 v[154:155], v2, s[42:43] offset:0 sc1
  global_load_dwordx2 v[156:157], v2, s[42:43] offset:512 sc1
  v_add_u32 v3, 393216, v2
  s_mov_b32 s70, 0
L_sn_23:
  ds_read_b32 v8, v38 offset:308
  s_waitcnt lgkmcnt(0)
  v_cmp_gt_u32 vcc, 0xa, v8
  s_cmp_eq_u64 vcc, 0
  s_cbranch_scc1 L_snd_24
  s_sleep 1
  s_add_u32 s70, s70, 1
  s_cmp_lt_u32 s70, 2097152
  s_cbranch_scc1 L_sn_23
L_snd_24:
  s_mov_b32 s70, 0
L_wt_25:
  ds_read_b32 v8, v38 offset:308
  ds_read_b64 v[80:81], v117 offset:1024
  ds_read_b64 v[82:83], v117 offset:1536
  ds_read_b64 v[84:85], v117 offset:2048
  ds_read_b64 v[86:87], v117 offset:2560
  ds_read_b64 v[88:89], v117 offset:3072
  ds_read_b64 v[90:91], v117 offset:3584
  ds_read_b64 v[92:93], v117 offset:4096
  ds_read_b64 v[94:95], v117 offset:4608
  ds_read_b64 v[96:97], v117 offset:5120
  ds_read_b64 v[98:99], v117 offset:5632
  ds_read_b64 v[100:101], v117 offset:6144
  s_waitcnt lgkmcnt(11)
  v_cmp_gt_u32 vcc, 11, v8
  s_cmp_eq_u64 vcc, 0
  s_cbranch_scc1 L_wtd_26
  s_waitcnt lgkmcnt(0)
  s_add_u32 s70, s70, 1
  s_cmp_lt_u32 s70, 2097152
  s_cbranch_scc1 L_wt_25
L_wtd_26:
  global_load_dwordx2 v[130:131], v3, s[42:43] offset:0 sc1
  global_load_dwordx2 v[132:133], v3, s[42:43] offset:512 sc1
  s_movk_i32 s69, 0xff
  s_waitcnt lgkmcnt(10)
  v_pk_mul_f32 v[80:81], v[80:81], v[102:103] op_sel:[0,0] op_sel_hi:[1,0]
  s_waitcnt lgkmcnt(9)
  v_pk_mul_f32 v[82:83], v[82:83], v[102:103] op_sel:[0,1] op_sel_hi:[1,1]
  s_waitcnt lgkmcnt(8)
  v_pk_fma_f32 v[80:81], v[84:85], v[104:105], v[80:81] op_sel:[0,0,0] op_sel_hi:[1,0,1]
  s_waitcnt lgkmcnt(7)
  v_pk_fma_f32 v[82:83], v[86:87], v[104:105], v[82:83] op_sel:[0,1,0] op_sel_hi:[1,1,1]
  s_waitcnt lgkmcnt(6)
  v_pk_fma_f32 v[80:81], v[88:89], v[106:107], v[80:81] op_sel:[0,0,0] op_sel_hi:[1,0,1]
  s_waitcnt lgkmcnt(5)
  v_pk_fma_f32 v[82:83], v[90:91], v[106:107], v[82:83] op_sel:[0,1,0] op_sel_hi:[1,1,1]
  s_waitcnt lgkmcnt(4)
  v_pk_fma_f32 v[80:81], v[92:93], v[108:109], v[80:81] op_sel:[0,0,0] op_sel_hi:[1,0,1]
  s_waitcnt lgkmcnt(3)
  v_pk_fma_f32 v[82:83], v[94:95], v[108:109], v[82:83] op_sel:[0,1,0] op_sel_hi:[1,1,1]
  s_waitcnt lgkmcnt(2)
  v_pk_fma_f32 v[80:81], v[96:97], v[110:111], v[80:81] op_sel:[0,0,0] op_sel_hi:[1,0,1]
  s_waitcnt lgkmcnt(1)
  v_pk_fma_f32 v[82:83], v[98:99], v[110:111], v[82:83] op_sel:[0,1,0] op_sel_hi:[1,1,1]
  s_waitcnt lgkmcnt(0)
  v_pk_fma_f32 v[80:81], v[100:101], v[112:113], v[80:81] op_sel:[0,0,0] op_sel_hi:[1,0,1]
  v_pk_add_f32 v[80:81], v[80:81], v[82:83]
  v_bfi_b32 v80, s69, v115, v80
  v_bfi_b32 v81, s69, v116, v81
  global_store_dwordx2 v114, v[80:81], s[42:43] sc1
  s_waitcnt vmcnt(1)
  s_mov_b32 s70, 0
  s_branch L_cp0c
L_cp0:
  global_load_dwordx2 v[154:155], v2, s[42:43] offset:0 sc1
  global_load_dwordx2 v[156:157], v2, s[42:43] offset:512 sc1
  s_sleep 4
  s_waitcnt vmcnt(0)
L_cp0c:
  v_xor_b32 v136, v154, v160
  v_xor_b32 v137, v155, v161
  v_xor_b32 v138, v156, v160
  v_xor_b32 v139, v157, v161
  v_xor_b32 v140, v40, v160
  v_xor_b32 v141, v41, v161
  v_or3_b32 v152, v136, v137, v138
  v_or3_b32 v153, v139, v140, v141
  v_or_b32 v136, 0x80, v136
  v_or_b32 v137, 0x80, v137
  v_or_b32 v138, 0x80, v138
  v_or_b32 v139, 0x80, v139
  v_or_b32 v140, 0x80, v140
  v_or_b32 v141, 0x80, v141
  v_or_b32 v152, v152, v153
  v_pk_add_f32 v[136:137], v[136:137], v[138:139]
  v_lshlrev_b32 v152, 24, v152
  v_pk_add_f32 v[136:137], v[136:137], v[140:141]
  v_cmp_ne_u32 vcc, 0, v152
  v_cvt_pk_bf16_f32 v136, v136, v137
  s_cmp_eq_u64 vcc, 0
  s_cbranch_scc1 L_cp0d
  s_add_u32 s70, s70, 1
  s_cmp_lt_u32 s70, 262144
  s_cbranch_scc1 L_cp0
L_cp0d:
  v_add_u32 v2, 393216, v2
  s_mov_b32 s70, 0
  s_branch L_cp1c
L_cp1:
  global_load_dwordx2 v[130:131], v2, s[42:43] offset:0 sc1
  global_load_dwordx2 v[132:133], v2, s[42:43] offset:512 sc1
  s_waitcnt vmcnt(0)
L_cp1c:
  v_xor_b32 v144, v130, v160
  v_xor_b32 v145, v131, v161
  v_xor_b32 v146, v132, v160
  v_xor_b32 v147, v133, v161
  v_xor_b32 v148, v80, v160
  v_xor_b32 v149, v81, v161
  v_or3_b32 v152, v144, v145, v146
  v_or3_b32 v153, v147, v148, v149
  v_or_b32 v144, 0x80, v144
  v_or_b32 v145, 0x80, v145
  v_or_b32 v146, 0x80, v146
  v_or_b32 v147, 0x80, v147
  v_or_b32 v148, 0x80, v148
  v_or_b32 v149, 0x80, v149
  v_or_b32 v152, v152, v153
  v_pk_add_f32 v[144:145], v[144:145], v[146:147]
  v_lshlrev_b32 v152, 24, v152
  v_pk_add_f32 v[144:145], v[144:145], v[148:149]
  v_cmp_ne_u32 vcc, 0, v152
  v_cvt_pk_bf16_f32 v144, v144, v145
  s_cmp_eq_u64 vcc, 0
  s_cbranch_scc1 L_cp1d
  s_add_u32 s70, s70, 1
  s_cmp_lt_u32 s70, 262144
  s_cbranch_scc1 L_cp1
L_cp1d:
  v_cmp_ne_u32 vcc, v136, v144
  s_cmp_eq_u64 vcc, 0
  s_cbranch_scc1 L_fin
  s_waitcnt vmcnt(0)
L_slow:
  s_mov_b32 s47, 0x20000
  s_load_dwordx16 s[16:31], s[0:1], 0
  s_load_dwordx8 s[32:39], s[0:1], 64
  v_and_b32 v2, 31, v1
  v_lshlrev_b32 v2, 7, v2
  v_add_u32 v2, 28672, v2
  s_mov_b32 s70, 0
L_sl_d:
  global_load_dword v3, v2, s[42:43] sc1
  s_waitcnt vmcnt(0) lgkmcnt(0)
  v_cmp_ne_u32 vcc, s74, v3
  s_cmp_eq_u64 vcc, 0
  s_cbranch_scc1 L_sl_dd
  s_sleep 8
  s_add_u32 s70, s70, 1
  s_cmp_lt_u32 s70, 262144
  s_cbranch_scc1 L_sl_d
L_sl_dd:
  v_lshlrev_b32 v2, 3, v1
  v_add_u32 v2, 524288, v2
  v_lshlrev_b32 v0, 2, v1
  v_add_u32 v0, 12288, v0
  s_mov_b32 s10, 0
L_sl_h:
  s_mov_b32 s70, 0
L_sl_hp:
  global_load_dwordx2 v[40:41], v2, s[42:43] offset:0 sc1
  global_load_dwordx2 v[42:43], v2, s[42:43] offset:512 sc1
  global_load_dwordx2 v[44:45], v2, s[42:43] offset:1024 sc1
  s_waitcnt vmcnt(0)
  v_xor_b32 v40, v40, v160
  v_xor_b32 v41, v41, v161
  v_xor_b32 v42, v42, v160
  v_xor_b32 v43, v43, v161
  v_xor_b32 v44, v44, v160
  v_xor_b32 v45, v45, v161
  v_or3_b32 v48, v40, v41, v42
  v_or3_b32 v49, v43, v44, v45
  v_or_b32 v40, 0x80, v40
  v_or_b32 v41, 0x80, v41
  v_or_b32 v42, 0x80, v42
  v_or_b32 v43, 0x80, v43
  v_or_b32 v44, 0x80, v44
  v_or_b32 v45, 0x80, v45
  v_or_b32 v48, v48, v49
  v_pk_add_f32 v[40:41], v[40:41], v[42:43]
  v_lshlrev_b32 v48, 24, v48
  v_pk_add_f32 v[40:41], v[40:41], v[44:45]
  v_cmp_ne_u32 vcc, 0, v48
  v_cvt_pk_bf16_f32 v40, v40, v41
  s_cmp_eq_u64 vcc, 0
  s_cbranch_scc1 L_sl_hd
  s_sleep 8
  s_add_u32 s70, s70, 1
  s_cmp_lt_u32 s70, 262144
  s_cbranch_scc1 L_sl_hp
L_sl_hd:
  ds_write_b32 v0, v40
  v_add_u32 v2, 2048, v2
  v_add_u32 v0, 256, v0
  s_add_u32 s10, s10, 1
  s_cmp_lt_u32 s10, 64
  s_cbranch_scc1 L_sl_h
  s_mov_b32 s44, s24
  s_mov_b32 s45, s25
  s_mov_b32 s46, 4194304
  s_mov_b32 s11, 1024
  s_mov_b32 s12, 4194304
  v_mov_b32 v4, 12288
  v_mov_b32 v5, 20480
  v_lshlrev_b32 v2, 4, v1
  s_call_b64 s[62:63], L_gv
  v_lshlrev_b32 v0, 4, v1
  global_load_dwordx4 v[40:43], v0, s[16:17] offset:0
  global_load_dwordx4 v[44:47], v0, s[16:17] offset:1024
  s_waitcnt vmcnt(0)
  v_lshlrev_b32 v104, 16, v40
  v_and_b32 v105, s73, v40
  v_lshlrev_b32 v106, 16, v41
  v_and_b32 v107, s73, v41
  v_lshlrev_b32 v108, 16, v42
  v_and_b32 v109, s73, v42
  v_lshlrev_b32 v110, 16, v43
  v_and_b32 v111, s73, v43
  v_lshlrev_b32 v112, 16, v44
  v_and_b32 v113, s73, v44
  v_lshlrev_b32 v114, 16, v45
  v_and_b32 v115, s73, v45
  v_lshlrev_b32 v116, 16, v46
  v_and_b32 v117, s73, v46
  v_lshlrev_b32 v118, 16, v47
  v_and_b32 v119, s73, v47
  v_lshrrev_b32 v2, 1, v1
  v_lshlrev_b32 v2, 7, v2
  v_and_b32 v3, 1, v1
  v_lshl_add_u32 v2, v3, 5, v2
  v_add_u32 v2, 12288, v2
  global_load_dwordx4 v[40:43], v2, s[42:43] offset:0 sc1
  global_load_dwordx4 v[44:47], v2, s[42:43] offset:16 sc1
  global_load_dwordx4 v[48:51], v2, s[42:43] offset:64 sc1
  global_load_dwordx4 v[52:55], v2, s[42:43] offset:80 sc1
  s_waitcnt vmcnt(0)
  v_lshlrev_b32 v88, 16, v40
  v_and_b32 v89, s73, v40
  v_lshlrev_b32 v90, 16, v42
  v_and_b32 v91, s73, v42
  v_lshlrev_b32 v92, 16, v44
  v_and_b32 v93, s73, v44
  v_lshlrev_b32 v94, 16, v46
  v_and_b32 v95, s73, v46
  v_lshlrev_b32 v96, 16, v48
  v_and_b32 v97, s73, v48
  v_lshlrev_b32 v98, 16, v50
  v_and_b32 v99, s73, v50
  v_lshlrev_b32 v100, 16, v52
  v_and_b32 v101, s73, v52
  v_lshlrev_b32 v102, 16, v54
  v_and_b32 v103, s73, v54
  v_cvt_pk_bf16_f32 v72, 0, v72
  v_cvt_pk_bf16_f32 v73, 0, v73
  v_cvt_pk_bf16_f32 v74, 0, v74
  v_cvt_pk_bf16_f32 v75, 0, v75
  v_cvt_pk_bf16_f32 v76, 0, v76
  v_cvt_pk_bf16_f32 v77, 0, v77
  v_cvt_pk_bf16_f32 v78, 0, v78
  v_cvt_pk_bf16_f32 v79, 0, v79
  v_cvt_pk_bf16_f32 v80, 0, v80
  v_cvt_pk_bf16_f32 v81, 0, v81
  v_cvt_pk_bf16_f32 v82, 0, v82
  v_cvt_pk_bf16_f32 v83, 0, v83
  v_cvt_pk_bf16_f32 v84, 0, v84
  v_cvt_pk_bf16_f32 v85, 0, v85
  v_cvt_pk_bf16_f32 v86, 0, v86
  v_cvt_pk_bf16_f32 v87, 0, v87
  v_mul_f32 v72, v72, v88
  v_mul_f32 v73, v73, v89
  v_mul_f32 v74, v74, v90
  v_mul_f32 v75, v75, v91
  v_mul_f32 v76, v76, v92
  v_mul_f32 v77, v77, v93
  v_mul_f32 v78, v78, v94
  v_mul_f32 v79, v79, v95
  v_mul_f32 v80, v80, v96
  v_mul_f32 v81, v81, v97
  v_mul_f32 v82, v82, v98
  v_mul_f32 v83, v83, v99
  v_mul_f32 v84, v84, v100
  v_mul_f32 v85, v85, v101
  v_mul_f32 v86, v86, v102
  v_mul_f32 v87, v87, v103
  v_cvt_pk_bf16_f32 v72, 0, v72
  v_cvt_pk_bf16_f32 v73, 0, v73
  v_cvt_pk_bf16_f32 v74, 0, v74
  v_cvt_pk_bf16_f32 v75, 0, v75
  v_cvt_pk_bf16_f32 v76, 0, v76
  v_cvt_pk_bf16_f32 v77, 0, v77
  v_cvt_pk_bf16_f32 v78, 0, v78
  v_cvt_pk_bf16_f32 v79, 0, v79
  v_cvt_pk_bf16_f32 v80, 0, v80
  v_cvt_pk_bf16_f32 v81, 0, v81
  v_cvt_pk_bf16_f32 v82, 0, v82
  v_cvt_pk_bf16_f32 v83, 0, v83
  v_cvt_pk_bf16_f32 v84, 0, v84
  v_cvt_pk_bf16_f32 v85, 0, v85
  v_cvt_pk_bf16_f32 v86, 0, v86
  v_cvt_pk_bf16_f32 v87, 0, v87
  v_add_f32 v104, v104, v72
  v_add_f32 v105, v105, v73
  v_add_f32 v106, v106, v74
  v_add_f32 v107, v107, v75
  v_add_f32 v108, v108, v76
  v_add_f32 v109, v109, v77
  v_add_f32 v110, v110, v78
  v_add_f32 v111, v111, v79
  v_add_f32 v112, v112, v80
  v_add_f32 v113, v113, v81
  v_add_f32 v114, v114, v82
  v_add_f32 v115, v115, v83
  v_add_f32 v116, v116, v84
  v_add_f32 v117, v117, v85
  v_add_f32 v118, v118, v86
  v_add_f32 v119, v119, v87
  v_cvt_pk_bf16_f32 v104, 0, v104
  v_cvt_pk_bf16_f32 v105, 0, v105
  v_cvt_pk_bf16_f32 v106, 0, v106
  v_cvt_pk_bf16_f32 v107, 0, v107
  v_cvt_pk_bf16_f32 v108, 0, v108
  v_cvt_pk_bf16_f32 v109, 0, v109
  v_cvt_pk_bf16_f32 v110, 0, v110
  v_cvt_pk_bf16_f32 v111, 0, v111
  v_cvt_pk_bf16_f32 v112, 0, v112
  v_cvt_pk_bf16_f32 v113, 0, v113
  v_cvt_pk_bf16_f32 v114, 0, v114
  v_cvt_pk_bf16_f32 v115, 0, v115
  v_cvt_pk_bf16_f32 v116, 0, v116
  v_cvt_pk_bf16_f32 v117, 0, v117
  v_cvt_pk_bf16_f32 v118, 0, v118
  v_cvt_pk_bf16_f32 v119, 0, v119
  v_add_f32 v8, v104, v105
  v_add_f32 v8, v8, v106
  v_add_f32 v8, v8, v107
  v_add_f32 v8, v8, v108
  v_add_f32 v8, v8, v109
  v_add_f32 v8, v8, v110
  v_add_f32 v8, v8, v111
  s_nop 1
  v_add_f32_dpp v8, v8, v8 row_ror:8 row_mask:0xf bank_mask:0xf
  s_nop 1
  v_add_f32_dpp v8, v8, v8 row_ror:4 row_mask:0xf bank_mask:0xf
  s_nop 1
  v_add_f32_dpp v8, v8, v8 row_ror:2 row_mask:0xf bank_mask:0xf
  s_nop 1
  v_add_f32_dpp v8, v8, v8 row_ror:1 row_mask:0xf bank_mask:0xf
  v_mov_b32 v9, v8
  s_nop 1
  v_permlane16_swap_b32 v9, v8
  v_add_f32 v8, v8, v9
  v_mov_b32 v9, v8
  s_nop 1
  v_permlane32_swap_b32 v9, v8
  v_add_f32 v8, v8, v9
  v_mul_f32 v8, 0x3b000000, v8
  v_sub_f32 v72, v104, v8
  v_sub_f32 v73, v105, v8
  v_sub_f32 v74, v106, v8
  v_sub_f32 v75, v107, v8
  v_sub_f32 v76, v108, v8
  v_sub_f32 v77, v109, v8
  v_sub_f32 v78, v110, v8
  v_sub_f32 v79, v111, v8
  v_mul_f32 v10, v72, v72
  v_fmac_f32 v10, v73, v73
  v_fmac_f32 v10, v74, v74
  v_fmac_f32 v10, v75, v75
  v_fmac_f32 v10, v76, v76
  v_fmac_f32 v10, v77, v77
  v_fmac_f32 v10, v78, v78
  v_fmac_f32 v10, v79, v79
  s_nop 1
  v_add_f32_dpp v10, v10, v10 row_ror:8 row_mask:0xf bank_mask:0xf
  s_nop 1
  v_add_f32_dpp v10, v10, v10 row_ror:4 row_mask:0xf bank_mask:0xf
  s_nop 1
  v_add_f32_dpp v10, v10, v10 row_ror:2 row_mask:0xf bank_mask:0xf
  s_nop 1
  v_add_f32_dpp v10, v10, v10 row_ror:1 row_mask:0xf bank_mask:0xf
  v_mov_b32 v9, v10
  s_nop 1
  v_permlane16_swap_b32 v9, v10
  v_add_f32 v10, v10, v9
  v_mov_b32 v9, v10
  s_nop 1
  v_permlane32_swap_b32 v9, v10
  v_add_f32 v10, v10, v9
  v_mul_f32 v10, 0x3b000000, v10
  v_cvt_pk_bf16_f32 v8, 0, v8
  v_cvt_pk_bf16_f32 v10, 0, v10
  v_add_f32 v10, 0x3727c5ac, v10
  v_cvt_pk_bf16_f32 v10, 0, v10
  v_sqrt_f32 v10, v10
  v_sub_f32 v72, v104, v8
  v_sub_f32 v73, v105, v8
  v_sub_f32 v74, v106, v8
  v_sub_f32 v75, v107, v8
  v_sub_f32 v76, v108, v8
  v_sub_f32 v77, v109, v8
  v_sub_f32 v78, v110, v8
  v_sub_f32 v79, v111, v8
  v_cvt_pk_bf16_f32 v10, 0, v10
  v_cvt_pk_bf16_f32 v72, 0, v72
  v_cvt_pk_bf16_f32 v73, 0, v73
  v_cvt_pk_bf16_f32 v74, 0, v74
  v_cvt_pk_bf16_f32 v75, 0, v75
  v_cvt_pk_bf16_f32 v76, 0, v76
  v_cvt_pk_bf16_f32 v77, 0, v77
  v_cvt_pk_bf16_f32 v78, 0, v78
  v_cvt_pk_bf16_f32 v79, 0, v79
  v_rcp_f32 v10, v10
  s_nop 0
  v_mul_f32 v72, v72, v10
  v_mul_f32 v73, v73, v10
  v_mul_f32 v74, v74, v10
  v_mul_f32 v75, v75, v10
  v_mul_f32 v76, v76, v10
  v_mul_f32 v77, v77, v10
  v_mul_f32 v78, v78, v10
  v_mul_f32 v79, v79, v10
  v_cvt_pk_bf16_f32 v72, 0, v72
  v_cvt_pk_bf16_f32 v73, 0, v73
  v_cvt_pk_bf16_f32 v74, 0, v74
  v_cvt_pk_bf16_f32 v75, 0, v75
  v_cvt_pk_bf16_f32 v76, 0, v76
  v_cvt_pk_bf16_f32 v77, 0, v77
  v_cvt_pk_bf16_f32 v78, 0, v78
  v_cvt_pk_bf16_f32 v79, 0, v79
  v_add_f32 v8, v112, v113
  v_add_f32 v8, v8, v114
  v_add_f32 v8, v8, v115
  v_add_f32 v8, v8, v116
  v_add_f32 v8, v8, v117
  v_add_f32 v8, v8, v118
  v_add_f32 v8, v8, v119
  s_nop 1
  v_add_f32_dpp v8, v8, v8 row_ror:8 row_mask:0xf bank_mask:0xf
  s_nop 1
  v_add_f32_dpp v8, v8, v8 row_ror:4 row_mask:0xf bank_mask:0xf
  s_nop 1
  v_add_f32_dpp v8, v8, v8 row_ror:2 row_mask:0xf bank_mask:0xf
  s_nop 1
  v_add_f32_dpp v8, v8, v8 row_ror:1 row_mask:0xf bank_mask:0xf
  v_mov_b32 v9, v8
  s_nop 1
  v_permlane16_swap_b32 v9, v8
  v_add_f32 v8, v8, v9
  v_mov_b32 v9, v8
  s_nop 1
  v_permlane32_swap_b32 v9, v8
  v_add_f32 v8, v8, v9
  v_mul_f32 v8, 0x3b000000, v8
  v_sub_f32 v80, v112, v8
  v_sub_f32 v81, v113, v8
  v_sub_f32 v82, v114, v8
  v_sub_f32 v83, v115, v8
  v_sub_f32 v84, v116, v8
  v_sub_f32 v85, v117, v8
  v_sub_f32 v86, v118, v8
  v_sub_f32 v87, v119, v8
  v_mul_f32 v10, v80, v80
  v_fmac_f32 v10, v81, v81
  v_fmac_f32 v10, v82, v82
  v_fmac_f32 v10, v83, v83
  v_fmac_f32 v10, v84, v84
  v_fmac_f32 v10, v85, v85
  v_fmac_f32 v10, v86, v86
  v_fmac_f32 v10, v87, v87
  s_nop 1
  v_add_f32_dpp v10, v10, v10 row_ror:8 row_mask:0xf bank_mask:0xf
  s_nop 1
  v_add_f32_dpp v10, v10, v10 row_ror:4 row_mask:0xf bank_mask:0xf
  s_nop 1
  v_add_f32_dpp v10, v10, v10 row_ror:2 row_mask:0xf bank_mask:0xf
  s_nop 1
  v_add_f32_dpp v10, v10, v10 row_ror:1 row_mask:0xf bank_mask:0xf
  v_mov_b32 v9, v10
  s_nop 1
  v_permlane16_swap_b32 v9, v10
  v_add_f32 v10, v10, v9
  v_mov_b32 v9, v10
  s_nop 1
  v_permlane32_swap_b32 v9, v10
  v_add_f32 v10, v10, v9
  v_mul_f32 v10, 0x3b000000, v10
  v_cvt_pk_bf16_f32 v8, 0, v8
  v_cvt_pk_bf16_f32 v10, 0, v10
  v_add_f32 v10, 0x3727c5ac, v10
  v_cvt_pk_bf16_f32 v10, 0, v10
  v_sqrt_f32 v10, v10
  v_sub_f32 v80, v112, v8
  v_sub_f32 v81, v113, v8
  v_sub_f32 v82, v114, v8
  v_sub_f32 v83, v115, v8
  v_sub_f32 v84, v116, v8
  v_sub_f32 v85, v117, v8
  v_sub_f32 v86, v118, v8
  v_sub_f32 v87, v119, v8
  v_cvt_pk_bf16_f32 v10, 0, v10
  v_cvt_pk_bf16_f32 v80, 0, v80
  v_cvt_pk_bf16_f32 v81, 0, v81
  v_cvt_pk_bf16_f32 v82, 0, v82
  v_cvt_pk_bf16_f32 v83, 0, v83
  v_cvt_pk_bf16_f32 v84, 0, v84
  v_cvt_pk_bf16_f32 v85, 0, v85
  v_cvt_pk_bf16_f32 v86, 0, v86
  v_cvt_pk_bf16_f32 v87, 0, v87
  v_rcp_f32 v10, v10
  s_nop 0
  v_mul_f32 v80, v80, v10
  v_mul_f32 v81, v81, v10
  v_mul_f32 v82, v82, v10
  v_mul_f32 v83, v83, v10
  v_mul_f32 v84, v84, v10
  v_mul_f32 v85, v85, v10
  v_mul_f32 v86, v86, v10
  v_mul_f32 v87, v87, v10
  v_cvt_pk_bf16_f32 v80, 0, v80
  v_cvt_pk_bf16_f32 v81, 0, v81
  v_cvt_pk_bf16_f32 v82, 0, v82
  v_cvt_pk_bf16_f32 v83, 0, v83
  v_cvt_pk_bf16_f32 v84, 0, v84
  v_cvt_pk_bf16_f32 v85, 0, v85
  v_cvt_pk_bf16_f32 v86, 0, v86
  v_cvt_pk_bf16_f32 v87, 0, v87
  v_lshrrev_b32 v2, 1, v1
  v_lshlrev_b32 v2, 7, v2
  v_and_b32 v3, 1, v1
  v_lshl_add_u32 v2, v3, 5, v2
  v_add_u32 v2, 20480, v2
  global_load_dwordx4 v[40:43], v2, s[42:43] offset:0 sc1
  global_load_dwordx4 v[44:47], v2, s[42:43] offset:16 sc1
  global_load_dwordx4 v[48:51], v2, s[42:43] offset:64 sc1
  global_load_dwordx4 v[52:55], v2, s[42:43] offset:80 sc1
  s_waitcnt vmcnt(0)
  v_lshlrev_b32 v88, 16, v40
  v_and_b32 v89, s73, v40
  v_lshlrev_b32 v90, 16, v42
  v_and_b32 v91, s73, v42
  v_lshlrev_b32 v92, 16, v44
  v_and_b32 v93, s73, v44
  v_lshlrev_b32 v94, 16, v46
  v_and_b32 v95, s73, v46
  v_lshlrev_b32 v96, 16, v48
  v_and_b32 v97, s73, v48
  v_lshlrev_b32 v98, 16, v50
  v_and_b32 v99, s73, v50
  v_lshlrev_b32 v100, 16, v52
  v_and_b32 v101, s73, v52
  v_lshlrev_b32 v102, 16, v54
  v_and_b32 v103, s73, v54
  v_add_f32 v88, 1.0, v88
  v_add_f32 v89, 1.0, v89
  v_add_f32 v90, 1.0, v90
  v_add_f32 v91, 1.0, v91
  v_add_f32 v92, 1.0, v92
  v_add_f32 v93, 1.0, v93
  v_add_f32 v94, 1.0, v94
  v_add_f32 v95, 1.0, v95
  v_add_f32 v96, 1.0, v96
  v_add_f32 v97, 1.0, v97
  v_add_f32 v98, 1.0, v98
  v_add_f32 v99, 1.0, v99
  v_add_f32 v100, 1.0, v100
  v_add_f32 v101, 1.0, v101
  v_add_f32 v102, 1.0, v102
  v_add_f32 v103, 1.0, v103
  v_cvt_pk_bf16_f32 v88, 0, v88
  v_cvt_pk_bf16_f32 v89, 0, v89
  v_cvt_pk_bf16_f32 v90, 0, v90
  v_cvt_pk_bf16_f32 v91, 0, v91
  v_cvt_pk_bf16_f32 v92, 0, v92
  v_cvt_pk_bf16_f32 v93, 0, v93
  v_cvt_pk_bf16_f32 v94, 0, v94
  v_cvt_pk_bf16_f32 v95, 0, v95
  v_cvt_pk_bf16_f32 v96, 0, v96
  v_cvt_pk_bf16_f32 v97, 0, v97
  v_cvt_pk_bf16_f32 v98, 0, v98
  v_cvt_pk_bf16_f32 v99, 0, v99
  v_cvt_pk_bf16_f32 v100, 0, v100
  v_cvt_pk_bf16_f32 v101, 0, v101
  v_cvt_pk_bf16_f32 v102, 0, v102
  v_cvt_pk_bf16_f32 v103, 0, v103
  v_mul_f32 v72, v72, v88
  v_mul_f32 v73, v73, v89
  v_mul_f32 v74, v74, v90
  v_mul_f32 v75, v75, v91
  v_mul_f32 v76, v76, v92
  v_mul_f32 v77, v77, v93
  v_mul_f32 v78, v78, v94
  v_mul_f32 v79, v79, v95
  v_mul_f32 v80, v80, v96
  v_mul_f32 v81, v81, v97
  v_mul_f32 v82, v82, v98
  v_mul_f32 v83, v83, v99
  v_mul_f32 v84, v84, v100
  v_mul_f32 v85, v85, v101
  v_mul_f32 v86, v86, v102
  v_mul_f32 v87, v87, v103
  v_cvt_pk_bf16_f32 v72, 0, v72
  v_cvt_pk_bf16_f32 v73, 0, v73
  v_cvt_pk_bf16_f32 v74, 0, v74
  v_cvt_pk_bf16_f32 v75, 0, v75
  v_cvt_pk_bf16_f32 v76, 0, v76
  v_cvt_pk_bf16_f32 v77, 0, v77
  v_cvt_pk_bf16_f32 v78, 0, v78
  v_cvt_pk_bf16_f32 v79, 0, v79
  v_cvt_pk_bf16_f32 v80, 0, v80
  v_cvt_pk_bf16_f32 v81, 0, v81
  v_cvt_pk_bf16_f32 v82, 0, v82
  v_cvt_pk_bf16_f32 v83, 0, v83
  v_cvt_pk_bf16_f32 v84, 0, v84
  v_cvt_pk_bf16_f32 v85, 0, v85
  v_cvt_pk_bf16_f32 v86, 0, v86
  v_cvt_pk_bf16_f32 v87, 0, v87
  v_lshrrev_b32 v2, 1, v1
  v_lshlrev_b32 v2, 7, v2
  v_and_b32 v3, 1, v1
  v_lshl_add_u32 v2, v3, 5, v2
  v_add_u32 v2, 16384, v2
  global_load_dwordx4 v[40:43], v2, s[42:43] offset:0 sc1
  global_load_dwordx4 v[44:47], v2, s[42:43] offset:16 sc1
  global_load_dwordx4 v[48:51], v2, s[42:43] offset:64 sc1
  global_load_dwordx4 v[52:55], v2, s[42:43] offset:80 sc1
  s_waitcnt vmcnt(0)
  v_lshlrev_b32 v88, 16, v40
  v_and_b32 v89, s73, v40
  v_lshlrev_b32 v90, 16, v42
  v_and_b32 v91, s73, v42
  v_lshlrev_b32 v92, 16, v44
  v_and_b32 v93, s73, v44
  v_lshlrev_b32 v94, 16, v46
  v_and_b32 v95, s73, v46
  v_lshlrev_b32 v96, 16, v48
  v_and_b32 v97, s73, v48
  v_lshlrev_b32 v98, 16, v50
  v_and_b32 v99, s73, v50
  v_lshlrev_b32 v100, 16, v52
  v_and_b32 v101, s73, v52
  v_lshlrev_b32 v102, 16, v54
  v_and_b32 v103, s73, v54
  v_add_f32 v72, v72, v88
  v_add_f32 v73, v73, v89
  v_add_f32 v74, v74, v90
  v_add_f32 v75, v75, v91
  v_add_f32 v76, v76, v92
  v_add_f32 v77, v77, v93
  v_add_f32 v78, v78, v94
  v_add_f32 v79, v79, v95
  v_add_f32 v80, v80, v96
  v_add_f32 v81, v81, v97
  v_add_f32 v82, v82, v98
  v_add_f32 v83, v83, v99
  v_add_f32 v84, v84, v100
  v_add_f32 v85, v85, v101
  v_add_f32 v86, v86, v102
  v_add_f32 v87, v87, v103
  v_cvt_pk_bf16_f32 v40, v72, v73
  v_cvt_pk_bf16_f32 v41, v74, v75
  v_cvt_pk_bf16_f32 v42, v76, v77
  v_cvt_pk_bf16_f32 v43, v78, v79
  v_cvt_pk_bf16_f32 v44, v80, v81
  v_cvt_pk_bf16_f32 v45, v82, v83
  v_cvt_pk_bf16_f32 v46, v84, v85
  v_cvt_pk_bf16_f32 v47, v86, v87
  v_add_u32 v3, 12288, v0
  ds_write_b128 v3, v[40:43] offset:0
  ds_write_b128 v3, v[44:47] offset:1024
  s_mov_b32 s44, s28
  s_mov_b32 s45, s29
  s_mov_b32 s46, 1409024
  s_mov_b32 s11, 2752
  s_mov_b32 s12, 1409024
  v_mov_b32 v4, 12288
  v_mov_b32 v5, 13312
  v_lshlrev_b32 v2, 4, v1
  s_call_b64 s[62:63], L_gv
  v_cvt_pk_bf16_f32 v120, 0, v72
  v_cvt_pk_bf16_f32 v121, 0, v73
  v_cvt_pk_bf16_f32 v122, 0, v74
  v_cvt_pk_bf16_f32 v123, 0, v75
  v_cvt_pk_bf16_f32 v124, 0, v76
  v_cvt_pk_bf16_f32 v125, 0, v77
  v_cvt_pk_bf16_f32 v126, 0, v78
  v_cvt_pk_bf16_f32 v127, 0, v79
  v_cvt_pk_bf16_f32 v128, 0, v80
  v_cvt_pk_bf16_f32 v129, 0, v81
  v_cvt_pk_bf16_f32 v130, 0, v82
  v_cvt_pk_bf16_f32 v131, 0, v83
  v_cvt_pk_bf16_f32 v132, 0, v84
  v_cvt_pk_bf16_f32 v133, 0, v85
  v_cvt_pk_bf16_f32 v134, 0, v86
  v_cvt_pk_bf16_f32 v135, 0, v87
  s_mov_b32 s44, s30
  s_mov_b32 s45, s31
  s_mov_b32 s46, 1409024
  s_mov_b32 s11, 2752
  s_mov_b32 s12, 1409024
  v_mov_b32 v4, 12288
  v_mov_b32 v5, 13312
  v_lshlrev_b32 v2, 4, v1
  s_call_b64 s[62:63], L_gv
  v_mul_f32 v88, 0xbfb8aa3b, v120
  v_mul_f32 v89, 0xbfb8aa3b, v121
  v_mul_f32 v90, 0xbfb8aa3b, v122
  v_mul_f32 v91, 0xbfb8aa3b, v123
  v_exp_f32 v88, v88
  v_exp_f32 v89, v89
  v_exp_f32 v90, v90
  v_exp_f32 v91, v91
  s_nop 0
  v_add_f32 v88, 1.0, v88
  v_add_f32 v89, 1.0, v89
  v_add_f32 v90, 1.0, v90
  v_add_f32 v91, 1.0, v91
  v_rcp_f32 v88, v88
  v_rcp_f32 v89, v89
  v_rcp_f32 v90, v90
  v_rcp_f32 v91, v91
  s_nop 0
  v_mul_f32 v120, v120, v88
  v_mul_f32 v121, v121, v89
  v_mul_f32 v122, v122, v90
  v_mul_f32 v123, v123, v91
  v_mul_f32 v88, 0xbfb8aa3b, v124
  v_mul_f32 v89, 0xbfb8aa3b, v125
  v_mul_f32 v90, 0xbfb8aa3b, v126
  v_mul_f32 v91, 0xbfb8aa3b, v127
  v_exp_f32 v88, v88
  v_exp_f32 v89, v89
  v_exp_f32 v90, v90
  v_exp_f32 v91, v91
  s_nop 0
  v_add_f32 v88, 1.0, v88
  v_add_f32 v89, 1.0, v89
  v_add_f32 v90, 1.0, v90
  v_add_f32 v91, 1.0, v91
  v_rcp_f32 v88, v88
  v_rcp_f32 v89, v89
  v_rcp_f32 v90, v90
  v_rcp_f32 v91, v91
  s_nop 0
  v_mul_f32 v124, v124, v88
  v_mul_f32 v125, v125, v89
  v_mul_f32 v126, v126, v90
  v_mul_f32 v127, v127, v91
  v_mul_f32 v88, 0xbfb8aa3b, v128
  v_mul_f32 v89, 0xbfb8aa3b, v129
  v_mul_f32 v90, 0xbfb8aa3b, v130
  v_mul_f32 v91, 0xbfb8aa3b, v131
  v_exp_f32 v88, v88
  v_exp_f32 v89, v89
  v_exp_f32 v90, v90
  v_exp_f32 v91, v91
  s_nop 0
  v_add_f32 v88, 1.0, v88
  v_add_f32 v89, 1.0, v89
  v_add_f32 v90, 1.0, v90
  v_add_f32 v91, 1.0, v91
  v_rcp_f32 v88, v88
  v_rcp_f32 v89, v89
  v_rcp_f32 v90, v90
  v_rcp_f32 v91, v91
  s_nop 0
  v_mul_f32 v128, v128, v88
  v_mul_f32 v129, v129, v89
  v_mul_f32 v130, v130, v90
  v_mul_f32 v131, v131, v91
  v_mul_f32 v88, 0xbfb8aa3b, v132
  v_mul_f32 v89, 0xbfb8aa3b, v133
  v_mul_f32 v90, 0xbfb8aa3b, v134
  v_mul_f32 v91, 0xbfb8aa3b, v135
  v_exp_f32 v88, v88
  v_exp_f32 v89, v89
  v_exp_f32 v90, v90
  v_exp_f32 v91, v91
  s_nop 0
  v_add_f32 v88, 1.0, v88
  v_add_f32 v89, 1.0, v89
  v_add_f32 v90, 1.0, v90
  v_add_f32 v91, 1.0, v91
  v_rcp_f32 v88, v88
  v_rcp_f32 v89, v89
  v_rcp_f32 v90, v90
  v_rcp_f32 v91, v91
  s_nop 0
  v_mul_f32 v132, v132, v88
  v_mul_f32 v133, v133, v89
  v_mul_f32 v134, v134, v90
  v_mul_f32 v135, v135, v91
  v_cvt_pk_bf16_f32 v120, 0, v120
  v_cvt_pk_bf16_f32 v121, 0, v121
  v_cvt_pk_bf16_f32 v122, 0, v122
  v_cvt_pk_bf16_f32 v123, 0, v123
  v_cvt_pk_bf16_f32 v124, 0, v124
  v_cvt_pk_bf16_f32 v125, 0, v125
  v_cvt_pk_bf16_f32 v126, 0, v126
  v_cvt_pk_bf16_f32 v127, 0, v127
  v_cvt_pk_bf16_f32 v128, 0, v128
  v_cvt_pk_bf16_f32 v129, 0, v129
  v_cvt_pk_bf16_f32 v130, 0, v130
  v_cvt_pk_bf16_f32 v131, 0, v131
  v_cvt_pk_bf16_f32 v132, 0, v132
  v_cvt_pk_bf16_f32 v133, 0, v133
  v_cvt_pk_bf16_f32 v134, 0, v134
  v_cvt_pk_bf16_f32 v135, 0, v135
  v_cvt_pk_bf16_f32 v72, 0, v72
  v_cvt_pk_bf16_f32 v73, 0, v73
  v_cvt_pk_bf16_f32 v74, 0, v74
  v_cvt_pk_bf16_f32 v75, 0, v75
  v_cvt_pk_bf16_f32 v76, 0, v76
  v_cvt_pk_bf16_f32 v77, 0, v77
  v_cvt_pk_bf16_f32 v78, 0, v78
  v_cvt_pk_bf16_f32 v79, 0, v79
  v_cvt_pk_bf16_f32 v80, 0, v80
  v_cvt_pk_bf16_f32 v81, 0, v81
  v_cvt_pk_bf16_f32 v82, 0, v82
  v_cvt_pk_bf16_f32 v83, 0, v83
  v_cvt_pk_bf16_f32 v84, 0, v84
  v_cvt_pk_bf16_f32 v85, 0, v85
  v_cvt_pk_bf16_f32 v86, 0, v86
  v_cvt_pk_bf16_f32 v87, 0, v87
  v_mul_f32 v72, v72, v120
  v_mul_f32 v73, v73, v121
  v_mul_f32 v74, v74, v122
  v_mul_f32 v75, v75, v123
  v_mul_f32 v76, v76, v124
  v_mul_f32 v77, v77, v125
  v_mul_f32 v78, v78, v126
  v_mul_f32 v79, v79, v127
  v_mul_f32 v80, v80, v128
  v_mul_f32 v81, v81, v129
  v_mul_f32 v82, v82, v130
  v_mul_f32 v83, v83, v131
  v_mul_f32 v84, v84, v132
  v_mul_f32 v85, v85, v133
  v_mul_f32 v86, v86, v134
  v_mul_f32 v87, v87, v135
  v_cvt_pk_bf16_f32 v40, v72, v73
  v_cvt_pk_bf16_f32 v41, v74, v75
  v_cvt_pk_bf16_f32 v42, v76, v77
  v_cvt_pk_bf16_f32 v43, v78, v79
  v_cvt_pk_bf16_f32 v44, v80, v81
  v_cvt_pk_bf16_f32 v45, v82, v83
  v_cvt_pk_bf16_f32 v46, v84, v85
  v_cvt_pk_bf16_f32 v47, v86, v87
  v_add_u32 v3, 14336, v0
  ds_write_b128 v3, v[40:43] offset:0
  ds_write_b128 v3, v[44:47] offset:3072
  s_mov_b32 s44, s28
  s_mov_b32 s45, s29
  s_mov_b32 s46, 1409024
  s_mov_b32 s11, 2752
  s_mov_b32 s12, 1409024
  v_mov_b32 v4, 12288
  v_mov_b32 v5, 13312
  v_lshlrev_b32 v2, 4, v1
  v_add_u32 v2, 1024, v2
  s_call_b64 s[62:63], L_gv
  v_cvt_pk_bf16_f32 v120, 0, v72
  v_cvt_pk_bf16_f32 v121, 0, v73
  v_cvt_pk_bf16_f32 v122, 0, v74
  v_cvt_pk_bf16_f32 v123, 0, v75
  v_cvt_pk_bf16_f32 v124, 0, v76
  v_cvt_pk_bf16_f32 v125, 0, v77
  v_cvt_pk_bf16_f32 v126, 0, v78
  v_cvt_pk_bf16_f32 v127, 0, v79
  v_cvt_pk_bf16_f32 v128, 0, v80
  v_cvt_pk_bf16_f32 v129, 0, v81
  v_cvt_pk_bf16_f32 v130, 0, v82
  v_cvt_pk_bf16_f32 v131, 0, v83
  v_cvt_pk_bf16_f32 v132, 0, v84
  v_cvt_pk_bf16_f32 v133, 0, v85
  v_cvt_pk_bf16_f32 v134, 0, v86
  v_cvt_pk_bf16_f32 v135, 0, v87
  s_mov_b32 s44, s30
  s_mov_b32 s45, s31
  s_mov_b32 s46, 1409024
  s_mov_b32 s11, 2752
  s_mov_b32 s12, 1409024
  v_mov_b32 v4, 12288
  v_mov_b32 v5, 13312
  v_lshlrev_b32 v2, 4, v1
  v_add_u32 v2, 1024, v2
  s_call_b64 s[62:63], L_gv
  v_mul_f32 v88, 0xbfb8aa3b, v120
  v_mul_f32 v89, 0xbfb8aa3b, v121
  v_mul_f32 v90, 0xbfb8aa3b, v122
  v_mul_f32 v91, 0xbfb8aa3b, v123
  v_exp_f32 v88, v88
  v_exp_f32 v89, v89
  v_exp_f32 v90, v90
  v_exp_f32 v91, v91
  s_nop 0
  v_add_f32 v88, 1.0, v88
  v_add_f32 v89, 1.0, v89
  v_add_f32 v90, 1.0, v90
  v_add_f32 v91, 1.0, v91
  v_rcp_f32 v88, v88
  v_rcp_f32 v89, v89
  v_rcp_f32 v90, v90
  v_rcp_f32 v91, v91
  s_nop 0
  v_mul_f32 v120, v120, v88
  v_mul_f32 v121, v121, v89
  v_mul_f32 v122, v122, v90
  v_mul_f32 v123, v123, v91
  v_mul_f32 v88, 0xbfb8aa3b, v124
  v_mul_f32 v89, 0xbfb8aa3b, v125
  v_mul_f32 v90, 0xbfb8aa3b, v126
  v_mul_f32 v91, 0xbfb8aa3b, v127
  v_exp_f32 v88, v88
  v_exp_f32 v89, v89
  v_exp_f32 v90, v90
  v_exp_f32 v91, v91
  s_nop 0
  v_add_f32 v88, 1.0, v88
  v_add_f32 v89, 1.0, v89
  v_add_f32 v90, 1.0, v90
  v_add_f32 v91, 1.0, v91
  v_rcp_f32 v88, v88
  v_rcp_f32 v89, v89
  v_rcp_f32 v90, v90
  v_rcp_f32 v91, v91
  s_nop 0
  v_mul_f32 v124, v124, v88
  v_mul_f32 v125, v125, v89
  v_mul_f32 v126, v126, v90
  v_mul_f32 v127, v127, v91
  v_mul_f32 v88, 0xbfb8aa3b, v128
  v_mul_f32 v89, 0xbfb8aa3b, v129
  v_mul_f32 v90, 0xbfb8aa3b, v130
  v_mul_f32 v91, 0xbfb8aa3b, v131
  v_exp_f32 v88, v88
  v_exp_f32 v89, v89
  v_exp_f32 v90, v90
  v_exp_f32 v91, v91
  s_nop 0
  v_add_f32 v88, 1.0, v88
  v_add_f32 v89, 1.0, v89
  v_add_f32 v90, 1.0, v90
  v_add_f32 v91, 1.0, v91
  v_rcp_f32 v88, v88
  v_rcp_f32 v89, v89
  v_rcp_f32 v90, v90
  v_rcp_f32 v91, v91
  s_nop 0
  v_mul_f32 v128, v128, v88
  v_mul_f32 v129, v129, v89
  v_mul_f32 v130, v130, v90
  v_mul_f32 v131, v131, v91
  v_mul_f32 v88, 0xbfb8aa3b, v132
  v_mul_f32 v89, 0xbfb8aa3b, v133
  v_mul_f32 v90, 0xbfb8aa3b, v134
  v_mul_f32 v91, 0xbfb8aa3b, v135
  v_exp_f32 v88, v88
  v_exp_f32 v89, v89
  v_exp_f32 v90, v90
  v_exp_f32 v91, v91
  s_nop 0
  v_add_f32 v88, 1.0, v88
  v_add_f32 v89, 1.0, v89
  v_add_f32 v90, 1.0, v90
  v_add_f32 v91, 1.0, v91
  v_rcp_f32 v88, v88
  v_rcp_f32 v89, v89
  v_rcp_f32 v90, v90
  v_rcp_f32 v91, v91
  s_nop 0
  v_mul_f32 v132, v132, v88
  v_mul_f32 v133, v133, v89
  v_mul_f32 v134, v134, v90
  v_mul_f32 v135, v135, v91
  v_cvt_pk_bf16_f32 v120, 0, v120
  v_cvt_pk_bf16_f32 v121, 0, v121
  v_cvt_pk_bf16_f32 v122, 0, v122
  v_cvt_pk_bf16_f32 v123, 0, v123
  v_cvt_pk_bf16_f32 v124, 0, v124
  v_cvt_pk_bf16_f32 v125, 0, v125
  v_cvt_pk_bf16_f32 v126, 0, v126
  v_cvt_pk_bf16_f32 v127, 0, v127
  v_cvt_pk_bf16_f32 v128, 0, v128
  v_cvt_pk_bf16_f32 v129, 0, v129
  v_cvt_pk_bf16_f32 v130, 0, v130
  v_cvt_pk_bf16_f32 v131, 0, v131
  v_cvt_pk_bf16_f32 v132, 0, v132
  v_cvt_pk_bf16_f32 v133, 0, v133
  v_cvt_pk_bf16_f32 v134, 0, v134
  v_cvt_pk_bf16_f32 v135, 0, v135
  v_cvt_pk_bf16_f32 v72, 0, v72
  v_cvt_pk_bf16_f32 v73, 0, v73
  v_cvt_pk_bf16_f32 v74, 0, v74
  v_cvt_pk_bf16_f32 v75, 0, v75
  v_cvt_pk_bf16_f32 v76, 0, v76
  v_cvt_pk_bf16_f32 v77, 0, v77
  v_cvt_pk_bf16_f32 v78, 0, v78
  v_cvt_pk_bf16_f32 v79, 0, v79
  v_cvt_pk_bf16_f32 v80, 0, v80
  v_cvt_pk_bf16_f32 v81, 0, v81
  v_cvt_pk_bf16_f32 v82, 0, v82
  v_cvt_pk_bf16_f32 v83, 0, v83
  v_cvt_pk_bf16_f32 v84, 0, v84
  v_cvt_pk_bf16_f32 v85, 0, v85
  v_cvt_pk_bf16_f32 v86, 0, v86
  v_cvt_pk_bf16_f32 v87, 0, v87
  v_mul_f32 v72, v72, v120
  v_mul_f32 v73, v73, v121
  v_mul_f32 v74, v74, v122
  v_mul_f32 v75, v75, v123
  v_mul_f32 v76, v76, v124
  v_mul_f32 v77, v77, v125
  v_mul_f32 v78, v78, v126
  v_mul_f32 v79, v79, v127
  v_mul_f32 v80, v80, v128
  v_mul_f32 v81, v81, v129
  v_mul_f32 v82, v82, v130
  v_mul_f32 v83, v83, v131
  v_mul_f32 v84, v84, v132
  v_mul_f32 v85, v85, v133
  v_mul_f32 v86, v86, v134
  v_mul_f32 v87, v87, v135
  v_cvt_pk_bf16_f32 v40, v72, v73
  v_cvt_pk_bf16_f32 v41, v74, v75
  v_cvt_pk_bf16_f32 v42, v76, v77
  v_cvt_pk_bf16_f32 v43, v78, v79
  v_cvt_pk_bf16_f32 v44, v80, v81
  v_cvt_pk_bf16_f32 v45, v82, v83
  v_cvt_pk_bf16_f32 v46, v84, v85
  v_cvt_pk_bf16_f32 v47, v86, v87
  v_add_u32 v3, 15360, v0
  ds_write_b128 v3, v[40:43] offset:0
  ds_write_b128 v3, v[44:47] offset:3072
  s_mov_b32 s44, s28
  s_mov_b32 s45, s29
  s_mov_b32 s46, 1409024
  s_mov_b32 s11, 2752
  s_mov_b32 s12, 1409024
  v_mov_b32 v4, 12288
  v_mov_b32 v5, 13312
  v_lshlrev_b32 v2, 4, v1
  v_add_u32 v2, 2048, v2
  s_call_b64 s[62:63], L_gv
  v_cvt_pk_bf16_f32 v120, 0, v72
  v_cvt_pk_bf16_f32 v121, 0, v73
  v_cvt_pk_bf16_f32 v122, 0, v74
  v_cvt_pk_bf16_f32 v123, 0, v75
  v_cvt_pk_bf16_f32 v124, 0, v76
  v_cvt_pk_bf16_f32 v125, 0, v77
  v_cvt_pk_bf16_f32 v126, 0, v78
  v_cvt_pk_bf16_f32 v127, 0, v79
  v_cvt_pk_bf16_f32 v128, 0, v80
  v_cvt_pk_bf16_f32 v129, 0, v81
  v_cvt_pk_bf16_f32 v130, 0, v82
  v_cvt_pk_bf16_f32 v131, 0, v83
  v_cvt_pk_bf16_f32 v132, 0, v84
  v_cvt_pk_bf16_f32 v133, 0, v85
  v_cvt_pk_bf16_f32 v134, 0, v86
  v_cvt_pk_bf16_f32 v135, 0, v87
  s_mov_b32 s44, s30
  s_mov_b32 s45, s31
  s_mov_b32 s46, 1409024
  s_mov_b32 s11, 2752
  s_mov_b32 s12, 1409024
  v_mov_b32 v4, 12288
  v_mov_b32 v5, 13312
  v_lshlrev_b32 v2, 4, v1
  v_add_u32 v2, 2048, v2
  s_call_b64 s[62:63], L_gv
  v_mul_f32 v88, 0xbfb8aa3b, v120
  v_mul_f32 v89, 0xbfb8aa3b, v121
  v_mul_f32 v90, 0xbfb8aa3b, v122
  v_mul_f32 v91, 0xbfb8aa3b, v123
  v_exp_f32 v88, v88
  v_exp_f32 v89, v89
  v_exp_f32 v90, v90
  v_exp_f32 v91, v91
  s_nop 0
  v_add_f32 v88, 1.0, v88
  v_add_f32 v89, 1.0, v89
  v_add_f32 v90, 1.0, v90
  v_add_f32 v91, 1.0, v91
  v_rcp_f32 v88, v88
  v_rcp_f32 v89, v89
  v_rcp_f32 v90, v90
  v_rcp_f32 v91, v91
  s_nop 0
  v_mul_f32 v120, v120, v88
  v_mul_f32 v121, v121, v89
  v_mul_f32 v122, v122, v90
  v_mul_f32 v123, v123, v91
  v_mul_f32 v88, 0xbfb8aa3b, v124
  v_mul_f32 v89, 0xbfb8aa3b, v125
  v_mul_f32 v90, 0xbfb8aa3b, v126
  v_mul_f32 v91, 0xbfb8aa3b, v127
  v_exp_f32 v88, v88
  v_exp_f32 v89, v89
  v_exp_f32 v90, v90
  v_exp_f32 v91, v91
  s_nop 0
  v_add_f32 v88, 1.0, v88
  v_add_f32 v89, 1.0, v89
  v_add_f32 v90, 1.0, v90
  v_add_f32 v91, 1.0, v91
  v_rcp_f32 v88, v88
  v_rcp_f32 v89, v89
  v_rcp_f32 v90, v90
  v_rcp_f32 v91, v91
  s_nop 0
  v_mul_f32 v124, v124, v88
  v_mul_f32 v125, v125, v89
  v_mul_f32 v126, v126, v90
  v_mul_f32 v127, v127, v91
  v_mul_f32 v88, 0xbfb8aa3b, v128
  v_mul_f32 v89, 0xbfb8aa3b, v129
  v_mul_f32 v90, 0xbfb8aa3b, v130
  v_mul_f32 v91, 0xbfb8aa3b, v131
  v_exp_f32 v88, v88
  v_exp_f32 v89, v89
  v_exp_f32 v90, v90
  v_exp_f32 v91, v91
  s_nop 0
  v_add_f32 v88, 1.0, v88
  v_add_f32 v89, 1.0, v89
  v_add_f32 v90, 1.0, v90
  v_add_f32 v91, 1.0, v91
  v_rcp_f32 v88, v88
  v_rcp_f32 v89, v89
  v_rcp_f32 v90, v90
  v_rcp_f32 v91, v91
  s_nop 0
  v_mul_f32 v128, v128, v88
  v_mul_f32 v129, v129, v89
  v_mul_f32 v130, v130, v90
  v_mul_f32 v131, v131, v91
  v_mul_f32 v88, 0xbfb8aa3b, v132
  v_mul_f32 v89, 0xbfb8aa3b, v133
  v_mul_f32 v90, 0xbfb8aa3b, v134
  v_mul_f32 v91, 0xbfb8aa3b, v135
  v_exp_f32 v88, v88
  v_exp_f32 v89, v89
  v_exp_f32 v90, v90
  v_exp_f32 v91, v91
  s_nop 0
  v_add_f32 v88, 1.0, v88
  v_add_f32 v89, 1.0, v89
  v_add_f32 v90, 1.0, v90
  v_add_f32 v91, 1.0, v91
  v_rcp_f32 v88, v88
  v_rcp_f32 v89, v89
  v_rcp_f32 v90, v90
  v_rcp_f32 v91, v91
  s_nop 0
  v_mul_f32 v132, v132, v88
  v_mul_f32 v133, v133, v89
  v_mul_f32 v134, v134, v90
  v_mul_f32 v135, v135, v91
  v_cvt_pk_bf16_f32 v120, 0, v120
  v_cvt_pk_bf16_f32 v121, 0, v121
  v_cvt_pk_bf16_f32 v122, 0, v122
  v_cvt_pk_bf16_f32 v123, 0, v123
  v_cvt_pk_bf16_f32 v124, 0, v124
  v_cvt_pk_bf16_f32 v125, 0, v125
  v_cvt_pk_bf16_f32 v126, 0, v126
  v_cvt_pk_bf16_f32 v127, 0, v127
  v_cvt_pk_bf16_f32 v128, 0, v128
  v_cvt_pk_bf16_f32 v129, 0, v129
  v_cvt_pk_bf16_f32 v130, 0, v130
  v_cvt_pk_bf16_f32 v131, 0, v131
  v_cvt_pk_bf16_f32 v132, 0, v132
  v_cvt_pk_bf16_f32 v133, 0, v133
  v_cvt_pk_bf16_f32 v134, 0, v134
  v_cvt_pk_bf16_f32 v135, 0, v135
  v_cvt_pk_bf16_f32 v72, 0, v72
  v_cvt_pk_bf16_f32 v73, 0, v73
  v_cvt_pk_bf16_f32 v74, 0, v74
  v_cvt_pk_bf16_f32 v75, 0, v75
  v_cvt_pk_bf16_f32 v76, 0, v76
  v_cvt_pk_bf16_f32 v77, 0, v77
  v_cvt_pk_bf16_f32 v78, 0, v78
  v_cvt_pk_bf16_f32 v79, 0, v79
  v_cvt_pk_bf16_f32 v80, 0, v80
  v_cvt_pk_bf16_f32 v81, 0, v81
  v_cvt_pk_bf16_f32 v82, 0, v82
  v_cvt_pk_bf16_f32 v83, 0, v83
  v_cvt_pk_bf16_f32 v84, 0, v84
  v_cvt_pk_bf16_f32 v85, 0, v85
  v_cvt_pk_bf16_f32 v86, 0, v86
  v_cvt_pk_bf16_f32 v87, 0, v87
  v_mul_f32 v72, v72, v120
  v_mul_f32 v73, v73, v121
  v_mul_f32 v74, v74, v122
  v_mul_f32 v75, v75, v123
  v_mul_f32 v76, v76, v124
  v_mul_f32 v77, v77, v125
  v_mul_f32 v78, v78, v126
  v_mul_f32 v79, v79, v127
  v_mul_f32 v80, v80, v128
  v_mul_f32 v81, v81, v129
  v_mul_f32 v82, v82, v130
  v_mul_f32 v83, v83, v131
  v_mul_f32 v84, v84, v132
  v_mul_f32 v85, v85, v133
  v_mul_f32 v86, v86, v134
  v_mul_f32 v87, v87, v135
  v_cvt_pk_bf16_f32 v40, v72, v73
  v_cvt_pk_bf16_f32 v41, v74, v75
  v_cvt_pk_bf16_f32 v42, v76, v77
  v_cvt_pk_bf16_f32 v43, v78, v79
  v_cvt_pk_bf16_f32 v44, v80, v81
  v_cvt_pk_bf16_f32 v45, v82, v83
  v_cvt_pk_bf16_f32 v46, v84, v85
  v_cvt_pk_bf16_f32 v47, v86, v87
  v_add_u32 v3, 16384, v0
  ds_write_b128 v3, v[40:43] offset:0
  ds_write_b128 v3, v[44:47] offset:3072
  s_mov_b32 s44, s32
  s_mov_b32 s45, s33
  s_mov_b32 s46, 1409024
  s_mov_b32 s11, 1024
  s_mov_b32 s12, 1409024
  v_mov_b32 v4, 14336
  v_mov_b32 v5, 17408
  v_lshlrev_b32 v2, 4, v1
  s_call_b64 s[62:63], L_gv
  v_lshrrev_b32 v2, 1, v1
  v_lshlrev_b32 v2, 7, v2
  v_and_b32 v3, 1, v1
  v_lshl_add_u32 v2, v3, 5, v2
  v_add_u32 v2, 24576, v2
  global_load_dwordx4 v[40:43], v2, s[42:43] offset:0 sc1
  global_load_dwordx4 v[44:47], v2, s[42:43] offset:16 sc1
  global_load_dwordx4 v[48:51], v2, s[42:43] offset:64 sc1
  global_load_dwordx4 v[52:55], v2, s[42:43] offset:80 sc1
  s_waitcnt vmcnt(0)
  v_lshlrev_b32 v88, 16, v40
  v_and_b32 v89, s73, v40
  v_lshlrev_b32 v90, 16, v42
  v_and_b32 v91, s73, v42
  v_lshlrev_b32 v92, 16, v44
  v_and_b32 v93, s73, v44
  v_lshlrev_b32 v94, 16, v46
  v_and_b32 v95, s73, v46
  v_lshlrev_b32 v96, 16, v48
  v_and_b32 v97, s73, v48
  v_lshlrev_b32 v98, 16, v50
  v_and_b32 v99, s73, v50
  v_lshlrev_b32 v100, 16, v52
  v_and_b32 v101, s73, v52
  v_lshlrev_b32 v102, 16, v54
  v_and_b32 v103, s73, v54
  v_cvt_pk_bf16_f32 v72, 0, v72
  v_cvt_pk_bf16_f32 v73, 0, v73
  v_cvt_pk_bf16_f32 v74, 0, v74
  v_cvt_pk_bf16_f32 v75, 0, v75
  v_cvt_pk_bf16_f32 v76, 0, v76
  v_cvt_pk_bf16_f32 v77, 0, v77
  v_cvt_pk_bf16_f32 v78, 0, v78
  v_cvt_pk_bf16_f32 v79, 0, v79
  v_cvt_pk_bf16_f32 v80, 0, v80
  v_cvt_pk_bf16_f32 v81, 0, v81
  v_cvt_pk_bf16_f32 v82, 0, v82
  v_cvt_pk_bf16_f32 v83, 0, v83
  v_cvt_pk_bf16_f32 v84, 0, v84
  v_cvt_pk_bf16_f32 v85, 0, v85
  v_cvt_pk_bf16_f32 v86, 0, v86
  v_cvt_pk_bf16_f32 v87, 0, v87
  v_mul_f32 v72, v72, v88
  v_mul_f32 v73, v73, v89
  v_mul_f32 v74, v74, v90
  v_mul_f32 v75, v75, v91
  v_mul_f32 v76, v76, v92
  v_mul_f32 v77, v77, v93
  v_mul_f32 v78, v78, v94
  v_mul_f32 v79, v79, v95
  v_mul_f32 v80, v80, v96
  v_mul_f32 v81, v81, v97
  v_mul_f32 v82, v82, v98
  v_mul_f32 v83, v83, v99
  v_mul_f32 v84, v84, v100
  v_mul_f32 v85, v85, v101
  v_mul_f32 v86, v86, v102
  v_mul_f32 v87, v87, v103
  v_cvt_pk_bf16_f32 v72, 0, v72
  v_cvt_pk_bf16_f32 v73, 0, v73
  v_cvt_pk_bf16_f32 v74, 0, v74
  v_cvt_pk_bf16_f32 v75, 0, v75
  v_cvt_pk_bf16_f32 v76, 0, v76
  v_cvt_pk_bf16_f32 v77, 0, v77
  v_cvt_pk_bf16_f32 v78, 0, v78
  v_cvt_pk_bf16_f32 v79, 0, v79
  v_cvt_pk_bf16_f32 v80, 0, v80
  v_cvt_pk_bf16_f32 v81, 0, v81
  v_cvt_pk_bf16_f32 v82, 0, v82
  v_cvt_pk_bf16_f32 v83, 0, v83
  v_cvt_pk_bf16_f32 v84, 0, v84
  v_cvt_pk_bf16_f32 v85, 0, v85
  v_cvt_pk_bf16_f32 v86, 0, v86
  v_cvt_pk_bf16_f32 v87, 0, v87
  v_add_f32 v104, v104, v72
  v_add_f32 v105, v105, v73
  v_add_f32 v106, v106, v74
  v_add_f32 v107, v107, v75
  v_add_f32 v108, v108, v76
  v_add_f32 v109, v109, v77
  v_add_f32 v110, v110, v78
  v_add_f32 v111, v111, v79
  v_add_f32 v112, v112, v80
  v_add_f32 v113, v113, v81
  v_add_f32 v114, v114, v82
  v_add_f32 v115, v115, v83
  v_add_f32 v116, v116, v84
  v_add_f32 v117, v117, v85
  v_add_f32 v118, v118, v86
  v_add_f32 v119, v119, v87
  v_cvt_pk_bf16_f32 v104, 0, v104
  v_cvt_pk_bf16_f32 v105, 0, v105
  v_cvt_pk_bf16_f32 v106, 0, v106
  v_cvt_pk_bf16_f32 v107, 0, v107
  v_cvt_pk_bf16_f32 v108, 0, v108
  v_cvt_pk_bf16_f32 v109, 0, v109
  v_cvt_pk_bf16_f32 v110, 0, v110
  v_cvt_pk_bf16_f32 v111, 0, v111
  v_cvt_pk_bf16_f32 v112, 0, v112
  v_cvt_pk_bf16_f32 v113, 0, v113
  v_cvt_pk_bf16_f32 v114, 0, v114
  v_cvt_pk_bf16_f32 v115, 0, v115
  v_cvt_pk_bf16_f32 v116, 0, v116
  v_cvt_pk_bf16_f32 v117, 0, v117
  v_cvt_pk_bf16_f32 v118, 0, v118
  v_cvt_pk_bf16_f32 v119, 0, v119
  v_cvt_pk_bf16_f32 v40, v104, v105
  v_cvt_pk_bf16_f32 v41, v106, v107
  v_cvt_pk_bf16_f32 v42, v108, v109
  v_cvt_pk_bf16_f32 v43, v110, v111
  v_cvt_pk_bf16_f32 v44, v112, v113
  v_cvt_pk_bf16_f32 v45, v114, v115
  v_cvt_pk_bf16_f32 v46, v116, v117
  v_cvt_pk_bf16_f32 v47, v118, v119
  global_store_dwordx4 v0, v[40:43], s[38:39] offset:0 sc1
  global_store_dwordx4 v0, v[44:47], s[38:39] offset:1024 sc1
  s_endpgm
L_gv:
  v_mov_b32 v72, 0
  v_mov_b32 v73, 0
  v_mov_b32 v74, 0
  v_mov_b32 v75, 0
  v_mov_b32 v76, 0
  v_mov_b32 v77, 0
  v_mov_b32 v78, 0
  v_mov_b32 v79, 0
  v_mov_b32 v80, 0
  v_mov_b32 v81, 0
  v_mov_b32 v82, 0
  v_mov_b32 v83, 0
  v_mov_b32 v84, 0
  v_mov_b32 v85, 0
  v_mov_b32 v86, 0
  v_mov_b32 v87, 0
  s_mov_b32 s10, 0
L_gvl:
  buffer_load_dwordx4 v[40:43], v2, s[44:47], s10 offen
  s_add_u32 s10, s10, s11
  buffer_load_dwordx4 v[44:47], v2, s[44:47], s10 offen
  s_add_u32 s10, s10, s11
  buffer_load_dwordx4 v[48:51], v2, s[44:47], s10 offen
  s_add_u32 s10, s10, s11
  buffer_load_dwordx4 v[52:55], v2, s[44:47], s10 offen
  s_add_u32 s10, s10, s11
  buffer_load_dwordx4 v[56:59], v2, s[44:47], s10 offen
  s_add_u32 s10, s10, s11
  buffer_load_dwordx4 v[60:63], v2, s[44:47], s10 offen
  s_add_u32 s10, s10, s11
  buffer_load_dwordx4 v[64:67], v2, s[44:47], s10 offen
  s_add_u32 s10, s10, s11
  buffer_load_dwordx4 v[68:71], v2, s[44:47], s10 offen
  s_add_u32 s10, s10, s11
  ds_read_b128 v[88:91], v4
  ds_read_b128 v[92:95], v5
  v_add_u32 v4, 16, v4
  v_add_u32 v5, 16, v5
  s_waitcnt lgkmcnt(0)
  v_and_b32 v8, 0xffff, v88
  v_lshlrev_b32 v9, 16, v88
  v_and_b32 v10, 0xffff, v92
  v_lshlrev_b32 v11, 16, v92
  s_waitcnt vmcnt(7)
  v_dot2c_f32_bf16 v72, v8, v40
  v_dot2c_f32_bf16 v73, v9, v40
  v_dot2c_f32_bf16 v74, v8, v41
  v_dot2c_f32_bf16 v75, v9, v41
  v_dot2c_f32_bf16 v76, v8, v42
  v_dot2c_f32_bf16 v77, v9, v42
  v_dot2c_f32_bf16 v78, v8, v43
  v_dot2c_f32_bf16 v79, v9, v43
  v_dot2c_f32_bf16 v80, v10, v40
  v_dot2c_f32_bf16 v81, v11, v40
  v_dot2c_f32_bf16 v82, v10, v41
  v_dot2c_f32_bf16 v83, v11, v41
  v_dot2c_f32_bf16 v84, v10, v42
  v_dot2c_f32_bf16 v85, v11, v42
  v_dot2c_f32_bf16 v86, v10, v43
  v_dot2c_f32_bf16 v87, v11, v43
  v_lshrrev_b32 v8, 16, v88
  v_and_b32 v9, s73, v88
  v_lshrrev_b32 v10, 16, v92
  v_and_b32 v11, s73, v92
  s_waitcnt vmcnt(6)
  v_dot2c_f32_bf16 v72, v8, v44
  v_dot2c_f32_bf16 v73, v9, v44
  v_dot2c_f32_bf16 v74, v8, v45
  v_dot2c_f32_bf16 v75, v9, v45
  v_dot2c_f32_bf16 v76, v8, v46
  v_dot2c_f32_bf16 v77, v9, v46
  v_dot2c_f32_bf16 v78, v8, v47
  v_dot2c_f32_bf16 v79, v9, v47
  v_dot2c_f32_bf16 v80, v10, v44
  v_dot2c_f32_bf16 v81, v11, v44
  v_dot2c_f32_bf16 v82, v10, v45
  v_dot2c_f32_bf16 v83, v11, v45
  v_dot2c_f32_bf16 v84, v10, v46
  v_dot2c_f32_bf16 v85, v11, v46
  v_dot2c_f32_bf16 v86, v10, v47
  v_dot2c_f32_bf16 v87, v11, v47
  v_and_b32 v8, 0xffff, v89
  v_lshlrev_b32 v9, 16, v89
  v_and_b32 v10, 0xffff, v93
  v_lshlrev_b32 v11, 16, v93
  s_waitcnt vmcnt(5)
  v_dot2c_f32_bf16 v72, v8, v48
  v_dot2c_f32_bf16 v73, v9, v48
  v_dot2c_f32_bf16 v74, v8, v49
  v_dot2c_f32_bf16 v75, v9, v49
  v_dot2c_f32_bf16 v76, v8, v50
  v_dot2c_f32_bf16 v77, v9, v50
  v_dot2c_f32_bf16 v78, v8, v51
  v_dot2c_f32_bf16 v79, v9, v51
  v_dot2c_f32_bf16 v80, v10, v48
  v_dot2c_f32_bf16 v81, v11, v48
  v_dot2c_f32_bf16 v82, v10, v49
  v_dot2c_f32_bf16 v83, v11, v49
  v_dot2c_f32_bf16 v84, v10, v50
  v_dot2c_f32_bf16 v85, v11, v50
  v_dot2c_f32_bf16 v86, v10, v51
  v_dot2c_f32_bf16 v87, v11, v51
  v_lshrrev_b32 v8, 16, v89
  v_and_b32 v9, s73, v89
  v_lshrrev_b32 v10, 16, v93
  v_and_b32 v11, s73, v93
  s_waitcnt vmcnt(4)
  v_dot2c_f32_bf16 v72, v8, v52
  v_dot2c_f32_bf16 v73, v9, v52
  v_dot2c_f32_bf16 v74, v8, v53
  v_dot2c_f32_bf16 v75, v9, v53
  v_dot2c_f32_bf16 v76, v8, v54
  v_dot2c_f32_bf16 v77, v9, v54
  v_dot2c_f32_bf16 v78, v8, v55
  v_dot2c_f32_bf16 v79, v9, v55
  v_dot2c_f32_bf16 v80, v10, v52
  v_dot2c_f32_bf16 v81, v11, v52
  v_dot2c_f32_bf16 v82, v10, v53
  v_dot2c_f32_bf16 v83, v11, v53
  v_dot2c_f32_bf16 v84, v10, v54
  v_dot2c_f32_bf16 v85, v11, v54
  v_dot2c_f32_bf16 v86, v10, v55
  v_dot2c_f32_bf16 v87, v11, v55
  v_and_b32 v8, 0xffff, v90
  v_lshlrev_b32 v9, 16, v90
  v_and_b32 v10, 0xffff, v94
  v_lshlrev_b32 v11, 16, v94
  s_waitcnt vmcnt(3)
  v_dot2c_f32_bf16 v72, v8, v56
  v_dot2c_f32_bf16 v73, v9, v56
  v_dot2c_f32_bf16 v74, v8, v57
  v_dot2c_f32_bf16 v75, v9, v57
  v_dot2c_f32_bf16 v76, v8, v58
  v_dot2c_f32_bf16 v77, v9, v58
  v_dot2c_f32_bf16 v78, v8, v59
  v_dot2c_f32_bf16 v79, v9, v59
  v_dot2c_f32_bf16 v80, v10, v56
  v_dot2c_f32_bf16 v81, v11, v56
  v_dot2c_f32_bf16 v82, v10, v57
  v_dot2c_f32_bf16 v83, v11, v57
  v_dot2c_f32_bf16 v84, v10, v58
  v_dot2c_f32_bf16 v85, v11, v58
  v_dot2c_f32_bf16 v86, v10, v59
  v_dot2c_f32_bf16 v87, v11, v59
  v_lshrrev_b32 v8, 16, v90
  v_and_b32 v9, s73, v90
  v_lshrrev_b32 v10, 16, v94
  v_and_b32 v11, s73, v94
  s_waitcnt vmcnt(2)
  v_dot2c_f32_bf16 v72, v8, v60
  v_dot2c_f32_bf16 v73, v9, v60
  v_dot2c_f32_bf16 v74, v8, v61
  v_dot2c_f32_bf16 v75, v9, v61
  v_dot2c_f32_bf16 v76, v8, v62
  v_dot2c_f32_bf16 v77, v9, v62
  v_dot2c_f32_bf16 v78, v8, v63
  v_dot2c_f32_bf16 v79, v9, v63
  v_dot2c_f32_bf16 v80, v10, v60
  v_dot2c_f32_bf16 v81, v11, v60
  v_dot2c_f32_bf16 v82, v10, v61
  v_dot2c_f32_bf16 v83, v11, v61
  v_dot2c_f32_bf16 v84, v10, v62
  v_dot2c_f32_bf16 v85, v11, v62
  v_dot2c_f32_bf16 v86, v10, v63
  v_dot2c_f32_bf16 v87, v11, v63
  v_and_b32 v8, 0xffff, v91
  v_lshlrev_b32 v9, 16, v91
  v_and_b32 v10, 0xffff, v95
  v_lshlrev_b32 v11, 16, v95
  s_waitcnt vmcnt(1)
  v_dot2c_f32_bf16 v72, v8, v64
  v_dot2c_f32_bf16 v73, v9, v64
  v_dot2c_f32_bf16 v74, v8, v65
  v_dot2c_f32_bf16 v75, v9, v65
  v_dot2c_f32_bf16 v76, v8, v66
  v_dot2c_f32_bf16 v77, v9, v66
  v_dot2c_f32_bf16 v78, v8, v67
  v_dot2c_f32_bf16 v79, v9, v67
  v_dot2c_f32_bf16 v80, v10, v64
  v_dot2c_f32_bf16 v81, v11, v64
  v_dot2c_f32_bf16 v82, v10, v65
  v_dot2c_f32_bf16 v83, v11, v65
  v_dot2c_f32_bf16 v84, v10, v66
  v_dot2c_f32_bf16 v85, v11, v66
  v_dot2c_f32_bf16 v86, v10, v67
  v_dot2c_f32_bf16 v87, v11, v67
  v_lshrrev_b32 v8, 16, v91
  v_and_b32 v9, s73, v91
  v_lshrrev_b32 v10, 16, v95
  v_and_b32 v11, s73, v95
  s_waitcnt vmcnt(0)
  v_dot2c_f32_bf16 v72, v8, v68
  v_dot2c_f32_bf16 v73, v9, v68
  v_dot2c_f32_bf16 v74, v8, v69
  v_dot2c_f32_bf16 v75, v9, v69
  v_dot2c_f32_bf16 v76, v8, v70
  v_dot2c_f32_bf16 v77, v9, v70
  v_dot2c_f32_bf16 v78, v8, v71
  v_dot2c_f32_bf16 v79, v9, v71
  v_dot2c_f32_bf16 v80, v10, v68
  v_dot2c_f32_bf16 v81, v11, v68
  v_dot2c_f32_bf16 v82, v10, v69
  v_dot2c_f32_bf16 v83, v11, v69
  v_dot2c_f32_bf16 v84, v10, v70
  v_dot2c_f32_bf16 v85, v11, v70
  v_dot2c_f32_bf16 v86, v10, v71
  v_dot2c_f32_bf16 v87, v11, v71
  s_cmp_lt_u32 s10, s12
  s_cbranch_scc1 L_gvl
  s_nop 1
  s_setpc_b64 s[62:63]
L_serv:
  s_cmp_ge_u32 s13, 4
  s_cbranch_scc1 L_team
  s_cmp_ge_u32 s13, 2
  s_cbranch_scc1 L_end
  v_mov_b32 v38, 0
  v_mov_b32 v4, -1
  v_mov_b32 v5, 0
  v_mov_b32 v6, 0
  v_mov_b32 v7, 0
  ds_write_b128 v38, v[4:7] offset:256
  ds_write_b64 v38, v[6:7] offset:312
  s_getreg_b32 s76, hwreg(HW_REG_XCC_ID, 0, 4)
  s_waitcnt lgkmcnt(0)
  s_load_dword s74, s[42:43], 0
  s_getpc_b64 s[56:57]
L_pc_27:
  s_lshr_b32 s3, s2, 5
  s_lshl3_add_u32 s3, s3, s8
  s_lshl_b32 s3, s3, 2
  s_add_u32 s3, s3, L_table-L_pc_27
  s_load_dword s14, s[56:57], s3
  s_barrier
  s_waitcnt lgkmcnt(0)
  s_mul_i32 s74, s74, 0x9e3779b1
  s_add_u32 s74, s74, 0x7f4a7c15
  s_bfe_u32 s32, s74, 0x80000
  s_bfe_u32 s33, s74, 0x80008
  s_bfe_u32 s34, s74, 0x80010
  s_bfe_u32 s35, s74, 0x80018
  s_cmp_eq_u32 s13, 0
  s_cbranch_scc1 L_sv0
  s_bfe_u32 s61, s14, 0x80010
  s_cmp_ge_u32 s61, 32
  s_cbranch_scc1 L_fin
  s_mov_b32 s70, 0
L_pl_28:
  ds_read_b32 v8, v38 offset:256
  s_waitcnt lgkmcnt(0)
  v_cmp_eq_u32 vcc, -1, v8
  s_cmp_eq_u64 vcc, 0
  s_cbranch_scc1 L_pld_29
  s_sleep 16
  s_add_u32 s70, s70, 1
  s_cmp_lt_u32 s70, 1048576
  s_cbranch_scc1 L_pl_28
L_pld_29:
  s_branch L_r_f2
L_sv0:
  s_add_u32 s76, s76, s74
  s_lshr_b32 s49, s2, 5
  s_lshl_b32 s50, s8, 5
  s_add_u32 s49, s49, s50
  s_lshl_b32 s49, s49, 2
  v_mov_b32 v8, s49
  v_mov_b32 v9, s76
  s_mov_b64 exec, 1
  global_store_dword v8, v9, s[42:43] offset:1024 sc1
  s_mov_b64 exec, -1
  s_lshl_b32 s54, s6, 9
  s_add_u32 s54, s54, 0
  s_lshl_b32 s55, s6, 9
  s_add_u32 s55, s55, 128
  s_lshl_b32 s56, s6, 9
  s_add_u32 s56, s56, 256
  s_mov_b32 s70, 0
L_sn_30:
  ds_read_b32 v8, v38 offset:312
  s_waitcnt lgkmcnt(0)
  v_cmp_gt_u32 vcc, 0x8, v8
  s_cmp_eq_u64 vcc, 0
  s_cbranch_scc1 L_snd_31
  s_sleep 16
  s_add_u32 s70, s70, 1
  s_cmp_lt_u32 s70, 2097152
  s_cbranch_scc1 L_sn_30
L_snd_31:
  s_sleep 64
  s_load_dwordx2 s[20:21], s[42:43], s54 offset:65536 glc
  s_load_dwordx2 s[24:25], s[42:43], s55 offset:65536 glc
  s_load_dwordx2 s[28:29], s[42:43], s56 offset:65536 glc
  s_mov_b32 s70, 0
  s_branch L_s3wc
L_s3w:
  s_load_dwordx2 s[20:21], s[42:43], s54 offset:65536 glc
  s_load_dwordx2 s[24:25], s[42:43], s55 offset:65536 glc
  s_load_dwordx2 s[28:29], s[42:43], s56 offset:65536 glc
L_s3wc:
  s_waitcnt lgkmcnt(0)
  s_xor_b32 s68, s21, s74
  s_xor_b32 s69, s25, s74
  s_or_b32 s68, s68, s69
  s_xor_b32 s69, s29, s74
  s_or_b32 s68, s68, s69
  s_cbranch_scc0 L_s3wd
  s_sleep 8
  s_add_u32 s70, s70, 1
  s_cmp_lt_u32 s70, 262144
  s_cbranch_scc1 L_s3w
L_s3wd:
  v_mov_b32 v8, 1
  ds_write_b32 v38, v8 offset:260
  s_mov_b32 s70, 0
L_sn_32:
  ds_read_b32 v8, v38 offset:312
  s_waitcnt lgkmcnt(0)
  v_cmp_gt_u32 vcc, 0xc, v8
  s_cmp_eq_u64 vcc, 0
  s_cbranch_scc1 L_snd_33
  s_sleep 16
  s_add_u32 s70, s70, 1
  s_cmp_lt_u32 s70, 2097152
  s_cbranch_scc1 L_sn_32
L_snd_33:
  s_load_dwordx2 s[20:21], s[42:43], s54 offset:98304 glc
  s_load_dwordx2 s[24:25], s[42:43], s55 offset:98304 glc
  s_load_dwordx2 s[28:29], s[42:43], s56 offset:98304 glc
  s_mov_b32 s70, 0
  s_branch L_s3sc
L_s3s:
  s_load_dwordx2 s[20:21], s[42:43], s54 offset:98304 glc
  s_load_dwordx2 s[24:25], s[42:43], s55 offset:98304 glc
  s_load_dwordx2 s[28:29], s[42:43], s56 offset:98304 glc
L_s3sc:
  s_waitcnt lgkmcnt(0)
  s_xor_b32 s68, s21, s74
  s_xor_b32 s69, s25, s74
  s_or_b32 s68, s68, s69
  s_xor_b32 s69, s29, s74
  s_or_b32 s68, s68, s69
  s_cbranch_scc0 L_s3sd
  s_sleep 8
  s_add_u32 s70, s70, 1
  s_cmp_lt_u32 s70, 262144
  s_cbranch_scc1 L_s3s
L_s3sd:
  ds_write_b32 v38, v38 offset:256
  s_branch L_fin
L_team:
  s_and_b32 s5, s13, 3
  v_and_b32 v0, 0xff, v0
  v_mov_b32 v38, 0
  s_mov_b32 s77, 0
  s_lshr_b32 s60, s2, 5
  v_lshrrev_b32 v12, 3, v0
  v_lshlrev_b32 v12, 5, v12
  v_bfe_u32 v3, v1, 2, 1
  v_lshl_add_u32 v12, v3, 10, v12
  v_and_b32 v8, 3, v1
  v_lshl_add_u32 v37, v8, 3, v12
  v_and_b32 v12, 0xffffffdf, v12
  v_lshl_add_u32 v12, v8, 4, v12
  v_bfe_u32 v8, v1, 3, 1
  v_lshl_add_u32 v12, v8, 3, v12
  v_lshl_add_u32 v12, v3, 5, v12
  s_waitcnt lgkmcnt(0)
  s_load_dword s74, s[42:43], 0
  s_barrier
  s_cmp_ge_u32 s13, 8
  s_cbranch_scc1 L_r_mod
L_r_q:
  s_lshl3_add_u32 s61, s8, s60
  s_lshl_b32 s48, s61, 7
  s_lshl_b32 s58, s61, 8
  s_add_u32 s58, s58, 32768
  global_load_dwordx2 v[14:15], v37, s[16:17]
  s_mov_b32 s44, s22
  s_mov_b32 s45, s23
  s_mov_b32 s46, 4194304
  s_mov_b32 s47, 0x20000
  s_cmp_ge_u32 s60, 2
  s_cbranch_scc1 L_q_go
  s_mov_b32 s70, 0
L_sn_34:
  ds_read_b32 v8, v38 offset:268
  s_waitcnt lgkmcnt(0)
  v_cmp_gt_u32 vcc, 0x4, v8
  s_cmp_eq_u64 vcc, 0
  s_cbranch_scc1 L_snd_35
  s_sleep 1
  s_add_u32 s70, s70, 1
  s_cmp_lt_u32 s70, 2097152
  s_cbranch_scc1 L_sn_34
L_snd_35:
L_q_go:
  v_lshrrev_b32 v2, 3, v1
  v_and_b32 v3, 6, v2
  v_xor_b32 v3, v3, v1
  v_mul_u32_u24 v2, 8192, v2
  v_and_b32 v3, 7, v3
  v_lshl_add_u32 v2, v3, 4, v2
  s_mul_i32 s49, s5, 1048576
  s_lshl_b32 s50, s5, 14
  s_add_u32 s49, s49, s48
  s_add_u32 s50, s50, 12288
  s_add_u32 s51, s50, 16384
L_dma_36:
  s_mov_b32 m0, s50
  s_add_u32 s50, s50, 1024
  buffer_load_dwordx4 v2, s[44:47], s49 offen nt lds
  s_add_u32 s49, s49, 65536
  s_cmp_lt_u32 s50, s51
  s_cbranch_scc1 L_dma_36
L_dmae_37:
  v_mov_b32 v3, 1
  s_mov_b64 exec, 1
  ds_add_u32 v38, v3 offset:264
  s_mov_b64 exec, -1
  s_waitcnt lgkmcnt(0)
  s_mul_i32 s74, s74, 0x9e3779b1
  s_add_u32 s74, s74, 0x7f4a7c15
  v_bfe_u32 v6, v1, 2, 1
  v_lshlrev_b32 v6, 5, v6
  v_add_u32 v6, 3136, v6
  s_lshl_b32 s49, s5, 3
  v_add_u32 v5, s49, v6
  s_waitcnt vmcnt(16)
  v_lshlrev_b32 v20, 16, v14
  v_and_b32 v21, s73, v14
  v_lshlrev_b32 v22, 16, v15
  v_and_b32 v23, s73, v15
  v_add_f32 v8, v20, v21
  v_mul_f32 v9, v20, v20
  v_add_f32 v10, v22, v23
  v_mul_f32 v11, v22, v22
  v_fmac_f32 v9, v21, v21
  v_fmac_f32 v11, v23, v23
  v_add_f32 v8, v8, v10
  v_add_f32 v9, v9, v11
  s_nop 0
  v_add_f32_dpp v8, v8, v8 quad_perm:[1,0,3,2] row_mask:0xf bank_mask:0xf
  v_add_f32_dpp v9, v9, v9 quad_perm:[1,0,3,2] row_mask:0xf bank_mask:0xf
  s_nop 0
  v_add_f32_dpp v8, v8, v8 quad_perm:[2,3,0,1] row_mask:0xf bank_mask:0xf
  v_add_f32_dpp v9, v9, v9 quad_perm:[2,3,0,1] row_mask:0xf bank_mask:0xf
  s_nop 0
  v_add_f32_dpp v8, v8, v8 row_ror:8 row_mask:0xf bank_mask:0xf
  v_add_f32_dpp v9, v9, v9 row_ror:8 row_mask:0xf bank_mask:0xf
  s_nop 0
  v_mov_b32 v10, v8
  v_mov_b32 v11, v9
  s_nop 0
  v_permlane16_swap_b32 v10, v8
  v_permlane16_swap_b32 v11, v9
  v_add_f32 v8, v8, v10
  v_add_f32 v9, v9, v11
  v_mov_b32 v10, v8
  v_mov_b32 v11, v9
  s_nop 0
  v_permlane32_swap_b32 v10, v8
  v_permlane32_swap_b32 v11, v9
  v_add_f32 v8, v8, v10
  v_add_f32 v9, v9, v11
  ds_write_b64 v5, v[8:9]
  s_waitcnt vmcnt(0) lgkmcnt(0)
  s_add_u32 s77, s77, 4
  v_mov_b32 v9, 1
  s_mov_b64 exec, 1
  ds_add_u32 v38, v9 offset:312
  s_mov_b64 exec, -1
  s_mov_b32 s70, 0
L_hy_38:
  ds_read_b32 v9, v38 offset:312
  s_waitcnt lgkmcnt(0)
  v_cmp_gt_u32 vcc, s77, v9
  s_cmp_eq_u64 vcc, 0
  s_cbranch_scc1 L_hyd_39
  s_add_u32 s70, s70, 1
  s_cmp_lt_u32 s70, 2097152
  s_cbranch_scc1 L_hy_38
L_hyd_39:
  ds_read_b128 v[24:27], v6
  ds_read_b128 v[28:31], v6 offset:16
  s_waitcnt lgkmcnt(0)
  v_pk_add_f32 v[24:25], v[24:25], v[26:27]
  v_pk_add_f32 v[28:29], v[28:29], v[30:31]
  v_pk_add_f32 v[24:25], v[24:25], v[28:29]
  v_mul_f32 v8, 0x3b000000, v24
  v_mul_f32 v9, 0x3b000000, v25
  v_fma_f32 v9, -v8, v8, v9
  v_cvt_pk_bf16_f32 v8, 0, v8
  v_max_f32 v9, 0, v9
  v_cvt_pk_bf16_f32 v9, 0, v9
  v_sub_f32 v20, v20, v8
  v_sub_f32 v21, v21, v8
  v_add_f32 v9, 0x3727c5ac, v9
  v_sub_f32 v22, v22, v8
  v_sub_f32 v23, v23, v8
  v_cvt_pk_bf16_f32 v9, 0, v9
  v_cvt_pk_bf16_f32 v20, 0, v20
  v_sqrt_f32 v9, v9
  v_cvt_pk_bf16_f32 v21, 0, v21
  v_cvt_pk_bf16_f32 v9, 0, v9
  v_cvt_pk_bf16_f32 v22, 0, v22
  v_rcp_f32 v9, v9
  v_cvt_pk_bf16_f32 v23, 0, v23
  v_mul_f32 v20, v20, v9
  v_mul_f32 v21, v21, v9
  v_mul_f32 v22, v22, v9
  v_mul_f32 v23, v23, v9
  v_cvt_pk_bf16_f32 v20, 0, v20
  v_cvt_pk_bf16_f32 v21, 0, v21
  v_cvt_pk_bf16_f32 v22, 0, v22
  v_cvt_pk_bf16_f32 v23, 0, v23
  s_lshl_b32 s49, s8, 13
  s_add_u32 s49, s49, 917504
  v_lshl_add_u32 v15, v0, 4, s49
  v_add_u32 v36, 0x1000, v15
  s_mov_b64 s[64:65], -1
  s_mov_b64 s[66:67], -1
  s_mov_b64 exec, s[64:65]
  global_load_dwordx4 v[16:19], v15, s[42:43] sc1
  s_mov_b64 exec, s[66:67]
  global_load_dwordx4 v[32:35], v36, s[42:43] sc1
  s_mov_b64 exec, -1
  v_lshrrev_b32 v2, 2, v1
  v_bfe_u32 v3, v1, 1, 1
  s_lshl_b32 s49, s5, 1
  v_or_b32 v3, s49, v3
  v_and_b32 v10, 6, v2
  v_xor_b32 v3, v3, v10
  v_lshlrev_b32 v2, 7, v2
  v_lshl_add_u32 v2, v3, 4, v2
  v_and_b32 v3, 1, v1
  v_lshl_add_u32 v2, v3, 3, v2
  v_add_u32 v2, 12288, v2
  ds_read_b64_tr_b16 v[40:41], v2 offset:0
  ds_read_b64_tr_b16 v[42:43], v2 offset:2048
  ds_read_b64_tr_b16 v[44:45], v2 offset:4096
  ds_read_b64_tr_b16 v[46:47], v2 offset:6144
  ds_read_b64_tr_b16 v[48:49], v2 offset:8192
  ds_read_b64_tr_b16 v[50:51], v2 offset:10240
  ds_read_b64_tr_b16 v[52:53], v2 offset:12288
  ds_read_b64_tr_b16 v[54:55], v2 offset:14336
  ds_read_b64_tr_b16 v[56:57], v2 offset:16384
  ds_read_b64_tr_b16 v[58:59], v2 offset:18432
  ds_read_b64_tr_b16 v[60:61], v2 offset:20480
  ds_read_b64_tr_b16 v[62:63], v2 offset:22528
  s_waitcnt lgkmcnt(10)
  ds_read_b64_tr_b16 v[64:65], v2 offset:24576
  ds_read_b64_tr_b16 v[66:67], v2 offset:26624
  s_waitcnt lgkmcnt(10)
  ds_read_b64_tr_b16 v[68:69], v2 offset:28672
  ds_read_b64_tr_b16 v[70:71], v2 offset:30720
  s_waitcnt lgkmcnt(10)
  ds_read_b64_tr_b16 v[72:73], v2 offset:32768
  ds_read_b64_tr_b16 v[74:75], v2 offset:34816
  s_waitcnt lgkmcnt(10)
  ds_read_b64_tr_b16 v[76:77], v2 offset:36864
  ds_read_b64_tr_b16 v[78:79], v2 offset:38912
  s_waitcnt lgkmcnt(10)
  ds_read_b64_tr_b16 v[80:81], v2 offset:40960
  ds_read_b64_tr_b16 v[82:83], v2 offset:43008
  s_waitcnt lgkmcnt(10)
  ds_read_b64_tr_b16 v[84:85], v2 offset:45056
  ds_read_b64_tr_b16 v[86:87], v2 offset:47104
  s_waitcnt lgkmcnt(10)
  ds_read_b64_tr_b16 v[88:89], v2 offset:49152
  ds_read_b64_tr_b16 v[90:91], v2 offset:51200
  s_waitcnt lgkmcnt(10)
  ds_read_b64_tr_b16 v[92:93], v2 offset:53248
  ds_read_b64_tr_b16 v[94:95], v2 offset:55296
  s_waitcnt lgkmcnt(10)
  ds_read_b64_tr_b16 v[96:97], v2 offset:57344
  ds_read_b64_tr_b16 v[98:99], v2 offset:59392
  s_waitcnt lgkmcnt(10)
  ds_read_b64_tr_b16 v[100:101], v2 offset:61440
  ds_read_b64_tr_b16 v[102:103], v2 offset:63488
  s_waitcnt lgkmcnt(10)
  s_waitcnt lgkmcnt(0)
  v_and_b32 v13, 1, v1
  v_lshlrev_b32 v13, 14, v13
  v_lshrrev_b32 v3, 4, v1
  v_lshl_add_u32 v13, v3, 4, v13
  s_lshl_b32 s49, s5, 6
  s_add_u32 s49, s49, s58
  v_add_u32 v13, s49, v13
  v_and_b32 v14, 1, v1
  v_mul_u32_u24 v14, 1056, v14
  v_lshrrev_b32 v3, 4, v1
  v_lshl_add_u32 v14, v3, 4, v14
  v_add_u32 v14, 1024, v14
  s_mov_b32 s70, 0
  s_branch L_q_c
L_q_p:
  s_mov_b64 exec, s[64:65]
  global_load_dwordx4 v[16:19], v15, s[42:43] sc1
  s_mov_b64 exec, s[66:67]
  global_load_dwordx4 v[32:35], v36, s[42:43] sc1
  s_mov_b64 exec, -1
L_q_c:
  s_waitcnt vmcnt(0)
  v_cmp_ne_u32 s[64:65], s74, v17
  v_cmp_ne_u32 s[68:69], s74, v19
  s_or_b64 s[64:65], s[64:65], s[68:69]
  v_cmp_ne_u32 s[66:67], s74, v33
  v_cmp_ne_u32 s[68:69], s74, v35
  s_or_b64 s[66:67], s[66:67], s[68:69]
  s_or_b64 vcc, s[64:65], s[66:67]
  s_or_b32 s64, s64, 1
  s_or_b32 s66, s66, 1
  s_cmp_eq_u64 vcc, 0
  s_cbranch_scc1 L_q_ok
  s_sleep 2
  s_add_u32 s70, s70, 1
  s_cmp_lt_u32 s70, 262144
  s_cbranch_scc1 L_q_p
L_q_ok:
  v_lshlrev_b32 v28, 16, v32
  v_and_b32 v29, s73, v32
  v_lshlrev_b32 v30, 16, v34
  v_and_b32 v31, s73, v34
  v_lshlrev_b32 v24, 16, v16
  v_and_b32 v25, s73, v16
  v_lshlrev_b32 v26, 16, v18
  v_and_b32 v27, s73, v18
  v_add_f32 v28, 1.0, v28
  v_add_f32 v29, 1.0, v29
  v_add_f32 v30, 1.0, v30
  v_add_f32 v31, 1.0, v31
  v_cvt_pk_bf16_f32 v28, 0, v28
  v_cvt_pk_bf16_f32 v29, 0, v29
  v_cvt_pk_bf16_f32 v30, 0, v30
  v_cvt_pk_bf16_f32 v31, 0, v31
  v_mul_f32 v20, v20, v28
  v_mul_f32 v21, v21, v29
  v_mul_f32 v22, v22, v30
  v_mul_f32 v23, v23, v31
  v_cvt_pk_bf16_f32 v20, 0, v20
  v_cvt_pk_bf16_f32 v21, 0, v21
  v_cvt_pk_bf16_f32 v22, 0, v22
  v_cvt_pk_bf16_f32 v23, 0, v23
  v_add_f32 v20, v20, v24
  v_add_f32 v21, v21, v25
  v_add_f32 v22, v22, v26
  v_add_f32 v23, v23, v27
  v_cvt_pk_bf16_f32 v16, v20, v21
  v_cvt_pk_bf16_f32 v17, v22, v23
  ds_write_b64 v12, v[16:17] offset:1024
  s_add_u32 s77, s77, 4
  v_mov_b32 v9, 1
  s_mov_b64 exec, 1
  ds_add_u32 v38, v9 offset:312
  s_mov_b64 exec, -1
  s_mov_b32 s70, 0
L_hy_40:
  ds_read_b32 v9, v38 offset:312
  s_waitcnt lgkmcnt(0)
  v_cmp_gt_u32 vcc, s77, v9
  s_cmp_eq_u64 vcc, 0
  s_cbranch_scc1 L_hyd_41
  s_add_u32 s70, s70, 1
  s_cmp_lt_u32 s70, 2097152
  s_cbranch_scc1 L_hy_40
L_hyd_41:
  ds_read_b128 v[104:107], v14 offset:0
  ds_read_b128 v[108:111], v14 offset:64
  ds_read_b128 v[112:115], v14 offset:128
  ds_read_b128 v[116:119], v14 offset:192
  ds_read_b128 v[120:123], v14 offset:256
  ds_read_b128 v[124:127], v14 offset:320
  ds_read_b128 v[128:131], v14 offset:384
  ds_read_b128 v[132:135], v14 offset:448
  ds_read_b128 v[136:139], v14 offset:512
  ds_read_b128 v[140:143], v14 offset:576
  ds_read_b128 v[144:147], v14 offset:640
  ds_read_b128 v[148:151], v14 offset:704
  s_waitcnt lgkmcnt(11)
  v_mfma_f32_16x16x32_bf16 v[8:11], v[40:43], v[104:107], 0
  ds_read_b128 v[152:155], v14 offset:768
  s_waitcnt lgkmcnt(11)
  v_mfma_f32_16x16x32_bf16 v[8:11], v[44:47], v[108:111], v[8:11]
  ds_read_b128 v[156:159], v14 offset:832
  s_waitcnt lgkmcnt(11)
  v_mfma_f32_16x16x32_bf16 v[8:11], v[48:51], v[112:115], v[8:11]
  ds_read_b128 v[160:163], v14 offset:896
  s_waitcnt lgkmcnt(11)
  v_mfma_f32_16x16x32_bf16 v[8:11], v[52:55], v[116:119], v[8:11]
  ds_read_b128 v[164:167], v14 offset:960
  s_waitcnt lgkmcnt(11)
  v_mfma_f32_16x16x32_bf16 v[8:11], v[56:59], v[120:123], v[8:11]
  s_waitcnt lgkmcnt(10)
  v_mfma_f32_16x16x32_bf16 v[8:11], v[60:63], v[124:127], v[8:11]
  s_waitcnt lgkmcnt(9)
  v_mfma_f32_16x16x32_bf16 v[8:11], v[64:67], v[128:131], v[8:11]
  s_waitcnt lgkmcnt(8)
  v_mfma_f32_16x16x32_bf16 v[8:11], v[68:71], v[132:135], v[8:11]
  s_waitcnt lgkmcnt(7)
  v_mfma_f32_16x16x32_bf16 v[8:11], v[72:75], v[136:139], v[8:11]
  s_waitcnt lgkmcnt(6)
  v_mfma_f32_16x16x32_bf16 v[8:11], v[76:79], v[140:143], v[8:11]
  s_waitcnt lgkmcnt(5)
  v_mfma_f32_16x16x32_bf16 v[8:11], v[80:83], v[144:147], v[8:11]
  s_waitcnt lgkmcnt(4)
  v_mfma_f32_16x16x32_bf16 v[8:11], v[84:87], v[148:151], v[8:11]
  s_waitcnt lgkmcnt(3)
  v_mfma_f32_16x16x32_bf16 v[8:11], v[88:91], v[152:155], v[8:11]
  s_waitcnt lgkmcnt(2)
  v_mfma_f32_16x16x32_bf16 v[8:11], v[92:95], v[156:159], v[8:11]
  s_waitcnt lgkmcnt(1)
  v_mfma_f32_16x16x32_bf16 v[8:11], v[96:99], v[160:163], v[8:11]
  s_waitcnt lgkmcnt(0)
  v_mfma_f32_16x16x32_bf16 v[8:11], v[100:103], v[164:167], v[8:11]
  s_nop 7
  v_cvt_pk_bf16_f32 v8, v8, v9
  v_cvt_pk_bf16_f32 v10, v10, v11
  v_mov_b32 v9, s74
  v_mov_b32 v11, s74
  v_min_u32 v8, s72, v8
  v_min_u32 v10, s72, v10
  s_mov_b32 exec_lo, 0x00030003
  s_mov_b32 exec_hi, 0x00030003
  global_store_dwordx4 v13, v[8:11], s[42:43] sc1
  s_mov_b64 exec, -1
L_r_wo:
  s_xor_b32 s61, s60, 1
  s_lshl_b32 s48, s8, 19
  s_lshl_b32 s49, s61, 7
  s_add_u32 s48, s48, s49
  s_lshr_b32 s58, s8, 1
  s_lshl_b32 s58, s58, 14
  s_and_b32 s49, s8, 1
  s_lshl_b32 s49, s49, 12
  s_add_u32 s58, s58, s49
  s_lshl_b32 s49, s61, 9
  s_add_u32 s58, s58, s49
  s_add_u32 s58, s58, 2097152
  s_mov_b32 s44, s24
  s_mov_b32 s45, s25
  s_mov_b32 s46, 4194304
  s_mov_b32 s47, 0x20000
  v_lshrrev_b32 v2, 3, v1
  v_and_b32 v3, 6, v2
  v_xor_b32 v3, v3, v1
  v_mul_u32_u24 v2, 1024, v2
  v_and_b32 v3, 7, v3
  v_lshl_add_u32 v2, v3, 4, v2
  s_mul_i32 s49, s5, 131072
  s_lshl_b32 s50, s5, 14
  s_add_u32 s49, s49, s48
  s_add_u32 s50, s50, 12288
  s_add_u32 s51, s50, 16384
L_dma_42:
  s_mov_b32 m0, s50
  s_add_u32 s50, s50, 1024
  buffer_load_dwordx4 v2, s[44:47], s49 offen nt lds
  s_add_u32 s49, s49, 8192
  s_waitcnt vmcnt(2)
  s_cmp_lt_u32 s50, s51
  s_cbranch_scc1 L_dma_42
L_dmae_43:
  s_bfe_u32 s32, s74, 0x80000
  s_bfe_u32 s33, s74, 0x80008
  s_bfe_u32 s34, s74, 0x80010
  s_bfe_u32 s35, s74, 0x80018
  s_lshl2_add_u32 s49, s8, s5
  s_lshl_b32 s49, s49, 11
  s_add_u32 s49, s49, 131072
  v_lshrrev_b32 v12, 5, v1
  v_and_b32 v16, 31, v1
  v_lshlrev_b32 v15, 16, v12
  v_lshl_add_u32 v15, v16, 4, v15
  v_add_u32 v15, s49, v15
  v_mul_u32_u24 v12, 1056, v12
  v_bfe_u32 v16, v1, 3, 2
  v_lshl_add_u32 v12, v16, 6, v12
  v_and_b32 v16, 3, v1
  v_lshl_add_u32 v12, v16, 4, v12
  v_bfe_u32 v16, v1, 2, 1
  v_lshl_add_u32 v12, v16, 3, v12
  s_lshl_b32 s49, s5, 8
  v_add_u32 v12, s49, v12
  v_and_b32 v13, 1, v1
  v_lshlrev_b32 v13, 6, v13
  v_lshrrev_b32 v3, 4, v1
  v_lshl_add_u32 v13, v3, 4, v13
  s_lshl_b32 s49, s5, 7
  s_add_u32 s49, s49, s58
  v_add_u32 v13, s49, v13
  v_bfe_u32 v3, v1, 1, 1
  v_lshl_add_u32 v13, v3, 16, v13
  v_mov_b32 v36, 0xff
  global_load_dword v11, v13, s[42:43] sc1
  s_waitcnt vmcnt(0)
  s_add_u32 s77, s77, 4
  v_mov_b32 v9, 1
  s_mov_b64 exec, 1
  ds_add_u32 v38, v9 offset:312
  s_mov_b64 exec, -1
  s_mov_b32 s70, 0
L_hy_44:
  ds_read_b32 v9, v38 offset:312
  s_waitcnt lgkmcnt(0)
  v_cmp_gt_u32 vcc, s77, v9
  s_cmp_eq_u64 vcc, 0
  s_cbranch_scc1 L_hyd_45
  s_sleep 4
  s_add_u32 s70, s70, 1
  s_cmp_lt_u32 s70, 2097152
  s_cbranch_scc1 L_hy_44
L_hyd_45:
  v_lshrrev_b32 v2, 2, v1
  v_bfe_u32 v3, v1, 1, 1
  s_lshl_b32 s49, s5, 1
  v_or_b32 v3, s49, v3
  v_and_b32 v10, 6, v2
  v_xor_b32 v3, v3, v10
  v_lshlrev_b32 v2, 7, v2
  v_lshl_add_u32 v2, v3, 4, v2
  v_and_b32 v3, 1, v1
  v_lshl_add_u32 v2, v3, 3, v2
  v_add_u32 v2, 12288, v2
  ds_read_b64_tr_b16 v[40:41], v2 offset:0
  ds_read_b64_tr_b16 v[42:43], v2 offset:2048
  ds_read_b64_tr_b16 v[44:45], v2 offset:4096
  ds_read_b64_tr_b16 v[46:47], v2 offset:6144
  ds_read_b64_tr_b16 v[48:49], v2 offset:8192
  ds_read_b64_tr_b16 v[50:51], v2 offset:10240
  ds_read_b64_tr_b16 v[52:53], v2 offset:12288
  ds_read_b64_tr_b16 v[54:55], v2 offset:14336
  ds_read_b64_tr_b16 v[56:57], v2 offset:16384
  ds_read_b64_tr_b16 v[58:59], v2 offset:18432
  ds_read_b64_tr_b16 v[60:61], v2 offset:20480
  ds_read_b64_tr_b16 v[62:63], v2 offset:22528
  s_waitcnt lgkmcnt(10)
  ds_read_b64_tr_b16 v[64:65], v2 offset:24576
  ds_read_b64_tr_b16 v[66:67], v2 offset:26624
  s_waitcnt lgkmcnt(10)
  ds_read_b64_tr_b16 v[68:69], v2 offset:28672
  ds_read_b64_tr_b16 v[70:71], v2 offset:30720
  s_waitcnt lgkmcnt(10)
  ds_read_b64_tr_b16 v[72:73], v2 offset:32768
  ds_read_b64_tr_b16 v[74:75], v2 offset:34816
  s_waitcnt lgkmcnt(10)
  ds_read_b64_tr_b16 v[76:77], v2 offset:36864
  ds_read_b64_tr_b16 v[78:79], v2 offset:38912
  s_waitcnt lgkmcnt(10)
  ds_read_b64_tr_b16 v[80:81], v2 offset:40960
  ds_read_b64_tr_b16 v[82:83], v2 offset:43008
  s_waitcnt lgkmcnt(10)
  ds_read_b64_tr_b16 v[84:85], v2 offset:45056
  ds_read_b64_tr_b16 v[86:87], v2 offset:47104
  s_waitcnt lgkmcnt(10)
  ds_read_b64_tr_b16 v[88:89], v2 offset:49152
  ds_read_b64_tr_b16 v[90:91], v2 offset:51200
  s_waitcnt lgkmcnt(10)
  ds_read_b64_tr_b16 v[92:93], v2 offset:53248
  ds_read_b64_tr_b16 v[94:95], v2 offset:55296
  s_waitcnt lgkmcnt(10)
  ds_read_b64_tr_b16 v[96:97], v2 offset:57344
  ds_read_b64_tr_b16 v[98:99], v2 offset:59392
  s_waitcnt lgkmcnt(10)
  ds_read_b64_tr_b16 v[100:101], v2 offset:61440
  ds_read_b64_tr_b16 v[102:103], v2 offset:63488
  s_waitcnt lgkmcnt(10)
  s_waitcnt lgkmcnt(0)
  s_mov_b32 s70, 0
L_pl_46:
  ds_read_b32 v8, v38 offset:256
  s_waitcnt lgkmcnt(0)
  v_cmp_eq_u32 vcc, -1, v8
  s_cmp_eq_u64 vcc, 0
  s_cbranch_scc1 L_pld_47
  s_sleep 8
  s_add_u32 s70, s70, 1
  s_cmp_lt_u32 s70, 1048576
  s_cbranch_scc1 L_pl_46
L_pld_47:
  s_mov_b64 s[20:21], -1
  s_mov_b64 s[22:23], -1
  s_mov_b64 s[24:25], -1
  s_mov_b64 exec, s[20:21]
  global_load_dwordx4 v[152:155], v15, s[42:43] offset:0 sc1
  s_mov_b64 exec, s[22:23]
  global_load_dwordx4 v[156:159], v15, s[42:43] offset:512 sc1
  s_mov_b64 exec, s[24:25]
  global_load_dwordx4 v[160:163], v15, s[42:43] offset:1024 sc1
  s_mov_b64 exec, -1
  s_waitcnt vmcnt(0)
  s_mov_b32 s70, 0
  s_branch L_wo_c
L_wo_:
  s_mov_b64 exec, s[20:21]
  global_load_dwordx4 v[152:155], v15, s[42:43] offset:0 sc1
  s_mov_b64 exec, s[22:23]
  global_load_dwordx4 v[156:159], v15, s[42:43] offset:512 sc1
  s_mov_b64 exec, s[24:25]
  global_load_dwordx4 v[160:163], v15, s[42:43] offset:1024 sc1
  s_mov_b64 exec, -1
  s_waitcnt vmcnt(0)
L_wo_c:
  v_xor_b32 v136, s32, v152
  v_xor_b32 v137, s33, v153
  v_xor_b32 v138, s34, v154
  v_xor_b32 v139, s35, v155
  v_xor_b32 v140, s32, v156
  v_xor_b32 v141, s33, v157
  v_xor_b32 v142, s34, v158
  v_xor_b32 v143, s35, v159
  v_xor_b32 v144, s32, v160
  v_xor_b32 v145, s33, v161
  v_xor_b32 v146, s34, v162
  v_xor_b32 v147, s35, v163
  v_or3_b32 v28, v136, v137, v138
  v_or3_b32 v29, v140, v141, v142
  v_or3_b32 v30, v144, v145, v146
  v_or_b32 v28, v28, v139
  v_or_b32 v29, v29, v143
  v_or_b32 v30, v30, v147
  v_cmp_ne_u32_sdwa s[20:21], v28, v38 src0_sel:BYTE_0 src1_sel:DWORD
  v_cmp_ne_u32_sdwa s[22:23], v29, v38 src0_sel:BYTE_0 src1_sel:DWORD
  v_cmp_ne_u32_sdwa s[24:25], v30, v38 src0_sel:BYTE_0 src1_sel:DWORD
  v_or_b32 v136, 0x80, v136
  v_or_b32 v137, 0x80, v137
  v_or_b32 v138, 0x80, v138
  v_or_b32 v139, 0x80, v139
  v_or_b32 v140, 0x80, v140
  v_or_b32 v141, 0x80, v141
  v_or_b32 v142, 0x80, v142
  v_or_b32 v143, 0x80, v143
  v_or_b32 v144, 0x80, v144
  v_or_b32 v145, 0x80, v145
  v_or_b32 v146, 0x80, v146
  v_or_b32 v147, 0x80, v147
  v_pk_add_f32 v[16:17], v[136:137], v[140:141]
  v_pk_add_f32 v[18:19], v[138:139], v[142:143]
  v_pk_add_f32 v[16:17], v[16:17], v[144:145]
  v_pk_add_f32 v[18:19], v[18:19], v[146:147]
  s_mov_b64 vcc, s[20:21]
  s_or_b64 vcc, vcc, s[22:23]
  s_or_b64 vcc, vcc, s[24:25]
  s_or_b32 s20, s20, 1
  s_or_b32 s22, s22, 1
  s_or_b32 s24, s24, 1
  s_cmp_eq_u64 vcc, 0
  s_cbranch_scc1 L_wo_ok
  s_add_u32 s70, s70, 1
  s_cmp_lt_u32 s70, 262144
  s_cbranch_scc1 L_wo_
L_wo_ok:
  v_cvt_pk_bf16_f32 v8, v16, v17
  v_cvt_pk_bf16_f32 v9, v18, v19
  ds_write_b64 v12, v[8:9] offset:1024
  s_add_u32 s77, s77, 4
  v_mov_b32 v3, 1
  s_mov_b64 exec, 1
  ds_add_u32 v38, v3 offset:312
  s_mov_b64 exec, -1
  s_mov_b32 s70, 0
L_hy_48:
  ds_read_b32 v3, v38 offset:312
  ds_read_b128 v[104:107], v14 offset:0
  ds_read_b128 v[108:111], v14 offset:64
  ds_read_b128 v[112:115], v14 offset:128
  ds_read_b128 v[116:119], v14 offset:192
  s_waitcnt lgkmcnt(4)
  v_cmp_gt_u32 vcc, s77, v3
  s_cmp_eq_u64 vcc, 0
  s_cbranch_scc1 L_hyd_49
  s_waitcnt lgkmcnt(0)
  s_add_u32 s70, s70, 1
  s_cmp_lt_u32 s70, 2097152
  s_cbranch_scc1 L_hy_48
L_hyd_49:
  ds_read_b128 v[120:123], v14 offset:256
  ds_read_b128 v[124:127], v14 offset:320
  ds_read_b128 v[128:131], v14 offset:384
  ds_read_b128 v[132:135], v14 offset:448
  ds_read_b128 v[136:139], v14 offset:512
  ds_read_b128 v[140:143], v14 offset:576
  ds_read_b128 v[144:147], v14 offset:640
  ds_read_b128 v[148:151], v14 offset:704
  s_waitcnt lgkmcnt(11)
  v_mfma_f32_16x16x32_bf16 v[8:11], v[40:43], v[104:107], 0
  s_waitcnt lgkmcnt(10)
  v_mfma_f32_16x16x32_bf16 v[8:11], v[44:47], v[108:111], v[8:11]
  ds_read_b128 v[104:107], v14 offset:768
  s_waitcnt lgkmcnt(10)
  v_mfma_f32_16x16x32_bf16 v[8:11], v[48:51], v[112:115], v[8:11]
  ds_read_b128 v[108:111], v14 offset:832
  s_waitcnt lgkmcnt(10)
  v_mfma_f32_16x16x32_bf16 v[8:11], v[52:55], v[116:119], v[8:11]
  ds_read_b128 v[112:115], v14 offset:896
  s_waitcnt lgkmcnt(10)
  v_mfma_f32_16x16x32_bf16 v[8:11], v[56:59], v[120:123], v[8:11]
  ds_read_b128 v[116:119], v14 offset:960
  s_waitcnt lgkmcnt(10)
  v_mfma_f32_16x16x32_bf16 v[8:11], v[60:63], v[124:127], v[8:11]
  s_waitcnt lgkmcnt(9)
  v_mfma_f32_16x16x32_bf16 v[8:11], v[64:67], v[128:131], v[8:11]
  s_waitcnt lgkmcnt(8)
  v_mfma_f32_16x16x32_bf16 v[8:11], v[68:71], v[132:135], v[8:11]
  s_waitcnt lgkmcnt(7)
  v_mfma_f32_16x16x32_bf16 v[8:11], v[72:75], v[136:139], v[8:11]
  s_waitcnt lgkmcnt(6)
  v_mfma_f32_16x16x32_bf16 v[8:11], v[76:79], v[140:143], v[8:11]
  s_waitcnt lgkmcnt(5)
  v_mfma_f32_16x16x32_bf16 v[8:11], v[80:83], v[144:147], v[8:11]
  s_waitcnt lgkmcnt(4)
  v_mfma_f32_16x16x32_bf16 v[8:11], v[84:87], v[148:151], v[8:11]
  s_waitcnt lgkmcnt(3)
  v_mfma_f32_16x16x32_bf16 v[8:11], v[88:91], v[104:107], v[8:11]
  s_waitcnt lgkmcnt(2)
  v_mfma_f32_16x16x32_bf16 v[8:11], v[92:95], v[108:111], v[8:11]
  s_waitcnt lgkmcnt(1)
  v_mfma_f32_16x16x32_bf16 v[8:11], v[96:99], v[112:115], v[8:11]
  s_waitcnt lgkmcnt(0)
  v_mfma_f32_16x16x32_bf16 v[8:11], v[100:103], v[116:119], v[8:11]
  s_nop 7
  v_bfi_b32 v8, v36, s32, v8
  v_bfi_b32 v9, v36, s33, v9
  v_bfi_b32 v10, v36, s34, v10
  v_bfi_b32 v11, v36, s35, v11
  s_mov_b32 exec_lo, 0x000f000f
  s_mov_b32 exec_hi, exec_lo
  global_store_dwordx4 v13, v[8:11], s[42:43] sc1
  v_mov_b32 v3, 1
  s_mov_b64 exec, 1
  ds_add_u32 v38, v3 offset:264
  s_mov_b64 exec, -1
  s_branch L_fin
L_r_mod:
  global_load_dwordx2 v[14:15], v37, s[34:35]
  s_mov_b32 s44, s36
  s_mov_b32 s45, s37
  s_mov_b32 s46, 3145728
  s_mov_b32 s47, 0x20000
  s_cmp_ge_u32 s60, 2
  s_cbranch_scc1 L_mod2
  s_lshl1_add_u32 s61, s8, s60
  s_lshl_b32 s48, s61, 7
  s_lshl_b32 s58, s61, 9
  s_add_u32 s58, s58, 917504
  v_lshrrev_b32 v2, 3, v1
  v_and_b32 v3, 6, v2
  v_xor_b32 v3, v3, v1
  v_mul_u32_u24 v2, 6144, v2
  v_and_b32 v3, 7, v3
  v_lshl_add_u32 v2, v3, 4, v2
  s_mul_i32 s49, s5, 786432
  s_lshl_b32 s50, s5, 14
  s_add_u32 s49, s49, s48
  s_add_u32 s50, s50, 77824
  s_add_u32 s51, s50, 16384
L_dma_50:
  s_mov_b32 m0, s50
  s_add_u32 s50, s50, 1024
  buffer_load_dwordx4 v2, s[44:47], s49 offen nt lds
  s_add_u32 s49, s49, 49152
  s_cmp_lt_u32 s50, s51
  s_cbranch_scc1 L_dma_50
L_dmae_51:
  v_mov_b32 v3, 1
  s_mov_b64 exec, 1
  ds_add_u32 v38, v3 offset:268
  s_mov_b64 exec, -1
  s_getpc_b64 s[56:57]
L_pc_52:
  s_lshr_b32 s3, s2, 5
  s_lshl3_add_u32 s3, s3, s8
  s_lshl_b32 s3, s3, 2
  s_add_u32 s3, s3, L_table-L_pc_52
  s_load_dword s14, s[56:57], s3
  s_waitcnt lgkmcnt(0)
  s_mul_i32 s74, s74, 0x9e3779b1
  s_add_u32 s74, s74, 0x7f4a7c15
  s_waitcnt vmcnt(16)
  v_lshlrev_b32 v16, 16, v14
  v_and_b32 v17, s73, v14
  v_lshlrev_b32 v18, 16, v15
  v_and_b32 v19, s73, v15
  v_mul_f32 v20, 0xbfb8aa3b, v16
  v_mul_f32 v21, 0xbfb8aa3b, v17
  v_mul_f32 v22, 0xbfb8aa3b, v18
  v_mul_f32 v23, 0xbfb8aa3b, v19
  v_exp_f32 v20, v20
  v_exp_f32 v21, v21
  v_exp_f32 v22, v22
  v_exp_f32 v23, v23
  s_nop 0
  v_add_f32 v20, 1.0, v20
  v_add_f32 v21, 1.0, v21
  v_add_f32 v22, 1.0, v22
  v_add_f32 v23, 1.0, v23
  v_rcp_f32 v20, v20
  v_rcp_f32 v21, v21
  v_rcp_f32 v22, v22
  v_rcp_f32 v23, v23
  s_nop 0
  v_mul_f32 v16, v16, v20
  v_mul_f32 v17, v17, v21
  v_mul_f32 v18, v18, v22
  v_mul_f32 v19, v19, v23
  v_cvt_pk_bf16_f32 v14, v16, v17
  v_cvt_pk_bf16_f32 v15, v18, v19
  ds_write_b64 v12, v[14:15] offset:3200
  v_and_b32 v13, 1, v1
  v_lshlrev_b32 v13, 6, v13
  v_lshrrev_b32 v3, 4, v1
  v_lshl_add_u32 v13, v3, 4, v13
  s_lshl_b32 s49, s5, 7
  s_add_u32 s49, s49, s58
  v_add_u32 v13, s49, v13
  v_bfe_u32 v3, v1, 1, 3
  v_lshl_add_u32 v13, v3, 13, v13
  v_and_b32 v14, 1, v1
  v_mul_u32_u24 v14, 1056, v14
  v_lshrrev_b32 v3, 4, v1
  v_lshl_add_u32 v14, v3, 4, v14
  v_add_u32 v14, 3200, v14
  v_lshrrev_b32 v2, 2, v1
  v_bfe_u32 v3, v1, 1, 1
  s_lshl_b32 s49, s5, 1
  v_or_b32 v3, s49, v3
  v_and_b32 v10, 6, v2
  v_xor_b32 v3, v3, v10
  v_lshlrev_b32 v2, 7, v2
  v_lshl_add_u32 v2, v3, 4, v2
  v_and_b32 v3, 1, v1
  v_lshl_add_u32 v2, v3, 3, v2
  v_add_u32 v2, 77824, v2
  s_waitcnt vmcnt(0) lgkmcnt(0)
  s_add_u32 s77, s77, 4
  v_mov_b32 v9, 1
  s_mov_b64 exec, 1
  ds_add_u32 v38, v9 offset:316
  s_mov_b64 exec, -1
  s_mov_b32 s70, 0
L_hy_53:
  ds_read_b32 v9, v38 offset:316
  s_waitcnt lgkmcnt(0)
  v_cmp_gt_u32 vcc, s77, v9
  s_cmp_eq_u64 vcc, 0
  s_cbranch_scc1 L_hyd_54
  s_add_u32 s70, s70, 1
  s_cmp_lt_u32 s70, 2097152
  s_cbranch_scc1 L_hy_53
L_hyd_54:
  ds_read_b64_tr_b16 v[40:41], v2 offset:0
  ds_read_b64_tr_b16 v[42:43], v2 offset:2048
  ds_read_b128 v[104:107], v14 offset:0
  ds_read_b64_tr_b16 v[44:45], v2 offset:4096
  ds_read_b64_tr_b16 v[46:47], v2 offset:6144
  ds_read_b128 v[108:111], v14 offset:64
  ds_read_b64_tr_b16 v[48:49], v2 offset:8192
  ds_read_b64_tr_b16 v[50:51], v2 offset:10240
  ds_read_b128 v[112:115], v14 offset:128
  ds_read_b64_tr_b16 v[52:53], v2 offset:12288
  ds_read_b64_tr_b16 v[54:55], v2 offset:14336
  ds_read_b128 v[116:119], v14 offset:192
  ds_read_b64_tr_b16 v[56:57], v2 offset:16384
  ds_read_b64_tr_b16 v[58:59], v2 offset:18432
  ds_read_b128 v[120:123], v14 offset:256
  s_waitcnt lgkmcnt(12)
  v_mfma_f32_16x16x32_bf16 v[8:11], v[40:43], v[104:107], 0
  ds_read_b64_tr_b16 v[60:61], v2 offset:20480
  ds_read_b64_tr_b16 v[62:63], v2 offset:22528
  ds_read_b128 v[124:127], v14 offset:320
  s_waitcnt lgkmcnt(12)
  v_mfma_f32_16x16x32_bf16 v[8:11], v[44:47], v[108:111], v[8:11]
  ds_read_b64_tr_b16 v[64:65], v2 offset:24576
  ds_read_b64_tr_b16 v[66:67], v2 offset:26624
  ds_read_b128 v[128:131], v14 offset:384
  s_waitcnt lgkmcnt(12)
  v_mfma_f32_16x16x32_bf16 v[8:11], v[48:51], v[112:115], v[8:11]
  ds_read_b64_tr_b16 v[68:69], v2 offset:28672
  ds_read_b64_tr_b16 v[70:71], v2 offset:30720
  ds_read_b128 v[132:135], v14 offset:448
  s_waitcnt lgkmcnt(12)
  v_mfma_f32_16x16x32_bf16 v[8:11], v[52:55], v[116:119], v[8:11]
  ds_read_b64_tr_b16 v[72:73], v2 offset:32768
  ds_read_b64_tr_b16 v[74:75], v2 offset:34816
  ds_read_b128 v[136:139], v14 offset:512
  s_waitcnt lgkmcnt(12)
  v_mfma_f32_16x16x32_bf16 v[8:11], v[56:59], v[120:123], v[8:11]
  ds_read_b64_tr_b16 v[76:77], v2 offset:36864
  ds_read_b64_tr_b16 v[78:79], v2 offset:38912
  ds_read_b128 v[140:143], v14 offset:576
  s_waitcnt lgkmcnt(12)
  v_mfma_f32_16x16x32_bf16 v[8:11], v[60:63], v[124:127], v[8:11]
  ds_read_b64_tr_b16 v[80:81], v2 offset:40960
  ds_read_b64_tr_b16 v[82:83], v2 offset:43008
  ds_read_b128 v[144:147], v14 offset:640
  s_waitcnt lgkmcnt(12)
  v_mfma_f32_16x16x32_bf16 v[8:11], v[64:67], v[128:131], v[8:11]
  ds_read_b64_tr_b16 v[84:85], v2 offset:45056
  ds_read_b64_tr_b16 v[86:87], v2 offset:47104
  ds_read_b128 v[148:151], v14 offset:704
  s_waitcnt lgkmcnt(12)
  v_mfma_f32_16x16x32_bf16 v[8:11], v[68:71], v[132:135], v[8:11]
  ds_read_b64_tr_b16 v[88:89], v2 offset:49152
  ds_read_b64_tr_b16 v[90:91], v2 offset:51200
  ds_read_b128 v[152:155], v14 offset:768
  s_waitcnt lgkmcnt(12)
  v_mfma_f32_16x16x32_bf16 v[8:11], v[72:75], v[136:139], v[8:11]
  ds_read_b64_tr_b16 v[92:93], v2 offset:53248
  ds_read_b64_tr_b16 v[94:95], v2 offset:55296
  ds_read_b128 v[156:159], v14 offset:832
  s_waitcnt lgkmcnt(12)
  v_mfma_f32_16x16x32_bf16 v[8:11], v[76:79], v[140:143], v[8:11]
  ds_read_b64_tr_b16 v[96:97], v2 offset:57344
  ds_read_b64_tr_b16 v[98:99], v2 offset:59392
  ds_read_b128 v[160:163], v14 offset:896
  s_waitcnt lgkmcnt(12)
  v_mfma_f32_16x16x32_bf16 v[8:11], v[80:83], v[144:147], v[8:11]
  ds_read_b64_tr_b16 v[100:101], v2 offset:61440
  ds_read_b64_tr_b16 v[102:103], v2 offset:63488
  ds_read_b128 v[164:167], v14 offset:960
  s_waitcnt lgkmcnt(12)
  v_mfma_f32_16x16x32_bf16 v[8:11], v[84:87], v[148:151], v[8:11]
  s_waitcnt lgkmcnt(9)
  v_mfma_f32_16x16x32_bf16 v[8:11], v[88:91], v[152:155], v[8:11]
  s_waitcnt lgkmcnt(6)
  v_mfma_f32_16x16x32_bf16 v[8:11], v[92:95], v[156:159], v[8:11]
  s_waitcnt lgkmcnt(3)
  v_mfma_f32_16x16x32_bf16 v[8:11], v[96:99], v[160:163], v[8:11]
  s_waitcnt lgkmcnt(0)
  v_mfma_f32_16x16x32_bf16 v[8:11], v[100:103], v[164:167], v[8:11]
  s_nop 7
  v_cvt_pk_bf16_f32 v8, v8, v9
  v_cvt_pk_bf16_f32 v10, v10, v11
  v_mov_b32 v9, s74
  v_mov_b32 v11, s74
  global_store_dwordx4 v13, v[8:11], s[42:43] sc1
  s_mov_b64 exec, -1
  s_add_u32 s77, s77, 4
  v_mov_b32 v9, 1
  s_mov_b64 exec, 1
  ds_add_u32 v38, v9 offset:316
  s_mov_b64 exec, -1
  s_mov_b32 s70, 0
L_hy_55:
  ds_read_b32 v9, v38 offset:316
  s_waitcnt lgkmcnt(0)
  v_cmp_gt_u32 vcc, s77, v9
  s_cmp_eq_u64 vcc, 0
  s_cbranch_scc1 L_hyd_56
  s_add_u32 s70, s70, 1
  s_cmp_lt_u32 s70, 2097152
  s_cbranch_scc1 L_hy_55
L_hyd_56:
  s_branch L_mod3
L_mod2:
  s_getpc_b64 s[56:57]
L_pc_57:
  s_lshr_b32 s3, s2, 5
  s_lshl3_add_u32 s3, s3, s8
  s_lshl_b32 s3, s3, 2
  s_add_u32 s3, s3, L_table-L_pc_57
  s_load_dword s14, s[56:57], s3
  s_waitcnt lgkmcnt(0)
  s_mul_i32 s74, s74, 0x9e3779b1
  s_add_u32 s74, s74, 0x7f4a7c15
  s_waitcnt vmcnt(0)
  v_lshlrev_b32 v16, 16, v14
  v_and_b32 v17, s73, v14
  v_lshlrev_b32 v18, 16, v15
  v_and_b32 v19, s73, v15
  v_mul_f32 v20, 0xbfb8aa3b, v16
  v_mul_f32 v21, 0xbfb8aa3b, v17
  v_mul_f32 v22, 0xbfb8aa3b, v18
  v_mul_f32 v23, 0xbfb8aa3b, v19
  v_exp_f32 v20, v20
  v_exp_f32 v21, v21
  v_exp_f32 v22, v22
  v_exp_f32 v23, v23
  s_nop 0
  v_add_f32 v20, 1.0, v20
  v_add_f32 v21, 1.0, v21
  v_add_f32 v22, 1.0, v22
  v_add_f32 v23, 1.0, v23
  v_rcp_f32 v20, v20
  v_rcp_f32 v21, v21
  v_rcp_f32 v22, v22
  v_rcp_f32 v23, v23
  s_nop 0
  v_mul_f32 v16, v16, v20
  v_mul_f32 v17, v17, v21
  v_mul_f32 v18, v18, v22
  v_mul_f32 v19, v19, v23
  v_cvt_pk_bf16_f32 v14, v16, v17
  v_cvt_pk_bf16_f32 v15, v18, v19
  ds_write_b64 v12, v[14:15] offset:3200
L_mod3:
  s_mov_b32 s70, 0
L_sn_58:
  ds_read_b32 v8, v38 offset:264
  s_waitcnt lgkmcnt(0)
  v_cmp_gt_u32 vcc, 0x4, v8
  s_cmp_eq_u64 vcc, 0
  s_cbranch_scc1 L_snd_59
  s_sleep 4
  s_add_u32 s70, s70, 1
  s_cmp_lt_u32 s70, 2097152
  s_cbranch_scc1 L_sn_58
L_snd_59:
  s_and_b32 s61, s14, 0xff
  s_cmp_ge_u32 s61, 48
  s_cbranch_scc1 L_r_f1
  s_mov_b32 s70, 0
L_sn_60:
  ds_read_b32 v8, v38 offset:312
  s_waitcnt lgkmcnt(0)
  v_cmp_gt_u32 vcc, 0x8, v8
  s_cmp_eq_u64 vcc, 0
  s_cbranch_scc1 L_snd_61
  s_sleep 4
  s_add_u32 s70, s70, 1
  s_cmp_lt_u32 s70, 2097152
  s_cbranch_scc1 L_sn_60
L_snd_61:
  s_and_b32 s61, s14, 0xff
L_mod4:
  s_cmp_ge_u32 s61, 48
  s_cbranch_scc1 L_r_f1
  s_lshl_b32 s48, s61, 7
  s_lshl_b32 s58, s61, 9
  s_add_u32 s58, s58, 4096
  v_lshrrev_b32 v2, 3, v1
  v_and_b32 v3, 6, v2
  v_xor_b32 v3, v3, v1
  v_mul_u32_u24 v2, 6144, v2
  v_and_b32 v3, 7, v3
  v_lshl_add_u32 v2, v3, 4, v2
  s_mul_i32 s49, s5, 786432
  s_lshl_b32 s50, s5, 14
  s_add_u32 s49, s49, s48
  s_add_u32 s50, s50, 77824
  s_add_u32 s51, s50, 16384
L_dma_62:
  s_mov_b32 m0, s50
  s_add_u32 s50, s50, 1024
  buffer_load_dwordx4 v2, s[44:47], s49 offen nt lds
  s_add_u32 s49, s49, 49152
  s_waitcnt vmcnt(5)
  s_cmp_lt_u32 s50, s51
  s_cbranch_scc1 L_dma_62
L_dmae_63:
  v_and_b32 v13, 1, v1
  v_lshlrev_b32 v13, 6, v13
  v_lshrrev_b32 v3, 4, v1
  v_lshl_add_u32 v13, v3, 4, v13
  s_lshl_b32 s49, s5, 7
  s_add_u32 s49, s49, s58
  v_add_u32 v13, s49, v13
  v_and_b32 v14, 1, v1
  v_mul_u32_u24 v14, 1056, v14
  v_lshrrev_b32 v3, 4, v1
  v_lshl_add_u32 v14, v3, 4, v14
  v_add_u32 v14, 3200, v14
  v_lshrrev_b32 v2, 2, v1
  v_bfe_u32 v3, v1, 1, 1
  s_lshl_b32 s49, s5, 1
  v_or_b32 v3, s49, v3
  v_and_b32 v10, 6, v2
  v_xor_b32 v3, v3, v10
  v_lshlrev_b32 v2, 7, v2
  v_lshl_add_u32 v2, v3, 4, v2
  v_and_b32 v3, 1, v1
  v_lshl_add_u32 v2, v3, 3, v2
  v_add_u32 v2, 77824, v2
  s_waitcnt vmcnt(0) lgkmcnt(0)
  s_add_u32 s77, s77, 4
  v_mov_b32 v9, 1
  s_mov_b64 exec, 1
  ds_add_u32 v38, v9 offset:316
  s_mov_b64 exec, -1
  s_mov_b32 s70, 0
L_hy_64:
  ds_read_b32 v9, v38 offset:316
  s_waitcnt lgkmcnt(0)
  v_cmp_gt_u32 vcc, s77, v9
  s_cmp_eq_u64 vcc, 0
  s_cbranch_scc1 L_hyd_65
  s_sleep 4
  s_add_u32 s70, s70, 1
  s_cmp_lt_u32 s70, 2097152
  s_cbranch_scc1 L_hy_64
L_hyd_65:
  ds_read_b64_tr_b16 v[40:41], v2 offset:0
  ds_read_b64_tr_b16 v[42:43], v2 offset:2048
  ds_read_b128 v[104:107], v14 offset:0
  ds_read_b64_tr_b16 v[44:45], v2 offset:4096
  ds_read_b64_tr_b16 v[46:47], v2 offset:6144
  ds_read_b128 v[108:111], v14 offset:64
  ds_read_b64_tr_b16 v[48:49], v2 offset:8192
  ds_read_b64_tr_b16 v[50:51], v2 offset:10240
  ds_read_b128 v[112:115], v14 offset:128
  ds_read_b64_tr_b16 v[52:53], v2 offset:12288
  ds_read_b64_tr_b16 v[54:55], v2 offset:14336
  ds_read_b128 v[116:119], v14 offset:192
  ds_read_b64_tr_b16 v[56:57], v2 offset:16384
  ds_read_b64_tr_b16 v[58:59], v2 offset:18432
  ds_read_b128 v[120:123], v14 offset:256
  s_waitcnt lgkmcnt(12)
  v_mfma_f32_16x16x32_bf16 v[8:11], v[40:43], v[104:107], 0
  ds_read_b64_tr_b16 v[60:61], v2 offset:20480
  ds_read_b64_tr_b16 v[62:63], v2 offset:22528
  ds_read_b128 v[124:127], v14 offset:320
  s_waitcnt lgkmcnt(12)
  v_mfma_f32_16x16x32_bf16 v[8:11], v[44:47], v[108:111], v[8:11]
  ds_read_b64_tr_b16 v[64:65], v2 offset:24576
  ds_read_b64_tr_b16 v[66:67], v2 offset:26624
  ds_read_b128 v[128:131], v14 offset:384
  s_waitcnt lgkmcnt(12)
  v_mfma_f32_16x16x32_bf16 v[8:11], v[48:51], v[112:115], v[8:11]
  ds_read_b64_tr_b16 v[68:69], v2 offset:28672
  ds_read_b64_tr_b16 v[70:71], v2 offset:30720
  ds_read_b128 v[132:135], v14 offset:448
  s_waitcnt lgkmcnt(12)
  v_mfma_f32_16x16x32_bf16 v[8:11], v[52:55], v[116:119], v[8:11]
  ds_read_b64_tr_b16 v[72:73], v2 offset:32768
  ds_read_b64_tr_b16 v[74:75], v2 offset:34816
  ds_read_b128 v[136:139], v14 offset:512
  s_waitcnt lgkmcnt(12)
  v_mfma_f32_16x16x32_bf16 v[8:11], v[56:59], v[120:123], v[8:11]
  ds_read_b64_tr_b16 v[76:77], v2 offset:36864
  ds_read_b64_tr_b16 v[78:79], v2 offset:38912
  ds_read_b128 v[140:143], v14 offset:576
  s_waitcnt lgkmcnt(12)
  v_mfma_f32_16x16x32_bf16 v[8:11], v[60:63], v[124:127], v[8:11]
  ds_read_b64_tr_b16 v[80:81], v2 offset:40960
  ds_read_b64_tr_b16 v[82:83], v2 offset:43008
  ds_read_b128 v[144:147], v14 offset:640
  s_waitcnt lgkmcnt(12)
  v_mfma_f32_16x16x32_bf16 v[8:11], v[64:67], v[128:131], v[8:11]
  ds_read_b64_tr_b16 v[84:85], v2 offset:45056
  ds_read_b64_tr_b16 v[86:87], v2 offset:47104
  ds_read_b128 v[148:151], v14 offset:704
  s_waitcnt lgkmcnt(12)
  v_mfma_f32_16x16x32_bf16 v[8:11], v[68:71], v[132:135], v[8:11]
  ds_read_b64_tr_b16 v[88:89], v2 offset:49152
  ds_read_b64_tr_b16 v[90:91], v2 offset:51200
  ds_read_b128 v[152:155], v14 offset:768
  s_waitcnt lgkmcnt(12)
  v_mfma_f32_16x16x32_bf16 v[8:11], v[72:75], v[136:139], v[8:11]
  ds_read_b64_tr_b16 v[92:93], v2 offset:53248
  ds_read_b64_tr_b16 v[94:95], v2 offset:55296
  ds_read_b128 v[156:159], v14 offset:832
  s_waitcnt lgkmcnt(12)
  v_mfma_f32_16x16x32_bf16 v[8:11], v[76:79], v[140:143], v[8:11]
  ds_read_b64_tr_b16 v[96:97], v2 offset:57344
  ds_read_b64_tr_b16 v[98:99], v2 offset:59392
  ds_read_b128 v[160:163], v14 offset:896
  s_waitcnt lgkmcnt(12)
  v_mfma_f32_16x16x32_bf16 v[8:11], v[80:83], v[144:147], v[8:11]
  ds_read_b64_tr_b16 v[100:101], v2 offset:61440
  ds_read_b64_tr_b16 v[102:103], v2 offset:63488
  ds_read_b128 v[164:167], v14 offset:960
  s_waitcnt lgkmcnt(12)
  v_mfma_f32_16x16x32_bf16 v[8:11], v[84:87], v[148:151], v[8:11]
  s_waitcnt lgkmcnt(9)
  v_mfma_f32_16x16x32_bf16 v[8:11], v[88:91], v[152:155], v[8:11]
  s_waitcnt lgkmcnt(6)
  v_mfma_f32_16x16x32_bf16 v[8:11], v[92:95], v[156:159], v[8:11]
  s_waitcnt lgkmcnt(3)
  v_mfma_f32_16x16x32_bf16 v[8:11], v[96:99], v[160:163], v[8:11]
  s_waitcnt lgkmcnt(0)
  v_mfma_f32_16x16x32_bf16 v[8:11], v[100:103], v[164:167], v[8:11]
  s_nop 7
  v_cvt_pk_bf16_f32 v8, v8, v9
  v_cvt_pk_bf16_f32 v10, v10, v11
  v_mov_b32 v9, s74
  v_mov_b32 v11, s74
  s_mov_b32 exec_lo, 0x00030003
  s_mov_b32 exec_hi, 0x00030003
  global_store_dwordx4 v13, v[8:11], s[42:43] sc1
  s_mov_b64 exec, -1
  s_add_u32 s77, s77, 4
  v_mov_b32 v9, 1
  s_mov_b64 exec, 1
  ds_add_u32 v38, v9 offset:316
  s_mov_b64 exec, -1
  s_mov_b32 s70, 0
L_hy_66:
  ds_read_b32 v9, v38 offset:316
  s_waitcnt lgkmcnt(0)
  v_cmp_gt_u32 vcc, s77, v9
  s_cmp_eq_u64 vcc, 0
  s_cbranch_scc1 L_hyd_67
  s_add_u32 s70, s70, 1
  s_cmp_lt_u32 s70, 2097152
  s_cbranch_scc1 L_hy_66
L_hyd_67:
  s_lshr_b32 s61, s14, 24
  s_or_b32 s14, s14, 0xff000000
  s_branch L_mod4
L_r_f1:
  s_bfe_u32 s61, s14, 0x80008
  s_cmp_ge_u32 s61, 43
  s_cbranch_scc1 L_fin
  s_lshl_b32 s48, s61, 6
  s_lshl_b32 s58, s61, 7
  s_add_u32 s58, s58, 1572864
  s_cmp_lt_u32 s5, 2
  s_cselect_b32 s44, s28, s30
  s_cselect_b32 s45, s29, s31
  s_mov_b32 s46, 1409024
  s_and_b32 s54, s61, 1
  v_lshrrev_b32 v2, 2, v1
  v_mul_u32_u24 v2, 5504, v2
  s_and_b32 s49, s5, 2
  s_or_b32 s49, s49, s54
  v_xor_b32 v3, s49, v1
  v_and_b32 v3, 3, v3
  v_lshl_add_u32 v2, v3, 4, v2
  s_and_b32 s55, s5, 1
  s_mul_i32 s49, s55, 704512
  s_add_u32 s49, s49, s48
  s_mul_i32 s50, s54, 2752
  s_add_u32 s49, s49, s50
  s_lshr_b32 s50, s5, 1
  s_lshl_b32 s50, s50, 15
  s_lshl_b32 s54, s54, 14
  s_add_u32 s50, s50, s54
  s_lshl_b32 s55, s55, 13
  s_add_u32 s50, s50, s55
  s_add_u32 s50, s50, 77824
  s_mov_b32 s70, 0
L_sn_68:
  ds_read_b32 v8, v38 offset:260
  s_waitcnt lgkmcnt(0)
  v_cmp_gt_u32 vcc, 0x1, v8
  s_cmp_eq_u64 vcc, 0
  s_cbranch_scc1 L_snd_69
  s_sleep 8
  s_add_u32 s70, s70, 1
  s_cmp_lt_u32 s70, 2097152
  s_cbranch_scc1 L_sn_68
L_snd_69:
  s_add_u32 s51, s50, 8192
L_dma_70:
  s_mov_b32 m0, s50
  s_add_u32 s50, s50, 1024
  buffer_load_dwordx4 v2, s[44:47], s49 offen  lds
  s_add_u32 s49, s49, 88064
  s_waitcnt vmcnt(3)
  s_cmp_lt_u32 s50, s51
  s_cbranch_scc1 L_dma_70
L_dmae_71:
  s_andn2_b32 s54, 1, s61
  v_lshrrev_b32 v2, 2, v1
  v_mul_u32_u24 v2, 5504, v2
  s_and_b32 s49, s5, 2
  s_or_b32 s49, s49, s54
  v_xor_b32 v3, s49, v1
  v_and_b32 v3, 3, v3
  v_lshl_add_u32 v2, v3, 4, v2
  s_and_b32 s55, s5, 1
  s_mul_i32 s49, s55, 704512
  s_add_u32 s49, s49, s48
  s_mul_i32 s50, s54, 2752
  s_add_u32 s49, s49, s50
  s_lshr_b32 s50, s5, 1
  s_lshl_b32 s50, s50, 15
  s_lshl_b32 s54, s54, 14
  s_add_u32 s50, s50, s54
  s_lshl_b32 s55, s55, 13
  s_add_u32 s50, s50, s55
  s_add_u32 s50, s50, 77824
  s_add_u32 s51, s50, 8192
L_dma_72:
  s_mov_b32 m0, s50
  s_add_u32 s50, s50, 1024
  buffer_load_dwordx4 v2, s[44:47], s49 offen nt lds
  s_add_u32 s49, s49, 88064
  s_waitcnt vmcnt(3)
  s_cmp_lt_u32 s50, s51
  s_cbranch_scc1 L_dma_72
L_dmae_73:
  v_lshlrev_b32 v15, 4, v0
  v_add_u32 v39, 16384, v15
  s_and_b32 s59, s2, 1
  s_lshl_b32 s59, s59, 16
  s_add_u32 s59, s59, 2101248
  v_add_u32 v15, s59, v15
  v_lshrrev_b32 v5, 2, v0
  v_lshlrev_b32 v5, 3, v5
  v_add_u32 v5, 9536, v5
  v_lshlrev_b32 v7, 3, v1
  v_add_u32 v7, 9536, v7
  v_and_b32 v14, 7, v1
  v_mul_u32_u24 v14, 1056, v14
  v_lshrrev_b32 v3, 4, v1
  v_lshl_add_u32 v14, v3, 4, v14
  v_bfe_u32 v6, v1, 2, 2
  v_lshl_add_u32 v6, v3, 3, v6
  v_mul_u32_u24 v6, 1056, v6
  v_and_b32 v8, 3, v1
  v_lshl_add_u32 v6, v8, 3, v6
  s_lshl_b32 s49, s5, 8
  s_add_u32 s49, s49, 77824
  v_add_u32 v6, s49, v6
  v_lshlrev_b32 v10, 3, v0
  v_add_u32 v10, 10048, v10
  v_mov_b32 v8, 0
  v_mov_b32 v9, 0
  ds_write_b64 v10, v[8:9]
  v_and_b32 v13, 1, v1
  v_lshlrev_b32 v13, 6, v13
  v_lshrrev_b32 v3, 4, v1
  v_lshl_add_u32 v13, v3, 4, v13
  s_lshl_b32 s49, s5, 17
  s_add_u32 s49, s49, s58
  v_add_u32 v13, s49, v13
  v_bfe_u32 v3, v1, 1, 3
  v_lshl_add_u32 v13, v3, 14, v13
  v_lshrrev_b32 v2, 3, v1
  v_lshlrev_b32 v2, 6, v2
  v_bfe_u32 v3, v1, 2, 1
  v_lshl_add_u32 v2, v3, 14, v2
  v_and_b32 v8, 2, v1
  v_or_b32 v3, v3, v8
  v_xor_b32 v3, s5, v3
  v_lshl_add_u32 v2, v3, 4, v2
  v_lshl_add_u32 v2, v8, 14, v2
  v_and_b32 v3, 1, v1
  v_lshl_add_u32 v2, v3, 3, v2
  v_add_u32 v2, 77824, v2
  s_waitcnt vmcnt(0)
  s_add_u32 s77, s77, 4
  v_mov_b32 v9, 1
  s_mov_b64 exec, 1
  ds_add_u32 v38, v9 offset:316
  s_mov_b64 exec, -1
  s_mov_b32 s70, 0
L_hy_74:
  ds_read_b32 v9, v38 offset:316
  s_waitcnt lgkmcnt(0)
  v_cmp_gt_u32 vcc, s77, v9
  s_cmp_eq_u64 vcc, 0
  s_cbranch_scc1 L_hyd_75
  s_sleep 4
  s_add_u32 s70, s70, 1
  s_cmp_lt_u32 s70, 2097152
  s_cbranch_scc1 L_hy_74
L_hyd_75:
  ds_read_b64_tr_b16 v[40:41], v2 offset:0
  ds_read_b64_tr_b16 v[42:43], v2 offset:512
  ds_read_b64_tr_b16 v[44:45], v2 offset:1024
  ds_read_b64_tr_b16 v[46:47], v2 offset:1536
  ds_read_b64_tr_b16 v[48:49], v2 offset:2048
  ds_read_b64_tr_b16 v[50:51], v2 offset:2560
  ds_read_b64_tr_b16 v[52:53], v2 offset:3072
  ds_read_b64_tr_b16 v[54:55], v2 offset:3584
  ds_read_b64_tr_b16 v[56:57], v2 offset:4096
  ds_read_b64_tr_b16 v[58:59], v2 offset:4608
  ds_read_b64_tr_b16 v[60:61], v2 offset:5120
  ds_read_b64_tr_b16 v[62:63], v2 offset:5632
  s_waitcnt lgkmcnt(10)
  ds_read_b64_tr_b16 v[64:65], v2 offset:6144
  ds_read_b64_tr_b16 v[66:67], v2 offset:6656
  s_waitcnt lgkmcnt(10)
  ds_read_b64_tr_b16 v[68:69], v2 offset:7168
  ds_read_b64_tr_b16 v[70:71], v2 offset:7680
  s_waitcnt lgkmcnt(10)
  ds_read_b64_tr_b16 v[72:73], v2 offset:8192
  ds_read_b64_tr_b16 v[74:75], v2 offset:8704
  s_waitcnt lgkmcnt(10)
  ds_read_b64_tr_b16 v[76:77], v2 offset:9216
  ds_read_b64_tr_b16 v[78:79], v2 offset:9728
  s_waitcnt lgkmcnt(10)
  ds_read_b64_tr_b16 v[80:81], v2 offset:10240
  ds_read_b64_tr_b16 v[82:83], v2 offset:10752
  s_waitcnt lgkmcnt(10)
  ds_read_b64_tr_b16 v[84:85], v2 offset:11264
  ds_read_b64_tr_b16 v[86:87], v2 offset:11776
  s_waitcnt lgkmcnt(10)
  ds_read_b64_tr_b16 v[88:89], v2 offset:12288
  ds_read_b64_tr_b16 v[90:91], v2 offset:12800
  s_waitcnt lgkmcnt(10)
  ds_read_b64_tr_b16 v[92:93], v2 offset:13312
  ds_read_b64_tr_b16 v[94:95], v2 offset:13824
  s_waitcnt lgkmcnt(10)
  ds_read_b64_tr_b16 v[96:97], v2 offset:14336
  ds_read_b64_tr_b16 v[98:99], v2 offset:14848
  s_waitcnt lgkmcnt(10)
  ds_read_b64_tr_b16 v[100:101], v2 offset:15360
  ds_read_b64_tr_b16 v[102:103], v2 offset:15872
  s_waitcnt lgkmcnt(10)
  s_waitcnt lgkmcnt(0)
  s_add_u32 s77, s77, 4
  v_mov_b32 v9, 1
  s_mov_b64 exec, 1
  ds_add_u32 v38, v9 offset:316
  s_mov_b64 exec, -1
  s_mov_b32 s70, 0
L_hy_76:
  ds_read_b32 v9, v38 offset:316
  s_waitcnt lgkmcnt(0)
  v_cmp_gt_u32 vcc, s77, v9
  s_cmp_eq_u64 vcc, 0
  s_cbranch_scc1 L_hyd_77
  s_add_u32 s70, s70, 1
  s_cmp_lt_u32 s70, 2097152
  s_cbranch_scc1 L_hy_76
L_hyd_77:
  s_mov_b32 s44, s32
  s_mov_b32 s45, s33
  s_mov_b32 s46, 1409024
  s_mov_b32 s47, 0x20000
  v_lshlrev_b32 v2, 4, v1
  s_lshl2_add_u32 s49, s61, s5
  s_lshl_b32 s49, s49, 13
  s_mul_i32 s50, s5, 8448
  s_add_u32 s50, s50, 77824
  s_add_u32 s51, s50, 8448
L_dma_78:
  s_mov_b32 m0, s50
  s_add_u32 s50, s50, 1056
  buffer_load_dwordx4 v2, s[44:47], s49 offen nt lds
  s_add_u32 s49, s49, 1024
  s_waitcnt vmcnt(3)
  s_cmp_lt_u32 s50, s51
  s_cbranch_scc1 L_dma_78
L_dmae_79:
  s_bfe_u32 s32, s74, 0x80000
  s_bfe_u32 s33, s74, 0x80008
  s_bfe_u32 s34, s74, 0x80010
  s_bfe_u32 s35, s74, 0x80018
  v_add_u32 v4, 16384, v15
  v_add_u32 v0, 32768, v15
  v_add_u32 v36, 49152, v15
  global_load_dwordx2 v[8:9], v37, s[16:17]
  s_mov_b32 s70, 0
L_pg_80:
  global_load_dwordx4 v[136:139], v39, s[42:43] offset:-4096 sc1
  global_load_dwordx4 v[140:143], v39, s[42:43] offset:0 sc1
  v_add_u32 v3, 4096, v39
  global_load_dwordx4 v[144:147], v3, s[42:43] sc1
  s_waitcnt vmcnt(0)
  s_mov_b64 vcc, 0
  v_cmp_ne_u32 s[68:69], s74, v137
  s_or_b64 vcc, vcc, s[68:69]
  v_cmp_ne_u32 s[68:69], s74, v139
  s_or_b64 vcc, vcc, s[68:69]
  v_cmp_ne_u32 s[68:69], s74, v141
  s_or_b64 vcc, vcc, s[68:69]
  v_cmp_ne_u32 s[68:69], s74, v143
  s_or_b64 vcc, vcc, s[68:69]
  v_cmp_ne_u32 s[68:69], s74, v145
  s_or_b64 vcc, vcc, s[68:69]
  v_cmp_ne_u32 s[68:69], s74, v147
  s_or_b64 vcc, vcc, s[68:69]
  s_cmp_eq_u64 vcc, 0
  s_cbranch_scc1 L_pge_81
  s_sleep 8
  s_add_u32 s70, s70, 1
  s_cmp_lt_u32 s70, 262144
  s_cbranch_scc1 L_pg_80
L_pge_81:
  v_and_b32 v39, 1, v1
  v_lshlrev_b32 v39, 6, v39
  v_add_u32 v39, 10944, v39
  v_lshrrev_b32 v3, 4, v1
  v_lshl_add_u32 v37, v3, 4, v39
  v_bfe_u32 v3, v1, 1, 3
  v_lshlrev_b32 v3, 7, v3
  v_sub_u32 v37, v37, v3
  v_bfe_u32 v3, v1, 4, 1
  v_lshl_add_u32 v39, v3, 3, v39
  v_lshrrev_b32 v3, 5, v1
  v_lshl_add_u32 v39, v3, 2, v39
  s_lshl_b32 s49, s5, 4
  v_add_u32 v39, s49, v39
  v_lshlrev_b32 v16, 16, v8
  v_and_b32 v17, s73, v8
  v_lshlrev_b32 v18, 16, v9
  v_and_b32 v19, s73, v9
  v_lshlrev_b32 v20, 16, v136
  v_and_b32 v21, s73, v136
  v_lshlrev_b32 v22, 16, v138
  v_and_b32 v23, s73, v138
  v_lshlrev_b32 v28, 16, v144
  v_and_b32 v29, s73, v144
  v_lshlrev_b32 v30, 16, v146
  v_and_b32 v31, s73, v146
  v_add_f32 v28, 1.0, v28
  v_add_f32 v29, 1.0, v29
  v_add_f32 v30, 1.0, v30
  v_add_f32 v31, 1.0, v31
  v_cvt_pk_bf16_f32 v8, v28, v29
  v_cvt_pk_bf16_f32 v9, v30, v31
  v_mov_b32 v141, v142
  ds_write_b64 v12, v[8:9] offset:5312
  ds_write_b64 v12, v[140:141] offset:7424
  v_cvt_pk_bf16_f32 v28, 0, v28
  v_cvt_pk_bf16_f32 v29, 0, v29
  v_cvt_pk_bf16_f32 v30, 0, v30
  v_cvt_pk_bf16_f32 v31, 0, v31
  v_mul_f32 v24, v20, v28
  v_mul_f32 v25, v21, v29
  v_mul_f32 v26, v22, v30
  v_mul_f32 v27, v23, v31
  v_mul_f32 v28, v16, v28
  v_mul_f32 v29, v17, v29
  v_mul_f32 v30, v18, v30
  v_mul_f32 v31, v19, v31
  s_waitcnt lgkmcnt(0)
  s_waitcnt vmcnt(0)
  s_mov_b32 s70, 0
L_sn_82:
  ds_read_b32 v8, v38 offset:264
  s_waitcnt lgkmcnt(0)
  v_cmp_gt_u32 vcc, 0x8, v8
  s_cmp_eq_u64 vcc, 0
  s_cbranch_scc1 L_snd_83
  s_sleep 2
  s_add_u32 s70, s70, 1
  s_cmp_lt_u32 s70, 2097152
  s_cbranch_scc1 L_sn_82
L_snd_83:
  v_readfirstlane_b32 s37, v15
  s_mov_b32 s70, 0
  s_movk_i32 s71, 0xff
  s_sub_u32 s37, s37, 4096
  s_mov_b32 s36, 1
L_f1_p:
  s_add_u32 s70, s70, 1
  s_cmp_ge_u32 s70, 262144
  s_cbranch_scc1 L_f1_ok
  s_mov_b32 s63, s71
  s_bitcmp1_b32 s63, 0
  s_cbranch_scc0 L_fl_84
  global_load_dwordx4 v[104:107], v15, s[42:43] offset:-4096 sc1
L_fl_84:
  s_bitcmp1_b32 s63, 1
  s_cbranch_scc0 L_fl_85
  global_load_dwordx4 v[108:111], v15, s[42:43] offset:0 sc1
L_fl_85:
  s_bitcmp1_b32 s63, 2
  s_cbranch_scc0 L_fl_86
  global_load_dwordx4 v[112:115], v4, s[42:43] offset:-4096 sc1
L_fl_86:
  s_bitcmp1_b32 s63, 3
  s_cbranch_scc0 L_fl_87
  global_load_dwordx4 v[116:119], v4, s[42:43] offset:0 sc1
L_fl_87:
  s_bitcmp1_b32 s63, 4
  s_cbranch_scc0 L_fl_88
  global_load_dwordx4 v[120:123], v0, s[42:43] offset:-4096 sc1
L_fl_88:
  s_bitcmp1_b32 s63, 5
  s_cbranch_scc0 L_fl_89
  global_load_dwordx4 v[124:127], v0, s[42:43] offset:0 sc1
L_fl_89:
  s_bitcmp1_b32 s63, 6
  s_cbranch_scc0 L_fl_90
  global_load_dwordx4 v[128:131], v36, s[42:43] offset:-4096 sc1
L_fl_90:
  s_bitcmp1_b32 s63, 7
  s_cbranch_scc0 L_fl_91
  global_load_dwordx4 v[132:135], v36, s[42:43] offset:0 sc1
L_fl_91:
  s_waitcnt vmcnt(0)
  s_bitcmp1_b32 s63, 0
  s_cbranch_scc0 L_fc_92
  v_xor_b32 v104, s32, v104
  v_xor_b32 v105, s33, v105
  v_xor_b32 v106, s34, v106
  v_xor_b32 v107, s35, v107
  v_or3_b32 v8, v104, v105, v106
  v_or_b32 v8, v8, v107
  v_cmp_ne_u32_sdwa vcc, v8, v38 src0_sel:BYTE_0 src1_sel:DWORD
  s_cmp_lg_u64 vcc, 0
  s_cbranch_scc1 L_fc_92
  s_bitset0_b32 s71, 0
L_fc_92:
  s_bitcmp1_b32 s63, 1
  s_cbranch_scc0 L_fc_93
  v_xor_b32 v108, s32, v108
  v_xor_b32 v109, s33, v109
  v_xor_b32 v110, s34, v110
  v_xor_b32 v111, s35, v111
  v_or3_b32 v8, v108, v109, v110
  v_or_b32 v8, v8, v111
  v_cmp_ne_u32_sdwa vcc, v8, v38 src0_sel:BYTE_0 src1_sel:DWORD
  s_cmp_lg_u64 vcc, 0
  s_cbranch_scc1 L_fc_93
  s_bitset0_b32 s71, 1
L_fc_93:
  s_bitcmp1_b32 s63, 2
  s_cbranch_scc0 L_fc_94
  v_xor_b32 v112, s32, v112
  v_xor_b32 v113, s33, v113
  v_xor_b32 v114, s34, v114
  v_xor_b32 v115, s35, v115
  v_or3_b32 v8, v112, v113, v114
  v_or_b32 v8, v8, v115
  v_cmp_ne_u32_sdwa vcc, v8, v38 src0_sel:BYTE_0 src1_sel:DWORD
  s_cmp_lg_u64 vcc, 0
  s_cbranch_scc1 L_fc_94
  s_bitset0_b32 s71, 2
L_fc_94:
  s_bitcmp1_b32 s63, 3
  s_cbranch_scc0 L_fc_95
  v_xor_b32 v116, s32, v116
  v_xor_b32 v117, s33, v117
  v_xor_b32 v118, s34, v118
  v_xor_b32 v119, s35, v119
  v_or3_b32 v8, v116, v117, v118
  v_or_b32 v8, v8, v119
  v_cmp_ne_u32_sdwa vcc, v8, v38 src0_sel:BYTE_0 src1_sel:DWORD
  s_cmp_lg_u64 vcc, 0
  s_cbranch_scc1 L_fc_95
  s_bitset0_b32 s71, 3
L_fc_95:
  s_bitcmp1_b32 s63, 4
  s_cbranch_scc0 L_fc_96
  v_xor_b32 v120, s32, v120
  v_xor_b32 v121, s33, v121
  v_xor_b32 v122, s34, v122
  v_xor_b32 v123, s35, v123
  v_or3_b32 v8, v120, v121, v122
  v_or_b32 v8, v8, v123
  v_cmp_ne_u32_sdwa vcc, v8, v38 src0_sel:BYTE_0 src1_sel:DWORD
  s_cmp_lg_u64 vcc, 0
  s_cbranch_scc1 L_fc_96
  s_bitset0_b32 s71, 4
L_fc_96:
  s_bitcmp1_b32 s63, 5
  s_cbranch_scc0 L_fc_97
  v_xor_b32 v124, s32, v124
  v_xor_b32 v125, s33, v125
  v_xor_b32 v126, s34, v126
  v_xor_b32 v127, s35, v127
  v_or3_b32 v8, v124, v125, v126
  v_or_b32 v8, v8, v127
  v_cmp_ne_u32_sdwa vcc, v8, v38 src0_sel:BYTE_0 src1_sel:DWORD
  s_cmp_lg_u64 vcc, 0
  s_cbranch_scc1 L_fc_97
  s_bitset0_b32 s71, 5
L_fc_97:
  s_bitcmp1_b32 s63, 6
  s_cbranch_scc0 L_fc_98
  v_xor_b32 v128, s32, v128
  v_xor_b32 v129, s33, v129
  v_xor_b32 v130, s34, v130
  v_xor_b32 v131, s35, v131
  v_or3_b32 v8, v128, v129, v130
  v_or_b32 v8, v8, v131
  v_cmp_ne_u32_sdwa vcc, v8, v38 src0_sel:BYTE_0 src1_sel:DWORD
  s_cmp_lg_u64 vcc, 0
  s_cbranch_scc1 L_fc_98
  s_bitset0_b32 s71, 6
L_fc_98:
  s_bitcmp1_b32 s63, 7
  s_cbranch_scc0 L_fc_99
  v_xor_b32 v132, s32, v132
  v_xor_b32 v133, s33, v133
  v_xor_b32 v134, s34, v134
  v_xor_b32 v135, s35, v135
  v_or3_b32 v8, v132, v133, v134
  v_or_b32 v8, v8, v135
  v_cmp_ne_u32_sdwa vcc, v8, v38 src0_sel:BYTE_0 src1_sel:DWORD
  s_cmp_lg_u64 vcc, 0
  s_cbranch_scc1 L_fc_99
  s_bitset0_b32 s71, 7
L_fc_99:
  s_cmp_lg_u32 s71, 0
  s_cbranch_scc1 L_f1_p
L_f1_ok:
  v_pk_add_f32 v[136:137], v[104:105], v[108:109]
  v_pk_add_f32 v[138:139], v[106:107], v[110:111]
  v_pk_add_f32 v[144:145], v[112:113], v[116:117]
  v_pk_add_f32 v[146:147], v[114:115], v[118:119]
  v_pk_add_f32 v[152:153], v[120:121], v[124:125]
  v_pk_add_f32 v[154:155], v[122:123], v[126:127]
  v_pk_add_f32 v[160:161], v[128:129], v[132:133]
  v_pk_add_f32 v[162:163], v[130:131], v[134:135]
  v_pk_add_f32 v[136:137], v[136:137], v[144:145]
  v_pk_add_f32 v[138:139], v[138:139], v[146:147]
  v_pk_add_f32 v[152:153], v[152:153], v[160:161]
  v_pk_add_f32 v[154:155], v[154:155], v[162:163]
  v_pk_add_f32 v[136:137], v[136:137], v[152:153]
  v_pk_add_f32 v[138:139], v[138:139], v[154:155]
  v_pk_fma_f32 v[8:9], v[136:137], v[24:25], v[28:29]
  v_pk_fma_f32 v[10:11], v[138:139], v[26:27], v[30:31]
  v_cvt_pk_bf16_f32 v8, v8, v9
  v_cvt_pk_bf16_f32 v9, v10, v11
  ds_write_b64 v12, v[8:9] offset:3200
  v_pk_fma_f32 v[16:17], v[136:137], v[20:21], v[16:17]
  v_pk_fma_f32 v[18:19], v[138:139], v[22:23], v[18:19]
  v_add_f32 v24, v16, v17
  v_mul_f32 v25, v16, v16
  v_add_f32 v26, v18, v19
  v_mul_f32 v27, v18, v18
  v_fmac_f32 v25, v17, v17
  v_fmac_f32 v27, v19, v19
  v_pk_add_f32 v[24:25], v[24:25], v[26:27]
  s_nop 1
  v_add_f32_dpp v24, v24, v24 quad_perm:[1,0,3,2] row_mask:0xf bank_mask:0xf
  v_add_f32_dpp v25, v25, v25 quad_perm:[1,0,3,2] row_mask:0xf bank_mask:0xf
  s_nop 0
  v_add_f32_dpp v24, v24, v24 quad_perm:[2,3,0,1] row_mask:0xf bank_mask:0xf
  v_add_f32_dpp v25, v25, v25 quad_perm:[2,3,0,1] row_mask:0xf bank_mask:0xf
  ds_write_b64 v5, v[24:25]
  s_add_u32 s77, s77, 4
  v_mov_b32 v10, 1
  s_mov_b64 exec, 1
  ds_add_u32 v38, v10 offset:316
  s_mov_b64 exec, -1
  s_mov_b32 s70, 0
L_hy_100:
  ds_read_b32 v10, v38 offset:316
  ds_read_b128 v[136:139], v14 offset:3200
  ds_read_b128 v[140:143], v14 offset:3264
  ds_read_b128 v[144:147], v14 offset:3328
  ds_read_b128 v[148:151], v14 offset:3392
  s_waitcnt lgkmcnt(4)
  v_cmp_gt_u32 vcc, s77, v10
  s_cmp_eq_u64 vcc, 0
  s_cbranch_scc1 L_hyd_101
  s_waitcnt lgkmcnt(0)
  s_add_u32 s70, s70, 1
  s_cmp_lt_u32 s70, 2097152
  s_cbranch_scc1 L_hy_100
L_hyd_101:
  ds_read_b64 v[20:21], v7
  ds_read_b128 v[152:155], v14 offset:3456
  ds_read_b128 v[156:159], v14 offset:3520
  ds_read_b128 v[160:163], v14 offset:3584
  ds_read_b128 v[164:167], v14 offset:3648
  s_waitcnt lgkmcnt(8)
  v_mfma_f32_16x16x32_bf16 v[32:35], v[40:43], v[136:139], 0
  s_waitcnt lgkmcnt(7)
  v_mfma_f32_16x16x32_bf16 v[32:35], v[44:47], v[140:143], v[32:35]
  ds_read_b128 v[136:139], v14 offset:3712
  s_waitcnt lgkmcnt(7)
  v_mfma_f32_16x16x32_bf16 v[32:35], v[48:51], v[144:147], v[32:35]
  ds_read_b128 v[140:143], v14 offset:3776
  s_waitcnt lgkmcnt(7)
  v_mfma_f32_16x16x32_bf16 v[32:35], v[52:55], v[148:151], v[32:35]
  ds_read_b128 v[144:147], v14 offset:3840
  s_waitcnt lgkmcnt(6)
  v_mfma_f32_16x16x32_bf16 v[32:35], v[56:59], v[152:155], v[32:35]
  ds_read_b128 v[148:151], v14 offset:3904
  v_add_f32_dpp v20, v20, v20 quad_perm:[2,3,0,1] row_mask:0xf bank_mask:0xf
  v_add_f32_dpp v21, v21, v21 quad_perm:[2,3,0,1] row_mask:0xf bank_mask:0xf
  s_waitcnt lgkmcnt(6)
  v_mfma_f32_16x16x32_bf16 v[32:35], v[60:63], v[156:159], v[32:35]
  ds_read_b128 v[152:155], v14 offset:3968
  v_add_f32_dpp v20, v20, v20 row_ror:4 row_mask:0xf bank_mask:0xf
  v_add_f32_dpp v21, v21, v21 row_ror:4 row_mask:0xf bank_mask:0xf
  s_waitcnt lgkmcnt(6)
  v_mfma_f32_16x16x32_bf16 v[32:35], v[64:67], v[160:163], v[32:35]
  ds_read_b128 v[156:159], v14 offset:4032
  v_add_f32_dpp v20, v20, v20 row_ror:8 row_mask:0xf bank_mask:0xf
  v_add_f32_dpp v21, v21, v21 row_ror:8 row_mask:0xf bank_mask:0xf
  s_waitcnt lgkmcnt(6)
  v_mfma_f32_16x16x32_bf16 v[32:35], v[68:71], v[164:167], v[32:35]
  ds_read_b128 v[160:163], v14 offset:4096
  v_mov_b32 v22, v20
  v_mov_b32 v23, v21
  s_waitcnt lgkmcnt(6)
  v_mfma_f32_16x16x32_bf16 v[32:35], v[72:75], v[136:139], v[32:35]
  ds_read_b128 v[164:167], v14 offset:4160
  v_permlane16_swap_b32 v22, v20
  v_permlane16_swap_b32 v23, v21
  s_waitcnt lgkmcnt(6)
  v_mfma_f32_16x16x32_bf16 v[32:35], v[76:79], v[140:143], v[32:35]
  v_pk_add_f32 v[20:21], v[20:21], v[22:23]
  v_mov_b32 v22, v20
  v_mov_b32 v23, v21
  s_waitcnt lgkmcnt(5)
  v_mfma_f32_16x16x32_bf16 v[32:35], v[80:83], v[144:147], v[32:35]
  v_permlane32_swap_b32 v22, v20
  v_permlane32_swap_b32 v23, v21
  s_waitcnt lgkmcnt(4)
  v_mfma_f32_16x16x32_bf16 v[32:35], v[84:87], v[148:151], v[32:35]
  v_pk_add_f32 v[20:21], v[20:21], v[22:23]
  v_mul_f32 v20, 0xbb000000, v20
  s_waitcnt lgkmcnt(3)
  v_mfma_f32_16x16x32_bf16 v[32:35], v[88:91], v[152:155], v[32:35]
  v_mul_f32 v21, 0x3b000000, v21
  v_fma_f32 v21, -v20, v20, v21
  s_waitcnt lgkmcnt(2)
  v_mfma_f32_16x16x32_bf16 v[32:35], v[92:95], v[156:159], v[32:35]
  v_max_f32 v21, 0, v21
  v_add_f32 v21, 0x3727c5ac, v21
  s_waitcnt lgkmcnt(1)
  v_mfma_f32_16x16x32_bf16 v[32:35], v[96:99], v[160:163], v[32:35]
  v_rsq_f32 v21, v21
  s_waitcnt lgkmcnt(0)
  v_mfma_f32_16x16x32_bf16 v[32:35], v[100:103], v[164:167], v[32:35]
  ds_read_b64_tr_b16 v[40:41], v6 offset:0
  ds_read_b64_tr_b16 v[42:43], v6 offset:4224
  ds_read_b64_tr_b16 v[44:45], v6 offset:32
  ds_read_b64_tr_b16 v[46:47], v6 offset:4256
  ds_read_b64_tr_b16 v[48:49], v6 offset:64
  ds_read_b64_tr_b16 v[50:51], v6 offset:4288
  ds_read_b64_tr_b16 v[52:53], v6 offset:96
  ds_read_b64_tr_b16 v[54:55], v6 offset:4320
  v_fmac_f32_dpp v32, v32, v20 row_shl:2 row_mask:0xf bank_mask:0x1
  v_fmac_f32_dpp v33, v33, v20 row_shl:2 row_mask:0xf bank_mask:0x1
  v_fmac_f32_dpp v34, v34, v20 row_shl:2 row_mask:0xf bank_mask:0x1
  v_fmac_f32_dpp v35, v35, v20 row_shl:2 row_mask:0xf bank_mask:0x1
  v_mul_f32 v8, v32, v21
  v_mul_f32 v9, v33, v21
  v_mul_f32 v10, v34, v21
  v_mul_f32 v11, v35, v21
  v_add_f32_dpp v8, v32, v8 row_shl:4 row_mask:0xf bank_mask:0xf
  v_add_f32_dpp v9, v33, v9 row_shl:4 row_mask:0xf bank_mask:0xf
  v_add_f32_dpp v10, v34, v10 row_shl:4 row_mask:0xf bank_mask:0xf
  v_add_f32_dpp v11, v35, v11 row_shl:4 row_mask:0xf bank_mask:0xf
  s_waitcnt lgkmcnt(4)
  ds_read_b64_tr_b16 v[56:57], v6 offset:128
  ds_read_b64_tr_b16 v[58:59], v6 offset:4352
  ds_read_b64_tr_b16 v[60:61], v6 offset:160
  ds_read_b64_tr_b16 v[62:63], v6 offset:4384
  ds_read_b64_tr_b16 v[64:65], v6 offset:192
  ds_read_b64_tr_b16 v[66:67], v6 offset:4416
  ds_read_b64_tr_b16 v[68:69], v6 offset:224
  ds_read_b64_tr_b16 v[70:71], v6 offset:4448
  v_permlane32_swap_b32 v8, v10
  v_permlane32_swap_b32 v9, v11
  v_mul_f32 v20, 0xbfb8aa3b, v8
  v_mul_f32 v21, 0xbfb8aa3b, v9
  v_exp_f32 v20, v20
  v_exp_f32 v21, v21
  v_mul_f32 v8, v8, v10
  v_mul_f32 v9, v9, v11
  v_add_f32 v20, 1.0, v20
  v_add_f32 v21, 1.0, v21
  v_rcp_f32 v20, v20
  v_rcp_f32 v21, v21
  s_mov_b32 exec_lo, 0x00030003
  s_mov_b32 exec_hi, 0x00030003
  v_mul_f32 v8, v8, v20
  v_mul_f32 v9, v9, v21
  v_cvt_pk_bf16_f32 v8, v8, v9
  ds_write_b32 v39, v8
  s_mov_b64 exec, -1
  s_waitcnt lgkmcnt(4)
  s_add_u32 s77, s77, 4
  v_mov_b32 v10, 1
  s_mov_b64 exec, 1
  ds_add_u32 v38, v10 offset:316
  s_mov_b64 exec, -1
  s_mov_b32 s70, 0
L_hy_102:
  ds_read_b32 v10, v38 offset:316
  ds_read_b128 v[136:139], v37 offset:0
  ds_read_b128 v[140:143], v37 offset:128
  ds_read_b128 v[144:147], v37 offset:256
  ds_read_b128 v[148:151], v37 offset:384
  s_waitcnt lgkmcnt(4)
  v_cmp_gt_u32 vcc, s77, v10
  s_cmp_eq_u64 vcc, 0
  s_cbranch_scc1 L_hyd_103
  s_waitcnt lgkmcnt(0)
  s_add_u32 s70, s70, 1
  s_cmp_lt_u32 s70, 2097152
  s_cbranch_scc1 L_hy_102
L_hyd_103:
  ds_read_b128 v[152:155], v37 offset:512
  ds_read_b128 v[156:159], v37 offset:640
  ds_read_b128 v[160:163], v37 offset:768
  ds_read_b128 v[164:167], v37 offset:896
  v_mov_b32 v3, 0xff
  s_waitcnt lgkmcnt(7)
  v_mfma_f32_16x16x32_bf16 v[8:11], v[40:43], v[136:139], 0
  s_waitcnt lgkmcnt(6)
  v_mfma_f32_16x16x32_bf16 v[8:11], v[44:47], v[140:143], v[8:11]
  s_waitcnt lgkmcnt(5)
  v_mfma_f32_16x16x32_bf16 v[8:11], v[48:51], v[144:147], v[8:11]
  s_waitcnt lgkmcnt(4)
  v_mfma_f32_16x16x32_bf16 v[8:11], v[52:55], v[148:151], v[8:11]
  s_waitcnt lgkmcnt(3)
  v_mfma_f32_16x16x32_bf16 v[8:11], v[56:59], v[152:155], v[8:11]
  s_waitcnt lgkmcnt(2)
  v_mfma_f32_16x16x32_bf16 v[8:11], v[60:63], v[156:159], v[8:11]
  s_waitcnt lgkmcnt(1)
  v_mfma_f32_16x16x32_bf16 v[8:11], v[64:67], v[160:163], v[8:11]
  s_waitcnt lgkmcnt(0)
  v_mfma_f32_16x16x32_bf16 v[8:11], v[68:71], v[164:167], v[8:11]
  s_nop 7
  v_bfi_b32 v8, v3, s32, v8
  v_bfi_b32 v9, v3, s33, v9
  v_bfi_b32 v10, v3, s34, v10
  v_bfi_b32 v11, v3, s35, v11
  global_store_dwordx4 v13, v[8:11], s[42:43] sc1
  s_branch L_fin
L_r_f2:
  v_bfe_u32 v12, v1, 2, 1
  v_and_b32 v14, 3, v1
  s_lshl_b32 s49, s61, 5
  v_lshl_add_u32 v3, v14, 3, s49
  v_lshl_add_u32 v37, v12, 10, v3
  v_and_b32 v15, 7, v1
  s_lshl_b32 s49, s61, 7
  v_lshl_add_u32 v15, v15, 4, s49
  v_add_u32 v39, 16384, v15
  v_bfe_u32 v3, v1, 3, 1
  v_lshl_add_u32 v15, v3, 12, v15
  v_lshrrev_b32 v3, 4, v1
  v_lshl_add_u32 v15, v3, 14, v15
  s_and_b32 s59, s2, 1
  s_lshl_b32 s59, s59, 16
  s_add_u32 s59, s59, 2097152
  v_add_u32 v15, s59, v15
  s_lshl_b32 s49, s61, 14
  s_add_u32 s49, s49, 1574912
  v_lshl_add_u32 v36, v1, 4, s49
  global_load_dword v11, v37, s[38:39]
  s_lshl_b32 s49, s61, 14
  s_add_u32 s49, s49, 1572864
  v_min_u32 v10, 42, v1
  v_lshl_add_u32 v10, v10, 7, s49
  global_load_dword v11, v10, s[42:43] sc1
  s_lshl_b32 s49, s61, 7
  s_add_u32 s49, s49, 28672
  v_mov_b32 v10, s49
  global_load_dword v11, v10, s[42:43] sc1
  global_load_dwordx2 v[8:9], v37, s[16:17]
  s_mov_b32 s70, 0
L_pg_104:
  global_load_dwordx4 v[136:139], v39, s[42:43] offset:-4096 sc1
  v_add_u32 v3, 8192, v39
  global_load_dwordx4 v[140:143], v3, s[42:43] sc1
  s_waitcnt vmcnt(0)
  s_mov_b64 vcc, 0
  v_cmp_ne_u32 s[68:69], s74, v137
  s_or_b64 vcc, vcc, s[68:69]
  v_cmp_ne_u32 s[68:69], s74, v139
  s_or_b64 vcc, vcc, s[68:69]
  v_cmp_ne_u32 s[68:69], s74, v141
  s_or_b64 vcc, vcc, s[68:69]
  v_cmp_ne_u32 s[68:69], s74, v143
  s_or_b64 vcc, vcc, s[68:69]
  s_cmp_eq_u64 vcc, 0
  s_cbranch_scc1 L_pge_105
  s_sleep 8
  s_add_u32 s70, s70, 1
  s_cmp_lt_u32 s70, 262144
  s_cbranch_scc1 L_pg_104
L_pge_105:
  v_lshlrev_b32 v16, 16, v8
  v_and_b32 v17, s73, v8
  v_lshlrev_b32 v18, 16, v9
  v_and_b32 v19, s73, v9
  v_lshlrev_b32 v20, 16, v136
  v_and_b32 v21, s73, v136
  v_lshlrev_b32 v22, 16, v138
  v_and_b32 v23, s73, v138
  v_lshlrev_b32 v24, 16, v140
  v_and_b32 v25, s73, v140
  v_lshlrev_b32 v26, 16, v142
  v_and_b32 v27, s73, v142
  s_mov_b32 s70, 0
L_sn_106:
  ds_read_b32 v8, v38 offset:264
  s_waitcnt lgkmcnt(0)
  v_cmp_gt_u32 vcc, 0x8, v8
  s_cmp_eq_u64 vcc, 0
  s_cbranch_scc1 L_snd_107
  s_sleep 2
  s_add_u32 s70, s70, 1
  s_cmp_lt_u32 s70, 2097152
  s_cbranch_scc1 L_sn_106
L_snd_107:
  s_mov_b32 s70, 0
L_f2_a:
  global_load_dwordx4 v[136:139], v15, s[42:43] sc1
  s_waitcnt vmcnt(0)
  v_xor_b32 v136, s32, v136
  v_xor_b32 v137, s33, v137
  v_xor_b32 v138, s34, v138
  v_xor_b32 v139, s35, v139
  v_or3_b32 v3, v136, v137, v138
  v_or_b32 v3, v3, v139
  v_lshlrev_b32 v3, 24, v3
  v_cmp_ne_u32 vcc, 0, v3
  s_cmp_eq_u64 vcc, 0
  s_cbranch_scc1 L_f2_ad
  s_sleep 4
  s_add_u32 s70, s70, 1
  s_cmp_lt_u32 s70, 262144
  s_cbranch_scc1 L_f2_a
L_f2_ad:
  s_cmp_lg_u32 s61, 0
  s_cbranch_scc1 L_f2_e
  v_mov_b32 v10, s74
  s_mov_b64 exec, 1
  global_store_dword v38, v10, s[42:43] offset:0 sc1
  s_mov_b64 exec, -1
L_f2_e:
  s_nop 1
  v_add_f32_dpp v136, v136, v136 row_ror:8 row_mask:0xf bank_mask:0xf
  v_add_f32_dpp v137, v137, v137 row_ror:8 row_mask:0xf bank_mask:0xf
  v_add_f32_dpp v138, v138, v138 row_ror:8 row_mask:0xf bank_mask:0xf
  v_add_f32_dpp v139, v139, v139 row_ror:8 row_mask:0xf bank_mask:0xf
  v_mov_b32 v140, v136
  v_mov_b32 v141, v137
  v_mov_b32 v142, v138
  v_mov_b32 v143, v139
  v_permlane16_swap_b32 v140, v136
  v_permlane16_swap_b32 v141, v137
  v_permlane16_swap_b32 v142, v138
  v_permlane16_swap_b32 v143, v139
  v_add_f32 v136, v136, v140
  v_add_f32 v137, v137, v141
  v_add_f32 v138, v138, v142
  v_add_f32 v139, v139, v143
  v_mov_b32 v140, v136
  v_mov_b32 v141, v137
  v_mov_b32 v142, v138
  v_mov_b32 v143, v139
  v_permlane32_swap_b32 v140, v136
  v_permlane32_swap_b32 v141, v137
  v_permlane32_swap_b32 v142, v138
  v_permlane32_swap_b32 v143, v139
  v_add_f32 v136, v136, v140
  v_add_f32 v137, v137, v141
  v_add_f32 v138, v138, v142
  v_add_f32 v139, v139, v143
  v_cvt_pk_bf16_f32 v136, 0, v136
  v_cvt_pk_bf16_f32 v137, 0, v137
  v_cvt_pk_bf16_f32 v138, 0, v138
  v_cvt_pk_bf16_f32 v139, 0, v139
  v_mul_f32 v136, v136, v20
  v_mul_f32 v137, v137, v21
  v_mul_f32 v138, v138, v22
  v_mul_f32 v139, v139, v23
  v_cvt_pk_bf16_f32 v136, 0, v136
  v_cvt_pk_bf16_f32 v137, 0, v137
  v_cvt_pk_bf16_f32 v138, 0, v138
  v_cvt_pk_bf16_f32 v139, 0, v139
  v_add_f32 v16, v16, v136
  v_add_f32 v17, v17, v137
  v_add_f32 v18, v18, v138
  v_add_f32 v19, v19, v139
  v_cvt_pk_bf16_f32 v16, 0, v16
  v_cvt_pk_bf16_f32 v17, 0, v17
  v_cvt_pk_bf16_f32 v18, 0, v18
  v_cvt_pk_bf16_f32 v19, 0, v19
  v_mov_b32 v156, s32
  v_mov_b32 v157, s33
  v_mov_b32 v158, s34
  v_mov_b32 v159, s35
  s_mov_b64 s[20:21], -1
  s_mov_b64 s[22:23], -1
  s_mov_b64 s[24:25], -1
  s_mov_b64 s[26:27], -1
  s_mov_b64 s[28:29], -1
  s_mov_b64 s[30:31], 0xffffff
  s_mov_b64 exec, s[20:21]
  global_load_dwordx4 v[136:139], v36, s[42:43] offset:-2048 sc1
  s_mov_b64 exec, s[22:23]
  global_load_dwordx4 v[140:143], v36, s[42:43] offset:-1024 sc1
  s_mov_b64 exec, s[24:25]
  global_load_dwordx4 v[144:147], v36, s[42:43] offset:0 sc1
  s_mov_b64 exec, s[26:27]
  global_load_dwordx4 v[148:151], v36, s[42:43] offset:1024 sc1
  s_mov_b64 exec, s[28:29]
  global_load_dwordx4 v[152:155], v36, s[42:43] offset:2048 sc1
  s_mov_b64 exec, s[30:31]
  global_load_dwordx4 v[156:159], v36, s[42:43] offset:3072 sc1
  s_mov_b64 exec, -1
  s_waitcnt vmcnt(0)
  s_mov_b32 s70, 0
  s_branch L_f2_pc
L_f2_p:
  s_mov_b64 exec, s[20:21]
  global_load_dwordx4 v[136:139], v36, s[42:43] offset:-2048 sc1
  s_mov_b64 exec, s[22:23]
  global_load_dwordx4 v[140:143], v36, s[42:43] offset:-1024 sc1
  s_mov_b64 exec, s[24:25]
  global_load_dwordx4 v[144:147], v36, s[42:43] offset:0 sc1
  s_mov_b64 exec, s[26:27]
  global_load_dwordx4 v[148:151], v36, s[42:43] offset:1024 sc1
  s_mov_b64 exec, s[28:29]
  global_load_dwordx4 v[152:155], v36, s[42:43] offset:2048 sc1
  s_mov_b64 exec, s[30:31]
  global_load_dwordx4 v[156:159], v36, s[42:43] offset:3072 sc1
  s_mov_b64 exec, -1
  s_waitcnt vmcnt(0)
L_f2_pc:
  v_xor_b32 v104, s32, v136
  v_xor_b32 v105, s33, v137
  v_xor_b32 v106, s34, v138
  v_xor_b32 v107, s35, v139
  v_xor_b32 v108, s32, v140
  v_xor_b32 v109, s33, v141
  v_xor_b32 v110, s34, v142
  v_xor_b32 v111, s35, v143
  v_xor_b32 v112, s32, v144
  v_xor_b32 v113, s33, v145
  v_xor_b32 v114, s34, v146
  v_xor_b32 v115, s35, v147
  v_xor_b32 v116, s32, v148
  v_xor_b32 v117, s33, v149
  v_xor_b32 v118, s34, v150
  v_xor_b32 v119, s35, v151
  v_xor_b32 v120, s32, v152
  v_xor_b32 v121, s33, v153
  v_xor_b32 v122, s34, v154
  v_xor_b32 v123, s35, v155
  v_xor_b32 v124, s32, v156
  v_xor_b32 v125, s33, v157
  v_xor_b32 v126, s34, v158
  v_xor_b32 v127, s35, v159
  v_or3_b32 v28, v104, v105, v106
  v_or3_b32 v29, v108, v109, v110
  v_or3_b32 v30, v112, v113, v114
  v_or3_b32 v31, v116, v117, v118
  v_or3_b32 v32, v120, v121, v122
  v_or3_b32 v33, v124, v125, v126
  v_or_b32 v28, v28, v107
  v_or_b32 v29, v29, v111
  v_or_b32 v30, v30, v115
  v_or_b32 v31, v31, v119
  v_or_b32 v32, v32, v123
  v_or_b32 v33, v33, v127
  v_cmp_ne_u32_sdwa s[20:21], v28, v38 src0_sel:BYTE_0 src1_sel:DWORD
  v_cmp_ne_u32_sdwa s[22:23], v29, v38 src0_sel:BYTE_0 src1_sel:DWORD
  v_cmp_ne_u32_sdwa s[24:25], v30, v38 src0_sel:BYTE_0 src1_sel:DWORD
  v_cmp_ne_u32_sdwa s[26:27], v31, v38 src0_sel:BYTE_0 src1_sel:DWORD
  v_cmp_ne_u32_sdwa s[28:29], v32, v38 src0_sel:BYTE_0 src1_sel:DWORD
  v_cmp_ne_u32_sdwa s[30:31], v33, v38 src0_sel:BYTE_0 src1_sel:DWORD
  v_pk_add_f32 v[104:105], v[104:105], v[108:109]
  v_pk_add_f32 v[106:107], v[106:107], v[110:111]
  v_pk_add_f32 v[112:113], v[112:113], v[116:117]
  v_pk_add_f32 v[114:115], v[114:115], v[118:119]
  v_pk_add_f32 v[120:121], v[120:121], v[124:125]
  v_pk_add_f32 v[122:123], v[122:123], v[126:127]
  v_pk_add_f32 v[104:105], v[104:105], v[112:113]
  v_pk_add_f32 v[106:107], v[106:107], v[114:115]
  v_pk_add_f32 v[104:105], v[104:105], v[120:121]
  v_pk_add_f32 v[106:107], v[106:107], v[122:123]
  s_mov_b64 vcc, s[20:21]
  s_or_b64 vcc, vcc, s[22:23]
  s_or_b64 vcc, vcc, s[24:25]
  s_or_b64 vcc, vcc, s[26:27]
  s_or_b64 vcc, vcc, s[28:29]
  s_or_b64 vcc, vcc, s[30:31]
  s_or_b32 s20, s20, 1
  s_or_b32 s22, s22, 1
  s_or_b32 s24, s24, 1
  s_or_b32 s26, s26, 1
  s_or_b32 s28, s28, 1
  s_or_b32 s30, s30, 1
  s_cmp_eq_u64 vcc, 0
  s_cbranch_scc1 L_f2_pok
  s_add_u32 s70, s70, 1
  s_cmp_lt_u32 s70, 262144
  s_cbranch_scc1 L_f2_p
L_f2_pok:
  s_nop 1
  v_add_f32_dpp v104, v104, v104 row_ror:8 row_mask:0xf bank_mask:0xf
  v_add_f32_dpp v105, v105, v105 row_ror:8 row_mask:0xf bank_mask:0xf
  v_add_f32_dpp v106, v106, v106 row_ror:8 row_mask:0xf bank_mask:0xf
  v_add_f32_dpp v107, v107, v107 row_ror:8 row_mask:0xf bank_mask:0xf
  v_mov_b32 v108, v104
  v_mov_b32 v109, v105
  v_mov_b32 v110, v106
  v_mov_b32 v111, v107
  v_permlane16_swap_b32 v108, v104
  v_permlane16_swap_b32 v109, v105
  v_permlane16_swap_b32 v110, v106
  v_permlane16_swap_b32 v111, v107
  v_add_f32 v104, v104, v108
  v_add_f32 v105, v105, v109
  v_add_f32 v106, v106, v110
  v_add_f32 v107, v107, v111
  v_mov_b32 v108, v104
  v_mov_b32 v109, v105
  v_mov_b32 v110, v106
  v_mov_b32 v111, v107
  v_permlane32_swap_b32 v108, v104
  v_permlane32_swap_b32 v109, v105
  v_permlane32_swap_b32 v110, v106
  v_permlane32_swap_b32 v111, v107
  v_add_f32 v104, v104, v108
  v_add_f32 v105, v105, v109
  v_add_f32 v106, v106, v110
  v_add_f32 v107, v107, v111
  v_cvt_pk_bf16_f32 v104, 0, v104
  v_cvt_pk_bf16_f32 v105, 0, v105
  v_cvt_pk_bf16_f32 v106, 0, v106
  v_cvt_pk_bf16_f32 v107, 0, v107
  v_mul_f32 v104, v104, v24
  v_mul_f32 v105, v105, v25
  v_mul_f32 v106, v106, v26
  v_mul_f32 v107, v107, v27
  v_cvt_pk_bf16_f32 v104, 0, v104
  v_cvt_pk_bf16_f32 v105, 0, v105
  v_cvt_pk_bf16_f32 v106, 0, v106
  v_cvt_pk_bf16_f32 v107, 0, v107
  v_add_f32 v8, v104, v16
  v_add_f32 v9, v105, v17
  v_add_f32 v10, v106, v18
  v_add_f32 v11, v107, v19
  v_cvt_pk_bf16_f32 v8, v8, v9
  v_cvt_pk_bf16_f32 v9, v10, v11
  s_mov_b64 exec, 0xff
  global_store_dwordx2 v37, v[8:9], s[38:39] sc1
  s_mov_b64 exec, 1
  v_mov_b32 v10, s74
  s_lshl_b32 s49, s61, 7
  s_add_u32 s49, s49, 28672
  v_mov_b32 v11, s49
  global_store_dword v11, v10, s[42:43] sc1
L_fin:
L_end:
  s_endpgm
.p2align 7
L_table:
  .long 0xff00ff13, 0x1504ff14, 0xff08ff1b, 0x1d0cff1c, 0xff10ff23, 0xff14ff24, 0xff18ff2b, 0x2d1cff2c
  .long 0xff01ff10, 0x1705ff16, 0xff09ff18, 0x1f0dff1e, 0xff11ff20, 0xff15ff25, 0xff19ff28, 0x2f1dff2e
  .long 0x1202ff11, 0xff0605ff, 0x1a0aff19, 0xff0e10ff, 0x2212ff21, 0x2716ff26, 0x2a1aff29, 0xff1e25ff
  .long 0xffff00ff, 0xffff06ff, 0xffff0bff, 0xffff11ff, 0xffff16ff, 0xffff1bff, 0xffff20ff, 0xffff26ff
  .long 0xffff01ff, 0xffff07ff, 0xffff0cff, 0xffff12ff, 0xffff17ff, 0xffff1cff, 0xffff21ff, 0xffff27ff
  .long 0xffff02ff, 0xffff08ff, 0xffff0dff, 0xffff13ff, 0xffff18ff, 0xffff1dff, 0xffff22ff, 0xffff28ff
  .long 0xffff03ff, 0xffff09ff, 0xffff0eff, 0xffff14ff, 0xffff19ff, 0xffff1eff, 0xffff23ff, 0xffff29ff
  .long 0xff0304ff, 0xff070aff, 0xff0b0fff, 0xff0f15ff, 0xff131aff, 0xff171fff, 0xff1b24ff, 0xff1f2aff
L_touch:
  .long 0x80804101, 0x80804909, 0x80804303, 0x80808080, 0x80804b0b, 0x80804505, 0x80804d0d, 0x80808080
  .long 0x80804707, 0x80804f0f, 0x80805900, 0x80808080, 0x80805b08, 0x80805d02, 0x80805f0a, 0x80808080
  .long 0x80805804, 0x80805a0c, 0x80805c06, 0x80808080, 0x80805e0e, 0x80805140, 0x80806148, 0x80808080
  .long 0x80806942, 0x8080714a, 0x80807944, 0x80808080, 0x8080534c, 0x80806346, 0x80806b4e, 0x80808080
.section .rodata,"a"
.p2align 6
.amdhsa_kernel adaLN_cond__sliding_block_cached__glu_gated_swiglu__decode_kernel
  .amdhsa_next_free_vgpr 168
  .amdhsa_next_free_sgpr 102
  .amdhsa_accum_offset 168
  .amdhsa_group_segment_fixed_size 0
  .amdhsa_kernarg_size 112
  .amdhsa_user_sgpr_count 2
  .amdhsa_user_sgpr_kernarg_segment_ptr 1
  .amdhsa_system_sgpr_workgroup_id_x 1
.end_amdhsa_kernel
```

```asm
; @launch grid=(256,1,1) block=(768,1,1) lds=143360
.amdgcn_target "amdgcn-amd-amdhsa--gfx950"
.text
.globl adaLN_cond__sliding_block_cached__glu_gated_swiglu__decode_kernel
.p2align 8
.type adaLN_cond__sliding_block_cached__glu_gated_swiglu__decode_kernel,@function
adaLN_cond__sliding_block_cached__glu_gated_swiglu__decode_kernel:
  s_cmp_ge_u32 s2, 256
  s_cbranch_scc1 L_end
  s_load_dwordx16 s[16:31], s[0:1], 0
  s_load_dwordx8 s[32:39], s[0:1], 64
  s_load_dwordx4 s[40:43], s[0:1], 96
  v_lshrrev_b32 v2, 6, v0
  v_and_b32 v1, 63, v0
  v_readfirstlane_b32 s13, v2
  s_bfe_u32 s7, s2, 0x20003
  s_bfe_u32 s6, s2, 0x20005
  s_and_b32 s8, s2, 7
  s_lshl2_add_u32 s6, s8, s6
  s_and_b32 s9, s2, 0x80
  s_lshr_b32 s9, s9, 2
  s_add_u32 s6, s6, s9
  s_mov_b32 s72, 0xfffffffe
  s_mov_b32 s73, 0xffff0000
  s_cmp_eq_u32 s7, 3
  s_cbranch_scc1 L_serv
  s_cmp_eq_u32 s13, 0
  s_cbranch_scc1 L_pub
L_stream:
  s_sub_u32 s9, s13, 1
  s_lshl_b32 s11, s9, 10
  s_mul_i32 s4, s7, 349184
  s_lshl_b32 s10, s6, 22
  s_add_u32 s10, s10, s4
  s_add_u32 s10, s10, 0x300000
  v_lshl_add_u32 v0, v1, 4, s11
  s_lshr_b32 s12, s2, 3
  s_mul_i32 s12, s12, 5
  s_mul_i32 s15, s8, 3
  s_add_u32 s12, s12, s15
  s_and_b32 s15, s12, 31
  s_min_u32 s15, s15, 30
  s_mul_i32 s12, s15, 11264
  s_lshr_b32 s46, s7, 1
  s_lshl_b32 s46, s46, 10
  s_add_u32 s46, s46, 349184
  s_mov_b32 s47, 0x20000
  s_mov_b32 s14, 349184
  s_waitcnt lgkmcnt(0)
  s_add_u32 s44, s18, s10
  s_addc_u32 s45, s19, 0
  buffer_load_dwordx4 v[44:47], v0, s[44:47], s12 offen nt
  s_add_u32 s12, s12, 11264
  s_cmp_eq_u32 s12, s14
  s_cselect_b32 s12, 0, s12
  buffer_load_dwordx4 v[48:51], v0, s[44:47], s12 offen nt
  s_add_u32 s12, s12, 11264
  s_cmp_eq_u32 s12, s14
  s_cselect_b32 s12, 0, s12
  buffer_load_dwordx4 v[52:55], v0, s[44:47], s12 offen nt
  s_add_u32 s12, s12, 11264
  s_cmp_eq_u32 s12, s14
  s_cselect_b32 s12, 0, s12
  buffer_load_dwordx4 v[40:43], v0, s[44:47], s14 offen nt
  s_add_u32 s48, s20, s10
  s_addc_u32 s49, s21, 0
  s_mov_b32 s50, s46
  s_mov_b32 s51, 0x20000
  s_mov_b32 s52, 0xcccccccc
  s_mov_b32 s53, 0xcccccccc
  s_mov_b32 s54, 0xaaaaaaaa
  s_mov_b32 s55, 0xaaaaaaaa
  v_and_b32 v38, 15, v1
  v_lshlrev_b32 v38, 4, v38
  s_lshl_b32 s10, s9, 11
  s_add_u32 s10, s10, 12288
  v_lshl_add_u32 v3, v1, 3, s10
  v_mov_b32 v4, 0x7fff0000
  v_mov_b32 v5, 0xff800000
  ds_write_b64 v3, v[4:5] offset:0
  ds_write_b64 v3, v[4:5] offset:512
  ds_write_b64 v3, v[4:5] offset:1024
  v_lshrrev_b32 v3, 4, v1
  v_lshl_add_u32 v39, v38, 1, s10
  v_lshl_add_u32 v39, v3, 3, v39
  s_sub_u32 s68, s15, 1
  v_bfrev_b32 v4, v1
  v_lshrrev_b32 v4, 28, v4
  v_lshl_add_u32 v3, v3, 8, s11
  v_cmp_eq_u32 s[70:71], 0, v4
  v_add_u32 v24, s68, v4
  v_subrev_u32 v5, 31, v24
  v_min_u32 v24, v5, v24
  v_cndmask_b32 v24, v24, 31, s[70:71]
  v_mul_u32_u24 v24, 11264, v24
  v_add_u32 v24, v3, v24
  v_add_u32 v26, s68, v4
  v_add_u32 v26, 16, v26
  v_subrev_u32 v5, 31, v26
  v_min_u32 v26, v5, v26
  v_mul_u32_u24 v26, 11264, v26
  v_add_u32 v26, v3, v26
  s_lshl_b32 s11, s9, 9
  s_sub_u32 s11, s11, s10
  s_mov_b32 s32, 4
  s_mul_i32 s33, s9, 0x60000000
  s_add_u32 s33, s33, 0x10000000
  s_mov_b64 s[64:65], 0
  s_mov_b64 s[66:67], 0
  s_mov_b32 s38, 0
  s_mov_b32 s39, 2
  s_mov_b32 s75, 0
  s_mov_b32 s61, 0
  s_barrier
  s_waitcnt lgkmcnt(0)
  s_mov_b32 s56, s10
  s_mov_b32 s41, 5
  s_mov_b32 s57, 0
  s_mov_b32 s34, 174899
  s_mov_b32 s77, 0
  s_mov_b32 s35, 28
  s_mov_b32 s59, 0
  v_mov_b32 v22, 1332
  v_mov_b32 v23, 0
  v_mov_b32 v2, 0
  s_call_b64 s[62:63], L_kq
  buffer_load_dwordx4 v[56:59], v0, s[44:47], s12 offen nt
  s_add_u32 s12, s12, 11264
  s_cmp_eq_u32 s12, s14
  s_cselect_b32 s12, 0, s12
  s_call_b64 s[62:63], L_kq
  buffer_load_dwordx4 v[60:63], v0, s[44:47], s12 offen nt
  s_add_u32 s12, s12, 11264
  s_cmp_eq_u32 s12, s14
  s_cselect_b32 s12, 0, s12
  s_call_b64 s[62:63], L_kq
  buffer_load_dwordx4 v[64:67], v0, s[44:47], s12 offen nt
  s_add_u32 s12, s12, 11264
  s_cmp_eq_u32 s12, s14
  s_cselect_b32 s12, 0, s12
  s_call_b64 s[62:63], L_kq
  buffer_load_dwordx4 v[68:71], v0, s[44:47], s12 offen nt
  s_add_u32 s12, s12, 11264
  s_cmp_eq_u32 s12, s14
  s_cselect_b32 s12, 0, s12
  s_call_b64 s[62:63], L_kq
  buffer_load_dwordx4 v[72:75], v0, s[44:47], s12 offen nt
  s_add_u32 s12, s12, 11264
  s_cmp_eq_u32 s12, s14
  s_cselect_b32 s12, 0, s12
  s_call_b64 s[62:63], L_kq
  buffer_load_dwordx4 v[76:79], v0, s[44:47], s12 offen nt
  s_add_u32 s12, s12, 11264
  s_cmp_eq_u32 s12, s14
  s_cselect_b32 s12, 0, s12
  s_call_b64 s[62:63], L_kq
  buffer_load_dwordx4 v[80:83], v0, s[44:47], s12 offen nt
  s_add_u32 s12, s12, 11264
  s_cmp_eq_u32 s12, s14
  s_cselect_b32 s12, 0, s12
  s_call_b64 s[62:63], L_kq
  buffer_load_dwordx4 v[84:87], v0, s[44:47], s12 offen nt
  s_add_u32 s12, s12, 11264
  s_cmp_eq_u32 s12, s14
  s_cselect_b32 s12, 0, s12
  s_call_b64 s[62:63], L_kq
  buffer_load_dwordx4 v[88:91], v0, s[44:47], s12 offen nt
  s_add_u32 s12, s12, 11264
  s_cmp_eq_u32 s12, s14
  s_cselect_b32 s12, 0, s12
  s_call_b64 s[62:63], L_kq
  buffer_load_dwordx4 v[92:95], v0, s[44:47], s12 offen nt
  s_add_u32 s12, s12, 11264
  s_cmp_eq_u32 s12, s14
  s_cselect_b32 s12, 0, s12
  s_call_b64 s[62:63], L_kq
  buffer_load_dwordx4 v[96:99], v0, s[44:47], s12 offen nt
  s_add_u32 s12, s12, 11264
  s_cmp_eq_u32 s12, s14
  s_cselect_b32 s12, 0, s12
  s_call_b64 s[62:63], L_ks
  buffer_load_dwordx4 v[100:103], v0, s[44:47], s12 offen nt
  s_add_u32 s12, s12, 11264
  s_cmp_eq_u32 s12, s14
  s_cselect_b32 s12, 0, s12
  s_call_b64 s[62:63], L_ks
  buffer_load_dwordx4 v[104:107], v0, s[44:47], s12 offen nt
  s_add_u32 s12, s12, 11264
  s_cmp_eq_u32 s12, s14
  s_cselect_b32 s12, 0, s12
  s_call_b64 s[62:63], L_ks
  buffer_load_dwordx4 v[108:111], v0, s[44:47], s12 offen nt
  s_add_u32 s12, s12, 11264
  s_cmp_eq_u32 s12, s14
  s_cselect_b32 s12, 0, s12
  s_call_b64 s[62:63], L_ks
  buffer_load_dwordx4 v[112:115], v0, s[44:47], s12 offen nt
  s_add_u32 s12, s12, 11264
  s_cmp_eq_u32 s12, s14
  s_cselect_b32 s12, 0, s12
  s_call_b64 s[62:63], L_ks
  buffer_load_dwordx4 v[116:119], v0, s[44:47], s12 offen nt
  s_add_u32 s12, s12, 11264
  s_cmp_eq_u32 s12, s14
  s_cselect_b32 s12, 0, s12
  s_call_b64 s[62:63], L_ks
  buffer_load_dwordx4 v[120:123], v0, s[44:47], s12 offen nt
  s_add_u32 s12, s12, 11264
  s_cmp_eq_u32 s12, s14
  s_cselect_b32 s12, 0, s12
  s_call_b64 s[62:63], L_ks
  buffer_load_dwordx4 v[124:127], v0, s[44:47], s12 offen nt
  s_add_u32 s12, s12, 11264
  s_cmp_eq_u32 s12, s14
  s_cselect_b32 s12, 0, s12
  s_call_b64 s[62:63], L_ks
  buffer_load_dwordx4 v[128:131], v0, s[44:47], s12 offen nt
  s_add_u32 s12, s12, 11264
  s_cmp_eq_u32 s12, s14
  s_cselect_b32 s12, 0, s12
  s_call_b64 s[62:63], L_ks
  buffer_load_dwordx4 v[132:135], v0, s[44:47], s12 offen nt
  s_add_u32 s12, s12, 11264
  s_cmp_eq_u32 s12, s14
  s_cselect_b32 s12, 0, s12
  s_call_b64 s[62:63], L_ks
  buffer_load_dwordx4 v[136:139], v0, s[44:47], s12 offen nt
  s_add_u32 s12, s12, 11264
  s_cmp_eq_u32 s12, s14
  s_cselect_b32 s12, 0, s12
  s_call_b64 s[62:63], L_ks
  buffer_load_dwordx4 v[140:143], v0, s[44:47], s12 offen nt
  s_add_u32 s12, s12, 11264
  s_cmp_eq_u32 s12, s14
  s_cselect_b32 s12, 0, s12
  s_call_b64 s[62:63], L_ks
  buffer_load_dwordx4 v[144:147], v0, s[44:47], s12 offen nt
  s_add_u32 s12, s12, 11264
  s_cmp_eq_u32 s12, s14
  s_cselect_b32 s12, 0, s12
  s_call_b64 s[62:63], L_ks
  buffer_load_dwordx4 v[148:151], v0, s[44:47], s12 offen nt
  s_add_u32 s12, s12, 11264
  s_cmp_eq_u32 s12, s14
  s_cselect_b32 s12, 0, s12
  s_call_b64 s[62:63], L_ks
  buffer_load_dwordx4 v[152:155], v0, s[44:47], s12 offen nt
  s_add_u32 s12, s12, 11264
  s_cmp_eq_u32 s12, s14
  s_cselect_b32 s12, 0, s12
  s_call_b64 s[62:63], L_ks
  buffer_load_dwordx4 v[156:159], v0, s[44:47], s12 offen nt
  s_add_u32 s12, s12, 11264
  s_cmp_eq_u32 s12, s14
  s_cselect_b32 s12, 0, s12
  s_call_b64 s[62:63], L_ks
  buffer_load_dwordx4 v[160:163], v0, s[44:47], s12 offen nt
  s_add_u32 s12, s12, 11264
  s_cmp_eq_u32 s12, s14
  s_cselect_b32 s12, 0, s12
  s_call_b64 s[62:63], L_ks
  buffer_load_dwordx4 v[164:167], v0, s[44:47], s12 offen nt
  s_add_u32 s12, s12, 11264
  s_cmp_eq_u32 s12, s14
  s_cselect_b32 s12, 0, s12
  s_mov_b32 s10, 0
L_kw:
  s_cmp_ge_u32 s39, 6
  s_cbranch_scc1 L_v0
  s_call_b64 s[100:101], L_work
  s_sleep 1
  s_add_u32 s10, s10, 1
  s_cmp_lt_u32 s10, 262144
  s_cbranch_scc1 L_kw
L_v0:
  s_mov_b32 s32, 0
  v_mov_b32 v2, 8
  s_mov_b32 s35, s59
  ds_read_b64 v[22:23], v2 offset:288
  s_waitcnt lgkmcnt(0)
  v_and_b32 v3, 1, v1
  v_lshlrev_b32 v3, 4, v3
  v_mov_b32 v20, 0xffff
  v_lshlrev_b32 v3, v3, v20
  v_bfe_u32 v20, v1, 1, 3
  v_cmp_eq_u32 vcc, 0, v20
  s_nop 1
  v_cndmask_b32 v34, 0, v3, vcc
  v_cmp_eq_u32 vcc, 1, v20
  s_nop 1
  v_cndmask_b32 v35, 0, v3, vcc
  v_cmp_eq_u32 vcc, 2, v20
  s_nop 1
  v_cndmask_b32 v36, 0, v3, vcc
  v_cmp_eq_u32 vcc, 3, v20
  s_nop 1
  v_cndmask_b32 v0, 0, v3, vcc
  s_mov_b32 s77, 61
  s_mov_b32 s34, 163021
  s_call_b64 s[62:63], L_vs
  v_add_u32_dpp v3, v28, v38 row_newbcast:0 row_mask:0xf bank_mask:0xf
  buffer_load_dwordx4 v[40:43], v3, s[48:51], 0 offen nt
  v_dot2_f32_bf16 v8, v136, v4, 0
  v_dot2_f32_bf16 v9, v140, v4, 0
  v_dot2_f32_bf16 v10, v144, v4, 0
  v_dot2_f32_bf16 v11, v148, v4, 0
  v_dot2_f32_bf16 v8, v137, v5, v8
  v_dot2_f32_bf16 v9, v141, v5, v9
  v_dot2_f32_bf16 v10, v145, v5, v10
  v_dot2_f32_bf16 v11, v149, v5, v11
  v_dot2_f32_bf16 v8, v138, v6, v8
  v_dot2_f32_bf16 v9, v142, v6, v9
  v_dot2_f32_bf16 v10, v146, v6, v10
  v_dot2_f32_bf16 v11, v150, v6, v11
  v_dot2_f32_bf16 v8, v139, v7, v8
  v_dot2_f32_bf16 v9, v143, v7, v9
  v_dot2_f32_bf16 v10, v147, v7, v10
  v_dot2_f32_bf16 v11, v151, v7, v11
  v_add_f32_dpp v8, v8, v8 row_ror:8 row_mask:0xf bank_mask:0x3
  v_add_f32_dpp v8, v9, v9 row_ror:8 row_mask:0xf bank_mask:0xc
  v_add_f32_dpp v10, v10, v10 row_ror:8 row_mask:0xf bank_mask:0x3
  v_add_f32_dpp v10, v11, v11 row_ror:8 row_mask:0xf bank_mask:0xc
  s_nop 0
  v_add_f32_dpp v18, v8, v8 row_shl:4 row_mask:0xf bank_mask:0x5
  v_add_f32_dpp v18, v10, v10 row_shr:4 row_mask:0xf bank_mask:0xa
  s_call_b64 s[62:63], L_vs
  s_cbranch_scc0 L_dr5
  v_add_u32_dpp v3, v28, v38 row_newbcast:1 row_mask:0xf bank_mask:0xf
  buffer_load_dwordx4 v[44:47], v3, s[48:51], 0 offen nt
  s_call_b64 s[62:63], L_vs
  s_cbranch_scc0 L_dr5
  v_add_u32_dpp v3, v28, v38 row_newbcast:2 row_mask:0xf bank_mask:0xf
  buffer_load_dwordx4 v[48:51], v3, s[48:51], 0 offen nt
  s_call_b64 s[62:63], L_vs
  s_cbranch_scc0 L_dr5
  v_add_u32_dpp v3, v28, v38 row_newbcast:3 row_mask:0xf bank_mask:0xf
  buffer_load_dwordx4 v[52:55], v3, s[48:51], 0 offen nt
  s_call_b64 s[62:63], L_vs
  s_cbranch_scc0 L_dr5
  v_add_u32_dpp v3, v28, v38 row_newbcast:4 row_mask:0xf bank_mask:0xf
  buffer_load_dwordx4 v[56:59], v3, s[48:51], 0 offen nt
  s_call_b64 s[62:63], L_vs
  s_cbranch_scc0 L_dr5
  v_add_u32_dpp v3, v28, v38 row_newbcast:5 row_mask:0xf bank_mask:0xf
  buffer_load_dwordx4 v[60:63], v3, s[48:51], 0 offen nt
  v_and_b32_dpp v12, v29, v34 row_newbcast:0 row_mask:0xf bank_mask:0xf
  v_and_b32_dpp v13, v29, v35 row_newbcast:0 row_mask:0xf bank_mask:0xf
  v_and_b32_dpp v14, v29, v36 row_newbcast:0 row_mask:0xf bank_mask:0xf
  v_and_b32_dpp v15, v29, v0 row_newbcast:0 row_mask:0xf bank_mask:0xf
  s_nop 1
  v_mfma_f32_16x16x32_bf16 v[8:11], v[12:15], v[40:43], v[8:11]
  s_call_b64 s[62:63], L_vs
  s_cbranch_scc0 L_dr6
  v_add_u32_dpp v3, v28, v38 row_newbcast:6 row_mask:0xf bank_mask:0xf
  buffer_load_dwordx4 v[64:67], v3, s[48:51], 0 offen nt
  v_and_b32_dpp v12, v29, v34 row_newbcast:1 row_mask:0xf bank_mask:0xf
  v_and_b32_dpp v13, v29, v35 row_newbcast:1 row_mask:0xf bank_mask:0xf
  v_and_b32_dpp v14, v29, v36 row_newbcast:1 row_mask:0xf bank_mask:0xf
  v_and_b32_dpp v15, v29, v0 row_newbcast:1 row_mask:0xf bank_mask:0xf
  s_nop 1
  v_mfma_f32_16x16x32_bf16 v[8:11], v[12:15], v[44:47], v[8:11]
  s_call_b64 s[62:63], L_vs
  s_cbranch_scc0 L_dr7
  v_add_u32_dpp v3, v28, v38 row_newbcast:7 row_mask:0xf bank_mask:0xf
  buffer_load_dwordx4 v[68:71], v3, s[48:51], 0 offen nt
  v_and_b32_dpp v12, v29, v34 row_newbcast:2 row_mask:0xf bank_mask:0xf
  v_and_b32_dpp v13, v29, v35 row_newbcast:2 row_mask:0xf bank_mask:0xf
  v_and_b32_dpp v14, v29, v36 row_newbcast:2 row_mask:0xf bank_mask:0xf
  v_and_b32_dpp v15, v29, v0 row_newbcast:2 row_mask:0xf bank_mask:0xf
  s_nop 1
  v_mfma_f32_16x16x32_bf16 v[8:11], v[12:15], v[48:51], v[8:11]
  s_call_b64 s[62:63], L_vs
  s_cbranch_scc0 L_dr8
  v_add_u32_dpp v3, v28, v38 row_newbcast:8 row_mask:0xf bank_mask:0xf
  buffer_load_dwordx4 v[72:75], v3, s[48:51], 0 offen nt
  v_and_b32_dpp v12, v29, v34 row_newbcast:3 row_mask:0xf bank_mask:0xf
  v_and_b32_dpp v13, v29, v35 row_newbcast:3 row_mask:0xf bank_mask:0xf
  v_and_b32_dpp v14, v29, v36 row_newbcast:3 row_mask:0xf bank_mask:0xf
  v_and_b32_dpp v15, v29, v0 row_newbcast:3 row_mask:0xf bank_mask:0xf
  s_nop 1
  v_mfma_f32_16x16x32_bf16 v[8:11], v[12:15], v[52:55], v[8:11]
  s_call_b64 s[62:63], L_vs
  s_cbranch_scc0 L_dr9
  v_add_u32_dpp v3, v28, v38 row_newbcast:9 row_mask:0xf bank_mask:0xf
  buffer_load_dwordx4 v[76:79], v3, s[48:51], 0 offen nt
  v_and_b32_dpp v12, v29, v34 row_newbcast:4 row_mask:0xf bank_mask:0xf
  v_and_b32_dpp v13, v29, v35 row_newbcast:4 row_mask:0xf bank_mask:0xf
  v_and_b32_dpp v14, v29, v36 row_newbcast:4 row_mask:0xf bank_mask:0xf
  v_and_b32_dpp v15, v29, v0 row_newbcast:4 row_mask:0xf bank_mask:0xf
  s_nop 1
  v_mfma_f32_16x16x32_bf16 v[8:11], v[12:15], v[56:59], v[8:11]
  s_call_b64 s[62:63], L_vs
  s_cbranch_scc0 L_dr10
  v_add_u32_dpp v3, v28, v38 row_newbcast:10 row_mask:0xf bank_mask:0xf
  buffer_load_dwordx4 v[80:83], v3, s[48:51], 0 offen nt
  v_and_b32_dpp v12, v29, v34 row_newbcast:5 row_mask:0xf bank_mask:0xf
  v_and_b32_dpp v13, v29, v35 row_newbcast:5 row_mask:0xf bank_mask:0xf
  v_and_b32_dpp v14, v29, v36 row_newbcast:5 row_mask:0xf bank_mask:0xf
  v_and_b32_dpp v15, v29, v0 row_newbcast:5 row_mask:0xf bank_mask:0xf
  s_nop 1
  v_mfma_f32_16x16x32_bf16 v[8:11], v[12:15], v[60:63], v[8:11]
  s_call_b64 s[62:63], L_vq
  s_cbranch_scc0 L_dr11
  v_add_u32_dpp v3, v28, v38 row_newbcast:11 row_mask:0xf bank_mask:0xf
  buffer_load_dwordx4 v[84:87], v3, s[48:51], 0 offen nt
  v_and_b32_dpp v12, v29, v34 row_newbcast:6 row_mask:0xf bank_mask:0xf
  v_and_b32_dpp v13, v29, v35 row_newbcast:6 row_mask:0xf bank_mask:0xf
  v_and_b32_dpp v14, v29, v36 row_newbcast:6 row_mask:0xf bank_mask:0xf
  v_and_b32_dpp v15, v29, v0 row_newbcast:6 row_mask:0xf bank_mask:0xf
  s_nop 1
  v_mfma_f32_16x16x32_bf16 v[8:11], v[12:15], v[64:67], v[8:11]
  s_call_b64 s[62:63], L_vq
  s_cbranch_scc0 L_dr12
  v_add_u32_dpp v3, v28, v38 row_newbcast:12 row_mask:0xf bank_mask:0xf
  buffer_load_dwordx4 v[88:91], v3, s[48:51], 0 offen nt
  v_and_b32_dpp v12, v29, v34 row_newbcast:7 row_mask:0xf bank_mask:0xf
  v_and_b32_dpp v13, v29, v35 row_newbcast:7 row_mask:0xf bank_mask:0xf
  v_and_b32_dpp v14, v29, v36 row_newbcast:7 row_mask:0xf bank_mask:0xf
  v_and_b32_dpp v15, v29, v0 row_newbcast:7 row_mask:0xf bank_mask:0xf
  s_nop 1
  v_mfma_f32_16x16x32_bf16 v[8:11], v[12:15], v[68:71], v[8:11]
  s_call_b64 s[62:63], L_vq
  s_cbranch_scc0 L_dr13
  v_add_u32_dpp v3, v28, v38 row_newbcast:13 row_mask:0xf bank_mask:0xf
  buffer_load_dwordx4 v[92:95], v3, s[48:51], 0 offen nt
  v_and_b32_dpp v12, v29, v34 row_newbcast:8 row_mask:0xf bank_mask:0xf
  v_and_b32_dpp v13, v29, v35 row_newbcast:8 row_mask:0xf bank_mask:0xf
  v_and_b32_dpp v14, v29, v36 row_newbcast:8 row_mask:0xf bank_mask:0xf
  v_and_b32_dpp v15, v29, v0 row_newbcast:8 row_mask:0xf bank_mask:0xf
  s_nop 1
  v_mfma_f32_16x16x32_bf16 v[8:11], v[12:15], v[72:75], v[8:11]
  s_call_b64 s[62:63], L_vq
  s_cbranch_scc0 L_dr14
  v_add_u32_dpp v3, v28, v38 row_newbcast:14 row_mask:0xf bank_mask:0xf
  buffer_load_dwordx4 v[96:99], v3, s[48:51], 0 offen nt
  v_and_b32_dpp v12, v29, v34 row_newbcast:9 row_mask:0xf bank_mask:0xf
  v_and_b32_dpp v13, v29, v35 row_newbcast:9 row_mask:0xf bank_mask:0xf
  v_and_b32_dpp v14, v29, v36 row_newbcast:9 row_mask:0xf bank_mask:0xf
  v_and_b32_dpp v15, v29, v0 row_newbcast:9 row_mask:0xf bank_mask:0xf
  s_nop 1
  v_mfma_f32_16x16x32_bf16 v[8:11], v[12:15], v[76:79], v[8:11]
  s_call_b64 s[62:63], L_vq
  s_cbranch_scc0 L_dr15
  v_add_u32_dpp v3, v28, v38 row_newbcast:15 row_mask:0xf bank_mask:0xf
  buffer_load_dwordx4 v[100:103], v3, s[48:51], 0 offen nt
  v_and_b32_dpp v12, v29, v34 row_newbcast:10 row_mask:0xf bank_mask:0xf
  v_and_b32_dpp v13, v29, v35 row_newbcast:10 row_mask:0xf bank_mask:0xf
  v_and_b32_dpp v14, v29, v36 row_newbcast:10 row_mask:0xf bank_mask:0xf
  v_and_b32_dpp v15, v29, v0 row_newbcast:10 row_mask:0xf bank_mask:0xf
  s_nop 1
  v_mfma_f32_16x16x32_bf16 v[8:11], v[12:15], v[80:83], v[8:11]
  s_call_b64 s[62:63], L_vq
  s_cbranch_scc0 L_dr16
  v_add_u32_dpp v3, v30, v38 row_newbcast:0 row_mask:0xf bank_mask:0xf
  buffer_load_dwordx4 v[104:107], v3, s[48:51], 0 offen nt
  v_and_b32_dpp v12, v29, v34 row_newbcast:11 row_mask:0xf bank_mask:0xf
  v_and_b32_dpp v13, v29, v35 row_newbcast:11 row_mask:0xf bank_mask:0xf
  v_and_b32_dpp v14, v29, v36 row_newbcast:11 row_mask:0xf bank_mask:0xf
  v_and_b32_dpp v15, v29, v0 row_newbcast:11 row_mask:0xf bank_mask:0xf
  s_nop 1
  v_mfma_f32_16x16x32_bf16 v[8:11], v[12:15], v[84:87], v[8:11]
  s_call_b64 s[62:63], L_vq
  s_cbranch_scc0 L_dr17
  v_add_u32_dpp v3, v30, v38 row_newbcast:1 row_mask:0xf bank_mask:0xf
  buffer_load_dwordx4 v[108:111], v3, s[48:51], 0 offen nt
  v_and_b32_dpp v12, v29, v34 row_newbcast:12 row_mask:0xf bank_mask:0xf
  v_and_b32_dpp v13, v29, v35 row_newbcast:12 row_mask:0xf bank_mask:0xf
  v_and_b32_dpp v14, v29, v36 row_newbcast:12 row_mask:0xf bank_mask:0xf
  v_and_b32_dpp v15, v29, v0 row_newbcast:12 row_mask:0xf bank_mask:0xf
  s_nop 1
  v_mfma_f32_16x16x32_bf16 v[8:11], v[12:15], v[88:91], v[8:11]
  s_call_b64 s[62:63], L_vq
  s_cbranch_scc0 L_dr18
  v_add_u32_dpp v3, v30, v38 row_newbcast:2 row_mask:0xf bank_mask:0xf
  buffer_load_dwordx4 v[112:115], v3, s[48:51], 0 offen nt
  v_and_b32_dpp v12, v29, v34 row_newbcast:13 row_mask:0xf bank_mask:0xf
  v_and_b32_dpp v13, v29, v35 row_newbcast:13 row_mask:0xf bank_mask:0xf
  v_and_b32_dpp v14, v29, v36 row_newbcast:13 row_mask:0xf bank_mask:0xf
  v_and_b32_dpp v15, v29, v0 row_newbcast:13 row_mask:0xf bank_mask:0xf
  s_nop 1
  v_mfma_f32_16x16x32_bf16 v[8:11], v[12:15], v[92:95], v[8:11]
  s_call_b64 s[62:63], L_vq
  s_cbranch_scc0 L_dr19
  v_add_u32_dpp v3, v30, v38 row_newbcast:3 row_mask:0xf bank_mask:0xf
  buffer_load_dwordx4 v[116:119], v3, s[48:51], 0 offen nt
  v_and_b32_dpp v12, v29, v34 row_newbcast:14 row_mask:0xf bank_mask:0xf
  v_and_b32_dpp v13, v29, v35 row_newbcast:14 row_mask:0xf bank_mask:0xf
  v_and_b32_dpp v14, v29, v36 row_newbcast:14 row_mask:0xf bank_mask:0xf
  v_and_b32_dpp v15, v29, v0 row_newbcast:14 row_mask:0xf bank_mask:0xf
  s_nop 1
  v_mfma_f32_16x16x32_bf16 v[8:11], v[12:15], v[96:99], v[8:11]
  s_call_b64 s[62:63], L_vq
  s_cbranch_scc0 L_dr20
  v_add_u32_dpp v3, v30, v38 row_newbcast:4 row_mask:0xf bank_mask:0xf
  buffer_load_dwordx4 v[120:123], v3, s[48:51], 0 offen nt
  v_and_b32_dpp v12, v29, v34 row_newbcast:15 row_mask:0xf bank_mask:0xf
  v_and_b32_dpp v13, v29, v35 row_newbcast:15 row_mask:0xf bank_mask:0xf
  v_and_b32_dpp v14, v29, v36 row_newbcast:15 row_mask:0xf bank_mask:0xf
  v_and_b32_dpp v15, v29, v0 row_newbcast:15 row_mask:0xf bank_mask:0xf
  s_nop 1
  v_mfma_f32_16x16x32_bf16 v[8:11], v[12:15], v[100:103], v[8:11]
  s_call_b64 s[62:63], L_vq
  s_cbranch_scc0 L_dr21
  v_add_u32_dpp v3, v30, v38 row_newbcast:5 row_mask:0xf bank_mask:0xf
  buffer_load_dwordx4 v[124:127], v3, s[48:51], 0 offen nt
  v_and_b32_dpp v12, v31, v34 row_newbcast:0 row_mask:0xf bank_mask:0xf
  v_and_b32_dpp v13, v31, v35 row_newbcast:0 row_mask:0xf bank_mask:0xf
  v_and_b32_dpp v14, v31, v36 row_newbcast:0 row_mask:0xf bank_mask:0xf
  v_and_b32_dpp v15, v31, v0 row_newbcast:0 row_mask:0xf bank_mask:0xf
  s_nop 1
  v_mfma_f32_16x16x32_bf16 v[8:11], v[12:15], v[104:107], v[8:11]
  s_call_b64 s[62:63], L_vq
  s_cbranch_scc0 L_dr22
  v_add_u32_dpp v3, v30, v38 row_newbcast:6 row_mask:0xf bank_mask:0xf
  buffer_load_dwordx4 v[128:131], v3, s[48:51], 0 offen nt
  v_and_b32_dpp v12, v31, v34 row_newbcast:1 row_mask:0xf bank_mask:0xf
  v_and_b32_dpp v13, v31, v35 row_newbcast:1 row_mask:0xf bank_mask:0xf
  v_and_b32_dpp v14, v31, v36 row_newbcast:1 row_mask:0xf bank_mask:0xf
  v_and_b32_dpp v15, v31, v0 row_newbcast:1 row_mask:0xf bank_mask:0xf
  s_nop 1
  v_mfma_f32_16x16x32_bf16 v[8:11], v[12:15], v[108:111], v[8:11]
  s_call_b64 s[62:63], L_vq
  s_cbranch_scc0 L_dr23
  v_add_u32_dpp v3, v30, v38 row_newbcast:7 row_mask:0xf bank_mask:0xf
  buffer_load_dwordx4 v[132:135], v3, s[48:51], 0 offen nt
  v_and_b32_dpp v12, v31, v34 row_newbcast:2 row_mask:0xf bank_mask:0xf
  v_and_b32_dpp v13, v31, v35 row_newbcast:2 row_mask:0xf bank_mask:0xf
  v_and_b32_dpp v14, v31, v36 row_newbcast:2 row_mask:0xf bank_mask:0xf
  v_and_b32_dpp v15, v31, v0 row_newbcast:2 row_mask:0xf bank_mask:0xf
  s_nop 1
  v_mfma_f32_16x16x32_bf16 v[8:11], v[12:15], v[112:115], v[8:11]
  s_call_b64 s[62:63], L_vq
  s_cbranch_scc0 L_dr24
  v_add_u32_dpp v3, v30, v38 row_newbcast:8 row_mask:0xf bank_mask:0xf
  buffer_load_dwordx4 v[136:139], v3, s[48:51], 0 offen nt
  v_and_b32_dpp v12, v31, v34 row_newbcast:3 row_mask:0xf bank_mask:0xf
  v_and_b32_dpp v13, v31, v35 row_newbcast:3 row_mask:0xf bank_mask:0xf
  v_and_b32_dpp v14, v31, v36 row_newbcast:3 row_mask:0xf bank_mask:0xf
  v_and_b32_dpp v15, v31, v0 row_newbcast:3 row_mask:0xf bank_mask:0xf
  s_nop 1
  v_mfma_f32_16x16x32_bf16 v[8:11], v[12:15], v[116:119], v[8:11]
  s_call_b64 s[62:63], L_vq
  s_cbranch_scc0 L_dr25
  v_add_u32_dpp v3, v30, v38 row_newbcast:9 row_mask:0xf bank_mask:0xf
  buffer_load_dwordx4 v[140:143], v3, s[48:51], 0 offen nt
  v_and_b32_dpp v12, v31, v34 row_newbcast:4 row_mask:0xf bank_mask:0xf
  v_and_b32_dpp v13, v31, v35 row_newbcast:4 row_mask:0xf bank_mask:0xf
  v_and_b32_dpp v14, v31, v36 row_newbcast:4 row_mask:0xf bank_mask:0xf
  v_and_b32_dpp v15, v31, v0 row_newbcast:4 row_mask:0xf bank_mask:0xf
  s_nop 1
  v_mfma_f32_16x16x32_bf16 v[8:11], v[12:15], v[120:123], v[8:11]
  s_call_b64 s[62:63], L_vq
  s_cbranch_scc0 L_dr26
  v_add_u32_dpp v3, v30, v38 row_newbcast:10 row_mask:0xf bank_mask:0xf
  buffer_load_dwordx4 v[144:147], v3, s[48:51], 0 offen nt
  v_and_b32_dpp v12, v31, v34 row_newbcast:5 row_mask:0xf bank_mask:0xf
  v_and_b32_dpp v13, v31, v35 row_newbcast:5 row_mask:0xf bank_mask:0xf
  v_and_b32_dpp v14, v31, v36 row_newbcast:5 row_mask:0xf bank_mask:0xf
  v_and_b32_dpp v15, v31, v0 row_newbcast:5 row_mask:0xf bank_mask:0xf
  s_nop 1
  v_mfma_f32_16x16x32_bf16 v[8:11], v[12:15], v[124:127], v[8:11]
  s_call_b64 s[62:63], L_vq
  s_cbranch_scc0 L_dr27
  v_add_u32_dpp v3, v30, v38 row_newbcast:11 row_mask:0xf bank_mask:0xf
  buffer_load_dwordx4 v[148:151], v3, s[48:51], 0 offen nt
  v_and_b32_dpp v12, v31, v34 row_newbcast:6 row_mask:0xf bank_mask:0xf
  v_and_b32_dpp v13, v31, v35 row_newbcast:6 row_mask:0xf bank_mask:0xf
  v_and_b32_dpp v14, v31, v36 row_newbcast:6 row_mask:0xf bank_mask:0xf
  v_and_b32_dpp v15, v31, v0 row_newbcast:6 row_mask:0xf bank_mask:0xf
  s_nop 1
  v_mfma_f32_16x16x32_bf16 v[8:11], v[12:15], v[128:131], v[8:11]
  s_call_b64 s[62:63], L_vq
  s_cbranch_scc0 L_dr28
  v_add_u32_dpp v3, v30, v38 row_newbcast:12 row_mask:0xf bank_mask:0xf
  buffer_load_dwordx4 v[152:155], v3, s[48:51], 0 offen nt
  v_and_b32_dpp v12, v31, v34 row_newbcast:7 row_mask:0xf bank_mask:0xf
  v_and_b32_dpp v13, v31, v35 row_newbcast:7 row_mask:0xf bank_mask:0xf
  v_and_b32_dpp v14, v31, v36 row_newbcast:7 row_mask:0xf bank_mask:0xf
  v_and_b32_dpp v15, v31, v0 row_newbcast:7 row_mask:0xf bank_mask:0xf
  s_nop 1
  v_mfma_f32_16x16x32_bf16 v[8:11], v[12:15], v[132:135], v[8:11]
  s_call_b64 s[62:63], L_vq
  s_cbranch_scc0 L_dr29
  v_add_u32_dpp v3, v30, v38 row_newbcast:13 row_mask:0xf bank_mask:0xf
  buffer_load_dwordx4 v[156:159], v3, s[48:51], 0 offen nt
  v_and_b32_dpp v12, v31, v34 row_newbcast:8 row_mask:0xf bank_mask:0xf
  v_and_b32_dpp v13, v31, v35 row_newbcast:8 row_mask:0xf bank_mask:0xf
  v_and_b32_dpp v14, v31, v36 row_newbcast:8 row_mask:0xf bank_mask:0xf
  v_and_b32_dpp v15, v31, v0 row_newbcast:8 row_mask:0xf bank_mask:0xf
  s_nop 1
  v_mfma_f32_16x16x32_bf16 v[8:11], v[12:15], v[136:139], v[8:11]
  s_call_b64 s[62:63], L_vq
  s_cbranch_scc0 L_dr30
  v_add_u32_dpp v3, v30, v38 row_newbcast:14 row_mask:0xf bank_mask:0xf
  buffer_load_dwordx4 v[160:163], v3, s[48:51], 0 offen nt
  v_and_b32_dpp v12, v31, v34 row_newbcast:9 row_mask:0xf bank_mask:0xf
  v_and_b32_dpp v13, v31, v35 row_newbcast:9 row_mask:0xf bank_mask:0xf
  v_and_b32_dpp v14, v31, v36 row_newbcast:9 row_mask:0xf bank_mask:0xf
  v_and_b32_dpp v15, v31, v0 row_newbcast:9 row_mask:0xf bank_mask:0xf
  s_nop 1
  v_mfma_f32_16x16x32_bf16 v[8:11], v[12:15], v[140:143], v[8:11]
  s_call_b64 s[62:63], L_vq
  s_cbranch_scc0 L_dr31
  v_add_u32_dpp v3, v30, v38 row_newbcast:15 row_mask:0xf bank_mask:0xf
  buffer_load_dwordx4 v[164:167], v3, s[48:51], 0 offen nt
  v_and_b32_dpp v12, v31, v34 row_newbcast:10 row_mask:0xf bank_mask:0xf
  v_and_b32_dpp v13, v31, v35 row_newbcast:10 row_mask:0xf bank_mask:0xf
  v_and_b32_dpp v14, v31, v36 row_newbcast:10 row_mask:0xf bank_mask:0xf
  v_and_b32_dpp v15, v31, v0 row_newbcast:10 row_mask:0xf bank_mask:0xf
  s_nop 1
  v_mfma_f32_16x16x32_bf16 v[8:11], v[12:15], v[144:147], v[8:11]
  s_call_b64 s[62:63], L_vq
  s_cbranch_scc0 L_dr32
  v_add_u32_dpp v3, v32, v38 row_newbcast:0 row_mask:0xf bank_mask:0xf
  buffer_load_dwordx4 v[40:43], v3, s[48:51], 0 offen nt
  v_and_b32_dpp v12, v31, v34 row_newbcast:11 row_mask:0xf bank_mask:0xf
  v_and_b32_dpp v13, v31, v35 row_newbcast:11 row_mask:0xf bank_mask:0xf
  v_and_b32_dpp v14, v31, v36 row_newbcast:11 row_mask:0xf bank_mask:0xf
  v_and_b32_dpp v15, v31, v0 row_newbcast:11 row_mask:0xf bank_mask:0xf
  s_nop 1
  v_mfma_f32_16x16x32_bf16 v[8:11], v[12:15], v[148:151], v[8:11]
  s_call_b64 s[62:63], L_vq
  s_cbranch_scc0 L_dr33
  v_add_u32_dpp v3, v32, v38 row_newbcast:1 row_mask:0xf bank_mask:0xf
  buffer_load_dwordx4 v[44:47], v3, s[48:51], 0 offen nt
  v_and_b32_dpp v12, v31, v34 row_newbcast:12 row_mask:0xf bank_mask:0xf
  v_and_b32_dpp v13, v31, v35 row_newbcast:12 row_mask:0xf bank_mask:0xf
  v_and_b32_dpp v14, v31, v36 row_newbcast:12 row_mask:0xf bank_mask:0xf
  v_and_b32_dpp v15, v31, v0 row_newbcast:12 row_mask:0xf bank_mask:0xf
  s_nop 1
  v_mfma_f32_16x16x32_bf16 v[8:11], v[12:15], v[152:155], v[8:11]
  s_call_b64 s[62:63], L_vq
  s_cbranch_scc0 L_dr34
  v_add_u32_dpp v3, v32, v38 row_newbcast:2 row_mask:0xf bank_mask:0xf
  buffer_load_dwordx4 v[48:51], v3, s[48:51], 0 offen nt
  v_and_b32_dpp v12, v31, v34 row_newbcast:13 row_mask:0xf bank_mask:0xf
  v_and_b32_dpp v13, v31, v35 row_newbcast:13 row_mask:0xf bank_mask:0xf
  v_and_b32_dpp v14, v31, v36 row_newbcast:13 row_mask:0xf bank_mask:0xf
  v_and_b32_dpp v15, v31, v0 row_newbcast:13 row_mask:0xf bank_mask:0xf
  s_nop 1
  v_mfma_f32_16x16x32_bf16 v[8:11], v[12:15], v[156:159], v[8:11]
  s_call_b64 s[62:63], L_vq
  s_cbranch_scc0 L_dr35
  v_add_u32_dpp v3, v32, v38 row_newbcast:3 row_mask:0xf bank_mask:0xf
  buffer_load_dwordx4 v[52:55], v3, s[48:51], 0 offen nt
  v_and_b32_dpp v12, v31, v34 row_newbcast:14 row_mask:0xf bank_mask:0xf
  v_and_b32_dpp v13, v31, v35 row_newbcast:14 row_mask:0xf bank_mask:0xf
  v_and_b32_dpp v14, v31, v36 row_newbcast:14 row_mask:0xf bank_mask:0xf
  v_and_b32_dpp v15, v31, v0 row_newbcast:14 row_mask:0xf bank_mask:0xf
  s_nop 1
  v_mfma_f32_16x16x32_bf16 v[8:11], v[12:15], v[160:163], v[8:11]
  s_call_b64 s[62:63], L_vq
  s_cbranch_scc0 L_dr36
  v_add_u32_dpp v3, v32, v38 row_newbcast:4 row_mask:0xf bank_mask:0xf
  buffer_load_dwordx4 v[56:59], v3, s[48:51], 0 offen nt
  v_and_b32_dpp v12, v31, v34 row_newbcast:15 row_mask:0xf bank_mask:0xf
  v_and_b32_dpp v13, v31, v35 row_newbcast:15 row_mask:0xf bank_mask:0xf
  v_and_b32_dpp v14, v31, v36 row_newbcast:15 row_mask:0xf bank_mask:0xf
  v_and_b32_dpp v15, v31, v0 row_newbcast:15 row_mask:0xf bank_mask:0xf
  s_nop 1
  v_mfma_f32_16x16x32_bf16 v[8:11], v[12:15], v[164:167], v[8:11]
  s_call_b64 s[62:63], L_vq
  s_cbranch_scc0 L_dr37
  v_add_u32_dpp v3, v32, v38 row_newbcast:5 row_mask:0xf bank_mask:0xf
  buffer_load_dwordx4 v[60:63], v3, s[48:51], 0 offen nt
  v_and_b32_dpp v12, v33, v34 row_newbcast:0 row_mask:0xf bank_mask:0xf
  v_and_b32_dpp v13, v33, v35 row_newbcast:0 row_mask:0xf bank_mask:0xf
  v_and_b32_dpp v14, v33, v36 row_newbcast:0 row_mask:0xf bank_mask:0xf
  v_and_b32_dpp v15, v33, v0 row_newbcast:0 row_mask:0xf bank_mask:0xf
  s_nop 1
  v_mfma_f32_16x16x32_bf16 v[8:11], v[12:15], v[40:43], v[8:11]
  s_call_b64 s[62:63], L_vq
  s_branch L_dr38
L_dr5:
  v_and_b32_dpp v12, v29, v34 row_newbcast:0 row_mask:0xf bank_mask:0xf
  v_and_b32_dpp v13, v29, v35 row_newbcast:0 row_mask:0xf bank_mask:0xf
  v_and_b32_dpp v14, v29, v36 row_newbcast:0 row_mask:0xf bank_mask:0xf
  v_and_b32_dpp v15, v29, v0 row_newbcast:0 row_mask:0xf bank_mask:0xf
  s_nop 1
  v_mfma_f32_16x16x32_bf16 v[8:11], v[12:15], v[40:43], v[8:11]
  s_cmp_eq_u32 s75, 6
  s_cbranch_scc1 L_epi
L_dr6:
  v_and_b32_dpp v12, v29, v34 row_newbcast:1 row_mask:0xf bank_mask:0xf
  v_and_b32_dpp v13, v29, v35 row_newbcast:1 row_mask:0xf bank_mask:0xf
  v_and_b32_dpp v14, v29, v36 row_newbcast:1 row_mask:0xf bank_mask:0xf
  v_and_b32_dpp v15, v29, v0 row_newbcast:1 row_mask:0xf bank_mask:0xf
  s_nop 1
  v_mfma_f32_16x16x32_bf16 v[8:11], v[12:15], v[44:47], v[8:11]
  s_cmp_eq_u32 s75, 7
  s_cbranch_scc1 L_epi
L_dr7:
  v_and_b32_dpp v12, v29, v34 row_newbcast:2 row_mask:0xf bank_mask:0xf
  v_and_b32_dpp v13, v29, v35 row_newbcast:2 row_mask:0xf bank_mask:0xf
  v_and_b32_dpp v14, v29, v36 row_newbcast:2 row_mask:0xf bank_mask:0xf
  v_and_b32_dpp v15, v29, v0 row_newbcast:2 row_mask:0xf bank_mask:0xf
  s_nop 1
  v_mfma_f32_16x16x32_bf16 v[8:11], v[12:15], v[48:51], v[8:11]
  s_cmp_eq_u32 s75, 8
  s_cbranch_scc1 L_epi
L_dr8:
  v_and_b32_dpp v12, v29, v34 row_newbcast:3 row_mask:0xf bank_mask:0xf
  v_and_b32_dpp v13, v29, v35 row_newbcast:3 row_mask:0xf bank_mask:0xf
  v_and_b32_dpp v14, v29, v36 row_newbcast:3 row_mask:0xf bank_mask:0xf
  v_and_b32_dpp v15, v29, v0 row_newbcast:3 row_mask:0xf bank_mask:0xf
  s_nop 1
  v_mfma_f32_16x16x32_bf16 v[8:11], v[12:15], v[52:55], v[8:11]
  s_cmp_eq_u32 s75, 9
  s_cbranch_scc1 L_epi
L_dr9:
  v_and_b32_dpp v12, v29, v34 row_newbcast:4 row_mask:0xf bank_mask:0xf
  v_and_b32_dpp v13, v29, v35 row_newbcast:4 row_mask:0xf bank_mask:0xf
  v_and_b32_dpp v14, v29, v36 row_newbcast:4 row_mask:0xf bank_mask:0xf
  v_and_b32_dpp v15, v29, v0 row_newbcast:4 row_mask:0xf bank_mask:0xf
  s_nop 1
  v_mfma_f32_16x16x32_bf16 v[8:11], v[12:15], v[56:59], v[8:11]
  s_cmp_eq_u32 s75, 10
  s_cbranch_scc1 L_epi
L_dr10:
  v_and_b32_dpp v12, v29, v34 row_newbcast:5 row_mask:0xf bank_mask:0xf
  v_and_b32_dpp v13, v29, v35 row_newbcast:5 row_mask:0xf bank_mask:0xf
  v_and_b32_dpp v14, v29, v36 row_newbcast:5 row_mask:0xf bank_mask:0xf
  v_and_b32_dpp v15, v29, v0 row_newbcast:5 row_mask:0xf bank_mask:0xf
  s_nop 1
  v_mfma_f32_16x16x32_bf16 v[8:11], v[12:15], v[60:63], v[8:11]
  s_cmp_eq_u32 s75, 11
  s_cbranch_scc1 L_epi
L_dr11:
  v_and_b32_dpp v12, v29, v34 row_newbcast:6 row_mask:0xf bank_mask:0xf
  v_and_b32_dpp v13, v29, v35 row_newbcast:6 row_mask:0xf bank_mask:0xf
  v_and_b32_dpp v14, v29, v36 row_newbcast:6 row_mask:0xf bank_mask:0xf
  v_and_b32_dpp v15, v29, v0 row_newbcast:6 row_mask:0xf bank_mask:0xf
  s_nop 1
  v_mfma_f32_16x16x32_bf16 v[8:11], v[12:15], v[64:67], v[8:11]
  s_cmp_eq_u32 s75, 12
  s_cbranch_scc1 L_epi
L_dr12:
  v_and_b32_dpp v12, v29, v34 row_newbcast:7 row_mask:0xf bank_mask:0xf
  v_and_b32_dpp v13, v29, v35 row_newbcast:7 row_mask:0xf bank_mask:0xf
  v_and_b32_dpp v14, v29, v36 row_newbcast:7 row_mask:0xf bank_mask:0xf
  v_and_b32_dpp v15, v29, v0 row_newbcast:7 row_mask:0xf bank_mask:0xf
  s_nop 1
  v_mfma_f32_16x16x32_bf16 v[8:11], v[12:15], v[68:71], v[8:11]
  s_cmp_eq_u32 s75, 13
  s_cbranch_scc1 L_epi
L_dr13:
  v_and_b32_dpp v12, v29, v34 row_newbcast:8 row_mask:0xf bank_mask:0xf
  v_and_b32_dpp v13, v29, v35 row_newbcast:8 row_mask:0xf bank_mask:0xf
  v_and_b32_dpp v14, v29, v36 row_newbcast:8 row_mask:0xf bank_mask:0xf
  v_and_b32_dpp v15, v29, v0 row_newbcast:8 row_mask:0xf bank_mask:0xf
  s_nop 1
  v_mfma_f32_16x16x32_bf16 v[8:11], v[12:15], v[72:75], v[8:11]
  s_cmp_eq_u32 s75, 14
  s_cbranch_scc1 L_epi
L_dr14:
  v_and_b32_dpp v12, v29, v34 row_newbcast:9 row_mask:0xf bank_mask:0xf
  v_and_b32_dpp v13, v29, v35 row_newbcast:9 row_mask:0xf bank_mask:0xf
  v_and_b32_dpp v14, v29, v36 row_newbcast:9 row_mask:0xf bank_mask:0xf
  v_and_b32_dpp v15, v29, v0 row_newbcast:9 row_mask:0xf bank_mask:0xf
  s_nop 1
  v_mfma_f32_16x16x32_bf16 v[8:11], v[12:15], v[76:79], v[8:11]
  s_cmp_eq_u32 s75, 15
  s_cbranch_scc1 L_epi
L_dr15:
  v_and_b32_dpp v12, v29, v34 row_newbcast:10 row_mask:0xf bank_mask:0xf
  v_and_b32_dpp v13, v29, v35 row_newbcast:10 row_mask:0xf bank_mask:0xf
  v_and_b32_dpp v14, v29, v36 row_newbcast:10 row_mask:0xf bank_mask:0xf
  v_and_b32_dpp v15, v29, v0 row_newbcast:10 row_mask:0xf bank_mask:0xf
  s_nop 1
  v_mfma_f32_16x16x32_bf16 v[8:11], v[12:15], v[80:83], v[8:11]
  s_cmp_eq_u32 s75, 16
  s_cbranch_scc1 L_epi
L_dr16:
  v_and_b32_dpp v12, v29, v34 row_newbcast:11 row_mask:0xf bank_mask:0xf
  v_and_b32_dpp v13, v29, v35 row_newbcast:11 row_mask:0xf bank_mask:0xf
  v_and_b32_dpp v14, v29, v36 row_newbcast:11 row_mask:0xf bank_mask:0xf
  v_and_b32_dpp v15, v29, v0 row_newbcast:11 row_mask:0xf bank_mask:0xf
  s_nop 1
  v_mfma_f32_16x16x32_bf16 v[8:11], v[12:15], v[84:87], v[8:11]
  s_cmp_eq_u32 s75, 17
  s_cbranch_scc1 L_epi
L_dr17:
  v_and_b32_dpp v12, v29, v34 row_newbcast:12 row_mask:0xf bank_mask:0xf
  v_and_b32_dpp v13, v29, v35 row_newbcast:12 row_mask:0xf bank_mask:0xf
  v_and_b32_dpp v14, v29, v36 row_newbcast:12 row_mask:0xf bank_mask:0xf
  v_and_b32_dpp v15, v29, v0 row_newbcast:12 row_mask:0xf bank_mask:0xf
  s_nop 1
  v_mfma_f32_16x16x32_bf16 v[8:11], v[12:15], v[88:91], v[8:11]
  s_cmp_eq_u32 s75, 18
  s_cbranch_scc1 L_epi
L_dr18:
  v_and_b32_dpp v12, v29, v34 row_newbcast:13 row_mask:0xf bank_mask:0xf
  v_and_b32_dpp v13, v29, v35 row_newbcast:13 row_mask:0xf bank_mask:0xf
  v_and_b32_dpp v14, v29, v36 row_newbcast:13 row_mask:0xf bank_mask:0xf
  v_and_b32_dpp v15, v29, v0 row_newbcast:13 row_mask:0xf bank_mask:0xf
  s_nop 1
  v_mfma_f32_16x16x32_bf16 v[8:11], v[12:15], v[92:95], v[8:11]
  s_cmp_eq_u32 s75, 19
  s_cbranch_scc1 L_epi
L_dr19:
  v_and_b32_dpp v12, v29, v34 row_newbcast:14 row_mask:0xf bank_mask:0xf
  v_and_b32_dpp v13, v29, v35 row_newbcast:14 row_mask:0xf bank_mask:0xf
  v_and_b32_dpp v14, v29, v36 row_newbcast:14 row_mask:0xf bank_mask:0xf
  v_and_b32_dpp v15, v29, v0 row_newbcast:14 row_mask:0xf bank_mask:0xf
  s_nop 1
  v_mfma_f32_16x16x32_bf16 v[8:11], v[12:15], v[96:99], v[8:11]
  s_cmp_eq_u32 s75, 20
  s_cbranch_scc1 L_epi
L_dr20:
  v_and_b32_dpp v12, v29, v34 row_newbcast:15 row_mask:0xf bank_mask:0xf
  v_and_b32_dpp v13, v29, v35 row_newbcast:15 row_mask:0xf bank_mask:0xf
  v_and_b32_dpp v14, v29, v36 row_newbcast:15 row_mask:0xf bank_mask:0xf
  v_and_b32_dpp v15, v29, v0 row_newbcast:15 row_mask:0xf bank_mask:0xf
  s_nop 1
  v_mfma_f32_16x16x32_bf16 v[8:11], v[12:15], v[100:103], v[8:11]
  s_cmp_eq_u32 s75, 21
  s_cbranch_scc1 L_epi
L_dr21:
  v_and_b32_dpp v12, v31, v34 row_newbcast:0 row_mask:0xf bank_mask:0xf
  v_and_b32_dpp v13, v31, v35 row_newbcast:0 row_mask:0xf bank_mask:0xf
  v_and_b32_dpp v14, v31, v36 row_newbcast:0 row_mask:0xf bank_mask:0xf
  v_and_b32_dpp v15, v31, v0 row_newbcast:0 row_mask:0xf bank_mask:0xf
  s_nop 1
  v_mfma_f32_16x16x32_bf16 v[8:11], v[12:15], v[104:107], v[8:11]
  s_cmp_eq_u32 s75, 22
  s_cbranch_scc1 L_epi
L_dr22:
  v_and_b32_dpp v12, v31, v34 row_newbcast:1 row_mask:0xf bank_mask:0xf
  v_and_b32_dpp v13, v31, v35 row_newbcast:1 row_mask:0xf bank_mask:0xf
  v_and_b32_dpp v14, v31, v36 row_newbcast:1 row_mask:0xf bank_mask:0xf
  v_and_b32_dpp v15, v31, v0 row_newbcast:1 row_mask:0xf bank_mask:0xf
  s_nop 1
  v_mfma_f32_16x16x32_bf16 v[8:11], v[12:15], v[108:111], v[8:11]
  s_cmp_eq_u32 s75, 23
  s_cbranch_scc1 L_epi
L_dr23:
  v_and_b32_dpp v12, v31, v34 row_newbcast:2 row_mask:0xf bank_mask:0xf
  v_and_b32_dpp v13, v31, v35 row_newbcast:2 row_mask:0xf bank_mask:0xf
  v_and_b32_dpp v14, v31, v36 row_newbcast:2 row_mask:0xf bank_mask:0xf
  v_and_b32_dpp v15, v31, v0 row_newbcast:2 row_mask:0xf bank_mask:0xf
  s_nop 1
  v_mfma_f32_16x16x32_bf16 v[8:11], v[12:15], v[112:115], v[8:11]
  s_cmp_eq_u32 s75, 24
  s_cbranch_scc1 L_epi
L_dr24:
  v_and_b32_dpp v12, v31, v34 row_newbcast:3 row_mask:0xf bank_mask:0xf
  v_and_b32_dpp v13, v31, v35 row_newbcast:3 row_mask:0xf bank_mask:0xf
  v_and_b32_dpp v14, v31, v36 row_newbcast:3 row_mask:0xf bank_mask:0xf
  v_and_b32_dpp v15, v31, v0 row_newbcast:3 row_mask:0xf bank_mask:0xf
  s_nop 1
  v_mfma_f32_16x16x32_bf16 v[8:11], v[12:15], v[116:119], v[8:11]
  s_cmp_eq_u32 s75, 25
  s_cbranch_scc1 L_epi
L_dr25:
  v_and_b32_dpp v12, v31, v34 row_newbcast:4 row_mask:0xf bank_mask:0xf
  v_and_b32_dpp v13, v31, v35 row_newbcast:4 row_mask:0xf bank_mask:0xf
  v_and_b32_dpp v14, v31, v36 row_newbcast:4 row_mask:0xf bank_mask:0xf
  v_and_b32_dpp v15, v31, v0 row_newbcast:4 row_mask:0xf bank_mask:0xf
  s_nop 1
  v_mfma_f32_16x16x32_bf16 v[8:11], v[12:15], v[120:123], v[8:11]
  s_cmp_eq_u32 s75, 26
  s_cbranch_scc1 L_epi
L_dr26:
  v_and_b32_dpp v12, v31, v34 row_newbcast:5 row_mask:0xf bank_mask:0xf
  v_and_b32_dpp v13, v31, v35 row_newbcast:5 row_mask:0xf bank_mask:0xf
  v_and_b32_dpp v14, v31, v36 row_newbcast:5 row_mask:0xf bank_mask:0xf
  v_and_b32_dpp v15, v31, v0 row_newbcast:5 row_mask:0xf bank_mask:0xf
  s_nop 1
  v_mfma_f32_16x16x32_bf16 v[8:11], v[12:15], v[124:127], v[8:11]
  s_cmp_eq_u32 s75, 27
  s_cbranch_scc1 L_epi
L_dr27:
  v_and_b32_dpp v12, v31, v34 row_newbcast:6 row_mask:0xf bank_mask:0xf
  v_and_b32_dpp v13, v31, v35 row_newbcast:6 row_mask:0xf bank_mask:0xf
  v_and_b32_dpp v14, v31, v36 row_newbcast:6 row_mask:0xf bank_mask:0xf
  v_and_b32_dpp v15, v31, v0 row_newbcast:6 row_mask:0xf bank_mask:0xf
  s_nop 1
  v_mfma_f32_16x16x32_bf16 v[8:11], v[12:15], v[128:131], v[8:11]
  s_cmp_eq_u32 s75, 28
  s_cbranch_scc1 L_epi
L_dr28:
  v_and_b32_dpp v12, v31, v34 row_newbcast:7 row_mask:0xf bank_mask:0xf
  v_and_b32_dpp v13, v31, v35 row_newbcast:7 row_mask:0xf bank_mask:0xf
  v_and_b32_dpp v14, v31, v36 row_newbcast:7 row_mask:0xf bank_mask:0xf
  v_and_b32_dpp v15, v31, v0 row_newbcast:7 row_mask:0xf bank_mask:0xf
  s_nop 1
  v_mfma_f32_16x16x32_bf16 v[8:11], v[12:15], v[132:135], v[8:11]
  s_cmp_eq_u32 s75, 29
  s_cbranch_scc1 L_epi
L_dr29:
  v_and_b32_dpp v12, v31, v34 row_newbcast:8 row_mask:0xf bank_mask:0xf
  v_and_b32_dpp v13, v31, v35 row_newbcast:8 row_mask:0xf bank_mask:0xf
  v_and_b32_dpp v14, v31, v36 row_newbcast:8 row_mask:0xf bank_mask:0xf
  v_and_b32_dpp v15, v31, v0 row_newbcast:8 row_mask:0xf bank_mask:0xf
  s_nop 1
  v_mfma_f32_16x16x32_bf16 v[8:11], v[12:15], v[136:139], v[8:11]
  s_cmp_eq_u32 s75, 30
  s_cbranch_scc1 L_epi
L_dr30:
  v_and_b32_dpp v12, v31, v34 row_newbcast:9 row_mask:0xf bank_mask:0xf
  v_and_b32_dpp v13, v31, v35 row_newbcast:9 row_mask:0xf bank_mask:0xf
  v_and_b32_dpp v14, v31, v36 row_newbcast:9 row_mask:0xf bank_mask:0xf
  v_and_b32_dpp v15, v31, v0 row_newbcast:9 row_mask:0xf bank_mask:0xf
  s_nop 1
  v_mfma_f32_16x16x32_bf16 v[8:11], v[12:15], v[140:143], v[8:11]
  s_cmp_eq_u32 s75, 31
  s_cbranch_scc1 L_epi
L_dr31:
  v_and_b32_dpp v12, v31, v34 row_newbcast:10 row_mask:0xf bank_mask:0xf
  v_and_b32_dpp v13, v31, v35 row_newbcast:10 row_mask:0xf bank_mask:0xf
  v_and_b32_dpp v14, v31, v36 row_newbcast:10 row_mask:0xf bank_mask:0xf
  v_and_b32_dpp v15, v31, v0 row_newbcast:10 row_mask:0xf bank_mask:0xf
  s_nop 1
  v_mfma_f32_16x16x32_bf16 v[8:11], v[12:15], v[144:147], v[8:11]
  s_cmp_eq_u32 s75, 32
  s_cbranch_scc1 L_epi
L_dr32:
  v_and_b32_dpp v12, v31, v34 row_newbcast:11 row_mask:0xf bank_mask:0xf
  v_and_b32_dpp v13, v31, v35 row_newbcast:11 row_mask:0xf bank_mask:0xf
  v_and_b32_dpp v14, v31, v36 row_newbcast:11 row_mask:0xf bank_mask:0xf
  v_and_b32_dpp v15, v31, v0 row_newbcast:11 row_mask:0xf bank_mask:0xf
  s_nop 1
  v_mfma_f32_16x16x32_bf16 v[8:11], v[12:15], v[148:151], v[8:11]
  s_cmp_eq_u32 s75, 33
  s_cbranch_scc1 L_epi
L_dr33:
  v_and_b32_dpp v12, v31, v34 row_newbcast:12 row_mask:0xf bank_mask:0xf
  v_and_b32_dpp v13, v31, v35 row_newbcast:12 row_mask:0xf bank_mask:0xf
  v_and_b32_dpp v14, v31, v36 row_newbcast:12 row_mask:0xf bank_mask:0xf
  v_and_b32_dpp v15, v31, v0 row_newbcast:12 row_mask:0xf bank_mask:0xf
  s_nop 1
  v_mfma_f32_16x16x32_bf16 v[8:11], v[12:15], v[152:155], v[8:11]
  s_cmp_eq_u32 s75, 34
  s_cbranch_scc1 L_epi
L_dr34:
  v_and_b32_dpp v12, v31, v34 row_newbcast:13 row_mask:0xf bank_mask:0xf
  v_and_b32_dpp v13, v31, v35 row_newbcast:13 row_mask:0xf bank_mask:0xf
  v_and_b32_dpp v14, v31, v36 row_newbcast:13 row_mask:0xf bank_mask:0xf
  v_and_b32_dpp v15, v31, v0 row_newbcast:13 row_mask:0xf bank_mask:0xf
  s_nop 1
  v_mfma_f32_16x16x32_bf16 v[8:11], v[12:15], v[156:159], v[8:11]
  s_cmp_eq_u32 s75, 35
  s_cbranch_scc1 L_epi
L_dr35:
  v_and_b32_dpp v12, v31, v34 row_newbcast:14 row_mask:0xf bank_mask:0xf
  v_and_b32_dpp v13, v31, v35 row_newbcast:14 row_mask:0xf bank_mask:0xf
  v_and_b32_dpp v14, v31, v36 row_newbcast:14 row_mask:0xf bank_mask:0xf
  v_and_b32_dpp v15, v31, v0 row_newbcast:14 row_mask:0xf bank_mask:0xf
  s_nop 1
  v_mfma_f32_16x16x32_bf16 v[8:11], v[12:15], v[160:163], v[8:11]
  s_cmp_eq_u32 s75, 36
  s_cbranch_scc1 L_epi
L_dr36:
  v_and_b32_dpp v12, v31, v34 row_newbcast:15 row_mask:0xf bank_mask:0xf
  v_and_b32_dpp v13, v31, v35 row_newbcast:15 row_mask:0xf bank_mask:0xf
  v_and_b32_dpp v14, v31, v36 row_newbcast:15 row_mask:0xf bank_mask:0xf
  v_and_b32_dpp v15, v31, v0 row_newbcast:15 row_mask:0xf bank_mask:0xf
  s_nop 1
  v_mfma_f32_16x16x32_bf16 v[8:11], v[12:15], v[164:167], v[8:11]
  s_cmp_eq_u32 s75, 37
  s_cbranch_scc1 L_epi
L_dr37:
  v_and_b32_dpp v12, v33, v34 row_newbcast:0 row_mask:0xf bank_mask:0xf
  v_and_b32_dpp v13, v33, v35 row_newbcast:0 row_mask:0xf bank_mask:0xf
  v_and_b32_dpp v14, v33, v36 row_newbcast:0 row_mask:0xf bank_mask:0xf
  v_and_b32_dpp v15, v33, v0 row_newbcast:0 row_mask:0xf bank_mask:0xf
  s_nop 1
  v_mfma_f32_16x16x32_bf16 v[8:11], v[12:15], v[40:43], v[8:11]
  s_cmp_eq_u32 s75, 38
  s_cbranch_scc1 L_epi
L_dr38:
  v_and_b32_dpp v12, v33, v34 row_newbcast:1 row_mask:0xf bank_mask:0xf
  v_and_b32_dpp v13, v33, v35 row_newbcast:1 row_mask:0xf bank_mask:0xf
  v_and_b32_dpp v14, v33, v36 row_newbcast:1 row_mask:0xf bank_mask:0xf
  v_and_b32_dpp v15, v33, v0 row_newbcast:1 row_mask:0xf bank_mask:0xf
  s_nop 1
  v_mfma_f32_16x16x32_bf16 v[8:11], v[12:15], v[44:47], v[8:11]
  s_cmp_eq_u32 s75, 39
  s_cbranch_scc1 L_epi
L_dr39:
  v_and_b32_dpp v12, v33, v34 row_newbcast:2 row_mask:0xf bank_mask:0xf
  v_and_b32_dpp v13, v33, v35 row_newbcast:2 row_mask:0xf bank_mask:0xf
  v_and_b32_dpp v14, v33, v36 row_newbcast:2 row_mask:0xf bank_mask:0xf
  v_and_b32_dpp v15, v33, v0 row_newbcast:2 row_mask:0xf bank_mask:0xf
  s_nop 1
  v_mfma_f32_16x16x32_bf16 v[8:11], v[12:15], v[48:51], v[8:11]
  s_cmp_eq_u32 s75, 40
  s_cbranch_scc1 L_epi
L_dr40:
  v_and_b32_dpp v12, v33, v34 row_newbcast:3 row_mask:0xf bank_mask:0xf
  v_and_b32_dpp v13, v33, v35 row_newbcast:3 row_mask:0xf bank_mask:0xf
  v_and_b32_dpp v14, v33, v36 row_newbcast:3 row_mask:0xf bank_mask:0xf
  v_and_b32_dpp v15, v33, v0 row_newbcast:3 row_mask:0xf bank_mask:0xf
  s_nop 1
  v_mfma_f32_16x16x32_bf16 v[8:11], v[12:15], v[52:55], v[8:11]
  s_cmp_eq_u32 s75, 41
  s_cbranch_scc1 L_epi
L_dr41:
  v_and_b32_dpp v12, v33, v34 row_newbcast:4 row_mask:0xf bank_mask:0xf
  v_and_b32_dpp v13, v33, v35 row_newbcast:4 row_mask:0xf bank_mask:0xf
  v_and_b32_dpp v14, v33, v36 row_newbcast:4 row_mask:0xf bank_mask:0xf
  v_and_b32_dpp v15, v33, v0 row_newbcast:4 row_mask:0xf bank_mask:0xf
  s_nop 1
  v_mfma_f32_16x16x32_bf16 v[8:11], v[12:15], v[56:59], v[8:11]
  s_cmp_eq_u32 s75, 42
  s_cbranch_scc1 L_epi
L_dr42:
  v_and_b32_dpp v12, v33, v34 row_newbcast:5 row_mask:0xf bank_mask:0xf
  v_and_b32_dpp v13, v33, v35 row_newbcast:5 row_mask:0xf bank_mask:0xf
  v_and_b32_dpp v14, v33, v36 row_newbcast:5 row_mask:0xf bank_mask:0xf
  v_and_b32_dpp v15, v33, v0 row_newbcast:5 row_mask:0xf bank_mask:0xf
  s_nop 1
  v_mfma_f32_16x16x32_bf16 v[8:11], v[12:15], v[60:63], v[8:11]
  s_cmp_eq_u32 s75, 43
  s_cbranch_scc1 L_epi
L_epi:
  v_lshrrev_b32 v3, 4, v1
  v_lshl_add_u32 v21, v3, 3, v39
  v_add_u32 v21, s11, v21
  v_mov_b32 v3, 1
  s_nop 3
  v_pk_add_f32 v[8:9], v[8:9], v[4:5]
  v_pk_add_f32 v[10:11], v[10:11], v[6:7]
  s_mov_b32 exec_hi, 0
  ds_write_b128 v21, v[8:11] offset:1024
  s_cmp_eq_u32 s21, 0
  s_cbranch_scc1 L_ep2
  s_mov_b32 exec_hi, 0
  ds_write_b128 v21, v[8:11] offset:6656
  s_mov_b64 exec, 1
  ds_add_u32 v1, v3 offset:304
  s_mov_b64 exec, -1
L_ep2:
  s_mov_b64 exec, 1
  ds_add_u32 v1, v3 offset:308
L_send:
  s_endpgm
L_ks:
  s_cmp_lt_u32 s32, s57
  s_cbranch_scc1 L_kq
  s_call_b64 s[100:101], L_work
L_kq:
  v_readfirstlane_b32 s78, v22
  v_readfirstlane_b32 s79, v23
L_ks2:
  s_mov_b64 exec, 1
  ds_dec_u32 v2, v39 offset:288
  ds_read_b64 v[22:23], v2 offset:288
  s_mov_b64 exec, -1
  s_mul_i32 s68, s35, 11
  s_and_b32 s69, s79, 0xffff
  s_sub_i32 s68, s68, s78
  s_mul_i32 s69, s69, s77
  s_mul_i32 s68, s68, 160
  s_sub_u32 s35, s35, 1
  s_add_i32 s68, s68, s69
  s_add_i32 s68, s68, s34
  s_max_i32 s68, s68, 4915
  s_min_i32 s68, s68, 20480
  s_lshr_b32 s37, s68, 12
  s_lshl_b32 s58, s68, 20
L_kl:
  s_add_u32 s32, s32, 1
  s_add_u32 s33, s33, 0x20000000
  s_add_u32 s68, s33, s58
  s_addc_u32 s41, s37, 0
  s_cmp_eq_u32 s41, 3
  s_cbranch_scc1 L_wt3
  s_cmp_eq_u32 s41, 2
  s_cbranch_scc1 L_wt2
  s_cmp_eq_u32 s41, 4
  s_cbranch_scc1 L_wt4
  s_cmp_eq_u32 s41, 1
  s_cbranch_scc1 L_wt1
L_wtx:
  s_cmp_eq_u32 s32, s32
L_wt5:
  s_waitcnt vmcnt(4)
  s_setpc_b64 s[62:63]
L_wt3:
  s_waitcnt vmcnt(2)
  s_setpc_b64 s[62:63]
L_wt2:
  s_waitcnt vmcnt(1)
  s_setpc_b64 s[62:63]
L_wt4:
  s_waitcnt vmcnt(3)
  s_setpc_b64 s[62:63]
L_wt1:
  s_waitcnt vmcnt(0)
  s_setpc_b64 s[62:63]
L_kq2:
  v_readfirstlane_b32 s78, v22
  v_readfirstlane_b32 s79, v23
L_ks3:
  s_mov_b64 exec, 1
  ds_dec_u32 v2, v39 offset:288
  ds_dec_u32 v2, v39 offset:288
  ds_read_b64 v[22:23], v2 offset:288
  s_mov_b64 exec, -1
  s_mul_i32 s68, s35, 11
  s_and_b32 s69, s79, 0xffff
  s_sub_i32 s68, s68, s78
  s_mul_i32 s69, s69, s77
  s_mul_i32 s68, s68, 160
  s_sub_u32 s35, s35, 2
  s_add_i32 s68, s68, s69
  s_add_i32 s68, s68, s34
  s_max_i32 s68, s68, 4915
  s_min_i32 s68, s68, 20480
  s_lshr_b32 s37, s68, 12
  s_lshl_b32 s58, s68, 20
  s_branch L_kl
L_vl:
  s_cmp_lt_u32 s32, s36
  s_cbranch_scc1 L_kl
  s_branch L_ev
L_vq2:
  v_readfirstlane_b32 s78, v22
  v_readfirstlane_b32 s79, v23
  s_cmp_lt_u32 s32, s36
  s_cbranch_scc1 L_ks3
  s_branch L_ev
L_vs:
  v_readfirstlane_b32 s78, v22
  v_readfirstlane_b32 s79, v23
  s_cmp_eq_u32 s61, 2
  s_cbranch_scc1 L_vs1
  s_cmp_eq_u32 s61, 1
  s_cbranch_scc1 L_x3
  s_cmp_gt_u32 s41, s32
  s_cbranch_scc1 L_ks2
L_x1:
  v_dot2_f32_bf16 v12, v152, v4, 0
  v_dot2_f32_bf16 v13, v156, v4, 0
  v_dot2_f32_bf16 v14, v160, v4, 0
  v_dot2_f32_bf16 v15, v164, v4, 0
  v_dot2_f32_bf16 v12, v153, v5, v12
  v_dot2_f32_bf16 v13, v157, v5, v13
  v_dot2_f32_bf16 v14, v161, v5, v14
  v_dot2_f32_bf16 v15, v165, v5, v15
  v_dot2_f32_bf16 v12, v154, v6, v12
  v_dot2_f32_bf16 v13, v158, v6, v13
  v_dot2_f32_bf16 v14, v162, v6, v14
  v_dot2_f32_bf16 v15, v166, v6, v15
  v_dot2_f32_bf16 v12, v155, v7, v12
  v_dot2_f32_bf16 v13, v159, v7, v13
  v_dot2_f32_bf16 v14, v163, v7, v14
  v_dot2_f32_bf16 v15, v167, v7, v15
  v_add_f32_dpp v12, v12, v12 row_ror:8 row_mask:0xf bank_mask:0x3
  v_add_f32_dpp v12, v13, v13 row_ror:8 row_mask:0xf bank_mask:0xc
  v_add_f32_dpp v14, v14, v14 row_ror:8 row_mask:0xf bank_mask:0x3
  v_add_f32_dpp v14, v15, v15 row_ror:8 row_mask:0xf bank_mask:0xc
  s_nop 0
  v_add_f32_dpp v19, v12, v12 row_shl:4 row_mask:0xf bank_mask:0x5
  v_add_f32_dpp v19, v14, v14 row_shr:4 row_mask:0xf bank_mask:0xa
  s_lshl_b32 s68, s20, 3
  s_add_u32 s68, s68, s56
  v_add_f32_dpp v16, v16, v16 quad_perm:[2,3,0,1] row_mask:0xf bank_mask:0xf
  v_add_f32_dpp v17, v17, v17 quad_perm:[2,3,0,1] row_mask:0xf bank_mask:0xf
  v_add_f32_dpp v18, v18, v18 quad_perm:[2,3,0,1] row_mask:0xf bank_mask:0xf
  v_add_f32_dpp v19, v19, v19 quad_perm:[2,3,0,1] row_mask:0xf bank_mask:0xf
  v_cndmask_b32 v8, v16, v17, s[52:53]
  v_cndmask_b32 v9, v18, v19, s[52:53]
  v_mov_b32 v20, 64
  v_lshlrev_b32 v21, 3, s9
  v_add_f32_dpp v8, v8, v8 quad_perm:[1,0,3,2] row_mask:0xf bank_mask:0xf
  v_add_f32_dpp v9, v9, v9 quad_perm:[1,0,3,2] row_mask:0xf bank_mask:0xf
  v_cndmask_b32 v27, v8, v9, s[54:55]
  v_cvt_pk_bf16_f32 v27, 0, v27
  v_mul_f32 v27, 0x3db504f3, v27
  v_cvt_pk_bf16_f32 v27, 0, v27
  v_max_f32 v37, v37, v27
  v_cmp_ngt_f32 vcc, s22, v27
  v_mov_b32 v4, 0
  v_max_f32_dpp v37, v37, v37 row_ror:8 row_mask:0xf bank_mask:0xf
  s_bcnt1_i32_b64 s69, vcc
  s_add_u32 s69, s69, s20
  v_max_f32_dpp v37, v37, v37 row_ror:4 row_mask:0xf bank_mask:0xf
  s_cmp_gt_u32 s69, 32
  s_cselect_b32 s21, 1, s21
  v_max_f32_dpp v37, v37, v37 row_ror:2 row_mask:0xf bank_mask:0xf
  s_cmp_eq_u32 s21, 0
  s_cselect_b64 s[66:67], vcc, 0
  s_cselect_b32 s20, s69, s20
  v_max_f32_dpp v37, v37, v37 row_ror:1 row_mask:0xf bank_mask:0xf
  v_mbcnt_lo_u32_b32 v3, s66, 0
  v_mov_b32 v8, v37
  v_mbcnt_hi_u32_b32 v3, s67, v3
  v_lshl_add_u32 v3, v3, 3, s68
  v_permlane16_swap_b32 v8, v37
  s_mov_b64 exec, s[66:67]
  ds_write_b64 v3, v[26:27] offset:1280
  s_mov_b64 exec, -1
  ds_read_b32 v32, v39 offset:1024
  v_max_f32 v37, v37, v8
  v_mov_b32 v8, v37
  v_mov_b32 v5, 0
  s_mov_b32 s18, s32
  v_permlane32_swap_b32 v8, v37
  v_max_f32 v37, v37, v8
  v_sub_f32 v17, v25, v37
  v_sub_f32 v18, v27, v37
  v_mul_f32 v17, 0x3fb8aa3b, v17
  v_mul_f32 v18, 0x3fb8aa3b, v18
  v_exp_f32 v17, v17
  v_exp_f32 v18, v18
  v_mov_b32 v16, v37
  v_add_f32 v17, v17, v18
  s_waitcnt lgkmcnt(0)
  s_cmp_le_u32 s20, 0
  s_cbranch_scc1 L_x2
  v_add_u32_dpp v3, v32, v38 row_newbcast:8 row_mask:0xf bank_mask:0xf
  buffer_load_dwordx4 v[136:139], v3, s[48:51], 0 offen nt
  s_cmp_le_u32 s20, 4
  s_cbranch_scc1 L_x2
  v_add_u32_dpp v3, v32, v38 row_newbcast:9 row_mask:0xf bank_mask:0xf
  buffer_load_dwordx4 v[140:143], v3, s[48:51], 0 offen nt
  s_cmp_le_u32 s20, 8
  s_cbranch_scc1 L_x2
  v_add_u32_dpp v3, v32, v38 row_newbcast:10 row_mask:0xf bank_mask:0xf
  buffer_load_dwordx4 v[144:147], v3, s[48:51], 0 offen nt
  s_cmp_le_u32 s20, 12
  s_cbranch_scc1 L_x2
  v_add_u32_dpp v3, v32, v38 row_newbcast:11 row_mask:0xf bank_mask:0xf
  buffer_load_dwordx4 v[148:151], v3, s[48:51], 0 offen nt
  s_cmp_le_u32 s20, 16
  s_cbranch_scc1 L_x2
  v_add_u32_dpp v3, v32, v38 row_newbcast:12 row_mask:0xf bank_mask:0xf
  buffer_load_dwordx4 v[152:155], v3, s[48:51], 0 offen nt
  s_cmp_le_u32 s20, 20
  s_cbranch_scc1 L_x2
  v_add_u32_dpp v3, v32, v38 row_newbcast:13 row_mask:0xf bank_mask:0xf
  buffer_load_dwordx4 v[156:159], v3, s[48:51], 0 offen nt
  s_cmp_le_u32 s20, 24
  s_cbranch_scc1 L_x2
  v_add_u32_dpp v3, v32, v38 row_newbcast:14 row_mask:0xf bank_mask:0xf
  buffer_load_dwordx4 v[160:163], v3, s[48:51], 0 offen nt
  s_cmp_le_u32 s20, 28
  s_cbranch_scc1 L_x2
  v_add_u32_dpp v3, v32, v38 row_newbcast:15 row_mask:0xf bank_mask:0xf
  buffer_load_dwordx4 v[164:167], v3, s[48:51], 0 offen nt
L_x2:
  s_nop 1
  v_add_f32_dpp v17, v17, v17 row_ror:8 row_mask:0xf bank_mask:0xf
  s_nop 1
  v_add_f32_dpp v17, v17, v17 row_ror:4 row_mask:0xf bank_mask:0xf
  s_nop 1
  v_add_f32_dpp v17, v17, v17 row_ror:2 row_mask:0xf bank_mask:0xf
  s_nop 1
  v_add_f32_dpp v17, v17, v17 row_ror:1 row_mask:0xf bank_mask:0xf
  v_mov_b32 v8, v17
  s_nop 1
  v_permlane16_swap_b32 v8, v17
  v_add_f32 v17, v17, v8
  v_mov_b32 v8, v17
  s_nop 1
  v_permlane32_swap_b32 v8, v17
  v_add_f32 v17, v17, v8
  s_mov_b64 exec, 1
  ds_max_f32 v1, v37 offset:276
  ds_write_b64 v21, v[16:17] offset:512
  ds_add_u32 v1, v20 offset:272
  s_mov_b64 exec, -1
  s_mov_b32 s61, 1
  s_mov_b32 s19, 1
  s_cmp_lt_u32 s32, 5
  s_cbranch_scc1 L_ks2
L_x3:
  v_max_f32 v21, s23, v37
  s_add_u32 s38, s38, 3
  s_lshr_b32 s38, s38, 2
  v_add_f32 v21, 0xc2a60000, v21
  s_max_u32 s38, s38, s32
  s_lshl_b32 s38, s38, 2
  v_cmp_nlt_f32 vcc, v27, v21
  s_lshl_b32 s68, s38, 3
  s_add_u32 s68, s68, s56
  s_andn2_b64 s[70:71], vcc, s[66:67]
  v_mbcnt_lo_u32_b32 v3, s70, 0
  v_mbcnt_hi_u32_b32 v3, s71, v3
  s_bcnt1_i32_b64 s69, s[70:71]
  v_lshl_add_u32 v3, v3, 3, s68
  s_mov_b64 exec, s[70:71]
  ds_write_b64 v3, v[26:27]
  s_mov_b64 exec, -1
  s_or_b64 s[66:67], s[66:67], s[70:71]
  s_add_u32 s38, s38, s69
  ds_read_b64 v[28:29], v39 offset:0
  ds_read_b64 v[30:31], v39 offset:512
  ds_read_b64 v[32:33], v39 offset:1024
  v_mov_b32 v8, 0
  v_mov_b32 v9, 0
  v_mov_b32 v10, 0
  v_mov_b32 v11, 0
  v_mov_b32 v6, 0
  v_mov_b32 v7, 0
  s_lshr_b32 s36, s38, 2
  s_mov_b32 s61, 2
  s_add_u32 s68, s38, 13
  s_lshr_b32 s68, s68, 2
  s_sub_u32 s69, s68, s59
  s_mov_b32 s59, s68
  s_add_u32 s35, s35, s69
  s_add_u32 s78, s78, s69
  v_mov_b32 v3, s69
  s_mov_b64 exec, 1
  ds_add_u32 v1, v3 offset:296
  ds_add_u32 v1, v3 offset:300
  s_mov_b64 exec, -1
  s_waitcnt lgkmcnt(0)
  v_sub_f32 v29, v29, v37
  v_sub_f32 v31, v31, v37
  v_sub_f32 v33, v33, v37
  v_mul_f32 v29, 0x3fb8aa3b, v29
  v_mul_f32 v31, 0x3fb8aa3b, v31
  v_mul_f32 v33, 0x3fb8aa3b, v33
  v_exp_f32 v29, v29
  v_exp_f32 v31, v31
  v_exp_f32 v33, v33
  s_nop 0
  v_cvt_pk_bf16_f32 v29, v29, v29
  v_cvt_pk_bf16_f32 v31, v31, v31
  v_cvt_pk_bf16_f32 v33, v33, v33
  s_cmp_eq_u32 s20, 0
  s_cselect_b32 s41, 0, s41
L_vs1:
  s_cmp_eq_u32 s19, 0
  s_cbranch_scc1 L_vs1b
  s_sub_u32 s68, s32, s18
  s_cmp_le_u32 s41, s68
  s_cbranch_scc1 L_snap
  s_cmp_lt_u32 s32, s36
  s_cbranch_scc1 L_ks2
  s_waitcnt vmcnt(0)
L_snap:
  s_cmp_le_u32 s20, 0
  s_cbranch_scc1 L_snp2
  v_and_b32_dpp v12, v33, v34 row_newbcast:8 row_mask:0xf bank_mask:0xf
  v_and_b32_dpp v13, v33, v35 row_newbcast:8 row_mask:0xf bank_mask:0xf
  v_and_b32_dpp v14, v33, v36 row_newbcast:8 row_mask:0xf bank_mask:0xf
  v_and_b32_dpp v15, v33, v0 row_newbcast:8 row_mask:0xf bank_mask:0xf
  s_nop 1
  v_mfma_f32_16x16x32_bf16 v[4:7], v[12:15], v[136:139], v[4:7]
  s_cmp_le_u32 s20, 4
  s_cbranch_scc1 L_snp2
  v_and_b32_dpp v12, v33, v34 row_newbcast:9 row_mask:0xf bank_mask:0xf
  v_and_b32_dpp v13, v33, v35 row_newbcast:9 row_mask:0xf bank_mask:0xf
  v_and_b32_dpp v14, v33, v36 row_newbcast:9 row_mask:0xf bank_mask:0xf
  v_and_b32_dpp v15, v33, v0 row_newbcast:9 row_mask:0xf bank_mask:0xf
  s_nop 1
  v_mfma_f32_16x16x32_bf16 v[4:7], v[12:15], v[140:143], v[4:7]
  s_cmp_le_u32 s20, 8
  s_cbranch_scc1 L_snp2
  v_and_b32_dpp v12, v33, v34 row_newbcast:10 row_mask:0xf bank_mask:0xf
  v_and_b32_dpp v13, v33, v35 row_newbcast:10 row_mask:0xf bank_mask:0xf
  v_and_b32_dpp v14, v33, v36 row_newbcast:10 row_mask:0xf bank_mask:0xf
  v_and_b32_dpp v15, v33, v0 row_newbcast:10 row_mask:0xf bank_mask:0xf
  s_nop 1
  v_mfma_f32_16x16x32_bf16 v[4:7], v[12:15], v[144:147], v[4:7]
  s_cmp_le_u32 s20, 12
  s_cbranch_scc1 L_snp2
  v_and_b32_dpp v12, v33, v34 row_newbcast:11 row_mask:0xf bank_mask:0xf
  v_and_b32_dpp v13, v33, v35 row_newbcast:11 row_mask:0xf bank_mask:0xf
  v_and_b32_dpp v14, v33, v36 row_newbcast:11 row_mask:0xf bank_mask:0xf
  v_and_b32_dpp v15, v33, v0 row_newbcast:11 row_mask:0xf bank_mask:0xf
  s_nop 1
  v_mfma_f32_16x16x32_bf16 v[4:7], v[12:15], v[148:151], v[4:7]
  s_cmp_le_u32 s20, 16
  s_cbranch_scc1 L_snp2
  v_and_b32_dpp v12, v33, v34 row_newbcast:12 row_mask:0xf bank_mask:0xf
  v_and_b32_dpp v13, v33, v35 row_newbcast:12 row_mask:0xf bank_mask:0xf
  v_and_b32_dpp v14, v33, v36 row_newbcast:12 row_mask:0xf bank_mask:0xf
  v_and_b32_dpp v15, v33, v0 row_newbcast:12 row_mask:0xf bank_mask:0xf
  s_nop 1
  v_mfma_f32_16x16x32_bf16 v[4:7], v[12:15], v[152:155], v[4:7]
  s_cmp_le_u32 s20, 20
  s_cbranch_scc1 L_snp2
  v_and_b32_dpp v12, v33, v34 row_newbcast:13 row_mask:0xf bank_mask:0xf
  v_and_b32_dpp v13, v33, v35 row_newbcast:13 row_mask:0xf bank_mask:0xf
  v_and_b32_dpp v14, v33, v36 row_newbcast:13 row_mask:0xf bank_mask:0xf
  v_and_b32_dpp v15, v33, v0 row_newbcast:13 row_mask:0xf bank_mask:0xf
  s_nop 1
  v_mfma_f32_16x16x32_bf16 v[4:7], v[12:15], v[156:159], v[4:7]
  s_cmp_le_u32 s20, 24
  s_cbranch_scc1 L_snp2
  v_and_b32_dpp v12, v33, v34 row_newbcast:14 row_mask:0xf bank_mask:0xf
  v_and_b32_dpp v13, v33, v35 row_newbcast:14 row_mask:0xf bank_mask:0xf
  v_and_b32_dpp v14, v33, v36 row_newbcast:14 row_mask:0xf bank_mask:0xf
  v_and_b32_dpp v15, v33, v0 row_newbcast:14 row_mask:0xf bank_mask:0xf
  s_nop 1
  v_mfma_f32_16x16x32_bf16 v[4:7], v[12:15], v[160:163], v[4:7]
  s_cmp_le_u32 s20, 28
  s_cbranch_scc1 L_snp2
  v_and_b32_dpp v12, v33, v34 row_newbcast:15 row_mask:0xf bank_mask:0xf
  v_and_b32_dpp v13, v33, v35 row_newbcast:15 row_mask:0xf bank_mask:0xf
  v_and_b32_dpp v14, v33, v36 row_newbcast:15 row_mask:0xf bank_mask:0xf
  v_and_b32_dpp v15, v33, v0 row_newbcast:15 row_mask:0xf bank_mask:0xf
  s_nop 1
  v_mfma_f32_16x16x32_bf16 v[4:7], v[12:15], v[164:167], v[4:7]
L_snp2:
  v_lshrrev_b32 v3, 4, v1
  v_lshl_add_u32 v21, v3, 3, v39
  v_add_u32 v21, s11, v21
  v_mov_b32 v3, 1
  s_nop 0
  s_mov_b32 s19, 0
  s_cmp_lg_u32 s21, 0
  s_cbranch_scc1 L_vs1b
  s_mov_b32 exec_hi, 0
  ds_write_b128 v21, v[4:7] offset:6656
  s_mov_b64 exec, 1
  ds_add_u32 v1, v3 offset:304
  s_mov_b64 exec, -1
  s_branch L_vs1b
L_vq:
  v_readfirstlane_b32 s78, v22
  v_readfirstlane_b32 s79, v23
L_vs1b:
L_vs2:
  s_cmp_lt_u32 s32, s36
  s_cbranch_scc1 L_ks2
L_ev:
  s_cmp_eq_u32 s75, 0
  s_cbranch_scc1 L_hand
  s_add_u32 s68, s32, 5
  s_cmp_lt_u32 s68, s75
  s_cbranch_scc0 L_wt1
  s_add_u32 s32, s32, 1
  s_mov_b64 exec, 1
  ds_dec_u32 v2, v39 offset:288
  s_mov_b64 exec, -1
  s_branch L_wtx
L_hand:
  v_mov_b32 v3, 0
  s_mov_b32 s70, 0
L_sn_1:
  ds_read_b64 v[18:19], v3 offset:272
  s_waitcnt lgkmcnt(0)
  v_cmp_gt_u32 vcc, 0x102c0, v18
  s_cmp_eq_u64 vcc, 0
  s_cbranch_scc1 L_snd_2
  s_sleep 1
  s_add_u32 s70, s70, 1
  s_cmp_lt_u32 s70, 2097152
  s_cbranch_scc1 L_sn_1
L_snd_2:
  v_add_f32 v21, 0xc2ba0000, v19
  v_cmp_nlt_f32 vcc, v25, v21
  s_lshl_b32 s68, s38, 3
  s_add_u32 s68, s68, s56
  s_andn2_b64 s[70:71], vcc, s[64:65]
  v_mbcnt_lo_u32_b32 v3, s70, 0
  v_mbcnt_hi_u32_b32 v3, s71, v3
  s_bcnt1_i32_b64 s69, s[70:71]
  v_lshl_add_u32 v3, v3, 3, s68
  s_mov_b64 exec, s[70:71]
  ds_write_b64 v3, v[24:25]
  s_mov_b64 exec, -1
  s_or_b64 s[64:65], s[64:65], s[70:71]
  s_add_u32 s38, s38, s69
  v_cmp_nlt_f32 vcc, v27, v21
  s_lshl_b32 s68, s38, 3
  s_add_u32 s68, s68, s56
  s_andn2_b64 s[70:71], vcc, s[66:67]
  v_mbcnt_lo_u32_b32 v3, s70, 0
  v_mbcnt_hi_u32_b32 v3, s71, v3
  s_bcnt1_i32_b64 s69, s[70:71]
  v_lshl_add_u32 v3, v3, 3, s68
  s_mov_b64 exec, s[70:71]
  ds_write_b64 v3, v[26:27]
  s_mov_b64 exec, -1
  s_or_b64 s[66:67], s[66:67], s[70:71]
  s_add_u32 s38, s38, s69
  ds_read_b64 v[28:29], v39 offset:0
  ds_read_b64 v[30:31], v39 offset:512
  ds_read_b64 v[32:33], v39 offset:1024
  s_add_u32 s75, s38, 23
  s_lshr_b32 s75, s75, 2
  s_sub_u32 s36, s75, 8
  s_max_i32 s36, s36, 0
  s_add_u32 s68, s38, 3
  s_lshr_b32 s68, s68, 2
  s_sub_u32 s69, s68, s59
  s_mov_b32 s59, s68
  s_add_u32 s35, s35, s69
  s_add_u32 s78, s78, s69
  v_mov_b32 v3, s69
  s_mov_b64 exec, 1
  ds_add_u32 v1, v3 offset:296
  ds_add_u32 v1, v3 offset:300
  s_mov_b64 exec, -1
  s_waitcnt lgkmcnt(0)
  v_sub_f32 v29, v29, v37
  v_sub_f32 v31, v31, v37
  v_sub_f32 v33, v33, v37
  v_mul_f32 v29, 0x3fb8aa3b, v29
  v_mul_f32 v31, 0x3fb8aa3b, v31
  v_mul_f32 v33, 0x3fb8aa3b, v33
  v_exp_f32 v29, v29
  v_exp_f32 v31, v31
  v_exp_f32 v33, v33
  s_nop 0
  v_cvt_pk_bf16_f32 v29, v29, v29
  v_cvt_pk_bf16_f32 v31, v31, v31
  v_cvt_pk_bf16_f32 v33, v33, v33
  s_branch L_vs2
L_work:
  s_cmp_eq_u32 s39, 4
  s_cbranch_scc1 L_w3
  s_cmp_eq_u32 s39, 3
  s_cbranch_scc1 L_w2b
  s_cmp_eq_u32 s39, 5
  s_cbranch_scc1 L_w5
L_w2:
  ds_read_b128 v[4:7], v38 offset:0
  s_waitcnt lgkmcnt(0)
  v_max3_u32 v8, v4, v5, v6
  v_max_u32 v8, v8, v7
  v_cmp_eq_u32 vcc, -1, v8
  s_cmp_lg_u64 vcc, 0
  s_cbranch_scc1 L_wr
  v_dot2_f32_bf16 v8, v40, v4, 0
  v_dot2_f32_bf16 v9, v44, v4, 0
  v_dot2_f32_bf16 v10, v48, v4, 0
  v_dot2_f32_bf16 v11, v52, v4, 0
  v_dot2_f32_bf16 v12, v56, v4, 0
  v_dot2_f32_bf16 v13, v60, v4, 0
  v_dot2_f32_bf16 v14, v64, v4, 0
  v_dot2_f32_bf16 v15, v68, v4, 0
  v_dot2_f32_bf16 v8, v41, v5, v8
  v_dot2_f32_bf16 v9, v45, v5, v9
  v_dot2_f32_bf16 v10, v49, v5, v10
  v_dot2_f32_bf16 v11, v53, v5, v11
  v_dot2_f32_bf16 v12, v57, v5, v12
  v_dot2_f32_bf16 v13, v61, v5, v13
  v_dot2_f32_bf16 v14, v65, v5, v14
  v_dot2_f32_bf16 v15, v69, v5, v15
  v_dot2_f32_bf16 v8, v42, v6, v8
  v_dot2_f32_bf16 v9, v46, v6, v9
  v_dot2_f32_bf16 v10, v50, v6, v10
  v_dot2_f32_bf16 v11, v54, v6, v11
  v_dot2_f32_bf16 v12, v58, v6, v12
  v_dot2_f32_bf16 v13, v62, v6, v13
  v_dot2_f32_bf16 v14, v66, v6, v14
  v_dot2_f32_bf16 v15, v70, v6, v15
  v_dot2_f32_bf16 v8, v43, v7, v8
  v_dot2_f32_bf16 v9, v47, v7, v9
  v_dot2_f32_bf16 v10, v51, v7, v10
  v_dot2_f32_bf16 v11, v55, v7, v11
  v_dot2_f32_bf16 v12, v59, v7, v12
  v_dot2_f32_bf16 v13, v63, v7, v13
  v_dot2_f32_bf16 v14, v67, v7, v14
  v_dot2_f32_bf16 v15, v71, v7, v15
  v_add_f32_dpp v8, v8, v8 row_ror:8 row_mask:0xf bank_mask:0x3
  v_add_f32_dpp v8, v9, v9 row_ror:8 row_mask:0xf bank_mask:0xc
  v_add_f32_dpp v10, v10, v10 row_ror:8 row_mask:0xf bank_mask:0x3
  v_add_f32_dpp v10, v11, v11 row_ror:8 row_mask:0xf bank_mask:0xc
  v_add_f32_dpp v12, v12, v12 row_ror:8 row_mask:0xf bank_mask:0x3
  v_add_f32_dpp v12, v13, v13 row_ror:8 row_mask:0xf bank_mask:0xc
  v_add_f32_dpp v14, v14, v14 row_ror:8 row_mask:0xf bank_mask:0x3
  v_add_f32_dpp v14, v15, v15 row_ror:8 row_mask:0xf bank_mask:0xc
  v_add_f32_dpp v16, v8, v8 row_shl:4 row_mask:0xf bank_mask:0x5
  v_add_f32_dpp v16, v10, v10 row_shr:4 row_mask:0xf bank_mask:0xa
  v_add_f32_dpp v17, v12, v12 row_shl:4 row_mask:0xf bank_mask:0x5
  v_add_f32_dpp v17, v14, v14 row_shr:4 row_mask:0xf bank_mask:0xa
  s_mov_b32 s39, 3
  s_mov_b32 s57, 17
L_wr:
  s_setpc_b64 s[100:101]
L_w2b:
  s_add_u32 s68, s41, 16
  s_cmp_lt_u32 s32, s68
  s_cbranch_scc1 L_wr
  v_dot2_f32_bf16 v8, v72, v4, 0
  v_dot2_f32_bf16 v9, v76, v4, 0
  v_dot2_f32_bf16 v10, v80, v4, 0
  v_dot2_f32_bf16 v11, v84, v4, 0
  v_dot2_f32_bf16 v12, v88, v4, 0
  v_dot2_f32_bf16 v13, v92, v4, 0
  v_dot2_f32_bf16 v14, v96, v4, 0
  v_dot2_f32_bf16 v15, v100, v4, 0
  v_dot2_f32_bf16 v8, v73, v5, v8
  v_dot2_f32_bf16 v9, v77, v5, v9
  v_dot2_f32_bf16 v10, v81, v5, v10
  v_dot2_f32_bf16 v11, v85, v5, v11
  v_dot2_f32_bf16 v12, v89, v5, v12
  v_dot2_f32_bf16 v13, v93, v5, v13
  v_dot2_f32_bf16 v14, v97, v5, v14
  v_dot2_f32_bf16 v15, v101, v5, v15
  v_dot2_f32_bf16 v8, v74, v6, v8
  v_dot2_f32_bf16 v9, v78, v6, v9
  v_dot2_f32_bf16 v10, v82, v6, v10
  v_dot2_f32_bf16 v11, v86, v6, v11
  v_dot2_f32_bf16 v12, v90, v6, v12
  v_dot2_f32_bf16 v13, v94, v6, v13
  v_dot2_f32_bf16 v14, v98, v6, v14
  v_dot2_f32_bf16 v15, v102, v6, v15
  v_dot2_f32_bf16 v8, v75, v7, v8
  v_dot2_f32_bf16 v9, v79, v7, v9
  v_dot2_f32_bf16 v10, v83, v7, v10
  v_dot2_f32_bf16 v11, v87, v7, v11
  v_dot2_f32_bf16 v12, v91, v7, v12
  v_dot2_f32_bf16 v13, v95, v7, v13
  v_dot2_f32_bf16 v14, v99, v7, v14
  v_dot2_f32_bf16 v15, v103, v7, v15
  v_add_f32_dpp v8, v8, v8 row_ror:8 row_mask:0xf bank_mask:0x3
  v_add_f32_dpp v8, v9, v9 row_ror:8 row_mask:0xf bank_mask:0xc
  v_add_f32_dpp v10, v10, v10 row_ror:8 row_mask:0xf bank_mask:0x3
  v_add_f32_dpp v10, v11, v11 row_ror:8 row_mask:0xf bank_mask:0xc
  v_add_f32_dpp v12, v12, v12 row_ror:8 row_mask:0xf bank_mask:0x3
  v_add_f32_dpp v12, v13, v13 row_ror:8 row_mask:0xf bank_mask:0xc
  v_add_f32_dpp v14, v14, v14 row_ror:8 row_mask:0xf bank_mask:0x3
  v_add_f32_dpp v14, v15, v15 row_ror:8 row_mask:0xf bank_mask:0xc
  v_add_f32_dpp v18, v8, v8 row_shl:4 row_mask:0xf bank_mask:0x5
  v_add_f32_dpp v18, v10, v10 row_shr:4 row_mask:0xf bank_mask:0xa
  v_add_f32_dpp v19, v12, v12 row_shl:4 row_mask:0xf bank_mask:0x5
  v_add_f32_dpp v19, v14, v14 row_shr:4 row_mask:0xf bank_mask:0xa
  v_mov_b32 v3, 0
  v_mov_b32 v20, 64
  v_add_f32_dpp v16, v16, v16 quad_perm:[2,3,0,1] row_mask:0xf bank_mask:0xf
  v_add_f32_dpp v17, v17, v17 quad_perm:[2,3,0,1] row_mask:0xf bank_mask:0xf
  v_add_f32_dpp v18, v18, v18 quad_perm:[2,3,0,1] row_mask:0xf bank_mask:0xf
  v_add_f32_dpp v19, v19, v19 quad_perm:[2,3,0,1] row_mask:0xf bank_mask:0xf
  v_cndmask_b32 v8, v16, v17, s[52:53]
  v_cndmask_b32 v9, v18, v19, s[52:53]
  s_nop 0
  v_lshlrev_b32 v21, 3, s9
  v_add_f32_dpp v8, v8, v8 quad_perm:[1,0,3,2] row_mask:0xf bank_mask:0xf
  v_add_f32_dpp v9, v9, v9 quad_perm:[1,0,3,2] row_mask:0xf bank_mask:0xf
  v_cndmask_b32 v25, v8, v9, s[54:55]
  v_cvt_pk_bf16_f32 v25, 0, v25
  v_mul_f32 v25, 0x3db504f3, v25
  v_cvt_pk_bf16_f32 v25, 0, v25
  v_cmp_gt_u32 vcc, s46, v24
  v_mov_b32 v37, 0xff800000
  s_nop 0
  v_cndmask_b32 v25, v37, v25, vcc
  v_mov_b32 v37, v25
  s_nop 1
  v_max_f32_dpp v37, v37, v37 row_ror:8 row_mask:0xf bank_mask:0xf
  s_nop 1
  v_max_f32_dpp v37, v37, v37 row_ror:4 row_mask:0xf bank_mask:0xf
  s_nop 1
  v_max_f32_dpp v37, v37, v37 row_ror:2 row_mask:0xf bank_mask:0xf
  s_nop 1
  v_max_f32_dpp v37, v37, v37 row_ror:1 row_mask:0xf bank_mask:0xf
  v_mov_b32 v8, v37
  s_nop 1
  v_permlane16_swap_b32 v8, v37
  v_max_f32 v37, v37, v8
  v_mov_b32 v8, v37
  s_nop 1
  v_permlane32_swap_b32 v8, v37
  v_max_f32 v37, v37, v8
  s_mov_b64 exec, 1
  ds_max_f32 v3, v37 offset:284
  ds_add_u32 v3, v20 offset:280
  s_mov_b64 exec, -1
  s_mov_b32 s39, 4
  s_mov_b32 s19, 0
  s_setpc_b64 s[100:101]
L_w5:
  s_add_u32 s68, s41, 24
  s_cmp_lt_u32 s32, s68
  s_cbranch_scc1 L_wr
  v_dot2_f32_bf16 v8, v104, v4, 0
  v_dot2_f32_bf16 v9, v108, v4, 0
  v_dot2_f32_bf16 v10, v112, v4, 0
  v_dot2_f32_bf16 v11, v116, v4, 0
  v_dot2_f32_bf16 v12, v120, v4, 0
  v_dot2_f32_bf16 v13, v124, v4, 0
  v_dot2_f32_bf16 v14, v128, v4, 0
  v_dot2_f32_bf16 v15, v132, v4, 0
  v_dot2_f32_bf16 v8, v105, v5, v8
  v_dot2_f32_bf16 v9, v109, v5, v9
  v_dot2_f32_bf16 v10, v113, v5, v10
  v_dot2_f32_bf16 v11, v117, v5, v11
  v_dot2_f32_bf16 v12, v121, v5, v12
  v_dot2_f32_bf16 v13, v125, v5, v13
  v_dot2_f32_bf16 v14, v129, v5, v14
  v_dot2_f32_bf16 v15, v133, v5, v15
  v_dot2_f32_bf16 v8, v106, v6, v8
  v_dot2_f32_bf16 v9, v110, v6, v9
  v_dot2_f32_bf16 v10, v114, v6, v10
  v_dot2_f32_bf16 v11, v118, v6, v11
  v_dot2_f32_bf16 v12, v122, v6, v12
  v_dot2_f32_bf16 v13, v126, v6, v13
  v_dot2_f32_bf16 v14, v130, v6, v14
  v_dot2_f32_bf16 v15, v134, v6, v15
  v_dot2_f32_bf16 v8, v107, v7, v8
  v_dot2_f32_bf16 v9, v111, v7, v9
  v_dot2_f32_bf16 v10, v115, v7, v10
  v_dot2_f32_bf16 v11, v119, v7, v11
  v_dot2_f32_bf16 v12, v123, v7, v12
  v_dot2_f32_bf16 v13, v127, v7, v13
  v_dot2_f32_bf16 v14, v131, v7, v14
  v_dot2_f32_bf16 v15, v135, v7, v15
  v_add_f32_dpp v8, v8, v8 row_ror:8 row_mask:0xf bank_mask:0x3
  v_add_f32_dpp v8, v9, v9 row_ror:8 row_mask:0xf bank_mask:0xc
  v_add_f32_dpp v10, v10, v10 row_ror:8 row_mask:0xf bank_mask:0x3
  v_add_f32_dpp v10, v11, v11 row_ror:8 row_mask:0xf bank_mask:0xc
  v_add_f32_dpp v12, v12, v12 row_ror:8 row_mask:0xf bank_mask:0x3
  v_add_f32_dpp v12, v13, v13 row_ror:8 row_mask:0xf bank_mask:0xc
  v_add_f32_dpp v14, v14, v14 row_ror:8 row_mask:0xf bank_mask:0x3
  v_add_f32_dpp v14, v15, v15 row_ror:8 row_mask:0xf bank_mask:0xc
  v_add_f32_dpp v16, v8, v8 row_shl:4 row_mask:0xf bank_mask:0x5
  v_add_f32_dpp v16, v10, v10 row_shr:4 row_mask:0xf bank_mask:0xa
  v_add_f32_dpp v17, v12, v12 row_shl:4 row_mask:0xf bank_mask:0x5
  v_add_f32_dpp v17, v14, v14 row_shr:4 row_mask:0xf bank_mask:0xa
  s_mov_b32 s39, 6
  s_mov_b32 s57, 99
  s_setpc_b64 s[100:101]
L_w3:
  v_mov_b32 v3, 0
  ds_read_b64 v[18:19], v3 offset:280
  s_waitcnt lgkmcnt(0)
  v_cmp_gt_u32 vcc, 0x102c0, v18
  s_cmp_lg_u64 vcc, 0
  s_cbranch_scc1 L_wr
  ds_read_b64 v[20:21], v3 offset:320
  s_waitcnt lgkmcnt(0)
  v_add_f32 v21, 0xc1c00000, v21
  v_cmp_nlt_f32 vcc, v25, v21
  v_readfirstlane_b32 s22, v21
  v_readfirstlane_b32 s23, v20
  s_mov_b32 s20, 0
  s_bcnt1_i32_b64 s68, vcc
  s_cmp_gt_u32 s68, 32
  s_cselect_b32 s21, 1, 0
  s_cbranch_scc1 L_w4
  s_mov_b32 s38, 160
  v_cmp_nlt_f32 vcc, v25, v21
  s_lshl_b32 s68, s38, 3
  s_add_u32 s68, s68, s56
  s_andn2_b64 s[70:71], vcc, s[64:65]
  v_mbcnt_lo_u32_b32 v3, s70, 0
  v_mbcnt_hi_u32_b32 v3, s71, v3
  s_bcnt1_i32_b64 s69, s[70:71]
  v_lshl_add_u32 v3, v3, 3, s68
  s_mov_b64 exec, s[70:71]
  ds_write_b64 v3, v[24:25]
  s_mov_b64 exec, -1
  s_or_b64 s[64:65], s[64:65], s[70:71]
  s_add_u32 s38, s38, s69
  s_mov_b32 s20, s69
  s_mov_b32 s38, 0
L_w4:
  v_add_f32 v21, 0xc2a60000, v20
  v_cmp_nlt_f32 vcc, v25, v21
  s_lshl_b32 s68, s38, 3
  s_add_u32 s68, s68, s56
  s_andn2_b64 s[70:71], vcc, s[64:65]
  v_mbcnt_lo_u32_b32 v3, s70, 0
  v_mbcnt_hi_u32_b32 v3, s71, v3
  s_bcnt1_i32_b64 s69, s[70:71]
  v_lshl_add_u32 v3, v3, 3, s68
  s_mov_b64 exec, s[70:71]
  ds_write_b64 v3, v[24:25]
  s_mov_b64 exec, -1
  s_or_b64 s[64:65], s[64:65], s[70:71]
  s_add_u32 s38, s38, s69
  s_add_u32 s68, s38, 6
  s_lshr_b32 s68, s68, 1
  s_sub_u32 s69, s68, s59
  s_mov_b32 s59, s68
  v_mov_b32 v3, s69
  s_mov_b64 exec, 1
  ds_add_u32 v1, v3 offset:296
  ds_add_u32 v1, v3 offset:300
  s_mov_b64 exec, -1
  s_sub_i32 s68, s59, 20
  s_max_i32 s68, s68, -4
  s_mul_i32 s68, s68, 245
  s_add_i32 s34, s34, s68
  s_mov_b32 s39, 5
  s_mov_b32 s57, 25
  ds_read_b64 v[28:29], v39 offset:0
  s_waitcnt lgkmcnt(0)
  s_setpc_b64 s[100:101]
L_pub:
  s_getpc_b64 s[56:57]
L_pct:
  s_lshr_b32 s3, s2, 3
  s_lshl_b32 s3, s3, 2
  s_add_u32 s3, s3, L_touch-L_pct
  s_load_dword s14, s[56:57], s3
  s_waitcnt lgkmcnt(0)
  s_bfe_u32 s48, s14, 0x30000
  s_lshl_b32 s48, s48, 6
  v_add_u32 v2, s48, v1
  s_bfe_u32 s48, s14, 0x30003
  s_bitcmp1_b32 s14, 7
  s_cbranch_scc1 L_te_4
  s_bitcmp1_b32 s14, 6
  s_cbranch_scc1 L_tq_3
  s_lshl1_add_u32 s48, s8, s48
  s_lshl_b32 s48, s48, 7
  v_mul_u32_u24 v2, 6144, v2
  v_add_u32 v2, s48, v2
  global_load_dword v167, v2, s[36:37]
  s_branch L_te_4
L_tq_3:
  s_lshl3_add_u32 s48, s8, s48
  s_lshl_b32 s48, s48, 7
  v_lshl_add_u32 v2, v2, 13, s48
  global_load_dword v167, v2, s[22:23]
L_te_4:
  s_bfe_u32 s48, s14, 0x30008
  s_lshl_b32 s48, s48, 6
  v_add_u32 v2, s48, v1
  s_bfe_u32 s48, s14, 0x3000b
  s_bitcmp1_b32 s14, 15
  s_cbranch_scc1 L_te_6
  s_bitcmp1_b32 s14, 14
  s_cbranch_scc1 L_tq_5
  s_lshl1_add_u32 s48, s8, s48
  s_lshl_b32 s48, s48, 7
  v_mul_u32_u24 v2, 6144, v2
  v_add_u32 v2, s48, v2
  global_load_dword v167, v2, s[36:37]
  s_branch L_te_6
L_tq_5:
  s_lshl3_add_u32 s48, s8, s48
  s_lshl_b32 s48, s48, 7
  v_lshl_add_u32 v2, v2, 13, s48
  global_load_dword v167, v2, s[22:23]
L_te_6:
  v_mov_b32 v38, 0
  v_mov_b32 v4, -1
  v_mov_b32 v8, 0xff800000
  v_mov_b32 v9, 0
  v_lshlrev_b32 v2, 3, v1
  ds_write_b64 v2, v[8:9] offset:448
  v_mov_b32 v5, 0
  v_mov_b32 v6, 0
  v_mov_b32 v7, 0
  v_lshlrev_b32 v2, 2, v1
  ds_write_b32 v2, v4 offset:0
  ds_write_b128 v38, v[4:7] offset:256
  v_mov_b32 v10, 0
  v_mov_b32 v11, v8
  v_mov_b32 v12, 0
  v_mov_b32 v13, v8
  ds_write_b128 v38, v[10:13] offset:272
  v_mov_b32 v10, 1332
  v_mov_b32 v11, 0
  v_mov_b32 v12, 1024
  v_mov_b32 v13, 0
  ds_write_b128 v38, v[10:13] offset:288
  v_mov_b32 v4, 0
  ds_write_b128 v38, v[4:7] offset:304
  s_getreg_b32 s76, hwreg(HW_REG_XCC_ID, 0, 4)
  s_waitcnt lgkmcnt(0)
  s_load_dword s74, s[42:43], 0
  s_barrier
  s_waitcnt lgkmcnt(0)
  s_mul_i32 s74, s74, 0x9e3779b1
  s_add_u32 s74, s74, 0x7f4a7c15
  s_add_u32 s76, s76, s74
  s_lshl2_add_u32 s64, s6, s7
  s_lshl_b32 s64, s64, 7
  s_add_u32 s64, s64, 65536
  v_mov_b32 v18, s64
  v_add_u32 v19, 32768, v18
  v_mov_b32 v17, 0x10000
  s_lshl2_add_u32 s49, s6, s7
  s_lshl_b32 s49, s49, 9
  s_add_u32 s49, s49, 131072
  v_and_b32 v10, 3, v1
  v_lshl_add_u32 v10, v10, 7, s49
  v_bfe_u32 v11, v1, 2, 1
  v_mul_u32_u24 v11, 393216, v11
  v_add_u32 v10, v10, v11
  s_mov_b64 exec, 0xff
  global_load_dword v166, v10, s[42:43] sc1
  s_mov_b64 exec, 1
  global_load_dword v166, v18, s[42:43] sc1
  global_load_dword v166, v19, s[42:43] sc1
  s_mov_b64 exec, -1
  s_mov_b32 s70, 0
L_qw_7:
  ds_read_b32 v8, v38 offset:288
  s_waitcnt lgkmcnt(0)
  v_cmp_lt_u32 vcc, 1233, v8
  s_cmp_eq_u64 vcc, 0
  s_cbranch_scc1 L_qw_7d
  s_sleep 4
  s_add_u32 s70, s70, 1
  s_cmp_lt_u32 s70, 2097152
  s_cbranch_scc1 L_qw_7
L_qw_7d:
  s_lshl_b32 s3, s6, 9
  s_mov_b64 exec, 1
  s_mov_b32 s70, 0
L_qp0:
  s_load_dwordx16 s[8:23], s[42:43], s3 offset:32768 glc
  s_load_dwordx16 s[24:39], s[42:43], s3 offset:32832 glc
  s_load_dwordx16 s[44:59], s[42:43], s3 offset:32896 glc
  s_load_dwordx16 s[84:99], s[42:43], s3 offset:32960 glc
  s_mov_b32 s62, -1
  s_mov_b32 s63, 0
  s_waitcnt lgkmcnt(0)
  s_and_b32 s62, s62, s9
  s_or_b32 s63, s63, s9
  s_and_b32 s62, s62, s11
  s_or_b32 s63, s63, s11
  s_and_b32 s62, s62, s13
  s_or_b32 s63, s63, s13
  s_and_b32 s62, s62, s15
  s_or_b32 s63, s63, s15
  s_and_b32 s62, s62, s17
  s_or_b32 s63, s63, s17
  s_and_b32 s62, s62, s19
  s_or_b32 s63, s63, s19
  s_and_b32 s62, s62, s21
  s_or_b32 s63, s63, s21
  s_and_b32 s62, s62, s23
  s_or_b32 s63, s63, s23
  s_and_b32 s62, s62, s25
  s_or_b32 s63, s63, s25
  s_and_b32 s62, s62, s27
  s_or_b32 s63, s63, s27
  s_and_b32 s62, s62, s29
  s_or_b32 s63, s63, s29
  s_and_b32 s62, s62, s31
  s_or_b32 s63, s63, s31
  s_and_b32 s62, s62, s33
  s_or_b32 s63, s63, s33
  s_and_b32 s62, s62, s35
  s_or_b32 s63, s63, s35
  s_and_b32 s62, s62, s37
  s_or_b32 s63, s63, s37
  s_and_b32 s62, s62, s39
  s_or_b32 s63, s63, s39
  s_and_b32 s62, s62, s45
  s_or_b32 s63, s63, s45
  s_and_b32 s62, s62, s47
  s_or_b32 s63, s63, s47
  s_and_b32 s62, s62, s49
  s_or_b32 s63, s63, s49
  s_and_b32 s62, s62, s51
  s_or_b32 s63, s63, s51
  s_and_b32 s62, s62, s53
  s_or_b32 s63, s63, s53
  s_and_b32 s62, s62, s55
  s_or_b32 s63, s63, s55
  s_and_b32 s62, s62, s57
  s_or_b32 s63, s63, s57
  s_and_b32 s62, s62, s59
  s_or_b32 s63, s63, s59
  s_and_b32 s62, s62, s85
  s_or_b32 s63, s63, s85
  s_and_b32 s62, s62, s87
  s_or_b32 s63, s63, s87
  s_and_b32 s62, s62, s89
  s_or_b32 s63, s63, s89
  s_and_b32 s62, s62, s91
  s_or_b32 s63, s63, s91
  s_and_b32 s62, s62, s93
  s_or_b32 s63, s63, s93
  s_and_b32 s62, s62, s95
  s_or_b32 s63, s63, s95
  s_and_b32 s62, s62, s97
  s_or_b32 s63, s63, s97
  s_and_b32 s62, s62, s99
  s_or_b32 s63, s63, s99
  s_xor_b32 s62, s62, s74
  s_xor_b32 s63, s63, s74
  s_or_b32 s62, s62, s63
  s_cbranch_scc0 L_qp0d
  s_sleep 2
  s_add_u32 s70, s70, 1
  s_cmp_lt_u32 s70, 262144
  s_cbranch_scc1 L_qp0
L_qp0d:
  v_mov_b32 v40, s8
  v_mov_b32 v41, s10
  v_mov_b32 v42, s12
  v_mov_b32 v43, s14
  v_mov_b32 v44, s16
  v_mov_b32 v45, s18
  v_mov_b32 v46, s20
  v_mov_b32 v47, s22
  v_mov_b32 v48, s24
  v_mov_b32 v49, s26
  v_mov_b32 v50, s28
  v_mov_b32 v51, s30
  v_mov_b32 v52, s32
  v_mov_b32 v53, s34
  v_mov_b32 v54, s36
  v_mov_b32 v55, s38
  v_mov_b32 v56, s44
  v_mov_b32 v57, s46
  v_mov_b32 v58, s48
  v_mov_b32 v59, s50
  v_mov_b32 v60, s52
  v_mov_b32 v61, s54
  v_mov_b32 v62, s56
  v_mov_b32 v63, s58
  v_mov_b32 v64, s84
  v_mov_b32 v65, s86
  v_mov_b32 v66, s88
  v_mov_b32 v67, s90
  v_mov_b32 v68, s92
  v_mov_b32 v69, s94
  v_mov_b32 v70, s96
  v_mov_b32 v71, s98
  s_mov_b32 s70, 0
L_qp1:
  s_load_dwordx16 s[8:23], s[42:43], s3 offset:33024 glc
  s_load_dwordx16 s[24:39], s[42:43], s3 offset:33088 glc
  s_load_dwordx16 s[44:59], s[42:43], s3 offset:33152 glc
  s_load_dwordx16 s[84:99], s[42:43], s3 offset:33216 glc
  s_mov_b32 s62, -1
  s_mov_b32 s63, 0
  s_waitcnt lgkmcnt(0)
  s_and_b32 s62, s62, s9
  s_or_b32 s63, s63, s9
  s_and_b32 s62, s62, s11
  s_or_b32 s63, s63, s11
  s_and_b32 s62, s62, s13
  s_or_b32 s63, s63, s13
  s_and_b32 s62, s62, s15
  s_or_b32 s63, s63, s15
  s_and_b32 s62, s62, s17
  s_or_b32 s63, s63, s17
  s_and_b32 s62, s62, s19
  s_or_b32 s63, s63, s19
  s_and_b32 s62, s62, s21
  s_or_b32 s63, s63, s21
  s_and_b32 s62, s62, s23
  s_or_b32 s63, s63, s23
  s_and_b32 s62, s62, s25
  s_or_b32 s63, s63, s25
  s_and_b32 s62, s62, s27
  s_or_b32 s63, s63, s27
  s_and_b32 s62, s62, s29
  s_or_b32 s63, s63, s29
  s_and_b32 s62, s62, s31
  s_or_b32 s63, s63, s31
  s_and_b32 s62, s62, s33
  s_or_b32 s63, s63, s33
  s_and_b32 s62, s62, s35
  s_or_b32 s63, s63, s35
  s_and_b32 s62, s62, s37
  s_or_b32 s63, s63, s37
  s_and_b32 s62, s62, s39
  s_or_b32 s63, s63, s39
  s_and_b32 s62, s62, s45
  s_or_b32 s63, s63, s45
  s_and_b32 s62, s62, s47
  s_or_b32 s63, s63, s47
  s_and_b32 s62, s62, s49
  s_or_b32 s63, s63, s49
  s_and_b32 s62, s62, s51
  s_or_b32 s63, s63, s51
  s_and_b32 s62, s62, s53
  s_or_b32 s63, s63, s53
  s_and_b32 s62, s62, s55
  s_or_b32 s63, s63, s55
  s_and_b32 s62, s62, s57
  s_or_b32 s63, s63, s57
  s_and_b32 s62, s62, s59
  s_or_b32 s63, s63, s59
  s_and_b32 s62, s62, s85
  s_or_b32 s63, s63, s85
  s_and_b32 s62, s62, s87
  s_or_b32 s63, s63, s87
  s_and_b32 s62, s62, s89
  s_or_b32 s63, s63, s89
  s_and_b32 s62, s62, s91
  s_or_b32 s63, s63, s91
  s_and_b32 s62, s62, s93
  s_or_b32 s63, s63, s93
  s_and_b32 s62, s62, s95
  s_or_b32 s63, s63, s95
  s_and_b32 s62, s62, s97
  s_or_b32 s63, s63, s97
  s_and_b32 s62, s62, s99
  s_or_b32 s63, s63, s99
  s_xor_b32 s62, s62, s74
  s_xor_b32 s63, s63, s74
  s_or_b32 s62, s62, s63
  s_cbranch_scc0 L_qp1d
  s_sleep 2
  s_add_u32 s70, s70, 1
  s_cmp_lt_u32 s70, 262144
  s_cbranch_scc1 L_qp1
L_qp1d:
  v_mov_b32 v72, s8
  v_mov_b32 v73, s10
  v_mov_b32 v74, s12
  v_mov_b32 v75, s14
  v_mov_b32 v76, s16
  v_mov_b32 v77, s18
  v_mov_b32 v78, s20
  v_mov_b32 v79, s22
  v_mov_b32 v80, s24
  v_mov_b32 v81, s26
  v_mov_b32 v82, s28
  v_mov_b32 v83, s30
  v_mov_b32 v84, s32
  v_mov_b32 v85, s34
  v_mov_b32 v86, s36
  v_mov_b32 v87, s38
  v_mov_b32 v88, s44
  v_mov_b32 v89, s46
  v_mov_b32 v90, s48
  v_mov_b32 v91, s50
  v_mov_b32 v92, s52
  v_mov_b32 v93, s54
  v_mov_b32 v94, s56
  v_mov_b32 v95, s58
  v_mov_b32 v96, s84
  v_mov_b32 v97, s86
  v_mov_b32 v98, s88
  v_mov_b32 v99, s90
  v_mov_b32 v100, s92
  v_mov_b32 v101, s94
  v_mov_b32 v102, s96
  v_mov_b32 v103, s98
  ds_write_b128 v38, v[40:43] offset:0
  ds_write_b128 v38, v[44:47] offset:16
  ds_write_b128 v38, v[48:51] offset:32
  ds_write_b128 v38, v[52:55] offset:48
  ds_write_b128 v38, v[56:59] offset:64
  ds_write_b128 v38, v[60:63] offset:80
  ds_write_b128 v38, v[64:67] offset:96
  ds_write_b128 v38, v[68:71] offset:112
  ds_write_b128 v38, v[72:75] offset:128
  ds_write_b128 v38, v[76:79] offset:144
  ds_write_b128 v38, v[80:83] offset:160
  ds_write_b128 v38, v[84:87] offset:176
  ds_write_b128 v38, v[88:91] offset:192
  ds_write_b128 v38, v[92:95] offset:208
  ds_write_b128 v38, v[96:99] offset:224
  ds_write_b128 v38, v[100:103] offset:240
  s_mov_b64 exec, -1
  s_and_b32 s8, s2, 7
  s_mov_b32 s13, 0
  s_add_u32 s52, s7, 1
  s_cmp_eq_u32 s52, 3
  s_cselect_b32 s52, 0, s52
  s_add_u32 s53, s52, s7
  s_sub_u32 s53, 3, s53
  s_lshl2_add_u32 s54, s6, s52
  s_lshl_b32 s54, s54, 7
  s_lshl2_add_u32 s55, s6, s53
  s_lshl_b32 s55, s55, 7
  s_mov_b32 s70, 0
L_sn_8:
  ds_read_b64 v[8:9], v38 offset:280
  s_waitcnt lgkmcnt(0)
  v_cmp_gt_u32 vcc, 0x2c0, v8
  s_cmp_eq_u64 vcc, 0
  s_cbranch_scc1 L_snd_9
  s_sleep 2
  s_add_u32 s70, s70, 1
  s_cmp_lt_u32 s70, 2097152
  s_cbranch_scc1 L_sn_8
L_snd_9:
  s_load_dwordx2 s[20:21], s[42:43], s54 offset:65536 glc
  s_load_dwordx2 s[24:25], s[42:43], s55 offset:65536 glc
  v_mov_b32 v8, v9
  v_mov_b32 v9, s74
  s_mov_b64 exec, 1
  global_store_dwordx2 v18, v[8:9], s[42:43] sc1
  s_mov_b32 s70, 0
  s_branch L_s3ec
L_s3e:
  s_load_dwordx2 s[20:21], s[42:43], s54 offset:65536 glc
  s_load_dwordx2 s[24:25], s[42:43], s55 offset:65536 glc
L_s3ec:
  s_waitcnt lgkmcnt(0)
  s_xor_b32 s68, s21, s74
  s_xor_b32 s69, s25, s74
  s_or_b32 s68, s68, s69
  s_cbranch_scc0 L_s3ed
  s_sleep 2
  s_add_u32 s70, s70, 1
  s_cmp_lt_u32 s70, 262144
  s_cbranch_scc1 L_s3e
L_s3ed:
  v_mov_b32 v12, s20
  v_max3_f32 v10, v8, v12, s24
  v_min3_f32 v11, v8, v12, s24
  ds_write_b64 v38, v[10:11] offset:320
  ds_add_u32 v38, v17 offset:280
  s_mov_b64 exec, -1
  s_lshl_b32 s64, s8, 7
  s_load_dwordx8 s[20:27], s[42:43], s64 offset:1024 glc
  s_waitcnt lgkmcnt(0)
  s_xor_b32 s68, s20, s76
  s_xor_b32 s69, s21, s76
  s_or_b32 s68, s68, s69
  s_xor_b32 s69, s22, s76
  s_or_b32 s68, s68, s69
  s_xor_b32 s69, s23, s76
  s_or_b32 s68, s68, s69
  s_xor_b32 s69, s24, s76
  s_or_b32 s68, s68, s69
  s_xor_b32 s69, s25, s76
  s_or_b32 s68, s68, s69
  s_xor_b32 s69, s26, s76
  s_or_b32 s68, s68, s69
  s_xor_b32 s69, s27, s76
  s_or_b32 s68, s68, s69
  s_cselect_b32 s75, 0, 1
  v_lshlrev_b32 v20, 3, s7
  v_lshlrev_b32 v21, 3, s52
  v_lshlrev_b32 v22, 3, s53
  s_mov_b32 s70, 0
L_sn_10:
  ds_read_b32 v8, v38 offset:272
  s_waitcnt lgkmcnt(0)
  v_cmp_gt_u32 vcc, 0x2c0, v8
  s_cmp_eq_u64 vcc, 0
  s_cbranch_scc1 L_snd_11
  s_sleep 1
  s_add_u32 s70, s70, 1
  s_cmp_lt_u32 s70, 2097152
  s_cbranch_scc1 L_sn_10
L_snd_11:
  v_and_b32 v9, 15, v1
  v_lshlrev_b32 v9, 3, v9
  ds_read_b64 v[10:11], v9 offset:512
  s_waitcnt lgkmcnt(0)
  v_mov_b32 v16, v10
  v_max_f32_dpp v8, v10, v10 quad_perm:[1,0,3,2] row_mask:0xf bank_mask:0xf
  s_nop 1
  v_max_f32_dpp v8, v8, v8 quad_perm:[2,3,0,1] row_mask:0xf bank_mask:0xf
  s_nop 1
  v_max_f32_dpp v8, v8, v8 row_half_mirror row_mask:0xf bank_mask:0xf
  s_nop 1
  v_max_f32_dpp v8, v8, v8 row_mirror row_mask:0xf bank_mask:0xf
  v_sub_f32 v9, v10, v8
  v_mul_f32 v9, 0x3fb8aa3b, v9
  v_exp_f32 v9, v9
  s_nop 0
  v_mul_f32 v10, v9, v11
  s_nop 1
  v_add_f32_dpp v10, v10, v10 quad_perm:[1,0,3,2] row_mask:0xf bank_mask:0xf
  s_nop 1
  v_add_f32_dpp v10, v10, v10 quad_perm:[2,3,0,1] row_mask:0xf bank_mask:0xf
  s_nop 1
  v_add_f32_dpp v10, v10, v10 row_half_mirror row_mask:0xf bank_mask:0xf
  s_nop 1
  v_add_f32_dpp v10, v10, v10 row_mirror row_mask:0xf bank_mask:0xf
  s_load_dwordx4 s[20:23], s[42:43], s54 offset:98304 glc
  s_load_dwordx4 s[24:27], s[42:43], s55 offset:98304 glc
  v_mov_b32 v9, s74
  v_mov_b32 v11, s74
  s_mov_b64 exec, 1
  global_store_dwordx4 v19, v[8:11], s[42:43] sc1
  ds_write_b32 v20, v8 offset:448
  ds_write_b32 v20, v10 offset:452
  s_mov_b32 s70, 0
  s_branch L_s3pc
L_s3p:
  s_load_dwordx4 s[20:23], s[42:43], s54 offset:98304 glc
  s_load_dwordx4 s[24:27], s[42:43], s55 offset:98304 glc
L_s3pc:
  s_waitcnt lgkmcnt(0)
  s_xor_b32 s68, s21, s74
  s_xor_b32 s69, s23, s74
  s_or_b32 s68, s68, s69
  s_xor_b32 s69, s25, s74
  s_or_b32 s68, s68, s69
  s_xor_b32 s69, s27, s74
  s_or_b32 s68, s68, s69
  s_cbranch_scc0 L_s3pd
  s_sleep 2
  s_add_u32 s70, s70, 1
  s_cmp_lt_u32 s70, 262144
  s_cbranch_scc1 L_s3p
L_s3pd:
  v_mov_b32 v12, s20
  v_mov_b32 v13, s22
  v_mov_b32 v14, s24
  v_mov_b32 v15, s26
  v_max_f32 v23, v12, v14
  ds_max_f32 v38, v23 offset:276
  ds_add_u32 v38, v17 offset:272
  ds_add_u32 v38, v17 offset:300
  ds_write_b64 v21, v[12:13] offset:448
  ds_write_b64 v22, v[14:15] offset:448
  s_mov_b64 exec, -1
  v_and_b32 v9, 3, v1
  v_lshlrev_b32 v9, 3, v9
  ds_read_b64 v[10:11], v9 offset:448
  s_waitcnt lgkmcnt(0)
  v_max_f32_dpp v8, v10, v10 quad_perm:[1,0,3,2] row_mask:0xf bank_mask:0xf
  s_nop 1
  v_max_f32_dpp v8, v8, v8 quad_perm:[2,3,0,1] row_mask:0xf bank_mask:0xf
  v_sub_f32 v9, v10, v8
  v_mul_f32 v9, 0x3fb8aa3b, v9
  v_exp_f32 v9, v9
  s_nop 0
  v_mul_f32 v10, v9, v11
  s_nop 1
  v_add_f32_dpp v10, v10, v10 quad_perm:[1,0,3,2] row_mask:0xf bank_mask:0xf
  s_nop 1
  v_add_f32_dpp v10, v10, v10 quad_perm:[2,3,0,1] row_mask:0xf bank_mask:0xf
  v_sub_f32 v9, v16, v8
  v_rcp_f32 v10, v10
  v_mul_f32 v9, 0x3fb8aa3b, v9
  v_exp_f32 v9, v9
  v_lshlrev_b32 v8, 2, v1
  v_mul_f32 v9, v9, v10
  s_mov_b64 exec, 0xffff
  ds_write_b32 v8, v9 offset:384
  s_mov_b64 exec, -1
  ds_write_b32 v38, v38 offset:256
  ds_read_b128 v[62:65], v38 offset:384
  ds_read_b128 v[66:69], v38 offset:400
  ds_read_b128 v[70:73], v38 offset:416
  v_lshlrev_b32 v77, 3, v1
  s_lshl2_add_u32 s68, s6, s7
  s_lshl_b32 s68, s68, 9
  s_add_u32 s68, s68, 131072
  v_add_u32 v74, s68, v77
  v_and_b32 v75, 1, v1
  v_lshlrev_b32 v75, 4, v75
  v_lshrrev_b32 v75, v75, s74
  v_lshrrev_b32 v76, 8, v75
  s_mov_b32 s70, 0
L_sn_12:
  ds_read_b32 v8, v38 offset:304
  s_waitcnt lgkmcnt(0)
  v_cmp_gt_u32 vcc, 0xa, v8
  s_cmp_eq_u64 vcc, 0
  s_cbranch_scc1 L_snd_13
  s_sleep 1
  s_add_u32 s70, s70, 1
  s_cmp_lt_u32 s70, 2097152
  s_cbranch_scc1 L_sn_12
L_snd_13:
  s_mov_b32 s70, 0
L_wt_14:
  ds_read_b32 v8, v38 offset:304
  ds_read_b64 v[40:41], v77 offset:6656
  ds_read_b64 v[42:43], v77 offset:7168
  ds_read_b64 v[44:45], v77 offset:7680
  ds_read_b64 v[46:47], v77 offset:8192
  ds_read_b64 v[48:49], v77 offset:8704
  ds_read_b64 v[50:51], v77 offset:9216
  ds_read_b64 v[52:53], v77 offset:9728
  ds_read_b64 v[54:55], v77 offset:10240
  ds_read_b64 v[56:57], v77 offset:10752
  ds_read_b64 v[58:59], v77 offset:11264
  ds_read_b64 v[60:61], v77 offset:11776
  s_waitcnt lgkmcnt(11)
  v_cmp_gt_u32 vcc, 11, v8
  s_cmp_eq_u64 vcc, 0
  s_cbranch_scc1 L_wtd_15
  s_waitcnt lgkmcnt(0)
  s_add_u32 s70, s70, 1
  s_cmp_lt_u32 s70, 2097152
  s_cbranch_scc1 L_wt_14
L_wtd_15:
  s_movk_i32 s69, 0xff
  s_waitcnt lgkmcnt(10)
  v_pk_mul_f32 v[40:41], v[40:41], v[62:63] op_sel:[0,0] op_sel_hi:[1,0]
  s_waitcnt lgkmcnt(9)
  v_pk_mul_f32 v[42:43], v[42:43], v[62:63] op_sel:[0,1] op_sel_hi:[1,1]
  s_waitcnt lgkmcnt(8)
  v_pk_fma_f32 v[40:41], v[44:45], v[64:65], v[40:41] op_sel:[0,0,0] op_sel_hi:[1,0,1]
  s_waitcnt lgkmcnt(7)
  v_pk_fma_f32 v[42:43], v[46:47], v[64:65], v[42:43] op_sel:[0,1,0] op_sel_hi:[1,1,1]
  s_waitcnt lgkmcnt(6)
  v_pk_fma_f32 v[40:41], v[48:49], v[66:67], v[40:41] op_sel:[0,0,0] op_sel_hi:[1,0,1]
  s_waitcnt lgkmcnt(5)
  v_pk_fma_f32 v[42:43], v[50:51], v[66:67], v[42:43] op_sel:[0,1,0] op_sel_hi:[1,1,1]
  s_waitcnt lgkmcnt(4)
  v_pk_fma_f32 v[40:41], v[52:53], v[68:69], v[40:41] op_sel:[0,0,0] op_sel_hi:[1,0,1]
  s_waitcnt lgkmcnt(3)
  v_pk_fma_f32 v[42:43], v[54:55], v[68:69], v[42:43] op_sel:[0,1,0] op_sel_hi:[1,1,1]
  s_waitcnt lgkmcnt(2)
  v_pk_fma_f32 v[40:41], v[56:57], v[70:71], v[40:41] op_sel:[0,0,0] op_sel_hi:[1,0,1]
  s_waitcnt lgkmcnt(1)
  v_pk_fma_f32 v[42:43], v[58:59], v[70:71], v[42:43] op_sel:[0,1,0] op_sel_hi:[1,1,1]
  s_waitcnt lgkmcnt(0)
  v_pk_fma_f32 v[40:41], v[60:61], v[72:73], v[40:41] op_sel:[0,0,0] op_sel_hi:[1,0,1]
  v_pk_add_f32 v[40:41], v[40:41], v[42:43]
  v_bfi_b32 v40, s69, v75, v40
  v_bfi_b32 v41, s69, v76, v41
  s_cmp_eq_u32 s75, 1
  s_cbranch_scc0 L_pf_16
  global_store_dwordx2 v74, v[40:41], s[42:43]
  s_branch L_pe_17
L_pf_16:
  global_store_dwordx2 v74, v[40:41], s[42:43] sc1
L_pe_17:
  ds_read_b128 v[102:105], v38 offset:384
  ds_read_b128 v[106:109], v38 offset:400
  ds_read_b128 v[110:113], v38 offset:416
  v_lshlrev_b32 v117, 3, v1
  s_lshl2_add_u32 s68, s6, s7
  s_lshl_b32 s68, s68, 9
  s_add_u32 s68, s68, 524288
  v_add_u32 v114, s68, v117
  v_and_b32 v115, 1, v1
  v_lshlrev_b32 v115, 4, v115
  v_lshrrev_b32 v115, v115, s74
  v_lshrrev_b32 v116, 8, v115
  s_waitcnt vmcnt(0)
  s_mov_b32 s70, 0
L_sn_18:
  ds_read_b32 v8, v38 offset:308
  s_waitcnt lgkmcnt(0)
  v_cmp_gt_u32 vcc, 0x1, v8
  s_cmp_eq_u64 vcc, 0
  s_cbranch_scc1 L_snd_19
  s_sleep 4
  s_add_u32 s70, s70, 1
  s_cmp_lt_u32 s70, 2097152
  s_cbranch_scc1 L_sn_18
L_snd_19:
  global_store_dwordx2 v74, v[40:41], s[42:43] sc1
  s_cmp_eq_u32 s7, 2
  s_cbranch_scc1 L_chk
  s_mov_b32 s70, 0
L_sn_20:
  ds_read_b32 v8, v38 offset:308
  s_waitcnt lgkmcnt(0)
  v_cmp_gt_u32 vcc, 0xa, v8
  s_cmp_eq_u64 vcc, 0
  s_cbranch_scc1 L_snd_21
  s_sleep 1
  s_add_u32 s70, s70, 1
  s_cmp_lt_u32 s70, 2097152
  s_cbranch_scc1 L_sn_20
L_snd_21:
  s_mov_b32 s70, 0
L_wt_22:
  ds_read_b32 v8, v38 offset:308
  ds_read_b64 v[80:81], v117 offset:1024
  ds_read_b64 v[82:83], v117 offset:1536
  ds_read_b64 v[84:85], v117 offset:2048
  ds_read_b64 v[86:87], v117 offset:2560
  ds_read_b64 v[88:89], v117 offset:3072
  ds_read_b64 v[90:91], v117 offset:3584
  ds_read_b64 v[92:93], v117 offset:4096
  ds_read_b64 v[94:95], v117 offset:4608
  ds_read_b64 v[96:97], v117 offset:5120
  ds_read_b64 v[98:99], v117 offset:5632
  ds_read_b64 v[100:101], v117 offset:6144
  s_waitcnt lgkmcnt(11)
  v_cmp_gt_u32 vcc, 11, v8
  s_cmp_eq_u64 vcc, 0
  s_cbranch_scc1 L_wtd_23
  s_waitcnt lgkmcnt(0)
  s_add_u32 s70, s70, 1
  s_cmp_lt_u32 s70, 2097152
  s_cbranch_scc1 L_wt_22
L_wtd_23:
  s_movk_i32 s69, 0xff
  s_waitcnt lgkmcnt(10)
  v_pk_mul_f32 v[80:81], v[80:81], v[102:103] op_sel:[0,0] op_sel_hi:[1,0]
  s_waitcnt lgkmcnt(9)
  v_pk_mul_f32 v[82:83], v[82:83], v[102:103] op_sel:[0,1] op_sel_hi:[1,1]
  s_waitcnt lgkmcnt(8)
  v_pk_fma_f32 v[80:81], v[84:85], v[104:105], v[80:81] op_sel:[0,0,0] op_sel_hi:[1,0,1]
  s_waitcnt lgkmcnt(7)
  v_pk_fma_f32 v[82:83], v[86:87], v[104:105], v[82:83] op_sel:[0,1,0] op_sel_hi:[1,1,1]
  s_waitcnt lgkmcnt(6)
  v_pk_fma_f32 v[80:81], v[88:89], v[106:107], v[80:81] op_sel:[0,0,0] op_sel_hi:[1,0,1]
  s_waitcnt lgkmcnt(5)
  v_pk_fma_f32 v[82:83], v[90:91], v[106:107], v[82:83] op_sel:[0,1,0] op_sel_hi:[1,1,1]
  s_waitcnt lgkmcnt(4)
  v_pk_fma_f32 v[80:81], v[92:93], v[108:109], v[80:81] op_sel:[0,0,0] op_sel_hi:[1,0,1]
  s_waitcnt lgkmcnt(3)
  v_pk_fma_f32 v[82:83], v[94:95], v[108:109], v[82:83] op_sel:[0,1,0] op_sel_hi:[1,1,1]
  s_waitcnt lgkmcnt(2)
  v_pk_fma_f32 v[80:81], v[96:97], v[110:111], v[80:81] op_sel:[0,0,0] op_sel_hi:[1,0,1]
  s_waitcnt lgkmcnt(1)
  v_pk_fma_f32 v[82:83], v[98:99], v[110:111], v[82:83] op_sel:[0,1,0] op_sel_hi:[1,1,1]
  s_waitcnt lgkmcnt(0)
  v_pk_fma_f32 v[80:81], v[100:101], v[112:113], v[80:81] op_sel:[0,0,0] op_sel_hi:[1,0,1]
  v_pk_add_f32 v[80:81], v[80:81], v[82:83]
  v_bfi_b32 v80, s69, v115, v80
  v_bfi_b32 v81, s69, v116, v81
  global_store_dwordx2 v114, v[80:81], s[42:43] sc1
  s_branch L_fin
L_chk:
  v_and_b32 v160, 0xff, v75
  v_and_b32 v161, 0xff, v76
  s_lshl_b32 s10, s6, 11
  s_add_u32 s10, s10, 131072
  v_lshl_add_u32 v2, v1, 3, s10
  global_load_dwordx2 v[154:155], v2, s[42:43] offset:0 sc1
  global_load_dwordx2 v[156:157], v2, s[42:43] offset:512 sc1
  v_add_u32 v3, 393216, v2
  s_mov_b32 s70, 0
L_sn_24:
  ds_read_b32 v8, v38 offset:308
  s_waitcnt lgkmcnt(0)
  v_cmp_gt_u32 vcc, 0xa, v8
  s_cmp_eq_u64 vcc, 0
  s_cbranch_scc1 L_snd_25
  s_sleep 1
  s_add_u32 s70, s70, 1
  s_cmp_lt_u32 s70, 2097152
  s_cbranch_scc1 L_sn_24
L_snd_25:
  s_mov_b32 s70, 0
L_wt_26:
  ds_read_b32 v8, v38 offset:308
  ds_read_b64 v[80:81], v117 offset:1024
  ds_read_b64 v[82:83], v117 offset:1536
  ds_read_b64 v[84:85], v117 offset:2048
  ds_read_b64 v[86:87], v117 offset:2560
  ds_read_b64 v[88:89], v117 offset:3072
  ds_read_b64 v[90:91], v117 offset:3584
  ds_read_b64 v[92:93], v117 offset:4096
  ds_read_b64 v[94:95], v117 offset:4608
  ds_read_b64 v[96:97], v117 offset:5120
  ds_read_b64 v[98:99], v117 offset:5632
  ds_read_b64 v[100:101], v117 offset:6144
  s_waitcnt lgkmcnt(11)
  v_cmp_gt_u32 vcc, 11, v8
  s_cmp_eq_u64 vcc, 0
  s_cbranch_scc1 L_wtd_27
  s_waitcnt lgkmcnt(0)
  s_add_u32 s70, s70, 1
  s_cmp_lt_u32 s70, 2097152
  s_cbranch_scc1 L_wt_26
L_wtd_27:
  global_load_dwordx2 v[130:131], v3, s[42:43] offset:0 sc1
  global_load_dwordx2 v[132:133], v3, s[42:43] offset:512 sc1
  s_movk_i32 s69, 0xff
  s_waitcnt lgkmcnt(10)
  v_pk_mul_f32 v[80:81], v[80:81], v[102:103] op_sel:[0,0] op_sel_hi:[1,0]
  s_waitcnt lgkmcnt(9)
  v_pk_mul_f32 v[82:83], v[82:83], v[102:103] op_sel:[0,1] op_sel_hi:[1,1]
  s_waitcnt lgkmcnt(8)
  v_pk_fma_f32 v[80:81], v[84:85], v[104:105], v[80:81] op_sel:[0,0,0] op_sel_hi:[1,0,1]
  s_waitcnt lgkmcnt(7)
  v_pk_fma_f32 v[82:83], v[86:87], v[104:105], v[82:83] op_sel:[0,1,0] op_sel_hi:[1,1,1]
  s_waitcnt lgkmcnt(6)
  v_pk_fma_f32 v[80:81], v[88:89], v[106:107], v[80:81] op_sel:[0,0,0] op_sel_hi:[1,0,1]
  s_waitcnt lgkmcnt(5)
  v_pk_fma_f32 v[82:83], v[90:91], v[106:107], v[82:83] op_sel:[0,1,0] op_sel_hi:[1,1,1]
  s_waitcnt lgkmcnt(4)
  v_pk_fma_f32 v[80:81], v[92:93], v[108:109], v[80:81] op_sel:[0,0,0] op_sel_hi:[1,0,1]
  s_waitcnt lgkmcnt(3)
  v_pk_fma_f32 v[82:83], v[94:95], v[108:109], v[82:83] op_sel:[0,1,0] op_sel_hi:[1,1,1]
  s_waitcnt lgkmcnt(2)
  v_pk_fma_f32 v[80:81], v[96:97], v[110:111], v[80:81] op_sel:[0,0,0] op_sel_hi:[1,0,1]
  s_waitcnt lgkmcnt(1)
  v_pk_fma_f32 v[82:83], v[98:99], v[110:111], v[82:83] op_sel:[0,1,0] op_sel_hi:[1,1,1]
  s_waitcnt lgkmcnt(0)
  v_pk_fma_f32 v[80:81], v[100:101], v[112:113], v[80:81] op_sel:[0,0,0] op_sel_hi:[1,0,1]
  v_pk_add_f32 v[80:81], v[80:81], v[82:83]
  v_bfi_b32 v80, s69, v115, v80
  v_bfi_b32 v81, s69, v116, v81
  global_store_dwordx2 v114, v[80:81], s[42:43] sc1
  s_waitcnt vmcnt(1)
  s_mov_b32 s70, 0
  s_branch L_cp0c
L_cp0:
  global_load_dwordx2 v[154:155], v2, s[42:43] offset:0 sc1
  global_load_dwordx2 v[156:157], v2, s[42:43] offset:512 sc1
  s_sleep 4
  s_waitcnt vmcnt(0)
L_cp0c:
  v_xor_b32 v136, v154, v160
  v_xor_b32 v137, v155, v161
  v_xor_b32 v138, v156, v160
  v_xor_b32 v139, v157, v161
  v_xor_b32 v140, v40, v160
  v_xor_b32 v141, v41, v161
  v_or3_b32 v152, v136, v137, v138
  v_or3_b32 v153, v139, v140, v141
  v_or_b32 v136, 0x80, v136
  v_or_b32 v137, 0x80, v137
  v_or_b32 v138, 0x80, v138
  v_or_b32 v139, 0x80, v139
  v_or_b32 v140, 0x80, v140
  v_or_b32 v141, 0x80, v141
  v_or_b32 v152, v152, v153
  v_pk_add_f32 v[136:137], v[136:137], v[138:139]
  v_lshlrev_b32 v152, 24, v152
  v_pk_add_f32 v[136:137], v[136:137], v[140:141]
  v_cmp_ne_u32 vcc, 0, v152
  v_cvt_pk_bf16_f32 v136, v136, v137
  s_cmp_eq_u64 vcc, 0
  s_cbranch_scc1 L_cp0d
  s_add_u32 s70, s70, 1
  s_cmp_lt_u32 s70, 262144
  s_cbranch_scc1 L_cp0
L_cp0d:
  v_add_u32 v2, 393216, v2
  s_mov_b32 s70, 0
  s_branch L_cp1c
L_cp1:
  global_load_dwordx2 v[130:131], v2, s[42:43] offset:0 sc1
  global_load_dwordx2 v[132:133], v2, s[42:43] offset:512 sc1
  s_waitcnt vmcnt(0)
L_cp1c:
  v_xor_b32 v144, v130, v160
  v_xor_b32 v145, v131, v161
  v_xor_b32 v146, v132, v160
  v_xor_b32 v147, v133, v161
  v_xor_b32 v148, v80, v160
  v_xor_b32 v149, v81, v161
  v_or3_b32 v152, v144, v145, v146
  v_or3_b32 v153, v147, v148, v149
  v_or_b32 v144, 0x80, v144
  v_or_b32 v145, 0x80, v145
  v_or_b32 v146, 0x80, v146
  v_or_b32 v147, 0x80, v147
  v_or_b32 v148, 0x80, v148
  v_or_b32 v149, 0x80, v149
  v_or_b32 v152, v152, v153
  v_pk_add_f32 v[144:145], v[144:145], v[146:147]
  v_lshlrev_b32 v152, 24, v152
  v_pk_add_f32 v[144:145], v[144:145], v[148:149]
  v_cmp_ne_u32 vcc, 0, v152
  v_cvt_pk_bf16_f32 v144, v144, v145
  s_cmp_eq_u64 vcc, 0
  s_cbranch_scc1 L_cp1d
  s_add_u32 s70, s70, 1
  s_cmp_lt_u32 s70, 262144
  s_cbranch_scc1 L_cp1
L_cp1d:
  v_cmp_ne_u32 vcc, v136, v144
  s_cmp_eq_u64 vcc, 0
  s_cbranch_scc1 L_fin
  s_waitcnt vmcnt(0)
L_slow:
  s_mov_b32 s47, 0x20000
  s_load_dwordx16 s[16:31], s[0:1], 0
  s_load_dwordx8 s[32:39], s[0:1], 64
  v_and_b32 v2, 31, v1
  v_lshlrev_b32 v2, 7, v2
  v_add_u32 v2, 28672, v2
  s_mov_b32 s70, 0
L_sl_d:
  global_load_dword v3, v2, s[42:43] sc1
  s_waitcnt vmcnt(0) lgkmcnt(0)
  v_cmp_ne_u32 vcc, s74, v3
  s_cmp_eq_u64 vcc, 0
  s_cbranch_scc1 L_sl_dd
  s_sleep 8
  s_add_u32 s70, s70, 1
  s_cmp_lt_u32 s70, 262144
  s_cbranch_scc1 L_sl_d
L_sl_dd:
  v_lshlrev_b32 v2, 3, v1
  v_add_u32 v2, 524288, v2
  v_lshlrev_b32 v0, 2, v1
  v_add_u32 v0, 12288, v0
  s_mov_b32 s10, 0
L_sl_h:
  s_mov_b32 s70, 0
L_sl_hp:
  global_load_dwordx2 v[40:41], v2, s[42:43] offset:0 sc1
  global_load_dwordx2 v[42:43], v2, s[42:43] offset:512 sc1
  global_load_dwordx2 v[44:45], v2, s[42:43] offset:1024 sc1
  s_waitcnt vmcnt(0)
  v_xor_b32 v40, v40, v160
  v_xor_b32 v41, v41, v161
  v_xor_b32 v42, v42, v160
  v_xor_b32 v43, v43, v161
  v_xor_b32 v44, v44, v160
  v_xor_b32 v45, v45, v161
  v_or3_b32 v48, v40, v41, v42
  v_or3_b32 v49, v43, v44, v45
  v_or_b32 v40, 0x80, v40
  v_or_b32 v41, 0x80, v41
  v_or_b32 v42, 0x80, v42
  v_or_b32 v43, 0x80, v43
  v_or_b32 v44, 0x80, v44
  v_or_b32 v45, 0x80, v45
  v_or_b32 v48, v48, v49
  v_pk_add_f32 v[40:41], v[40:41], v[42:43]
  v_lshlrev_b32 v48, 24, v48
  v_pk_add_f32 v[40:41], v[40:41], v[44:45]
  v_cmp_ne_u32 vcc, 0, v48
  v_cvt_pk_bf16_f32 v40, v40, v41
  s_cmp_eq_u64 vcc, 0
  s_cbranch_scc1 L_sl_hd
  s_sleep 8
  s_add_u32 s70, s70, 1
  s_cmp_lt_u32 s70, 262144
  s_cbranch_scc1 L_sl_hp
L_sl_hd:
  ds_write_b32 v0, v40
  v_add_u32 v2, 2048, v2
  v_add_u32 v0, 256, v0
  s_add_u32 s10, s10, 1
  s_cmp_lt_u32 s10, 64
  s_cbranch_scc1 L_sl_h
  s_mov_b32 s44, s24
  s_mov_b32 s45, s25
  s_mov_b32 s46, 4194304
  s_mov_b32 s11, 1024
  s_mov_b32 s12, 4194304
  v_mov_b32 v4, 12288
  v_mov_b32 v5, 20480
  v_lshlrev_b32 v2, 4, v1
  s_call_b64 s[62:63], L_gv
  v_lshlrev_b32 v0, 4, v1
  global_load_dwordx4 v[40:43], v0, s[16:17] offset:0
  global_load_dwordx4 v[44:47], v0, s[16:17] offset:1024
  s_waitcnt vmcnt(0)
  v_lshlrev_b32 v104, 16, v40
  v_and_b32 v105, s73, v40
  v_lshlrev_b32 v106, 16, v41
  v_and_b32 v107, s73, v41
  v_lshlrev_b32 v108, 16, v42
  v_and_b32 v109, s73, v42
  v_lshlrev_b32 v110, 16, v43
  v_and_b32 v111, s73, v43
  v_lshlrev_b32 v112, 16, v44
  v_and_b32 v113, s73, v44
  v_lshlrev_b32 v114, 16, v45
  v_and_b32 v115, s73, v45
  v_lshlrev_b32 v116, 16, v46
  v_and_b32 v117, s73, v46
  v_lshlrev_b32 v118, 16, v47
  v_and_b32 v119, s73, v47
  v_lshrrev_b32 v2, 1, v1
  v_lshlrev_b32 v2, 7, v2
  v_and_b32 v3, 1, v1
  v_lshl_add_u32 v2, v3, 5, v2
  v_add_u32 v2, 12288, v2
  global_load_dwordx4 v[40:43], v2, s[42:43] offset:0 sc1
  global_load_dwordx4 v[44:47], v2, s[42:43] offset:16 sc1
  global_load_dwordx4 v[48:51], v2, s[42:43] offset:64 sc1
  global_load_dwordx4 v[52:55], v2, s[42:43] offset:80 sc1
  s_waitcnt vmcnt(0)
  v_lshlrev_b32 v88, 16, v40
  v_and_b32 v89, s73, v40
  v_lshlrev_b32 v90, 16, v42
  v_and_b32 v91, s73, v42
  v_lshlrev_b32 v92, 16, v44
  v_and_b32 v93, s73, v44
  v_lshlrev_b32 v94, 16, v46
  v_and_b32 v95, s73, v46
  v_lshlrev_b32 v96, 16, v48
  v_and_b32 v97, s73, v48
  v_lshlrev_b32 v98, 16, v50
  v_and_b32 v99, s73, v50
  v_lshlrev_b32 v100, 16, v52
  v_and_b32 v101, s73, v52
  v_lshlrev_b32 v102, 16, v54
  v_and_b32 v103, s73, v54
  v_cvt_pk_bf16_f32 v72, 0, v72
  v_cvt_pk_bf16_f32 v73, 0, v73
  v_cvt_pk_bf16_f32 v74, 0, v74
  v_cvt_pk_bf16_f32 v75, 0, v75
  v_cvt_pk_bf16_f32 v76, 0, v76
  v_cvt_pk_bf16_f32 v77, 0, v77
  v_cvt_pk_bf16_f32 v78, 0, v78
  v_cvt_pk_bf16_f32 v79, 0, v79
  v_cvt_pk_bf16_f32 v80, 0, v80
  v_cvt_pk_bf16_f32 v81, 0, v81
  v_cvt_pk_bf16_f32 v82, 0, v82
  v_cvt_pk_bf16_f32 v83, 0, v83
  v_cvt_pk_bf16_f32 v84, 0, v84
  v_cvt_pk_bf16_f32 v85, 0, v85
  v_cvt_pk_bf16_f32 v86, 0, v86
  v_cvt_pk_bf16_f32 v87, 0, v87
  v_mul_f32 v72, v72, v88
  v_mul_f32 v73, v73, v89
  v_mul_f32 v74, v74, v90
  v_mul_f32 v75, v75, v91
  v_mul_f32 v76, v76, v92
  v_mul_f32 v77, v77, v93
  v_mul_f32 v78, v78, v94
  v_mul_f32 v79, v79, v95
  v_mul_f32 v80, v80, v96
  v_mul_f32 v81, v81, v97
  v_mul_f32 v82, v82, v98
  v_mul_f32 v83, v83, v99
  v_mul_f32 v84, v84, v100
  v_mul_f32 v85, v85, v101
  v_mul_f32 v86, v86, v102
  v_mul_f32 v87, v87, v103
  v_cvt_pk_bf16_f32 v72, 0, v72
  v_cvt_pk_bf16_f32 v73, 0, v73
  v_cvt_pk_bf16_f32 v74, 0, v74
  v_cvt_pk_bf16_f32 v75, 0, v75
  v_cvt_pk_bf16_f32 v76, 0, v76
  v_cvt_pk_bf16_f32 v77, 0, v77
  v_cvt_pk_bf16_f32 v78, 0, v78
  v_cvt_pk_bf16_f32 v79, 0, v79
  v_cvt_pk_bf16_f32 v80, 0, v80
  v_cvt_pk_bf16_f32 v81, 0, v81
  v_cvt_pk_bf16_f32 v82, 0, v82
  v_cvt_pk_bf16_f32 v83, 0, v83
  v_cvt_pk_bf16_f32 v84, 0, v84
  v_cvt_pk_bf16_f32 v85, 0, v85
  v_cvt_pk_bf16_f32 v86, 0, v86
  v_cvt_pk_bf16_f32 v87, 0, v87
  v_add_f32 v104, v104, v72
  v_add_f32 v105, v105, v73
  v_add_f32 v106, v106, v74
  v_add_f32 v107, v107, v75
  v_add_f32 v108, v108, v76
  v_add_f32 v109, v109, v77
  v_add_f32 v110, v110, v78
  v_add_f32 v111, v111, v79
  v_add_f32 v112, v112, v80
  v_add_f32 v113, v113, v81
  v_add_f32 v114, v114, v82
  v_add_f32 v115, v115, v83
  v_add_f32 v116, v116, v84
  v_add_f32 v117, v117, v85
  v_add_f32 v118, v118, v86
  v_add_f32 v119, v119, v87
  v_cvt_pk_bf16_f32 v104, 0, v104
  v_cvt_pk_bf16_f32 v105, 0, v105
  v_cvt_pk_bf16_f32 v106, 0, v106
  v_cvt_pk_bf16_f32 v107, 0, v107
  v_cvt_pk_bf16_f32 v108, 0, v108
  v_cvt_pk_bf16_f32 v109, 0, v109
  v_cvt_pk_bf16_f32 v110, 0, v110
  v_cvt_pk_bf16_f32 v111, 0, v111
  v_cvt_pk_bf16_f32 v112, 0, v112
  v_cvt_pk_bf16_f32 v113, 0, v113
  v_cvt_pk_bf16_f32 v114, 0, v114
  v_cvt_pk_bf16_f32 v115, 0, v115
  v_cvt_pk_bf16_f32 v116, 0, v116
  v_cvt_pk_bf16_f32 v117, 0, v117
  v_cvt_pk_bf16_f32 v118, 0, v118
  v_cvt_pk_bf16_f32 v119, 0, v119
  v_add_f32 v8, v104, v105
  v_add_f32 v8, v8, v106
  v_add_f32 v8, v8, v107
  v_add_f32 v8, v8, v108
  v_add_f32 v8, v8, v109
  v_add_f32 v8, v8, v110
  v_add_f32 v8, v8, v111
  s_nop 1
  v_add_f32_dpp v8, v8, v8 row_ror:8 row_mask:0xf bank_mask:0xf
  s_nop 1
  v_add_f32_dpp v8, v8, v8 row_ror:4 row_mask:0xf bank_mask:0xf
  s_nop 1
  v_add_f32_dpp v8, v8, v8 row_ror:2 row_mask:0xf bank_mask:0xf
  s_nop 1
  v_add_f32_dpp v8, v8, v8 row_ror:1 row_mask:0xf bank_mask:0xf
  v_mov_b32 v9, v8
  s_nop 1
  v_permlane16_swap_b32 v9, v8
  v_add_f32 v8, v8, v9
  v_mov_b32 v9, v8
  s_nop 1
  v_permlane32_swap_b32 v9, v8
  v_add_f32 v8, v8, v9
  v_mul_f32 v8, 0x3b000000, v8
  v_sub_f32 v72, v104, v8
  v_sub_f32 v73, v105, v8
  v_sub_f32 v74, v106, v8
  v_sub_f32 v75, v107, v8
  v_sub_f32 v76, v108, v8
  v_sub_f32 v77, v109, v8
  v_sub_f32 v78, v110, v8
  v_sub_f32 v79, v111, v8
  v_mul_f32 v10, v72, v72
  v_fmac_f32 v10, v73, v73
  v_fmac_f32 v10, v74, v74
  v_fmac_f32 v10, v75, v75
  v_fmac_f32 v10, v76, v76
  v_fmac_f32 v10, v77, v77
  v_fmac_f32 v10, v78, v78
  v_fmac_f32 v10, v79, v79
  s_nop 1
  v_add_f32_dpp v10, v10, v10 row_ror:8 row_mask:0xf bank_mask:0xf
  s_nop 1
  v_add_f32_dpp v10, v10, v10 row_ror:4 row_mask:0xf bank_mask:0xf
  s_nop 1
  v_add_f32_dpp v10, v10, v10 row_ror:2 row_mask:0xf bank_mask:0xf
  s_nop 1
  v_add_f32_dpp v10, v10, v10 row_ror:1 row_mask:0xf bank_mask:0xf
  v_mov_b32 v9, v10
  s_nop 1
  v_permlane16_swap_b32 v9, v10
  v_add_f32 v10, v10, v9
  v_mov_b32 v9, v10
  s_nop 1
  v_permlane32_swap_b32 v9, v10
  v_add_f32 v10, v10, v9
  v_mul_f32 v10, 0x3b000000, v10
  v_cvt_pk_bf16_f32 v8, 0, v8
  v_cvt_pk_bf16_f32 v10, 0, v10
  v_add_f32 v10, 0x3727c5ac, v10
  v_cvt_pk_bf16_f32 v10, 0, v10
  v_sqrt_f32 v10, v10
  v_sub_f32 v72, v104, v8
  v_sub_f32 v73, v105, v8
  v_sub_f32 v74, v106, v8
  v_sub_f32 v75, v107, v8
  v_sub_f32 v76, v108, v8
  v_sub_f32 v77, v109, v8
  v_sub_f32 v78, v110, v8
  v_sub_f32 v79, v111, v8
  v_cvt_pk_bf16_f32 v10, 0, v10
  v_cvt_pk_bf16_f32 v72, 0, v72
  v_cvt_pk_bf16_f32 v73, 0, v73
  v_cvt_pk_bf16_f32 v74, 0, v74
  v_cvt_pk_bf16_f32 v75, 0, v75
  v_cvt_pk_bf16_f32 v76, 0, v76
  v_cvt_pk_bf16_f32 v77, 0, v77
  v_cvt_pk_bf16_f32 v78, 0, v78
  v_cvt_pk_bf16_f32 v79, 0, v79
  v_rcp_f32 v10, v10
  s_nop 0
  v_mul_f32 v72, v72, v10
  v_mul_f32 v73, v73, v10
  v_mul_f32 v74, v74, v10
  v_mul_f32 v75, v75, v10
  v_mul_f32 v76, v76, v10
  v_mul_f32 v77, v77, v10
  v_mul_f32 v78, v78, v10
  v_mul_f32 v79, v79, v10
  v_cvt_pk_bf16_f32 v72, 0, v72
  v_cvt_pk_bf16_f32 v73, 0, v73
  v_cvt_pk_bf16_f32 v74, 0, v74
  v_cvt_pk_bf16_f32 v75, 0, v75
  v_cvt_pk_bf16_f32 v76, 0, v76
  v_cvt_pk_bf16_f32 v77, 0, v77
  v_cvt_pk_bf16_f32 v78, 0, v78
  v_cvt_pk_bf16_f32 v79, 0, v79
  v_add_f32 v8, v112, v113
  v_add_f32 v8, v8, v114
  v_add_f32 v8, v8, v115
  v_add_f32 v8, v8, v116
  v_add_f32 v8, v8, v117
  v_add_f32 v8, v8, v118
  v_add_f32 v8, v8, v119
  s_nop 1
  v_add_f32_dpp v8, v8, v8 row_ror:8 row_mask:0xf bank_mask:0xf
  s_nop 1
  v_add_f32_dpp v8, v8, v8 row_ror:4 row_mask:0xf bank_mask:0xf
  s_nop 1
  v_add_f32_dpp v8, v8, v8 row_ror:2 row_mask:0xf bank_mask:0xf
  s_nop 1
  v_add_f32_dpp v8, v8, v8 row_ror:1 row_mask:0xf bank_mask:0xf
  v_mov_b32 v9, v8
  s_nop 1
  v_permlane16_swap_b32 v9, v8
  v_add_f32 v8, v8, v9
  v_mov_b32 v9, v8
  s_nop 1
  v_permlane32_swap_b32 v9, v8
  v_add_f32 v8, v8, v9
  v_mul_f32 v8, 0x3b000000, v8
  v_sub_f32 v80, v112, v8
  v_sub_f32 v81, v113, v8
  v_sub_f32 v82, v114, v8
  v_sub_f32 v83, v115, v8
  v_sub_f32 v84, v116, v8
  v_sub_f32 v85, v117, v8
  v_sub_f32 v86, v118, v8
  v_sub_f32 v87, v119, v8
  v_mul_f32 v10, v80, v80
  v_fmac_f32 v10, v81, v81
  v_fmac_f32 v10, v82, v82
  v_fmac_f32 v10, v83, v83
  v_fmac_f32 v10, v84, v84
  v_fmac_f32 v10, v85, v85
  v_fmac_f32 v10, v86, v86
  v_fmac_f32 v10, v87, v87
  s_nop 1
  v_add_f32_dpp v10, v10, v10 row_ror:8 row_mask:0xf bank_mask:0xf
  s_nop 1
  v_add_f32_dpp v10, v10, v10 row_ror:4 row_mask:0xf bank_mask:0xf
  s_nop 1
  v_add_f32_dpp v10, v10, v10 row_ror:2 row_mask:0xf bank_mask:0xf
  s_nop 1
  v_add_f32_dpp v10, v10, v10 row_ror:1 row_mask:0xf bank_mask:0xf
  v_mov_b32 v9, v10
  s_nop 1
  v_permlane16_swap_b32 v9, v10
  v_add_f32 v10, v10, v9
  v_mov_b32 v9, v10
  s_nop 1
  v_permlane32_swap_b32 v9, v10
  v_add_f32 v10, v10, v9
  v_mul_f32 v10, 0x3b000000, v10
  v_cvt_pk_bf16_f32 v8, 0, v8
  v_cvt_pk_bf16_f32 v10, 0, v10
  v_add_f32 v10, 0x3727c5ac, v10
  v_cvt_pk_bf16_f32 v10, 0, v10
  v_sqrt_f32 v10, v10
  v_sub_f32 v80, v112, v8
  v_sub_f32 v81, v113, v8
  v_sub_f32 v82, v114, v8
  v_sub_f32 v83, v115, v8
  v_sub_f32 v84, v116, v8
  v_sub_f32 v85, v117, v8
  v_sub_f32 v86, v118, v8
  v_sub_f32 v87, v119, v8
  v_cvt_pk_bf16_f32 v10, 0, v10
  v_cvt_pk_bf16_f32 v80, 0, v80
  v_cvt_pk_bf16_f32 v81, 0, v81
  v_cvt_pk_bf16_f32 v82, 0, v82
  v_cvt_pk_bf16_f32 v83, 0, v83
  v_cvt_pk_bf16_f32 v84, 0, v84
  v_cvt_pk_bf16_f32 v85, 0, v85
  v_cvt_pk_bf16_f32 v86, 0, v86
  v_cvt_pk_bf16_f32 v87, 0, v87
  v_rcp_f32 v10, v10
  s_nop 0
  v_mul_f32 v80, v80, v10
  v_mul_f32 v81, v81, v10
  v_mul_f32 v82, v82, v10
  v_mul_f32 v83, v83, v10
  v_mul_f32 v84, v84, v10
  v_mul_f32 v85, v85, v10
  v_mul_f32 v86, v86, v10
  v_mul_f32 v87, v87, v10
  v_cvt_pk_bf16_f32 v80, 0, v80
  v_cvt_pk_bf16_f32 v81, 0, v81
  v_cvt_pk_bf16_f32 v82, 0, v82
  v_cvt_pk_bf16_f32 v83, 0, v83
  v_cvt_pk_bf16_f32 v84, 0, v84
  v_cvt_pk_bf16_f32 v85, 0, v85
  v_cvt_pk_bf16_f32 v86, 0, v86
  v_cvt_pk_bf16_f32 v87, 0, v87
  v_lshrrev_b32 v2, 1, v1
  v_lshlrev_b32 v2, 7, v2
  v_and_b32 v3, 1, v1
  v_lshl_add_u32 v2, v3, 5, v2
  v_add_u32 v2, 20480, v2
  global_load_dwordx4 v[40:43], v2, s[42:43] offset:0 sc1
  global_load_dwordx4 v[44:47], v2, s[42:43] offset:16 sc1
  global_load_dwordx4 v[48:51], v2, s[42:43] offset:64 sc1
  global_load_dwordx4 v[52:55], v2, s[42:43] offset:80 sc1
  s_waitcnt vmcnt(0)
  v_lshlrev_b32 v88, 16, v40
  v_and_b32 v89, s73, v40
  v_lshlrev_b32 v90, 16, v42
  v_and_b32 v91, s73, v42
  v_lshlrev_b32 v92, 16, v44
  v_and_b32 v93, s73, v44
  v_lshlrev_b32 v94, 16, v46
  v_and_b32 v95, s73, v46
  v_lshlrev_b32 v96, 16, v48
  v_and_b32 v97, s73, v48
  v_lshlrev_b32 v98, 16, v50
  v_and_b32 v99, s73, v50
  v_lshlrev_b32 v100, 16, v52
  v_and_b32 v101, s73, v52
  v_lshlrev_b32 v102, 16, v54
  v_and_b32 v103, s73, v54
  v_add_f32 v88, 1.0, v88
  v_add_f32 v89, 1.0, v89
  v_add_f32 v90, 1.0, v90
  v_add_f32 v91, 1.0, v91
  v_add_f32 v92, 1.0, v92
  v_add_f32 v93, 1.0, v93
  v_add_f32 v94, 1.0, v94
  v_add_f32 v95, 1.0, v95
  v_add_f32 v96, 1.0, v96
  v_add_f32 v97, 1.0, v97
  v_add_f32 v98, 1.0, v98
  v_add_f32 v99, 1.0, v99
  v_add_f32 v100, 1.0, v100
  v_add_f32 v101, 1.0, v101
  v_add_f32 v102, 1.0, v102
  v_add_f32 v103, 1.0, v103
  v_cvt_pk_bf16_f32 v88, 0, v88
  v_cvt_pk_bf16_f32 v89, 0, v89
  v_cvt_pk_bf16_f32 v90, 0, v90
  v_cvt_pk_bf16_f32 v91, 0, v91
  v_cvt_pk_bf16_f32 v92, 0, v92
  v_cvt_pk_bf16_f32 v93, 0, v93
  v_cvt_pk_bf16_f32 v94, 0, v94
  v_cvt_pk_bf16_f32 v95, 0, v95
  v_cvt_pk_bf16_f32 v96, 0, v96
  v_cvt_pk_bf16_f32 v97, 0, v97
  v_cvt_pk_bf16_f32 v98, 0, v98
  v_cvt_pk_bf16_f32 v99, 0, v99
  v_cvt_pk_bf16_f32 v100, 0, v100
  v_cvt_pk_bf16_f32 v101, 0, v101
  v_cvt_pk_bf16_f32 v102, 0, v102
  v_cvt_pk_bf16_f32 v103, 0, v103
  v_mul_f32 v72, v72, v88
  v_mul_f32 v73, v73, v89
  v_mul_f32 v74, v74, v90
  v_mul_f32 v75, v75, v91
  v_mul_f32 v76, v76, v92
  v_mul_f32 v77, v77, v93
  v_mul_f32 v78, v78, v94
  v_mul_f32 v79, v79, v95
  v_mul_f32 v80, v80, v96
  v_mul_f32 v81, v81, v97
  v_mul_f32 v82, v82, v98
  v_mul_f32 v83, v83, v99
  v_mul_f32 v84, v84, v100
  v_mul_f32 v85, v85, v101
  v_mul_f32 v86, v86, v102
  v_mul_f32 v87, v87, v103
  v_cvt_pk_bf16_f32 v72, 0, v72
  v_cvt_pk_bf16_f32 v73, 0, v73
  v_cvt_pk_bf16_f32 v74, 0, v74
  v_cvt_pk_bf16_f32 v75, 0, v75
  v_cvt_pk_bf16_f32 v76, 0, v76
  v_cvt_pk_bf16_f32 v77, 0, v77
  v_cvt_pk_bf16_f32 v78, 0, v78
  v_cvt_pk_bf16_f32 v79, 0, v79
  v_cvt_pk_bf16_f32 v80, 0, v80
  v_cvt_pk_bf16_f32 v81, 0, v81
  v_cvt_pk_bf16_f32 v82, 0, v82
  v_cvt_pk_bf16_f32 v83, 0, v83
  v_cvt_pk_bf16_f32 v84, 0, v84
  v_cvt_pk_bf16_f32 v85, 0, v85
  v_cvt_pk_bf16_f32 v86, 0, v86
  v_cvt_pk_bf16_f32 v87, 0, v87
  v_lshrrev_b32 v2, 1, v1
  v_lshlrev_b32 v2, 7, v2
  v_and_b32 v3, 1, v1
  v_lshl_add_u32 v2, v3, 5, v2
  v_add_u32 v2, 16384, v2
  global_load_dwordx4 v[40:43], v2, s[42:43] offset:0 sc1
  global_load_dwordx4 v[44:47], v2, s[42:43] offset:16 sc1
  global_load_dwordx4 v[48:51], v2, s[42:43] offset:64 sc1
  global_load_dwordx4 v[52:55], v2, s[42:43] offset:80 sc1
  s_waitcnt vmcnt(0)
  v_lshlrev_b32 v88, 16, v40
  v_and_b32 v89, s73, v40
  v_lshlrev_b32 v90, 16, v42
  v_and_b32 v91, s73, v42
  v_lshlrev_b32 v92, 16, v44
  v_and_b32 v93, s73, v44
  v_lshlrev_b32 v94, 16, v46
  v_and_b32 v95, s73, v46
  v_lshlrev_b32 v96, 16, v48
  v_and_b32 v97, s73, v48
  v_lshlrev_b32 v98, 16, v50
  v_and_b32 v99, s73, v50
  v_lshlrev_b32 v100, 16, v52
  v_and_b32 v101, s73, v52
  v_lshlrev_b32 v102, 16, v54
  v_and_b32 v103, s73, v54
  v_add_f32 v72, v72, v88
  v_add_f32 v73, v73, v89
  v_add_f32 v74, v74, v90
  v_add_f32 v75, v75, v91
  v_add_f32 v76, v76, v92
  v_add_f32 v77, v77, v93
  v_add_f32 v78, v78, v94
  v_add_f32 v79, v79, v95
  v_add_f32 v80, v80, v96
  v_add_f32 v81, v81, v97
  v_add_f32 v82, v82, v98
  v_add_f32 v83, v83, v99
  v_add_f32 v84, v84, v100
  v_add_f32 v85, v85, v101
  v_add_f32 v86, v86, v102
  v_add_f32 v87, v87, v103
  v_cvt_pk_bf16_f32 v40, v72, v73
  v_cvt_pk_bf16_f32 v41, v74, v75
  v_cvt_pk_bf16_f32 v42, v76, v77
  v_cvt_pk_bf16_f32 v43, v78, v79
  v_cvt_pk_bf16_f32 v44, v80, v81
  v_cvt_pk_bf16_f32 v45, v82, v83
  v_cvt_pk_bf16_f32 v46, v84, v85
  v_cvt_pk_bf16_f32 v47, v86, v87
  v_add_u32 v3, 12288, v0
  ds_write_b128 v3, v[40:43] offset:0
  ds_write_b128 v3, v[44:47] offset:1024
  s_mov_b32 s44, s28
  s_mov_b32 s45, s29
  s_mov_b32 s46, 1409024
  s_mov_b32 s11, 2752
  s_mov_b32 s12, 1409024
  v_mov_b32 v4, 12288
  v_mov_b32 v5, 13312
  v_lshlrev_b32 v2, 4, v1
  s_call_b64 s[62:63], L_gv
  v_cvt_pk_bf16_f32 v120, 0, v72
  v_cvt_pk_bf16_f32 v121, 0, v73
  v_cvt_pk_bf16_f32 v122, 0, v74
  v_cvt_pk_bf16_f32 v123, 0, v75
  v_cvt_pk_bf16_f32 v124, 0, v76
  v_cvt_pk_bf16_f32 v125, 0, v77
  v_cvt_pk_bf16_f32 v126, 0, v78
  v_cvt_pk_bf16_f32 v127, 0, v79
  v_cvt_pk_bf16_f32 v128, 0, v80
  v_cvt_pk_bf16_f32 v129, 0, v81
  v_cvt_pk_bf16_f32 v130, 0, v82
  v_cvt_pk_bf16_f32 v131, 0, v83
  v_cvt_pk_bf16_f32 v132, 0, v84
  v_cvt_pk_bf16_f32 v133, 0, v85
  v_cvt_pk_bf16_f32 v134, 0, v86
  v_cvt_pk_bf16_f32 v135, 0, v87
  s_mov_b32 s44, s30
  s_mov_b32 s45, s31
  s_mov_b32 s46, 1409024
  s_mov_b32 s11, 2752
  s_mov_b32 s12, 1409024
  v_mov_b32 v4, 12288
  v_mov_b32 v5, 13312
  v_lshlrev_b32 v2, 4, v1
  s_call_b64 s[62:63], L_gv
  v_mul_f32 v88, 0xbfb8aa3b, v120
  v_mul_f32 v89, 0xbfb8aa3b, v121
  v_mul_f32 v90, 0xbfb8aa3b, v122
  v_mul_f32 v91, 0xbfb8aa3b, v123
  v_exp_f32 v88, v88
  v_exp_f32 v89, v89
  v_exp_f32 v90, v90
  v_exp_f32 v91, v91
  s_nop 0
  v_add_f32 v88, 1.0, v88
  v_add_f32 v89, 1.0, v89
  v_add_f32 v90, 1.0, v90
  v_add_f32 v91, 1.0, v91
  v_rcp_f32 v88, v88
  v_rcp_f32 v89, v89
  v_rcp_f32 v90, v90
  v_rcp_f32 v91, v91
  s_nop 0
  v_mul_f32 v120, v120, v88
  v_mul_f32 v121, v121, v89
  v_mul_f32 v122, v122, v90
  v_mul_f32 v123, v123, v91
  v_mul_f32 v88, 0xbfb8aa3b, v124
  v_mul_f32 v89, 0xbfb8aa3b, v125
  v_mul_f32 v90, 0xbfb8aa3b, v126
  v_mul_f32 v91, 0xbfb8aa3b, v127
  v_exp_f32 v88, v88
  v_exp_f32 v89, v89
  v_exp_f32 v90, v90
  v_exp_f32 v91, v91
  s_nop 0
  v_add_f32 v88, 1.0, v88
  v_add_f32 v89, 1.0, v89
  v_add_f32 v90, 1.0, v90
  v_add_f32 v91, 1.0, v91
  v_rcp_f32 v88, v88
  v_rcp_f32 v89, v89
  v_rcp_f32 v90, v90
  v_rcp_f32 v91, v91
  s_nop 0
  v_mul_f32 v124, v124, v88
  v_mul_f32 v125, v125, v89
  v_mul_f32 v126, v126, v90
  v_mul_f32 v127, v127, v91
  v_mul_f32 v88, 0xbfb8aa3b, v128
  v_mul_f32 v89, 0xbfb8aa3b, v129
  v_mul_f32 v90, 0xbfb8aa3b, v130
  v_mul_f32 v91, 0xbfb8aa3b, v131
  v_exp_f32 v88, v88
  v_exp_f32 v89, v89
  v_exp_f32 v90, v90
  v_exp_f32 v91, v91
  s_nop 0
  v_add_f32 v88, 1.0, v88
  v_add_f32 v89, 1.0, v89
  v_add_f32 v90, 1.0, v90
  v_add_f32 v91, 1.0, v91
  v_rcp_f32 v88, v88
  v_rcp_f32 v89, v89
  v_rcp_f32 v90, v90
  v_rcp_f32 v91, v91
  s_nop 0
  v_mul_f32 v128, v128, v88
  v_mul_f32 v129, v129, v89
  v_mul_f32 v130, v130, v90
  v_mul_f32 v131, v131, v91
  v_mul_f32 v88, 0xbfb8aa3b, v132
  v_mul_f32 v89, 0xbfb8aa3b, v133
  v_mul_f32 v90, 0xbfb8aa3b, v134
  v_mul_f32 v91, 0xbfb8aa3b, v135
  v_exp_f32 v88, v88
  v_exp_f32 v89, v89
  v_exp_f32 v90, v90
  v_exp_f32 v91, v91
  s_nop 0
  v_add_f32 v88, 1.0, v88
  v_add_f32 v89, 1.0, v89
  v_add_f32 v90, 1.0, v90
  v_add_f32 v91, 1.0, v91
  v_rcp_f32 v88, v88
  v_rcp_f32 v89, v89
  v_rcp_f32 v90, v90
  v_rcp_f32 v91, v91
  s_nop 0
  v_mul_f32 v132, v132, v88
  v_mul_f32 v133, v133, v89
  v_mul_f32 v134, v134, v90
  v_mul_f32 v135, v135, v91
  v_cvt_pk_bf16_f32 v120, 0, v120
  v_cvt_pk_bf16_f32 v121, 0, v121
  v_cvt_pk_bf16_f32 v122, 0, v122
  v_cvt_pk_bf16_f32 v123, 0, v123
  v_cvt_pk_bf16_f32 v124, 0, v124
  v_cvt_pk_bf16_f32 v125, 0, v125
  v_cvt_pk_bf16_f32 v126, 0, v126
  v_cvt_pk_bf16_f32 v127, 0, v127
  v_cvt_pk_bf16_f32 v128, 0, v128
  v_cvt_pk_bf16_f32 v129, 0, v129
  v_cvt_pk_bf16_f32 v130, 0, v130
  v_cvt_pk_bf16_f32 v131, 0, v131
  v_cvt_pk_bf16_f32 v132, 0, v132
  v_cvt_pk_bf16_f32 v133, 0, v133
  v_cvt_pk_bf16_f32 v134, 0, v134
  v_cvt_pk_bf16_f32 v135, 0, v135
  v_cvt_pk_bf16_f32 v72, 0, v72
  v_cvt_pk_bf16_f32 v73, 0, v73
  v_cvt_pk_bf16_f32 v74, 0, v74
  v_cvt_pk_bf16_f32 v75, 0, v75
  v_cvt_pk_bf16_f32 v76, 0, v76
  v_cvt_pk_bf16_f32 v77, 0, v77
  v_cvt_pk_bf16_f32 v78, 0, v78
  v_cvt_pk_bf16_f32 v79, 0, v79
  v_cvt_pk_bf16_f32 v80, 0, v80
  v_cvt_pk_bf16_f32 v81, 0, v81
  v_cvt_pk_bf16_f32 v82, 0, v82
  v_cvt_pk_bf16_f32 v83, 0, v83
  v_cvt_pk_bf16_f32 v84, 0, v84
  v_cvt_pk_bf16_f32 v85, 0, v85
  v_cvt_pk_bf16_f32 v86, 0, v86
  v_cvt_pk_bf16_f32 v87, 0, v87
  v_mul_f32 v72, v72, v120
  v_mul_f32 v73, v73, v121
  v_mul_f32 v74, v74, v122
  v_mul_f32 v75, v75, v123
  v_mul_f32 v76, v76, v124
  v_mul_f32 v77, v77, v125
  v_mul_f32 v78, v78, v126
  v_mul_f32 v79, v79, v127
  v_mul_f32 v80, v80, v128
  v_mul_f32 v81, v81, v129
  v_mul_f32 v82, v82, v130
  v_mul_f32 v83, v83, v131
  v_mul_f32 v84, v84, v132
  v_mul_f32 v85, v85, v133
  v_mul_f32 v86, v86, v134
  v_mul_f32 v87, v87, v135
  v_cvt_pk_bf16_f32 v40, v72, v73
  v_cvt_pk_bf16_f32 v41, v74, v75
  v_cvt_pk_bf16_f32 v42, v76, v77
  v_cvt_pk_bf16_f32 v43, v78, v79
  v_cvt_pk_bf16_f32 v44, v80, v81
  v_cvt_pk_bf16_f32 v45, v82, v83
  v_cvt_pk_bf16_f32 v46, v84, v85
  v_cvt_pk_bf16_f32 v47, v86, v87
  v_add_u32 v3, 14336, v0
  ds_write_b128 v3, v[40:43] offset:0
  ds_write_b128 v3, v[44:47] offset:3072
  s_mov_b32 s44, s28
  s_mov_b32 s45, s29
  s_mov_b32 s46, 1409024
  s_mov_b32 s11, 2752
  s_mov_b32 s12, 1409024
  v_mov_b32 v4, 12288
  v_mov_b32 v5, 13312
  v_lshlrev_b32 v2, 4, v1
  v_add_u32 v2, 1024, v2
  s_call_b64 s[62:63], L_gv
  v_cvt_pk_bf16_f32 v120, 0, v72
  v_cvt_pk_bf16_f32 v121, 0, v73
  v_cvt_pk_bf16_f32 v122, 0, v74
  v_cvt_pk_bf16_f32 v123, 0, v75
  v_cvt_pk_bf16_f32 v124, 0, v76
  v_cvt_pk_bf16_f32 v125, 0, v77
  v_cvt_pk_bf16_f32 v126, 0, v78
  v_cvt_pk_bf16_f32 v127, 0, v79
  v_cvt_pk_bf16_f32 v128, 0, v80
  v_cvt_pk_bf16_f32 v129, 0, v81
  v_cvt_pk_bf16_f32 v130, 0, v82
  v_cvt_pk_bf16_f32 v131, 0, v83
  v_cvt_pk_bf16_f32 v132, 0, v84
  v_cvt_pk_bf16_f32 v133, 0, v85
  v_cvt_pk_bf16_f32 v134, 0, v86
  v_cvt_pk_bf16_f32 v135, 0, v87
  s_mov_b32 s44, s30
  s_mov_b32 s45, s31
  s_mov_b32 s46, 1409024
  s_mov_b32 s11, 2752
  s_mov_b32 s12, 1409024
  v_mov_b32 v4, 12288
  v_mov_b32 v5, 13312
  v_lshlrev_b32 v2, 4, v1
  v_add_u32 v2, 1024, v2
  s_call_b64 s[62:63], L_gv
  v_mul_f32 v88, 0xbfb8aa3b, v120
  v_mul_f32 v89, 0xbfb8aa3b, v121
  v_mul_f32 v90, 0xbfb8aa3b, v122
  v_mul_f32 v91, 0xbfb8aa3b, v123
  v_exp_f32 v88, v88
  v_exp_f32 v89, v89
  v_exp_f32 v90, v90
  v_exp_f32 v91, v91
  s_nop 0
  v_add_f32 v88, 1.0, v88
  v_add_f32 v89, 1.0, v89
  v_add_f32 v90, 1.0, v90
  v_add_f32 v91, 1.0, v91
  v_rcp_f32 v88, v88
  v_rcp_f32 v89, v89
  v_rcp_f32 v90, v90
  v_rcp_f32 v91, v91
  s_nop 0
  v_mul_f32 v120, v120, v88
  v_mul_f32 v121, v121, v89
  v_mul_f32 v122, v122, v90
  v_mul_f32 v123, v123, v91
  v_mul_f32 v88, 0xbfb8aa3b, v124
  v_mul_f32 v89, 0xbfb8aa3b, v125
  v_mul_f32 v90, 0xbfb8aa3b, v126
  v_mul_f32 v91, 0xbfb8aa3b, v127
  v_exp_f32 v88, v88
  v_exp_f32 v89, v89
  v_exp_f32 v90, v90
  v_exp_f32 v91, v91
  s_nop 0
  v_add_f32 v88, 1.0, v88
  v_add_f32 v89, 1.0, v89
  v_add_f32 v90, 1.0, v90
  v_add_f32 v91, 1.0, v91
  v_rcp_f32 v88, v88
  v_rcp_f32 v89, v89
  v_rcp_f32 v90, v90
  v_rcp_f32 v91, v91
  s_nop 0
  v_mul_f32 v124, v124, v88
  v_mul_f32 v125, v125, v89
  v_mul_f32 v126, v126, v90
  v_mul_f32 v127, v127, v91
  v_mul_f32 v88, 0xbfb8aa3b, v128
  v_mul_f32 v89, 0xbfb8aa3b, v129
  v_mul_f32 v90, 0xbfb8aa3b, v130
  v_mul_f32 v91, 0xbfb8aa3b, v131
  v_exp_f32 v88, v88
  v_exp_f32 v89, v89
  v_exp_f32 v90, v90
  v_exp_f32 v91, v91
  s_nop 0
  v_add_f32 v88, 1.0, v88
  v_add_f32 v89, 1.0, v89
  v_add_f32 v90, 1.0, v90
  v_add_f32 v91, 1.0, v91
  v_rcp_f32 v88, v88
  v_rcp_f32 v89, v89
  v_rcp_f32 v90, v90
  v_rcp_f32 v91, v91
  s_nop 0
  v_mul_f32 v128, v128, v88
  v_mul_f32 v129, v129, v89
  v_mul_f32 v130, v130, v90
  v_mul_f32 v131, v131, v91
  v_mul_f32 v88, 0xbfb8aa3b, v132
  v_mul_f32 v89, 0xbfb8aa3b, v133
  v_mul_f32 v90, 0xbfb8aa3b, v134
  v_mul_f32 v91, 0xbfb8aa3b, v135
  v_exp_f32 v88, v88
  v_exp_f32 v89, v89
  v_exp_f32 v90, v90
  v_exp_f32 v91, v91
  s_nop 0
  v_add_f32 v88, 1.0, v88
  v_add_f32 v89, 1.0, v89
  v_add_f32 v90, 1.0, v90
  v_add_f32 v91, 1.0, v91
  v_rcp_f32 v88, v88
  v_rcp_f32 v89, v89
  v_rcp_f32 v90, v90
  v_rcp_f32 v91, v91
  s_nop 0
  v_mul_f32 v132, v132, v88
  v_mul_f32 v133, v133, v89
  v_mul_f32 v134, v134, v90
  v_mul_f32 v135, v135, v91
  v_cvt_pk_bf16_f32 v120, 0, v120
  v_cvt_pk_bf16_f32 v121, 0, v121
  v_cvt_pk_bf16_f32 v122, 0, v122
  v_cvt_pk_bf16_f32 v123, 0, v123
  v_cvt_pk_bf16_f32 v124, 0, v124
  v_cvt_pk_bf16_f32 v125, 0, v125
  v_cvt_pk_bf16_f32 v126, 0, v126
  v_cvt_pk_bf16_f32 v127, 0, v127
  v_cvt_pk_bf16_f32 v128, 0, v128
  v_cvt_pk_bf16_f32 v129, 0, v129
  v_cvt_pk_bf16_f32 v130, 0, v130
  v_cvt_pk_bf16_f32 v131, 0, v131
  v_cvt_pk_bf16_f32 v132, 0, v132
  v_cvt_pk_bf16_f32 v133, 0, v133
  v_cvt_pk_bf16_f32 v134, 0, v134
  v_cvt_pk_bf16_f32 v135, 0, v135
  v_cvt_pk_bf16_f32 v72, 0, v72
  v_cvt_pk_bf16_f32 v73, 0, v73
  v_cvt_pk_bf16_f32 v74, 0, v74
  v_cvt_pk_bf16_f32 v75, 0, v75
  v_cvt_pk_bf16_f32 v76, 0, v76
  v_cvt_pk_bf16_f32 v77, 0, v77
  v_cvt_pk_bf16_f32 v78, 0, v78
  v_cvt_pk_bf16_f32 v79, 0, v79
  v_cvt_pk_bf16_f32 v80, 0, v80
  v_cvt_pk_bf16_f32 v81, 0, v81
  v_cvt_pk_bf16_f32 v82, 0, v82
  v_cvt_pk_bf16_f32 v83, 0, v83
  v_cvt_pk_bf16_f32 v84, 0, v84
  v_cvt_pk_bf16_f32 v85, 0, v85
  v_cvt_pk_bf16_f32 v86, 0, v86
  v_cvt_pk_bf16_f32 v87, 0, v87
  v_mul_f32 v72, v72, v120
  v_mul_f32 v73, v73, v121
  v_mul_f32 v74, v74, v122
  v_mul_f32 v75, v75, v123
  v_mul_f32 v76, v76, v124
  v_mul_f32 v77, v77, v125
  v_mul_f32 v78, v78, v126
  v_mul_f32 v79, v79, v127
  v_mul_f32 v80, v80, v128
  v_mul_f32 v81, v81, v129
  v_mul_f32 v82, v82, v130
  v_mul_f32 v83, v83, v131
  v_mul_f32 v84, v84, v132
  v_mul_f32 v85, v85, v133
  v_mul_f32 v86, v86, v134
  v_mul_f32 v87, v87, v135
  v_cvt_pk_bf16_f32 v40, v72, v73
  v_cvt_pk_bf16_f32 v41, v74, v75
  v_cvt_pk_bf16_f32 v42, v76, v77
  v_cvt_pk_bf16_f32 v43, v78, v79
  v_cvt_pk_bf16_f32 v44, v80, v81
  v_cvt_pk_bf16_f32 v45, v82, v83
  v_cvt_pk_bf16_f32 v46, v84, v85
  v_cvt_pk_bf16_f32 v47, v86, v87
  v_add_u32 v3, 15360, v0
  ds_write_b128 v3, v[40:43] offset:0
  ds_write_b128 v3, v[44:47] offset:3072
  s_mov_b32 s44, s28
  s_mov_b32 s45, s29
  s_mov_b32 s46, 1409024
  s_mov_b32 s11, 2752
  s_mov_b32 s12, 1409024
  v_mov_b32 v4, 12288
  v_mov_b32 v5, 13312
  v_lshlrev_b32 v2, 4, v1
  v_add_u32 v2, 2048, v2
  s_call_b64 s[62:63], L_gv
  v_cvt_pk_bf16_f32 v120, 0, v72
  v_cvt_pk_bf16_f32 v121, 0, v73
  v_cvt_pk_bf16_f32 v122, 0, v74
  v_cvt_pk_bf16_f32 v123, 0, v75
  v_cvt_pk_bf16_f32 v124, 0, v76
  v_cvt_pk_bf16_f32 v125, 0, v77
  v_cvt_pk_bf16_f32 v126, 0, v78
  v_cvt_pk_bf16_f32 v127, 0, v79
  v_cvt_pk_bf16_f32 v128, 0, v80
  v_cvt_pk_bf16_f32 v129, 0, v81
  v_cvt_pk_bf16_f32 v130, 0, v82
  v_cvt_pk_bf16_f32 v131, 0, v83
  v_cvt_pk_bf16_f32 v132, 0, v84
  v_cvt_pk_bf16_f32 v133, 0, v85
  v_cvt_pk_bf16_f32 v134, 0, v86
  v_cvt_pk_bf16_f32 v135, 0, v87
  s_mov_b32 s44, s30
  s_mov_b32 s45, s31
  s_mov_b32 s46, 1409024
  s_mov_b32 s11, 2752
  s_mov_b32 s12, 1409024
  v_mov_b32 v4, 12288
  v_mov_b32 v5, 13312
  v_lshlrev_b32 v2, 4, v1
  v_add_u32 v2, 2048, v2
  s_call_b64 s[62:63], L_gv
  v_mul_f32 v88, 0xbfb8aa3b, v120
  v_mul_f32 v89, 0xbfb8aa3b, v121
  v_mul_f32 v90, 0xbfb8aa3b, v122
  v_mul_f32 v91, 0xbfb8aa3b, v123
  v_exp_f32 v88, v88
  v_exp_f32 v89, v89
  v_exp_f32 v90, v90
  v_exp_f32 v91, v91
  s_nop 0
  v_add_f32 v88, 1.0, v88
  v_add_f32 v89, 1.0, v89
  v_add_f32 v90, 1.0, v90
  v_add_f32 v91, 1.0, v91
  v_rcp_f32 v88, v88
  v_rcp_f32 v89, v89
  v_rcp_f32 v90, v90
  v_rcp_f32 v91, v91
  s_nop 0
  v_mul_f32 v120, v120, v88
  v_mul_f32 v121, v121, v89
  v_mul_f32 v122, v122, v90
  v_mul_f32 v123, v123, v91
  v_mul_f32 v88, 0xbfb8aa3b, v124
  v_mul_f32 v89, 0xbfb8aa3b, v125
  v_mul_f32 v90, 0xbfb8aa3b, v126
  v_mul_f32 v91, 0xbfb8aa3b, v127
  v_exp_f32 v88, v88
  v_exp_f32 v89, v89
  v_exp_f32 v90, v90
  v_exp_f32 v91, v91
  s_nop 0
  v_add_f32 v88, 1.0, v88
  v_add_f32 v89, 1.0, v89
  v_add_f32 v90, 1.0, v90
  v_add_f32 v91, 1.0, v91
  v_rcp_f32 v88, v88
  v_rcp_f32 v89, v89
  v_rcp_f32 v90, v90
  v_rcp_f32 v91, v91
  s_nop 0
  v_mul_f32 v124, v124, v88
  v_mul_f32 v125, v125, v89
  v_mul_f32 v126, v126, v90
  v_mul_f32 v127, v127, v91
  v_mul_f32 v88, 0xbfb8aa3b, v128
  v_mul_f32 v89, 0xbfb8aa3b, v129
  v_mul_f32 v90, 0xbfb8aa3b, v130
  v_mul_f32 v91, 0xbfb8aa3b, v131
  v_exp_f32 v88, v88
  v_exp_f32 v89, v89
  v_exp_f32 v90, v90
  v_exp_f32 v91, v91
  s_nop 0
  v_add_f32 v88, 1.0, v88
  v_add_f32 v89, 1.0, v89
  v_add_f32 v90, 1.0, v90
  v_add_f32 v91, 1.0, v91
  v_rcp_f32 v88, v88
  v_rcp_f32 v89, v89
  v_rcp_f32 v90, v90
  v_rcp_f32 v91, v91
  s_nop 0
  v_mul_f32 v128, v128, v88
  v_mul_f32 v129, v129, v89
  v_mul_f32 v130, v130, v90
  v_mul_f32 v131, v131, v91
  v_mul_f32 v88, 0xbfb8aa3b, v132
  v_mul_f32 v89, 0xbfb8aa3b, v133
  v_mul_f32 v90, 0xbfb8aa3b, v134
  v_mul_f32 v91, 0xbfb8aa3b, v135
  v_exp_f32 v88, v88
  v_exp_f32 v89, v89
  v_exp_f32 v90, v90
  v_exp_f32 v91, v91
  s_nop 0
  v_add_f32 v88, 1.0, v88
  v_add_f32 v89, 1.0, v89
  v_add_f32 v90, 1.0, v90
  v_add_f32 v91, 1.0, v91
  v_rcp_f32 v88, v88
  v_rcp_f32 v89, v89
  v_rcp_f32 v90, v90
  v_rcp_f32 v91, v91
  s_nop 0
  v_mul_f32 v132, v132, v88
  v_mul_f32 v133, v133, v89
  v_mul_f32 v134, v134, v90
  v_mul_f32 v135, v135, v91
  v_cvt_pk_bf16_f32 v120, 0, v120
  v_cvt_pk_bf16_f32 v121, 0, v121
  v_cvt_pk_bf16_f32 v122, 0, v122
  v_cvt_pk_bf16_f32 v123, 0, v123
  v_cvt_pk_bf16_f32 v124, 0, v124
  v_cvt_pk_bf16_f32 v125, 0, v125
  v_cvt_pk_bf16_f32 v126, 0, v126
  v_cvt_pk_bf16_f32 v127, 0, v127
  v_cvt_pk_bf16_f32 v128, 0, v128
  v_cvt_pk_bf16_f32 v129, 0, v129
  v_cvt_pk_bf16_f32 v130, 0, v130
  v_cvt_pk_bf16_f32 v131, 0, v131
  v_cvt_pk_bf16_f32 v132, 0, v132
  v_cvt_pk_bf16_f32 v133, 0, v133
  v_cvt_pk_bf16_f32 v134, 0, v134
  v_cvt_pk_bf16_f32 v135, 0, v135
  v_cvt_pk_bf16_f32 v72, 0, v72
  v_cvt_pk_bf16_f32 v73, 0, v73
  v_cvt_pk_bf16_f32 v74, 0, v74
  v_cvt_pk_bf16_f32 v75, 0, v75
  v_cvt_pk_bf16_f32 v76, 0, v76
  v_cvt_pk_bf16_f32 v77, 0, v77
  v_cvt_pk_bf16_f32 v78, 0, v78
  v_cvt_pk_bf16_f32 v79, 0, v79
  v_cvt_pk_bf16_f32 v80, 0, v80
  v_cvt_pk_bf16_f32 v81, 0, v81
  v_cvt_pk_bf16_f32 v82, 0, v82
  v_cvt_pk_bf16_f32 v83, 0, v83
  v_cvt_pk_bf16_f32 v84, 0, v84
  v_cvt_pk_bf16_f32 v85, 0, v85
  v_cvt_pk_bf16_f32 v86, 0, v86
  v_cvt_pk_bf16_f32 v87, 0, v87
  v_mul_f32 v72, v72, v120
  v_mul_f32 v73, v73, v121
  v_mul_f32 v74, v74, v122
  v_mul_f32 v75, v75, v123
  v_mul_f32 v76, v76, v124
  v_mul_f32 v77, v77, v125
  v_mul_f32 v78, v78, v126
  v_mul_f32 v79, v79, v127
  v_mul_f32 v80, v80, v128
  v_mul_f32 v81, v81, v129
  v_mul_f32 v82, v82, v130
  v_mul_f32 v83, v83, v131
  v_mul_f32 v84, v84, v132
  v_mul_f32 v85, v85, v133
  v_mul_f32 v86, v86, v134
  v_mul_f32 v87, v87, v135
  v_cvt_pk_bf16_f32 v40, v72, v73
  v_cvt_pk_bf16_f32 v41, v74, v75
  v_cvt_pk_bf16_f32 v42, v76, v77
  v_cvt_pk_bf16_f32 v43, v78, v79
  v_cvt_pk_bf16_f32 v44, v80, v81
  v_cvt_pk_bf16_f32 v45, v82, v83
  v_cvt_pk_bf16_f32 v46, v84, v85
  v_cvt_pk_bf16_f32 v47, v86, v87
  v_add_u32 v3, 16384, v0
  ds_write_b128 v3, v[40:43] offset:0
  ds_write_b128 v3, v[44:47] offset:3072
  s_mov_b32 s44, s32
  s_mov_b32 s45, s33
  s_mov_b32 s46, 1409024
  s_mov_b32 s11, 1024
  s_mov_b32 s12, 1409024
  v_mov_b32 v4, 14336
  v_mov_b32 v5, 17408
  v_lshlrev_b32 v2, 4, v1
  s_call_b64 s[62:63], L_gv
  v_lshrrev_b32 v2, 1, v1
  v_lshlrev_b32 v2, 7, v2
  v_and_b32 v3, 1, v1
  v_lshl_add_u32 v2, v3, 5, v2
  v_add_u32 v2, 24576, v2
  global_load_dwordx4 v[40:43], v2, s[42:43] offset:0 sc1
  global_load_dwordx4 v[44:47], v2, s[42:43] offset:16 sc1
  global_load_dwordx4 v[48:51], v2, s[42:43] offset:64 sc1
  global_load_dwordx4 v[52:55], v2, s[42:43] offset:80 sc1
  s_waitcnt vmcnt(0)
  v_lshlrev_b32 v88, 16, v40
  v_and_b32 v89, s73, v40
  v_lshlrev_b32 v90, 16, v42
  v_and_b32 v91, s73, v42
  v_lshlrev_b32 v92, 16, v44
  v_and_b32 v93, s73, v44
  v_lshlrev_b32 v94, 16, v46
  v_and_b32 v95, s73, v46
  v_lshlrev_b32 v96, 16, v48
  v_and_b32 v97, s73, v48
  v_lshlrev_b32 v98, 16, v50
  v_and_b32 v99, s73, v50
  v_lshlrev_b32 v100, 16, v52
  v_and_b32 v101, s73, v52
  v_lshlrev_b32 v102, 16, v54
  v_and_b32 v103, s73, v54
  v_cvt_pk_bf16_f32 v72, 0, v72
  v_cvt_pk_bf16_f32 v73, 0, v73
  v_cvt_pk_bf16_f32 v74, 0, v74
  v_cvt_pk_bf16_f32 v75, 0, v75
  v_cvt_pk_bf16_f32 v76, 0, v76
  v_cvt_pk_bf16_f32 v77, 0, v77
  v_cvt_pk_bf16_f32 v78, 0, v78
  v_cvt_pk_bf16_f32 v79, 0, v79
  v_cvt_pk_bf16_f32 v80, 0, v80
  v_cvt_pk_bf16_f32 v81, 0, v81
  v_cvt_pk_bf16_f32 v82, 0, v82
  v_cvt_pk_bf16_f32 v83, 0, v83
  v_cvt_pk_bf16_f32 v84, 0, v84
  v_cvt_pk_bf16_f32 v85, 0, v85
  v_cvt_pk_bf16_f32 v86, 0, v86
  v_cvt_pk_bf16_f32 v87, 0, v87
  v_mul_f32 v72, v72, v88
  v_mul_f32 v73, v73, v89
  v_mul_f32 v74, v74, v90
  v_mul_f32 v75, v75, v91
  v_mul_f32 v76, v76, v92
  v_mul_f32 v77, v77, v93
  v_mul_f32 v78, v78, v94
  v_mul_f32 v79, v79, v95
  v_mul_f32 v80, v80, v96
  v_mul_f32 v81, v81, v97
  v_mul_f32 v82, v82, v98
  v_mul_f32 v83, v83, v99
  v_mul_f32 v84, v84, v100
  v_mul_f32 v85, v85, v101
  v_mul_f32 v86, v86, v102
  v_mul_f32 v87, v87, v103
  v_cvt_pk_bf16_f32 v72, 0, v72
  v_cvt_pk_bf16_f32 v73, 0, v73
  v_cvt_pk_bf16_f32 v74, 0, v74
  v_cvt_pk_bf16_f32 v75, 0, v75
  v_cvt_pk_bf16_f32 v76, 0, v76
  v_cvt_pk_bf16_f32 v77, 0, v77
  v_cvt_pk_bf16_f32 v78, 0, v78
  v_cvt_pk_bf16_f32 v79, 0, v79
  v_cvt_pk_bf16_f32 v80, 0, v80
  v_cvt_pk_bf16_f32 v81, 0, v81
  v_cvt_pk_bf16_f32 v82, 0, v82
  v_cvt_pk_bf16_f32 v83, 0, v83
  v_cvt_pk_bf16_f32 v84, 0, v84
  v_cvt_pk_bf16_f32 v85, 0, v85
  v_cvt_pk_bf16_f32 v86, 0, v86
  v_cvt_pk_bf16_f32 v87, 0, v87
  v_add_f32 v104, v104, v72
  v_add_f32 v105, v105, v73
  v_add_f32 v106, v106, v74
  v_add_f32 v107, v107, v75
  v_add_f32 v108, v108, v76
  v_add_f32 v109, v109, v77
  v_add_f32 v110, v110, v78
  v_add_f32 v111, v111, v79
  v_add_f32 v112, v112, v80
  v_add_f32 v113, v113, v81
  v_add_f32 v114, v114, v82
  v_add_f32 v115, v115, v83
  v_add_f32 v116, v116, v84
  v_add_f32 v117, v117, v85
  v_add_f32 v118, v118, v86
  v_add_f32 v119, v119, v87
  v_cvt_pk_bf16_f32 v104, 0, v104
  v_cvt_pk_bf16_f32 v105, 0, v105
  v_cvt_pk_bf16_f32 v106, 0, v106
  v_cvt_pk_bf16_f32 v107, 0, v107
  v_cvt_pk_bf16_f32 v108, 0, v108
  v_cvt_pk_bf16_f32 v109, 0, v109
  v_cvt_pk_bf16_f32 v110, 0, v110
  v_cvt_pk_bf16_f32 v111, 0, v111
  v_cvt_pk_bf16_f32 v112, 0, v112
  v_cvt_pk_bf16_f32 v113, 0, v113
  v_cvt_pk_bf16_f32 v114, 0, v114
  v_cvt_pk_bf16_f32 v115, 0, v115
  v_cvt_pk_bf16_f32 v116, 0, v116
  v_cvt_pk_bf16_f32 v117, 0, v117
  v_cvt_pk_bf16_f32 v118, 0, v118
  v_cvt_pk_bf16_f32 v119, 0, v119
  v_cvt_pk_bf16_f32 v40, v104, v105
  v_cvt_pk_bf16_f32 v41, v106, v107
  v_cvt_pk_bf16_f32 v42, v108, v109
  v_cvt_pk_bf16_f32 v43, v110, v111
  v_cvt_pk_bf16_f32 v44, v112, v113
  v_cvt_pk_bf16_f32 v45, v114, v115
  v_cvt_pk_bf16_f32 v46, v116, v117
  v_cvt_pk_bf16_f32 v47, v118, v119
  global_store_dwordx4 v0, v[40:43], s[38:39] offset:0 sc1
  global_store_dwordx4 v0, v[44:47], s[38:39] offset:1024 sc1
  s_endpgm
L_gv:
  v_mov_b32 v72, 0
  v_mov_b32 v73, 0
  v_mov_b32 v74, 0
  v_mov_b32 v75, 0
  v_mov_b32 v76, 0
  v_mov_b32 v77, 0
  v_mov_b32 v78, 0
  v_mov_b32 v79, 0
  v_mov_b32 v80, 0
  v_mov_b32 v81, 0
  v_mov_b32 v82, 0
  v_mov_b32 v83, 0
  v_mov_b32 v84, 0
  v_mov_b32 v85, 0
  v_mov_b32 v86, 0
  v_mov_b32 v87, 0
  s_mov_b32 s10, 0
L_gvl:
  buffer_load_dwordx4 v[40:43], v2, s[44:47], s10 offen
  s_add_u32 s10, s10, s11
  buffer_load_dwordx4 v[44:47], v2, s[44:47], s10 offen
  s_add_u32 s10, s10, s11
  buffer_load_dwordx4 v[48:51], v2, s[44:47], s10 offen
  s_add_u32 s10, s10, s11
  buffer_load_dwordx4 v[52:55], v2, s[44:47], s10 offen
  s_add_u32 s10, s10, s11
  buffer_load_dwordx4 v[56:59], v2, s[44:47], s10 offen
  s_add_u32 s10, s10, s11
  buffer_load_dwordx4 v[60:63], v2, s[44:47], s10 offen
  s_add_u32 s10, s10, s11
  buffer_load_dwordx4 v[64:67], v2, s[44:47], s10 offen
  s_add_u32 s10, s10, s11
  buffer_load_dwordx4 v[68:71], v2, s[44:47], s10 offen
  s_add_u32 s10, s10, s11
  ds_read_b128 v[88:91], v4
  ds_read_b128 v[92:95], v5
  v_add_u32 v4, 16, v4
  v_add_u32 v5, 16, v5
  s_waitcnt lgkmcnt(0)
  v_and_b32 v8, 0xffff, v88
  v_lshlrev_b32 v9, 16, v88
  v_and_b32 v10, 0xffff, v92
  v_lshlrev_b32 v11, 16, v92
  s_waitcnt vmcnt(7)
  v_dot2c_f32_bf16 v72, v8, v40
  v_dot2c_f32_bf16 v73, v9, v40
  v_dot2c_f32_bf16 v74, v8, v41
  v_dot2c_f32_bf16 v75, v9, v41
  v_dot2c_f32_bf16 v76, v8, v42
  v_dot2c_f32_bf16 v77, v9, v42
  v_dot2c_f32_bf16 v78, v8, v43
  v_dot2c_f32_bf16 v79, v9, v43
  v_dot2c_f32_bf16 v80, v10, v40
  v_dot2c_f32_bf16 v81, v11, v40
  v_dot2c_f32_bf16 v82, v10, v41
  v_dot2c_f32_bf16 v83, v11, v41
  v_dot2c_f32_bf16 v84, v10, v42
  v_dot2c_f32_bf16 v85, v11, v42
  v_dot2c_f32_bf16 v86, v10, v43
  v_dot2c_f32_bf16 v87, v11, v43
  v_lshrrev_b32 v8, 16, v88
  v_and_b32 v9, s73, v88
  v_lshrrev_b32 v10, 16, v92
  v_and_b32 v11, s73, v92
  s_waitcnt vmcnt(6)
  v_dot2c_f32_bf16 v72, v8, v44
  v_dot2c_f32_bf16 v73, v9, v44
  v_dot2c_f32_bf16 v74, v8, v45
  v_dot2c_f32_bf16 v75, v9, v45
  v_dot2c_f32_bf16 v76, v8, v46
  v_dot2c_f32_bf16 v77, v9, v46
  v_dot2c_f32_bf16 v78, v8, v47
  v_dot2c_f32_bf16 v79, v9, v47
  v_dot2c_f32_bf16 v80, v10, v44
  v_dot2c_f32_bf16 v81, v11, v44
  v_dot2c_f32_bf16 v82, v10, v45
  v_dot2c_f32_bf16 v83, v11, v45
  v_dot2c_f32_bf16 v84, v10, v46
  v_dot2c_f32_bf16 v85, v11, v46
  v_dot2c_f32_bf16 v86, v10, v47
  v_dot2c_f32_bf16 v87, v11, v47
  v_and_b32 v8, 0xffff, v89
  v_lshlrev_b32 v9, 16, v89
  v_and_b32 v10, 0xffff, v93
  v_lshlrev_b32 v11, 16, v93
  s_waitcnt vmcnt(5)
  v_dot2c_f32_bf16 v72, v8, v48
  v_dot2c_f32_bf16 v73, v9, v48
  v_dot2c_f32_bf16 v74, v8, v49
  v_dot2c_f32_bf16 v75, v9, v49
  v_dot2c_f32_bf16 v76, v8, v50
  v_dot2c_f32_bf16 v77, v9, v50
  v_dot2c_f32_bf16 v78, v8, v51
  v_dot2c_f32_bf16 v79, v9, v51
  v_dot2c_f32_bf16 v80, v10, v48
  v_dot2c_f32_bf16 v81, v11, v48
  v_dot2c_f32_bf16 v82, v10, v49
  v_dot2c_f32_bf16 v83, v11, v49
  v_dot2c_f32_bf16 v84, v10, v50
  v_dot2c_f32_bf16 v85, v11, v50
  v_dot2c_f32_bf16 v86, v10, v51
  v_dot2c_f32_bf16 v87, v11, v51
  v_lshrrev_b32 v8, 16, v89
  v_and_b32 v9, s73, v89
  v_lshrrev_b32 v10, 16, v93
  v_and_b32 v11, s73, v93
  s_waitcnt vmcnt(4)
  v_dot2c_f32_bf16 v72, v8, v52
  v_dot2c_f32_bf16 v73, v9, v52
  v_dot2c_f32_bf16 v74, v8, v53
  v_dot2c_f32_bf16 v75, v9, v53
  v_dot2c_f32_bf16 v76, v8, v54
  v_dot2c_f32_bf16 v77, v9, v54
  v_dot2c_f32_bf16 v78, v8, v55
  v_dot2c_f32_bf16 v79, v9, v55
  v_dot2c_f32_bf16 v80, v10, v52
  v_dot2c_f32_bf16 v81, v11, v52
  v_dot2c_f32_bf16 v82, v10, v53
  v_dot2c_f32_bf16 v83, v11, v53
  v_dot2c_f32_bf16 v84, v10, v54
  v_dot2c_f32_bf16 v85, v11, v54
  v_dot2c_f32_bf16 v86, v10, v55
  v_dot2c_f32_bf16 v87, v11, v55
  v_and_b32 v8, 0xffff, v90
  v_lshlrev_b32 v9, 16, v90
  v_and_b32 v10, 0xffff, v94
  v_lshlrev_b32 v11, 16, v94
  s_waitcnt vmcnt(3)
  v_dot2c_f32_bf16 v72, v8, v56
  v_dot2c_f32_bf16 v73, v9, v56
  v_dot2c_f32_bf16 v74, v8, v57
  v_dot2c_f32_bf16 v75, v9, v57
  v_dot2c_f32_bf16 v76, v8, v58
  v_dot2c_f32_bf16 v77, v9, v58
  v_dot2c_f32_bf16 v78, v8, v59
  v_dot2c_f32_bf16 v79, v9, v59
  v_dot2c_f32_bf16 v80, v10, v56
  v_dot2c_f32_bf16 v81, v11, v56
  v_dot2c_f32_bf16 v82, v10, v57
  v_dot2c_f32_bf16 v83, v11, v57
  v_dot2c_f32_bf16 v84, v10, v58
  v_dot2c_f32_bf16 v85, v11, v58
  v_dot2c_f32_bf16 v86, v10, v59
  v_dot2c_f32_bf16 v87, v11, v59
  v_lshrrev_b32 v8, 16, v90
  v_and_b32 v9, s73, v90
  v_lshrrev_b32 v10, 16, v94
  v_and_b32 v11, s73, v94
  s_waitcnt vmcnt(2)
  v_dot2c_f32_bf16 v72, v8, v60
  v_dot2c_f32_bf16 v73, v9, v60
  v_dot2c_f32_bf16 v74, v8, v61
  v_dot2c_f32_bf16 v75, v9, v61
  v_dot2c_f32_bf16 v76, v8, v62
  v_dot2c_f32_bf16 v77, v9, v62
  v_dot2c_f32_bf16 v78, v8, v63
  v_dot2c_f32_bf16 v79, v9, v63
  v_dot2c_f32_bf16 v80, v10, v60
  v_dot2c_f32_bf16 v81, v11, v60
  v_dot2c_f32_bf16 v82, v10, v61
  v_dot2c_f32_bf16 v83, v11, v61
  v_dot2c_f32_bf16 v84, v10, v62
  v_dot2c_f32_bf16 v85, v11, v62
  v_dot2c_f32_bf16 v86, v10, v63
  v_dot2c_f32_bf16 v87, v11, v63
  v_and_b32 v8, 0xffff, v91
  v_lshlrev_b32 v9, 16, v91
  v_and_b32 v10, 0xffff, v95
  v_lshlrev_b32 v11, 16, v95
  s_waitcnt vmcnt(1)
  v_dot2c_f32_bf16 v72, v8, v64
  v_dot2c_f32_bf16 v73, v9, v64
  v_dot2c_f32_bf16 v74, v8, v65
  v_dot2c_f32_bf16 v75, v9, v65
  v_dot2c_f32_bf16 v76, v8, v66
  v_dot2c_f32_bf16 v77, v9, v66
  v_dot2c_f32_bf16 v78, v8, v67
  v_dot2c_f32_bf16 v79, v9, v67
  v_dot2c_f32_bf16 v80, v10, v64
  v_dot2c_f32_bf16 v81, v11, v64
  v_dot2c_f32_bf16 v82, v10, v65
  v_dot2c_f32_bf16 v83, v11, v65
  v_dot2c_f32_bf16 v84, v10, v66
  v_dot2c_f32_bf16 v85, v11, v66
  v_dot2c_f32_bf16 v86, v10, v67
  v_dot2c_f32_bf16 v87, v11, v67
  v_lshrrev_b32 v8, 16, v91
  v_and_b32 v9, s73, v91
  v_lshrrev_b32 v10, 16, v95
  v_and_b32 v11, s73, v95
  s_waitcnt vmcnt(0)
  v_dot2c_f32_bf16 v72, v8, v68
  v_dot2c_f32_bf16 v73, v9, v68
  v_dot2c_f32_bf16 v74, v8, v69
  v_dot2c_f32_bf16 v75, v9, v69
  v_dot2c_f32_bf16 v76, v8, v70
  v_dot2c_f32_bf16 v77, v9, v70
  v_dot2c_f32_bf16 v78, v8, v71
  v_dot2c_f32_bf16 v79, v9, v71
  v_dot2c_f32_bf16 v80, v10, v68
  v_dot2c_f32_bf16 v81, v11, v68
  v_dot2c_f32_bf16 v82, v10, v69
  v_dot2c_f32_bf16 v83, v11, v69
  v_dot2c_f32_bf16 v84, v10, v70
  v_dot2c_f32_bf16 v85, v11, v70
  v_dot2c_f32_bf16 v86, v10, v71
  v_dot2c_f32_bf16 v87, v11, v71
  s_cmp_lt_u32 s10, s12
  s_cbranch_scc1 L_gvl
  s_nop 1
  s_setpc_b64 s[62:63]
L_serv:
  s_cmp_ge_u32 s13, 4
  s_cbranch_scc1 L_team
  s_cmp_ge_u32 s13, 2
  s_cbranch_scc1 L_end
  v_mov_b32 v38, 0
  v_mov_b32 v4, -1
  v_mov_b32 v5, 0
  v_mov_b32 v6, 0
  v_mov_b32 v7, 0
  ds_write_b128 v38, v[4:7] offset:256
  ds_write_b64 v38, v[6:7] offset:312
  s_getreg_b32 s76, hwreg(HW_REG_XCC_ID, 0, 4)
  s_waitcnt lgkmcnt(0)
  s_load_dword s74, s[42:43], 0
  s_getpc_b64 s[56:57]
L_pc_28:
  s_lshr_b32 s3, s2, 5
  s_lshl3_add_u32 s3, s3, s8
  s_lshl_b32 s3, s3, 2
  s_add_u32 s3, s3, L_table-L_pc_28
  s_load_dword s14, s[56:57], s3
  s_barrier
  s_waitcnt lgkmcnt(0)
  s_mul_i32 s74, s74, 0x9e3779b1
  s_add_u32 s74, s74, 0x7f4a7c15
  s_bfe_u32 s32, s74, 0x80000
  s_bfe_u32 s33, s74, 0x80008
  s_bfe_u32 s34, s74, 0x80010
  s_bfe_u32 s35, s74, 0x80018
  s_cmp_eq_u32 s13, 0
  s_cbranch_scc1 L_sv0
  s_bfe_u32 s61, s14, 0x80010
  s_cmp_ge_u32 s61, 32
  s_cbranch_scc1 L_fin
  s_mov_b32 s70, 0
L_pl_29:
  ds_read_b32 v8, v38 offset:256
  s_waitcnt lgkmcnt(0)
  v_cmp_eq_u32 vcc, -1, v8
  s_cmp_eq_u64 vcc, 0
  s_cbranch_scc1 L_pld_30
  s_sleep 16
  s_add_u32 s70, s70, 1
  s_cmp_lt_u32 s70, 1048576
  s_cbranch_scc1 L_pl_29
L_pld_30:
  s_branch L_r_f2
L_sv0:
  s_add_u32 s76, s76, s74
  s_lshr_b32 s49, s2, 5
  s_lshl_b32 s50, s8, 5
  s_add_u32 s49, s49, s50
  s_lshl_b32 s49, s49, 2
  v_mov_b32 v8, s49
  v_mov_b32 v9, s76
  s_mov_b64 exec, 1
  global_store_dword v8, v9, s[42:43] offset:1024 sc1
  s_mov_b64 exec, -1
  s_lshl_b32 s54, s6, 9
  s_add_u32 s54, s54, 0
  s_lshl_b32 s55, s6, 9
  s_add_u32 s55, s55, 128
  s_lshl_b32 s56, s6, 9
  s_add_u32 s56, s56, 256
  s_mov_b32 s70, 0
L_sn_31:
  ds_read_b32 v8, v38 offset:312
  s_waitcnt lgkmcnt(0)
  v_cmp_gt_u32 vcc, 0x8, v8
  s_cmp_eq_u64 vcc, 0
  s_cbranch_scc1 L_snd_32
  s_sleep 16
  s_add_u32 s70, s70, 1
  s_cmp_lt_u32 s70, 2097152
  s_cbranch_scc1 L_sn_31
L_snd_32:
  s_load_dwordx2 s[20:21], s[42:43], s54 offset:65536 glc
  s_mov_b32 s70, 0
  s_branch L_s3wc
L_s3w:
  s_load_dwordx2 s[20:21], s[42:43], s54 offset:65536 glc
L_s3wc:
  s_waitcnt lgkmcnt(0)
  s_xor_b32 s68, s21, s74
  s_cbranch_scc0 L_s3wd
  s_sleep 8
  s_add_u32 s70, s70, 1
  s_cmp_lt_u32 s70, 262144
  s_cbranch_scc1 L_s3w
L_s3wd:
  v_mov_b32 v8, 1
  ds_write_b32 v38, v8 offset:260
  s_mov_b32 s70, 0
L_sn_33:
  ds_read_b32 v8, v38 offset:312
  s_waitcnt lgkmcnt(0)
  v_cmp_gt_u32 vcc, 0xc, v8
  s_cmp_eq_u64 vcc, 0
  s_cbranch_scc1 L_snd_34
  s_sleep 16
  s_add_u32 s70, s70, 1
  s_cmp_lt_u32 s70, 2097152
  s_cbranch_scc1 L_sn_33
L_snd_34:
  s_load_dwordx2 s[20:21], s[42:43], s54 offset:98304 glc
  s_load_dwordx2 s[24:25], s[42:43], s55 offset:98304 glc
  s_load_dwordx2 s[28:29], s[42:43], s56 offset:98304 glc
  s_mov_b32 s70, 0
  s_branch L_s3sc
L_s3s:
  s_load_dwordx2 s[20:21], s[42:43], s54 offset:98304 glc
  s_load_dwordx2 s[24:25], s[42:43], s55 offset:98304 glc
  s_load_dwordx2 s[28:29], s[42:43], s56 offset:98304 glc
L_s3sc:
  s_waitcnt lgkmcnt(0)
  s_xor_b32 s68, s21, s74
  s_xor_b32 s69, s25, s74
  s_or_b32 s68, s68, s69
  s_xor_b32 s69, s29, s74
  s_or_b32 s68, s68, s69
  s_cbranch_scc0 L_s3sd
  s_sleep 8
  s_add_u32 s70, s70, 1
  s_cmp_lt_u32 s70, 262144
  s_cbranch_scc1 L_s3s
L_s3sd:
  ds_write_b32 v38, v38 offset:256
  s_branch L_fin
L_team:
  s_and_b32 s5, s13, 3
  v_and_b32 v0, 0xff, v0
  v_mov_b32 v38, 0
  s_mov_b32 s77, 0
  s_lshr_b32 s60, s2, 5
  v_lshrrev_b32 v12, 3, v0
  v_lshlrev_b32 v12, 5, v12
  v_bfe_u32 v3, v1, 2, 1
  v_lshl_add_u32 v12, v3, 10, v12
  v_and_b32 v8, 3, v1
  v_lshl_add_u32 v37, v8, 3, v12
  v_and_b32 v12, 0xffffffdf, v12
  v_lshl_add_u32 v12, v8, 4, v12
  v_bfe_u32 v8, v1, 3, 1
  v_lshl_add_u32 v12, v8, 3, v12
  v_lshl_add_u32 v12, v3, 5, v12
  s_waitcnt lgkmcnt(0)
  s_load_dword s74, s[42:43], 0
  s_barrier
  s_cmp_ge_u32 s13, 8
  s_cbranch_scc1 L_r_mod
L_r_q:
  s_lshl3_add_u32 s61, s8, s60
  s_lshl_b32 s48, s61, 7
  s_lshl_b32 s58, s61, 8
  s_add_u32 s58, s58, 32768
  global_load_dwordx2 v[14:15], v37, s[16:17]
  s_mov_b32 s44, s22
  s_mov_b32 s45, s23
  s_mov_b32 s46, 4194304
  s_mov_b32 s47, 0x20000
  s_cmp_ge_u32 s60, 2
  s_cbranch_scc1 L_q_go
  s_mov_b32 s70, 0
L_sn_35:
  ds_read_b32 v8, v38 offset:268
  s_waitcnt lgkmcnt(0)
  v_cmp_gt_u32 vcc, 0x4, v8
  s_cmp_eq_u64 vcc, 0
  s_cbranch_scc1 L_snd_36
  s_sleep 1
  s_add_u32 s70, s70, 1
  s_cmp_lt_u32 s70, 2097152
  s_cbranch_scc1 L_sn_35
L_snd_36:
L_q_go:
  v_lshrrev_b32 v2, 3, v1
  v_and_b32 v3, 6, v2
  v_xor_b32 v3, v3, v1
  v_mul_u32_u24 v2, 8192, v2
  v_and_b32 v3, 7, v3
  v_lshl_add_u32 v2, v3, 4, v2
  s_mul_i32 s49, s5, 1048576
  s_lshl_b32 s50, s5, 14
  s_add_u32 s49, s49, s48
  s_add_u32 s50, s50, 12288
  s_add_u32 s51, s50, 16384
L_dma_37:
  s_mov_b32 m0, s50
  s_add_u32 s50, s50, 1024
  buffer_load_dwordx4 v2, s[44:47], s49 offen nt lds
  s_add_u32 s49, s49, 65536
  s_cmp_lt_u32 s50, s51
  s_cbranch_scc1 L_dma_37
L_dmae_38:
  v_mov_b32 v3, 1
  s_mov_b64 exec, 1
  ds_add_u32 v38, v3 offset:264
  s_mov_b64 exec, -1
  s_waitcnt lgkmcnt(0)
  s_mul_i32 s74, s74, 0x9e3779b1
  s_add_u32 s74, s74, 0x7f4a7c15
  v_bfe_u32 v6, v1, 2, 1
  v_lshlrev_b32 v6, 5, v6
  v_add_u32 v6, 3136, v6
  s_lshl_b32 s49, s5, 3
  v_add_u32 v5, s49, v6
  s_waitcnt vmcnt(16)
  v_lshlrev_b32 v20, 16, v14
  v_and_b32 v21, s73, v14
  v_lshlrev_b32 v22, 16, v15
  v_and_b32 v23, s73, v15
  v_add_f32 v8, v20, v21
  v_mul_f32 v9, v20, v20
  v_add_f32 v10, v22, v23
  v_mul_f32 v11, v22, v22
  v_fmac_f32 v9, v21, v21
  v_fmac_f32 v11, v23, v23
  v_add_f32 v8, v8, v10
  v_add_f32 v9, v9, v11
  s_nop 0
  v_add_f32_dpp v8, v8, v8 quad_perm:[1,0,3,2] row_mask:0xf bank_mask:0xf
  v_add_f32_dpp v9, v9, v9 quad_perm:[1,0,3,2] row_mask:0xf bank_mask:0xf
  s_nop 0
  v_add_f32_dpp v8, v8, v8 quad_perm:[2,3,0,1] row_mask:0xf bank_mask:0xf
  v_add_f32_dpp v9, v9, v9 quad_perm:[2,3,0,1] row_mask:0xf bank_mask:0xf
  s_nop 0
  v_add_f32_dpp v8, v8, v8 row_ror:8 row_mask:0xf bank_mask:0xf
  v_add_f32_dpp v9, v9, v9 row_ror:8 row_mask:0xf bank_mask:0xf
  s_nop 0
  v_mov_b32 v10, v8
  v_mov_b32 v11, v9
  s_nop 0
  v_permlane16_swap_b32 v10, v8
  v_permlane16_swap_b32 v11, v9
  v_add_f32 v8, v8, v10
  v_add_f32 v9, v9, v11
  v_mov_b32 v10, v8
  v_mov_b32 v11, v9
  s_nop 0
  v_permlane32_swap_b32 v10, v8
  v_permlane32_swap_b32 v11, v9
  v_add_f32 v8, v8, v10
  v_add_f32 v9, v9, v11
  ds_write_b64 v5, v[8:9]
  s_waitcnt vmcnt(0) lgkmcnt(0)
  s_add_u32 s77, s77, 4
  v_mov_b32 v9, 1
  s_mov_b64 exec, 1
  ds_add_u32 v38, v9 offset:312
  s_mov_b64 exec, -1
  s_mov_b32 s70, 0
L_hy_39:
  ds_read_b32 v9, v38 offset:312
  s_waitcnt lgkmcnt(0)
  v_cmp_gt_u32 vcc, s77, v9
  s_cmp_eq_u64 vcc, 0
  s_cbranch_scc1 L_hyd_40
  s_add_u32 s70, s70, 1
  s_cmp_lt_u32 s70, 2097152
  s_cbranch_scc1 L_hy_39
L_hyd_40:
  ds_read_b128 v[24:27], v6
  ds_read_b128 v[28:31], v6 offset:16
  s_waitcnt lgkmcnt(0)
  v_pk_add_f32 v[24:25], v[24:25], v[26:27]
  v_pk_add_f32 v[28:29], v[28:29], v[30:31]
  v_pk_add_f32 v[24:25], v[24:25], v[28:29]
  v_mul_f32 v8, 0x3b000000, v24
  v_mul_f32 v9, 0x3b000000, v25
  v_fma_f32 v9, -v8, v8, v9
  v_cvt_pk_bf16_f32 v8, 0, v8
  v_max_f32 v9, 0, v9
  v_cvt_pk_bf16_f32 v9, 0, v9
  v_sub_f32 v20, v20, v8
  v_sub_f32 v21, v21, v8
  v_add_f32 v9, 0x3727c5ac, v9
  v_sub_f32 v22, v22, v8
  v_sub_f32 v23, v23, v8
  v_cvt_pk_bf16_f32 v9, 0, v9
  v_cvt_pk_bf16_f32 v20, 0, v20
  v_sqrt_f32 v9, v9
  v_cvt_pk_bf16_f32 v21, 0, v21
  v_cvt_pk_bf16_f32 v9, 0, v9
  v_cvt_pk_bf16_f32 v22, 0, v22
  v_rcp_f32 v9, v9
  v_cvt_pk_bf16_f32 v23, 0, v23
  v_mul_f32 v20, v20, v9
  v_mul_f32 v21, v21, v9
  v_mul_f32 v22, v22, v9
  v_mul_f32 v23, v23, v9
  v_cvt_pk_bf16_f32 v20, 0, v20
  v_cvt_pk_bf16_f32 v21, 0, v21
  v_cvt_pk_bf16_f32 v22, 0, v22
  v_cvt_pk_bf16_f32 v23, 0, v23
  s_lshl_b32 s49, s8, 13
  s_add_u32 s49, s49, 917504
  v_lshl_add_u32 v15, v0, 4, s49
  v_add_u32 v36, 0x1000, v15
  s_mov_b64 s[64:65], -1
  s_mov_b64 s[66:67], -1
  s_mov_b64 exec, s[64:65]
  global_load_dwordx4 v[16:19], v15, s[42:43] sc1
  s_mov_b64 exec, s[66:67]
  global_load_dwordx4 v[32:35], v36, s[42:43] sc1
  s_mov_b64 exec, -1
  v_lshrrev_b32 v2, 2, v1
  v_bfe_u32 v3, v1, 1, 1
  s_lshl_b32 s49, s5, 1
  v_or_b32 v3, s49, v3
  v_and_b32 v10, 6, v2
  v_xor_b32 v3, v3, v10
  v_lshlrev_b32 v2, 7, v2
  v_lshl_add_u32 v2, v3, 4, v2
  v_and_b32 v3, 1, v1
  v_lshl_add_u32 v2, v3, 3, v2
  v_add_u32 v2, 12288, v2
  ds_read_b64_tr_b16 v[40:41], v2 offset:0
  ds_read_b64_tr_b16 v[42:43], v2 offset:2048
  ds_read_b64_tr_b16 v[44:45], v2 offset:4096
  ds_read_b64_tr_b16 v[46:47], v2 offset:6144
  ds_read_b64_tr_b16 v[48:49], v2 offset:8192
  ds_read_b64_tr_b16 v[50:51], v2 offset:10240
  ds_read_b64_tr_b16 v[52:53], v2 offset:12288
  ds_read_b64_tr_b16 v[54:55], v2 offset:14336
  ds_read_b64_tr_b16 v[56:57], v2 offset:16384
  ds_read_b64_tr_b16 v[58:59], v2 offset:18432
  ds_read_b64_tr_b16 v[60:61], v2 offset:20480
  ds_read_b64_tr_b16 v[62:63], v2 offset:22528
  s_waitcnt lgkmcnt(10)
  ds_read_b64_tr_b16 v[64:65], v2 offset:24576
  ds_read_b64_tr_b16 v[66:67], v2 offset:26624
  s_waitcnt lgkmcnt(10)
  ds_read_b64_tr_b16 v[68:69], v2 offset:28672
  ds_read_b64_tr_b16 v[70:71], v2 offset:30720
  s_waitcnt lgkmcnt(10)
  ds_read_b64_tr_b16 v[72:73], v2 offset:32768
  ds_read_b64_tr_b16 v[74:75], v2 offset:34816
  s_waitcnt lgkmcnt(10)
  ds_read_b64_tr_b16 v[76:77], v2 offset:36864
  ds_read_b64_tr_b16 v[78:79], v2 offset:38912
  s_waitcnt lgkmcnt(10)
  ds_read_b64_tr_b16 v[80:81], v2 offset:40960
  ds_read_b64_tr_b16 v[82:83], v2 offset:43008
  s_waitcnt lgkmcnt(10)
  ds_read_b64_tr_b16 v[84:85], v2 offset:45056
  ds_read_b64_tr_b16 v[86:87], v2 offset:47104
  s_waitcnt lgkmcnt(10)
  ds_read_b64_tr_b16 v[88:89], v2 offset:49152
  ds_read_b64_tr_b16 v[90:91], v2 offset:51200
  s_waitcnt lgkmcnt(10)
  ds_read_b64_tr_b16 v[92:93], v2 offset:53248
  ds_read_b64_tr_b16 v[94:95], v2 offset:55296
  s_waitcnt lgkmcnt(10)
  ds_read_b64_tr_b16 v[96:97], v2 offset:57344
  ds_read_b64_tr_b16 v[98:99], v2 offset:59392
  s_waitcnt lgkmcnt(10)
  ds_read_b64_tr_b16 v[100:101], v2 offset:61440
  ds_read_b64_tr_b16 v[102:103], v2 offset:63488
  s_waitcnt lgkmcnt(10)
  s_waitcnt lgkmcnt(0)
  v_and_b32 v13, 1, v1
  v_lshlrev_b32 v13, 14, v13
  v_lshrrev_b32 v3, 4, v1
  v_lshl_add_u32 v13, v3, 4, v13
  s_lshl_b32 s49, s5, 6
  s_add_u32 s49, s49, s58
  v_add_u32 v13, s49, v13
  v_and_b32 v14, 1, v1
  v_mul_u32_u24 v14, 1056, v14
  v_lshrrev_b32 v3, 4, v1
  v_lshl_add_u32 v14, v3, 4, v14
  v_add_u32 v14, 1024, v14
  s_mov_b32 s70, 0
  s_branch L_q_c
L_q_p:
  s_mov_b64 exec, s[64:65]
  global_load_dwordx4 v[16:19], v15, s[42:43] sc1
  s_mov_b64 exec, s[66:67]
  global_load_dwordx4 v[32:35], v36, s[42:43] sc1
  s_mov_b64 exec, -1
L_q_c:
  s_waitcnt vmcnt(0)
  v_cmp_ne_u32 s[64:65], s74, v17
  v_cmp_ne_u32 s[68:69], s74, v19
  s_or_b64 s[64:65], s[64:65], s[68:69]
  v_cmp_ne_u32 s[66:67], s74, v33
  v_cmp_ne_u32 s[68:69], s74, v35
  s_or_b64 s[66:67], s[66:67], s[68:69]
  s_or_b64 vcc, s[64:65], s[66:67]
  s_or_b32 s64, s64, 1
  s_or_b32 s66, s66, 1
  s_cmp_eq_u64 vcc, 0
  s_cbranch_scc1 L_q_ok
  s_sleep 2
  s_add_u32 s70, s70, 1
  s_cmp_lt_u32 s70, 262144
  s_cbranch_scc1 L_q_p
L_q_ok:
  v_lshlrev_b32 v28, 16, v32
  v_and_b32 v29, s73, v32
  v_lshlrev_b32 v30, 16, v34
  v_and_b32 v31, s73, v34
  v_lshlrev_b32 v24, 16, v16
  v_and_b32 v25, s73, v16
  v_lshlrev_b32 v26, 16, v18
  v_and_b32 v27, s73, v18
  v_add_f32 v28, 1.0, v28
  v_add_f32 v29, 1.0, v29
  v_add_f32 v30, 1.0, v30
  v_add_f32 v31, 1.0, v31
  v_cvt_pk_bf16_f32 v28, 0, v28
  v_cvt_pk_bf16_f32 v29, 0, v29
  v_cvt_pk_bf16_f32 v30, 0, v30
  v_cvt_pk_bf16_f32 v31, 0, v31
  v_mul_f32 v20, v20, v28
  v_mul_f32 v21, v21, v29
  v_mul_f32 v22, v22, v30
  v_mul_f32 v23, v23, v31
  v_cvt_pk_bf16_f32 v20, 0, v20
  v_cvt_pk_bf16_f32 v21, 0, v21
  v_cvt_pk_bf16_f32 v22, 0, v22
  v_cvt_pk_bf16_f32 v23, 0, v23
  v_add_f32 v20, v20, v24
  v_add_f32 v21, v21, v25
  v_add_f32 v22, v22, v26
  v_add_f32 v23, v23, v27
  v_cvt_pk_bf16_f32 v16, v20, v21
  v_cvt_pk_bf16_f32 v17, v22, v23
  ds_write_b64 v12, v[16:17] offset:1024
  s_add_u32 s77, s77, 4
  v_mov_b32 v9, 1
  s_mov_b64 exec, 1
  ds_add_u32 v38, v9 offset:312
  s_mov_b64 exec, -1
  s_mov_b32 s70, 0
L_hy_41:
  ds_read_b32 v9, v38 offset:312
  s_waitcnt lgkmcnt(0)
  v_cmp_gt_u32 vcc, s77, v9
  s_cmp_eq_u64 vcc, 0
  s_cbranch_scc1 L_hyd_42
  s_add_u32 s70, s70, 1
  s_cmp_lt_u32 s70, 2097152
  s_cbranch_scc1 L_hy_41
L_hyd_42:
  ds_read_b128 v[104:107], v14 offset:0
  ds_read_b128 v[108:111], v14 offset:64
  ds_read_b128 v[112:115], v14 offset:128
  ds_read_b128 v[116:119], v14 offset:192
  ds_read_b128 v[120:123], v14 offset:256
  ds_read_b128 v[124:127], v14 offset:320
  ds_read_b128 v[128:131], v14 offset:384
  ds_read_b128 v[132:135], v14 offset:448
  ds_read_b128 v[136:139], v14 offset:512
  ds_read_b128 v[140:143], v14 offset:576
  ds_read_b128 v[144:147], v14 offset:640
  ds_read_b128 v[148:151], v14 offset:704
  s_waitcnt lgkmcnt(11)
  v_mfma_f32_16x16x32_bf16 v[8:11], v[40:43], v[104:107], 0
  ds_read_b128 v[152:155], v14 offset:768
  s_waitcnt lgkmcnt(11)
  v_mfma_f32_16x16x32_bf16 v[8:11], v[44:47], v[108:111], v[8:11]
  ds_read_b128 v[156:159], v14 offset:832
  s_waitcnt lgkmcnt(11)
  v_mfma_f32_16x16x32_bf16 v[8:11], v[48:51], v[112:115], v[8:11]
  ds_read_b128 v[160:163], v14 offset:896
  s_waitcnt lgkmcnt(11)
  v_mfma_f32_16x16x32_bf16 v[8:11], v[52:55], v[116:119], v[8:11]
  ds_read_b128 v[164:167], v14 offset:960
  s_waitcnt lgkmcnt(11)
  v_mfma_f32_16x16x32_bf16 v[8:11], v[56:59], v[120:123], v[8:11]
  s_waitcnt lgkmcnt(10)
  v_mfma_f32_16x16x32_bf16 v[8:11], v[60:63], v[124:127], v[8:11]
  s_waitcnt lgkmcnt(9)
  v_mfma_f32_16x16x32_bf16 v[8:11], v[64:67], v[128:131], v[8:11]
  s_waitcnt lgkmcnt(8)
  v_mfma_f32_16x16x32_bf16 v[8:11], v[68:71], v[132:135], v[8:11]
  s_waitcnt lgkmcnt(7)
  v_mfma_f32_16x16x32_bf16 v[8:11], v[72:75], v[136:139], v[8:11]
  s_waitcnt lgkmcnt(6)
  v_mfma_f32_16x16x32_bf16 v[8:11], v[76:79], v[140:143], v[8:11]
  s_waitcnt lgkmcnt(5)
  v_mfma_f32_16x16x32_bf16 v[8:11], v[80:83], v[144:147], v[8:11]
  s_waitcnt lgkmcnt(4)
  v_mfma_f32_16x16x32_bf16 v[8:11], v[84:87], v[148:151], v[8:11]
  s_waitcnt lgkmcnt(3)
  v_mfma_f32_16x16x32_bf16 v[8:11], v[88:91], v[152:155], v[8:11]
  s_waitcnt lgkmcnt(2)
  v_mfma_f32_16x16x32_bf16 v[8:11], v[92:95], v[156:159], v[8:11]
  s_waitcnt lgkmcnt(1)
  v_mfma_f32_16x16x32_bf16 v[8:11], v[96:99], v[160:163], v[8:11]
  s_waitcnt lgkmcnt(0)
  v_mfma_f32_16x16x32_bf16 v[8:11], v[100:103], v[164:167], v[8:11]
  s_nop 7
  v_cvt_pk_bf16_f32 v8, v8, v9
  v_cvt_pk_bf16_f32 v10, v10, v11
  v_mov_b32 v9, s74
  v_mov_b32 v11, s74
  v_min_u32 v8, s72, v8
  v_min_u32 v10, s72, v10
  s_mov_b32 exec_lo, 0x00030003
  s_mov_b32 exec_hi, 0x00030003
  global_store_dwordx4 v13, v[8:11], s[42:43] sc1
  s_mov_b64 exec, -1
L_r_wo:
  s_xor_b32 s61, s60, 1
  s_lshl_b32 s48, s8, 19
  s_lshl_b32 s49, s61, 7
  s_add_u32 s48, s48, s49
  s_lshr_b32 s58, s8, 1
  s_lshl_b32 s58, s58, 14
  s_and_b32 s49, s8, 1
  s_lshl_b32 s49, s49, 12
  s_add_u32 s58, s58, s49
  s_lshl_b32 s49, s61, 9
  s_add_u32 s58, s58, s49
  s_add_u32 s58, s58, 2097152
  s_mov_b32 s44, s24
  s_mov_b32 s45, s25
  s_mov_b32 s46, 4194304
  s_mov_b32 s47, 0x20000
  v_lshrrev_b32 v2, 3, v1
  v_and_b32 v3, 6, v2
  v_xor_b32 v3, v3, v1
  v_mul_u32_u24 v2, 1024, v2
  v_and_b32 v3, 7, v3
  v_lshl_add_u32 v2, v3, 4, v2
  s_mul_i32 s49, s5, 131072
  s_lshl_b32 s50, s5, 14
  s_add_u32 s49, s49, s48
  s_add_u32 s50, s50, 12288
  s_add_u32 s51, s50, 16384
L_dma_43:
  s_mov_b32 m0, s50
  s_add_u32 s50, s50, 1024
  buffer_load_dwordx4 v2, s[44:47], s49 offen nt lds
  s_add_u32 s49, s49, 8192
  s_waitcnt vmcnt(2)
  s_cmp_lt_u32 s50, s51
  s_cbranch_scc1 L_dma_43
L_dmae_44:
  s_bfe_u32 s32, s74, 0x80000
  s_bfe_u32 s33, s74, 0x80008
  s_bfe_u32 s34, s74, 0x80010
  s_bfe_u32 s35, s74, 0x80018
  s_lshl2_add_u32 s49, s8, s5
  s_lshl_b32 s49, s49, 11
  s_add_u32 s49, s49, 131072
  v_lshrrev_b32 v12, 5, v1
  v_and_b32 v16, 31, v1
  v_lshlrev_b32 v15, 16, v12
  v_lshl_add_u32 v15, v16, 4, v15
  v_add_u32 v15, s49, v15
  v_mul_u32_u24 v12, 1056, v12
  v_bfe_u32 v16, v1, 3, 2
  v_lshl_add_u32 v12, v16, 6, v12
  v_and_b32 v16, 3, v1
  v_lshl_add_u32 v12, v16, 4, v12
  v_bfe_u32 v16, v1, 2, 1
  v_lshl_add_u32 v12, v16, 3, v12
  s_lshl_b32 s49, s5, 8
  v_add_u32 v12, s49, v12
  v_and_b32 v13, 1, v1
  v_lshlrev_b32 v13, 6, v13
  v_lshrrev_b32 v3, 4, v1
  v_lshl_add_u32 v13, v3, 4, v13
  s_lshl_b32 s49, s5, 7
  s_add_u32 s49, s49, s58
  v_add_u32 v13, s49, v13
  v_bfe_u32 v3, v1, 1, 1
  v_lshl_add_u32 v13, v3, 16, v13
  v_mov_b32 v36, 0xff
  global_load_dword v11, v13, s[42:43] sc1
  s_waitcnt vmcnt(0)
  s_add_u32 s77, s77, 4
  v_mov_b32 v9, 1
  s_mov_b64 exec, 1
  ds_add_u32 v38, v9 offset:312
  s_mov_b64 exec, -1
  s_mov_b32 s70, 0
L_hy_45:
  ds_read_b32 v9, v38 offset:312
  s_waitcnt lgkmcnt(0)
  v_cmp_gt_u32 vcc, s77, v9
  s_cmp_eq_u64 vcc, 0
  s_cbranch_scc1 L_hyd_46
  s_sleep 4
  s_add_u32 s70, s70, 1
  s_cmp_lt_u32 s70, 2097152
  s_cbranch_scc1 L_hy_45
L_hyd_46:
  v_lshrrev_b32 v2, 2, v1
  v_bfe_u32 v3, v1, 1, 1
  s_lshl_b32 s49, s5, 1
  v_or_b32 v3, s49, v3
  v_and_b32 v10, 6, v2
  v_xor_b32 v3, v3, v10
  v_lshlrev_b32 v2, 7, v2
  v_lshl_add_u32 v2, v3, 4, v2
  v_and_b32 v3, 1, v1
  v_lshl_add_u32 v2, v3, 3, v2
  v_add_u32 v2, 12288, v2
  ds_read_b64_tr_b16 v[40:41], v2 offset:0
  ds_read_b64_tr_b16 v[42:43], v2 offset:2048
  ds_read_b64_tr_b16 v[44:45], v2 offset:4096
  ds_read_b64_tr_b16 v[46:47], v2 offset:6144
  ds_read_b64_tr_b16 v[48:49], v2 offset:8192
  ds_read_b64_tr_b16 v[50:51], v2 offset:10240
  ds_read_b64_tr_b16 v[52:53], v2 offset:12288
  ds_read_b64_tr_b16 v[54:55], v2 offset:14336
  ds_read_b64_tr_b16 v[56:57], v2 offset:16384
  ds_read_b64_tr_b16 v[58:59], v2 offset:18432
  ds_read_b64_tr_b16 v[60:61], v2 offset:20480
  ds_read_b64_tr_b16 v[62:63], v2 offset:22528
  s_waitcnt lgkmcnt(10)
  ds_read_b64_tr_b16 v[64:65], v2 offset:24576
  ds_read_b64_tr_b16 v[66:67], v2 offset:26624
  s_waitcnt lgkmcnt(10)
  ds_read_b64_tr_b16 v[68:69], v2 offset:28672
  ds_read_b64_tr_b16 v[70:71], v2 offset:30720
  s_waitcnt lgkmcnt(10)
  ds_read_b64_tr_b16 v[72:73], v2 offset:32768
  ds_read_b64_tr_b16 v[74:75], v2 offset:34816
  s_waitcnt lgkmcnt(10)
  ds_read_b64_tr_b16 v[76:77], v2 offset:36864
  ds_read_b64_tr_b16 v[78:79], v2 offset:38912
  s_waitcnt lgkmcnt(10)
  ds_read_b64_tr_b16 v[80:81], v2 offset:40960
  ds_read_b64_tr_b16 v[82:83], v2 offset:43008
  s_waitcnt lgkmcnt(10)
  ds_read_b64_tr_b16 v[84:85], v2 offset:45056
  ds_read_b64_tr_b16 v[86:87], v2 offset:47104
  s_waitcnt lgkmcnt(10)
  ds_read_b64_tr_b16 v[88:89], v2 offset:49152
  ds_read_b64_tr_b16 v[90:91], v2 offset:51200
  s_waitcnt lgkmcnt(10)
  ds_read_b64_tr_b16 v[92:93], v2 offset:53248
  ds_read_b64_tr_b16 v[94:95], v2 offset:55296
  s_waitcnt lgkmcnt(10)
  ds_read_b64_tr_b16 v[96:97], v2 offset:57344
  ds_read_b64_tr_b16 v[98:99], v2 offset:59392
  s_waitcnt lgkmcnt(10)
  ds_read_b64_tr_b16 v[100:101], v2 offset:61440
  ds_read_b64_tr_b16 v[102:103], v2 offset:63488
  s_waitcnt lgkmcnt(10)
  s_waitcnt lgkmcnt(0)
  s_mov_b32 s70, 0
L_pl_47:
  ds_read_b32 v8, v38 offset:256
  s_waitcnt lgkmcnt(0)
  v_cmp_eq_u32 vcc, -1, v8
  s_cmp_eq_u64 vcc, 0
  s_cbranch_scc1 L_pld_48
  s_sleep 8
  s_add_u32 s70, s70, 1
  s_cmp_lt_u32 s70, 1048576
  s_cbranch_scc1 L_pl_47
L_pld_48:
  s_mov_b64 s[20:21], -1
  s_mov_b64 s[22:23], -1
  s_mov_b64 s[24:25], -1
  s_mov_b64 exec, s[20:21]
  global_load_dwordx4 v[152:155], v15, s[42:43] offset:0 sc1
  s_mov_b64 exec, s[22:23]
  global_load_dwordx4 v[156:159], v15, s[42:43] offset:512 sc1
  s_mov_b64 exec, s[24:25]
  global_load_dwordx4 v[160:163], v15, s[42:43] offset:1024 sc1
  s_mov_b64 exec, -1
  s_waitcnt vmcnt(0)
  s_mov_b32 s70, 0
  s_branch L_wo_c
L_wo_:
  s_mov_b64 exec, s[20:21]
  global_load_dwordx4 v[152:155], v15, s[42:43] offset:0 sc1
  s_mov_b64 exec, s[22:23]
  global_load_dwordx4 v[156:159], v15, s[42:43] offset:512 sc1
  s_mov_b64 exec, s[24:25]
  global_load_dwordx4 v[160:163], v15, s[42:43] offset:1024 sc1
  s_mov_b64 exec, -1
  s_waitcnt vmcnt(0)
L_wo_c:
  v_xor_b32 v136, s32, v152
  v_xor_b32 v137, s33, v153
  v_xor_b32 v138, s34, v154
  v_xor_b32 v139, s35, v155
  v_xor_b32 v140, s32, v156
  v_xor_b32 v141, s33, v157
  v_xor_b32 v142, s34, v158
  v_xor_b32 v143, s35, v159
  v_xor_b32 v144, s32, v160
  v_xor_b32 v145, s33, v161
  v_xor_b32 v146, s34, v162
  v_xor_b32 v147, s35, v163
  v_or3_b32 v28, v136, v137, v138
  v_or3_b32 v29, v140, v141, v142
  v_or3_b32 v30, v144, v145, v146
  v_or_b32 v28, v28, v139
  v_or_b32 v29, v29, v143
  v_or_b32 v30, v30, v147
  v_cmp_ne_u32_sdwa s[20:21], v28, v38 src0_sel:BYTE_0 src1_sel:DWORD
  v_cmp_ne_u32_sdwa s[22:23], v29, v38 src0_sel:BYTE_0 src1_sel:DWORD
  v_cmp_ne_u32_sdwa s[24:25], v30, v38 src0_sel:BYTE_0 src1_sel:DWORD
  v_or_b32 v136, 0x80, v136
  v_or_b32 v137, 0x80, v137
  v_or_b32 v138, 0x80, v138
  v_or_b32 v139, 0x80, v139
  v_or_b32 v140, 0x80, v140
  v_or_b32 v141, 0x80, v141
  v_or_b32 v142, 0x80, v142
  v_or_b32 v143, 0x80, v143
  v_or_b32 v144, 0x80, v144
  v_or_b32 v145, 0x80, v145
  v_or_b32 v146, 0x80, v146
  v_or_b32 v147, 0x80, v147
  v_pk_add_f32 v[16:17], v[136:137], v[140:141]
  v_pk_add_f32 v[18:19], v[138:139], v[142:143]
  v_pk_add_f32 v[16:17], v[16:17], v[144:145]
  v_pk_add_f32 v[18:19], v[18:19], v[146:147]
  s_mov_b64 vcc, s[20:21]
  s_or_b64 vcc, vcc, s[22:23]
  s_or_b64 vcc, vcc, s[24:25]
  s_or_b32 s20, s20, 1
  s_or_b32 s22, s22, 1
  s_or_b32 s24, s24, 1
  s_cmp_eq_u64 vcc, 0
  s_cbranch_scc1 L_wo_ok
  s_add_u32 s70, s70, 1
  s_cmp_lt_u32 s70, 262144
  s_cbranch_scc1 L_wo_
L_wo_ok:
  v_cvt_pk_bf16_f32 v8, v16, v17
  v_cvt_pk_bf16_f32 v9, v18, v19
  ds_write_b64 v12, v[8:9] offset:1024
  s_add_u32 s77, s77, 4
  v_mov_b32 v3, 1
  s_mov_b64 exec, 1
  ds_add_u32 v38, v3 offset:312
  s_mov_b64 exec, -1
  s_mov_b32 s70, 0
L_hy_49:
  ds_read_b32 v3, v38 offset:312
  ds_read_b128 v[104:107], v14 offset:0
  ds_read_b128 v[108:111], v14 offset:64
  ds_read_b128 v[112:115], v14 offset:128
  ds_read_b128 v[116:119], v14 offset:192
  s_waitcnt lgkmcnt(4)
  v_cmp_gt_u32 vcc, s77, v3
  s_cmp_eq_u64 vcc, 0
  s_cbranch_scc1 L_hyd_50
  s_waitcnt lgkmcnt(0)
  s_add_u32 s70, s70, 1
  s_cmp_lt_u32 s70, 2097152
  s_cbranch_scc1 L_hy_49
L_hyd_50:
  ds_read_b128 v[120:123], v14 offset:256
  ds_read_b128 v[124:127], v14 offset:320
  ds_read_b128 v[128:131], v14 offset:384
  ds_read_b128 v[132:135], v14 offset:448
  ds_read_b128 v[136:139], v14 offset:512
  ds_read_b128 v[140:143], v14 offset:576
  ds_read_b128 v[144:147], v14 offset:640
  ds_read_b128 v[148:151], v14 offset:704
  s_waitcnt lgkmcnt(11)
  v_mfma_f32_16x16x32_bf16 v[8:11], v[40:43], v[104:107], 0
  s_waitcnt lgkmcnt(10)
  v_mfma_f32_16x16x32_bf16 v[8:11], v[44:47], v[108:111], v[8:11]
  ds_read_b128 v[104:107], v14 offset:768
  s_waitcnt lgkmcnt(10)
  v_mfma_f32_16x16x32_bf16 v[8:11], v[48:51], v[112:115], v[8:11]
  ds_read_b128 v[108:111], v14 offset:832
  s_waitcnt lgkmcnt(10)
  v_mfma_f32_16x16x32_bf16 v[8:11], v[52:55], v[116:119], v[8:11]
  ds_read_b128 v[112:115], v14 offset:896
  s_waitcnt lgkmcnt(10)
  v_mfma_f32_16x16x32_bf16 v[8:11], v[56:59], v[120:123], v[8:11]
  ds_read_b128 v[116:119], v14 offset:960
  s_waitcnt lgkmcnt(10)
  v_mfma_f32_16x16x32_bf16 v[8:11], v[60:63], v[124:127], v[8:11]
  s_waitcnt lgkmcnt(9)
  v_mfma_f32_16x16x32_bf16 v[8:11], v[64:67], v[128:131], v[8:11]
  s_waitcnt lgkmcnt(8)
  v_mfma_f32_16x16x32_bf16 v[8:11], v[68:71], v[132:135], v[8:11]
  s_waitcnt lgkmcnt(7)
  v_mfma_f32_16x16x32_bf16 v[8:11], v[72:75], v[136:139], v[8:11]
  s_waitcnt lgkmcnt(6)
  v_mfma_f32_16x16x32_bf16 v[8:11], v[76:79], v[140:143], v[8:11]
  s_waitcnt lgkmcnt(5)
  v_mfma_f32_16x16x32_bf16 v[8:11], v[80:83], v[144:147], v[8:11]
  s_waitcnt lgkmcnt(4)
  v_mfma_f32_16x16x32_bf16 v[8:11], v[84:87], v[148:151], v[8:11]
  s_waitcnt lgkmcnt(3)
  v_mfma_f32_16x16x32_bf16 v[8:11], v[88:91], v[104:107], v[8:11]
  s_waitcnt lgkmcnt(2)
  v_mfma_f32_16x16x32_bf16 v[8:11], v[92:95], v[108:111], v[8:11]
  s_waitcnt lgkmcnt(1)
  v_mfma_f32_16x16x32_bf16 v[8:11], v[96:99], v[112:115], v[8:11]
  s_waitcnt lgkmcnt(0)
  v_mfma_f32_16x16x32_bf16 v[8:11], v[100:103], v[116:119], v[8:11]
  s_nop 7
  v_bfi_b32 v8, v36, s32, v8
  v_bfi_b32 v9, v36, s33, v9
  v_bfi_b32 v10, v36, s34, v10
  v_bfi_b32 v11, v36, s35, v11
  s_mov_b32 exec_lo, 0x000f000f
  s_mov_b32 exec_hi, exec_lo
  global_store_dwordx4 v13, v[8:11], s[42:43] sc1
  v_mov_b32 v3, 1
  s_mov_b64 exec, 1
  ds_add_u32 v38, v3 offset:264
  s_mov_b64 exec, -1
  s_branch L_fin
L_r_mod:
  global_load_dwordx2 v[14:15], v37, s[34:35]
  s_mov_b32 s44, s36
  s_mov_b32 s45, s37
  s_mov_b32 s46, 3145728
  s_mov_b32 s47, 0x20000
  s_cmp_ge_u32 s60, 2
  s_cbranch_scc1 L_mod2
  s_lshl1_add_u32 s61, s8, s60
  s_lshl_b32 s48, s61, 7
  s_lshl_b32 s58, s61, 9
  s_add_u32 s58, s58, 917504
  v_lshrrev_b32 v2, 3, v1
  v_and_b32 v3, 6, v2
  v_xor_b32 v3, v3, v1
  v_mul_u32_u24 v2, 6144, v2
  v_and_b32 v3, 7, v3
  v_lshl_add_u32 v2, v3, 4, v2
  s_mul_i32 s49, s5, 786432
  s_lshl_b32 s50, s5, 14
  s_add_u32 s49, s49, s48
  s_add_u32 s50, s50, 77824
  s_add_u32 s51, s50, 16384
L_dma_51:
  s_mov_b32 m0, s50
  s_add_u32 s50, s50, 1024
  buffer_load_dwordx4 v2, s[44:47], s49 offen nt lds
  s_add_u32 s49, s49, 49152
  s_cmp_lt_u32 s50, s51
  s_cbranch_scc1 L_dma_51
L_dmae_52:
  v_mov_b32 v3, 1
  s_mov_b64 exec, 1
  ds_add_u32 v38, v3 offset:268
  s_mov_b64 exec, -1
  s_getpc_b64 s[56:57]
L_pc_53:
  s_lshr_b32 s3, s2, 5
  s_lshl3_add_u32 s3, s3, s8
  s_lshl_b32 s3, s3, 2
  s_add_u32 s3, s3, L_table-L_pc_53
  s_load_dword s14, s[56:57], s3
  s_waitcnt lgkmcnt(0)
  s_mul_i32 s74, s74, 0x9e3779b1
  s_add_u32 s74, s74, 0x7f4a7c15
  s_waitcnt vmcnt(16)
  v_lshlrev_b32 v16, 16, v14
  v_and_b32 v17, s73, v14
  v_lshlrev_b32 v18, 16, v15
  v_and_b32 v19, s73, v15
  v_mul_f32 v20, 0xbfb8aa3b, v16
  v_mul_f32 v21, 0xbfb8aa3b, v17
  v_mul_f32 v22, 0xbfb8aa3b, v18
  v_mul_f32 v23, 0xbfb8aa3b, v19
  v_exp_f32 v20, v20
  v_exp_f32 v21, v21
  v_exp_f32 v22, v22
  v_exp_f32 v23, v23
  s_nop 0
  v_add_f32 v20, 1.0, v20
  v_add_f32 v21, 1.0, v21
  v_add_f32 v22, 1.0, v22
  v_add_f32 v23, 1.0, v23
  v_rcp_f32 v20, v20
  v_rcp_f32 v21, v21
  v_rcp_f32 v22, v22
  v_rcp_f32 v23, v23
  s_nop 0
  v_mul_f32 v16, v16, v20
  v_mul_f32 v17, v17, v21
  v_mul_f32 v18, v18, v22
  v_mul_f32 v19, v19, v23
  v_cvt_pk_bf16_f32 v14, v16, v17
  v_cvt_pk_bf16_f32 v15, v18, v19
  ds_write_b64 v12, v[14:15] offset:3200
  v_and_b32 v13, 1, v1
  v_lshlrev_b32 v13, 6, v13
  v_lshrrev_b32 v3, 4, v1
  v_lshl_add_u32 v13, v3, 4, v13
  s_lshl_b32 s49, s5, 7
  s_add_u32 s49, s49, s58
  v_add_u32 v13, s49, v13
  v_bfe_u32 v3, v1, 1, 3
  v_lshl_add_u32 v13, v3, 13, v13
  v_and_b32 v14, 1, v1
  v_mul_u32_u24 v14, 1056, v14
  v_lshrrev_b32 v3, 4, v1
  v_lshl_add_u32 v14, v3, 4, v14
  v_add_u32 v14, 3200, v14
  v_lshrrev_b32 v2, 2, v1
  v_bfe_u32 v3, v1, 1, 1
  s_lshl_b32 s49, s5, 1
  v_or_b32 v3, s49, v3
  v_and_b32 v10, 6, v2
  v_xor_b32 v3, v3, v10
  v_lshlrev_b32 v2, 7, v2
  v_lshl_add_u32 v2, v3, 4, v2
  v_and_b32 v3, 1, v1
  v_lshl_add_u32 v2, v3, 3, v2
  v_add_u32 v2, 77824, v2
  s_waitcnt vmcnt(0) lgkmcnt(0)
  s_add_u32 s77, s77, 4
  v_mov_b32 v9, 1
  s_mov_b64 exec, 1
  ds_add_u32 v38, v9 offset:316
  s_mov_b64 exec, -1
  s_mov_b32 s70, 0
L_hy_54:
  ds_read_b32 v9, v38 offset:316
  s_waitcnt lgkmcnt(0)
  v_cmp_gt_u32 vcc, s77, v9
  s_cmp_eq_u64 vcc, 0
  s_cbranch_scc1 L_hyd_55
  s_add_u32 s70, s70, 1
  s_cmp_lt_u32 s70, 2097152
  s_cbranch_scc1 L_hy_54
L_hyd_55:
  ds_read_b64_tr_b16 v[40:41], v2 offset:0
  ds_read_b64_tr_b16 v[42:43], v2 offset:2048
  ds_read_b128 v[104:107], v14 offset:0
  ds_read_b64_tr_b16 v[44:45], v2 offset:4096
  ds_read_b64_tr_b16 v[46:47], v2 offset:6144
  ds_read_b128 v[108:111], v14 offset:64
  ds_read_b64_tr_b16 v[48:49], v2 offset:8192
  ds_read_b64_tr_b16 v[50:51], v2 offset:10240
  ds_read_b128 v[112:115], v14 offset:128
  ds_read_b64_tr_b16 v[52:53], v2 offset:12288
  ds_read_b64_tr_b16 v[54:55], v2 offset:14336
  ds_read_b128 v[116:119], v14 offset:192
  ds_read_b64_tr_b16 v[56:57], v2 offset:16384
  ds_read_b64_tr_b16 v[58:59], v2 offset:18432
  ds_read_b128 v[120:123], v14 offset:256
  s_waitcnt lgkmcnt(12)
  v_mfma_f32_16x16x32_bf16 v[8:11], v[40:43], v[104:107], 0
  ds_read_b64_tr_b16 v[60:61], v2 offset:20480
  ds_read_b64_tr_b16 v[62:63], v2 offset:22528
  ds_read_b128 v[124:127], v14 offset:320
  s_waitcnt lgkmcnt(12)
  v_mfma_f32_16x16x32_bf16 v[8:11], v[44:47], v[108:111], v[8:11]
  ds_read_b64_tr_b16 v[64:65], v2 offset:24576
  ds_read_b64_tr_b16 v[66:67], v2 offset:26624
  ds_read_b128 v[128:131], v14 offset:384
  s_waitcnt lgkmcnt(12)
  v_mfma_f32_16x16x32_bf16 v[8:11], v[48:51], v[112:115], v[8:11]
  ds_read_b64_tr_b16 v[68:69], v2 offset:28672
  ds_read_b64_tr_b16 v[70:71], v2 offset:30720
  ds_read_b128 v[132:135], v14 offset:448
  s_waitcnt lgkmcnt(12)
  v_mfma_f32_16x16x32_bf16 v[8:11], v[52:55], v[116:119], v[8:11]
  ds_read_b64_tr_b16 v[72:73], v2 offset:32768
  ds_read_b64_tr_b16 v[74:75], v2 offset:34816
  ds_read_b128 v[136:139], v14 offset:512
  s_waitcnt lgkmcnt(12)
  v_mfma_f32_16x16x32_bf16 v[8:11], v[56:59], v[120:123], v[8:11]
  ds_read_b64_tr_b16 v[76:77], v2 offset:36864
  ds_read_b64_tr_b16 v[78:79], v2 offset:38912
  ds_read_b128 v[140:143], v14 offset:576
  s_waitcnt lgkmcnt(12)
  v_mfma_f32_16x16x32_bf16 v[8:11], v[60:63], v[124:127], v[8:11]
  ds_read_b64_tr_b16 v[80:81], v2 offset:40960
  ds_read_b64_tr_b16 v[82:83], v2 offset:43008
  ds_read_b128 v[144:147], v14 offset:640
  s_waitcnt lgkmcnt(12)
  v_mfma_f32_16x16x32_bf16 v[8:11], v[64:67], v[128:131], v[8:11]
  ds_read_b64_tr_b16 v[84:85], v2 offset:45056
  ds_read_b64_tr_b16 v[86:87], v2 offset:47104
  ds_read_b128 v[148:151], v14 offset:704
  s_waitcnt lgkmcnt(12)
  v_mfma_f32_16x16x32_bf16 v[8:11], v[68:71], v[132:135], v[8:11]
  ds_read_b64_tr_b16 v[88:89], v2 offset:49152
  ds_read_b64_tr_b16 v[90:91], v2 offset:51200
  ds_read_b128 v[152:155], v14 offset:768
  s_waitcnt lgkmcnt(12)
  v_mfma_f32_16x16x32_bf16 v[8:11], v[72:75], v[136:139], v[8:11]
  ds_read_b64_tr_b16 v[92:93], v2 offset:53248
  ds_read_b64_tr_b16 v[94:95], v2 offset:55296
  ds_read_b128 v[156:159], v14 offset:832
  s_waitcnt lgkmcnt(12)
  v_mfma_f32_16x16x32_bf16 v[8:11], v[76:79], v[140:143], v[8:11]
  ds_read_b64_tr_b16 v[96:97], v2 offset:57344
  ds_read_b64_tr_b16 v[98:99], v2 offset:59392
  ds_read_b128 v[160:163], v14 offset:896
  s_waitcnt lgkmcnt(12)
  v_mfma_f32_16x16x32_bf16 v[8:11], v[80:83], v[144:147], v[8:11]
  ds_read_b64_tr_b16 v[100:101], v2 offset:61440
  ds_read_b64_tr_b16 v[102:103], v2 offset:63488
  ds_read_b128 v[164:167], v14 offset:960
  s_waitcnt lgkmcnt(12)
  v_mfma_f32_16x16x32_bf16 v[8:11], v[84:87], v[148:151], v[8:11]
  s_waitcnt lgkmcnt(9)
  v_mfma_f32_16x16x32_bf16 v[8:11], v[88:91], v[152:155], v[8:11]
  s_waitcnt lgkmcnt(6)
  v_mfma_f32_16x16x32_bf16 v[8:11], v[92:95], v[156:159], v[8:11]
  s_waitcnt lgkmcnt(3)
  v_mfma_f32_16x16x32_bf16 v[8:11], v[96:99], v[160:163], v[8:11]
  s_waitcnt lgkmcnt(0)
  v_mfma_f32_16x16x32_bf16 v[8:11], v[100:103], v[164:167], v[8:11]
  s_nop 7
  v_cvt_pk_bf16_f32 v8, v8, v9
  v_cvt_pk_bf16_f32 v10, v10, v11
  v_mov_b32 v9, s74
  v_mov_b32 v11, s74
  global_store_dwordx4 v13, v[8:11], s[42:43] sc1
  s_mov_b64 exec, -1
  s_add_u32 s77, s77, 4
  v_mov_b32 v9, 1
  s_mov_b64 exec, 1
  ds_add_u32 v38, v9 offset:316
  s_mov_b64 exec, -1
  s_mov_b32 s70, 0
L_hy_56:
  ds_read_b32 v9, v38 offset:316
  s_waitcnt lgkmcnt(0)
  v_cmp_gt_u32 vcc, s77, v9
  s_cmp_eq_u64 vcc, 0
  s_cbranch_scc1 L_hyd_57
  s_add_u32 s70, s70, 1
  s_cmp_lt_u32 s70, 2097152
  s_cbranch_scc1 L_hy_56
L_hyd_57:
  s_branch L_mod3
L_mod2:
  s_getpc_b64 s[56:57]
L_pc_58:
  s_lshr_b32 s3, s2, 5
  s_lshl3_add_u32 s3, s3, s8
  s_lshl_b32 s3, s3, 2
  s_add_u32 s3, s3, L_table-L_pc_58
  s_load_dword s14, s[56:57], s3
  s_waitcnt lgkmcnt(0)
  s_mul_i32 s74, s74, 0x9e3779b1
  s_add_u32 s74, s74, 0x7f4a7c15
  s_waitcnt vmcnt(0)
  v_lshlrev_b32 v16, 16, v14
  v_and_b32 v17, s73, v14
  v_lshlrev_b32 v18, 16, v15
  v_and_b32 v19, s73, v15
  v_mul_f32 v20, 0xbfb8aa3b, v16
  v_mul_f32 v21, 0xbfb8aa3b, v17
  v_mul_f32 v22, 0xbfb8aa3b, v18
  v_mul_f32 v23, 0xbfb8aa3b, v19
  v_exp_f32 v20, v20
  v_exp_f32 v21, v21
  v_exp_f32 v22, v22
  v_exp_f32 v23, v23
  s_nop 0
  v_add_f32 v20, 1.0, v20
  v_add_f32 v21, 1.0, v21
  v_add_f32 v22, 1.0, v22
  v_add_f32 v23, 1.0, v23
  v_rcp_f32 v20, v20
  v_rcp_f32 v21, v21
  v_rcp_f32 v22, v22
  v_rcp_f32 v23, v23
  s_nop 0
  v_mul_f32 v16, v16, v20
  v_mul_f32 v17, v17, v21
  v_mul_f32 v18, v18, v22
  v_mul_f32 v19, v19, v23
  v_cvt_pk_bf16_f32 v14, v16, v17
  v_cvt_pk_bf16_f32 v15, v18, v19
  ds_write_b64 v12, v[14:15] offset:3200
L_mod3:
  s_mov_b32 s70, 0
L_sn_59:
  ds_read_b32 v8, v38 offset:264
  s_waitcnt lgkmcnt(0)
  v_cmp_gt_u32 vcc, 0x4, v8
  s_cmp_eq_u64 vcc, 0
  s_cbranch_scc1 L_snd_60
  s_sleep 4
  s_add_u32 s70, s70, 1
  s_cmp_lt_u32 s70, 2097152
  s_cbranch_scc1 L_sn_59
L_snd_60:
  s_and_b32 s61, s14, 0xff
  s_cmp_ge_u32 s61, 48
  s_cbranch_scc1 L_r_f1
  s_mov_b32 s70, 0
L_sn_61:
  ds_read_b32 v8, v38 offset:312
  s_waitcnt lgkmcnt(0)
  v_cmp_gt_u32 vcc, 0x8, v8
  s_cmp_eq_u64 vcc, 0
  s_cbranch_scc1 L_snd_62
  s_sleep 4
  s_add_u32 s70, s70, 1
  s_cmp_lt_u32 s70, 2097152
  s_cbranch_scc1 L_sn_61
L_snd_62:
  s_and_b32 s61, s14, 0xff
L_mod4:
  s_cmp_ge_u32 s61, 48
  s_cbranch_scc1 L_r_f1
  s_lshl_b32 s48, s61, 7
  s_lshl_b32 s58, s61, 9
  s_add_u32 s58, s58, 4096
  v_lshrrev_b32 v2, 3, v1
  v_and_b32 v3, 6, v2
  v_xor_b32 v3, v3, v1
  v_mul_u32_u24 v2, 6144, v2
  v_and_b32 v3, 7, v3
  v_lshl_add_u32 v2, v3, 4, v2
  s_mul_i32 s49, s5, 786432
  s_lshl_b32 s50, s5, 14
  s_add_u32 s49, s49, s48
  s_add_u32 s50, s50, 77824
  s_add_u32 s51, s50, 16384
L_dma_63:
  s_mov_b32 m0, s50
  s_add_u32 s50, s50, 1024
  buffer_load_dwordx4 v2, s[44:47], s49 offen nt lds
  s_add_u32 s49, s49, 49152
  s_waitcnt vmcnt(5)
  s_cmp_lt_u32 s50, s51
  s_cbranch_scc1 L_dma_63
L_dmae_64:
  v_and_b32 v13, 1, v1
  v_lshlrev_b32 v13, 6, v13
  v_lshrrev_b32 v3, 4, v1
  v_lshl_add_u32 v13, v3, 4, v13
  s_lshl_b32 s49, s5, 7
  s_add_u32 s49, s49, s58
  v_add_u32 v13, s49, v13
  v_and_b32 v14, 1, v1
  v_mul_u32_u24 v14, 1056, v14
  v_lshrrev_b32 v3, 4, v1
  v_lshl_add_u32 v14, v3, 4, v14
  v_add_u32 v14, 3200, v14
  v_lshrrev_b32 v2, 2, v1
  v_bfe_u32 v3, v1, 1, 1
  s_lshl_b32 s49, s5, 1
  v_or_b32 v3, s49, v3
  v_and_b32 v10, 6, v2
  v_xor_b32 v3, v3, v10
  v_lshlrev_b32 v2, 7, v2
  v_lshl_add_u32 v2, v3, 4, v2
  v_and_b32 v3, 1, v1
  v_lshl_add_u32 v2, v3, 3, v2
  v_add_u32 v2, 77824, v2
  s_waitcnt vmcnt(0) lgkmcnt(0)
  s_add_u32 s77, s77, 4
  v_mov_b32 v9, 1
  s_mov_b64 exec, 1
  ds_add_u32 v38, v9 offset:316
  s_mov_b64 exec, -1
  s_mov_b32 s70, 0
L_hy_65:
  ds_read_b32 v9, v38 offset:316
  s_waitcnt lgkmcnt(0)
  v_cmp_gt_u32 vcc, s77, v9
  s_cmp_eq_u64 vcc, 0
  s_cbranch_scc1 L_hyd_66
  s_sleep 4
  s_add_u32 s70, s70, 1
  s_cmp_lt_u32 s70, 2097152
  s_cbranch_scc1 L_hy_65
L_hyd_66:
  ds_read_b64_tr_b16 v[40:41], v2 offset:0
  ds_read_b64_tr_b16 v[42:43], v2 offset:2048
  ds_read_b128 v[104:107], v14 offset:0
  ds_read_b64_tr_b16 v[44:45], v2 offset:4096
  ds_read_b64_tr_b16 v[46:47], v2 offset:6144
  ds_read_b128 v[108:111], v14 offset:64
  ds_read_b64_tr_b16 v[48:49], v2 offset:8192
  ds_read_b64_tr_b16 v[50:51], v2 offset:10240
  ds_read_b128 v[112:115], v14 offset:128
  ds_read_b64_tr_b16 v[52:53], v2 offset:12288
  ds_read_b64_tr_b16 v[54:55], v2 offset:14336
  ds_read_b128 v[116:119], v14 offset:192
  ds_read_b64_tr_b16 v[56:57], v2 offset:16384
  ds_read_b64_tr_b16 v[58:59], v2 offset:18432
  ds_read_b128 v[120:123], v14 offset:256
  s_waitcnt lgkmcnt(12)
  v_mfma_f32_16x16x32_bf16 v[8:11], v[40:43], v[104:107], 0
  ds_read_b64_tr_b16 v[60:61], v2 offset:20480
  ds_read_b64_tr_b16 v[62:63], v2 offset:22528
  ds_read_b128 v[124:127], v14 offset:320
  s_waitcnt lgkmcnt(12)
  v_mfma_f32_16x16x32_bf16 v[8:11], v[44:47], v[108:111], v[8:11]
  ds_read_b64_tr_b16 v[64:65], v2 offset:24576
  ds_read_b64_tr_b16 v[66:67], v2 offset:26624
  ds_read_b128 v[128:131], v14 offset:384
  s_waitcnt lgkmcnt(12)
  v_mfma_f32_16x16x32_bf16 v[8:11], v[48:51], v[112:115], v[8:11]
  ds_read_b64_tr_b16 v[68:69], v2 offset:28672
  ds_read_b64_tr_b16 v[70:71], v2 offset:30720
  ds_read_b128 v[132:135], v14 offset:448
  s_waitcnt lgkmcnt(12)
  v_mfma_f32_16x16x32_bf16 v[8:11], v[52:55], v[116:119], v[8:11]
  ds_read_b64_tr_b16 v[72:73], v2 offset:32768
  ds_read_b64_tr_b16 v[74:75], v2 offset:34816
  ds_read_b128 v[136:139], v14 offset:512
  s_waitcnt lgkmcnt(12)
  v_mfma_f32_16x16x32_bf16 v[8:11], v[56:59], v[120:123], v[8:11]
  ds_read_b64_tr_b16 v[76:77], v2 offset:36864
  ds_read_b64_tr_b16 v[78:79], v2 offset:38912
  ds_read_b128 v[140:143], v14 offset:576
  s_waitcnt lgkmcnt(12)
  v_mfma_f32_16x16x32_bf16 v[8:11], v[60:63], v[124:127], v[8:11]
  ds_read_b64_tr_b16 v[80:81], v2 offset:40960
  ds_read_b64_tr_b16 v[82:83], v2 offset:43008
  ds_read_b128 v[144:147], v14 offset:640
  s_waitcnt lgkmcnt(12)
  v_mfma_f32_16x16x32_bf16 v[8:11], v[64:67], v[128:131], v[8:11]
  ds_read_b64_tr_b16 v[84:85], v2 offset:45056
  ds_read_b64_tr_b16 v[86:87], v2 offset:47104
  ds_read_b128 v[148:151], v14 offset:704
  s_waitcnt lgkmcnt(12)
  v_mfma_f32_16x16x32_bf16 v[8:11], v[68:71], v[132:135], v[8:11]
  ds_read_b64_tr_b16 v[88:89], v2 offset:49152
  ds_read_b64_tr_b16 v[90:91], v2 offset:51200
  ds_read_b128 v[152:155], v14 offset:768
  s_waitcnt lgkmcnt(12)
  v_mfma_f32_16x16x32_bf16 v[8:11], v[72:75], v[136:139], v[8:11]
  ds_read_b64_tr_b16 v[92:93], v2 offset:53248
  ds_read_b64_tr_b16 v[94:95], v2 offset:55296
  ds_read_b128 v[156:159], v14 offset:832
  s_waitcnt lgkmcnt(12)
  v_mfma_f32_16x16x32_bf16 v[8:11], v[76:79], v[140:143], v[8:11]
  ds_read_b64_tr_b16 v[96:97], v2 offset:57344
  ds_read_b64_tr_b16 v[98:99], v2 offset:59392
  ds_read_b128 v[160:163], v14 offset:896
  s_waitcnt lgkmcnt(12)
  v_mfma_f32_16x16x32_bf16 v[8:11], v[80:83], v[144:147], v[8:11]
  ds_read_b64_tr_b16 v[100:101], v2 offset:61440
  ds_read_b64_tr_b16 v[102:103], v2 offset:63488
  ds_read_b128 v[164:167], v14 offset:960
  s_waitcnt lgkmcnt(12)
  v_mfma_f32_16x16x32_bf16 v[8:11], v[84:87], v[148:151], v[8:11]
  s_waitcnt lgkmcnt(9)
  v_mfma_f32_16x16x32_bf16 v[8:11], v[88:91], v[152:155], v[8:11]
  s_waitcnt lgkmcnt(6)
  v_mfma_f32_16x16x32_bf16 v[8:11], v[92:95], v[156:159], v[8:11]
  s_waitcnt lgkmcnt(3)
  v_mfma_f32_16x16x32_bf16 v[8:11], v[96:99], v[160:163], v[8:11]
  s_waitcnt lgkmcnt(0)
  v_mfma_f32_16x16x32_bf16 v[8:11], v[100:103], v[164:167], v[8:11]
  s_nop 7
  v_cvt_pk_bf16_f32 v8, v8, v9
  v_cvt_pk_bf16_f32 v10, v10, v11
  v_mov_b32 v9, s74
  v_mov_b32 v11, s74
  s_mov_b32 exec_lo, 0x00030003
  s_mov_b32 exec_hi, 0x00030003
  global_store_dwordx4 v13, v[8:11], s[42:43] sc1
  s_mov_b64 exec, -1
  s_add_u32 s77, s77, 4
  v_mov_b32 v9, 1
  s_mov_b64 exec, 1
  ds_add_u32 v38, v9 offset:316
  s_mov_b64 exec, -1
  s_mov_b32 s70, 0
L_hy_67:
  ds_read_b32 v9, v38 offset:316
  s_waitcnt lgkmcnt(0)
  v_cmp_gt_u32 vcc, s77, v9
  s_cmp_eq_u64 vcc, 0
  s_cbranch_scc1 L_hyd_68
  s_add_u32 s70, s70, 1
  s_cmp_lt_u32 s70, 2097152
  s_cbranch_scc1 L_hy_67
L_hyd_68:
  s_lshr_b32 s61, s14, 24
  s_or_b32 s14, s14, 0xff000000
  s_branch L_mod4
L_r_f1:
  s_bfe_u32 s61, s14, 0x80008
  s_cmp_ge_u32 s61, 43
  s_cbranch_scc1 L_fin
  s_lshl_b32 s48, s61, 6
  s_lshl_b32 s58, s61, 7
  s_add_u32 s58, s58, 1572864
  s_cmp_lt_u32 s5, 2
  s_cselect_b32 s44, s28, s30
  s_cselect_b32 s45, s29, s31
  s_mov_b32 s46, 1409024
  s_and_b32 s54, s61, 1
  v_lshrrev_b32 v2, 2, v1
  v_mul_u32_u24 v2, 5504, v2
  s_and_b32 s49, s5, 2
  s_or_b32 s49, s49, s54
  v_xor_b32 v3, s49, v1
  v_and_b32 v3, 3, v3
  v_lshl_add_u32 v2, v3, 4, v2
  s_and_b32 s55, s5, 1
  s_mul_i32 s49, s55, 704512
  s_add_u32 s49, s49, s48
  s_mul_i32 s50, s54, 2752
  s_add_u32 s49, s49, s50
  s_lshr_b32 s50, s5, 1
  s_lshl_b32 s50, s50, 15
  s_lshl_b32 s54, s54, 14
  s_add_u32 s50, s50, s54
  s_lshl_b32 s55, s55, 13
  s_add_u32 s50, s50, s55
  s_add_u32 s50, s50, 77824
  s_mov_b32 s70, 0
L_sn_69:
  ds_read_b32 v8, v38 offset:260
  s_waitcnt lgkmcnt(0)
  v_cmp_gt_u32 vcc, 0x1, v8
  s_cmp_eq_u64 vcc, 0
  s_cbranch_scc1 L_snd_70
  s_sleep 8
  s_add_u32 s70, s70, 1
  s_cmp_lt_u32 s70, 2097152
  s_cbranch_scc1 L_sn_69
L_snd_70:
  s_add_u32 s51, s50, 8192
L_dma_71:
  s_mov_b32 m0, s50
  s_add_u32 s50, s50, 1024
  buffer_load_dwordx4 v2, s[44:47], s49 offen  lds
  s_add_u32 s49, s49, 88064
  s_waitcnt vmcnt(3)
  s_cmp_lt_u32 s50, s51
  s_cbranch_scc1 L_dma_71
L_dmae_72:
  s_andn2_b32 s54, 1, s61
  v_lshrrev_b32 v2, 2, v1
  v_mul_u32_u24 v2, 5504, v2
  s_and_b32 s49, s5, 2
  s_or_b32 s49, s49, s54
  v_xor_b32 v3, s49, v1
  v_and_b32 v3, 3, v3
  v_lshl_add_u32 v2, v3, 4, v2
  s_and_b32 s55, s5, 1
  s_mul_i32 s49, s55, 704512
  s_add_u32 s49, s49, s48
  s_mul_i32 s50, s54, 2752
  s_add_u32 s49, s49, s50
  s_lshr_b32 s50, s5, 1
  s_lshl_b32 s50, s50, 15
  s_lshl_b32 s54, s54, 14
  s_add_u32 s50, s50, s54
  s_lshl_b32 s55, s55, 13
  s_add_u32 s50, s50, s55
  s_add_u32 s50, s50, 77824
  s_add_u32 s51, s50, 8192
L_dma_73:
  s_mov_b32 m0, s50
  s_add_u32 s50, s50, 1024
  buffer_load_dwordx4 v2, s[44:47], s49 offen nt lds
  s_add_u32 s49, s49, 88064
  s_waitcnt vmcnt(3)
  s_cmp_lt_u32 s50, s51
  s_cbranch_scc1 L_dma_73
L_dmae_74:
  v_lshlrev_b32 v15, 4, v0
  v_add_u32 v39, 16384, v15
  s_and_b32 s59, s2, 1
  s_lshl_b32 s59, s59, 16
  s_add_u32 s59, s59, 2101248
  v_add_u32 v15, s59, v15
  v_lshrrev_b32 v5, 2, v0
  v_lshlrev_b32 v5, 3, v5
  v_add_u32 v5, 9536, v5
  v_lshlrev_b32 v7, 3, v1
  v_add_u32 v7, 9536, v7
  v_and_b32 v14, 7, v1
  v_mul_u32_u24 v14, 1056, v14
  v_lshrrev_b32 v3, 4, v1
  v_lshl_add_u32 v14, v3, 4, v14
  v_bfe_u32 v6, v1, 2, 2
  v_lshl_add_u32 v6, v3, 3, v6
  v_mul_u32_u24 v6, 1056, v6
  v_and_b32 v8, 3, v1
  v_lshl_add_u32 v6, v8, 3, v6
  s_lshl_b32 s49, s5, 8
  s_add_u32 s49, s49, 77824
  v_add_u32 v6, s49, v6
  v_lshlrev_b32 v10, 3, v0
  v_add_u32 v10, 10048, v10
  v_mov_b32 v8, 0
  v_mov_b32 v9, 0
  ds_write_b64 v10, v[8:9]
  v_and_b32 v13, 1, v1
  v_lshlrev_b32 v13, 6, v13
  v_lshrrev_b32 v3, 4, v1
  v_lshl_add_u32 v13, v3, 4, v13
  s_lshl_b32 s49, s5, 17
  s_add_u32 s49, s49, s58
  v_add_u32 v13, s49, v13
  v_bfe_u32 v3, v1, 1, 3
  v_lshl_add_u32 v13, v3, 14, v13
  v_lshrrev_b32 v2, 3, v1
  v_lshlrev_b32 v2, 6, v2
  v_bfe_u32 v3, v1, 2, 1
  v_lshl_add_u32 v2, v3, 14, v2
  v_and_b32 v8, 2, v1
  v_or_b32 v3, v3, v8
  v_xor_b32 v3, s5, v3
  v_lshl_add_u32 v2, v3, 4, v2
  v_lshl_add_u32 v2, v8, 14, v2
  v_and_b32 v3, 1, v1
  v_lshl_add_u32 v2, v3, 3, v2
  v_add_u32 v2, 77824, v2
  s_waitcnt vmcnt(0)
  s_add_u32 s77, s77, 4
  v_mov_b32 v9, 1
  s_mov_b64 exec, 1
  ds_add_u32 v38, v9 offset:316
  s_mov_b64 exec, -1
  s_mov_b32 s70, 0
L_hy_75:
  ds_read_b32 v9, v38 offset:316
  s_waitcnt lgkmcnt(0)
  v_cmp_gt_u32 vcc, s77, v9
  s_cmp_eq_u64 vcc, 0
  s_cbranch_scc1 L_hyd_76
  s_sleep 4
  s_add_u32 s70, s70, 1
  s_cmp_lt_u32 s70, 2097152
  s_cbranch_scc1 L_hy_75
L_hyd_76:
  ds_read_b64_tr_b16 v[40:41], v2 offset:0
  ds_read_b64_tr_b16 v[42:43], v2 offset:512
  ds_read_b64_tr_b16 v[44:45], v2 offset:1024
  ds_read_b64_tr_b16 v[46:47], v2 offset:1536
  ds_read_b64_tr_b16 v[48:49], v2 offset:2048
  ds_read_b64_tr_b16 v[50:51], v2 offset:2560
  ds_read_b64_tr_b16 v[52:53], v2 offset:3072
  ds_read_b64_tr_b16 v[54:55], v2 offset:3584
  ds_read_b64_tr_b16 v[56:57], v2 offset:4096
  ds_read_b64_tr_b16 v[58:59], v2 offset:4608
  ds_read_b64_tr_b16 v[60:61], v2 offset:5120
  ds_read_b64_tr_b16 v[62:63], v2 offset:5632
  s_waitcnt lgkmcnt(10)
  ds_read_b64_tr_b16 v[64:65], v2 offset:6144
  ds_read_b64_tr_b16 v[66:67], v2 offset:6656
  s_waitcnt lgkmcnt(10)
  ds_read_b64_tr_b16 v[68:69], v2 offset:7168
  ds_read_b64_tr_b16 v[70:71], v2 offset:7680
  s_waitcnt lgkmcnt(10)
  ds_read_b64_tr_b16 v[72:73], v2 offset:8192
  ds_read_b64_tr_b16 v[74:75], v2 offset:8704
  s_waitcnt lgkmcnt(10)
  ds_read_b64_tr_b16 v[76:77], v2 offset:9216
  ds_read_b64_tr_b16 v[78:79], v2 offset:9728
  s_waitcnt lgkmcnt(10)
  ds_read_b64_tr_b16 v[80:81], v2 offset:10240
  ds_read_b64_tr_b16 v[82:83], v2 offset:10752
  s_waitcnt lgkmcnt(10)
  ds_read_b64_tr_b16 v[84:85], v2 offset:11264
  ds_read_b64_tr_b16 v[86:87], v2 offset:11776
  s_waitcnt lgkmcnt(10)
  ds_read_b64_tr_b16 v[88:89], v2 offset:12288
  ds_read_b64_tr_b16 v[90:91], v2 offset:12800
  s_waitcnt lgkmcnt(10)
  ds_read_b64_tr_b16 v[92:93], v2 offset:13312
  ds_read_b64_tr_b16 v[94:95], v2 offset:13824
  s_waitcnt lgkmcnt(10)
  ds_read_b64_tr_b16 v[96:97], v2 offset:14336
  ds_read_b64_tr_b16 v[98:99], v2 offset:14848
  s_waitcnt lgkmcnt(10)
  ds_read_b64_tr_b16 v[100:101], v2 offset:15360
  ds_read_b64_tr_b16 v[102:103], v2 offset:15872
  s_waitcnt lgkmcnt(10)
  s_waitcnt lgkmcnt(0)
  s_add_u32 s77, s77, 4
  v_mov_b32 v9, 1
  s_mov_b64 exec, 1
  ds_add_u32 v38, v9 offset:316
  s_mov_b64 exec, -1
  s_mov_b32 s70, 0
L_hy_77:
  ds_read_b32 v9, v38 offset:316
  s_waitcnt lgkmcnt(0)
  v_cmp_gt_u32 vcc, s77, v9
  s_cmp_eq_u64 vcc, 0
  s_cbranch_scc1 L_hyd_78
  s_add_u32 s70, s70, 1
  s_cmp_lt_u32 s70, 2097152
  s_cbranch_scc1 L_hy_77
L_hyd_78:
  s_mov_b32 s44, s32
  s_mov_b32 s45, s33
  s_mov_b32 s46, 1409024
  s_mov_b32 s47, 0x20000
  v_lshlrev_b32 v2, 4, v1
  s_lshl2_add_u32 s49, s61, s5
  s_lshl_b32 s49, s49, 13
  s_mul_i32 s50, s5, 8448
  s_add_u32 s50, s50, 77824
  s_add_u32 s51, s50, 8448
L_dma_79:
  s_mov_b32 m0, s50
  s_add_u32 s50, s50, 1056
  buffer_load_dwordx4 v2, s[44:47], s49 offen nt lds
  s_add_u32 s49, s49, 1024
  s_waitcnt vmcnt(3)
  s_cmp_lt_u32 s50, s51
  s_cbranch_scc1 L_dma_79
L_dmae_80:
  s_bfe_u32 s32, s74, 0x80000
  s_bfe_u32 s33, s74, 0x80008
  s_bfe_u32 s34, s74, 0x80010
  s_bfe_u32 s35, s74, 0x80018
  v_add_u32 v4, 16384, v15
  v_add_u32 v0, 32768, v15
  v_add_u32 v36, 49152, v15
  global_load_dwordx2 v[8:9], v37, s[16:17]
  s_mov_b32 s70, 0
L_pg_81:
  global_load_dwordx4 v[136:139], v39, s[42:43] offset:-4096 sc1
  global_load_dwordx4 v[140:143], v39, s[42:43] offset:0 sc1
  v_add_u32 v3, 4096, v39
  global_load_dwordx4 v[144:147], v3, s[42:43] sc1
  s_waitcnt vmcnt(0)
  s_mov_b64 vcc, 0
  v_cmp_ne_u32 s[68:69], s74, v137
  s_or_b64 vcc, vcc, s[68:69]
  v_cmp_ne_u32 s[68:69], s74, v139
  s_or_b64 vcc, vcc, s[68:69]
  v_cmp_ne_u32 s[68:69], s74, v141
  s_or_b64 vcc, vcc, s[68:69]
  v_cmp_ne_u32 s[68:69], s74, v143
  s_or_b64 vcc, vcc, s[68:69]
  v_cmp_ne_u32 s[68:69], s74, v145
  s_or_b64 vcc, vcc, s[68:69]
  v_cmp_ne_u32 s[68:69], s74, v147
  s_or_b64 vcc, vcc, s[68:69]
  s_cmp_eq_u64 vcc, 0
  s_cbranch_scc1 L_pge_82
  s_sleep 8
  s_add_u32 s70, s70, 1
  s_cmp_lt_u32 s70, 262144
  s_cbranch_scc1 L_pg_81
L_pge_82:
  v_and_b32 v39, 1, v1
  v_lshlrev_b32 v39, 6, v39
  v_add_u32 v39, 10944, v39
  v_lshrrev_b32 v3, 4, v1
  v_lshl_add_u32 v37, v3, 4, v39
  v_bfe_u32 v3, v1, 1, 3
  v_lshlrev_b32 v3, 7, v3
  v_sub_u32 v37, v37, v3
  v_bfe_u32 v3, v1, 4, 1
  v_lshl_add_u32 v39, v3, 3, v39
  v_lshrrev_b32 v3, 5, v1
  v_lshl_add_u32 v39, v3, 2, v39
  s_lshl_b32 s49, s5, 4
  v_add_u32 v39, s49, v39
  v_lshlrev_b32 v16, 16, v8
  v_and_b32 v17, s73, v8
  v_lshlrev_b32 v18, 16, v9
  v_and_b32 v19, s73, v9
  v_lshlrev_b32 v20, 16, v136
  v_and_b32 v21, s73, v136
  v_lshlrev_b32 v22, 16, v138
  v_and_b32 v23, s73, v138
  v_lshlrev_b32 v28, 16, v144
  v_and_b32 v29, s73, v144
  v_lshlrev_b32 v30, 16, v146
  v_and_b32 v31, s73, v146
  v_add_f32 v28, 1.0, v28
  v_add_f32 v29, 1.0, v29
  v_add_f32 v30, 1.0, v30
  v_add_f32 v31, 1.0, v31
  v_cvt_pk_bf16_f32 v8, v28, v29
  v_cvt_pk_bf16_f32 v9, v30, v31
  v_mov_b32 v141, v142
  ds_write_b64 v12, v[8:9] offset:5312
  ds_write_b64 v12, v[140:141] offset:7424
  v_cvt_pk_bf16_f32 v28, 0, v28
  v_cvt_pk_bf16_f32 v29, 0, v29
  v_cvt_pk_bf16_f32 v30, 0, v30
  v_cvt_pk_bf16_f32 v31, 0, v31
  v_mul_f32 v24, v20, v28
  v_mul_f32 v25, v21, v29
  v_mul_f32 v26, v22, v30
  v_mul_f32 v27, v23, v31
  v_mul_f32 v28, v16, v28
  v_mul_f32 v29, v17, v29
  v_mul_f32 v30, v18, v30
  v_mul_f32 v31, v19, v31
  s_waitcnt lgkmcnt(0)
  s_waitcnt vmcnt(0)
  s_mov_b32 s70, 0
L_sn_83:
  ds_read_b32 v8, v38 offset:264
  s_waitcnt lgkmcnt(0)
  v_cmp_gt_u32 vcc, 0x8, v8
  s_cmp_eq_u64 vcc, 0
  s_cbranch_scc1 L_snd_84
  s_sleep 2
  s_add_u32 s70, s70, 1
  s_cmp_lt_u32 s70, 2097152
  s_cbranch_scc1 L_sn_83
L_snd_84:
  v_readfirstlane_b32 s37, v15
  s_mov_b32 s70, 0
  s_movk_i32 s71, 0xff
  s_sub_u32 s37, s37, 4096
  s_mov_b32 s36, 1
L_f1_p:
  s_add_u32 s70, s70, 1
  s_cmp_ge_u32 s70, 262144
  s_cbranch_scc1 L_f1_ok
  s_mov_b32 s63, s71
  s_bitcmp1_b32 s63, 0
  s_cbranch_scc0 L_fl_85
  global_load_dwordx4 v[104:107], v15, s[42:43] offset:-4096 sc1
L_fl_85:
  s_bitcmp1_b32 s63, 1
  s_cbranch_scc0 L_fl_86
  global_load_dwordx4 v[108:111], v15, s[42:43] offset:0 sc1
L_fl_86:
  s_bitcmp1_b32 s63, 2
  s_cbranch_scc0 L_fl_87
  global_load_dwordx4 v[112:115], v4, s[42:43] offset:-4096 sc1
L_fl_87:
  s_bitcmp1_b32 s63, 3
  s_cbranch_scc0 L_fl_88
  global_load_dwordx4 v[116:119], v4, s[42:43] offset:0 sc1
L_fl_88:
  s_bitcmp1_b32 s63, 4
  s_cbranch_scc0 L_fl_89
  global_load_dwordx4 v[120:123], v0, s[42:43] offset:-4096 sc1
L_fl_89:
  s_bitcmp1_b32 s63, 5
  s_cbranch_scc0 L_fl_90
  global_load_dwordx4 v[124:127], v0, s[42:43] offset:0 sc1
L_fl_90:
  s_bitcmp1_b32 s63, 6
  s_cbranch_scc0 L_fl_91
  global_load_dwordx4 v[128:131], v36, s[42:43] offset:-4096 sc1
L_fl_91:
  s_bitcmp1_b32 s63, 7
  s_cbranch_scc0 L_fl_92
  global_load_dwordx4 v[132:135], v36, s[42:43] offset:0 sc1
L_fl_92:
  s_waitcnt vmcnt(0)
  s_bitcmp1_b32 s63, 0
  s_cbranch_scc0 L_fc_93
  v_xor_b32 v104, s32, v104
  v_xor_b32 v105, s33, v105
  v_xor_b32 v106, s34, v106
  v_xor_b32 v107, s35, v107
  v_or3_b32 v8, v104, v105, v106
  v_or_b32 v8, v8, v107
  v_cmp_ne_u32_sdwa vcc, v8, v38 src0_sel:BYTE_0 src1_sel:DWORD
  s_cmp_lg_u64 vcc, 0
  s_cbranch_scc1 L_fc_93
  s_bitset0_b32 s71, 0
L_fc_93:
  s_bitcmp1_b32 s63, 1
  s_cbranch_scc0 L_fc_94
  v_xor_b32 v108, s32, v108
  v_xor_b32 v109, s33, v109
  v_xor_b32 v110, s34, v110
  v_xor_b32 v111, s35, v111
  v_or3_b32 v8, v108, v109, v110
  v_or_b32 v8, v8, v111
  v_cmp_ne_u32_sdwa vcc, v8, v38 src0_sel:BYTE_0 src1_sel:DWORD
  s_cmp_lg_u64 vcc, 0
  s_cbranch_scc1 L_fc_94
  s_bitset0_b32 s71, 1
L_fc_94:
  s_bitcmp1_b32 s63, 2
  s_cbranch_scc0 L_fc_95
  v_xor_b32 v112, s32, v112
  v_xor_b32 v113, s33, v113
  v_xor_b32 v114, s34, v114
  v_xor_b32 v115, s35, v115
  v_or3_b32 v8, v112, v113, v114
  v_or_b32 v8, v8, v115
  v_cmp_ne_u32_sdwa vcc, v8, v38 src0_sel:BYTE_0 src1_sel:DWORD
  s_cmp_lg_u64 vcc, 0
  s_cbranch_scc1 L_fc_95
  s_bitset0_b32 s71, 2
L_fc_95:
  s_bitcmp1_b32 s63, 3
  s_cbranch_scc0 L_fc_96
  v_xor_b32 v116, s32, v116
  v_xor_b32 v117, s33, v117
  v_xor_b32 v118, s34, v118
  v_xor_b32 v119, s35, v119
  v_or3_b32 v8, v116, v117, v118
  v_or_b32 v8, v8, v119
  v_cmp_ne_u32_sdwa vcc, v8, v38 src0_sel:BYTE_0 src1_sel:DWORD
  s_cmp_lg_u64 vcc, 0
  s_cbranch_scc1 L_fc_96
  s_bitset0_b32 s71, 3
L_fc_96:
  s_bitcmp1_b32 s63, 4
  s_cbranch_scc0 L_fc_97
  v_xor_b32 v120, s32, v120
  v_xor_b32 v121, s33, v121
  v_xor_b32 v122, s34, v122
  v_xor_b32 v123, s35, v123
  v_or3_b32 v8, v120, v121, v122
  v_or_b32 v8, v8, v123
  v_cmp_ne_u32_sdwa vcc, v8, v38 src0_sel:BYTE_0 src1_sel:DWORD
  s_cmp_lg_u64 vcc, 0
  s_cbranch_scc1 L_fc_97
  s_bitset0_b32 s71, 4
L_fc_97:
  s_bitcmp1_b32 s63, 5
  s_cbranch_scc0 L_fc_98
  v_xor_b32 v124, s32, v124
  v_xor_b32 v125, s33, v125
  v_xor_b32 v126, s34, v126
  v_xor_b32 v127, s35, v127
  v_or3_b32 v8, v124, v125, v126
  v_or_b32 v8, v8, v127
  v_cmp_ne_u32_sdwa vcc, v8, v38 src0_sel:BYTE_0 src1_sel:DWORD
  s_cmp_lg_u64 vcc, 0
  s_cbranch_scc1 L_fc_98
  s_bitset0_b32 s71, 5
L_fc_98:
  s_bitcmp1_b32 s63, 6
  s_cbranch_scc0 L_fc_99
  v_xor_b32 v128, s32, v128
  v_xor_b32 v129, s33, v129
  v_xor_b32 v130, s34, v130
  v_xor_b32 v131, s35, v131
  v_or3_b32 v8, v128, v129, v130
  v_or_b32 v8, v8, v131
  v_cmp_ne_u32_sdwa vcc, v8, v38 src0_sel:BYTE_0 src1_sel:DWORD
  s_cmp_lg_u64 vcc, 0
  s_cbranch_scc1 L_fc_99
  s_bitset0_b32 s71, 6
L_fc_99:
  s_bitcmp1_b32 s63, 7
  s_cbranch_scc0 L_fc_100
  v_xor_b32 v132, s32, v132
  v_xor_b32 v133, s33, v133
  v_xor_b32 v134, s34, v134
  v_xor_b32 v135, s35, v135
  v_or3_b32 v8, v132, v133, v134
  v_or_b32 v8, v8, v135
  v_cmp_ne_u32_sdwa vcc, v8, v38 src0_sel:BYTE_0 src1_sel:DWORD
  s_cmp_lg_u64 vcc, 0
  s_cbranch_scc1 L_fc_100
  s_bitset0_b32 s71, 7
L_fc_100:
  s_cmp_lg_u32 s71, 0
  s_cbranch_scc1 L_f1_p
L_f1_ok:
  v_pk_add_f32 v[136:137], v[104:105], v[108:109]
  v_pk_add_f32 v[138:139], v[106:107], v[110:111]
  v_pk_add_f32 v[144:145], v[112:113], v[116:117]
  v_pk_add_f32 v[146:147], v[114:115], v[118:119]
  v_pk_add_f32 v[152:153], v[120:121], v[124:125]
  v_pk_add_f32 v[154:155], v[122:123], v[126:127]
  v_pk_add_f32 v[160:161], v[128:129], v[132:133]
  v_pk_add_f32 v[162:163], v[130:131], v[134:135]
  v_pk_add_f32 v[136:137], v[136:137], v[144:145]
  v_pk_add_f32 v[138:139], v[138:139], v[146:147]
  v_pk_add_f32 v[152:153], v[152:153], v[160:161]
  v_pk_add_f32 v[154:155], v[154:155], v[162:163]
  v_pk_add_f32 v[136:137], v[136:137], v[152:153]
  v_pk_add_f32 v[138:139], v[138:139], v[154:155]
  v_pk_fma_f32 v[8:9], v[136:137], v[24:25], v[28:29]
  v_pk_fma_f32 v[10:11], v[138:139], v[26:27], v[30:31]
  v_cvt_pk_bf16_f32 v8, v8, v9
  v_cvt_pk_bf16_f32 v9, v10, v11
  ds_write_b64 v12, v[8:9] offset:3200
  v_pk_fma_f32 v[16:17], v[136:137], v[20:21], v[16:17]
  v_pk_fma_f32 v[18:19], v[138:139], v[22:23], v[18:19]
  v_add_f32 v24, v16, v17
  v_mul_f32 v25, v16, v16
  v_add_f32 v26, v18, v19
  v_mul_f32 v27, v18, v18
  v_fmac_f32 v25, v17, v17
  v_fmac_f32 v27, v19, v19
  v_pk_add_f32 v[24:25], v[24:25], v[26:27]
  s_nop 1
  v_add_f32_dpp v24, v24, v24 quad_perm:[1,0,3,2] row_mask:0xf bank_mask:0xf
  v_add_f32_dpp v25, v25, v25 quad_perm:[1,0,3,2] row_mask:0xf bank_mask:0xf
  s_nop 0
  v_add_f32_dpp v24, v24, v24 quad_perm:[2,3,0,1] row_mask:0xf bank_mask:0xf
  v_add_f32_dpp v25, v25, v25 quad_perm:[2,3,0,1] row_mask:0xf bank_mask:0xf
  ds_write_b64 v5, v[24:25]
  s_add_u32 s77, s77, 4
  v_mov_b32 v10, 1
  s_mov_b64 exec, 1
  ds_add_u32 v38, v10 offset:316
  s_mov_b64 exec, -1
  s_mov_b32 s70, 0
L_hy_101:
  ds_read_b32 v10, v38 offset:316
  ds_read_b128 v[136:139], v14 offset:3200
  ds_read_b128 v[140:143], v14 offset:3264
  ds_read_b128 v[144:147], v14 offset:3328
  ds_read_b128 v[148:151], v14 offset:3392
  s_waitcnt lgkmcnt(4)
  v_cmp_gt_u32 vcc, s77, v10
  s_cmp_eq_u64 vcc, 0
  s_cbranch_scc1 L_hyd_102
  s_waitcnt lgkmcnt(0)
  s_add_u32 s70, s70, 1
  s_cmp_lt_u32 s70, 2097152
  s_cbranch_scc1 L_hy_101
L_hyd_102:
  ds_read_b64 v[20:21], v7
  ds_read_b128 v[152:155], v14 offset:3456
  ds_read_b128 v[156:159], v14 offset:3520
  ds_read_b128 v[160:163], v14 offset:3584
  ds_read_b128 v[164:167], v14 offset:3648
  s_waitcnt lgkmcnt(8)
  v_mfma_f32_16x16x32_bf16 v[32:35], v[40:43], v[136:139], 0
  s_waitcnt lgkmcnt(7)
  v_mfma_f32_16x16x32_bf16 v[32:35], v[44:47], v[140:143], v[32:35]
  ds_read_b128 v[136:139], v14 offset:3712
  s_waitcnt lgkmcnt(7)
  v_mfma_f32_16x16x32_bf16 v[32:35], v[48:51], v[144:147], v[32:35]
  ds_read_b128 v[140:143], v14 offset:3776
  s_waitcnt lgkmcnt(7)
  v_mfma_f32_16x16x32_bf16 v[32:35], v[52:55], v[148:151], v[32:35]
  ds_read_b128 v[144:147], v14 offset:3840
  s_waitcnt lgkmcnt(6)
  v_mfma_f32_16x16x32_bf16 v[32:35], v[56:59], v[152:155], v[32:35]
  ds_read_b128 v[148:151], v14 offset:3904
  v_add_f32_dpp v20, v20, v20 quad_perm:[2,3,0,1] row_mask:0xf bank_mask:0xf
  v_add_f32_dpp v21, v21, v21 quad_perm:[2,3,0,1] row_mask:0xf bank_mask:0xf
  s_waitcnt lgkmcnt(6)
  v_mfma_f32_16x16x32_bf16 v[32:35], v[60:63], v[156:159], v[32:35]
  ds_read_b128 v[152:155], v14 offset:3968
  v_add_f32_dpp v20, v20, v20 row_ror:4 row_mask:0xf bank_mask:0xf
  v_add_f32_dpp v21, v21, v21 row_ror:4 row_mask:0xf bank_mask:0xf
  s_waitcnt lgkmcnt(6)
  v_mfma_f32_16x16x32_bf16 v[32:35], v[64:67], v[160:163], v[32:35]
  ds_read_b128 v[156:159], v14 offset:4032
  v_add_f32_dpp v20, v20, v20 row_ror:8 row_mask:0xf bank_mask:0xf
  v_add_f32_dpp v21, v21, v21 row_ror:8 row_mask:0xf bank_mask:0xf
  s_waitcnt lgkmcnt(6)
  v_mfma_f32_16x16x32_bf16 v[32:35], v[68:71], v[164:167], v[32:35]
  ds_read_b128 v[160:163], v14 offset:4096
  v_mov_b32 v22, v20
  v_mov_b32 v23, v21
  s_waitcnt lgkmcnt(6)
  v_mfma_f32_16x16x32_bf16 v[32:35], v[72:75], v[136:139], v[32:35]
  ds_read_b128 v[164:167], v14 offset:4160
  v_permlane16_swap_b32 v22, v20
  v_permlane16_swap_b32 v23, v21
  s_waitcnt lgkmcnt(6)
  v_mfma_f32_16x16x32_bf16 v[32:35], v[76:79], v[140:143], v[32:35]
  v_pk_add_f32 v[20:21], v[20:21], v[22:23]
  v_mov_b32 v22, v20
  v_mov_b32 v23, v21
  s_waitcnt lgkmcnt(5)
  v_mfma_f32_16x16x32_bf16 v[32:35], v[80:83], v[144:147], v[32:35]
  v_permlane32_swap_b32 v22, v20
  v_permlane32_swap_b32 v23, v21
  s_waitcnt lgkmcnt(4)
  v_mfma_f32_16x16x32_bf16 v[32:35], v[84:87], v[148:151], v[32:35]
  v_pk_add_f32 v[20:21], v[20:21], v[22:23]
  v_mul_f32 v20, 0xbb000000, v20
  s_waitcnt lgkmcnt(3)
  v_mfma_f32_16x16x32_bf16 v[32:35], v[88:91], v[152:155], v[32:35]
  v_mul_f32 v21, 0x3b000000, v21
  v_fma_f32 v21, -v20, v20, v21
  s_waitcnt lgkmcnt(2)
  v_mfma_f32_16x16x32_bf16 v[32:35], v[92:95], v[156:159], v[32:35]
  v_max_f32 v21, 0, v21
  v_add_f32 v21, 0x3727c5ac, v21
  s_waitcnt lgkmcnt(1)
  v_mfma_f32_16x16x32_bf16 v[32:35], v[96:99], v[160:163], v[32:35]
  v_rsq_f32 v21, v21
  s_waitcnt lgkmcnt(0)
  v_mfma_f32_16x16x32_bf16 v[32:35], v[100:103], v[164:167], v[32:35]
  ds_read_b64_tr_b16 v[40:41], v6 offset:0
  ds_read_b64_tr_b16 v[42:43], v6 offset:4224
  ds_read_b64_tr_b16 v[44:45], v6 offset:32
  ds_read_b64_tr_b16 v[46:47], v6 offset:4256
  ds_read_b64_tr_b16 v[48:49], v6 offset:64
  ds_read_b64_tr_b16 v[50:51], v6 offset:4288
  ds_read_b64_tr_b16 v[52:53], v6 offset:96
  ds_read_b64_tr_b16 v[54:55], v6 offset:4320
  v_fmac_f32_dpp v32, v32, v20 row_shl:2 row_mask:0xf bank_mask:0x1
  v_fmac_f32_dpp v33, v33, v20 row_shl:2 row_mask:0xf bank_mask:0x1
  v_fmac_f32_dpp v34, v34, v20 row_shl:2 row_mask:0xf bank_mask:0x1
  v_fmac_f32_dpp v35, v35, v20 row_shl:2 row_mask:0xf bank_mask:0x1
  v_mul_f32 v8, v32, v21
  v_mul_f32 v9, v33, v21
  v_mul_f32 v10, v34, v21
  v_mul_f32 v11, v35, v21
  v_add_f32_dpp v8, v32, v8 row_shl:4 row_mask:0xf bank_mask:0xf
  v_add_f32_dpp v9, v33, v9 row_shl:4 row_mask:0xf bank_mask:0xf
  v_add_f32_dpp v10, v34, v10 row_shl:4 row_mask:0xf bank_mask:0xf
  v_add_f32_dpp v11, v35, v11 row_shl:4 row_mask:0xf bank_mask:0xf
  s_waitcnt lgkmcnt(4)
  ds_read_b64_tr_b16 v[56:57], v6 offset:128
  ds_read_b64_tr_b16 v[58:59], v6 offset:4352
  ds_read_b64_tr_b16 v[60:61], v6 offset:160
  ds_read_b64_tr_b16 v[62:63], v6 offset:4384
  ds_read_b64_tr_b16 v[64:65], v6 offset:192
  ds_read_b64_tr_b16 v[66:67], v6 offset:4416
  ds_read_b64_tr_b16 v[68:69], v6 offset:224
  ds_read_b64_tr_b16 v[70:71], v6 offset:4448
  v_permlane32_swap_b32 v8, v10
  v_permlane32_swap_b32 v9, v11
  v_mul_f32 v20, 0xbfb8aa3b, v8
  v_mul_f32 v21, 0xbfb8aa3b, v9
  v_exp_f32 v20, v20
  v_exp_f32 v21, v21
  v_mul_f32 v8, v8, v10
  v_mul_f32 v9, v9, v11
  v_add_f32 v20, 1.0, v20
  v_add_f32 v21, 1.0, v21
  v_rcp_f32 v20, v20
  v_rcp_f32 v21, v21
  s_mov_b32 exec_lo, 0x00030003
  s_mov_b32 exec_hi, 0x00030003
  v_mul_f32 v8, v8, v20
  v_mul_f32 v9, v9, v21
  v_cvt_pk_bf16_f32 v8, v8, v9
  ds_write_b32 v39, v8
  s_mov_b64 exec, -1
  s_waitcnt lgkmcnt(4)
  s_add_u32 s77, s77, 4
  v_mov_b32 v10, 1
  s_mov_b64 exec, 1
  ds_add_u32 v38, v10 offset:316
  s_mov_b64 exec, -1
  s_mov_b32 s70, 0
L_hy_103:
  ds_read_b32 v10, v38 offset:316
  ds_read_b128 v[136:139], v37 offset:0
  ds_read_b128 v[140:143], v37 offset:128
  ds_read_b128 v[144:147], v37 offset:256
  ds_read_b128 v[148:151], v37 offset:384
  s_waitcnt lgkmcnt(4)
  v_cmp_gt_u32 vcc, s77, v10
  s_cmp_eq_u64 vcc, 0
  s_cbranch_scc1 L_hyd_104
  s_waitcnt lgkmcnt(0)
  s_add_u32 s70, s70, 1
  s_cmp_lt_u32 s70, 2097152
  s_cbranch_scc1 L_hy_103
L_hyd_104:
  ds_read_b128 v[152:155], v37 offset:512
  ds_read_b128 v[156:159], v37 offset:640
  ds_read_b128 v[160:163], v37 offset:768
  ds_read_b128 v[164:167], v37 offset:896
  v_mov_b32 v3, 0xff
  s_waitcnt lgkmcnt(7)
  v_mfma_f32_16x16x32_bf16 v[8:11], v[40:43], v[136:139], 0
  s_waitcnt lgkmcnt(6)
  v_mfma_f32_16x16x32_bf16 v[8:11], v[44:47], v[140:143], v[8:11]
  s_waitcnt lgkmcnt(5)
  v_mfma_f32_16x16x32_bf16 v[8:11], v[48:51], v[144:147], v[8:11]
  s_waitcnt lgkmcnt(4)
  v_mfma_f32_16x16x32_bf16 v[8:11], v[52:55], v[148:151], v[8:11]
  s_waitcnt lgkmcnt(3)
  v_mfma_f32_16x16x32_bf16 v[8:11], v[56:59], v[152:155], v[8:11]
  s_waitcnt lgkmcnt(2)
  v_mfma_f32_16x16x32_bf16 v[8:11], v[60:63], v[156:159], v[8:11]
  s_waitcnt lgkmcnt(1)
  v_mfma_f32_16x16x32_bf16 v[8:11], v[64:67], v[160:163], v[8:11]
  s_waitcnt lgkmcnt(0)
  v_mfma_f32_16x16x32_bf16 v[8:11], v[68:71], v[164:167], v[8:11]
  s_nop 7
  v_bfi_b32 v8, v3, s32, v8
  v_bfi_b32 v9, v3, s33, v9
  v_bfi_b32 v10, v3, s34, v10
  v_bfi_b32 v11, v3, s35, v11
  global_store_dwordx4 v13, v[8:11], s[42:43] sc1
  s_branch L_fin
L_r_f2:
  v_bfe_u32 v12, v1, 2, 1
  v_and_b32 v14, 3, v1
  s_lshl_b32 s49, s61, 5
  v_lshl_add_u32 v3, v14, 3, s49
  v_lshl_add_u32 v37, v12, 10, v3
  v_and_b32 v15, 7, v1
  s_lshl_b32 s49, s61, 7
  v_lshl_add_u32 v15, v15, 4, s49
  v_add_u32 v39, 16384, v15
  v_bfe_u32 v3, v1, 3, 1
  v_lshl_add_u32 v15, v3, 12, v15
  v_lshrrev_b32 v3, 4, v1
  v_lshl_add_u32 v15, v3, 14, v15
  s_and_b32 s59, s2, 1
  s_lshl_b32 s59, s59, 16
  s_add_u32 s59, s59, 2097152
  v_add_u32 v15, s59, v15
  s_lshl_b32 s49, s61, 14
  s_add_u32 s49, s49, 1574912
  v_lshl_add_u32 v36, v1, 4, s49
  global_load_dword v11, v37, s[38:39]
  s_lshl_b32 s49, s61, 14
  s_add_u32 s49, s49, 1572864
  v_min_u32 v10, 42, v1
  v_lshl_add_u32 v10, v10, 7, s49
  global_load_dword v11, v10, s[42:43] sc1
  s_lshl_b32 s49, s61, 7
  s_add_u32 s49, s49, 28672
  v_mov_b32 v10, s49
  global_load_dword v11, v10, s[42:43] sc1
  global_load_dwordx2 v[8:9], v37, s[16:17]
  s_mov_b32 s70, 0
L_pg_105:
  global_load_dwordx4 v[136:139], v39, s[42:43] offset:-4096 sc1
  v_add_u32 v3, 8192, v39
  global_load_dwordx4 v[140:143], v3, s[42:43] sc1
  s_waitcnt vmcnt(0)
  s_mov_b64 vcc, 0
  v_cmp_ne_u32 s[68:69], s74, v137
  s_or_b64 vcc, vcc, s[68:69]
  v_cmp_ne_u32 s[68:69], s74, v139
  s_or_b64 vcc, vcc, s[68:69]
  v_cmp_ne_u32 s[68:69], s74, v141
  s_or_b64 vcc, vcc, s[68:69]
  v_cmp_ne_u32 s[68:69], s74, v143
  s_or_b64 vcc, vcc, s[68:69]
  s_cmp_eq_u64 vcc, 0
  s_cbranch_scc1 L_pge_106
  s_sleep 8
  s_add_u32 s70, s70, 1
  s_cmp_lt_u32 s70, 262144
  s_cbranch_scc1 L_pg_105
L_pge_106:
  v_lshlrev_b32 v16, 16, v8
  v_and_b32 v17, s73, v8
  v_lshlrev_b32 v18, 16, v9
  v_and_b32 v19, s73, v9
  v_lshlrev_b32 v20, 16, v136
  v_and_b32 v21, s73, v136
  v_lshlrev_b32 v22, 16, v138
  v_and_b32 v23, s73, v138
  v_lshlrev_b32 v24, 16, v140
  v_and_b32 v25, s73, v140
  v_lshlrev_b32 v26, 16, v142
  v_and_b32 v27, s73, v142
  s_mov_b32 s70, 0
L_sn_107:
  ds_read_b32 v8, v38 offset:264
  s_waitcnt lgkmcnt(0)
  v_cmp_gt_u32 vcc, 0x8, v8
  s_cmp_eq_u64 vcc, 0
  s_cbranch_scc1 L_snd_108
  s_sleep 2
  s_add_u32 s70, s70, 1
  s_cmp_lt_u32 s70, 2097152
  s_cbranch_scc1 L_sn_107
L_snd_108:
  s_mov_b32 s70, 0
L_f2_a:
  global_load_dwordx4 v[136:139], v15, s[42:43] sc1
  s_waitcnt vmcnt(0)
  v_xor_b32 v136, s32, v136
  v_xor_b32 v137, s33, v137
  v_xor_b32 v138, s34, v138
  v_xor_b32 v139, s35, v139
  v_or3_b32 v3, v136, v137, v138
  v_or_b32 v3, v3, v139
  v_lshlrev_b32 v3, 24, v3
  v_cmp_ne_u32 vcc, 0, v3
  s_cmp_eq_u64 vcc, 0
  s_cbranch_scc1 L_f2_ad
  s_sleep 4
  s_add_u32 s70, s70, 1
  s_cmp_lt_u32 s70, 262144
  s_cbranch_scc1 L_f2_a
L_f2_ad:
  s_cmp_lg_u32 s61, 0
  s_cbranch_scc1 L_f2_e
  v_mov_b32 v10, s74
  s_mov_b64 exec, 1
  global_store_dword v38, v10, s[42:43] offset:0 sc1
  s_mov_b64 exec, -1
L_f2_e:
  s_nop 1
  v_add_f32_dpp v136, v136, v136 row_ror:8 row_mask:0xf bank_mask:0xf
  v_add_f32_dpp v137, v137, v137 row_ror:8 row_mask:0xf bank_mask:0xf
  v_add_f32_dpp v138, v138, v138 row_ror:8 row_mask:0xf bank_mask:0xf
  v_add_f32_dpp v139, v139, v139 row_ror:8 row_mask:0xf bank_mask:0xf
  v_mov_b32 v140, v136
  v_mov_b32 v141, v137
  v_mov_b32 v142, v138
  v_mov_b32 v143, v139
  v_permlane16_swap_b32 v140, v136
  v_permlane16_swap_b32 v141, v137
  v_permlane16_swap_b32 v142, v138
  v_permlane16_swap_b32 v143, v139
  v_add_f32 v136, v136, v140
  v_add_f32 v137, v137, v141
  v_add_f32 v138, v138, v142
  v_add_f32 v139, v139, v143
  v_mov_b32 v140, v136
  v_mov_b32 v141, v137
  v_mov_b32 v142, v138
  v_mov_b32 v143, v139
  v_permlane32_swap_b32 v140, v136
  v_permlane32_swap_b32 v141, v137
  v_permlane32_swap_b32 v142, v138
  v_permlane32_swap_b32 v143, v139
  v_add_f32 v136, v136, v140
  v_add_f32 v137, v137, v141
  v_add_f32 v138, v138, v142
  v_add_f32 v139, v139, v143
  v_cvt_pk_bf16_f32 v136, 0, v136
  v_cvt_pk_bf16_f32 v137, 0, v137
  v_cvt_pk_bf16_f32 v138, 0, v138
  v_cvt_pk_bf16_f32 v139, 0, v139
  v_mul_f32 v136, v136, v20
  v_mul_f32 v137, v137, v21
  v_mul_f32 v138, v138, v22
  v_mul_f32 v139, v139, v23
  v_cvt_pk_bf16_f32 v136, 0, v136
  v_cvt_pk_bf16_f32 v137, 0, v137
  v_cvt_pk_bf16_f32 v138, 0, v138
  v_cvt_pk_bf16_f32 v139, 0, v139
  v_add_f32 v16, v16, v136
  v_add_f32 v17, v17, v137
  v_add_f32 v18, v18, v138
  v_add_f32 v19, v19, v139
  v_cvt_pk_bf16_f32 v16, 0, v16
  v_cvt_pk_bf16_f32 v17, 0, v17
  v_cvt_pk_bf16_f32 v18, 0, v18
  v_cvt_pk_bf16_f32 v19, 0, v19
  v_mov_b32 v156, s32
  v_mov_b32 v157, s33
  v_mov_b32 v158, s34
  v_mov_b32 v159, s35
  s_mov_b64 s[20:21], -1
  s_mov_b64 s[22:23], -1
  s_mov_b64 s[24:25], -1
  s_mov_b64 s[26:27], -1
  s_mov_b64 s[28:29], -1
  s_mov_b64 s[30:31], 0xffffff
  s_mov_b64 exec, s[20:21]
  global_load_dwordx4 v[136:139], v36, s[42:43] offset:-2048 sc1
  s_mov_b64 exec, s[22:23]
  global_load_dwordx4 v[140:143], v36, s[42:43] offset:-1024 sc1
  s_mov_b64 exec, s[24:25]
  global_load_dwordx4 v[144:147], v36, s[42:43] offset:0 sc1
  s_mov_b64 exec, s[26:27]
  global_load_dwordx4 v[148:151], v36, s[42:43] offset:1024 sc1
  s_mov_b64 exec, s[28:29]
  global_load_dwordx4 v[152:155], v36, s[42:43] offset:2048 sc1
  s_mov_b64 exec, s[30:31]
  global_load_dwordx4 v[156:159], v36, s[42:43] offset:3072 sc1
  s_mov_b64 exec, -1
  s_waitcnt vmcnt(0)
  s_mov_b32 s70, 0
  s_branch L_f2_pc
L_f2_p:
  s_mov_b64 exec, s[20:21]
  global_load_dwordx4 v[136:139], v36, s[42:43] offset:-2048 sc1
  s_mov_b64 exec, s[22:23]
  global_load_dwordx4 v[140:143], v36, s[42:43] offset:-1024 sc1
  s_mov_b64 exec, s[24:25]
  global_load_dwordx4 v[144:147], v36, s[42:43] offset:0 sc1
  s_mov_b64 exec, s[26:27]
  global_load_dwordx4 v[148:151], v36, s[42:43] offset:1024 sc1
  s_mov_b64 exec, s[28:29]
  global_load_dwordx4 v[152:155], v36, s[42:43] offset:2048 sc1
  s_mov_b64 exec, s[30:31]
  global_load_dwordx4 v[156:159], v36, s[42:43] offset:3072 sc1
  s_mov_b64 exec, -1
  s_waitcnt vmcnt(0)
L_f2_pc:
  v_xor_b32 v104, s32, v136
  v_xor_b32 v105, s33, v137
  v_xor_b32 v106, s34, v138
  v_xor_b32 v107, s35, v139
  v_xor_b32 v108, s32, v140
  v_xor_b32 v109, s33, v141
  v_xor_b32 v110, s34, v142
  v_xor_b32 v111, s35, v143
  v_xor_b32 v112, s32, v144
  v_xor_b32 v113, s33, v145
  v_xor_b32 v114, s34, v146
  v_xor_b32 v115, s35, v147
  v_xor_b32 v116, s32, v148
  v_xor_b32 v117, s33, v149
  v_xor_b32 v118, s34, v150
  v_xor_b32 v119, s35, v151
  v_xor_b32 v120, s32, v152
  v_xor_b32 v121, s33, v153
  v_xor_b32 v122, s34, v154
  v_xor_b32 v123, s35, v155
  v_xor_b32 v124, s32, v156
  v_xor_b32 v125, s33, v157
  v_xor_b32 v126, s34, v158
  v_xor_b32 v127, s35, v159
  v_or3_b32 v28, v104, v105, v106
  v_or3_b32 v29, v108, v109, v110
  v_or3_b32 v30, v112, v113, v114
  v_or3_b32 v31, v116, v117, v118
  v_or3_b32 v32, v120, v121, v122
  v_or3_b32 v33, v124, v125, v126
  v_or_b32 v28, v28, v107
  v_or_b32 v29, v29, v111
  v_or_b32 v30, v30, v115
  v_or_b32 v31, v31, v119
  v_or_b32 v32, v32, v123
  v_or_b32 v33, v33, v127
  v_cmp_ne_u32_sdwa s[20:21], v28, v38 src0_sel:BYTE_0 src1_sel:DWORD
  v_cmp_ne_u32_sdwa s[22:23], v29, v38 src0_sel:BYTE_0 src1_sel:DWORD
  v_cmp_ne_u32_sdwa s[24:25], v30, v38 src0_sel:BYTE_0 src1_sel:DWORD
  v_cmp_ne_u32_sdwa s[26:27], v31, v38 src0_sel:BYTE_0 src1_sel:DWORD
  v_cmp_ne_u32_sdwa s[28:29], v32, v38 src0_sel:BYTE_0 src1_sel:DWORD
  v_cmp_ne_u32_sdwa s[30:31], v33, v38 src0_sel:BYTE_0 src1_sel:DWORD
  v_pk_add_f32 v[104:105], v[104:105], v[108:109]
  v_pk_add_f32 v[106:107], v[106:107], v[110:111]
  v_pk_add_f32 v[112:113], v[112:113], v[116:117]
  v_pk_add_f32 v[114:115], v[114:115], v[118:119]
  v_pk_add_f32 v[120:121], v[120:121], v[124:125]
  v_pk_add_f32 v[122:123], v[122:123], v[126:127]
  v_pk_add_f32 v[104:105], v[104:105], v[112:113]
  v_pk_add_f32 v[106:107], v[106:107], v[114:115]
  v_pk_add_f32 v[104:105], v[104:105], v[120:121]
  v_pk_add_f32 v[106:107], v[106:107], v[122:123]
  s_mov_b64 vcc, s[20:21]
  s_or_b64 vcc, vcc, s[22:23]
  s_or_b64 vcc, vcc, s[24:25]
  s_or_b64 vcc, vcc, s[26:27]
  s_or_b64 vcc, vcc, s[28:29]
  s_or_b64 vcc, vcc, s[30:31]
  s_or_b32 s20, s20, 1
  s_or_b32 s22, s22, 1
  s_or_b32 s24, s24, 1
  s_or_b32 s26, s26, 1
  s_or_b32 s28, s28, 1
  s_or_b32 s30, s30, 1
  s_cmp_eq_u64 vcc, 0
  s_cbranch_scc1 L_f2_pok
  s_add_u32 s70, s70, 1
  s_cmp_lt_u32 s70, 262144
  s_cbranch_scc1 L_f2_p
L_f2_pok:
  s_nop 1
  v_add_f32_dpp v104, v104, v104 row_ror:8 row_mask:0xf bank_mask:0xf
  v_add_f32_dpp v105, v105, v105 row_ror:8 row_mask:0xf bank_mask:0xf
  v_add_f32_dpp v106, v106, v106 row_ror:8 row_mask:0xf bank_mask:0xf
  v_add_f32_dpp v107, v107, v107 row_ror:8 row_mask:0xf bank_mask:0xf
  v_mov_b32 v108, v104
  v_mov_b32 v109, v105
  v_mov_b32 v110, v106
  v_mov_b32 v111, v107
  v_permlane16_swap_b32 v108, v104
  v_permlane16_swap_b32 v109, v105
  v_permlane16_swap_b32 v110, v106
  v_permlane16_swap_b32 v111, v107
  v_add_f32 v104, v104, v108
  v_add_f32 v105, v105, v109
  v_add_f32 v106, v106, v110
  v_add_f32 v107, v107, v111
  v_mov_b32 v108, v104
  v_mov_b32 v109, v105
  v_mov_b32 v110, v106
  v_mov_b32 v111, v107
  v_permlane32_swap_b32 v108, v104
  v_permlane32_swap_b32 v109, v105
  v_permlane32_swap_b32 v110, v106
  v_permlane32_swap_b32 v111, v107
  v_add_f32 v104, v104, v108
  v_add_f32 v105, v105, v109
  v_add_f32 v106, v106, v110
  v_add_f32 v107, v107, v111
  v_cvt_pk_bf16_f32 v104, 0, v104
  v_cvt_pk_bf16_f32 v105, 0, v105
  v_cvt_pk_bf16_f32 v106, 0, v106
  v_cvt_pk_bf16_f32 v107, 0, v107
  v_mul_f32 v104, v104, v24
  v_mul_f32 v105, v105, v25
  v_mul_f32 v106, v106, v26
  v_mul_f32 v107, v107, v27
  v_cvt_pk_bf16_f32 v104, 0, v104
  v_cvt_pk_bf16_f32 v105, 0, v105
  v_cvt_pk_bf16_f32 v106, 0, v106
  v_cvt_pk_bf16_f32 v107, 0, v107
  v_add_f32 v8, v104, v16
  v_add_f32 v9, v105, v17
  v_add_f32 v10, v106, v18
  v_add_f32 v11, v107, v19
  v_cvt_pk_bf16_f32 v8, v8, v9
  v_cvt_pk_bf16_f32 v9, v10, v11
  s_mov_b64 exec, 0xff
  global_store_dwordx2 v37, v[8:9], s[38:39] sc1
  s_mov_b64 exec, 1
  v_mov_b32 v10, s74
  s_lshl_b32 s49, s61, 7
  s_add_u32 s49, s49, 28672
  v_mov_b32 v11, s49
  global_store_dword v11, v10, s[42:43] sc1
L_fin:
L_end:
  s_endpgm
.p2align 7
L_table:
  .long 0xff00ff13, 0x1504ff14, 0xff08ff1b, 0x1d0cff1c, 0xff10ff23, 0xff14ff24, 0xff18ff2b, 0x2d1cff2c
  .long 0xff01ff10, 0x1705ff16, 0xff09ff18, 0x1f0dff1e, 0xff11ff20, 0xff15ff25, 0xff19ff28, 0x2f1dff2e
  .long 0x1202ff11, 0xff0605ff, 0x1a0aff19, 0xff0e10ff, 0x2212ff21, 0x2716ff26, 0x2a1aff29, 0xff1e25ff
  .long 0xffff00ff, 0xffff06ff, 0xffff0bff, 0xffff11ff, 0xffff16ff, 0xffff1bff, 0xffff20ff, 0xffff26ff
  .long 0xffff01ff, 0xffff07ff, 0xffff0cff, 0xffff12ff, 0xffff17ff, 0xffff1cff, 0xffff21ff, 0xffff27ff
  .long 0xffff02ff, 0xffff08ff, 0xffff0dff, 0xffff13ff, 0xffff18ff, 0xffff1dff, 0xffff22ff, 0xffff28ff
  .long 0xffff03ff, 0xffff09ff, 0xffff0eff, 0xffff14ff, 0xffff19ff, 0xffff1eff, 0xffff23ff, 0xffff29ff
  .long 0xff0304ff, 0xff070aff, 0xff0b0fff, 0xff0f15ff, 0xff131aff, 0xff171fff, 0xff1b24ff, 0xff1f2aff
L_touch:
  .long 0x80804101, 0x80804909, 0x80804303, 0x80808080, 0x80804b0b, 0x80804505, 0x80804d0d, 0x80808080
  .long 0x80804707, 0x80804f0f, 0x80805900, 0x80808080, 0x80805b08, 0x80805d02, 0x80805f0a, 0x80808080
  .long 0x80805804, 0x80805a0c, 0x80805c06, 0x80808080, 0x80805e0e, 0x80805140, 0x80806148, 0x80808080
  .long 0x80806942, 0x8080714a, 0x80807944, 0x80808080, 0x8080534c, 0x80806346, 0x80806b4e, 0x80808080
.section .rodata,"a"
.p2align 6
.amdhsa_kernel adaLN_cond__sliding_block_cached__glu_gated_swiglu__decode_kernel
  .amdhsa_next_free_vgpr 168
  .amdhsa_next_free_sgpr 102
  .amdhsa_accum_offset 168
  .amdhsa_group_segment_fixed_size 0
  .amdhsa_kernarg_size 112
  .amdhsa_user_sgpr_count 2
  .amdhsa_user_sgpr_kernarg_segment_ptr 1
  .amdhsa_system_sgpr_workgroup_id_x 1
.end_amdhsa_kernel
```

```asm
; @launch grid=(256,1,1) block=(768,1,1) lds=143360
.amdgcn_target "amdgcn-amd-amdhsa--gfx950"
.text
.globl adaLN_cond__sliding_block_cached__glu_gated_swiglu__decode_kernel
.p2align 8
.type adaLN_cond__sliding_block_cached__glu_gated_swiglu__decode_kernel,@function
adaLN_cond__sliding_block_cached__glu_gated_swiglu__decode_kernel:
  s_cmp_ge_u32 s2, 256
  s_cbranch_scc1 L_end
  s_load_dwordx16 s[16:31], s[0:1], 0
  s_load_dwordx8 s[32:39], s[0:1], 64
  s_load_dwordx4 s[40:43], s[0:1], 96
  v_lshrrev_b32 v2, 6, v0
  v_and_b32 v1, 63, v0
  v_readfirstlane_b32 s13, v2
  s_bfe_u32 s7, s2, 0x20003
  s_bfe_u32 s6, s2, 0x20005
  s_and_b32 s8, s2, 7
  s_lshl2_add_u32 s6, s8, s6
  s_and_b32 s9, s2, 0x80
  s_lshr_b32 s9, s9, 2
  s_add_u32 s6, s6, s9
  s_mov_b32 s72, 0xfffffffe
  s_mov_b32 s73, 0xffff0000
  s_cmp_eq_u32 s7, 3
  s_cbranch_scc1 L_serv
  s_cmp_eq_u32 s13, 0
  s_cbranch_scc1 L_pub
L_stream:
  s_sub_u32 s9, s13, 1
  s_lshl_b32 s11, s9, 10
  s_mul_i32 s4, s7, 349184
  s_lshl_b32 s10, s6, 22
  s_add_u32 s10, s10, s4
  s_add_u32 s10, s10, 0x300000
  v_and_b32 v0, 15, v1
  v_lshl_add_u32 v0, v0, 6, s11
  v_and_b32 v3, 48, v1
  v_add_u32 v0, v3, v0
  s_lshr_b32 s12, s2, 3
  s_mul_i32 s12, s12, 5
  s_mul_i32 s15, s8, 3
  s_add_u32 s12, s12, s15
  s_and_b32 s15, s12, 31
  s_min_u32 s15, s15, 30
  s_mul_i32 s12, s15, 11264
  s_lshr_b32 s46, s7, 1
  s_lshl_b32 s46, s46, 10
  s_add_u32 s46, s46, 349184
  s_mov_b32 s47, 0x20000
  s_mov_b32 s14, 349184
  s_waitcnt lgkmcnt(0)
  s_add_u32 s44, s18, s10
  s_addc_u32 s45, s19, 0
  buffer_load_dwordx4 v[44:47], v0, s[44:47], s12 offen nt
  s_add_u32 s12, s12, 11264
  s_cmp_eq_u32 s12, s14
  s_cselect_b32 s12, 0, s12
  buffer_load_dwordx4 v[48:51], v0, s[44:47], s12 offen nt
  s_add_u32 s12, s12, 11264
  s_cmp_eq_u32 s12, s14
  s_cselect_b32 s12, 0, s12
  buffer_load_dwordx4 v[52:55], v0, s[44:47], s12 offen nt
  s_add_u32 s12, s12, 11264
  s_cmp_eq_u32 s12, s14
  s_cselect_b32 s12, 0, s12
  buffer_load_dwordx4 v[40:43], v0, s[44:47], s14 offen nt
  s_add_u32 s48, s20, s10
  s_addc_u32 s49, s21, 0
  s_mov_b32 s50, s46
  s_mov_b32 s51, 0x20000
  s_mov_b32 s52, 0xcccccccc
  s_mov_b32 s53, 0xcccccccc
  s_mov_b32 s54, 0xaaaaaaaa
  s_mov_b32 s55, 0xaaaaaaaa
  v_and_b32 v38, 15, v1
  v_lshlrev_b32 v38, 4, v38
  s_lshl_b32 s10, s9, 11
  s_add_u32 s10, s10, 12288
  v_lshl_add_u32 v3, v1, 3, s10
  v_mov_b32 v4, 0x7fff0000
  v_mov_b32 v5, 0xff800000
  ds_write_b64 v3, v[4:5] offset:0
  ds_write_b64 v3, v[4:5] offset:512
  ds_write_b64 v3, v[4:5] offset:1024
  v_lshrrev_b32 v3, 4, v1
  v_lshl_add_u32 v39, v38, 1, s10
  v_lshl_add_u32 v39, v3, 3, v39
  s_sub_u32 s68, s15, 1
  v_bfrev_b32 v4, v1
  v_lshrrev_b32 v4, 28, v4
  v_lshl_add_u32 v3, v3, 8, s11
  v_cmp_eq_u32 s[70:71], 0, v4
  v_add_u32 v24, s68, v4
  v_subrev_u32 v5, 31, v24
  v_min_u32 v24, v5, v24
  v_cndmask_b32 v24, v24, 31, s[70:71]
  v_mul_u32_u24 v24, 11264, v24
  v_add_u32 v24, v3, v24
  v_add_u32 v26, s68, v4
  v_add_u32 v26, 16, v26
  v_subrev_u32 v5, 31, v26
  v_min_u32 v26, v5, v26
  v_mul_u32_u24 v26, 11264, v26
  v_add_u32 v26, v3, v26
  s_lshl_b32 s11, s9, 9
  s_sub_u32 s11, s11, s10
  s_mov_b32 s32, 4
  s_mul_i32 s33, s9, 0x60000000
  s_add_u32 s33, s33, 0x10000000
  s_mov_b64 s[64:65], 0
  s_mov_b64 s[66:67], 0
  s_mov_b32 s38, 0
  s_mov_b32 s39, 2
  s_mov_b32 s75, 0
  s_mov_b32 s61, 0
  s_barrier
  s_waitcnt lgkmcnt(0)
  s_mov_b32 s56, s10
  s_mov_b32 s41, 5
  s_mov_b32 s57, 0
  s_mov_b32 s34, 174694
  s_mov_b32 s77, 0
  s_mov_b32 s35, 28
  s_mov_b32 s59, 0
  v_mov_b32 v22, 1332
  v_mov_b32 v23, 0
  v_mov_b32 v2, 0
  s_call_b64 s[62:63], L_kq
  buffer_load_dwordx4 v[56:59], v0, s[44:47], s12 offen nt
  s_add_u32 s12, s12, 11264
  s_cmp_eq_u32 s12, s14
  s_cselect_b32 s12, 0, s12
  s_call_b64 s[62:63], L_kq
  buffer_load_dwordx4 v[60:63], v0, s[44:47], s12 offen nt
  s_add_u32 s12, s12, 11264
  s_cmp_eq_u32 s12, s14
  s_cselect_b32 s12, 0, s12
  s_call_b64 s[62:63], L_kq
  buffer_load_dwordx4 v[64:67], v0, s[44:47], s12 offen nt
  s_add_u32 s12, s12, 11264
  s_cmp_eq_u32 s12, s14
  s_cselect_b32 s12, 0, s12
  s_call_b64 s[62:63], L_kq
  buffer_load_dwordx4 v[68:71], v0, s[44:47], s12 offen nt
  s_add_u32 s12, s12, 11264
  s_cmp_eq_u32 s12, s14
  s_cselect_b32 s12, 0, s12
  s_call_b64 s[62:63], L_kq
  buffer_load_dwordx4 v[72:75], v0, s[44:47], s12 offen nt
  s_add_u32 s12, s12, 11264
  s_cmp_eq_u32 s12, s14
  s_cselect_b32 s12, 0, s12
  s_call_b64 s[62:63], L_kq
  buffer_load_dwordx4 v[76:79], v0, s[44:47], s12 offen nt
  s_add_u32 s12, s12, 11264
  s_cmp_eq_u32 s12, s14
  s_cselect_b32 s12, 0, s12
  s_call_b64 s[62:63], L_kq
  buffer_load_dwordx4 v[80:83], v0, s[44:47], s12 offen nt
  s_add_u32 s12, s12, 11264
  s_cmp_eq_u32 s12, s14
  s_cselect_b32 s12, 0, s12
  s_call_b64 s[62:63], L_kq
  buffer_load_dwordx4 v[84:87], v0, s[44:47], s12 offen nt
  s_add_u32 s12, s12, 11264
  s_cmp_eq_u32 s12, s14
  s_cselect_b32 s12, 0, s12
  s_call_b64 s[62:63], L_kq
  buffer_load_dwordx4 v[88:91], v0, s[44:47], s12 offen nt
  s_add_u32 s12, s12, 11264
  s_cmp_eq_u32 s12, s14
  s_cselect_b32 s12, 0, s12
  s_call_b64 s[62:63], L_kq
  buffer_load_dwordx4 v[92:95], v0, s[44:47], s12 offen nt
  s_add_u32 s12, s12, 11264
  s_cmp_eq_u32 s12, s14
  s_cselect_b32 s12, 0, s12
  s_call_b64 s[62:63], L_kq
  buffer_load_dwordx4 v[96:99], v0, s[44:47], s12 offen nt
  s_add_u32 s12, s12, 11264
  s_cmp_eq_u32 s12, s14
  s_cselect_b32 s12, 0, s12
  s_call_b64 s[62:63], L_ks
  buffer_load_dwordx4 v[100:103], v0, s[44:47], s12 offen nt
  s_add_u32 s12, s12, 11264
  s_cmp_eq_u32 s12, s14
  s_cselect_b32 s12, 0, s12
  s_call_b64 s[62:63], L_ks
  buffer_load_dwordx4 v[104:107], v0, s[44:47], s12 offen nt
  s_add_u32 s12, s12, 11264
  s_cmp_eq_u32 s12, s14
  s_cselect_b32 s12, 0, s12
  s_call_b64 s[62:63], L_ks
  buffer_load_dwordx4 v[108:111], v0, s[44:47], s12 offen nt
  s_add_u32 s12, s12, 11264
  s_cmp_eq_u32 s12, s14
  s_cselect_b32 s12, 0, s12
  s_call_b64 s[62:63], L_ks
  buffer_load_dwordx4 v[112:115], v0, s[44:47], s12 offen nt
  s_add_u32 s12, s12, 11264
  s_cmp_eq_u32 s12, s14
  s_cselect_b32 s12, 0, s12
  s_call_b64 s[62:63], L_ks
  buffer_load_dwordx4 v[116:119], v0, s[44:47], s12 offen nt
  s_add_u32 s12, s12, 11264
  s_cmp_eq_u32 s12, s14
  s_cselect_b32 s12, 0, s12
  s_call_b64 s[62:63], L_ks
  buffer_load_dwordx4 v[120:123], v0, s[44:47], s12 offen nt
  s_add_u32 s12, s12, 11264
  s_cmp_eq_u32 s12, s14
  s_cselect_b32 s12, 0, s12
  s_call_b64 s[62:63], L_ks
  buffer_load_dwordx4 v[124:127], v0, s[44:47], s12 offen nt
  s_add_u32 s12, s12, 11264
  s_cmp_eq_u32 s12, s14
  s_cselect_b32 s12, 0, s12
  s_call_b64 s[62:63], L_ks
  buffer_load_dwordx4 v[128:131], v0, s[44:47], s12 offen nt
  s_add_u32 s12, s12, 11264
  s_cmp_eq_u32 s12, s14
  s_cselect_b32 s12, 0, s12
  s_call_b64 s[62:63], L_ks
  buffer_load_dwordx4 v[132:135], v0, s[44:47], s12 offen nt
  s_add_u32 s12, s12, 11264
  s_cmp_eq_u32 s12, s14
  s_cselect_b32 s12, 0, s12
  s_call_b64 s[62:63], L_ks
  buffer_load_dwordx4 v[136:139], v0, s[44:47], s12 offen nt
  s_add_u32 s12, s12, 11264
  s_cmp_eq_u32 s12, s14
  s_cselect_b32 s12, 0, s12
  s_call_b64 s[62:63], L_ks
  buffer_load_dwordx4 v[140:143], v0, s[44:47], s12 offen nt
  s_add_u32 s12, s12, 11264
  s_cmp_eq_u32 s12, s14
  s_cselect_b32 s12, 0, s12
  s_call_b64 s[62:63], L_ks
  buffer_load_dwordx4 v[144:147], v0, s[44:47], s12 offen nt
  s_add_u32 s12, s12, 11264
  s_cmp_eq_u32 s12, s14
  s_cselect_b32 s12, 0, s12
  s_call_b64 s[62:63], L_ks
  buffer_load_dwordx4 v[148:151], v0, s[44:47], s12 offen nt
  s_add_u32 s12, s12, 11264
  s_cmp_eq_u32 s12, s14
  s_cselect_b32 s12, 0, s12
  s_call_b64 s[62:63], L_ks
  buffer_load_dwordx4 v[152:155], v0, s[44:47], s12 offen nt
  s_add_u32 s12, s12, 11264
  s_cmp_eq_u32 s12, s14
  s_cselect_b32 s12, 0, s12
  s_call_b64 s[62:63], L_ks
  buffer_load_dwordx4 v[156:159], v0, s[44:47], s12 offen nt
  s_add_u32 s12, s12, 11264
  s_cmp_eq_u32 s12, s14
  s_cselect_b32 s12, 0, s12
  s_call_b64 s[62:63], L_ks
  buffer_load_dwordx4 v[160:163], v0, s[44:47], s12 offen nt
  s_add_u32 s12, s12, 11264
  s_cmp_eq_u32 s12, s14
  s_cselect_b32 s12, 0, s12
  s_call_b64 s[62:63], L_ks
  buffer_load_dwordx4 v[164:167], v0, s[44:47], s12 offen nt
  s_add_u32 s12, s12, 11264
  s_cmp_eq_u32 s12, s14
  s_cselect_b32 s12, 0, s12
  s_mov_b32 s10, 0
L_kw:
  s_cmp_ge_u32 s39, 6
  s_cbranch_scc1 L_v0
  s_call_b64 s[100:101], L_work
  s_sleep 1
  s_add_u32 s10, s10, 1
  s_cmp_lt_u32 s10, 262144
  s_cbranch_scc1 L_kw
L_v0:
  s_mov_b32 s32, 0
  v_mov_b32 v2, 8
  s_mov_b32 s35, s59
  ds_read_b64 v[22:23], v2 offset:288
  s_waitcnt lgkmcnt(0)
  v_and_b32 v3, 1, v1
  v_lshlrev_b32 v3, 4, v3
  v_mov_b32 v20, 0xffff
  v_lshlrev_b32 v3, v3, v20
  v_bfe_u32 v20, v1, 1, 3
  v_cmp_eq_u32 vcc, 0, v20
  s_nop 1
  v_cndmask_b32 v34, 0, v3, vcc
  v_cmp_eq_u32 vcc, 1, v20
  s_nop 1
  v_cndmask_b32 v35, 0, v3, vcc
  v_cmp_eq_u32 vcc, 2, v20
  s_nop 1
  v_cndmask_b32 v36, 0, v3, vcc
  v_cmp_eq_u32 vcc, 3, v20
  s_nop 1
  v_cndmask_b32 v0, 0, v3, vcc
  s_mov_b32 s77, 61
  s_mov_b32 s34, 163021
  s_call_b64 s[62:63], L_vs
  v_add_u32_dpp v3, v28, v38 row_newbcast:0 row_mask:0xf bank_mask:0xf
  buffer_load_dwordx4 v[40:43], v3, s[48:51], 0 offen nt
  s_mov_b64 vcc, s[54:55]
  v_mfma_f32_16x16x32_bf16 v[8:11], v[136:139], v[4:7], 0
  v_mfma_f32_16x16x32_bf16 v[136:139], v[140:143], v[4:7], 0
  v_mfma_f32_16x16x32_bf16 v[140:143], v[144:147], v[4:7], 0
  v_mfma_f32_16x16x32_bf16 v[144:147], v[148:151], v[4:7], 0
  s_nop 4
  v_cndmask_b32_dpp v12, v8, v9, vcc quad_perm:[0,1,2,3] row_mask:0xf bank_mask:0x1
  v_cndmask_b32_dpp v13, v10, v11, vcc quad_perm:[0,1,2,3] row_mask:0xf bank_mask:0x1
  v_cndmask_b32_dpp v12, v136, v137, vcc quad_perm:[0,1,2,3] row_mask:0xf bank_mask:0x4
  v_cndmask_b32_dpp v13, v138, v139, vcc quad_perm:[0,1,2,3] row_mask:0xf bank_mask:0x4
  v_cndmask_b32_dpp v12, v140, v141, vcc quad_perm:[0,1,2,3] row_mask:0xf bank_mask:0x2
  v_cndmask_b32_dpp v13, v142, v143, vcc quad_perm:[0,1,2,3] row_mask:0xf bank_mask:0x2
  v_cndmask_b32_dpp v12, v144, v145, vcc quad_perm:[0,1,2,3] row_mask:0xf bank_mask:0x8
  v_cndmask_b32_dpp v13, v146, v147, vcc quad_perm:[0,1,2,3] row_mask:0xf bank_mask:0x8
  v_cndmask_b32 v18, v12, v13, s[52:53]
  s_call_b64 s[62:63], L_vs
  s_cbranch_scc0 L_dr5
  v_add_u32_dpp v3, v28, v38 row_newbcast:1 row_mask:0xf bank_mask:0xf
  buffer_load_dwordx4 v[44:47], v3, s[48:51], 0 offen nt
  s_call_b64 s[62:63], L_vs
  s_cbranch_scc0 L_dr5
  v_add_u32_dpp v3, v28, v38 row_newbcast:2 row_mask:0xf bank_mask:0xf
  buffer_load_dwordx4 v[48:51], v3, s[48:51], 0 offen nt
  s_call_b64 s[62:63], L_vs
  s_cbranch_scc0 L_dr5
  v_add_u32_dpp v3, v28, v38 row_newbcast:3 row_mask:0xf bank_mask:0xf
  buffer_load_dwordx4 v[52:55], v3, s[48:51], 0 offen nt
  s_call_b64 s[62:63], L_vs
  s_cbranch_scc0 L_dr5
  v_add_u32_dpp v3, v28, v38 row_newbcast:4 row_mask:0xf bank_mask:0xf
  buffer_load_dwordx4 v[56:59], v3, s[48:51], 0 offen nt
  s_call_b64 s[62:63], L_vs
  s_cbranch_scc0 L_dr5
  v_add_u32_dpp v3, v28, v38 row_newbcast:5 row_mask:0xf bank_mask:0xf
  buffer_load_dwordx4 v[60:63], v3, s[48:51], 0 offen nt
  v_and_b32_dpp v12, v29, v34 row_newbcast:0 row_mask:0xf bank_mask:0xf
  v_and_b32_dpp v13, v29, v35 row_newbcast:0 row_mask:0xf bank_mask:0xf
  v_and_b32_dpp v14, v29, v36 row_newbcast:0 row_mask:0xf bank_mask:0xf
  v_and_b32_dpp v15, v29, v0 row_newbcast:0 row_mask:0xf bank_mask:0xf
  s_nop 1
  v_mfma_f32_16x16x32_bf16 v[8:11], v[12:15], v[40:43], v[8:11]
  s_call_b64 s[62:63], L_vs
  s_cbranch_scc0 L_dr6
  v_add_u32_dpp v3, v28, v38 row_newbcast:6 row_mask:0xf bank_mask:0xf
  buffer_load_dwordx4 v[64:67], v3, s[48:51], 0 offen nt
  v_and_b32_dpp v12, v29, v34 row_newbcast:1 row_mask:0xf bank_mask:0xf
  v_and_b32_dpp v13, v29, v35 row_newbcast:1 row_mask:0xf bank_mask:0xf
  v_and_b32_dpp v14, v29, v36 row_newbcast:1 row_mask:0xf bank_mask:0xf
  v_and_b32_dpp v15, v29, v0 row_newbcast:1 row_mask:0xf bank_mask:0xf
  s_nop 1
  v_mfma_f32_16x16x32_bf16 v[8:11], v[12:15], v[44:47], v[8:11]
  s_call_b64 s[62:63], L_vs
  s_cbranch_scc0 L_dr7
  v_add_u32_dpp v3, v28, v38 row_newbcast:7 row_mask:0xf bank_mask:0xf
  buffer_load_dwordx4 v[68:71], v3, s[48:51], 0 offen nt
  v_and_b32_dpp v12, v29, v34 row_newbcast:2 row_mask:0xf bank_mask:0xf
  v_and_b32_dpp v13, v29, v35 row_newbcast:2 row_mask:0xf bank_mask:0xf
  v_and_b32_dpp v14, v29, v36 row_newbcast:2 row_mask:0xf bank_mask:0xf
  v_and_b32_dpp v15, v29, v0 row_newbcast:2 row_mask:0xf bank_mask:0xf
  s_nop 1
  v_mfma_f32_16x16x32_bf16 v[8:11], v[12:15], v[48:51], v[8:11]
  s_call_b64 s[62:63], L_vs
  s_cbranch_scc0 L_dr8
  v_add_u32_dpp v3, v28, v38 row_newbcast:8 row_mask:0xf bank_mask:0xf
  buffer_load_dwordx4 v[72:75], v3, s[48:51], 0 offen nt
  v_and_b32_dpp v12, v29, v34 row_newbcast:3 row_mask:0xf bank_mask:0xf
  v_and_b32_dpp v13, v29, v35 row_newbcast:3 row_mask:0xf bank_mask:0xf
  v_and_b32_dpp v14, v29, v36 row_newbcast:3 row_mask:0xf bank_mask:0xf
  v_and_b32_dpp v15, v29, v0 row_newbcast:3 row_mask:0xf bank_mask:0xf
  s_nop 1
  v_mfma_f32_16x16x32_bf16 v[8:11], v[12:15], v[52:55], v[8:11]
  s_call_b64 s[62:63], L_vs
  s_cbranch_scc0 L_dr9
  v_add_u32_dpp v3, v28, v38 row_newbcast:9 row_mask:0xf bank_mask:0xf
  buffer_load_dwordx4 v[76:79], v3, s[48:51], 0 offen nt
  v_and_b32_dpp v12, v29, v34 row_newbcast:4 row_mask:0xf bank_mask:0xf
  v_and_b32_dpp v13, v29, v35 row_newbcast:4 row_mask:0xf bank_mask:0xf
  v_and_b32_dpp v14, v29, v36 row_newbcast:4 row_mask:0xf bank_mask:0xf
  v_and_b32_dpp v15, v29, v0 row_newbcast:4 row_mask:0xf bank_mask:0xf
  s_nop 1
  v_mfma_f32_16x16x32_bf16 v[8:11], v[12:15], v[56:59], v[8:11]
  s_call_b64 s[62:63], L_vs
  s_cbranch_scc0 L_dr10
  v_add_u32_dpp v3, v28, v38 row_newbcast:10 row_mask:0xf bank_mask:0xf
  buffer_load_dwordx4 v[80:83], v3, s[48:51], 0 offen nt
  v_and_b32_dpp v12, v29, v34 row_newbcast:5 row_mask:0xf bank_mask:0xf
  v_and_b32_dpp v13, v29, v35 row_newbcast:5 row_mask:0xf bank_mask:0xf
  v_and_b32_dpp v14, v29, v36 row_newbcast:5 row_mask:0xf bank_mask:0xf
  v_and_b32_dpp v15, v29, v0 row_newbcast:5 row_mask:0xf bank_mask:0xf
  s_nop 1
  v_mfma_f32_16x16x32_bf16 v[8:11], v[12:15], v[60:63], v[8:11]
  s_call_b64 s[62:63], L_vq
  s_cbranch_scc0 L_dr11
  v_add_u32_dpp v3, v28, v38 row_newbcast:11 row_mask:0xf bank_mask:0xf
  buffer_load_dwordx4 v[84:87], v3, s[48:51], 0 offen nt
  v_and_b32_dpp v12, v29, v34 row_newbcast:6 row_mask:0xf bank_mask:0xf
  v_and_b32_dpp v13, v29, v35 row_newbcast:6 row_mask:0xf bank_mask:0xf
  v_and_b32_dpp v14, v29, v36 row_newbcast:6 row_mask:0xf bank_mask:0xf
  v_and_b32_dpp v15, v29, v0 row_newbcast:6 row_mask:0xf bank_mask:0xf
  s_nop 1
  v_mfma_f32_16x16x32_bf16 v[8:11], v[12:15], v[64:67], v[8:11]
  s_call_b64 s[62:63], L_vq
  s_cbranch_scc0 L_dr12
  v_add_u32_dpp v3, v28, v38 row_newbcast:12 row_mask:0xf bank_mask:0xf
  buffer_load_dwordx4 v[88:91], v3, s[48:51], 0 offen nt
  v_and_b32_dpp v12, v29, v34 row_newbcast:7 row_mask:0xf bank_mask:0xf
  v_and_b32_dpp v13, v29, v35 row_newbcast:7 row_mask:0xf bank_mask:0xf
  v_and_b32_dpp v14, v29, v36 row_newbcast:7 row_mask:0xf bank_mask:0xf
  v_and_b32_dpp v15, v29, v0 row_newbcast:7 row_mask:0xf bank_mask:0xf
  s_nop 1
  v_mfma_f32_16x16x32_bf16 v[8:11], v[12:15], v[68:71], v[8:11]
  s_call_b64 s[62:63], L_vq
  s_cbranch_scc0 L_dr13
  v_add_u32_dpp v3, v28, v38 row_newbcast:13 row_mask:0xf bank_mask:0xf
  buffer_load_dwordx4 v[92:95], v3, s[48:51], 0 offen nt
  v_and_b32_dpp v12, v29, v34 row_newbcast:8 row_mask:0xf bank_mask:0xf
  v_and_b32_dpp v13, v29, v35 row_newbcast:8 row_mask:0xf bank_mask:0xf
  v_and_b32_dpp v14, v29, v36 row_newbcast:8 row_mask:0xf bank_mask:0xf
  v_and_b32_dpp v15, v29, v0 row_newbcast:8 row_mask:0xf bank_mask:0xf
  s_nop 1
  v_mfma_f32_16x16x32_bf16 v[8:11], v[12:15], v[72:75], v[8:11]
  s_call_b64 s[62:63], L_vq
  s_cbranch_scc0 L_dr14
  v_add_u32_dpp v3, v28, v38 row_newbcast:14 row_mask:0xf bank_mask:0xf
  buffer_load_dwordx4 v[96:99], v3, s[48:51], 0 offen nt
  v_and_b32_dpp v12, v29, v34 row_newbcast:9 row_mask:0xf bank_mask:0xf
  v_and_b32_dpp v13, v29, v35 row_newbcast:9 row_mask:0xf bank_mask:0xf
  v_and_b32_dpp v14, v29, v36 row_newbcast:9 row_mask:0xf bank_mask:0xf
  v_and_b32_dpp v15, v29, v0 row_newbcast:9 row_mask:0xf bank_mask:0xf
  s_nop 1
  v_mfma_f32_16x16x32_bf16 v[8:11], v[12:15], v[76:79], v[8:11]
  s_call_b64 s[62:63], L_vq
  s_cbranch_scc0 L_dr15
  v_add_u32_dpp v3, v28, v38 row_newbcast:15 row_mask:0xf bank_mask:0xf
  buffer_load_dwordx4 v[100:103], v3, s[48:51], 0 offen nt
  v_and_b32_dpp v12, v29, v34 row_newbcast:10 row_mask:0xf bank_mask:0xf
  v_and_b32_dpp v13, v29, v35 row_newbcast:10 row_mask:0xf bank_mask:0xf
  v_and_b32_dpp v14, v29, v36 row_newbcast:10 row_mask:0xf bank_mask:0xf
  v_and_b32_dpp v15, v29, v0 row_newbcast:10 row_mask:0xf bank_mask:0xf
  s_nop 1
  v_mfma_f32_16x16x32_bf16 v[8:11], v[12:15], v[80:83], v[8:11]
  s_call_b64 s[62:63], L_vq
  s_cbranch_scc0 L_dr16
  v_add_u32_dpp v3, v30, v38 row_newbcast:0 row_mask:0xf bank_mask:0xf
  buffer_load_dwordx4 v[104:107], v3, s[48:51], 0 offen nt
  v_and_b32_dpp v12, v29, v34 row_newbcast:11 row_mask:0xf bank_mask:0xf
  v_and_b32_dpp v13, v29, v35 row_newbcast:11 row_mask:0xf bank_mask:0xf
  v_and_b32_dpp v14, v29, v36 row_newbcast:11 row_mask:0xf bank_mask:0xf
  v_and_b32_dpp v15, v29, v0 row_newbcast:11 row_mask:0xf bank_mask:0xf
  s_nop 1
  v_mfma_f32_16x16x32_bf16 v[8:11], v[12:15], v[84:87], v[8:11]
  s_call_b64 s[62:63], L_vq
  s_cbranch_scc0 L_dr17
  v_add_u32_dpp v3, v30, v38 row_newbcast:1 row_mask:0xf bank_mask:0xf
  buffer_load_dwordx4 v[108:111], v3, s[48:51], 0 offen nt
  v_and_b32_dpp v12, v29, v34 row_newbcast:12 row_mask:0xf bank_mask:0xf
  v_and_b32_dpp v13, v29, v35 row_newbcast:12 row_mask:0xf bank_mask:0xf
  v_and_b32_dpp v14, v29, v36 row_newbcast:12 row_mask:0xf bank_mask:0xf
  v_and_b32_dpp v15, v29, v0 row_newbcast:12 row_mask:0xf bank_mask:0xf
  s_nop 1
  v_mfma_f32_16x16x32_bf16 v[8:11], v[12:15], v[88:91], v[8:11]
  s_call_b64 s[62:63], L_vq
  s_cbranch_scc0 L_dr18
  v_add_u32_dpp v3, v30, v38 row_newbcast:2 row_mask:0xf bank_mask:0xf
  buffer_load_dwordx4 v[112:115], v3, s[48:51], 0 offen nt
  v_and_b32_dpp v12, v29, v34 row_newbcast:13 row_mask:0xf bank_mask:0xf
  v_and_b32_dpp v13, v29, v35 row_newbcast:13 row_mask:0xf bank_mask:0xf
  v_and_b32_dpp v14, v29, v36 row_newbcast:13 row_mask:0xf bank_mask:0xf
  v_and_b32_dpp v15, v29, v0 row_newbcast:13 row_mask:0xf bank_mask:0xf
  s_nop 1
  v_mfma_f32_16x16x32_bf16 v[8:11], v[12:15], v[92:95], v[8:11]
  s_call_b64 s[62:63], L_vq
  s_cbranch_scc0 L_dr19
  v_add_u32_dpp v3, v30, v38 row_newbcast:3 row_mask:0xf bank_mask:0xf
  buffer_load_dwordx4 v[116:119], v3, s[48:51], 0 offen nt
  v_and_b32_dpp v12, v29, v34 row_newbcast:14 row_mask:0xf bank_mask:0xf
  v_and_b32_dpp v13, v29, v35 row_newbcast:14 row_mask:0xf bank_mask:0xf
  v_and_b32_dpp v14, v29, v36 row_newbcast:14 row_mask:0xf bank_mask:0xf
  v_and_b32_dpp v15, v29, v0 row_newbcast:14 row_mask:0xf bank_mask:0xf
  s_nop 1
  v_mfma_f32_16x16x32_bf16 v[8:11], v[12:15], v[96:99], v[8:11]
  s_call_b64 s[62:63], L_vq
  s_cbranch_scc0 L_dr20
  v_add_u32_dpp v3, v30, v38 row_newbcast:4 row_mask:0xf bank_mask:0xf
  buffer_load_dwordx4 v[120:123], v3, s[48:51], 0 offen nt
  v_and_b32_dpp v12, v29, v34 row_newbcast:15 row_mask:0xf bank_mask:0xf
  v_and_b32_dpp v13, v29, v35 row_newbcast:15 row_mask:0xf bank_mask:0xf
  v_and_b32_dpp v14, v29, v36 row_newbcast:15 row_mask:0xf bank_mask:0xf
  v_and_b32_dpp v15, v29, v0 row_newbcast:15 row_mask:0xf bank_mask:0xf
  s_nop 1
  v_mfma_f32_16x16x32_bf16 v[8:11], v[12:15], v[100:103], v[8:11]
  s_call_b64 s[62:63], L_vq
  s_cbranch_scc0 L_dr21
  v_add_u32_dpp v3, v30, v38 row_newbcast:5 row_mask:0xf bank_mask:0xf
  buffer_load_dwordx4 v[124:127], v3, s[48:51], 0 offen nt
  v_and_b32_dpp v12, v31, v34 row_newbcast:0 row_mask:0xf bank_mask:0xf
  v_and_b32_dpp v13, v31, v35 row_newbcast:0 row_mask:0xf bank_mask:0xf
  v_and_b32_dpp v14, v31, v36 row_newbcast:0 row_mask:0xf bank_mask:0xf
  v_and_b32_dpp v15, v31, v0 row_newbcast:0 row_mask:0xf bank_mask:0xf
  s_nop 1
  v_mfma_f32_16x16x32_bf16 v[8:11], v[12:15], v[104:107], v[8:11]
  s_call_b64 s[62:63], L_vq
  s_cbranch_scc0 L_dr22
  v_add_u32_dpp v3, v30, v38 row_newbcast:6 row_mask:0xf bank_mask:0xf
  buffer_load_dwordx4 v[128:131], v3, s[48:51], 0 offen nt
  v_and_b32_dpp v12, v31, v34 row_newbcast:1 row_mask:0xf bank_mask:0xf
  v_and_b32_dpp v13, v31, v35 row_newbcast:1 row_mask:0xf bank_mask:0xf
  v_and_b32_dpp v14, v31, v36 row_newbcast:1 row_mask:0xf bank_mask:0xf
  v_and_b32_dpp v15, v31, v0 row_newbcast:1 row_mask:0xf bank_mask:0xf
  s_nop 1
  v_mfma_f32_16x16x32_bf16 v[8:11], v[12:15], v[108:111], v[8:11]
  s_call_b64 s[62:63], L_vq
  s_cbranch_scc0 L_dr23
  v_add_u32_dpp v3, v30, v38 row_newbcast:7 row_mask:0xf bank_mask:0xf
  buffer_load_dwordx4 v[132:135], v3, s[48:51], 0 offen nt
  v_and_b32_dpp v12, v31, v34 row_newbcast:2 row_mask:0xf bank_mask:0xf
  v_and_b32_dpp v13, v31, v35 row_newbcast:2 row_mask:0xf bank_mask:0xf
  v_and_b32_dpp v14, v31, v36 row_newbcast:2 row_mask:0xf bank_mask:0xf
  v_and_b32_dpp v15, v31, v0 row_newbcast:2 row_mask:0xf bank_mask:0xf
  s_nop 1
  v_mfma_f32_16x16x32_bf16 v[8:11], v[12:15], v[112:115], v[8:11]
  s_call_b64 s[62:63], L_vq
  s_cbranch_scc0 L_dr24
  v_add_u32_dpp v3, v30, v38 row_newbcast:8 row_mask:0xf bank_mask:0xf
  buffer_load_dwordx4 v[136:139], v3, s[48:51], 0 offen nt
  v_and_b32_dpp v12, v31, v34 row_newbcast:3 row_mask:0xf bank_mask:0xf
  v_and_b32_dpp v13, v31, v35 row_newbcast:3 row_mask:0xf bank_mask:0xf
  v_and_b32_dpp v14, v31, v36 row_newbcast:3 row_mask:0xf bank_mask:0xf
  v_and_b32_dpp v15, v31, v0 row_newbcast:3 row_mask:0xf bank_mask:0xf
  s_nop 1
  v_mfma_f32_16x16x32_bf16 v[8:11], v[12:15], v[116:119], v[8:11]
  s_call_b64 s[62:63], L_vq
  s_cbranch_scc0 L_dr25
  v_add_u32_dpp v3, v30, v38 row_newbcast:9 row_mask:0xf bank_mask:0xf
  buffer_load_dwordx4 v[140:143], v3, s[48:51], 0 offen nt
  v_and_b32_dpp v12, v31, v34 row_newbcast:4 row_mask:0xf bank_mask:0xf
  v_and_b32_dpp v13, v31, v35 row_newbcast:4 row_mask:0xf bank_mask:0xf
  v_and_b32_dpp v14, v31, v36 row_newbcast:4 row_mask:0xf bank_mask:0xf
  v_and_b32_dpp v15, v31, v0 row_newbcast:4 row_mask:0xf bank_mask:0xf
  s_nop 1
  v_mfma_f32_16x16x32_bf16 v[8:11], v[12:15], v[120:123], v[8:11]
  s_call_b64 s[62:63], L_vq
  s_cbranch_scc0 L_dr26
  v_add_u32_dpp v3, v30, v38 row_newbcast:10 row_mask:0xf bank_mask:0xf
  buffer_load_dwordx4 v[144:147], v3, s[48:51], 0 offen nt
  v_and_b32_dpp v12, v31, v34 row_newbcast:5 row_mask:0xf bank_mask:0xf
  v_and_b32_dpp v13, v31, v35 row_newbcast:5 row_mask:0xf bank_mask:0xf
  v_and_b32_dpp v14, v31, v36 row_newbcast:5 row_mask:0xf bank_mask:0xf
  v_and_b32_dpp v15, v31, v0 row_newbcast:5 row_mask:0xf bank_mask:0xf
  s_nop 1
  v_mfma_f32_16x16x32_bf16 v[8:11], v[12:15], v[124:127], v[8:11]
  s_call_b64 s[62:63], L_vq
  s_cbranch_scc0 L_dr27
  v_add_u32_dpp v3, v30, v38 row_newbcast:11 row_mask:0xf bank_mask:0xf
  buffer_load_dwordx4 v[148:151], v3, s[48:51], 0 offen nt
  v_and_b32_dpp v12, v31, v34 row_newbcast:6 row_mask:0xf bank_mask:0xf
  v_and_b32_dpp v13, v31, v35 row_newbcast:6 row_mask:0xf bank_mask:0xf
  v_and_b32_dpp v14, v31, v36 row_newbcast:6 row_mask:0xf bank_mask:0xf
  v_and_b32_dpp v15, v31, v0 row_newbcast:6 row_mask:0xf bank_mask:0xf
  s_nop 1
  v_mfma_f32_16x16x32_bf16 v[8:11], v[12:15], v[128:131], v[8:11]
  s_call_b64 s[62:63], L_vq
  s_cbranch_scc0 L_dr28
  v_add_u32_dpp v3, v30, v38 row_newbcast:12 row_mask:0xf bank_mask:0xf
  buffer_load_dwordx4 v[152:155], v3, s[48:51], 0 offen nt
  v_and_b32_dpp v12, v31, v34 row_newbcast:7 row_mask:0xf bank_mask:0xf
  v_and_b32_dpp v13, v31, v35 row_newbcast:7 row_mask:0xf bank_mask:0xf
  v_and_b32_dpp v14, v31, v36 row_newbcast:7 row_mask:0xf bank_mask:0xf
  v_and_b32_dpp v15, v31, v0 row_newbcast:7 row_mask:0xf bank_mask:0xf
  s_nop 1
  v_mfma_f32_16x16x32_bf16 v[8:11], v[12:15], v[132:135], v[8:11]
  s_call_b64 s[62:63], L_vq
  s_cbranch_scc0 L_dr29
  v_add_u32_dpp v3, v30, v38 row_newbcast:13 row_mask:0xf bank_mask:0xf
  buffer_load_dwordx4 v[156:159], v3, s[48:51], 0 offen nt
  v_and_b32_dpp v12, v31, v34 row_newbcast:8 row_mask:0xf bank_mask:0xf
  v_and_b32_dpp v13, v31, v35 row_newbcast:8 row_mask:0xf bank_mask:0xf
  v_and_b32_dpp v14, v31, v36 row_newbcast:8 row_mask:0xf bank_mask:0xf
  v_and_b32_dpp v15, v31, v0 row_newbcast:8 row_mask:0xf bank_mask:0xf
  s_nop 1
  v_mfma_f32_16x16x32_bf16 v[8:11], v[12:15], v[136:139], v[8:11]
  s_call_b64 s[62:63], L_vq
  s_cbranch_scc0 L_dr30
  v_add_u32_dpp v3, v30, v38 row_newbcast:14 row_mask:0xf bank_mask:0xf
  buffer_load_dwordx4 v[160:163], v3, s[48:51], 0 offen nt
  v_and_b32_dpp v12, v31, v34 row_newbcast:9 row_mask:0xf bank_mask:0xf
  v_and_b32_dpp v13, v31, v35 row_newbcast:9 row_mask:0xf bank_mask:0xf
  v_and_b32_dpp v14, v31, v36 row_newbcast:9 row_mask:0xf bank_mask:0xf
  v_and_b32_dpp v15, v31, v0 row_newbcast:9 row_mask:0xf bank_mask:0xf
  s_nop 1
  v_mfma_f32_16x16x32_bf16 v[8:11], v[12:15], v[140:143], v[8:11]
  s_call_b64 s[62:63], L_vq
  s_cbranch_scc0 L_dr31
  v_add_u32_dpp v3, v30, v38 row_newbcast:15 row_mask:0xf bank_mask:0xf
  buffer_load_dwordx4 v[164:167], v3, s[48:51], 0 offen nt
  v_and_b32_dpp v12, v31, v34 row_newbcast:10 row_mask:0xf bank_mask:0xf
  v_and_b32_dpp v13, v31, v35 row_newbcast:10 row_mask:0xf bank_mask:0xf
  v_and_b32_dpp v14, v31, v36 row_newbcast:10 row_mask:0xf bank_mask:0xf
  v_and_b32_dpp v15, v31, v0 row_newbcast:10 row_mask:0xf bank_mask:0xf
  s_nop 1
  v_mfma_f32_16x16x32_bf16 v[8:11], v[12:15], v[144:147], v[8:11]
  s_call_b64 s[62:63], L_vq
  s_cbranch_scc0 L_dr32
  v_add_u32_dpp v3, v32, v38 row_newbcast:0 row_mask:0xf bank_mask:0xf
  buffer_load_dwordx4 v[40:43], v3, s[48:51], 0 offen nt
  v_and_b32_dpp v12, v31, v34 row_newbcast:11 row_mask:0xf bank_mask:0xf
  v_and_b32_dpp v13, v31, v35 row_newbcast:11 row_mask:0xf bank_mask:0xf
  v_and_b32_dpp v14, v31, v36 row_newbcast:11 row_mask:0xf bank_mask:0xf
  v_and_b32_dpp v15, v31, v0 row_newbcast:11 row_mask:0xf bank_mask:0xf
  s_nop 1
  v_mfma_f32_16x16x32_bf16 v[8:11], v[12:15], v[148:151], v[8:11]
  s_call_b64 s[62:63], L_vq
  s_cbranch_scc0 L_dr33
  v_add_u32_dpp v3, v32, v38 row_newbcast:1 row_mask:0xf bank_mask:0xf
  buffer_load_dwordx4 v[44:47], v3, s[48:51], 0 offen nt
  v_and_b32_dpp v12, v31, v34 row_newbcast:12 row_mask:0xf bank_mask:0xf
  v_and_b32_dpp v13, v31, v35 row_newbcast:12 row_mask:0xf bank_mask:0xf
  v_and_b32_dpp v14, v31, v36 row_newbcast:12 row_mask:0xf bank_mask:0xf
  v_and_b32_dpp v15, v31, v0 row_newbcast:12 row_mask:0xf bank_mask:0xf
  s_nop 1
  v_mfma_f32_16x16x32_bf16 v[8:11], v[12:15], v[152:155], v[8:11]
  s_call_b64 s[62:63], L_vq
  s_cbranch_scc0 L_dr34
  v_add_u32_dpp v3, v32, v38 row_newbcast:2 row_mask:0xf bank_mask:0xf
  buffer_load_dwordx4 v[48:51], v3, s[48:51], 0 offen nt
  v_and_b32_dpp v12, v31, v34 row_newbcast:13 row_mask:0xf bank_mask:0xf
  v_and_b32_dpp v13, v31, v35 row_newbcast:13 row_mask:0xf bank_mask:0xf
  v_and_b32_dpp v14, v31, v36 row_newbcast:13 row_mask:0xf bank_mask:0xf
  v_and_b32_dpp v15, v31, v0 row_newbcast:13 row_mask:0xf bank_mask:0xf
  s_nop 1
  v_mfma_f32_16x16x32_bf16 v[8:11], v[12:15], v[156:159], v[8:11]
  s_call_b64 s[62:63], L_vq
  s_cbranch_scc0 L_dr35
  v_add_u32_dpp v3, v32, v38 row_newbcast:3 row_mask:0xf bank_mask:0xf
  buffer_load_dwordx4 v[52:55], v3, s[48:51], 0 offen nt
  v_and_b32_dpp v12, v31, v34 row_newbcast:14 row_mask:0xf bank_mask:0xf
  v_and_b32_dpp v13, v31, v35 row_newbcast:14 row_mask:0xf bank_mask:0xf
  v_and_b32_dpp v14, v31, v36 row_newbcast:14 row_mask:0xf bank_mask:0xf
  v_and_b32_dpp v15, v31, v0 row_newbcast:14 row_mask:0xf bank_mask:0xf
  s_nop 1
  v_mfma_f32_16x16x32_bf16 v[8:11], v[12:15], v[160:163], v[8:11]
  s_call_b64 s[62:63], L_vq
  s_cbranch_scc0 L_dr36
  v_add_u32_dpp v3, v32, v38 row_newbcast:4 row_mask:0xf bank_mask:0xf
  buffer_load_dwordx4 v[56:59], v3, s[48:51], 0 offen nt
  v_and_b32_dpp v12, v31, v34 row_newbcast:15 row_mask:0xf bank_mask:0xf
  v_and_b32_dpp v13, v31, v35 row_newbcast:15 row_mask:0xf bank_mask:0xf
  v_and_b32_dpp v14, v31, v36 row_newbcast:15 row_mask:0xf bank_mask:0xf
  v_and_b32_dpp v15, v31, v0 row_newbcast:15 row_mask:0xf bank_mask:0xf
  s_nop 1
  v_mfma_f32_16x16x32_bf16 v[8:11], v[12:15], v[164:167], v[8:11]
  s_call_b64 s[62:63], L_vq
  s_cbranch_scc0 L_dr37
  v_add_u32_dpp v3, v32, v38 row_newbcast:5 row_mask:0xf bank_mask:0xf
  buffer_load_dwordx4 v[60:63], v3, s[48:51], 0 offen nt
  v_and_b32_dpp v12, v33, v34 row_newbcast:0 row_mask:0xf bank_mask:0xf
  v_and_b32_dpp v13, v33, v35 row_newbcast:0 row_mask:0xf bank_mask:0xf
  v_and_b32_dpp v14, v33, v36 row_newbcast:0 row_mask:0xf bank_mask:0xf
  v_and_b32_dpp v15, v33, v0 row_newbcast:0 row_mask:0xf bank_mask:0xf
  s_nop 1
  v_mfma_f32_16x16x32_bf16 v[8:11], v[12:15], v[40:43], v[8:11]
  s_call_b64 s[62:63], L_vq
  s_branch L_dr38
L_dr5:
  v_and_b32_dpp v12, v29, v34 row_newbcast:0 row_mask:0xf bank_mask:0xf
  v_and_b32_dpp v13, v29, v35 row_newbcast:0 row_mask:0xf bank_mask:0xf
  v_and_b32_dpp v14, v29, v36 row_newbcast:0 row_mask:0xf bank_mask:0xf
  v_and_b32_dpp v15, v29, v0 row_newbcast:0 row_mask:0xf bank_mask:0xf
  s_nop 1
  v_mfma_f32_16x16x32_bf16 v[8:11], v[12:15], v[40:43], v[8:11]
  s_cmp_eq_u32 s75, 6
  s_cbranch_scc1 L_epi
L_dr6:
  v_and_b32_dpp v12, v29, v34 row_newbcast:1 row_mask:0xf bank_mask:0xf
  v_and_b32_dpp v13, v29, v35 row_newbcast:1 row_mask:0xf bank_mask:0xf
  v_and_b32_dpp v14, v29, v36 row_newbcast:1 row_mask:0xf bank_mask:0xf
  v_and_b32_dpp v15, v29, v0 row_newbcast:1 row_mask:0xf bank_mask:0xf
  s_nop 1
  v_mfma_f32_16x16x32_bf16 v[8:11], v[12:15], v[44:47], v[8:11]
  s_cmp_eq_u32 s75, 7
  s_cbranch_scc1 L_epi
L_dr7:
  v_and_b32_dpp v12, v29, v34 row_newbcast:2 row_mask:0xf bank_mask:0xf
  v_and_b32_dpp v13, v29, v35 row_newbcast:2 row_mask:0xf bank_mask:0xf
  v_and_b32_dpp v14, v29, v36 row_newbcast:2 row_mask:0xf bank_mask:0xf
  v_and_b32_dpp v15, v29, v0 row_newbcast:2 row_mask:0xf bank_mask:0xf
  s_nop 1
  v_mfma_f32_16x16x32_bf16 v[8:11], v[12:15], v[48:51], v[8:11]
  s_cmp_eq_u32 s75, 8
  s_cbranch_scc1 L_epi
L_dr8:
  v_and_b32_dpp v12, v29, v34 row_newbcast:3 row_mask:0xf bank_mask:0xf
  v_and_b32_dpp v13, v29, v35 row_newbcast:3 row_mask:0xf bank_mask:0xf
  v_and_b32_dpp v14, v29, v36 row_newbcast:3 row_mask:0xf bank_mask:0xf
  v_and_b32_dpp v15, v29, v0 row_newbcast:3 row_mask:0xf bank_mask:0xf
  s_nop 1
  v_mfma_f32_16x16x32_bf16 v[8:11], v[12:15], v[52:55], v[8:11]
  s_cmp_eq_u32 s75, 9
  s_cbranch_scc1 L_epi
L_dr9:
  v_and_b32_dpp v12, v29, v34 row_newbcast:4 row_mask:0xf bank_mask:0xf
  v_and_b32_dpp v13, v29, v35 row_newbcast:4 row_mask:0xf bank_mask:0xf
  v_and_b32_dpp v14, v29, v36 row_newbcast:4 row_mask:0xf bank_mask:0xf
  v_and_b32_dpp v15, v29, v0 row_newbcast:4 row_mask:0xf bank_mask:0xf
  s_nop 1
  v_mfma_f32_16x16x32_bf16 v[8:11], v[12:15], v[56:59], v[8:11]
  s_cmp_eq_u32 s75, 10
  s_cbranch_scc1 L_epi
L_dr10:
  v_and_b32_dpp v12, v29, v34 row_newbcast:5 row_mask:0xf bank_mask:0xf
  v_and_b32_dpp v13, v29, v35 row_newbcast:5 row_mask:0xf bank_mask:0xf
  v_and_b32_dpp v14, v29, v36 row_newbcast:5 row_mask:0xf bank_mask:0xf
  v_and_b32_dpp v15, v29, v0 row_newbcast:5 row_mask:0xf bank_mask:0xf
  s_nop 1
  v_mfma_f32_16x16x32_bf16 v[8:11], v[12:15], v[60:63], v[8:11]
  s_cmp_eq_u32 s75, 11
  s_cbranch_scc1 L_epi
L_dr11:
  v_and_b32_dpp v12, v29, v34 row_newbcast:6 row_mask:0xf bank_mask:0xf
  v_and_b32_dpp v13, v29, v35 row_newbcast:6 row_mask:0xf bank_mask:0xf
  v_and_b32_dpp v14, v29, v36 row_newbcast:6 row_mask:0xf bank_mask:0xf
  v_and_b32_dpp v15, v29, v0 row_newbcast:6 row_mask:0xf bank_mask:0xf
  s_nop 1
  v_mfma_f32_16x16x32_bf16 v[8:11], v[12:15], v[64:67], v[8:11]
  s_cmp_eq_u32 s75, 12
  s_cbranch_scc1 L_epi
L_dr12:
  v_and_b32_dpp v12, v29, v34 row_newbcast:7 row_mask:0xf bank_mask:0xf
  v_and_b32_dpp v13, v29, v35 row_newbcast:7 row_mask:0xf bank_mask:0xf
  v_and_b32_dpp v14, v29, v36 row_newbcast:7 row_mask:0xf bank_mask:0xf
  v_and_b32_dpp v15, v29, v0 row_newbcast:7 row_mask:0xf bank_mask:0xf
  s_nop 1
  v_mfma_f32_16x16x32_bf16 v[8:11], v[12:15], v[68:71], v[8:11]
  s_cmp_eq_u32 s75, 13
  s_cbranch_scc1 L_epi
L_dr13:
  v_and_b32_dpp v12, v29, v34 row_newbcast:8 row_mask:0xf bank_mask:0xf
  v_and_b32_dpp v13, v29, v35 row_newbcast:8 row_mask:0xf bank_mask:0xf
  v_and_b32_dpp v14, v29, v36 row_newbcast:8 row_mask:0xf bank_mask:0xf
  v_and_b32_dpp v15, v29, v0 row_newbcast:8 row_mask:0xf bank_mask:0xf
  s_nop 1
  v_mfma_f32_16x16x32_bf16 v[8:11], v[12:15], v[72:75], v[8:11]
  s_cmp_eq_u32 s75, 14
  s_cbranch_scc1 L_epi
L_dr14:
  v_and_b32_dpp v12, v29, v34 row_newbcast:9 row_mask:0xf bank_mask:0xf
  v_and_b32_dpp v13, v29, v35 row_newbcast:9 row_mask:0xf bank_mask:0xf
  v_and_b32_dpp v14, v29, v36 row_newbcast:9 row_mask:0xf bank_mask:0xf
  v_and_b32_dpp v15, v29, v0 row_newbcast:9 row_mask:0xf bank_mask:0xf
  s_nop 1
  v_mfma_f32_16x16x32_bf16 v[8:11], v[12:15], v[76:79], v[8:11]
  s_cmp_eq_u32 s75, 15
  s_cbranch_scc1 L_epi
L_dr15:
  v_and_b32_dpp v12, v29, v34 row_newbcast:10 row_mask:0xf bank_mask:0xf
  v_and_b32_dpp v13, v29, v35 row_newbcast:10 row_mask:0xf bank_mask:0xf
  v_and_b32_dpp v14, v29, v36 row_newbcast:10 row_mask:0xf bank_mask:0xf
  v_and_b32_dpp v15, v29, v0 row_newbcast:10 row_mask:0xf bank_mask:0xf
  s_nop 1
  v_mfma_f32_16x16x32_bf16 v[8:11], v[12:15], v[80:83], v[8:11]
  s_cmp_eq_u32 s75, 16
  s_cbranch_scc1 L_epi
L_dr16:
  v_and_b32_dpp v12, v29, v34 row_newbcast:11 row_mask:0xf bank_mask:0xf
  v_and_b32_dpp v13, v29, v35 row_newbcast:11 row_mask:0xf bank_mask:0xf
  v_and_b32_dpp v14, v29, v36 row_newbcast:11 row_mask:0xf bank_mask:0xf
  v_and_b32_dpp v15, v29, v0 row_newbcast:11 row_mask:0xf bank_mask:0xf
  s_nop 1
  v_mfma_f32_16x16x32_bf16 v[8:11], v[12:15], v[84:87], v[8:11]
  s_cmp_eq_u32 s75, 17
  s_cbranch_scc1 L_epi
L_dr17:
  v_and_b32_dpp v12, v29, v34 row_newbcast:12 row_mask:0xf bank_mask:0xf
  v_and_b32_dpp v13, v29, v35 row_newbcast:12 row_mask:0xf bank_mask:0xf
  v_and_b32_dpp v14, v29, v36 row_newbcast:12 row_mask:0xf bank_mask:0xf
  v_and_b32_dpp v15, v29, v0 row_newbcast:12 row_mask:0xf bank_mask:0xf
  s_nop 1
  v_mfma_f32_16x16x32_bf16 v[8:11], v[12:15], v[88:91], v[8:11]
  s_cmp_eq_u32 s75, 18
  s_cbranch_scc1 L_epi
L_dr18:
  v_and_b32_dpp v12, v29, v34 row_newbcast:13 row_mask:0xf bank_mask:0xf
  v_and_b32_dpp v13, v29, v35 row_newbcast:13 row_mask:0xf bank_mask:0xf
  v_and_b32_dpp v14, v29, v36 row_newbcast:13 row_mask:0xf bank_mask:0xf
  v_and_b32_dpp v15, v29, v0 row_newbcast:13 row_mask:0xf bank_mask:0xf
  s_nop 1
  v_mfma_f32_16x16x32_bf16 v[8:11], v[12:15], v[92:95], v[8:11]
  s_cmp_eq_u32 s75, 19
  s_cbranch_scc1 L_epi
L_dr19:
  v_and_b32_dpp v12, v29, v34 row_newbcast:14 row_mask:0xf bank_mask:0xf
  v_and_b32_dpp v13, v29, v35 row_newbcast:14 row_mask:0xf bank_mask:0xf
  v_and_b32_dpp v14, v29, v36 row_newbcast:14 row_mask:0xf bank_mask:0xf
  v_and_b32_dpp v15, v29, v0 row_newbcast:14 row_mask:0xf bank_mask:0xf
  s_nop 1
  v_mfma_f32_16x16x32_bf16 v[8:11], v[12:15], v[96:99], v[8:11]
  s_cmp_eq_u32 s75, 20
  s_cbranch_scc1 L_epi
L_dr20:
  v_and_b32_dpp v12, v29, v34 row_newbcast:15 row_mask:0xf bank_mask:0xf
  v_and_b32_dpp v13, v29, v35 row_newbcast:15 row_mask:0xf bank_mask:0xf
  v_and_b32_dpp v14, v29, v36 row_newbcast:15 row_mask:0xf bank_mask:0xf
  v_and_b32_dpp v15, v29, v0 row_newbcast:15 row_mask:0xf bank_mask:0xf
  s_nop 1
  v_mfma_f32_16x16x32_bf16 v[8:11], v[12:15], v[100:103], v[8:11]
  s_cmp_eq_u32 s75, 21
  s_cbranch_scc1 L_epi
L_dr21:
  v_and_b32_dpp v12, v31, v34 row_newbcast:0 row_mask:0xf bank_mask:0xf
  v_and_b32_dpp v13, v31, v35 row_newbcast:0 row_mask:0xf bank_mask:0xf
  v_and_b32_dpp v14, v31, v36 row_newbcast:0 row_mask:0xf bank_mask:0xf
  v_and_b32_dpp v15, v31, v0 row_newbcast:0 row_mask:0xf bank_mask:0xf
  s_nop 1
  v_mfma_f32_16x16x32_bf16 v[8:11], v[12:15], v[104:107], v[8:11]
  s_cmp_eq_u32 s75, 22
  s_cbranch_scc1 L_epi
L_dr22:
  v_and_b32_dpp v12, v31, v34 row_newbcast:1 row_mask:0xf bank_mask:0xf
  v_and_b32_dpp v13, v31, v35 row_newbcast:1 row_mask:0xf bank_mask:0xf
  v_and_b32_dpp v14, v31, v36 row_newbcast:1 row_mask:0xf bank_mask:0xf
  v_and_b32_dpp v15, v31, v0 row_newbcast:1 row_mask:0xf bank_mask:0xf
  s_nop 1
  v_mfma_f32_16x16x32_bf16 v[8:11], v[12:15], v[108:111], v[8:11]
  s_cmp_eq_u32 s75, 23
  s_cbranch_scc1 L_epi
L_dr23:
  v_and_b32_dpp v12, v31, v34 row_newbcast:2 row_mask:0xf bank_mask:0xf
  v_and_b32_dpp v13, v31, v35 row_newbcast:2 row_mask:0xf bank_mask:0xf
  v_and_b32_dpp v14, v31, v36 row_newbcast:2 row_mask:0xf bank_mask:0xf
  v_and_b32_dpp v15, v31, v0 row_newbcast:2 row_mask:0xf bank_mask:0xf
  s_nop 1
  v_mfma_f32_16x16x32_bf16 v[8:11], v[12:15], v[112:115], v[8:11]
  s_cmp_eq_u32 s75, 24
  s_cbranch_scc1 L_epi
L_dr24:
  v_and_b32_dpp v12, v31, v34 row_newbcast:3 row_mask:0xf bank_mask:0xf
  v_and_b32_dpp v13, v31, v35 row_newbcast:3 row_mask:0xf bank_mask:0xf
  v_and_b32_dpp v14, v31, v36 row_newbcast:3 row_mask:0xf bank_mask:0xf
  v_and_b32_dpp v15, v31, v0 row_newbcast:3 row_mask:0xf bank_mask:0xf
  s_nop 1
  v_mfma_f32_16x16x32_bf16 v[8:11], v[12:15], v[116:119], v[8:11]
  s_cmp_eq_u32 s75, 25
  s_cbranch_scc1 L_epi
L_dr25:
  v_and_b32_dpp v12, v31, v34 row_newbcast:4 row_mask:0xf bank_mask:0xf
  v_and_b32_dpp v13, v31, v35 row_newbcast:4 row_mask:0xf bank_mask:0xf
  v_and_b32_dpp v14, v31, v36 row_newbcast:4 row_mask:0xf bank_mask:0xf
  v_and_b32_dpp v15, v31, v0 row_newbcast:4 row_mask:0xf bank_mask:0xf
  s_nop 1
  v_mfma_f32_16x16x32_bf16 v[8:11], v[12:15], v[120:123], v[8:11]
  s_cmp_eq_u32 s75, 26
  s_cbranch_scc1 L_epi
L_dr26:
  v_and_b32_dpp v12, v31, v34 row_newbcast:5 row_mask:0xf bank_mask:0xf
  v_and_b32_dpp v13, v31, v35 row_newbcast:5 row_mask:0xf bank_mask:0xf
  v_and_b32_dpp v14, v31, v36 row_newbcast:5 row_mask:0xf bank_mask:0xf
  v_and_b32_dpp v15, v31, v0 row_newbcast:5 row_mask:0xf bank_mask:0xf
  s_nop 1
  v_mfma_f32_16x16x32_bf16 v[8:11], v[12:15], v[124:127], v[8:11]
  s_cmp_eq_u32 s75, 27
  s_cbranch_scc1 L_epi
L_dr27:
  v_and_b32_dpp v12, v31, v34 row_newbcast:6 row_mask:0xf bank_mask:0xf
  v_and_b32_dpp v13, v31, v35 row_newbcast:6 row_mask:0xf bank_mask:0xf
  v_and_b32_dpp v14, v31, v36 row_newbcast:6 row_mask:0xf bank_mask:0xf
  v_and_b32_dpp v15, v31, v0 row_newbcast:6 row_mask:0xf bank_mask:0xf
  s_nop 1
  v_mfma_f32_16x16x32_bf16 v[8:11], v[12:15], v[128:131], v[8:11]
  s_cmp_eq_u32 s75, 28
  s_cbranch_scc1 L_epi
L_dr28:
  v_and_b32_dpp v12, v31, v34 row_newbcast:7 row_mask:0xf bank_mask:0xf
  v_and_b32_dpp v13, v31, v35 row_newbcast:7 row_mask:0xf bank_mask:0xf
  v_and_b32_dpp v14, v31, v36 row_newbcast:7 row_mask:0xf bank_mask:0xf
  v_and_b32_dpp v15, v31, v0 row_newbcast:7 row_mask:0xf bank_mask:0xf
  s_nop 1
  v_mfma_f32_16x16x32_bf16 v[8:11], v[12:15], v[132:135], v[8:11]
  s_cmp_eq_u32 s75, 29
  s_cbranch_scc1 L_epi
L_dr29:
  v_and_b32_dpp v12, v31, v34 row_newbcast:8 row_mask:0xf bank_mask:0xf
  v_and_b32_dpp v13, v31, v35 row_newbcast:8 row_mask:0xf bank_mask:0xf
  v_and_b32_dpp v14, v31, v36 row_newbcast:8 row_mask:0xf bank_mask:0xf
  v_and_b32_dpp v15, v31, v0 row_newbcast:8 row_mask:0xf bank_mask:0xf
  s_nop 1
  v_mfma_f32_16x16x32_bf16 v[8:11], v[12:15], v[136:139], v[8:11]
  s_cmp_eq_u32 s75, 30
  s_cbranch_scc1 L_epi
L_dr30:
  v_and_b32_dpp v12, v31, v34 row_newbcast:9 row_mask:0xf bank_mask:0xf
  v_and_b32_dpp v13, v31, v35 row_newbcast:9 row_mask:0xf bank_mask:0xf
  v_and_b32_dpp v14, v31, v36 row_newbcast:9 row_mask:0xf bank_mask:0xf
  v_and_b32_dpp v15, v31, v0 row_newbcast:9 row_mask:0xf bank_mask:0xf
  s_nop 1
  v_mfma_f32_16x16x32_bf16 v[8:11], v[12:15], v[140:143], v[8:11]
  s_cmp_eq_u32 s75, 31
  s_cbranch_scc1 L_epi
L_dr31:
  v_and_b32_dpp v12, v31, v34 row_newbcast:10 row_mask:0xf bank_mask:0xf
  v_and_b32_dpp v13, v31, v35 row_newbcast:10 row_mask:0xf bank_mask:0xf
  v_and_b32_dpp v14, v31, v36 row_newbcast:10 row_mask:0xf bank_mask:0xf
  v_and_b32_dpp v15, v31, v0 row_newbcast:10 row_mask:0xf bank_mask:0xf
  s_nop 1
  v_mfma_f32_16x16x32_bf16 v[8:11], v[12:15], v[144:147], v[8:11]
  s_cmp_eq_u32 s75, 32
  s_cbranch_scc1 L_epi
L_dr32:
  v_and_b32_dpp v12, v31, v34 row_newbcast:11 row_mask:0xf bank_mask:0xf
  v_and_b32_dpp v13, v31, v35 row_newbcast:11 row_mask:0xf bank_mask:0xf
  v_and_b32_dpp v14, v31, v36 row_newbcast:11 row_mask:0xf bank_mask:0xf
  v_and_b32_dpp v15, v31, v0 row_newbcast:11 row_mask:0xf bank_mask:0xf
  s_nop 1
  v_mfma_f32_16x16x32_bf16 v[8:11], v[12:15], v[148:151], v[8:11]
  s_cmp_eq_u32 s75, 33
  s_cbranch_scc1 L_epi
L_dr33:
  v_and_b32_dpp v12, v31, v34 row_newbcast:12 row_mask:0xf bank_mask:0xf
  v_and_b32_dpp v13, v31, v35 row_newbcast:12 row_mask:0xf bank_mask:0xf
  v_and_b32_dpp v14, v31, v36 row_newbcast:12 row_mask:0xf bank_mask:0xf
  v_and_b32_dpp v15, v31, v0 row_newbcast:12 row_mask:0xf bank_mask:0xf
  s_nop 1
  v_mfma_f32_16x16x32_bf16 v[8:11], v[12:15], v[152:155], v[8:11]
  s_cmp_eq_u32 s75, 34
  s_cbranch_scc1 L_epi
L_dr34:
  v_and_b32_dpp v12, v31, v34 row_newbcast:13 row_mask:0xf bank_mask:0xf
  v_and_b32_dpp v13, v31, v35 row_newbcast:13 row_mask:0xf bank_mask:0xf
  v_and_b32_dpp v14, v31, v36 row_newbcast:13 row_mask:0xf bank_mask:0xf
  v_and_b32_dpp v15, v31, v0 row_newbcast:13 row_mask:0xf bank_mask:0xf
  s_nop 1
  v_mfma_f32_16x16x32_bf16 v[8:11], v[12:15], v[156:159], v[8:11]
  s_cmp_eq_u32 s75, 35
  s_cbranch_scc1 L_epi
L_dr35:
  v_and_b32_dpp v12, v31, v34 row_newbcast:14 row_mask:0xf bank_mask:0xf
  v_and_b32_dpp v13, v31, v35 row_newbcast:14 row_mask:0xf bank_mask:0xf
  v_and_b32_dpp v14, v31, v36 row_newbcast:14 row_mask:0xf bank_mask:0xf
  v_and_b32_dpp v15, v31, v0 row_newbcast:14 row_mask:0xf bank_mask:0xf
  s_nop 1
  v_mfma_f32_16x16x32_bf16 v[8:11], v[12:15], v[160:163], v[8:11]
  s_cmp_eq_u32 s75, 36
  s_cbranch_scc1 L_epi
L_dr36:
  v_and_b32_dpp v12, v31, v34 row_newbcast:15 row_mask:0xf bank_mask:0xf
  v_and_b32_dpp v13, v31, v35 row_newbcast:15 row_mask:0xf bank_mask:0xf
  v_and_b32_dpp v14, v31, v36 row_newbcast:15 row_mask:0xf bank_mask:0xf
  v_and_b32_dpp v15, v31, v0 row_newbcast:15 row_mask:0xf bank_mask:0xf
  s_nop 1
  v_mfma_f32_16x16x32_bf16 v[8:11], v[12:15], v[164:167], v[8:11]
  s_cmp_eq_u32 s75, 37
  s_cbranch_scc1 L_epi
L_dr37:
  v_and_b32_dpp v12, v33, v34 row_newbcast:0 row_mask:0xf bank_mask:0xf
  v_and_b32_dpp v13, v33, v35 row_newbcast:0 row_mask:0xf bank_mask:0xf
  v_and_b32_dpp v14, v33, v36 row_newbcast:0 row_mask:0xf bank_mask:0xf
  v_and_b32_dpp v15, v33, v0 row_newbcast:0 row_mask:0xf bank_mask:0xf
  s_nop 1
  v_mfma_f32_16x16x32_bf16 v[8:11], v[12:15], v[40:43], v[8:11]
  s_cmp_eq_u32 s75, 38
  s_cbranch_scc1 L_epi
L_dr38:
  v_and_b32_dpp v12, v33, v34 row_newbcast:1 row_mask:0xf bank_mask:0xf
  v_and_b32_dpp v13, v33, v35 row_newbcast:1 row_mask:0xf bank_mask:0xf
  v_and_b32_dpp v14, v33, v36 row_newbcast:1 row_mask:0xf bank_mask:0xf
  v_and_b32_dpp v15, v33, v0 row_newbcast:1 row_mask:0xf bank_mask:0xf
  s_nop 1
  v_mfma_f32_16x16x32_bf16 v[8:11], v[12:15], v[44:47], v[8:11]
  s_cmp_eq_u32 s75, 39
  s_cbranch_scc1 L_epi
L_dr39:
  v_and_b32_dpp v12, v33, v34 row_newbcast:2 row_mask:0xf bank_mask:0xf
  v_and_b32_dpp v13, v33, v35 row_newbcast:2 row_mask:0xf bank_mask:0xf
  v_and_b32_dpp v14, v33, v36 row_newbcast:2 row_mask:0xf bank_mask:0xf
  v_and_b32_dpp v15, v33, v0 row_newbcast:2 row_mask:0xf bank_mask:0xf
  s_nop 1
  v_mfma_f32_16x16x32_bf16 v[8:11], v[12:15], v[48:51], v[8:11]
  s_cmp_eq_u32 s75, 40
  s_cbranch_scc1 L_epi
L_dr40:
  v_and_b32_dpp v12, v33, v34 row_newbcast:3 row_mask:0xf bank_mask:0xf
  v_and_b32_dpp v13, v33, v35 row_newbcast:3 row_mask:0xf bank_mask:0xf
  v_and_b32_dpp v14, v33, v36 row_newbcast:3 row_mask:0xf bank_mask:0xf
  v_and_b32_dpp v15, v33, v0 row_newbcast:3 row_mask:0xf bank_mask:0xf
  s_nop 1
  v_mfma_f32_16x16x32_bf16 v[8:11], v[12:15], v[52:55], v[8:11]
  s_cmp_eq_u32 s75, 41
  s_cbranch_scc1 L_epi
L_dr41:
  v_and_b32_dpp v12, v33, v34 row_newbcast:4 row_mask:0xf bank_mask:0xf
  v_and_b32_dpp v13, v33, v35 row_newbcast:4 row_mask:0xf bank_mask:0xf
  v_and_b32_dpp v14, v33, v36 row_newbcast:4 row_mask:0xf bank_mask:0xf
  v_and_b32_dpp v15, v33, v0 row_newbcast:4 row_mask:0xf bank_mask:0xf
  s_nop 1
  v_mfma_f32_16x16x32_bf16 v[8:11], v[12:15], v[56:59], v[8:11]
  s_cmp_eq_u32 s75, 42
  s_cbranch_scc1 L_epi
L_dr42:
  v_and_b32_dpp v12, v33, v34 row_newbcast:5 row_mask:0xf bank_mask:0xf
  v_and_b32_dpp v13, v33, v35 row_newbcast:5 row_mask:0xf bank_mask:0xf
  v_and_b32_dpp v14, v33, v36 row_newbcast:5 row_mask:0xf bank_mask:0xf
  v_and_b32_dpp v15, v33, v0 row_newbcast:5 row_mask:0xf bank_mask:0xf
  s_nop 1
  v_mfma_f32_16x16x32_bf16 v[8:11], v[12:15], v[60:63], v[8:11]
  s_cmp_eq_u32 s75, 43
  s_cbranch_scc1 L_epi
L_epi:
  v_lshrrev_b32 v3, 4, v1
  v_lshl_add_u32 v21, v3, 3, v39
  v_add_u32 v21, s11, v21
  v_mov_b32 v3, 1
  s_nop 3
  v_pk_add_f32 v[8:9], v[8:9], v[4:5]
  v_pk_add_f32 v[10:11], v[10:11], v[6:7]
  s_mov_b32 exec_hi, 0
  ds_write_b128 v21, v[8:11] offset:1024
  s_cmp_eq_u32 s21, 0
  s_cbranch_scc1 L_ep2
  s_mov_b32 exec_hi, 0
  ds_write_b128 v21, v[8:11] offset:6656
  s_mov_b64 exec, 1
  ds_add_u32 v1, v3 offset:304
  s_mov_b64 exec, -1
L_ep2:
  s_mov_b64 exec, 1
  ds_add_u32 v1, v3 offset:308
L_send:
  s_endpgm
L_ks:
  s_cmp_lt_u32 s32, s57
  s_cbranch_scc1 L_kq
  s_call_b64 s[100:101], L_work
L_kq:
  v_readfirstlane_b32 s78, v22
  v_readfirstlane_b32 s79, v23
L_ks2:
  s_mov_b64 exec, 1
  ds_dec_u32 v2, v39 offset:288
  ds_read_b64 v[22:23], v2 offset:288
  s_mov_b64 exec, -1
  s_mul_i32 s68, s35, 11
  s_and_b32 s69, s79, 0xffff
  s_sub_i32 s68, s68, s78
  s_mul_i32 s69, s69, s77
  s_mul_i32 s68, s68, 160
  s_sub_u32 s35, s35, 1
  s_add_i32 s68, s68, s69
  s_add_i32 s68, s68, s34
  s_max_i32 s68, s68, 4915
  s_min_i32 s68, s68, 20480
  s_lshr_b32 s37, s68, 12
  s_lshl_b32 s58, s68, 20
L_kl:
  s_add_u32 s32, s32, 1
  s_add_u32 s33, s33, 0x20000000
  s_add_u32 s68, s33, s58
  s_addc_u32 s41, s37, 0
  s_cmp_eq_u32 s41, 3
  s_cbranch_scc1 L_wt3
  s_cmp_eq_u32 s41, 2
  s_cbranch_scc1 L_wt2
  s_cmp_eq_u32 s41, 4
  s_cbranch_scc1 L_wt4
  s_cmp_eq_u32 s41, 1
  s_cbranch_scc1 L_wt1
L_wtx:
  s_cmp_eq_u32 s32, s32
L_wt5:
  s_waitcnt vmcnt(4)
  s_setpc_b64 s[62:63]
L_wt3:
  s_waitcnt vmcnt(2)
  s_setpc_b64 s[62:63]
L_wt2:
  s_waitcnt vmcnt(1)
  s_setpc_b64 s[62:63]
L_wt4:
  s_waitcnt vmcnt(3)
  s_setpc_b64 s[62:63]
L_wt1:
  s_waitcnt vmcnt(0)
  s_setpc_b64 s[62:63]
L_kq2:
  v_readfirstlane_b32 s78, v22
  v_readfirstlane_b32 s79, v23
L_ks3:
  s_mov_b64 exec, 1
  ds_dec_u32 v2, v39 offset:288
  ds_dec_u32 v2, v39 offset:288
  ds_read_b64 v[22:23], v2 offset:288
  s_mov_b64 exec, -1
  s_mul_i32 s68, s35, 11
  s_and_b32 s69, s79, 0xffff
  s_sub_i32 s68, s68, s78
  s_mul_i32 s69, s69, s77
  s_mul_i32 s68, s68, 160
  s_sub_u32 s35, s35, 2
  s_add_i32 s68, s68, s69
  s_add_i32 s68, s68, s34
  s_max_i32 s68, s68, 4915
  s_min_i32 s68, s68, 20480
  s_lshr_b32 s37, s68, 12
  s_lshl_b32 s58, s68, 20
  s_branch L_kl
L_vl:
  s_cmp_lt_u32 s32, s36
  s_cbranch_scc1 L_kl
  s_branch L_ev
L_vq2:
  v_readfirstlane_b32 s78, v22
  v_readfirstlane_b32 s79, v23
  s_cmp_lt_u32 s32, s36
  s_cbranch_scc1 L_ks3
  s_branch L_ev
L_vs:
  v_readfirstlane_b32 s78, v22
  v_readfirstlane_b32 s79, v23
  s_cmp_eq_u32 s61, 2
  s_cbranch_scc1 L_vs1
  s_cmp_eq_u32 s61, 1
  s_cbranch_scc1 L_x3
  s_cmp_gt_u32 s41, s32
  s_cbranch_scc1 L_ks2
L_x1:
  s_mov_b64 vcc, s[54:55]
  v_mfma_f32_16x16x32_bf16 v[8:11], v[152:155], v[4:7], 0
  v_mfma_f32_16x16x32_bf16 v[152:155], v[156:159], v[4:7], 0
  v_mfma_f32_16x16x32_bf16 v[156:159], v[160:163], v[4:7], 0
  v_mfma_f32_16x16x32_bf16 v[160:163], v[164:167], v[4:7], 0
  s_nop 4
  v_cndmask_b32_dpp v12, v8, v9, vcc quad_perm:[0,1,2,3] row_mask:0xf bank_mask:0x1
  v_cndmask_b32_dpp v13, v10, v11, vcc quad_perm:[0,1,2,3] row_mask:0xf bank_mask:0x1
  v_cndmask_b32_dpp v12, v152, v153, vcc quad_perm:[0,1,2,3] row_mask:0xf bank_mask:0x4
  v_cndmask_b32_dpp v13, v154, v155, vcc quad_perm:[0,1,2,3] row_mask:0xf bank_mask:0x4
  v_cndmask_b32_dpp v12, v156, v157, vcc quad_perm:[0,1,2,3] row_mask:0xf bank_mask:0x2
  v_cndmask_b32_dpp v13, v158, v159, vcc quad_perm:[0,1,2,3] row_mask:0xf bank_mask:0x2
  v_cndmask_b32_dpp v12, v160, v161, vcc quad_perm:[0,1,2,3] row_mask:0xf bank_mask:0x8
  v_cndmask_b32_dpp v13, v162, v163, vcc quad_perm:[0,1,2,3] row_mask:0xf bank_mask:0x8
  v_cndmask_b32 v19, v12, v13, s[52:53]
  s_lshl_b32 s68, s20, 3
  s_add_u32 s68, s68, s56
  v_add_f32_dpp v16, v16, v16 quad_perm:[2,3,0,1] row_mask:0xf bank_mask:0xf
  v_add_f32_dpp v17, v17, v17 quad_perm:[2,3,0,1] row_mask:0xf bank_mask:0xf
  v_add_f32_dpp v18, v18, v18 quad_perm:[2,3,0,1] row_mask:0xf bank_mask:0xf
  v_add_f32_dpp v19, v19, v19 quad_perm:[2,3,0,1] row_mask:0xf bank_mask:0xf
  v_cndmask_b32 v8, v16, v17, s[52:53]
  v_cndmask_b32 v9, v18, v19, s[52:53]
  v_mov_b32 v20, 64
  v_lshlrev_b32 v21, 3, s9
  v_add_f32_dpp v8, v8, v8 quad_perm:[1,0,3,2] row_mask:0xf bank_mask:0xf
  v_add_f32_dpp v9, v9, v9 quad_perm:[1,0,3,2] row_mask:0xf bank_mask:0xf
  v_cndmask_b32 v27, v8, v9, s[54:55]
  v_cvt_pk_bf16_f32 v27, 0, v27
  v_mul_f32 v27, 0x3db504f3, v27
  v_cvt_pk_bf16_f32 v27, 0, v27
  v_max_f32 v37, v37, v27
  v_cmp_ngt_f32 vcc, s22, v27
  v_mov_b32 v4, 0
  v_max_f32_dpp v37, v37, v37 row_ror:8 row_mask:0xf bank_mask:0xf
  s_bcnt1_i32_b64 s69, vcc
  s_add_u32 s69, s69, s20
  v_max_f32_dpp v37, v37, v37 row_ror:4 row_mask:0xf bank_mask:0xf
  s_cmp_gt_u32 s69, 32
  s_cselect_b32 s21, 1, s21
  v_max_f32_dpp v37, v37, v37 row_ror:2 row_mask:0xf bank_mask:0xf
  s_cmp_eq_u32 s21, 0
  s_cselect_b64 s[66:67], vcc, 0
  s_cselect_b32 s20, s69, s20
  v_max_f32_dpp v37, v37, v37 row_ror:1 row_mask:0xf bank_mask:0xf
  v_mbcnt_lo_u32_b32 v3, s66, 0
  v_mov_b32 v8, v37
  v_mbcnt_hi_u32_b32 v3, s67, v3
  v_lshl_add_u32 v3, v3, 3, s68
  v_permlane16_swap_b32 v8, v37
  s_mov_b64 exec, s[66:67]
  ds_write_b64 v3, v[26:27] offset:1280
  s_mov_b64 exec, -1
  ds_read_b32 v32, v39 offset:1024
  v_max_f32 v37, v37, v8
  v_mov_b32 v8, v37
  v_mov_b32 v5, 0
  s_mov_b32 s18, s32
  v_permlane32_swap_b32 v8, v37
  v_max_f32 v37, v37, v8
  v_sub_f32 v17, v25, v37
  v_sub_f32 v18, v27, v37
  v_mul_f32 v17, 0x3fb8aa3b, v17
  v_mul_f32 v18, 0x3fb8aa3b, v18
  v_exp_f32 v17, v17
  v_exp_f32 v18, v18
  v_mov_b32 v16, v37
  v_add_f32 v17, v17, v18
  s_waitcnt lgkmcnt(0)
  s_cmp_le_u32 s20, 0
  s_cbranch_scc1 L_x2
  v_add_u32_dpp v3, v32, v38 row_newbcast:8 row_mask:0xf bank_mask:0xf
  buffer_load_dwordx4 v[136:139], v3, s[48:51], 0 offen nt
  s_cmp_le_u32 s20, 4
  s_cbranch_scc1 L_x2
  v_add_u32_dpp v3, v32, v38 row_newbcast:9 row_mask:0xf bank_mask:0xf
  buffer_load_dwordx4 v[140:143], v3, s[48:51], 0 offen nt
  s_cmp_le_u32 s20, 8
  s_cbranch_scc1 L_x2
  v_add_u32_dpp v3, v32, v38 row_newbcast:10 row_mask:0xf bank_mask:0xf
  buffer_load_dwordx4 v[144:147], v3, s[48:51], 0 offen nt
  s_cmp_le_u32 s20, 12
  s_cbranch_scc1 L_x2
  v_add_u32_dpp v3, v32, v38 row_newbcast:11 row_mask:0xf bank_mask:0xf
  buffer_load_dwordx4 v[148:151], v3, s[48:51], 0 offen nt
  s_cmp_le_u32 s20, 16
  s_cbranch_scc1 L_x2
  v_add_u32_dpp v3, v32, v38 row_newbcast:12 row_mask:0xf bank_mask:0xf
  buffer_load_dwordx4 v[152:155], v3, s[48:51], 0 offen nt
  s_cmp_le_u32 s20, 20
  s_cbranch_scc1 L_x2
  v_add_u32_dpp v3, v32, v38 row_newbcast:13 row_mask:0xf bank_mask:0xf
  buffer_load_dwordx4 v[156:159], v3, s[48:51], 0 offen nt
  s_cmp_le_u32 s20, 24
  s_cbranch_scc1 L_x2
  v_add_u32_dpp v3, v32, v38 row_newbcast:14 row_mask:0xf bank_mask:0xf
  buffer_load_dwordx4 v[160:163], v3, s[48:51], 0 offen nt
  s_cmp_le_u32 s20, 28
  s_cbranch_scc1 L_x2
  v_add_u32_dpp v3, v32, v38 row_newbcast:15 row_mask:0xf bank_mask:0xf
  buffer_load_dwordx4 v[164:167], v3, s[48:51], 0 offen nt
L_x2:
  s_nop 1
  v_add_f32_dpp v17, v17, v17 row_ror:8 row_mask:0xf bank_mask:0xf
  s_nop 1
  v_add_f32_dpp v17, v17, v17 row_ror:4 row_mask:0xf bank_mask:0xf
  s_nop 1
  v_add_f32_dpp v17, v17, v17 row_ror:2 row_mask:0xf bank_mask:0xf
  s_nop 1
  v_add_f32_dpp v17, v17, v17 row_ror:1 row_mask:0xf bank_mask:0xf
  v_mov_b32 v8, v17
  s_nop 1
  v_permlane16_swap_b32 v8, v17
  v_add_f32 v17, v17, v8
  v_mov_b32 v8, v17
  s_nop 1
  v_permlane32_swap_b32 v8, v17
  v_add_f32 v17, v17, v8
  s_mov_b64 exec, 1
  ds_max_f32 v1, v37 offset:276
  ds_write_b64 v21, v[16:17] offset:512
  ds_add_u32 v1, v20 offset:272
  s_mov_b64 exec, -1
  s_mov_b32 s61, 1
  s_mov_b32 s19, 1
  s_cmp_lt_u32 s32, 5
  s_cbranch_scc1 L_ks2
L_x3:
  v_max_f32 v21, s23, v37
  s_add_u32 s38, s38, 3
  s_lshr_b32 s38, s38, 2
  v_add_f32 v21, 0xc2a60000, v21
  s_max_u32 s38, s38, s32
  s_lshl_b32 s38, s38, 2
  v_cmp_nlt_f32 vcc, v27, v21
  s_lshl_b32 s68, s38, 3
  s_add_u32 s68, s68, s56
  s_andn2_b64 s[70:71], vcc, s[66:67]
  v_mbcnt_lo_u32_b32 v3, s70, 0
  v_mbcnt_hi_u32_b32 v3, s71, v3
  s_bcnt1_i32_b64 s69, s[70:71]
  v_lshl_add_u32 v3, v3, 3, s68
  s_mov_b64 exec, s[70:71]
  ds_write_b64 v3, v[26:27]
  s_mov_b64 exec, -1
  s_or_b64 s[66:67], s[66:67], s[70:71]
  s_add_u32 s38, s38, s69
  ds_read_b64 v[28:29], v39 offset:0
  ds_read_b64 v[30:31], v39 offset:512
  ds_read_b64 v[32:33], v39 offset:1024
  v_mov_b32 v8, 0
  v_mov_b32 v9, 0
  v_mov_b32 v10, 0
  v_mov_b32 v11, 0
  v_mov_b32 v6, 0
  v_mov_b32 v7, 0
  s_lshr_b32 s36, s38, 2
  s_mov_b32 s61, 2
  s_add_u32 s68, s38, 13
  s_lshr_b32 s68, s68, 2
  s_sub_u32 s69, s68, s59
  s_mov_b32 s59, s68
  s_add_u32 s35, s35, s69
  s_add_u32 s78, s78, s69
  v_mov_b32 v3, s69
  s_mov_b64 exec, 1
  ds_add_u32 v1, v3 offset:296
  ds_add_u32 v1, v3 offset:300
  s_mov_b64 exec, -1
  s_waitcnt lgkmcnt(0)
  v_sub_f32 v29, v29, v37
  v_sub_f32 v31, v31, v37
  v_sub_f32 v33, v33, v37
  v_mul_f32 v29, 0x3fb8aa3b, v29
  v_mul_f32 v31, 0x3fb8aa3b, v31
  v_mul_f32 v33, 0x3fb8aa3b, v33
  v_exp_f32 v29, v29
  v_exp_f32 v31, v31
  v_exp_f32 v33, v33
  s_nop 0
  v_cvt_pk_bf16_f32 v29, v29, v29
  v_cvt_pk_bf16_f32 v31, v31, v31
  v_cvt_pk_bf16_f32 v33, v33, v33
  s_cmp_eq_u32 s20, 0
  s_cselect_b32 s41, 0, s41
L_vs1:
  s_cmp_eq_u32 s19, 0
  s_cbranch_scc1 L_vs1b
  s_sub_u32 s68, s32, s18
  s_cmp_le_u32 s41, s68
  s_cbranch_scc1 L_snap
  s_cmp_lt_u32 s32, s36
  s_cbranch_scc1 L_ks2
  s_waitcnt vmcnt(0)
L_snap:
  s_cmp_le_u32 s20, 0
  s_cbranch_scc1 L_snp2
  v_and_b32_dpp v12, v33, v34 row_newbcast:8 row_mask:0xf bank_mask:0xf
  v_and_b32_dpp v13, v33, v35 row_newbcast:8 row_mask:0xf bank_mask:0xf
  v_and_b32_dpp v14, v33, v36 row_newbcast:8 row_mask:0xf bank_mask:0xf
  v_and_b32_dpp v15, v33, v0 row_newbcast:8 row_mask:0xf bank_mask:0xf
  s_nop 1
  v_mfma_f32_16x16x32_bf16 v[4:7], v[12:15], v[136:139], v[4:7]
  s_cmp_le_u32 s20, 4
  s_cbranch_scc1 L_snp2
  v_and_b32_dpp v12, v33, v34 row_newbcast:9 row_mask:0xf bank_mask:0xf
  v_and_b32_dpp v13, v33, v35 row_newbcast:9 row_mask:0xf bank_mask:0xf
  v_and_b32_dpp v14, v33, v36 row_newbcast:9 row_mask:0xf bank_mask:0xf
  v_and_b32_dpp v15, v33, v0 row_newbcast:9 row_mask:0xf bank_mask:0xf
  s_nop 1
  v_mfma_f32_16x16x32_bf16 v[4:7], v[12:15], v[140:143], v[4:7]
  s_cmp_le_u32 s20, 8
  s_cbranch_scc1 L_snp2
  v_and_b32_dpp v12, v33, v34 row_newbcast:10 row_mask:0xf bank_mask:0xf
  v_and_b32_dpp v13, v33, v35 row_newbcast:10 row_mask:0xf bank_mask:0xf
  v_and_b32_dpp v14, v33, v36 row_newbcast:10 row_mask:0xf bank_mask:0xf
  v_and_b32_dpp v15, v33, v0 row_newbcast:10 row_mask:0xf bank_mask:0xf
  s_nop 1
  v_mfma_f32_16x16x32_bf16 v[4:7], v[12:15], v[144:147], v[4:7]
  s_cmp_le_u32 s20, 12
  s_cbranch_scc1 L_snp2
  v_and_b32_dpp v12, v33, v34 row_newbcast:11 row_mask:0xf bank_mask:0xf
  v_and_b32_dpp v13, v33, v35 row_newbcast:11 row_mask:0xf bank_mask:0xf
  v_and_b32_dpp v14, v33, v36 row_newbcast:11 row_mask:0xf bank_mask:0xf
  v_and_b32_dpp v15, v33, v0 row_newbcast:11 row_mask:0xf bank_mask:0xf
  s_nop 1
  v_mfma_f32_16x16x32_bf16 v[4:7], v[12:15], v[148:151], v[4:7]
  s_cmp_le_u32 s20, 16
  s_cbranch_scc1 L_snp2
  v_and_b32_dpp v12, v33, v34 row_newbcast:12 row_mask:0xf bank_mask:0xf
  v_and_b32_dpp v13, v33, v35 row_newbcast:12 row_mask:0xf bank_mask:0xf
  v_and_b32_dpp v14, v33, v36 row_newbcast:12 row_mask:0xf bank_mask:0xf
  v_and_b32_dpp v15, v33, v0 row_newbcast:12 row_mask:0xf bank_mask:0xf
  s_nop 1
  v_mfma_f32_16x16x32_bf16 v[4:7], v[12:15], v[152:155], v[4:7]
  s_cmp_le_u32 s20, 20
  s_cbranch_scc1 L_snp2
  v_and_b32_dpp v12, v33, v34 row_newbcast:13 row_mask:0xf bank_mask:0xf
  v_and_b32_dpp v13, v33, v35 row_newbcast:13 row_mask:0xf bank_mask:0xf
  v_and_b32_dpp v14, v33, v36 row_newbcast:13 row_mask:0xf bank_mask:0xf
  v_and_b32_dpp v15, v33, v0 row_newbcast:13 row_mask:0xf bank_mask:0xf
  s_nop 1
  v_mfma_f32_16x16x32_bf16 v[4:7], v[12:15], v[156:159], v[4:7]
  s_cmp_le_u32 s20, 24
  s_cbranch_scc1 L_snp2
  v_and_b32_dpp v12, v33, v34 row_newbcast:14 row_mask:0xf bank_mask:0xf
  v_and_b32_dpp v13, v33, v35 row_newbcast:14 row_mask:0xf bank_mask:0xf
  v_and_b32_dpp v14, v33, v36 row_newbcast:14 row_mask:0xf bank_mask:0xf
  v_and_b32_dpp v15, v33, v0 row_newbcast:14 row_mask:0xf bank_mask:0xf
  s_nop 1
  v_mfma_f32_16x16x32_bf16 v[4:7], v[12:15], v[160:163], v[4:7]
  s_cmp_le_u32 s20, 28
  s_cbranch_scc1 L_snp2
  v_and_b32_dpp v12, v33, v34 row_newbcast:15 row_mask:0xf bank_mask:0xf
  v_and_b32_dpp v13, v33, v35 row_newbcast:15 row_mask:0xf bank_mask:0xf
  v_and_b32_dpp v14, v33, v36 row_newbcast:15 row_mask:0xf bank_mask:0xf
  v_and_b32_dpp v15, v33, v0 row_newbcast:15 row_mask:0xf bank_mask:0xf
  s_nop 1
  v_mfma_f32_16x16x32_bf16 v[4:7], v[12:15], v[164:167], v[4:7]
L_snp2:
  v_lshrrev_b32 v3, 4, v1
  v_lshl_add_u32 v21, v3, 3, v39
  v_add_u32 v21, s11, v21
  v_mov_b32 v3, 1
  s_nop 0
  s_mov_b32 s19, 0
  s_cmp_lg_u32 s21, 0
  s_cbranch_scc1 L_vs1b
  s_mov_b32 exec_hi, 0
  ds_write_b128 v21, v[4:7] offset:6656
  s_mov_b64 exec, 1
  ds_add_u32 v1, v3 offset:304
  s_mov_b64 exec, -1
  s_branch L_vs1b
L_vq:
  v_readfirstlane_b32 s78, v22
  v_readfirstlane_b32 s79, v23
L_vs1b:
L_vs2:
  s_cmp_lt_u32 s32, s36
  s_cbranch_scc1 L_ks2
L_ev:
  s_cmp_eq_u32 s75, 0
  s_cbranch_scc1 L_hand
  s_add_u32 s68, s32, 5
  s_cmp_lt_u32 s68, s75
  s_cbranch_scc0 L_wt1
  s_add_u32 s32, s32, 1
  s_mov_b64 exec, 1
  ds_dec_u32 v2, v39 offset:288
  s_mov_b64 exec, -1
  s_branch L_wtx
L_hand:
  v_mov_b32 v3, 0
  s_mov_b32 s70, 0
L_sn_1:
  ds_read_b64 v[18:19], v3 offset:272
  s_waitcnt lgkmcnt(0)
  v_cmp_gt_u32 vcc, 0x102c0, v18
  s_cmp_eq_u64 vcc, 0
  s_cbranch_scc1 L_snd_2
  s_sleep 1
  s_add_u32 s70, s70, 1
  s_cmp_lt_u32 s70, 2097152
  s_cbranch_scc1 L_sn_1
L_snd_2:
  v_add_f32 v21, 0xc2ba0000, v19
  v_cmp_nlt_f32 vcc, v25, v21
  s_lshl_b32 s68, s38, 3
  s_add_u32 s68, s68, s56
  s_andn2_b64 s[70:71], vcc, s[64:65]
  v_mbcnt_lo_u32_b32 v3, s70, 0
  v_mbcnt_hi_u32_b32 v3, s71, v3
  s_bcnt1_i32_b64 s69, s[70:71]
  v_lshl_add_u32 v3, v3, 3, s68
  s_mov_b64 exec, s[70:71]
  ds_write_b64 v3, v[24:25]
  s_mov_b64 exec, -1
  s_or_b64 s[64:65], s[64:65], s[70:71]
  s_add_u32 s38, s38, s69
  v_cmp_nlt_f32 vcc, v27, v21
  s_lshl_b32 s68, s38, 3
  s_add_u32 s68, s68, s56
  s_andn2_b64 s[70:71], vcc, s[66:67]
  v_mbcnt_lo_u32_b32 v3, s70, 0
  v_mbcnt_hi_u32_b32 v3, s71, v3
  s_bcnt1_i32_b64 s69, s[70:71]
  v_lshl_add_u32 v3, v3, 3, s68
  s_mov_b64 exec, s[70:71]
  ds_write_b64 v3, v[26:27]
  s_mov_b64 exec, -1
  s_or_b64 s[66:67], s[66:67], s[70:71]
  s_add_u32 s38, s38, s69
  ds_read_b64 v[28:29], v39 offset:0
  ds_read_b64 v[30:31], v39 offset:512
  ds_read_b64 v[32:33], v39 offset:1024
  s_add_u32 s75, s38, 23
  s_lshr_b32 s75, s75, 2
  s_sub_u32 s36, s75, 8
  s_max_i32 s36, s36, 0
  s_add_u32 s68, s38, 3
  s_lshr_b32 s68, s68, 2
  s_sub_u32 s69, s68, s59
  s_mov_b32 s59, s68
  s_add_u32 s35, s35, s69
  s_add_u32 s78, s78, s69
  v_mov_b32 v3, s69
  s_mov_b64 exec, 1
  ds_add_u32 v1, v3 offset:296
  ds_add_u32 v1, v3 offset:300
  s_mov_b64 exec, -1
  s_waitcnt lgkmcnt(0)
  v_sub_f32 v29, v29, v37
  v_sub_f32 v31, v31, v37
  v_sub_f32 v33, v33, v37
  v_mul_f32 v29, 0x3fb8aa3b, v29
  v_mul_f32 v31, 0x3fb8aa3b, v31
  v_mul_f32 v33, 0x3fb8aa3b, v33
  v_exp_f32 v29, v29
  v_exp_f32 v31, v31
  v_exp_f32 v33, v33
  s_nop 0
  v_cvt_pk_bf16_f32 v29, v29, v29
  v_cvt_pk_bf16_f32 v31, v31, v31
  v_cvt_pk_bf16_f32 v33, v33, v33
  s_branch L_vs2
L_work:
  s_cmp_eq_u32 s39, 4
  s_cbranch_scc1 L_w3
  s_cmp_eq_u32 s39, 3
  s_cbranch_scc1 L_w2b
  s_cmp_eq_u32 s39, 5
  s_cbranch_scc1 L_w5
L_w2:
  v_and_b32 v3, 0xf0, v0
  ds_read_b128 v[4:7], v3 offset:0
  s_waitcnt lgkmcnt(0)
  v_max3_u32 v8, v4, v5, v6
  v_max_u32 v8, v8, v7
  v_cmp_eq_u32 vcc, -1, v8
  s_cmp_lg_u64 vcc, 0
  s_cbranch_scc1 L_wr
  s_mov_b64 vcc, s[54:55]
  v_mfma_f32_16x16x32_bf16 v[8:11], v[40:43], v[4:7], 0
  v_mfma_f32_16x16x32_bf16 v[40:43], v[44:47], v[4:7], 0
  v_mfma_f32_16x16x32_bf16 v[44:47], v[48:51], v[4:7], 0
  v_mfma_f32_16x16x32_bf16 v[48:51], v[52:55], v[4:7], 0
  v_mfma_f32_16x16x32_bf16 v[52:55], v[56:59], v[4:7], 0
  v_mfma_f32_16x16x32_bf16 v[56:59], v[60:63], v[4:7], 0
  v_mfma_f32_16x16x32_bf16 v[60:63], v[64:67], v[4:7], 0
  v_mfma_f32_16x16x32_bf16 v[64:67], v[68:71], v[4:7], 0
  s_nop 0
  v_cndmask_b32_dpp v12, v8, v9, vcc quad_perm:[0,1,2,3] row_mask:0xf bank_mask:0x1
  v_cndmask_b32_dpp v13, v10, v11, vcc quad_perm:[0,1,2,3] row_mask:0xf bank_mask:0x1
  v_cndmask_b32_dpp v12, v40, v41, vcc quad_perm:[0,1,2,3] row_mask:0xf bank_mask:0x4
  v_cndmask_b32_dpp v13, v42, v43, vcc quad_perm:[0,1,2,3] row_mask:0xf bank_mask:0x4
  v_cndmask_b32_dpp v12, v44, v45, vcc quad_perm:[0,1,2,3] row_mask:0xf bank_mask:0x2
  v_cndmask_b32_dpp v13, v46, v47, vcc quad_perm:[0,1,2,3] row_mask:0xf bank_mask:0x2
  v_cndmask_b32_dpp v12, v48, v49, vcc quad_perm:[0,1,2,3] row_mask:0xf bank_mask:0x8
  v_cndmask_b32_dpp v13, v50, v51, vcc quad_perm:[0,1,2,3] row_mask:0xf bank_mask:0x8
  v_cndmask_b32 v16, v12, v13, s[52:53]
  v_cndmask_b32_dpp v12, v52, v53, vcc quad_perm:[0,1,2,3] row_mask:0xf bank_mask:0x1
  v_cndmask_b32_dpp v13, v54, v55, vcc quad_perm:[0,1,2,3] row_mask:0xf bank_mask:0x1
  v_cndmask_b32_dpp v12, v56, v57, vcc quad_perm:[0,1,2,3] row_mask:0xf bank_mask:0x4
  v_cndmask_b32_dpp v13, v58, v59, vcc quad_perm:[0,1,2,3] row_mask:0xf bank_mask:0x4
  v_cndmask_b32_dpp v12, v60, v61, vcc quad_perm:[0,1,2,3] row_mask:0xf bank_mask:0x2
  v_cndmask_b32_dpp v13, v62, v63, vcc quad_perm:[0,1,2,3] row_mask:0xf bank_mask:0x2
  v_cndmask_b32_dpp v12, v64, v65, vcc quad_perm:[0,1,2,3] row_mask:0xf bank_mask:0x8
  v_cndmask_b32_dpp v13, v66, v67, vcc quad_perm:[0,1,2,3] row_mask:0xf bank_mask:0x8
  v_cndmask_b32 v17, v12, v13, s[52:53]
  s_mov_b32 s39, 3
  s_mov_b32 s57, 17
L_wr:
  s_setpc_b64 s[100:101]
L_w2b:
  s_add_u32 s68, s41, 16
  s_cmp_lt_u32 s32, s68
  s_cbranch_scc1 L_wr
  s_mov_b64 vcc, s[54:55]
  v_mfma_f32_16x16x32_bf16 v[8:11], v[72:75], v[4:7], 0
  v_mfma_f32_16x16x32_bf16 v[72:75], v[76:79], v[4:7], 0
  v_mfma_f32_16x16x32_bf16 v[76:79], v[80:83], v[4:7], 0
  v_mfma_f32_16x16x32_bf16 v[80:83], v[84:87], v[4:7], 0
  v_mfma_f32_16x16x32_bf16 v[84:87], v[88:91], v[4:7], 0
  v_mfma_f32_16x16x32_bf16 v[88:91], v[92:95], v[4:7], 0
  v_mfma_f32_16x16x32_bf16 v[92:95], v[96:99], v[4:7], 0
  v_mfma_f32_16x16x32_bf16 v[96:99], v[100:103], v[4:7], 0
  s_nop 0
  v_cndmask_b32_dpp v12, v8, v9, vcc quad_perm:[0,1,2,3] row_mask:0xf bank_mask:0x1
  v_cndmask_b32_dpp v13, v10, v11, vcc quad_perm:[0,1,2,3] row_mask:0xf bank_mask:0x1
  v_cndmask_b32_dpp v12, v72, v73, vcc quad_perm:[0,1,2,3] row_mask:0xf bank_mask:0x4
  v_cndmask_b32_dpp v13, v74, v75, vcc quad_perm:[0,1,2,3] row_mask:0xf bank_mask:0x4
  v_cndmask_b32_dpp v12, v76, v77, vcc quad_perm:[0,1,2,3] row_mask:0xf bank_mask:0x2
  v_cndmask_b32_dpp v13, v78, v79, vcc quad_perm:[0,1,2,3] row_mask:0xf bank_mask:0x2
  v_cndmask_b32_dpp v12, v80, v81, vcc quad_perm:[0,1,2,3] row_mask:0xf bank_mask:0x8
  v_cndmask_b32_dpp v13, v82, v83, vcc quad_perm:[0,1,2,3] row_mask:0xf bank_mask:0x8
  v_cndmask_b32 v18, v12, v13, s[52:53]
  v_cndmask_b32_dpp v12, v84, v85, vcc quad_perm:[0,1,2,3] row_mask:0xf bank_mask:0x1
  v_cndmask_b32_dpp v13, v86, v87, vcc quad_perm:[0,1,2,3] row_mask:0xf bank_mask:0x1
  v_cndmask_b32_dpp v12, v88, v89, vcc quad_perm:[0,1,2,3] row_mask:0xf bank_mask:0x4
  v_cndmask_b32_dpp v13, v90, v91, vcc quad_perm:[0,1,2,3] row_mask:0xf bank_mask:0x4
  v_cndmask_b32_dpp v12, v92, v93, vcc quad_perm:[0,1,2,3] row_mask:0xf bank_mask:0x2
  v_cndmask_b32_dpp v13, v94, v95, vcc quad_perm:[0,1,2,3] row_mask:0xf bank_mask:0x2
  v_cndmask_b32_dpp v12, v96, v97, vcc quad_perm:[0,1,2,3] row_mask:0xf bank_mask:0x8
  v_cndmask_b32_dpp v13, v98, v99, vcc quad_perm:[0,1,2,3] row_mask:0xf bank_mask:0x8
  v_cndmask_b32 v19, v12, v13, s[52:53]
  v_mov_b32 v3, 0
  v_mov_b32 v20, 64
  v_add_f32_dpp v16, v16, v16 quad_perm:[2,3,0,1] row_mask:0xf bank_mask:0xf
  v_add_f32_dpp v17, v17, v17 quad_perm:[2,3,0,1] row_mask:0xf bank_mask:0xf
  v_add_f32_dpp v18, v18, v18 quad_perm:[2,3,0,1] row_mask:0xf bank_mask:0xf
  v_add_f32_dpp v19, v19, v19 quad_perm:[2,3,0,1] row_mask:0xf bank_mask:0xf
  v_cndmask_b32 v8, v16, v17, s[52:53]
  v_cndmask_b32 v9, v18, v19, s[52:53]
  s_nop 0
  v_lshlrev_b32 v21, 3, s9
  v_add_f32_dpp v8, v8, v8 quad_perm:[1,0,3,2] row_mask:0xf bank_mask:0xf
  v_add_f32_dpp v9, v9, v9 quad_perm:[1,0,3,2] row_mask:0xf bank_mask:0xf
  v_cndmask_b32 v25, v8, v9, s[54:55]
  v_cvt_pk_bf16_f32 v25, 0, v25
  v_mul_f32 v25, 0x3db504f3, v25
  v_cvt_pk_bf16_f32 v25, 0, v25
  v_cmp_gt_u32 vcc, s46, v24
  v_mov_b32 v37, 0xff800000
  s_nop 0
  v_cndmask_b32 v25, v37, v25, vcc
  v_mov_b32 v37, v25
  s_nop 1
  v_max_f32_dpp v37, v37, v37 row_ror:8 row_mask:0xf bank_mask:0xf
  s_nop 1
  v_max_f32_dpp v37, v37, v37 row_ror:4 row_mask:0xf bank_mask:0xf
  s_nop 1
  v_max_f32_dpp v37, v37, v37 row_ror:2 row_mask:0xf bank_mask:0xf
  s_nop 1
  v_max_f32_dpp v37, v37, v37 row_ror:1 row_mask:0xf bank_mask:0xf
  v_mov_b32 v8, v37
  s_nop 1
  v_permlane16_swap_b32 v8, v37
  v_max_f32 v37, v37, v8
  v_mov_b32 v8, v37
  s_nop 1
  v_permlane32_swap_b32 v8, v37
  v_max_f32 v37, v37, v8
  s_mov_b64 exec, 1
  ds_max_f32 v3, v37 offset:284
  ds_add_u32 v3, v20 offset:280
  s_mov_b64 exec, -1
  s_mov_b32 s39, 4
  s_mov_b32 s19, 0
  s_setpc_b64 s[100:101]
L_w5:
  s_add_u32 s68, s41, 24
  s_cmp_lt_u32 s32, s68
  s_cbranch_scc1 L_wr
  s_mov_b64 vcc, s[54:55]
  v_mfma_f32_16x16x32_bf16 v[8:11], v[104:107], v[4:7], 0
  v_mfma_f32_16x16x32_bf16 v[104:107], v[108:111], v[4:7], 0
  v_mfma_f32_16x16x32_bf16 v[108:111], v[112:115], v[4:7], 0
  v_mfma_f32_16x16x32_bf16 v[112:115], v[116:119], v[4:7], 0
  v_mfma_f32_16x16x32_bf16 v[116:119], v[120:123], v[4:7], 0
  v_mfma_f32_16x16x32_bf16 v[120:123], v[124:127], v[4:7], 0
  v_mfma_f32_16x16x32_bf16 v[124:127], v[128:131], v[4:7], 0
  v_mfma_f32_16x16x32_bf16 v[128:131], v[132:135], v[4:7], 0
  s_nop 0
  v_cndmask_b32_dpp v12, v8, v9, vcc quad_perm:[0,1,2,3] row_mask:0xf bank_mask:0x1
  v_cndmask_b32_dpp v13, v10, v11, vcc quad_perm:[0,1,2,3] row_mask:0xf bank_mask:0x1
  v_cndmask_b32_dpp v12, v104, v105, vcc quad_perm:[0,1,2,3] row_mask:0xf bank_mask:0x4
  v_cndmask_b32_dpp v13, v106, v107, vcc quad_perm:[0,1,2,3] row_mask:0xf bank_mask:0x4
  v_cndmask_b32_dpp v12, v108, v109, vcc quad_perm:[0,1,2,3] row_mask:0xf bank_mask:0x2
  v_cndmask_b32_dpp v13, v110, v111, vcc quad_perm:[0,1,2,3] row_mask:0xf bank_mask:0x2
  v_cndmask_b32_dpp v12, v112, v113, vcc quad_perm:[0,1,2,3] row_mask:0xf bank_mask:0x8
  v_cndmask_b32_dpp v13, v114, v115, vcc quad_perm:[0,1,2,3] row_mask:0xf bank_mask:0x8
  v_cndmask_b32 v16, v12, v13, s[52:53]
  v_cndmask_b32_dpp v12, v116, v117, vcc quad_perm:[0,1,2,3] row_mask:0xf bank_mask:0x1
  v_cndmask_b32_dpp v13, v118, v119, vcc quad_perm:[0,1,2,3] row_mask:0xf bank_mask:0x1
  v_cndmask_b32_dpp v12, v120, v121, vcc quad_perm:[0,1,2,3] row_mask:0xf bank_mask:0x4
  v_cndmask_b32_dpp v13, v122, v123, vcc quad_perm:[0,1,2,3] row_mask:0xf bank_mask:0x4
  v_cndmask_b32_dpp v12, v124, v125, vcc quad_perm:[0,1,2,3] row_mask:0xf bank_mask:0x2
  v_cndmask_b32_dpp v13, v126, v127, vcc quad_perm:[0,1,2,3] row_mask:0xf bank_mask:0x2
  v_cndmask_b32_dpp v12, v128, v129, vcc quad_perm:[0,1,2,3] row_mask:0xf bank_mask:0x8
  v_cndmask_b32_dpp v13, v130, v131, vcc quad_perm:[0,1,2,3] row_mask:0xf bank_mask:0x8
  v_cndmask_b32 v17, v12, v13, s[52:53]
  s_mov_b32 s39, 6
  s_mov_b32 s57, 99
  s_setpc_b64 s[100:101]
L_w3:
  v_mov_b32 v3, 0
  ds_read_b64 v[18:19], v3 offset:280
  s_waitcnt lgkmcnt(0)
  v_cmp_gt_u32 vcc, 0x102c0, v18
  s_cmp_lg_u64 vcc, 0
  s_cbranch_scc1 L_wr
  ds_read_b64 v[20:21], v3 offset:320
  s_waitcnt lgkmcnt(0)
  v_add_f32 v21, 0xc1c00000, v21
  v_cmp_nlt_f32 vcc, v25, v21
  v_readfirstlane_b32 s22, v21
  v_readfirstlane_b32 s23, v20
  s_mov_b32 s20, 0
  s_bcnt1_i32_b64 s68, vcc
  s_cmp_gt_u32 s68, 32
  s_cselect_b32 s21, 1, 0
  s_cbranch_scc1 L_w4
  s_mov_b32 s38, 160
  v_cmp_nlt_f32 vcc, v25, v21
  s_lshl_b32 s68, s38, 3
  s_add_u32 s68, s68, s56
  s_andn2_b64 s[70:71], vcc, s[64:65]
  v_mbcnt_lo_u32_b32 v3, s70, 0
  v_mbcnt_hi_u32_b32 v3, s71, v3
  s_bcnt1_i32_b64 s69, s[70:71]
  v_lshl_add_u32 v3, v3, 3, s68
  s_mov_b64 exec, s[70:71]
  ds_write_b64 v3, v[24:25]
  s_mov_b64 exec, -1
  s_or_b64 s[64:65], s[64:65], s[70:71]
  s_add_u32 s38, s38, s69
  s_mov_b32 s20, s69
  s_mov_b32 s38, 0
L_w4:
  v_add_f32 v21, 0xc2a60000, v20
  v_cmp_nlt_f32 vcc, v25, v21
  s_lshl_b32 s68, s38, 3
  s_add_u32 s68, s68, s56
  s_andn2_b64 s[70:71], vcc, s[64:65]
  v_mbcnt_lo_u32_b32 v3, s70, 0
  v_mbcnt_hi_u32_b32 v3, s71, v3
  s_bcnt1_i32_b64 s69, s[70:71]
  v_lshl_add_u32 v3, v3, 3, s68
  s_mov_b64 exec, s[70:71]
  ds_write_b64 v3, v[24:25]
  s_mov_b64 exec, -1
  s_or_b64 s[64:65], s[64:65], s[70:71]
  s_add_u32 s38, s38, s69
  s_add_u32 s68, s38, 6
  s_lshr_b32 s68, s68, 1
  s_sub_u32 s69, s68, s59
  s_mov_b32 s59, s68
  v_mov_b32 v3, s69
  s_mov_b64 exec, 1
  ds_add_u32 v1, v3 offset:296
  ds_add_u32 v1, v3 offset:300
  s_mov_b64 exec, -1
  s_sub_i32 s68, s59, 20
  s_max_i32 s68, s68, -4
  s_mul_i32 s68, s68, 245
  s_add_i32 s34, s34, s68
  s_mov_b32 s39, 5
  s_mov_b32 s57, 25
  ds_read_b64 v[28:29], v39 offset:0
  s_waitcnt lgkmcnt(0)
  s_setpc_b64 s[100:101]
L_pub:
  s_getpc_b64 s[56:57]
L_pct:
  s_lshr_b32 s3, s2, 3
  s_lshl_b32 s3, s3, 2
  s_add_u32 s3, s3, L_touch-L_pct
  s_load_dword s14, s[56:57], s3
  s_waitcnt lgkmcnt(0)
  s_bfe_u32 s48, s14, 0x30000
  s_lshl_b32 s48, s48, 6
  v_add_u32 v2, s48, v1
  s_bfe_u32 s48, s14, 0x30003
  s_bitcmp1_b32 s14, 7
  s_cbranch_scc1 L_te_4
  s_bitcmp1_b32 s14, 6
  s_cbranch_scc1 L_tq_3
  s_lshl1_add_u32 s48, s8, s48
  s_lshl_b32 s48, s48, 7
  v_mul_u32_u24 v2, 6144, v2
  v_add_u32 v2, s48, v2
  global_load_dword v167, v2, s[36:37]
  s_branch L_te_4
L_tq_3:
  s_lshl3_add_u32 s48, s8, s48
  s_lshl_b32 s48, s48, 7
  v_lshl_add_u32 v2, v2, 13, s48
  global_load_dword v167, v2, s[22:23]
L_te_4:
  s_bfe_u32 s48, s14, 0x30008
  s_lshl_b32 s48, s48, 6
  v_add_u32 v2, s48, v1
  s_bfe_u32 s48, s14, 0x3000b
  s_bitcmp1_b32 s14, 15
  s_cbranch_scc1 L_te_6
  s_bitcmp1_b32 s14, 14
  s_cbranch_scc1 L_tq_5
  s_lshl1_add_u32 s48, s8, s48
  s_lshl_b32 s48, s48, 7
  v_mul_u32_u24 v2, 6144, v2
  v_add_u32 v2, s48, v2
  global_load_dword v167, v2, s[36:37]
  s_branch L_te_6
L_tq_5:
  s_lshl3_add_u32 s48, s8, s48
  s_lshl_b32 s48, s48, 7
  v_lshl_add_u32 v2, v2, 13, s48
  global_load_dword v167, v2, s[22:23]
L_te_6:
  v_mov_b32 v38, 0
  v_mov_b32 v4, -1
  v_mov_b32 v8, 0xff800000
  v_mov_b32 v9, 0
  v_lshlrev_b32 v2, 3, v1
  ds_write_b64 v2, v[8:9] offset:448
  v_mov_b32 v5, 0
  v_mov_b32 v6, 0
  v_mov_b32 v7, 0
  v_lshlrev_b32 v2, 2, v1
  ds_write_b32 v2, v4 offset:0
  ds_write_b128 v38, v[4:7] offset:256
  v_mov_b32 v10, 0
  v_mov_b32 v11, v8
  v_mov_b32 v12, 0
  v_mov_b32 v13, v8
  ds_write_b128 v38, v[10:13] offset:272
  v_mov_b32 v10, 1332
  v_mov_b32 v11, 0
  v_mov_b32 v12, 1024
  v_mov_b32 v13, 0
  ds_write_b128 v38, v[10:13] offset:288
  v_mov_b32 v4, 0
  ds_write_b128 v38, v[4:7] offset:304
  s_getreg_b32 s76, hwreg(HW_REG_XCC_ID, 0, 4)
  s_waitcnt lgkmcnt(0)
  s_load_dword s74, s[42:43], 0
  s_barrier
  s_waitcnt lgkmcnt(0)
  s_mul_i32 s74, s74, 0x9e3779b1
  s_add_u32 s74, s74, 0x7f4a7c15
  s_add_u32 s76, s76, s74
  s_lshl2_add_u32 s64, s6, s7
  s_lshl_b32 s64, s64, 7
  s_add_u32 s64, s64, 65536
  v_mov_b32 v18, s64
  v_add_u32 v19, 32768, v18
  v_mov_b32 v17, 0x10000
  s_lshl2_add_u32 s49, s6, s7
  s_lshl_b32 s49, s49, 9
  s_add_u32 s49, s49, 131072
  v_and_b32 v10, 3, v1
  v_lshl_add_u32 v10, v10, 7, s49
  v_bfe_u32 v11, v1, 2, 1
  v_mul_u32_u24 v11, 393216, v11
  v_add_u32 v10, v10, v11
  s_mov_b64 exec, 0xff
  global_load_dword v166, v10, s[42:43] sc1
  s_mov_b64 exec, 1
  global_load_dword v166, v18, s[42:43] sc1
  global_load_dword v166, v19, s[42:43] sc1
  s_mov_b64 exec, -1
  s_mov_b32 s70, 0
L_qw_7:
  ds_read_b32 v8, v38 offset:288
  s_waitcnt lgkmcnt(0)
  v_cmp_lt_u32 vcc, 1233, v8
  s_cmp_eq_u64 vcc, 0
  s_cbranch_scc1 L_qw_7d
  s_sleep 4
  s_add_u32 s70, s70, 1
  s_cmp_lt_u32 s70, 2097152
  s_cbranch_scc1 L_qw_7
L_qw_7d:
  s_lshl_b32 s3, s6, 9
  s_mov_b64 exec, 1
  s_mov_b32 s70, 0
L_qp0:
  s_load_dwordx16 s[8:23], s[42:43], s3 offset:32768 glc
  s_load_dwordx16 s[24:39], s[42:43], s3 offset:32832 glc
  s_load_dwordx16 s[44:59], s[42:43], s3 offset:32896 glc
  s_load_dwordx16 s[84:99], s[42:43], s3 offset:32960 glc
  s_mov_b32 s62, -1
  s_mov_b32 s63, 0
  s_waitcnt lgkmcnt(0)
  s_and_b32 s62, s62, s9
  s_or_b32 s63, s63, s9
  s_and_b32 s62, s62, s11
  s_or_b32 s63, s63, s11
  s_and_b32 s62, s62, s13
  s_or_b32 s63, s63, s13
  s_and_b32 s62, s62, s15
  s_or_b32 s63, s63, s15
  s_and_b32 s62, s62, s17
  s_or_b32 s63, s63, s17
  s_and_b32 s62, s62, s19
  s_or_b32 s63, s63, s19
  s_and_b32 s62, s62, s21
  s_or_b32 s63, s63, s21
  s_and_b32 s62, s62, s23
  s_or_b32 s63, s63, s23
  s_and_b32 s62, s62, s25
  s_or_b32 s63, s63, s25
  s_and_b32 s62, s62, s27
  s_or_b32 s63, s63, s27
  s_and_b32 s62, s62, s29
  s_or_b32 s63, s63, s29
  s_and_b32 s62, s62, s31
  s_or_b32 s63, s63, s31
  s_and_b32 s62, s62, s33
  s_or_b32 s63, s63, s33
  s_and_b32 s62, s62, s35
  s_or_b32 s63, s63, s35
  s_and_b32 s62, s62, s37
  s_or_b32 s63, s63, s37
  s_and_b32 s62, s62, s39
  s_or_b32 s63, s63, s39
  s_and_b32 s62, s62, s45
  s_or_b32 s63, s63, s45
  s_and_b32 s62, s62, s47
  s_or_b32 s63, s63, s47
  s_and_b32 s62, s62, s49
  s_or_b32 s63, s63, s49
  s_and_b32 s62, s62, s51
  s_or_b32 s63, s63, s51
  s_and_b32 s62, s62, s53
  s_or_b32 s63, s63, s53
  s_and_b32 s62, s62, s55
  s_or_b32 s63, s63, s55
  s_and_b32 s62, s62, s57
  s_or_b32 s63, s63, s57
  s_and_b32 s62, s62, s59
  s_or_b32 s63, s63, s59
  s_and_b32 s62, s62, s85
  s_or_b32 s63, s63, s85
  s_and_b32 s62, s62, s87
  s_or_b32 s63, s63, s87
  s_and_b32 s62, s62, s89
  s_or_b32 s63, s63, s89
  s_and_b32 s62, s62, s91
  s_or_b32 s63, s63, s91
  s_and_b32 s62, s62, s93
  s_or_b32 s63, s63, s93
  s_and_b32 s62, s62, s95
  s_or_b32 s63, s63, s95
  s_and_b32 s62, s62, s97
  s_or_b32 s63, s63, s97
  s_and_b32 s62, s62, s99
  s_or_b32 s63, s63, s99
  s_xor_b32 s62, s62, s74
  s_xor_b32 s63, s63, s74
  s_or_b32 s62, s62, s63
  s_cbranch_scc0 L_qp0d
  s_sleep 2
  s_add_u32 s70, s70, 1
  s_cmp_lt_u32 s70, 262144
  s_cbranch_scc1 L_qp0
L_qp0d:
  v_mov_b32 v40, s8
  v_mov_b32 v41, s10
  v_mov_b32 v42, s12
  v_mov_b32 v43, s14
  v_mov_b32 v44, s16
  v_mov_b32 v45, s18
  v_mov_b32 v46, s20
  v_mov_b32 v47, s22
  v_mov_b32 v48, s24
  v_mov_b32 v49, s26
  v_mov_b32 v50, s28
  v_mov_b32 v51, s30
  v_mov_b32 v52, s32
  v_mov_b32 v53, s34
  v_mov_b32 v54, s36
  v_mov_b32 v55, s38
  v_mov_b32 v56, s44
  v_mov_b32 v57, s46
  v_mov_b32 v58, s48
  v_mov_b32 v59, s50
  v_mov_b32 v60, s52
  v_mov_b32 v61, s54
  v_mov_b32 v62, s56
  v_mov_b32 v63, s58
  v_mov_b32 v64, s84
  v_mov_b32 v65, s86
  v_mov_b32 v66, s88
  v_mov_b32 v67, s90
  v_mov_b32 v68, s92
  v_mov_b32 v69, s94
  v_mov_b32 v70, s96
  v_mov_b32 v71, s98
  s_mov_b32 s70, 0
L_qp1:
  s_load_dwordx16 s[8:23], s[42:43], s3 offset:33024 glc
  s_load_dwordx16 s[24:39], s[42:43], s3 offset:33088 glc
  s_load_dwordx16 s[44:59], s[42:43], s3 offset:33152 glc
  s_load_dwordx16 s[84:99], s[42:43], s3 offset:33216 glc
  s_mov_b32 s62, -1
  s_mov_b32 s63, 0
  s_waitcnt lgkmcnt(0)
  s_and_b32 s62, s62, s9
  s_or_b32 s63, s63, s9
  s_and_b32 s62, s62, s11
  s_or_b32 s63, s63, s11
  s_and_b32 s62, s62, s13
  s_or_b32 s63, s63, s13
  s_and_b32 s62, s62, s15
  s_or_b32 s63, s63, s15
  s_and_b32 s62, s62, s17
  s_or_b32 s63, s63, s17
  s_and_b32 s62, s62, s19
  s_or_b32 s63, s63, s19
  s_and_b32 s62, s62, s21
  s_or_b32 s63, s63, s21
  s_and_b32 s62, s62, s23
  s_or_b32 s63, s63, s23
  s_and_b32 s62, s62, s25
  s_or_b32 s63, s63, s25
  s_and_b32 s62, s62, s27
  s_or_b32 s63, s63, s27
  s_and_b32 s62, s62, s29
  s_or_b32 s63, s63, s29
  s_and_b32 s62, s62, s31
  s_or_b32 s63, s63, s31
  s_and_b32 s62, s62, s33
  s_or_b32 s63, s63, s33
  s_and_b32 s62, s62, s35
  s_or_b32 s63, s63, s35
  s_and_b32 s62, s62, s37
  s_or_b32 s63, s63, s37
  s_and_b32 s62, s62, s39
  s_or_b32 s63, s63, s39
  s_and_b32 s62, s62, s45
  s_or_b32 s63, s63, s45
  s_and_b32 s62, s62, s47
  s_or_b32 s63, s63, s47
  s_and_b32 s62, s62, s49
  s_or_b32 s63, s63, s49
  s_and_b32 s62, s62, s51
  s_or_b32 s63, s63, s51
  s_and_b32 s62, s62, s53
  s_or_b32 s63, s63, s53
  s_and_b32 s62, s62, s55
  s_or_b32 s63, s63, s55
  s_and_b32 s62, s62, s57
  s_or_b32 s63, s63, s57
  s_and_b32 s62, s62, s59
  s_or_b32 s63, s63, s59
  s_and_b32 s62, s62, s85
  s_or_b32 s63, s63, s85
  s_and_b32 s62, s62, s87
  s_or_b32 s63, s63, s87
  s_and_b32 s62, s62, s89
  s_or_b32 s63, s63, s89
  s_and_b32 s62, s62, s91
  s_or_b32 s63, s63, s91
  s_and_b32 s62, s62, s93
  s_or_b32 s63, s63, s93
  s_and_b32 s62, s62, s95
  s_or_b32 s63, s63, s95
  s_and_b32 s62, s62, s97
  s_or_b32 s63, s63, s97
  s_and_b32 s62, s62, s99
  s_or_b32 s63, s63, s99
  s_xor_b32 s62, s62, s74
  s_xor_b32 s63, s63, s74
  s_or_b32 s62, s62, s63
  s_cbranch_scc0 L_qp1d
  s_sleep 2
  s_add_u32 s70, s70, 1
  s_cmp_lt_u32 s70, 262144
  s_cbranch_scc1 L_qp1
L_qp1d:
  v_mov_b32 v72, s8
  v_mov_b32 v73, s10
  v_mov_b32 v74, s12
  v_mov_b32 v75, s14
  v_mov_b32 v76, s16
  v_mov_b32 v77, s18
  v_mov_b32 v78, s20
  v_mov_b32 v79, s22
  v_mov_b32 v80, s24
  v_mov_b32 v81, s26
  v_mov_b32 v82, s28
  v_mov_b32 v83, s30
  v_mov_b32 v84, s32
  v_mov_b32 v85, s34
  v_mov_b32 v86, s36
  v_mov_b32 v87, s38
  v_mov_b32 v88, s44
  v_mov_b32 v89, s46
  v_mov_b32 v90, s48
  v_mov_b32 v91, s50
  v_mov_b32 v92, s52
  v_mov_b32 v93, s54
  v_mov_b32 v94, s56
  v_mov_b32 v95, s58
  v_mov_b32 v96, s84
  v_mov_b32 v97, s86
  v_mov_b32 v98, s88
  v_mov_b32 v99, s90
  v_mov_b32 v100, s92
  v_mov_b32 v101, s94
  v_mov_b32 v102, s96
  v_mov_b32 v103, s98
  ds_write_b128 v38, v[40:43] offset:0
  ds_write_b128 v38, v[44:47] offset:16
  ds_write_b128 v38, v[48:51] offset:32
  ds_write_b128 v38, v[52:55] offset:48
  ds_write_b128 v38, v[56:59] offset:64
  ds_write_b128 v38, v[60:63] offset:80
  ds_write_b128 v38, v[64:67] offset:96
  ds_write_b128 v38, v[68:71] offset:112
  ds_write_b128 v38, v[72:75] offset:128
  ds_write_b128 v38, v[76:79] offset:144
  ds_write_b128 v38, v[80:83] offset:160
  ds_write_b128 v38, v[84:87] offset:176
  ds_write_b128 v38, v[88:91] offset:192
  ds_write_b128 v38, v[92:95] offset:208
  ds_write_b128 v38, v[96:99] offset:224
  ds_write_b128 v38, v[100:103] offset:240
  s_mov_b64 exec, -1
  s_and_b32 s8, s2, 7
  s_mov_b32 s13, 0
  s_add_u32 s52, s7, 1
  s_cmp_eq_u32 s52, 3
  s_cselect_b32 s52, 0, s52
  s_add_u32 s53, s52, s7
  s_sub_u32 s53, 3, s53
  s_lshl2_add_u32 s54, s6, s52
  s_lshl_b32 s54, s54, 7
  s_lshl2_add_u32 s55, s6, s53
  s_lshl_b32 s55, s55, 7
  s_mov_b32 s70, 0
L_sn_8:
  ds_read_b64 v[8:9], v38 offset:280
  s_waitcnt lgkmcnt(0)
  v_cmp_gt_u32 vcc, 0x2c0, v8
  s_cmp_eq_u64 vcc, 0
  s_cbranch_scc1 L_snd_9
  s_sleep 2
  s_add_u32 s70, s70, 1
  s_cmp_lt_u32 s70, 2097152
  s_cbranch_scc1 L_sn_8
L_snd_9:
  s_load_dwordx2 s[20:21], s[42:43], s54 offset:65536 glc
  s_load_dwordx2 s[24:25], s[42:43], s55 offset:65536 glc
  v_mov_b32 v8, v9
  v_mov_b32 v9, s74
  s_mov_b64 exec, 1
  global_store_dwordx2 v18, v[8:9], s[42:43] sc1
  s_mov_b32 s70, 0
  s_branch L_s3ec
L_s3e:
  s_load_dwordx2 s[20:21], s[42:43], s54 offset:65536 glc
  s_load_dwordx2 s[24:25], s[42:43], s55 offset:65536 glc
L_s3ec:
  s_waitcnt lgkmcnt(0)
  s_xor_b32 s68, s21, s74
  s_xor_b32 s69, s25, s74
  s_or_b32 s68, s68, s69
  s_cbranch_scc0 L_s3ed
  s_sleep 2
  s_add_u32 s70, s70, 1
  s_cmp_lt_u32 s70, 262144
  s_cbranch_scc1 L_s3e
L_s3ed:
  v_mov_b32 v12, s20
  v_max3_f32 v10, v8, v12, s24
  v_min3_f32 v11, v8, v12, s24
  ds_write_b64 v38, v[10:11] offset:320
  ds_add_u32 v38, v17 offset:280
  s_mov_b64 exec, -1
  s_lshl_b32 s64, s8, 7
  s_load_dwordx8 s[20:27], s[42:43], s64 offset:1024 glc
  s_waitcnt lgkmcnt(0)
  s_xor_b32 s68, s20, s76
  s_xor_b32 s69, s21, s76
  s_or_b32 s68, s68, s69
  s_xor_b32 s69, s22, s76
  s_or_b32 s68, s68, s69
  s_xor_b32 s69, s23, s76
  s_or_b32 s68, s68, s69
  s_xor_b32 s69, s24, s76
  s_or_b32 s68, s68, s69
  s_xor_b32 s69, s25, s76
  s_or_b32 s68, s68, s69
  s_xor_b32 s69, s26, s76
  s_or_b32 s68, s68, s69
  s_xor_b32 s69, s27, s76
  s_or_b32 s68, s68, s69
  s_cselect_b32 s75, 0, 1
  v_lshlrev_b32 v20, 3, s7
  v_lshlrev_b32 v21, 3, s52
  v_lshlrev_b32 v22, 3, s53
  s_mov_b32 s70, 0
L_sn_10:
  ds_read_b32 v8, v38 offset:272
  s_waitcnt lgkmcnt(0)
  v_cmp_gt_u32 vcc, 0x2c0, v8
  s_cmp_eq_u64 vcc, 0
  s_cbranch_scc1 L_snd_11
  s_sleep 1
  s_add_u32 s70, s70, 1
  s_cmp_lt_u32 s70, 2097152
  s_cbranch_scc1 L_sn_10
L_snd_11:
  v_and_b32 v9, 15, v1
  v_lshlrev_b32 v9, 3, v9
  ds_read_b64 v[10:11], v9 offset:512
  s_waitcnt lgkmcnt(0)
  v_mov_b32 v16, v10
  v_max_f32_dpp v8, v10, v10 quad_perm:[1,0,3,2] row_mask:0xf bank_mask:0xf
  s_nop 1
  v_max_f32_dpp v8, v8, v8 quad_perm:[2,3,0,1] row_mask:0xf bank_mask:0xf
  s_nop 1
  v_max_f32_dpp v8, v8, v8 row_half_mirror row_mask:0xf bank_mask:0xf
  s_nop 1
  v_max_f32_dpp v8, v8, v8 row_mirror row_mask:0xf bank_mask:0xf
  v_sub_f32 v9, v10, v8
  v_mul_f32 v9, 0x3fb8aa3b, v9
  v_exp_f32 v9, v9
  s_nop 0
  v_mul_f32 v10, v9, v11
  s_nop 1
  v_add_f32_dpp v10, v10, v10 quad_perm:[1,0,3,2] row_mask:0xf bank_mask:0xf
  s_nop 1
  v_add_f32_dpp v10, v10, v10 quad_perm:[2,3,0,1] row_mask:0xf bank_mask:0xf
  s_nop 1
  v_add_f32_dpp v10, v10, v10 row_half_mirror row_mask:0xf bank_mask:0xf
  s_nop 1
  v_add_f32_dpp v10, v10, v10 row_mirror row_mask:0xf bank_mask:0xf
  s_load_dwordx4 s[20:23], s[42:43], s54 offset:98304 glc
  s_load_dwordx4 s[24:27], s[42:43], s55 offset:98304 glc
  v_mov_b32 v9, s74
  v_mov_b32 v11, s74
  s_mov_b64 exec, 1
  global_store_dwordx4 v19, v[8:11], s[42:43] sc1
  ds_write_b32 v20, v8 offset:448
  ds_write_b32 v20, v10 offset:452
  s_mov_b32 s70, 0
  s_branch L_s3pc
L_s3p:
  s_load_dwordx4 s[20:23], s[42:43], s54 offset:98304 glc
  s_load_dwordx4 s[24:27], s[42:43], s55 offset:98304 glc
L_s3pc:
  s_waitcnt lgkmcnt(0)
  s_xor_b32 s68, s21, s74
  s_xor_b32 s69, s23, s74
  s_or_b32 s68, s68, s69
  s_xor_b32 s69, s25, s74
  s_or_b32 s68, s68, s69
  s_xor_b32 s69, s27, s74
  s_or_b32 s68, s68, s69
  s_cbranch_scc0 L_s3pd
  s_sleep 2
  s_add_u32 s70, s70, 1
  s_cmp_lt_u32 s70, 262144
  s_cbranch_scc1 L_s3p
L_s3pd:
  v_mov_b32 v12, s20
  v_mov_b32 v13, s22
  v_mov_b32 v14, s24
  v_mov_b32 v15, s26
  v_max_f32 v23, v12, v14
  ds_max_f32 v38, v23 offset:276
  ds_add_u32 v38, v17 offset:272
  ds_add_u32 v38, v17 offset:300
  ds_write_b64 v21, v[12:13] offset:448
  ds_write_b64 v22, v[14:15] offset:448
  s_mov_b64 exec, -1
  v_and_b32 v9, 3, v1
  v_lshlrev_b32 v9, 3, v9
  ds_read_b64 v[10:11], v9 offset:448
  s_waitcnt lgkmcnt(0)
  v_max_f32_dpp v8, v10, v10 quad_perm:[1,0,3,2] row_mask:0xf bank_mask:0xf
  s_nop 1
  v_max_f32_dpp v8, v8, v8 quad_perm:[2,3,0,1] row_mask:0xf bank_mask:0xf
  v_sub_f32 v9, v10, v8
  v_mul_f32 v9, 0x3fb8aa3b, v9
  v_exp_f32 v9, v9
  s_nop 0
  v_mul_f32 v10, v9, v11
  s_nop 1
  v_add_f32_dpp v10, v10, v10 quad_perm:[1,0,3,2] row_mask:0xf bank_mask:0xf
  s_nop 1
  v_add_f32_dpp v10, v10, v10 quad_perm:[2,3,0,1] row_mask:0xf bank_mask:0xf
  v_sub_f32 v9, v16, v8
  v_rcp_f32 v10, v10
  v_mul_f32 v9, 0x3fb8aa3b, v9
  v_exp_f32 v9, v9
  v_lshlrev_b32 v8, 2, v1
  v_mul_f32 v9, v9, v10
  s_mov_b64 exec, 0xffff
  ds_write_b32 v8, v9 offset:384
  s_mov_b64 exec, -1
  ds_write_b32 v38, v38 offset:256
  ds_read_b128 v[62:65], v38 offset:384
  ds_read_b128 v[66:69], v38 offset:400
  ds_read_b128 v[70:73], v38 offset:416
  v_lshlrev_b32 v77, 3, v1
  s_lshl2_add_u32 s68, s6, s7
  s_lshl_b32 s68, s68, 9
  s_add_u32 s68, s68, 131072
  v_add_u32 v74, s68, v77
  v_and_b32 v75, 1, v1
  v_lshlrev_b32 v75, 4, v75
  v_lshrrev_b32 v75, v75, s74
  v_lshrrev_b32 v76, 8, v75
  s_mov_b32 s70, 0
L_sn_12:
  ds_read_b32 v8, v38 offset:304
  s_waitcnt lgkmcnt(0)
  v_cmp_gt_u32 vcc, 0xa, v8
  s_cmp_eq_u64 vcc, 0
  s_cbranch_scc1 L_snd_13
  s_sleep 1
  s_add_u32 s70, s70, 1
  s_cmp_lt_u32 s70, 2097152
  s_cbranch_scc1 L_sn_12
L_snd_13:
  s_mov_b32 s70, 0
L_wt_14:
  ds_read_b32 v8, v38 offset:304
  ds_read_b64 v[40:41], v77 offset:6656
  ds_read_b64 v[42:43], v77 offset:7168
  ds_read_b64 v[44:45], v77 offset:7680
  ds_read_b64 v[46:47], v77 offset:8192
  ds_read_b64 v[48:49], v77 offset:8704
  ds_read_b64 v[50:51], v77 offset:9216
  ds_read_b64 v[52:53], v77 offset:9728
  ds_read_b64 v[54:55], v77 offset:10240
  ds_read_b64 v[56:57], v77 offset:10752
  ds_read_b64 v[58:59], v77 offset:11264
  ds_read_b64 v[60:61], v77 offset:11776
  s_waitcnt lgkmcnt(11)
  v_cmp_gt_u32 vcc, 11, v8
  s_cmp_eq_u64 vcc, 0
  s_cbranch_scc1 L_wtd_15
  s_waitcnt lgkmcnt(0)
  s_add_u32 s70, s70, 1
  s_cmp_lt_u32 s70, 2097152
  s_cbranch_scc1 L_wt_14
L_wtd_15:
  s_movk_i32 s69, 0xff
  s_waitcnt lgkmcnt(10)
  v_pk_mul_f32 v[40:41], v[40:41], v[62:63] op_sel:[0,0] op_sel_hi:[1,0]
  s_waitcnt lgkmcnt(9)
  v_pk_mul_f32 v[42:43], v[42:43], v[62:63] op_sel:[0,1] op_sel_hi:[1,1]
  s_waitcnt lgkmcnt(8)
  v_pk_fma_f32 v[40:41], v[44:45], v[64:65], v[40:41] op_sel:[0,0,0] op_sel_hi:[1,0,1]
  s_waitcnt lgkmcnt(7)
  v_pk_fma_f32 v[42:43], v[46:47], v[64:65], v[42:43] op_sel:[0,1,0] op_sel_hi:[1,1,1]
  s_waitcnt lgkmcnt(6)
  v_pk_fma_f32 v[40:41], v[48:49], v[66:67], v[40:41] op_sel:[0,0,0] op_sel_hi:[1,0,1]
  s_waitcnt lgkmcnt(5)
  v_pk_fma_f32 v[42:43], v[50:51], v[66:67], v[42:43] op_sel:[0,1,0] op_sel_hi:[1,1,1]
  s_waitcnt lgkmcnt(4)
  v_pk_fma_f32 v[40:41], v[52:53], v[68:69], v[40:41] op_sel:[0,0,0] op_sel_hi:[1,0,1]
  s_waitcnt lgkmcnt(3)
  v_pk_fma_f32 v[42:43], v[54:55], v[68:69], v[42:43] op_sel:[0,1,0] op_sel_hi:[1,1,1]
  s_waitcnt lgkmcnt(2)
  v_pk_fma_f32 v[40:41], v[56:57], v[70:71], v[40:41] op_sel:[0,0,0] op_sel_hi:[1,0,1]
  s_waitcnt lgkmcnt(1)
  v_pk_fma_f32 v[42:43], v[58:59], v[70:71], v[42:43] op_sel:[0,1,0] op_sel_hi:[1,1,1]
  s_waitcnt lgkmcnt(0)
  v_pk_fma_f32 v[40:41], v[60:61], v[72:73], v[40:41] op_sel:[0,0,0] op_sel_hi:[1,0,1]
  v_pk_add_f32 v[40:41], v[40:41], v[42:43]
  v_bfi_b32 v40, s69, v75, v40
  v_bfi_b32 v41, s69, v76, v41
  s_cmp_eq_u32 s75, 1
  s_cbranch_scc0 L_pf_16
  global_store_dwordx2 v74, v[40:41], s[42:43]
  s_branch L_pe_17
L_pf_16:
  global_store_dwordx2 v74, v[40:41], s[42:43] sc1
L_pe_17:
  ds_read_b128 v[102:105], v38 offset:384
  ds_read_b128 v[106:109], v38 offset:400
  ds_read_b128 v[110:113], v38 offset:416
  v_lshlrev_b32 v117, 3, v1
  s_lshl2_add_u32 s68, s6, s7
  s_lshl_b32 s68, s68, 9
  s_add_u32 s68, s68, 524288
  v_add_u32 v114, s68, v117
  v_and_b32 v115, 1, v1
  v_lshlrev_b32 v115, 4, v115
  v_lshrrev_b32 v115, v115, s74
  v_lshrrev_b32 v116, 8, v115
  s_waitcnt vmcnt(0)
  s_mov_b32 s70, 0
L_sn_18:
  ds_read_b32 v8, v38 offset:308
  s_waitcnt lgkmcnt(0)
  v_cmp_gt_u32 vcc, 0x1, v8
  s_cmp_eq_u64 vcc, 0
  s_cbranch_scc1 L_snd_19
  s_sleep 4
  s_add_u32 s70, s70, 1
  s_cmp_lt_u32 s70, 2097152
  s_cbranch_scc1 L_sn_18
L_snd_19:
  global_store_dwordx2 v74, v[40:41], s[42:43] sc1
  s_cmp_eq_u32 s7, 2
  s_cbranch_scc1 L_chk
  s_mov_b32 s70, 0
L_sn_20:
  ds_read_b32 v8, v38 offset:308
  s_waitcnt lgkmcnt(0)
  v_cmp_gt_u32 vcc, 0xa, v8
  s_cmp_eq_u64 vcc, 0
  s_cbranch_scc1 L_snd_21
  s_sleep 1
  s_add_u32 s70, s70, 1
  s_cmp_lt_u32 s70, 2097152
  s_cbranch_scc1 L_sn_20
L_snd_21:
  s_mov_b32 s70, 0
L_wt_22:
  ds_read_b32 v8, v38 offset:308
  ds_read_b64 v[80:81], v117 offset:1024
  ds_read_b64 v[82:83], v117 offset:1536
  ds_read_b64 v[84:85], v117 offset:2048
  ds_read_b64 v[86:87], v117 offset:2560
  ds_read_b64 v[88:89], v117 offset:3072
  ds_read_b64 v[90:91], v117 offset:3584
  ds_read_b64 v[92:93], v117 offset:4096
  ds_read_b64 v[94:95], v117 offset:4608
  ds_read_b64 v[96:97], v117 offset:5120
  ds_read_b64 v[98:99], v117 offset:5632
  ds_read_b64 v[100:101], v117 offset:6144
  s_waitcnt lgkmcnt(11)
  v_cmp_gt_u32 vcc, 11, v8
  s_cmp_eq_u64 vcc, 0
  s_cbranch_scc1 L_wtd_23
  s_waitcnt lgkmcnt(0)
  s_add_u32 s70, s70, 1
  s_cmp_lt_u32 s70, 2097152
  s_cbranch_scc1 L_wt_22
L_wtd_23:
  s_movk_i32 s69, 0xff
  s_waitcnt lgkmcnt(10)
  v_pk_mul_f32 v[80:81], v[80:81], v[102:103] op_sel:[0,0] op_sel_hi:[1,0]
  s_waitcnt lgkmcnt(9)
  v_pk_mul_f32 v[82:83], v[82:83], v[102:103] op_sel:[0,1] op_sel_hi:[1,1]
  s_waitcnt lgkmcnt(8)
  v_pk_fma_f32 v[80:81], v[84:85], v[104:105], v[80:81] op_sel:[0,0,0] op_sel_hi:[1,0,1]
  s_waitcnt lgkmcnt(7)
  v_pk_fma_f32 v[82:83], v[86:87], v[104:105], v[82:83] op_sel:[0,1,0] op_sel_hi:[1,1,1]
  s_waitcnt lgkmcnt(6)
  v_pk_fma_f32 v[80:81], v[88:89], v[106:107], v[80:81] op_sel:[0,0,0] op_sel_hi:[1,0,1]
  s_waitcnt lgkmcnt(5)
  v_pk_fma_f32 v[82:83], v[90:91], v[106:107], v[82:83] op_sel:[0,1,0] op_sel_hi:[1,1,1]
  s_waitcnt lgkmcnt(4)
  v_pk_fma_f32 v[80:81], v[92:93], v[108:109], v[80:81] op_sel:[0,0,0] op_sel_hi:[1,0,1]
  s_waitcnt lgkmcnt(3)
  v_pk_fma_f32 v[82:83], v[94:95], v[108:109], v[82:83] op_sel:[0,1,0] op_sel_hi:[1,1,1]
  s_waitcnt lgkmcnt(2)
  v_pk_fma_f32 v[80:81], v[96:97], v[110:111], v[80:81] op_sel:[0,0,0] op_sel_hi:[1,0,1]
  s_waitcnt lgkmcnt(1)
  v_pk_fma_f32 v[82:83], v[98:99], v[110:111], v[82:83] op_sel:[0,1,0] op_sel_hi:[1,1,1]
  s_waitcnt lgkmcnt(0)
  v_pk_fma_f32 v[80:81], v[100:101], v[112:113], v[80:81] op_sel:[0,0,0] op_sel_hi:[1,0,1]
  v_pk_add_f32 v[80:81], v[80:81], v[82:83]
  v_bfi_b32 v80, s69, v115, v80
  v_bfi_b32 v81, s69, v116, v81
  global_store_dwordx2 v114, v[80:81], s[42:43] sc1
  s_branch L_fin
L_chk:
  v_and_b32 v160, 0xff, v75
  v_and_b32 v161, 0xff, v76
  s_lshl_b32 s10, s6, 11
  s_add_u32 s10, s10, 131072
  v_lshl_add_u32 v2, v1, 3, s10
  global_load_dwordx2 v[154:155], v2, s[42:43] offset:0 sc1
  global_load_dwordx2 v[156:157], v2, s[42:43] offset:512 sc1
  v_add_u32 v3, 393216, v2
  s_mov_b32 s70, 0
L_sn_24:
  ds_read_b32 v8, v38 offset:308
  s_waitcnt lgkmcnt(0)
  v_cmp_gt_u32 vcc, 0xa, v8
  s_cmp_eq_u64 vcc, 0
  s_cbranch_scc1 L_snd_25
  s_sleep 1
  s_add_u32 s70, s70, 1
  s_cmp_lt_u32 s70, 2097152
  s_cbranch_scc1 L_sn_24
L_snd_25:
  s_mov_b32 s70, 0
L_wt_26:
  ds_read_b32 v8, v38 offset:308
  ds_read_b64 v[80:81], v117 offset:1024
  ds_read_b64 v[82:83], v117 offset:1536
  ds_read_b64 v[84:85], v117 offset:2048
  ds_read_b64 v[86:87], v117 offset:2560
  ds_read_b64 v[88:89], v117 offset:3072
  ds_read_b64 v[90:91], v117 offset:3584
  ds_read_b64 v[92:93], v117 offset:4096
  ds_read_b64 v[94:95], v117 offset:4608
  ds_read_b64 v[96:97], v117 offset:5120
  ds_read_b64 v[98:99], v117 offset:5632
  ds_read_b64 v[100:101], v117 offset:6144
  s_waitcnt lgkmcnt(11)
  v_cmp_gt_u32 vcc, 11, v8
  s_cmp_eq_u64 vcc, 0
  s_cbranch_scc1 L_wtd_27
  s_waitcnt lgkmcnt(0)
  s_add_u32 s70, s70, 1
  s_cmp_lt_u32 s70, 2097152
  s_cbranch_scc1 L_wt_26
L_wtd_27:
  global_load_dwordx2 v[130:131], v3, s[42:43] offset:0 sc1
  global_load_dwordx2 v[132:133], v3, s[42:43] offset:512 sc1
  s_movk_i32 s69, 0xff
  s_waitcnt lgkmcnt(10)
  v_pk_mul_f32 v[80:81], v[80:81], v[102:103] op_sel:[0,0] op_sel_hi:[1,0]
  s_waitcnt lgkmcnt(9)
  v_pk_mul_f32 v[82:83], v[82:83], v[102:103] op_sel:[0,1] op_sel_hi:[1,1]
  s_waitcnt lgkmcnt(8)
  v_pk_fma_f32 v[80:81], v[84:85], v[104:105], v[80:81] op_sel:[0,0,0] op_sel_hi:[1,0,1]
  s_waitcnt lgkmcnt(7)
  v_pk_fma_f32 v[82:83], v[86:87], v[104:105], v[82:83] op_sel:[0,1,0] op_sel_hi:[1,1,1]
  s_waitcnt lgkmcnt(6)
  v_pk_fma_f32 v[80:81], v[88:89], v[106:107], v[80:81] op_sel:[0,0,0] op_sel_hi:[1,0,1]
  s_waitcnt lgkmcnt(5)
  v_pk_fma_f32 v[82:83], v[90:91], v[106:107], v[82:83] op_sel:[0,1,0] op_sel_hi:[1,1,1]
  s_waitcnt lgkmcnt(4)
  v_pk_fma_f32 v[80:81], v[92:93], v[108:109], v[80:81] op_sel:[0,0,0] op_sel_hi:[1,0,1]
  s_waitcnt lgkmcnt(3)
  v_pk_fma_f32 v[82:83], v[94:95], v[108:109], v[82:83] op_sel:[0,1,0] op_sel_hi:[1,1,1]
  s_waitcnt lgkmcnt(2)
  v_pk_fma_f32 v[80:81], v[96:97], v[110:111], v[80:81] op_sel:[0,0,0] op_sel_hi:[1,0,1]
  s_waitcnt lgkmcnt(1)
  v_pk_fma_f32 v[82:83], v[98:99], v[110:111], v[82:83] op_sel:[0,1,0] op_sel_hi:[1,1,1]
  s_waitcnt lgkmcnt(0)
  v_pk_fma_f32 v[80:81], v[100:101], v[112:113], v[80:81] op_sel:[0,0,0] op_sel_hi:[1,0,1]
  v_pk_add_f32 v[80:81], v[80:81], v[82:83]
  v_bfi_b32 v80, s69, v115, v80
  v_bfi_b32 v81, s69, v116, v81
  global_store_dwordx2 v114, v[80:81], s[42:43] sc1
  s_waitcnt vmcnt(1)
  s_mov_b32 s70, 0
  s_branch L_cp0c
L_cp0:
  global_load_dwordx2 v[154:155], v2, s[42:43] offset:0 sc1
  global_load_dwordx2 v[156:157], v2, s[42:43] offset:512 sc1
  s_sleep 4
  s_waitcnt vmcnt(0)
L_cp0c:
  v_xor_b32 v136, v154, v160
  v_xor_b32 v137, v155, v161
  v_xor_b32 v138, v156, v160
  v_xor_b32 v139, v157, v161
  v_xor_b32 v140, v40, v160
  v_xor_b32 v141, v41, v161
  v_or3_b32 v152, v136, v137, v138
  v_or3_b32 v153, v139, v140, v141
  v_or_b32 v136, 0x80, v136
  v_or_b32 v137, 0x80, v137
  v_or_b32 v138, 0x80, v138
  v_or_b32 v139, 0x80, v139
  v_or_b32 v140, 0x80, v140
  v_or_b32 v141, 0x80, v141
  v_or_b32 v152, v152, v153
  v_pk_add_f32 v[136:137], v[136:137], v[138:139]
  v_lshlrev_b32 v152, 24, v152
  v_pk_add_f32 v[136:137], v[136:137], v[140:141]
  v_cmp_ne_u32 vcc, 0, v152
  v_cvt_pk_bf16_f32 v136, v136, v137
  s_cmp_eq_u64 vcc, 0
  s_cbranch_scc1 L_cp0d
  s_add_u32 s70, s70, 1
  s_cmp_lt_u32 s70, 262144
  s_cbranch_scc1 L_cp0
L_cp0d:
  v_add_u32 v2, 393216, v2
  s_mov_b32 s70, 0
  s_branch L_cp1c
L_cp1:
  global_load_dwordx2 v[130:131], v2, s[42:43] offset:0 sc1
  global_load_dwordx2 v[132:133], v2, s[42:43] offset:512 sc1
  s_waitcnt vmcnt(0)
L_cp1c:
  v_xor_b32 v144, v130, v160
  v_xor_b32 v145, v131, v161
  v_xor_b32 v146, v132, v160
  v_xor_b32 v147, v133, v161
  v_xor_b32 v148, v80, v160
  v_xor_b32 v149, v81, v161
  v_or3_b32 v152, v144, v145, v146
  v_or3_b32 v153, v147, v148, v149
  v_or_b32 v144, 0x80, v144
  v_or_b32 v145, 0x80, v145
  v_or_b32 v146, 0x80, v146
  v_or_b32 v147, 0x80, v147
  v_or_b32 v148, 0x80, v148
  v_or_b32 v149, 0x80, v149
  v_or_b32 v152, v152, v153
  v_pk_add_f32 v[144:145], v[144:145], v[146:147]
  v_lshlrev_b32 v152, 24, v152
  v_pk_add_f32 v[144:145], v[144:145], v[148:149]
  v_cmp_ne_u32 vcc, 0, v152
  v_cvt_pk_bf16_f32 v144, v144, v145
  s_cmp_eq_u64 vcc, 0
  s_cbranch_scc1 L_cp1d
  s_add_u32 s70, s70, 1
  s_cmp_lt_u32 s70, 262144
  s_cbranch_scc1 L_cp1
L_cp1d:
  v_cmp_ne_u32 vcc, v136, v144
  s_cmp_eq_u64 vcc, 0
  s_cbranch_scc1 L_fin
  s_waitcnt vmcnt(0)
L_slow:
  s_mov_b32 s47, 0x20000
  s_load_dwordx16 s[16:31], s[0:1], 0
  s_load_dwordx8 s[32:39], s[0:1], 64
  v_and_b32 v2, 31, v1
  v_lshlrev_b32 v2, 7, v2
  v_add_u32 v2, 28672, v2
  s_mov_b32 s70, 0
L_sl_d:
  global_load_dword v3, v2, s[42:43] sc1
  s_waitcnt vmcnt(0) lgkmcnt(0)
  v_cmp_ne_u32 vcc, s74, v3
  s_cmp_eq_u64 vcc, 0
  s_cbranch_scc1 L_sl_dd
  s_sleep 8
  s_add_u32 s70, s70, 1
  s_cmp_lt_u32 s70, 262144
  s_cbranch_scc1 L_sl_d
L_sl_dd:
  v_lshlrev_b32 v2, 3, v1
  v_add_u32 v2, 524288, v2
  v_lshlrev_b32 v0, 2, v1
  v_add_u32 v0, 12288, v0
  s_mov_b32 s10, 0
L_sl_h:
  s_mov_b32 s70, 0
L_sl_hp:
  global_load_dwordx2 v[40:41], v2, s[42:43] offset:0 sc1
  global_load_dwordx2 v[42:43], v2, s[42:43] offset:512 sc1
  global_load_dwordx2 v[44:45], v2, s[42:43] offset:1024 sc1
  s_waitcnt vmcnt(0)
  v_xor_b32 v40, v40, v160
  v_xor_b32 v41, v41, v161
  v_xor_b32 v42, v42, v160
  v_xor_b32 v43, v43, v161
  v_xor_b32 v44, v44, v160
  v_xor_b32 v45, v45, v161
  v_or3_b32 v48, v40, v41, v42
  v_or3_b32 v49, v43, v44, v45
  v_or_b32 v40, 0x80, v40
  v_or_b32 v41, 0x80, v41
  v_or_b32 v42, 0x80, v42
  v_or_b32 v43, 0x80, v43
  v_or_b32 v44, 0x80, v44
  v_or_b32 v45, 0x80, v45
  v_or_b32 v48, v48, v49
  v_pk_add_f32 v[40:41], v[40:41], v[42:43]
  v_lshlrev_b32 v48, 24, v48
  v_pk_add_f32 v[40:41], v[40:41], v[44:45]
  v_cmp_ne_u32 vcc, 0, v48
  v_cvt_pk_bf16_f32 v40, v40, v41
  s_cmp_eq_u64 vcc, 0
  s_cbranch_scc1 L_sl_hd
  s_sleep 8
  s_add_u32 s70, s70, 1
  s_cmp_lt_u32 s70, 262144
  s_cbranch_scc1 L_sl_hp
L_sl_hd:
  ds_write_b32 v0, v40
  v_add_u32 v2, 2048, v2
  v_add_u32 v0, 256, v0
  s_add_u32 s10, s10, 1
  s_cmp_lt_u32 s10, 64
  s_cbranch_scc1 L_sl_h
  s_mov_b32 s44, s24
  s_mov_b32 s45, s25
  s_mov_b32 s46, 4194304
  s_mov_b32 s11, 1024
  s_mov_b32 s12, 4194304
  v_mov_b32 v4, 12288
  v_mov_b32 v5, 20480
  v_lshlrev_b32 v2, 4, v1
  s_call_b64 s[62:63], L_gv
  v_lshlrev_b32 v0, 4, v1
  global_load_dwordx4 v[40:43], v0, s[16:17] offset:0
  global_load_dwordx4 v[44:47], v0, s[16:17] offset:1024
  s_waitcnt vmcnt(0)
  v_lshlrev_b32 v104, 16, v40
  v_and_b32 v105, s73, v40
  v_lshlrev_b32 v106, 16, v41
  v_and_b32 v107, s73, v41
  v_lshlrev_b32 v108, 16, v42
  v_and_b32 v109, s73, v42
  v_lshlrev_b32 v110, 16, v43
  v_and_b32 v111, s73, v43
  v_lshlrev_b32 v112, 16, v44
  v_and_b32 v113, s73, v44
  v_lshlrev_b32 v114, 16, v45
  v_and_b32 v115, s73, v45
  v_lshlrev_b32 v116, 16, v46
  v_and_b32 v117, s73, v46
  v_lshlrev_b32 v118, 16, v47
  v_and_b32 v119, s73, v47
  v_lshrrev_b32 v2, 1, v1
  v_lshlrev_b32 v2, 7, v2
  v_and_b32 v3, 1, v1
  v_lshl_add_u32 v2, v3, 5, v2
  v_add_u32 v2, 12288, v2
  global_load_dwordx4 v[40:43], v2, s[42:43] offset:0 sc1
  global_load_dwordx4 v[44:47], v2, s[42:43] offset:16 sc1
  global_load_dwordx4 v[48:51], v2, s[42:43] offset:64 sc1
  global_load_dwordx4 v[52:55], v2, s[42:43] offset:80 sc1
  s_waitcnt vmcnt(0)
  v_lshlrev_b32 v88, 16, v40
  v_and_b32 v89, s73, v40
  v_lshlrev_b32 v90, 16, v42
  v_and_b32 v91, s73, v42
  v_lshlrev_b32 v92, 16, v44
  v_and_b32 v93, s73, v44
  v_lshlrev_b32 v94, 16, v46
  v_and_b32 v95, s73, v46
  v_lshlrev_b32 v96, 16, v48
  v_and_b32 v97, s73, v48
  v_lshlrev_b32 v98, 16, v50
  v_and_b32 v99, s73, v50
  v_lshlrev_b32 v100, 16, v52
  v_and_b32 v101, s73, v52
  v_lshlrev_b32 v102, 16, v54
  v_and_b32 v103, s73, v54
  v_cvt_pk_bf16_f32 v72, 0, v72
  v_cvt_pk_bf16_f32 v73, 0, v73
  v_cvt_pk_bf16_f32 v74, 0, v74
  v_cvt_pk_bf16_f32 v75, 0, v75
  v_cvt_pk_bf16_f32 v76, 0, v76
  v_cvt_pk_bf16_f32 v77, 0, v77
  v_cvt_pk_bf16_f32 v78, 0, v78
  v_cvt_pk_bf16_f32 v79, 0, v79
  v_cvt_pk_bf16_f32 v80, 0, v80
  v_cvt_pk_bf16_f32 v81, 0, v81
  v_cvt_pk_bf16_f32 v82, 0, v82
  v_cvt_pk_bf16_f32 v83, 0, v83
  v_cvt_pk_bf16_f32 v84, 0, v84
  v_cvt_pk_bf16_f32 v85, 0, v85
  v_cvt_pk_bf16_f32 v86, 0, v86
  v_cvt_pk_bf16_f32 v87, 0, v87
  v_mul_f32 v72, v72, v88
  v_mul_f32 v73, v73, v89
  v_mul_f32 v74, v74, v90
  v_mul_f32 v75, v75, v91
  v_mul_f32 v76, v76, v92
  v_mul_f32 v77, v77, v93
  v_mul_f32 v78, v78, v94
  v_mul_f32 v79, v79, v95
  v_mul_f32 v80, v80, v96
  v_mul_f32 v81, v81, v97
  v_mul_f32 v82, v82, v98
  v_mul_f32 v83, v83, v99
  v_mul_f32 v84, v84, v100
  v_mul_f32 v85, v85, v101
  v_mul_f32 v86, v86, v102
  v_mul_f32 v87, v87, v103
  v_cvt_pk_bf16_f32 v72, 0, v72
  v_cvt_pk_bf16_f32 v73, 0, v73
  v_cvt_pk_bf16_f32 v74, 0, v74
  v_cvt_pk_bf16_f32 v75, 0, v75
  v_cvt_pk_bf16_f32 v76, 0, v76
  v_cvt_pk_bf16_f32 v77, 0, v77
  v_cvt_pk_bf16_f32 v78, 0, v78
  v_cvt_pk_bf16_f32 v79, 0, v79
  v_cvt_pk_bf16_f32 v80, 0, v80
  v_cvt_pk_bf16_f32 v81, 0, v81
  v_cvt_pk_bf16_f32 v82, 0, v82
  v_cvt_pk_bf16_f32 v83, 0, v83
  v_cvt_pk_bf16_f32 v84, 0, v84
  v_cvt_pk_bf16_f32 v85, 0, v85
  v_cvt_pk_bf16_f32 v86, 0, v86
  v_cvt_pk_bf16_f32 v87, 0, v87
  v_add_f32 v104, v104, v72
  v_add_f32 v105, v105, v73
  v_add_f32 v106, v106, v74
  v_add_f32 v107, v107, v75
  v_add_f32 v108, v108, v76
  v_add_f32 v109, v109, v77
  v_add_f32 v110, v110, v78
  v_add_f32 v111, v111, v79
  v_add_f32 v112, v112, v80
  v_add_f32 v113, v113, v81
  v_add_f32 v114, v114, v82
  v_add_f32 v115, v115, v83
  v_add_f32 v116, v116, v84
  v_add_f32 v117, v117, v85
  v_add_f32 v118, v118, v86
  v_add_f32 v119, v119, v87
  v_cvt_pk_bf16_f32 v104, 0, v104
  v_cvt_pk_bf16_f32 v105, 0, v105
  v_cvt_pk_bf16_f32 v106, 0, v106
  v_cvt_pk_bf16_f32 v107, 0, v107
  v_cvt_pk_bf16_f32 v108, 0, v108
  v_cvt_pk_bf16_f32 v109, 0, v109
  v_cvt_pk_bf16_f32 v110, 0, v110
  v_cvt_pk_bf16_f32 v111, 0, v111
  v_cvt_pk_bf16_f32 v112, 0, v112
  v_cvt_pk_bf16_f32 v113, 0, v113
  v_cvt_pk_bf16_f32 v114, 0, v114
  v_cvt_pk_bf16_f32 v115, 0, v115
  v_cvt_pk_bf16_f32 v116, 0, v116
  v_cvt_pk_bf16_f32 v117, 0, v117
  v_cvt_pk_bf16_f32 v118, 0, v118
  v_cvt_pk_bf16_f32 v119, 0, v119
  v_add_f32 v8, v104, v105
  v_add_f32 v8, v8, v106
  v_add_f32 v8, v8, v107
  v_add_f32 v8, v8, v108
  v_add_f32 v8, v8, v109
  v_add_f32 v8, v8, v110
  v_add_f32 v8, v8, v111
  s_nop 1
  v_add_f32_dpp v8, v8, v8 row_ror:8 row_mask:0xf bank_mask:0xf
  s_nop 1
  v_add_f32_dpp v8, v8, v8 row_ror:4 row_mask:0xf bank_mask:0xf
  s_nop 1
  v_add_f32_dpp v8, v8, v8 row_ror:2 row_mask:0xf bank_mask:0xf
  s_nop 1
  v_add_f32_dpp v8, v8, v8 row_ror:1 row_mask:0xf bank_mask:0xf
  v_mov_b32 v9, v8
  s_nop 1
  v_permlane16_swap_b32 v9, v8
  v_add_f32 v8, v8, v9
  v_mov_b32 v9, v8
  s_nop 1
  v_permlane32_swap_b32 v9, v8
  v_add_f32 v8, v8, v9
  v_mul_f32 v8, 0x3b000000, v8
  v_sub_f32 v72, v104, v8
  v_sub_f32 v73, v105, v8
  v_sub_f32 v74, v106, v8
  v_sub_f32 v75, v107, v8
  v_sub_f32 v76, v108, v8
  v_sub_f32 v77, v109, v8
  v_sub_f32 v78, v110, v8
  v_sub_f32 v79, v111, v8
  v_mul_f32 v10, v72, v72
  v_fmac_f32 v10, v73, v73
  v_fmac_f32 v10, v74, v74
  v_fmac_f32 v10, v75, v75
  v_fmac_f32 v10, v76, v76
  v_fmac_f32 v10, v77, v77
  v_fmac_f32 v10, v78, v78
  v_fmac_f32 v10, v79, v79
  s_nop 1
  v_add_f32_dpp v10, v10, v10 row_ror:8 row_mask:0xf bank_mask:0xf
  s_nop 1
  v_add_f32_dpp v10, v10, v10 row_ror:4 row_mask:0xf bank_mask:0xf
  s_nop 1
  v_add_f32_dpp v10, v10, v10 row_ror:2 row_mask:0xf bank_mask:0xf
  s_nop 1
  v_add_f32_dpp v10, v10, v10 row_ror:1 row_mask:0xf bank_mask:0xf
  v_mov_b32 v9, v10
  s_nop 1
  v_permlane16_swap_b32 v9, v10
  v_add_f32 v10, v10, v9
  v_mov_b32 v9, v10
  s_nop 1
  v_permlane32_swap_b32 v9, v10
  v_add_f32 v10, v10, v9
  v_mul_f32 v10, 0x3b000000, v10
  v_cvt_pk_bf16_f32 v8, 0, v8
  v_cvt_pk_bf16_f32 v10, 0, v10
  v_add_f32 v10, 0x3727c5ac, v10
  v_cvt_pk_bf16_f32 v10, 0, v10
  v_sqrt_f32 v10, v10
  v_sub_f32 v72, v104, v8
  v_sub_f32 v73, v105, v8
  v_sub_f32 v74, v106, v8
  v_sub_f32 v75, v107, v8
  v_sub_f32 v76, v108, v8
  v_sub_f32 v77, v109, v8
  v_sub_f32 v78, v110, v8
  v_sub_f32 v79, v111, v8
  v_cvt_pk_bf16_f32 v10, 0, v10
  v_cvt_pk_bf16_f32 v72, 0, v72
  v_cvt_pk_bf16_f32 v73, 0, v73
  v_cvt_pk_bf16_f32 v74, 0, v74
  v_cvt_pk_bf16_f32 v75, 0, v75
  v_cvt_pk_bf16_f32 v76, 0, v76
  v_cvt_pk_bf16_f32 v77, 0, v77
  v_cvt_pk_bf16_f32 v78, 0, v78
  v_cvt_pk_bf16_f32 v79, 0, v79
  v_rcp_f32 v10, v10
  s_nop 0
  v_mul_f32 v72, v72, v10
  v_mul_f32 v73, v73, v10
  v_mul_f32 v74, v74, v10
  v_mul_f32 v75, v75, v10
  v_mul_f32 v76, v76, v10
  v_mul_f32 v77, v77, v10
  v_mul_f32 v78, v78, v10
  v_mul_f32 v79, v79, v10
  v_cvt_pk_bf16_f32 v72, 0, v72
  v_cvt_pk_bf16_f32 v73, 0, v73
  v_cvt_pk_bf16_f32 v74, 0, v74
  v_cvt_pk_bf16_f32 v75, 0, v75
  v_cvt_pk_bf16_f32 v76, 0, v76
  v_cvt_pk_bf16_f32 v77, 0, v77
  v_cvt_pk_bf16_f32 v78, 0, v78
  v_cvt_pk_bf16_f32 v79, 0, v79
  v_add_f32 v8, v112, v113
  v_add_f32 v8, v8, v114
  v_add_f32 v8, v8, v115
  v_add_f32 v8, v8, v116
  v_add_f32 v8, v8, v117
  v_add_f32 v8, v8, v118
  v_add_f32 v8, v8, v119
  s_nop 1
  v_add_f32_dpp v8, v8, v8 row_ror:8 row_mask:0xf bank_mask:0xf
  s_nop 1
  v_add_f32_dpp v8, v8, v8 row_ror:4 row_mask:0xf bank_mask:0xf
  s_nop 1
  v_add_f32_dpp v8, v8, v8 row_ror:2 row_mask:0xf bank_mask:0xf
  s_nop 1
  v_add_f32_dpp v8, v8, v8 row_ror:1 row_mask:0xf bank_mask:0xf
  v_mov_b32 v9, v8
  s_nop 1
  v_permlane16_swap_b32 v9, v8
  v_add_f32 v8, v8, v9
  v_mov_b32 v9, v8
  s_nop 1
  v_permlane32_swap_b32 v9, v8
  v_add_f32 v8, v8, v9
  v_mul_f32 v8, 0x3b000000, v8
  v_sub_f32 v80, v112, v8
  v_sub_f32 v81, v113, v8
  v_sub_f32 v82, v114, v8
  v_sub_f32 v83, v115, v8
  v_sub_f32 v84, v116, v8
  v_sub_f32 v85, v117, v8
  v_sub_f32 v86, v118, v8
  v_sub_f32 v87, v119, v8
  v_mul_f32 v10, v80, v80
  v_fmac_f32 v10, v81, v81
  v_fmac_f32 v10, v82, v82
  v_fmac_f32 v10, v83, v83
  v_fmac_f32 v10, v84, v84
  v_fmac_f32 v10, v85, v85
  v_fmac_f32 v10, v86, v86
  v_fmac_f32 v10, v87, v87
  s_nop 1
  v_add_f32_dpp v10, v10, v10 row_ror:8 row_mask:0xf bank_mask:0xf
  s_nop 1
  v_add_f32_dpp v10, v10, v10 row_ror:4 row_mask:0xf bank_mask:0xf
  s_nop 1
  v_add_f32_dpp v10, v10, v10 row_ror:2 row_mask:0xf bank_mask:0xf
  s_nop 1
  v_add_f32_dpp v10, v10, v10 row_ror:1 row_mask:0xf bank_mask:0xf
  v_mov_b32 v9, v10
  s_nop 1
  v_permlane16_swap_b32 v9, v10
  v_add_f32 v10, v10, v9
  v_mov_b32 v9, v10
  s_nop 1
  v_permlane32_swap_b32 v9, v10
  v_add_f32 v10, v10, v9
  v_mul_f32 v10, 0x3b000000, v10
  v_cvt_pk_bf16_f32 v8, 0, v8
  v_cvt_pk_bf16_f32 v10, 0, v10
  v_add_f32 v10, 0x3727c5ac, v10
  v_cvt_pk_bf16_f32 v10, 0, v10
  v_sqrt_f32 v10, v10
  v_sub_f32 v80, v112, v8
  v_sub_f32 v81, v113, v8
  v_sub_f32 v82, v114, v8
  v_sub_f32 v83, v115, v8
  v_sub_f32 v84, v116, v8
  v_sub_f32 v85, v117, v8
  v_sub_f32 v86, v118, v8
  v_sub_f32 v87, v119, v8
  v_cvt_pk_bf16_f32 v10, 0, v10
  v_cvt_pk_bf16_f32 v80, 0, v80
  v_cvt_pk_bf16_f32 v81, 0, v81
  v_cvt_pk_bf16_f32 v82, 0, v82
  v_cvt_pk_bf16_f32 v83, 0, v83
  v_cvt_pk_bf16_f32 v84, 0, v84
  v_cvt_pk_bf16_f32 v85, 0, v85
  v_cvt_pk_bf16_f32 v86, 0, v86
  v_cvt_pk_bf16_f32 v87, 0, v87
  v_rcp_f32 v10, v10
  s_nop 0
  v_mul_f32 v80, v80, v10
  v_mul_f32 v81, v81, v10
  v_mul_f32 v82, v82, v10
  v_mul_f32 v83, v83, v10
  v_mul_f32 v84, v84, v10
  v_mul_f32 v85, v85, v10
  v_mul_f32 v86, v86, v10
  v_mul_f32 v87, v87, v10
  v_cvt_pk_bf16_f32 v80, 0, v80
  v_cvt_pk_bf16_f32 v81, 0, v81
  v_cvt_pk_bf16_f32 v82, 0, v82
  v_cvt_pk_bf16_f32 v83, 0, v83
  v_cvt_pk_bf16_f32 v84, 0, v84
  v_cvt_pk_bf16_f32 v85, 0, v85
  v_cvt_pk_bf16_f32 v86, 0, v86
  v_cvt_pk_bf16_f32 v87, 0, v87
  v_lshrrev_b32 v2, 1, v1
  v_lshlrev_b32 v2, 7, v2
  v_and_b32 v3, 1, v1
  v_lshl_add_u32 v2, v3, 5, v2
  v_add_u32 v2, 20480, v2
  global_load_dwordx4 v[40:43], v2, s[42:43] offset:0 sc1
  global_load_dwordx4 v[44:47], v2, s[42:43] offset:16 sc1
  global_load_dwordx4 v[48:51], v2, s[42:43] offset:64 sc1
  global_load_dwordx4 v[52:55], v2, s[42:43] offset:80 sc1
  s_waitcnt vmcnt(0)
  v_lshlrev_b32 v88, 16, v40
  v_and_b32 v89, s73, v40
  v_lshlrev_b32 v90, 16, v42
  v_and_b32 v91, s73, v42
  v_lshlrev_b32 v92, 16, v44
  v_and_b32 v93, s73, v44
  v_lshlrev_b32 v94, 16, v46
  v_and_b32 v95, s73, v46
  v_lshlrev_b32 v96, 16, v48
  v_and_b32 v97, s73, v48
  v_lshlrev_b32 v98, 16, v50
  v_and_b32 v99, s73, v50
  v_lshlrev_b32 v100, 16, v52
  v_and_b32 v101, s73, v52
  v_lshlrev_b32 v102, 16, v54
  v_and_b32 v103, s73, v54
  v_add_f32 v88, 1.0, v88
  v_add_f32 v89, 1.0, v89
  v_add_f32 v90, 1.0, v90
  v_add_f32 v91, 1.0, v91
  v_add_f32 v92, 1.0, v92
  v_add_f32 v93, 1.0, v93
  v_add_f32 v94, 1.0, v94
  v_add_f32 v95, 1.0, v95
  v_add_f32 v96, 1.0, v96
  v_add_f32 v97, 1.0, v97
  v_add_f32 v98, 1.0, v98
  v_add_f32 v99, 1.0, v99
  v_add_f32 v100, 1.0, v100
  v_add_f32 v101, 1.0, v101
  v_add_f32 v102, 1.0, v102
  v_add_f32 v103, 1.0, v103
  v_cvt_pk_bf16_f32 v88, 0, v88
  v_cvt_pk_bf16_f32 v89, 0, v89
  v_cvt_pk_bf16_f32 v90, 0, v90
  v_cvt_pk_bf16_f32 v91, 0, v91
  v_cvt_pk_bf16_f32 v92, 0, v92
  v_cvt_pk_bf16_f32 v93, 0, v93
  v_cvt_pk_bf16_f32 v94, 0, v94
  v_cvt_pk_bf16_f32 v95, 0, v95
  v_cvt_pk_bf16_f32 v96, 0, v96
  v_cvt_pk_bf16_f32 v97, 0, v97
  v_cvt_pk_bf16_f32 v98, 0, v98
  v_cvt_pk_bf16_f32 v99, 0, v99
  v_cvt_pk_bf16_f32 v100, 0, v100
  v_cvt_pk_bf16_f32 v101, 0, v101
  v_cvt_pk_bf16_f32 v102, 0, v102
  v_cvt_pk_bf16_f32 v103, 0, v103
  v_mul_f32 v72, v72, v88
  v_mul_f32 v73, v73, v89
  v_mul_f32 v74, v74, v90
  v_mul_f32 v75, v75, v91
  v_mul_f32 v76, v76, v92
  v_mul_f32 v77, v77, v93
  v_mul_f32 v78, v78, v94
  v_mul_f32 v79, v79, v95
  v_mul_f32 v80, v80, v96
  v_mul_f32 v81, v81, v97
  v_mul_f32 v82, v82, v98
  v_mul_f32 v83, v83, v99
  v_mul_f32 v84, v84, v100
  v_mul_f32 v85, v85, v101
  v_mul_f32 v86, v86, v102
  v_mul_f32 v87, v87, v103
  v_cvt_pk_bf16_f32 v72, 0, v72
  v_cvt_pk_bf16_f32 v73, 0, v73
  v_cvt_pk_bf16_f32 v74, 0, v74
  v_cvt_pk_bf16_f32 v75, 0, v75
  v_cvt_pk_bf16_f32 v76, 0, v76
  v_cvt_pk_bf16_f32 v77, 0, v77
  v_cvt_pk_bf16_f32 v78, 0, v78
  v_cvt_pk_bf16_f32 v79, 0, v79
  v_cvt_pk_bf16_f32 v80, 0, v80
  v_cvt_pk_bf16_f32 v81, 0, v81
  v_cvt_pk_bf16_f32 v82, 0, v82
  v_cvt_pk_bf16_f32 v83, 0, v83
  v_cvt_pk_bf16_f32 v84, 0, v84
  v_cvt_pk_bf16_f32 v85, 0, v85
  v_cvt_pk_bf16_f32 v86, 0, v86
  v_cvt_pk_bf16_f32 v87, 0, v87
  v_lshrrev_b32 v2, 1, v1
  v_lshlrev_b32 v2, 7, v2
  v_and_b32 v3, 1, v1
  v_lshl_add_u32 v2, v3, 5, v2
  v_add_u32 v2, 16384, v2
  global_load_dwordx4 v[40:43], v2, s[42:43] offset:0 sc1
  global_load_dwordx4 v[44:47], v2, s[42:43] offset:16 sc1
  global_load_dwordx4 v[48:51], v2, s[42:43] offset:64 sc1
  global_load_dwordx4 v[52:55], v2, s[42:43] offset:80 sc1
  s_waitcnt vmcnt(0)
  v_lshlrev_b32 v88, 16, v40
  v_and_b32 v89, s73, v40
  v_lshlrev_b32 v90, 16, v42
  v_and_b32 v91, s73, v42
  v_lshlrev_b32 v92, 16, v44
  v_and_b32 v93, s73, v44
  v_lshlrev_b32 v94, 16, v46
  v_and_b32 v95, s73, v46
  v_lshlrev_b32 v96, 16, v48
  v_and_b32 v97, s73, v48
  v_lshlrev_b32 v98, 16, v50
  v_and_b32 v99, s73, v50
  v_lshlrev_b32 v100, 16, v52
  v_and_b32 v101, s73, v52
  v_lshlrev_b32 v102, 16, v54
  v_and_b32 v103, s73, v54
  v_add_f32 v72, v72, v88
  v_add_f32 v73, v73, v89
  v_add_f32 v74, v74, v90
  v_add_f32 v75, v75, v91
  v_add_f32 v76, v76, v92
  v_add_f32 v77, v77, v93
  v_add_f32 v78, v78, v94
  v_add_f32 v79, v79, v95
  v_add_f32 v80, v80, v96
  v_add_f32 v81, v81, v97
  v_add_f32 v82, v82, v98
  v_add_f32 v83, v83, v99
  v_add_f32 v84, v84, v100
  v_add_f32 v85, v85, v101
  v_add_f32 v86, v86, v102
  v_add_f32 v87, v87, v103
  v_cvt_pk_bf16_f32 v40, v72, v73
  v_cvt_pk_bf16_f32 v41, v74, v75
  v_cvt_pk_bf16_f32 v42, v76, v77
  v_cvt_pk_bf16_f32 v43, v78, v79
  v_cvt_pk_bf16_f32 v44, v80, v81
  v_cvt_pk_bf16_f32 v45, v82, v83
  v_cvt_pk_bf16_f32 v46, v84, v85
  v_cvt_pk_bf16_f32 v47, v86, v87
  v_add_u32 v3, 12288, v0
  ds_write_b128 v3, v[40:43] offset:0
  ds_write_b128 v3, v[44:47] offset:1024
  s_mov_b32 s44, s28
  s_mov_b32 s45, s29
  s_mov_b32 s46, 1409024
  s_mov_b32 s11, 2752
  s_mov_b32 s12, 1409024
  v_mov_b32 v4, 12288
  v_mov_b32 v5, 13312
  v_lshlrev_b32 v2, 4, v1
  s_call_b64 s[62:63], L_gv
  v_cvt_pk_bf16_f32 v120, 0, v72
  v_cvt_pk_bf16_f32 v121, 0, v73
  v_cvt_pk_bf16_f32 v122, 0, v74
  v_cvt_pk_bf16_f32 v123, 0, v75
  v_cvt_pk_bf16_f32 v124, 0, v76
  v_cvt_pk_bf16_f32 v125, 0, v77
  v_cvt_pk_bf16_f32 v126, 0, v78
  v_cvt_pk_bf16_f32 v127, 0, v79
  v_cvt_pk_bf16_f32 v128, 0, v80
  v_cvt_pk_bf16_f32 v129, 0, v81
  v_cvt_pk_bf16_f32 v130, 0, v82
  v_cvt_pk_bf16_f32 v131, 0, v83
  v_cvt_pk_bf16_f32 v132, 0, v84
  v_cvt_pk_bf16_f32 v133, 0, v85
  v_cvt_pk_bf16_f32 v134, 0, v86
  v_cvt_pk_bf16_f32 v135, 0, v87
  s_mov_b32 s44, s30
  s_mov_b32 s45, s31
  s_mov_b32 s46, 1409024
  s_mov_b32 s11, 2752
  s_mov_b32 s12, 1409024
  v_mov_b32 v4, 12288
  v_mov_b32 v5, 13312
  v_lshlrev_b32 v2, 4, v1
  s_call_b64 s[62:63], L_gv
  v_mul_f32 v88, 0xbfb8aa3b, v120
  v_mul_f32 v89, 0xbfb8aa3b, v121
  v_mul_f32 v90, 0xbfb8aa3b, v122
  v_mul_f32 v91, 0xbfb8aa3b, v123
  v_exp_f32 v88, v88
  v_exp_f32 v89, v89
  v_exp_f32 v90, v90
  v_exp_f32 v91, v91
  s_nop 0
  v_add_f32 v88, 1.0, v88
  v_add_f32 v89, 1.0, v89
  v_add_f32 v90, 1.0, v90
  v_add_f32 v91, 1.0, v91
  v_rcp_f32 v88, v88
  v_rcp_f32 v89, v89
  v_rcp_f32 v90, v90
  v_rcp_f32 v91, v91
  s_nop 0
  v_mul_f32 v120, v120, v88
  v_mul_f32 v121, v121, v89
  v_mul_f32 v122, v122, v90
  v_mul_f32 v123, v123, v91
  v_mul_f32 v88, 0xbfb8aa3b, v124
  v_mul_f32 v89, 0xbfb8aa3b, v125
  v_mul_f32 v90, 0xbfb8aa3b, v126
  v_mul_f32 v91, 0xbfb8aa3b, v127
  v_exp_f32 v88, v88
  v_exp_f32 v89, v89
  v_exp_f32 v90, v90
  v_exp_f32 v91, v91
  s_nop 0
  v_add_f32 v88, 1.0, v88
  v_add_f32 v89, 1.0, v89
  v_add_f32 v90, 1.0, v90
  v_add_f32 v91, 1.0, v91
  v_rcp_f32 v88, v88
  v_rcp_f32 v89, v89
  v_rcp_f32 v90, v90
  v_rcp_f32 v91, v91
  s_nop 0
  v_mul_f32 v124, v124, v88
  v_mul_f32 v125, v125, v89
  v_mul_f32 v126, v126, v90
  v_mul_f32 v127, v127, v91
  v_mul_f32 v88, 0xbfb8aa3b, v128
  v_mul_f32 v89, 0xbfb8aa3b, v129
  v_mul_f32 v90, 0xbfb8aa3b, v130
  v_mul_f32 v91, 0xbfb8aa3b, v131
  v_exp_f32 v88, v88
  v_exp_f32 v89, v89
  v_exp_f32 v90, v90
  v_exp_f32 v91, v91
  s_nop 0
  v_add_f32 v88, 1.0, v88
  v_add_f32 v89, 1.0, v89
  v_add_f32 v90, 1.0, v90
  v_add_f32 v91, 1.0, v91
  v_rcp_f32 v88, v88
  v_rcp_f32 v89, v89
  v_rcp_f32 v90, v90
  v_rcp_f32 v91, v91
  s_nop 0
  v_mul_f32 v128, v128, v88
  v_mul_f32 v129, v129, v89
  v_mul_f32 v130, v130, v90
  v_mul_f32 v131, v131, v91
  v_mul_f32 v88, 0xbfb8aa3b, v132
  v_mul_f32 v89, 0xbfb8aa3b, v133
  v_mul_f32 v90, 0xbfb8aa3b, v134
  v_mul_f32 v91, 0xbfb8aa3b, v135
  v_exp_f32 v88, v88
  v_exp_f32 v89, v89
  v_exp_f32 v90, v90
  v_exp_f32 v91, v91
  s_nop 0
  v_add_f32 v88, 1.0, v88
  v_add_f32 v89, 1.0, v89
  v_add_f32 v90, 1.0, v90
  v_add_f32 v91, 1.0, v91
  v_rcp_f32 v88, v88
  v_rcp_f32 v89, v89
  v_rcp_f32 v90, v90
  v_rcp_f32 v91, v91
  s_nop 0
  v_mul_f32 v132, v132, v88
  v_mul_f32 v133, v133, v89
  v_mul_f32 v134, v134, v90
  v_mul_f32 v135, v135, v91
  v_cvt_pk_bf16_f32 v120, 0, v120
  v_cvt_pk_bf16_f32 v121, 0, v121
  v_cvt_pk_bf16_f32 v122, 0, v122
  v_cvt_pk_bf16_f32 v123, 0, v123
  v_cvt_pk_bf16_f32 v124, 0, v124
  v_cvt_pk_bf16_f32 v125, 0, v125
  v_cvt_pk_bf16_f32 v126, 0, v126
  v_cvt_pk_bf16_f32 v127, 0, v127
  v_cvt_pk_bf16_f32 v128, 0, v128
  v_cvt_pk_bf16_f32 v129, 0, v129
  v_cvt_pk_bf16_f32 v130, 0, v130
  v_cvt_pk_bf16_f32 v131, 0, v131
  v_cvt_pk_bf16_f32 v132, 0, v132
  v_cvt_pk_bf16_f32 v133, 0, v133
  v_cvt_pk_bf16_f32 v134, 0, v134
  v_cvt_pk_bf16_f32 v135, 0, v135
  v_cvt_pk_bf16_f32 v72, 0, v72
  v_cvt_pk_bf16_f32 v73, 0, v73
  v_cvt_pk_bf16_f32 v74, 0, v74
  v_cvt_pk_bf16_f32 v75, 0, v75
  v_cvt_pk_bf16_f32 v76, 0, v76
  v_cvt_pk_bf16_f32 v77, 0, v77
  v_cvt_pk_bf16_f32 v78, 0, v78
  v_cvt_pk_bf16_f32 v79, 0, v79
  v_cvt_pk_bf16_f32 v80, 0, v80
  v_cvt_pk_bf16_f32 v81, 0, v81
  v_cvt_pk_bf16_f32 v82, 0, v82
  v_cvt_pk_bf16_f32 v83, 0, v83
  v_cvt_pk_bf16_f32 v84, 0, v84
  v_cvt_pk_bf16_f32 v85, 0, v85
  v_cvt_pk_bf16_f32 v86, 0, v86
  v_cvt_pk_bf16_f32 v87, 0, v87
  v_mul_f32 v72, v72, v120
  v_mul_f32 v73, v73, v121
  v_mul_f32 v74, v74, v122
  v_mul_f32 v75, v75, v123
  v_mul_f32 v76, v76, v124
  v_mul_f32 v77, v77, v125
  v_mul_f32 v78, v78, v126
  v_mul_f32 v79, v79, v127
  v_mul_f32 v80, v80, v128
  v_mul_f32 v81, v81, v129
  v_mul_f32 v82, v82, v130
  v_mul_f32 v83, v83, v131
  v_mul_f32 v84, v84, v132
  v_mul_f32 v85, v85, v133
  v_mul_f32 v86, v86, v134
  v_mul_f32 v87, v87, v135
  v_cvt_pk_bf16_f32 v40, v72, v73
  v_cvt_pk_bf16_f32 v41, v74, v75
  v_cvt_pk_bf16_f32 v42, v76, v77
  v_cvt_pk_bf16_f32 v43, v78, v79
  v_cvt_pk_bf16_f32 v44, v80, v81
  v_cvt_pk_bf16_f32 v45, v82, v83
  v_cvt_pk_bf16_f32 v46, v84, v85
  v_cvt_pk_bf16_f32 v47, v86, v87
  v_add_u32 v3, 14336, v0
  ds_write_b128 v3, v[40:43] offset:0
  ds_write_b128 v3, v[44:47] offset:3072
  s_mov_b32 s44, s28
  s_mov_b32 s45, s29
  s_mov_b32 s46, 1409024
  s_mov_b32 s11, 2752
  s_mov_b32 s12, 1409024
  v_mov_b32 v4, 12288
  v_mov_b32 v5, 13312
  v_lshlrev_b32 v2, 4, v1
  v_add_u32 v2, 1024, v2
  s_call_b64 s[62:63], L_gv
  v_cvt_pk_bf16_f32 v120, 0, v72
  v_cvt_pk_bf16_f32 v121, 0, v73
  v_cvt_pk_bf16_f32 v122, 0, v74
  v_cvt_pk_bf16_f32 v123, 0, v75
  v_cvt_pk_bf16_f32 v124, 0, v76
  v_cvt_pk_bf16_f32 v125, 0, v77
  v_cvt_pk_bf16_f32 v126, 0, v78
  v_cvt_pk_bf16_f32 v127, 0, v79
  v_cvt_pk_bf16_f32 v128, 0, v80
  v_cvt_pk_bf16_f32 v129, 0, v81
  v_cvt_pk_bf16_f32 v130, 0, v82
  v_cvt_pk_bf16_f32 v131, 0, v83
  v_cvt_pk_bf16_f32 v132, 0, v84
  v_cvt_pk_bf16_f32 v133, 0, v85
  v_cvt_pk_bf16_f32 v134, 0, v86
  v_cvt_pk_bf16_f32 v135, 0, v87
  s_mov_b32 s44, s30
  s_mov_b32 s45, s31
  s_mov_b32 s46, 1409024
  s_mov_b32 s11, 2752
  s_mov_b32 s12, 1409024
  v_mov_b32 v4, 12288
  v_mov_b32 v5, 13312
  v_lshlrev_b32 v2, 4, v1
  v_add_u32 v2, 1024, v2
  s_call_b64 s[62:63], L_gv
  v_mul_f32 v88, 0xbfb8aa3b, v120
  v_mul_f32 v89, 0xbfb8aa3b, v121
  v_mul_f32 v90, 0xbfb8aa3b, v122
  v_mul_f32 v91, 0xbfb8aa3b, v123
  v_exp_f32 v88, v88
  v_exp_f32 v89, v89
  v_exp_f32 v90, v90
  v_exp_f32 v91, v91
  s_nop 0
  v_add_f32 v88, 1.0, v88
  v_add_f32 v89, 1.0, v89
  v_add_f32 v90, 1.0, v90
  v_add_f32 v91, 1.0, v91
  v_rcp_f32 v88, v88
  v_rcp_f32 v89, v89
  v_rcp_f32 v90, v90
  v_rcp_f32 v91, v91
  s_nop 0
  v_mul_f32 v120, v120, v88
  v_mul_f32 v121, v121, v89
  v_mul_f32 v122, v122, v90
  v_mul_f32 v123, v123, v91
  v_mul_f32 v88, 0xbfb8aa3b, v124
  v_mul_f32 v89, 0xbfb8aa3b, v125
  v_mul_f32 v90, 0xbfb8aa3b, v126
  v_mul_f32 v91, 0xbfb8aa3b, v127
  v_exp_f32 v88, v88
  v_exp_f32 v89, v89
  v_exp_f32 v90, v90
  v_exp_f32 v91, v91
  s_nop 0
  v_add_f32 v88, 1.0, v88
  v_add_f32 v89, 1.0, v89
  v_add_f32 v90, 1.0, v90
  v_add_f32 v91, 1.0, v91
  v_rcp_f32 v88, v88
  v_rcp_f32 v89, v89
  v_rcp_f32 v90, v90
  v_rcp_f32 v91, v91
  s_nop 0
  v_mul_f32 v124, v124, v88
  v_mul_f32 v125, v125, v89
  v_mul_f32 v126, v126, v90
  v_mul_f32 v127, v127, v91
  v_mul_f32 v88, 0xbfb8aa3b, v128
  v_mul_f32 v89, 0xbfb8aa3b, v129
  v_mul_f32 v90, 0xbfb8aa3b, v130
  v_mul_f32 v91, 0xbfb8aa3b, v131
  v_exp_f32 v88, v88
  v_exp_f32 v89, v89
  v_exp_f32 v90, v90
  v_exp_f32 v91, v91
  s_nop 0
  v_add_f32 v88, 1.0, v88
  v_add_f32 v89, 1.0, v89
  v_add_f32 v90, 1.0, v90
  v_add_f32 v91, 1.0, v91
  v_rcp_f32 v88, v88
  v_rcp_f32 v89, v89
  v_rcp_f32 v90, v90
  v_rcp_f32 v91, v91
  s_nop 0
  v_mul_f32 v128, v128, v88
  v_mul_f32 v129, v129, v89
  v_mul_f32 v130, v130, v90
  v_mul_f32 v131, v131, v91
  v_mul_f32 v88, 0xbfb8aa3b, v132
  v_mul_f32 v89, 0xbfb8aa3b, v133
  v_mul_f32 v90, 0xbfb8aa3b, v134
  v_mul_f32 v91, 0xbfb8aa3b, v135
  v_exp_f32 v88, v88
  v_exp_f32 v89, v89
  v_exp_f32 v90, v90
  v_exp_f32 v91, v91
  s_nop 0
  v_add_f32 v88, 1.0, v88
  v_add_f32 v89, 1.0, v89
  v_add_f32 v90, 1.0, v90
  v_add_f32 v91, 1.0, v91
  v_rcp_f32 v88, v88
  v_rcp_f32 v89, v89
  v_rcp_f32 v90, v90
  v_rcp_f32 v91, v91
  s_nop 0
  v_mul_f32 v132, v132, v88
  v_mul_f32 v133, v133, v89
  v_mul_f32 v134, v134, v90
  v_mul_f32 v135, v135, v91
  v_cvt_pk_bf16_f32 v120, 0, v120
  v_cvt_pk_bf16_f32 v121, 0, v121
  v_cvt_pk_bf16_f32 v122, 0, v122
  v_cvt_pk_bf16_f32 v123, 0, v123
  v_cvt_pk_bf16_f32 v124, 0, v124
  v_cvt_pk_bf16_f32 v125, 0, v125
  v_cvt_pk_bf16_f32 v126, 0, v126
  v_cvt_pk_bf16_f32 v127, 0, v127
  v_cvt_pk_bf16_f32 v128, 0, v128
  v_cvt_pk_bf16_f32 v129, 0, v129
  v_cvt_pk_bf16_f32 v130, 0, v130
  v_cvt_pk_bf16_f32 v131, 0, v131
  v_cvt_pk_bf16_f32 v132, 0, v132
  v_cvt_pk_bf16_f32 v133, 0, v133
  v_cvt_pk_bf16_f32 v134, 0, v134
  v_cvt_pk_bf16_f32 v135, 0, v135
  v_cvt_pk_bf16_f32 v72, 0, v72
  v_cvt_pk_bf16_f32 v73, 0, v73
  v_cvt_pk_bf16_f32 v74, 0, v74
  v_cvt_pk_bf16_f32 v75, 0, v75
  v_cvt_pk_bf16_f32 v76, 0, v76
  v_cvt_pk_bf16_f32 v77, 0, v77
  v_cvt_pk_bf16_f32 v78, 0, v78
  v_cvt_pk_bf16_f32 v79, 0, v79
  v_cvt_pk_bf16_f32 v80, 0, v80
  v_cvt_pk_bf16_f32 v81, 0, v81
  v_cvt_pk_bf16_f32 v82, 0, v82
  v_cvt_pk_bf16_f32 v83, 0, v83
  v_cvt_pk_bf16_f32 v84, 0, v84
  v_cvt_pk_bf16_f32 v85, 0, v85
  v_cvt_pk_bf16_f32 v86, 0, v86
  v_cvt_pk_bf16_f32 v87, 0, v87
  v_mul_f32 v72, v72, v120
  v_mul_f32 v73, v73, v121
  v_mul_f32 v74, v74, v122
  v_mul_f32 v75, v75, v123
  v_mul_f32 v76, v76, v124
  v_mul_f32 v77, v77, v125
  v_mul_f32 v78, v78, v126
  v_mul_f32 v79, v79, v127
  v_mul_f32 v80, v80, v128
  v_mul_f32 v81, v81, v129
  v_mul_f32 v82, v82, v130
  v_mul_f32 v83, v83, v131
  v_mul_f32 v84, v84, v132
  v_mul_f32 v85, v85, v133
  v_mul_f32 v86, v86, v134
  v_mul_f32 v87, v87, v135
  v_cvt_pk_bf16_f32 v40, v72, v73
  v_cvt_pk_bf16_f32 v41, v74, v75
  v_cvt_pk_bf16_f32 v42, v76, v77
  v_cvt_pk_bf16_f32 v43, v78, v79
  v_cvt_pk_bf16_f32 v44, v80, v81
  v_cvt_pk_bf16_f32 v45, v82, v83
  v_cvt_pk_bf16_f32 v46, v84, v85
  v_cvt_pk_bf16_f32 v47, v86, v87
  v_add_u32 v3, 15360, v0
  ds_write_b128 v3, v[40:43] offset:0
  ds_write_b128 v3, v[44:47] offset:3072
  s_mov_b32 s44, s28
  s_mov_b32 s45, s29
  s_mov_b32 s46, 1409024
  s_mov_b32 s11, 2752
  s_mov_b32 s12, 1409024
  v_mov_b32 v4, 12288
  v_mov_b32 v5, 13312
  v_lshlrev_b32 v2, 4, v1
  v_add_u32 v2, 2048, v2
  s_call_b64 s[62:63], L_gv
  v_cvt_pk_bf16_f32 v120, 0, v72
  v_cvt_pk_bf16_f32 v121, 0, v73
  v_cvt_pk_bf16_f32 v122, 0, v74
  v_cvt_pk_bf16_f32 v123, 0, v75
  v_cvt_pk_bf16_f32 v124, 0, v76
  v_cvt_pk_bf16_f32 v125, 0, v77
  v_cvt_pk_bf16_f32 v126, 0, v78
  v_cvt_pk_bf16_f32 v127, 0, v79
  v_cvt_pk_bf16_f32 v128, 0, v80
  v_cvt_pk_bf16_f32 v129, 0, v81
  v_cvt_pk_bf16_f32 v130, 0, v82
  v_cvt_pk_bf16_f32 v131, 0, v83
  v_cvt_pk_bf16_f32 v132, 0, v84
  v_cvt_pk_bf16_f32 v133, 0, v85
  v_cvt_pk_bf16_f32 v134, 0, v86
  v_cvt_pk_bf16_f32 v135, 0, v87
  s_mov_b32 s44, s30
  s_mov_b32 s45, s31
  s_mov_b32 s46, 1409024
  s_mov_b32 s11, 2752
  s_mov_b32 s12, 1409024
  v_mov_b32 v4, 12288
  v_mov_b32 v5, 13312
  v_lshlrev_b32 v2, 4, v1
  v_add_u32 v2, 2048, v2
  s_call_b64 s[62:63], L_gv
  v_mul_f32 v88, 0xbfb8aa3b, v120
  v_mul_f32 v89, 0xbfb8aa3b, v121
  v_mul_f32 v90, 0xbfb8aa3b, v122
  v_mul_f32 v91, 0xbfb8aa3b, v123
  v_exp_f32 v88, v88
  v_exp_f32 v89, v89
  v_exp_f32 v90, v90
  v_exp_f32 v91, v91
  s_nop 0
  v_add_f32 v88, 1.0, v88
  v_add_f32 v89, 1.0, v89
  v_add_f32 v90, 1.0, v90
  v_add_f32 v91, 1.0, v91
  v_rcp_f32 v88, v88
  v_rcp_f32 v89, v89
  v_rcp_f32 v90, v90
  v_rcp_f32 v91, v91
  s_nop 0
  v_mul_f32 v120, v120, v88
  v_mul_f32 v121, v121, v89
  v_mul_f32 v122, v122, v90
  v_mul_f32 v123, v123, v91
  v_mul_f32 v88, 0xbfb8aa3b, v124
  v_mul_f32 v89, 0xbfb8aa3b, v125
  v_mul_f32 v90, 0xbfb8aa3b, v126
  v_mul_f32 v91, 0xbfb8aa3b, v127
  v_exp_f32 v88, v88
  v_exp_f32 v89, v89
  v_exp_f32 v90, v90
  v_exp_f32 v91, v91
  s_nop 0
  v_add_f32 v88, 1.0, v88
  v_add_f32 v89, 1.0, v89
  v_add_f32 v90, 1.0, v90
  v_add_f32 v91, 1.0, v91
  v_rcp_f32 v88, v88
  v_rcp_f32 v89, v89
  v_rcp_f32 v90, v90
  v_rcp_f32 v91, v91
  s_nop 0
  v_mul_f32 v124, v124, v88
  v_mul_f32 v125, v125, v89
  v_mul_f32 v126, v126, v90
  v_mul_f32 v127, v127, v91
  v_mul_f32 v88, 0xbfb8aa3b, v128
  v_mul_f32 v89, 0xbfb8aa3b, v129
  v_mul_f32 v90, 0xbfb8aa3b, v130
  v_mul_f32 v91, 0xbfb8aa3b, v131
  v_exp_f32 v88, v88
  v_exp_f32 v89, v89
  v_exp_f32 v90, v90
  v_exp_f32 v91, v91
  s_nop 0
  v_add_f32 v88, 1.0, v88
  v_add_f32 v89, 1.0, v89
  v_add_f32 v90, 1.0, v90
  v_add_f32 v91, 1.0, v91
  v_rcp_f32 v88, v88
  v_rcp_f32 v89, v89
  v_rcp_f32 v90, v90
  v_rcp_f32 v91, v91
  s_nop 0
  v_mul_f32 v128, v128, v88
  v_mul_f32 v129, v129, v89
  v_mul_f32 v130, v130, v90
  v_mul_f32 v131, v131, v91
  v_mul_f32 v88, 0xbfb8aa3b, v132
  v_mul_f32 v89, 0xbfb8aa3b, v133
  v_mul_f32 v90, 0xbfb8aa3b, v134
  v_mul_f32 v91, 0xbfb8aa3b, v135
  v_exp_f32 v88, v88
  v_exp_f32 v89, v89
  v_exp_f32 v90, v90
  v_exp_f32 v91, v91
  s_nop 0
  v_add_f32 v88, 1.0, v88
  v_add_f32 v89, 1.0, v89
  v_add_f32 v90, 1.0, v90
  v_add_f32 v91, 1.0, v91
  v_rcp_f32 v88, v88
  v_rcp_f32 v89, v89
  v_rcp_f32 v90, v90
  v_rcp_f32 v91, v91
  s_nop 0
  v_mul_f32 v132, v132, v88
  v_mul_f32 v133, v133, v89
  v_mul_f32 v134, v134, v90
  v_mul_f32 v135, v135, v91
  v_cvt_pk_bf16_f32 v120, 0, v120
  v_cvt_pk_bf16_f32 v121, 0, v121
  v_cvt_pk_bf16_f32 v122, 0, v122
  v_cvt_pk_bf16_f32 v123, 0, v123
  v_cvt_pk_bf16_f32 v124, 0, v124
  v_cvt_pk_bf16_f32 v125, 0, v125
  v_cvt_pk_bf16_f32 v126, 0, v126
  v_cvt_pk_bf16_f32 v127, 0, v127
  v_cvt_pk_bf16_f32 v128, 0, v128
  v_cvt_pk_bf16_f32 v129, 0, v129
  v_cvt_pk_bf16_f32 v130, 0, v130
  v_cvt_pk_bf16_f32 v131, 0, v131
  v_cvt_pk_bf16_f32 v132, 0, v132
  v_cvt_pk_bf16_f32 v133, 0, v133
  v_cvt_pk_bf16_f32 v134, 0, v134
  v_cvt_pk_bf16_f32 v135, 0, v135
  v_cvt_pk_bf16_f32 v72, 0, v72
  v_cvt_pk_bf16_f32 v73, 0, v73
  v_cvt_pk_bf16_f32 v74, 0, v74
  v_cvt_pk_bf16_f32 v75, 0, v75
  v_cvt_pk_bf16_f32 v76, 0, v76
  v_cvt_pk_bf16_f32 v77, 0, v77
  v_cvt_pk_bf16_f32 v78, 0, v78
  v_cvt_pk_bf16_f32 v79, 0, v79
  v_cvt_pk_bf16_f32 v80, 0, v80
  v_cvt_pk_bf16_f32 v81, 0, v81
  v_cvt_pk_bf16_f32 v82, 0, v82
  v_cvt_pk_bf16_f32 v83, 0, v83
  v_cvt_pk_bf16_f32 v84, 0, v84
  v_cvt_pk_bf16_f32 v85, 0, v85
  v_cvt_pk_bf16_f32 v86, 0, v86
  v_cvt_pk_bf16_f32 v87, 0, v87
  v_mul_f32 v72, v72, v120
  v_mul_f32 v73, v73, v121
  v_mul_f32 v74, v74, v122
  v_mul_f32 v75, v75, v123
  v_mul_f32 v76, v76, v124
  v_mul_f32 v77, v77, v125
  v_mul_f32 v78, v78, v126
  v_mul_f32 v79, v79, v127
  v_mul_f32 v80, v80, v128
  v_mul_f32 v81, v81, v129
  v_mul_f32 v82, v82, v130
  v_mul_f32 v83, v83, v131
  v_mul_f32 v84, v84, v132
  v_mul_f32 v85, v85, v133
  v_mul_f32 v86, v86, v134
  v_mul_f32 v87, v87, v135
  v_cvt_pk_bf16_f32 v40, v72, v73
  v_cvt_pk_bf16_f32 v41, v74, v75
  v_cvt_pk_bf16_f32 v42, v76, v77
  v_cvt_pk_bf16_f32 v43, v78, v79
  v_cvt_pk_bf16_f32 v44, v80, v81
  v_cvt_pk_bf16_f32 v45, v82, v83
  v_cvt_pk_bf16_f32 v46, v84, v85
  v_cvt_pk_bf16_f32 v47, v86, v87
  v_add_u32 v3, 16384, v0
  ds_write_b128 v3, v[40:43] offset:0
  ds_write_b128 v3, v[44:47] offset:3072
  s_mov_b32 s44, s32
  s_mov_b32 s45, s33
  s_mov_b32 s46, 1409024
  s_mov_b32 s11, 1024
  s_mov_b32 s12, 1409024
  v_mov_b32 v4, 14336
  v_mov_b32 v5, 17408
  v_lshlrev_b32 v2, 4, v1
  s_call_b64 s[62:63], L_gv
  v_lshrrev_b32 v2, 1, v1
  v_lshlrev_b32 v2, 7, v2
  v_and_b32 v3, 1, v1
  v_lshl_add_u32 v2, v3, 5, v2
  v_add_u32 v2, 24576, v2
  global_load_dwordx4 v[40:43], v2, s[42:43] offset:0 sc1
  global_load_dwordx4 v[44:47], v2, s[42:43] offset:16 sc1
  global_load_dwordx4 v[48:51], v2, s[42:43] offset:64 sc1
  global_load_dwordx4 v[52:55], v2, s[42:43] offset:80 sc1
  s_waitcnt vmcnt(0)
  v_lshlrev_b32 v88, 16, v40
  v_and_b32 v89, s73, v40
  v_lshlrev_b32 v90, 16, v42
  v_and_b32 v91, s73, v42
  v_lshlrev_b32 v92, 16, v44
  v_and_b32 v93, s73, v44
  v_lshlrev_b32 v94, 16, v46
  v_and_b32 v95, s73, v46
  v_lshlrev_b32 v96, 16, v48
  v_and_b32 v97, s73, v48
  v_lshlrev_b32 v98, 16, v50
  v_and_b32 v99, s73, v50
  v_lshlrev_b32 v100, 16, v52
  v_and_b32 v101, s73, v52
  v_lshlrev_b32 v102, 16, v54
  v_and_b32 v103, s73, v54
  v_cvt_pk_bf16_f32 v72, 0, v72
  v_cvt_pk_bf16_f32 v73, 0, v73
  v_cvt_pk_bf16_f32 v74, 0, v74
  v_cvt_pk_bf16_f32 v75, 0, v75
  v_cvt_pk_bf16_f32 v76, 0, v76
  v_cvt_pk_bf16_f32 v77, 0, v77
  v_cvt_pk_bf16_f32 v78, 0, v78
  v_cvt_pk_bf16_f32 v79, 0, v79
  v_cvt_pk_bf16_f32 v80, 0, v80
  v_cvt_pk_bf16_f32 v81, 0, v81
  v_cvt_pk_bf16_f32 v82, 0, v82
  v_cvt_pk_bf16_f32 v83, 0, v83
  v_cvt_pk_bf16_f32 v84, 0, v84
  v_cvt_pk_bf16_f32 v85, 0, v85
  v_cvt_pk_bf16_f32 v86, 0, v86
  v_cvt_pk_bf16_f32 v87, 0, v87
  v_mul_f32 v72, v72, v88
  v_mul_f32 v73, v73, v89
  v_mul_f32 v74, v74, v90
  v_mul_f32 v75, v75, v91
  v_mul_f32 v76, v76, v92
  v_mul_f32 v77, v77, v93
  v_mul_f32 v78, v78, v94
  v_mul_f32 v79, v79, v95
  v_mul_f32 v80, v80, v96
  v_mul_f32 v81, v81, v97
  v_mul_f32 v82, v82, v98
  v_mul_f32 v83, v83, v99
  v_mul_f32 v84, v84, v100
  v_mul_f32 v85, v85, v101
  v_mul_f32 v86, v86, v102
  v_mul_f32 v87, v87, v103
  v_cvt_pk_bf16_f32 v72, 0, v72
  v_cvt_pk_bf16_f32 v73, 0, v73
  v_cvt_pk_bf16_f32 v74, 0, v74
  v_cvt_pk_bf16_f32 v75, 0, v75
  v_cvt_pk_bf16_f32 v76, 0, v76
  v_cvt_pk_bf16_f32 v77, 0, v77
  v_cvt_pk_bf16_f32 v78, 0, v78
  v_cvt_pk_bf16_f32 v79, 0, v79
  v_cvt_pk_bf16_f32 v80, 0, v80
  v_cvt_pk_bf16_f32 v81, 0, v81
  v_cvt_pk_bf16_f32 v82, 0, v82
  v_cvt_pk_bf16_f32 v83, 0, v83
  v_cvt_pk_bf16_f32 v84, 0, v84
  v_cvt_pk_bf16_f32 v85, 0, v85
  v_cvt_pk_bf16_f32 v86, 0, v86
  v_cvt_pk_bf16_f32 v87, 0, v87
  v_add_f32 v104, v104, v72
  v_add_f32 v105, v105, v73
  v_add_f32 v106, v106, v74
  v_add_f32 v107, v107, v75
  v_add_f32 v108, v108, v76
  v_add_f32 v109, v109, v77
  v_add_f32 v110, v110, v78
  v_add_f32 v111, v111, v79
  v_add_f32 v112, v112, v80
  v_add_f32 v113, v113, v81
  v_add_f32 v114, v114, v82
  v_add_f32 v115, v115, v83
  v_add_f32 v116, v116, v84
  v_add_f32 v117, v117, v85
  v_add_f32 v118, v118, v86
  v_add_f32 v119, v119, v87
  v_cvt_pk_bf16_f32 v104, 0, v104
  v_cvt_pk_bf16_f32 v105, 0, v105
  v_cvt_pk_bf16_f32 v106, 0, v106
  v_cvt_pk_bf16_f32 v107, 0, v107
  v_cvt_pk_bf16_f32 v108, 0, v108
  v_cvt_pk_bf16_f32 v109, 0, v109
  v_cvt_pk_bf16_f32 v110, 0, v110
  v_cvt_pk_bf16_f32 v111, 0, v111
  v_cvt_pk_bf16_f32 v112, 0, v112
  v_cvt_pk_bf16_f32 v113, 0, v113
  v_cvt_pk_bf16_f32 v114, 0, v114
  v_cvt_pk_bf16_f32 v115, 0, v115
  v_cvt_pk_bf16_f32 v116, 0, v116
  v_cvt_pk_bf16_f32 v117, 0, v117
  v_cvt_pk_bf16_f32 v118, 0, v118
  v_cvt_pk_bf16_f32 v119, 0, v119
  v_cvt_pk_bf16_f32 v40, v104, v105
  v_cvt_pk_bf16_f32 v41, v106, v107
  v_cvt_pk_bf16_f32 v42, v108, v109
  v_cvt_pk_bf16_f32 v43, v110, v111
  v_cvt_pk_bf16_f32 v44, v112, v113
  v_cvt_pk_bf16_f32 v45, v114, v115
  v_cvt_pk_bf16_f32 v46, v116, v117
  v_cvt_pk_bf16_f32 v47, v118, v119
  global_store_dwordx4 v0, v[40:43], s[38:39] offset:0 sc1
  global_store_dwordx4 v0, v[44:47], s[38:39] offset:1024 sc1
  s_endpgm
L_gv:
  v_mov_b32 v72, 0
  v_mov_b32 v73, 0
  v_mov_b32 v74, 0
  v_mov_b32 v75, 0
  v_mov_b32 v76, 0
  v_mov_b32 v77, 0
  v_mov_b32 v78, 0
  v_mov_b32 v79, 0
  v_mov_b32 v80, 0
  v_mov_b32 v81, 0
  v_mov_b32 v82, 0
  v_mov_b32 v83, 0
  v_mov_b32 v84, 0
  v_mov_b32 v85, 0
  v_mov_b32 v86, 0
  v_mov_b32 v87, 0
  s_mov_b32 s10, 0
L_gvl:
  buffer_load_dwordx4 v[40:43], v2, s[44:47], s10 offen
  s_add_u32 s10, s10, s11
  buffer_load_dwordx4 v[44:47], v2, s[44:47], s10 offen
  s_add_u32 s10, s10, s11
  buffer_load_dwordx4 v[48:51], v2, s[44:47], s10 offen
  s_add_u32 s10, s10, s11
  buffer_load_dwordx4 v[52:55], v2, s[44:47], s10 offen
  s_add_u32 s10, s10, s11
  buffer_load_dwordx4 v[56:59], v2, s[44:47], s10 offen
  s_add_u32 s10, s10, s11
  buffer_load_dwordx4 v[60:63], v2, s[44:47], s10 offen
  s_add_u32 s10, s10, s11
  buffer_load_dwordx4 v[64:67], v2, s[44:47], s10 offen
  s_add_u32 s10, s10, s11
  buffer_load_dwordx4 v[68:71], v2, s[44:47], s10 offen
  s_add_u32 s10, s10, s11
  ds_read_b128 v[88:91], v4
  ds_read_b128 v[92:95], v5
  v_add_u32 v4, 16, v4
  v_add_u32 v5, 16, v5
  s_waitcnt lgkmcnt(0)
  v_and_b32 v8, 0xffff, v88
  v_lshlrev_b32 v9, 16, v88
  v_and_b32 v10, 0xffff, v92
  v_lshlrev_b32 v11, 16, v92
  s_waitcnt vmcnt(7)
  v_dot2c_f32_bf16 v72, v8, v40
  v_dot2c_f32_bf16 v73, v9, v40
  v_dot2c_f32_bf16 v74, v8, v41
  v_dot2c_f32_bf16 v75, v9, v41
  v_dot2c_f32_bf16 v76, v8, v42
  v_dot2c_f32_bf16 v77, v9, v42
  v_dot2c_f32_bf16 v78, v8, v43
  v_dot2c_f32_bf16 v79, v9, v43
  v_dot2c_f32_bf16 v80, v10, v40
  v_dot2c_f32_bf16 v81, v11, v40
  v_dot2c_f32_bf16 v82, v10, v41
  v_dot2c_f32_bf16 v83, v11, v41
  v_dot2c_f32_bf16 v84, v10, v42
  v_dot2c_f32_bf16 v85, v11, v42
  v_dot2c_f32_bf16 v86, v10, v43
  v_dot2c_f32_bf16 v87, v11, v43
  v_lshrrev_b32 v8, 16, v88
  v_and_b32 v9, s73, v88
  v_lshrrev_b32 v10, 16, v92
  v_and_b32 v11, s73, v92
  s_waitcnt vmcnt(6)
  v_dot2c_f32_bf16 v72, v8, v44
  v_dot2c_f32_bf16 v73, v9, v44
  v_dot2c_f32_bf16 v74, v8, v45
  v_dot2c_f32_bf16 v75, v9, v45
  v_dot2c_f32_bf16 v76, v8, v46
  v_dot2c_f32_bf16 v77, v9, v46
  v_dot2c_f32_bf16 v78, v8, v47
  v_dot2c_f32_bf16 v79, v9, v47
  v_dot2c_f32_bf16 v80, v10, v44
  v_dot2c_f32_bf16 v81, v11, v44
  v_dot2c_f32_bf16 v82, v10, v45
  v_dot2c_f32_bf16 v83, v11, v45
  v_dot2c_f32_bf16 v84, v10, v46
  v_dot2c_f32_bf16 v85, v11, v46
  v_dot2c_f32_bf16 v86, v10, v47
  v_dot2c_f32_bf16 v87, v11, v47
  v_and_b32 v8, 0xffff, v89
  v_lshlrev_b32 v9, 16, v89
  v_and_b32 v10, 0xffff, v93
  v_lshlrev_b32 v11, 16, v93
  s_waitcnt vmcnt(5)
  v_dot2c_f32_bf16 v72, v8, v48
  v_dot2c_f32_bf16 v73, v9, v48
  v_dot2c_f32_bf16 v74, v8, v49
  v_dot2c_f32_bf16 v75, v9, v49
  v_dot2c_f32_bf16 v76, v8, v50
  v_dot2c_f32_bf16 v77, v9, v50
  v_dot2c_f32_bf16 v78, v8, v51
  v_dot2c_f32_bf16 v79, v9, v51
  v_dot2c_f32_bf16 v80, v10, v48
  v_dot2c_f32_bf16 v81, v11, v48
  v_dot2c_f32_bf16 v82, v10, v49
  v_dot2c_f32_bf16 v83, v11, v49
  v_dot2c_f32_bf16 v84, v10, v50
  v_dot2c_f32_bf16 v85, v11, v50
  v_dot2c_f32_bf16 v86, v10, v51
  v_dot2c_f32_bf16 v87, v11, v51
  v_lshrrev_b32 v8, 16, v89
  v_and_b32 v9, s73, v89
  v_lshrrev_b32 v10, 16, v93
  v_and_b32 v11, s73, v93
  s_waitcnt vmcnt(4)
  v_dot2c_f32_bf16 v72, v8, v52
  v_dot2c_f32_bf16 v73, v9, v52
  v_dot2c_f32_bf16 v74, v8, v53
  v_dot2c_f32_bf16 v75, v9, v53
  v_dot2c_f32_bf16 v76, v8, v54
  v_dot2c_f32_bf16 v77, v9, v54
  v_dot2c_f32_bf16 v78, v8, v55
  v_dot2c_f32_bf16 v79, v9, v55
  v_dot2c_f32_bf16 v80, v10, v52
  v_dot2c_f32_bf16 v81, v11, v52
  v_dot2c_f32_bf16 v82, v10, v53
  v_dot2c_f32_bf16 v83, v11, v53
  v_dot2c_f32_bf16 v84, v10, v54
  v_dot2c_f32_bf16 v85, v11, v54
  v_dot2c_f32_bf16 v86, v10, v55
  v_dot2c_f32_bf16 v87, v11, v55
  v_and_b32 v8, 0xffff, v90
  v_lshlrev_b32 v9, 16, v90
  v_and_b32 v10, 0xffff, v94
  v_lshlrev_b32 v11, 16, v94
  s_waitcnt vmcnt(3)
  v_dot2c_f32_bf16 v72, v8, v56
  v_dot2c_f32_bf16 v73, v9, v56
  v_dot2c_f32_bf16 v74, v8, v57
  v_dot2c_f32_bf16 v75, v9, v57
  v_dot2c_f32_bf16 v76, v8, v58
  v_dot2c_f32_bf16 v77, v9, v58
  v_dot2c_f32_bf16 v78, v8, v59
  v_dot2c_f32_bf16 v79, v9, v59
  v_dot2c_f32_bf16 v80, v10, v56
  v_dot2c_f32_bf16 v81, v11, v56
  v_dot2c_f32_bf16 v82, v10, v57
  v_dot2c_f32_bf16 v83, v11, v57
  v_dot2c_f32_bf16 v84, v10, v58
  v_dot2c_f32_bf16 v85, v11, v58
  v_dot2c_f32_bf16 v86, v10, v59
  v_dot2c_f32_bf16 v87, v11, v59
  v_lshrrev_b32 v8, 16, v90
  v_and_b32 v9, s73, v90
  v_lshrrev_b32 v10, 16, v94
  v_and_b32 v11, s73, v94
  s_waitcnt vmcnt(2)
  v_dot2c_f32_bf16 v72, v8, v60
  v_dot2c_f32_bf16 v73, v9, v60
  v_dot2c_f32_bf16 v74, v8, v61
  v_dot2c_f32_bf16 v75, v9, v61
  v_dot2c_f32_bf16 v76, v8, v62
  v_dot2c_f32_bf16 v77, v9, v62
  v_dot2c_f32_bf16 v78, v8, v63
  v_dot2c_f32_bf16 v79, v9, v63
  v_dot2c_f32_bf16 v80, v10, v60
  v_dot2c_f32_bf16 v81, v11, v60
  v_dot2c_f32_bf16 v82, v10, v61
  v_dot2c_f32_bf16 v83, v11, v61
  v_dot2c_f32_bf16 v84, v10, v62
  v_dot2c_f32_bf16 v85, v11, v62
  v_dot2c_f32_bf16 v86, v10, v63
  v_dot2c_f32_bf16 v87, v11, v63
  v_and_b32 v8, 0xffff, v91
  v_lshlrev_b32 v9, 16, v91
  v_and_b32 v10, 0xffff, v95
  v_lshlrev_b32 v11, 16, v95
  s_waitcnt vmcnt(1)
  v_dot2c_f32_bf16 v72, v8, v64
  v_dot2c_f32_bf16 v73, v9, v64
  v_dot2c_f32_bf16 v74, v8, v65
  v_dot2c_f32_bf16 v75, v9, v65
  v_dot2c_f32_bf16 v76, v8, v66
  v_dot2c_f32_bf16 v77, v9, v66
  v_dot2c_f32_bf16 v78, v8, v67
  v_dot2c_f32_bf16 v79, v9, v67
  v_dot2c_f32_bf16 v80, v10, v64
  v_dot2c_f32_bf16 v81, v11, v64
  v_dot2c_f32_bf16 v82, v10, v65
  v_dot2c_f32_bf16 v83, v11, v65
  v_dot2c_f32_bf16 v84, v10, v66
  v_dot2c_f32_bf16 v85, v11, v66
  v_dot2c_f32_bf16 v86, v10, v67
  v_dot2c_f32_bf16 v87, v11, v67
  v_lshrrev_b32 v8, 16, v91
  v_and_b32 v9, s73, v91
  v_lshrrev_b32 v10, 16, v95
  v_and_b32 v11, s73, v95
  s_waitcnt vmcnt(0)
  v_dot2c_f32_bf16 v72, v8, v68
  v_dot2c_f32_bf16 v73, v9, v68
  v_dot2c_f32_bf16 v74, v8, v69
  v_dot2c_f32_bf16 v75, v9, v69
  v_dot2c_f32_bf16 v76, v8, v70
  v_dot2c_f32_bf16 v77, v9, v70
  v_dot2c_f32_bf16 v78, v8, v71
  v_dot2c_f32_bf16 v79, v9, v71
  v_dot2c_f32_bf16 v80, v10, v68
  v_dot2c_f32_bf16 v81, v11, v68
  v_dot2c_f32_bf16 v82, v10, v69
  v_dot2c_f32_bf16 v83, v11, v69
  v_dot2c_f32_bf16 v84, v10, v70
  v_dot2c_f32_bf16 v85, v11, v70
  v_dot2c_f32_bf16 v86, v10, v71
  v_dot2c_f32_bf16 v87, v11, v71
  s_cmp_lt_u32 s10, s12
  s_cbranch_scc1 L_gvl
  s_nop 1
  s_setpc_b64 s[62:63]
L_serv:
  s_cmp_ge_u32 s13, 4
  s_cbranch_scc1 L_team
  s_cmp_lt_u32 s13, 2
  s_cbranch_scc1 L_sv1
  s_getpc_b64 s[56:57]
L_pcc:
  s_sub_u32 s56, s56, L_pcc-adaLN_cond__sliding_block_cached__glu_gated_swiglu__decode_kernel
  s_subb_u32 s57, s57, 0
  s_lshr_b32 s3, s2, 5
  s_lshl1_add_u32 s3, s3, s13
  s_sub_u32 s3, s3, 2
  s_lshl_b32 s3, s3, 12
  v_lshl_add_u32 v2, v1, 6, s3
  v_min_u32 v2, L_end-adaLN_cond__sliding_block_cached__glu_gated_swiglu__decode_kernel, v2
  global_load_dword v3, v2, s[56:57]
  s_endpgm
L_sv1:
  v_mov_b32 v38, 0
  v_mov_b32 v4, -1
  v_mov_b32 v5, 0
  v_mov_b32 v6, 0
  v_mov_b32 v7, 0
  ds_write_b128 v38, v[4:7] offset:256
  ds_write_b64 v38, v[6:7] offset:312
  s_getreg_b32 s76, hwreg(HW_REG_XCC_ID, 0, 4)
  s_waitcnt lgkmcnt(0)
  s_load_dword s74, s[42:43], 0
  s_getpc_b64 s[56:57]
L_pc_28:
  s_lshr_b32 s3, s2, 5
  s_lshl3_add_u32 s3, s3, s8
  s_lshl_b32 s3, s3, 2
  s_add_u32 s3, s3, L_table-L_pc_28
  s_load_dword s14, s[56:57], s3
  s_barrier
  s_waitcnt lgkmcnt(0)
  s_mul_i32 s74, s74, 0x9e3779b1
  s_add_u32 s74, s74, 0x7f4a7c15
  s_bfe_u32 s32, s74, 0x80000
  s_bfe_u32 s33, s74, 0x80008
  s_bfe_u32 s34, s74, 0x80010
  s_bfe_u32 s35, s74, 0x80018
  s_cmp_eq_u32 s13, 0
  s_cbranch_scc1 L_sv0
  s_bfe_u32 s61, s14, 0x80010
  s_cmp_ge_u32 s61, 32
  s_cbranch_scc1 L_fin
  s_mov_b32 s70, 0
L_pl_29:
  ds_read_b32 v8, v38 offset:256
  s_waitcnt lgkmcnt(0)
  v_cmp_eq_u32 vcc, -1, v8
  s_cmp_eq_u64 vcc, 0
  s_cbranch_scc1 L_pld_30
  s_sleep 16
  s_add_u32 s70, s70, 1
  s_cmp_lt_u32 s70, 1048576
  s_cbranch_scc1 L_pl_29
L_pld_30:
  s_branch L_r_f2
L_sv0:
  s_add_u32 s76, s76, s74
  s_lshr_b32 s49, s2, 5
  s_lshl_b32 s50, s8, 5
  s_add_u32 s49, s49, s50
  s_lshl_b32 s49, s49, 2
  v_mov_b32 v8, s49
  v_mov_b32 v9, s76
  s_mov_b64 exec, 1
  global_store_dword v8, v9, s[42:43] offset:1024 sc1
  s_mov_b64 exec, -1
  s_lshl_b32 s54, s6, 9
  s_add_u32 s54, s54, 0
  s_lshl_b32 s55, s6, 9
  s_add_u32 s55, s55, 128
  s_lshl_b32 s56, s6, 9
  s_add_u32 s56, s56, 256
  s_mov_b32 s70, 0
L_sn_31:
  ds_read_b32 v8, v38 offset:312
  s_waitcnt lgkmcnt(0)
  v_cmp_gt_u32 vcc, 0x8, v8
  s_cmp_eq_u64 vcc, 0
  s_cbranch_scc1 L_snd_32
  s_sleep 16
  s_add_u32 s70, s70, 1
  s_cmp_lt_u32 s70, 2097152
  s_cbranch_scc1 L_sn_31
L_snd_32:
  s_load_dwordx2 s[20:21], s[42:43], s54 offset:65536 glc
  s_mov_b32 s70, 0
  s_branch L_s3wc
L_s3w:
  s_load_dwordx2 s[20:21], s[42:43], s54 offset:65536 glc
L_s3wc:
  s_waitcnt lgkmcnt(0)
  s_xor_b32 s68, s21, s74
  s_cbranch_scc0 L_s3wd
  s_sleep 8
  s_add_u32 s70, s70, 1
  s_cmp_lt_u32 s70, 262144
  s_cbranch_scc1 L_s3w
L_s3wd:
  v_mov_b32 v8, 1
  ds_write_b32 v38, v8 offset:260
  s_mov_b32 s70, 0
L_sn_33:
  ds_read_b32 v8, v38 offset:312
  s_waitcnt lgkmcnt(0)
  v_cmp_gt_u32 vcc, 0xc, v8
  s_cmp_eq_u64 vcc, 0
  s_cbranch_scc1 L_snd_34
  s_sleep 16
  s_add_u32 s70, s70, 1
  s_cmp_lt_u32 s70, 2097152
  s_cbranch_scc1 L_sn_33
L_snd_34:
  s_load_dwordx2 s[20:21], s[42:43], s54 offset:98304 glc
  s_load_dwordx2 s[24:25], s[42:43], s55 offset:98304 glc
  s_load_dwordx2 s[28:29], s[42:43], s56 offset:98304 glc
  s_mov_b32 s70, 0
  s_branch L_s3sc
L_s3s:
  s_load_dwordx2 s[20:21], s[42:43], s54 offset:98304 glc
  s_load_dwordx2 s[24:25], s[42:43], s55 offset:98304 glc
  s_load_dwordx2 s[28:29], s[42:43], s56 offset:98304 glc
L_s3sc:
  s_waitcnt lgkmcnt(0)
  s_xor_b32 s68, s21, s74
  s_xor_b32 s69, s25, s74
  s_or_b32 s68, s68, s69
  s_xor_b32 s69, s29, s74
  s_or_b32 s68, s68, s69
  s_cbranch_scc0 L_s3sd
  s_sleep 8
  s_add_u32 s70, s70, 1
  s_cmp_lt_u32 s70, 262144
  s_cbranch_scc1 L_s3s
L_s3sd:
  ds_write_b32 v38, v38 offset:256
  s_branch L_fin
L_team:
  s_and_b32 s5, s13, 3
  v_and_b32 v0, 0xff, v0
  v_mov_b32 v38, 0
  s_mov_b32 s77, 0
  s_lshr_b32 s60, s2, 5
  v_lshrrev_b32 v12, 3, v0
  v_lshlrev_b32 v12, 5, v12
  v_bfe_u32 v3, v1, 2, 1
  v_lshl_add_u32 v12, v3, 10, v12
  v_and_b32 v8, 3, v1
  v_lshl_add_u32 v37, v8, 3, v12
  v_and_b32 v12, 0xffffffdf, v12
  v_lshl_add_u32 v12, v8, 4, v12
  v_bfe_u32 v8, v1, 3, 1
  v_lshl_add_u32 v12, v8, 3, v12
  v_lshl_add_u32 v12, v3, 5, v12
  s_waitcnt lgkmcnt(0)
  s_load_dword s74, s[42:43], 0
  s_barrier
  s_cmp_ge_u32 s13, 8
  s_cbranch_scc1 L_r_mod
L_r_q:
  s_lshl3_add_u32 s61, s8, s60
  s_lshl_b32 s48, s61, 7
  s_lshl_b32 s58, s61, 8
  s_add_u32 s58, s58, 32768
  global_load_dwordx2 v[14:15], v37, s[16:17]
  s_mov_b32 s44, s22
  s_mov_b32 s45, s23
  s_mov_b32 s46, 4194304
  s_mov_b32 s47, 0x20000
  s_cmp_ge_u32 s60, 2
  s_cbranch_scc1 L_q_go
  s_mov_b32 s70, 0
L_sn_35:
  ds_read_b32 v8, v38 offset:268
  s_waitcnt lgkmcnt(0)
  v_cmp_gt_u32 vcc, 0x4, v8
  s_cmp_eq_u64 vcc, 0
  s_cbranch_scc1 L_snd_36
  s_sleep 1
  s_add_u32 s70, s70, 1
  s_cmp_lt_u32 s70, 2097152
  s_cbranch_scc1 L_sn_35
L_snd_36:
L_q_go:
  v_lshrrev_b32 v2, 3, v1
  v_and_b32 v3, 6, v2
  v_xor_b32 v3, v3, v1
  v_mul_u32_u24 v2, 8192, v2
  v_and_b32 v3, 7, v3
  v_lshl_add_u32 v2, v3, 4, v2
  s_mul_i32 s49, s5, 1048576
  s_lshl_b32 s50, s5, 14
  s_add_u32 s49, s49, s48
  s_add_u32 s50, s50, 12288
  s_add_u32 s51, s50, 16384
L_dma_37:
  s_mov_b32 m0, s50
  s_add_u32 s50, s50, 1024
  buffer_load_dwordx4 v2, s[44:47], s49 offen nt lds
  s_add_u32 s49, s49, 65536
  s_cmp_lt_u32 s50, s51
  s_cbranch_scc1 L_dma_37
L_dmae_38:
  v_mov_b32 v3, 1
  s_mov_b64 exec, 1
  ds_add_u32 v38, v3 offset:264
  s_mov_b64 exec, -1
  s_waitcnt lgkmcnt(0)
  s_mul_i32 s74, s74, 0x9e3779b1
  s_add_u32 s74, s74, 0x7f4a7c15
  v_bfe_u32 v6, v1, 2, 1
  v_lshlrev_b32 v6, 5, v6
  v_add_u32 v6, 3136, v6
  s_lshl_b32 s49, s5, 3
  v_add_u32 v5, s49, v6
  s_waitcnt vmcnt(16)
  v_lshlrev_b32 v20, 16, v14
  v_and_b32 v21, s73, v14
  v_lshlrev_b32 v22, 16, v15
  v_and_b32 v23, s73, v15
  v_add_f32 v8, v20, v21
  v_mul_f32 v9, v20, v20
  v_add_f32 v10, v22, v23
  v_mul_f32 v11, v22, v22
  v_fmac_f32 v9, v21, v21
  v_fmac_f32 v11, v23, v23
  v_add_f32 v8, v8, v10
  v_add_f32 v9, v9, v11
  s_nop 0
  v_add_f32_dpp v8, v8, v8 quad_perm:[1,0,3,2] row_mask:0xf bank_mask:0xf
  v_add_f32_dpp v9, v9, v9 quad_perm:[1,0,3,2] row_mask:0xf bank_mask:0xf
  s_nop 0
  v_add_f32_dpp v8, v8, v8 quad_perm:[2,3,0,1] row_mask:0xf bank_mask:0xf
  v_add_f32_dpp v9, v9, v9 quad_perm:[2,3,0,1] row_mask:0xf bank_mask:0xf
  s_nop 0
  v_add_f32_dpp v8, v8, v8 row_ror:8 row_mask:0xf bank_mask:0xf
  v_add_f32_dpp v9, v9, v9 row_ror:8 row_mask:0xf bank_mask:0xf
  s_nop 0
  v_mov_b32 v10, v8
  v_mov_b32 v11, v9
  s_nop 0
  v_permlane16_swap_b32 v10, v8
  v_permlane16_swap_b32 v11, v9
  v_add_f32 v8, v8, v10
  v_add_f32 v9, v9, v11
  v_mov_b32 v10, v8
  v_mov_b32 v11, v9
  s_nop 0
  v_permlane32_swap_b32 v10, v8
  v_permlane32_swap_b32 v11, v9
  v_add_f32 v8, v8, v10
  v_add_f32 v9, v9, v11
  ds_write_b64 v5, v[8:9]
  s_waitcnt vmcnt(0) lgkmcnt(0)
  s_add_u32 s77, s77, 4
  v_mov_b32 v9, 1
  s_mov_b64 exec, 1
  ds_add_u32 v38, v9 offset:312
  s_mov_b64 exec, -1
  s_mov_b32 s70, 0
L_hy_39:
  ds_read_b32 v9, v38 offset:312
  s_waitcnt lgkmcnt(0)
  v_cmp_gt_u32 vcc, s77, v9
  s_cmp_eq_u64 vcc, 0
  s_cbranch_scc1 L_hyd_40
  s_add_u32 s70, s70, 1
  s_cmp_lt_u32 s70, 2097152
  s_cbranch_scc1 L_hy_39
L_hyd_40:
  ds_read_b128 v[24:27], v6
  ds_read_b128 v[28:31], v6 offset:16
  s_waitcnt lgkmcnt(0)
  v_pk_add_f32 v[24:25], v[24:25], v[26:27]
  v_pk_add_f32 v[28:29], v[28:29], v[30:31]
  v_pk_add_f32 v[24:25], v[24:25], v[28:29]
  v_mul_f32 v8, 0x3b000000, v24
  v_mul_f32 v9, 0x3b000000, v25
  v_fma_f32 v9, -v8, v8, v9
  v_cvt_pk_bf16_f32 v8, 0, v8
  v_max_f32 v9, 0, v9
  v_cvt_pk_bf16_f32 v9, 0, v9
  v_sub_f32 v20, v20, v8
  v_sub_f32 v21, v21, v8
  v_add_f32 v9, 0x3727c5ac, v9
  v_sub_f32 v22, v22, v8
  v_sub_f32 v23, v23, v8
  v_cvt_pk_bf16_f32 v9, 0, v9
  v_cvt_pk_bf16_f32 v20, 0, v20
  v_sqrt_f32 v9, v9
  v_cvt_pk_bf16_f32 v21, 0, v21
  v_cvt_pk_bf16_f32 v9, 0, v9
  v_cvt_pk_bf16_f32 v22, 0, v22
  v_rcp_f32 v9, v9
  v_cvt_pk_bf16_f32 v23, 0, v23
  v_mul_f32 v20, v20, v9
  v_mul_f32 v21, v21, v9
  v_mul_f32 v22, v22, v9
  v_mul_f32 v23, v23, v9
  v_cvt_pk_bf16_f32 v20, 0, v20
  v_cvt_pk_bf16_f32 v21, 0, v21
  v_cvt_pk_bf16_f32 v22, 0, v22
  v_cvt_pk_bf16_f32 v23, 0, v23
  s_lshl_b32 s49, s8, 13
  s_add_u32 s49, s49, 917504
  v_lshl_add_u32 v15, v0, 4, s49
  v_add_u32 v36, 0x1000, v15
  s_mov_b64 s[64:65], -1
  s_mov_b64 s[66:67], -1
  s_mov_b64 exec, s[64:65]
  global_load_dwordx4 v[16:19], v15, s[42:43] sc1
  s_mov_b64 exec, s[66:67]
  global_load_dwordx4 v[32:35], v36, s[42:43] sc1
  s_mov_b64 exec, -1
  v_lshrrev_b32 v2, 2, v1
  v_bfe_u32 v3, v1, 1, 1
  s_lshl_b32 s49, s5, 1
  v_or_b32 v3, s49, v3
  v_and_b32 v10, 6, v2
  v_xor_b32 v3, v3, v10
  v_lshlrev_b32 v2, 7, v2
  v_lshl_add_u32 v2, v3, 4, v2
  v_and_b32 v3, 1, v1
  v_lshl_add_u32 v2, v3, 3, v2
  v_add_u32 v2, 12288, v2
  ds_read_b64_tr_b16 v[40:41], v2 offset:0
  ds_read_b64_tr_b16 v[42:43], v2 offset:2048
  ds_read_b64_tr_b16 v[44:45], v2 offset:4096
  ds_read_b64_tr_b16 v[46:47], v2 offset:6144
  ds_read_b64_tr_b16 v[48:49], v2 offset:8192
  ds_read_b64_tr_b16 v[50:51], v2 offset:10240
  ds_read_b64_tr_b16 v[52:53], v2 offset:12288
  ds_read_b64_tr_b16 v[54:55], v2 offset:14336
  ds_read_b64_tr_b16 v[56:57], v2 offset:16384
  ds_read_b64_tr_b16 v[58:59], v2 offset:18432
  ds_read_b64_tr_b16 v[60:61], v2 offset:20480
  ds_read_b64_tr_b16 v[62:63], v2 offset:22528
  s_waitcnt lgkmcnt(10)
  ds_read_b64_tr_b16 v[64:65], v2 offset:24576
  ds_read_b64_tr_b16 v[66:67], v2 offset:26624
  s_waitcnt lgkmcnt(10)
  ds_read_b64_tr_b16 v[68:69], v2 offset:28672
  ds_read_b64_tr_b16 v[70:71], v2 offset:30720
  s_waitcnt lgkmcnt(10)
  ds_read_b64_tr_b16 v[72:73], v2 offset:32768
  ds_read_b64_tr_b16 v[74:75], v2 offset:34816
  s_waitcnt lgkmcnt(10)
  ds_read_b64_tr_b16 v[76:77], v2 offset:36864
  ds_read_b64_tr_b16 v[78:79], v2 offset:38912
  s_waitcnt lgkmcnt(10)
  ds_read_b64_tr_b16 v[80:81], v2 offset:40960
  ds_read_b64_tr_b16 v[82:83], v2 offset:43008
  s_waitcnt lgkmcnt(10)
  ds_read_b64_tr_b16 v[84:85], v2 offset:45056
  ds_read_b64_tr_b16 v[86:87], v2 offset:47104
  s_waitcnt lgkmcnt(10)
  ds_read_b64_tr_b16 v[88:89], v2 offset:49152
  ds_read_b64_tr_b16 v[90:91], v2 offset:51200
  s_waitcnt lgkmcnt(10)
  ds_read_b64_tr_b16 v[92:93], v2 offset:53248
  ds_read_b64_tr_b16 v[94:95], v2 offset:55296
  s_waitcnt lgkmcnt(10)
  ds_read_b64_tr_b16 v[96:97], v2 offset:57344
  ds_read_b64_tr_b16 v[98:99], v2 offset:59392
  s_waitcnt lgkmcnt(10)
  ds_read_b64_tr_b16 v[100:101], v2 offset:61440
  ds_read_b64_tr_b16 v[102:103], v2 offset:63488
  s_waitcnt lgkmcnt(10)
  s_waitcnt lgkmcnt(0)
  v_and_b32 v13, 1, v1
  v_lshlrev_b32 v13, 14, v13
  v_lshrrev_b32 v3, 4, v1
  v_lshl_add_u32 v13, v3, 4, v13
  s_lshl_b32 s49, s5, 6
  s_add_u32 s49, s49, s58
  v_add_u32 v13, s49, v13
  v_and_b32 v14, 1, v1
  v_mul_u32_u24 v14, 1056, v14
  v_lshrrev_b32 v3, 4, v1
  v_lshl_add_u32 v14, v3, 4, v14
  v_add_u32 v14, 1024, v14
  s_mov_b32 s70, 0
  s_branch L_q_c
L_q_p:
  s_mov_b64 exec, s[64:65]
  global_load_dwordx4 v[16:19], v15, s[42:43] sc1
  s_mov_b64 exec, s[66:67]
  global_load_dwordx4 v[32:35], v36, s[42:43] sc1
  s_mov_b64 exec, -1
L_q_c:
  s_waitcnt vmcnt(0)
  v_cmp_ne_u32 s[64:65], s74, v17
  v_cmp_ne_u32 s[68:69], s74, v19
  s_or_b64 s[64:65], s[64:65], s[68:69]
  v_cmp_ne_u32 s[66:67], s74, v33
  v_cmp_ne_u32 s[68:69], s74, v35
  s_or_b64 s[66:67], s[66:67], s[68:69]
  s_or_b64 vcc, s[64:65], s[66:67]
  s_or_b32 s64, s64, 1
  s_or_b32 s66, s66, 1
  s_cmp_eq_u64 vcc, 0
  s_cbranch_scc1 L_q_ok
  s_sleep 2
  s_add_u32 s70, s70, 1
  s_cmp_lt_u32 s70, 262144
  s_cbranch_scc1 L_q_p
L_q_ok:
  v_lshlrev_b32 v28, 16, v32
  v_and_b32 v29, s73, v32
  v_lshlrev_b32 v30, 16, v34
  v_and_b32 v31, s73, v34
  v_lshlrev_b32 v24, 16, v16
  v_and_b32 v25, s73, v16
  v_lshlrev_b32 v26, 16, v18
  v_and_b32 v27, s73, v18
  v_add_f32 v28, 1.0, v28
  v_add_f32 v29, 1.0, v29
  v_add_f32 v30, 1.0, v30
  v_add_f32 v31, 1.0, v31
  v_cvt_pk_bf16_f32 v28, 0, v28
  v_cvt_pk_bf16_f32 v29, 0, v29
  v_cvt_pk_bf16_f32 v30, 0, v30
  v_cvt_pk_bf16_f32 v31, 0, v31
  v_mul_f32 v20, v20, v28
  v_mul_f32 v21, v21, v29
  v_mul_f32 v22, v22, v30
  v_mul_f32 v23, v23, v31
  v_cvt_pk_bf16_f32 v20, 0, v20
  v_cvt_pk_bf16_f32 v21, 0, v21
  v_cvt_pk_bf16_f32 v22, 0, v22
  v_cvt_pk_bf16_f32 v23, 0, v23
  v_add_f32 v20, v20, v24
  v_add_f32 v21, v21, v25
  v_add_f32 v22, v22, v26
  v_add_f32 v23, v23, v27
  v_cvt_pk_bf16_f32 v16, v20, v21
  v_cvt_pk_bf16_f32 v17, v22, v23
  ds_write_b64 v12, v[16:17] offset:1024
  s_add_u32 s77, s77, 4
  v_mov_b32 v9, 1
  s_mov_b64 exec, 1
  ds_add_u32 v38, v9 offset:312
  s_mov_b64 exec, -1
  s_mov_b32 s70, 0
L_hy_41:
  ds_read_b32 v9, v38 offset:312
  s_waitcnt lgkmcnt(0)
  v_cmp_gt_u32 vcc, s77, v9
  s_cmp_eq_u64 vcc, 0
  s_cbranch_scc1 L_hyd_42
  s_add_u32 s70, s70, 1
  s_cmp_lt_u32 s70, 2097152
  s_cbranch_scc1 L_hy_41
L_hyd_42:
  ds_read_b128 v[104:107], v14 offset:0
  ds_read_b128 v[108:111], v14 offset:64
  ds_read_b128 v[112:115], v14 offset:128
  ds_read_b128 v[116:119], v14 offset:192
  ds_read_b128 v[120:123], v14 offset:256
  ds_read_b128 v[124:127], v14 offset:320
  ds_read_b128 v[128:131], v14 offset:384
  ds_read_b128 v[132:135], v14 offset:448
  ds_read_b128 v[136:139], v14 offset:512
  ds_read_b128 v[140:143], v14 offset:576
  ds_read_b128 v[144:147], v14 offset:640
  ds_read_b128 v[148:151], v14 offset:704
  s_waitcnt lgkmcnt(11)
  v_mfma_f32_16x16x32_bf16 v[8:11], v[40:43], v[104:107], 0
  ds_read_b128 v[152:155], v14 offset:768
  s_waitcnt lgkmcnt(11)
  v_mfma_f32_16x16x32_bf16 v[8:11], v[44:47], v[108:111], v[8:11]
  ds_read_b128 v[156:159], v14 offset:832
  s_waitcnt lgkmcnt(11)
  v_mfma_f32_16x16x32_bf16 v[8:11], v[48:51], v[112:115], v[8:11]
  ds_read_b128 v[160:163], v14 offset:896
  s_waitcnt lgkmcnt(11)
  v_mfma_f32_16x16x32_bf16 v[8:11], v[52:55], v[116:119], v[8:11]
  ds_read_b128 v[164:167], v14 offset:960
  s_waitcnt lgkmcnt(11)
  v_mfma_f32_16x16x32_bf16 v[8:11], v[56:59], v[120:123], v[8:11]
  s_waitcnt lgkmcnt(10)
  v_mfma_f32_16x16x32_bf16 v[8:11], v[60:63], v[124:127], v[8:11]
  s_waitcnt lgkmcnt(9)
  v_mfma_f32_16x16x32_bf16 v[8:11], v[64:67], v[128:131], v[8:11]
  s_waitcnt lgkmcnt(8)
  v_mfma_f32_16x16x32_bf16 v[8:11], v[68:71], v[132:135], v[8:11]
  s_waitcnt lgkmcnt(7)
  v_mfma_f32_16x16x32_bf16 v[8:11], v[72:75], v[136:139], v[8:11]
  s_waitcnt lgkmcnt(6)
  v_mfma_f32_16x16x32_bf16 v[8:11], v[76:79], v[140:143], v[8:11]
  s_waitcnt lgkmcnt(5)
  v_mfma_f32_16x16x32_bf16 v[8:11], v[80:83], v[144:147], v[8:11]
  s_waitcnt lgkmcnt(4)
  v_mfma_f32_16x16x32_bf16 v[8:11], v[84:87], v[148:151], v[8:11]
  s_waitcnt lgkmcnt(3)
  v_mfma_f32_16x16x32_bf16 v[8:11], v[88:91], v[152:155], v[8:11]
  s_waitcnt lgkmcnt(2)
  v_mfma_f32_16x16x32_bf16 v[8:11], v[92:95], v[156:159], v[8:11]
  s_waitcnt lgkmcnt(1)
  v_mfma_f32_16x16x32_bf16 v[8:11], v[96:99], v[160:163], v[8:11]
  s_waitcnt lgkmcnt(0)
  v_mfma_f32_16x16x32_bf16 v[8:11], v[100:103], v[164:167], v[8:11]
  s_nop 7
  v_cvt_pk_bf16_f32 v8, v8, v9
  v_cvt_pk_bf16_f32 v10, v10, v11
  v_mov_b32 v9, s74
  v_mov_b32 v11, s74
  v_min_u32 v8, s72, v8
  v_min_u32 v10, s72, v10
  s_mov_b32 exec_lo, 0x00030003
  s_mov_b32 exec_hi, 0x00030003
  global_store_dwordx4 v13, v[8:11], s[42:43] sc1
  s_mov_b64 exec, -1
L_r_wo:
  s_xor_b32 s61, s60, 1
  s_lshl_b32 s48, s8, 19
  s_lshl_b32 s49, s61, 7
  s_add_u32 s48, s48, s49
  s_lshr_b32 s58, s8, 1
  s_lshl_b32 s58, s58, 14
  s_and_b32 s49, s8, 1
  s_lshl_b32 s49, s49, 12
  s_add_u32 s58, s58, s49
  s_lshl_b32 s49, s61, 9
  s_add_u32 s58, s58, s49
  s_add_u32 s58, s58, 2097152
  s_mov_b32 s44, s24
  s_mov_b32 s45, s25
  s_mov_b32 s46, 4194304
  s_mov_b32 s47, 0x20000
  v_lshrrev_b32 v2, 3, v1
  v_and_b32 v3, 6, v2
  v_xor_b32 v3, v3, v1
  v_mul_u32_u24 v2, 1024, v2
  v_and_b32 v3, 7, v3
  v_lshl_add_u32 v2, v3, 4, v2
  s_mul_i32 s49, s5, 131072
  s_lshl_b32 s50, s5, 14
  s_add_u32 s49, s49, s48
  s_add_u32 s50, s50, 12288
  s_add_u32 s51, s50, 16384
L_dma_43:
  s_mov_b32 m0, s50
  s_add_u32 s50, s50, 1024
  buffer_load_dwordx4 v2, s[44:47], s49 offen nt lds
  s_add_u32 s49, s49, 8192
  s_waitcnt vmcnt(2)
  s_cmp_lt_u32 s50, s51
  s_cbranch_scc1 L_dma_43
L_dmae_44:
  s_bfe_u32 s32, s74, 0x80000
  s_bfe_u32 s33, s74, 0x80008
  s_bfe_u32 s34, s74, 0x80010
  s_bfe_u32 s35, s74, 0x80018
  s_lshl2_add_u32 s49, s8, s5
  s_lshl_b32 s49, s49, 11
  s_add_u32 s49, s49, 131072
  v_lshrrev_b32 v12, 5, v1
  v_and_b32 v16, 31, v1
  v_lshlrev_b32 v15, 16, v12
  v_lshl_add_u32 v15, v16, 4, v15
  v_add_u32 v15, s49, v15
  v_mul_u32_u24 v12, 1056, v12
  v_bfe_u32 v16, v1, 3, 2
  v_lshl_add_u32 v12, v16, 6, v12
  v_and_b32 v16, 3, v1
  v_lshl_add_u32 v12, v16, 4, v12
  v_bfe_u32 v16, v1, 2, 1
  v_lshl_add_u32 v12, v16, 3, v12
  s_lshl_b32 s49, s5, 8
  v_add_u32 v12, s49, v12
  v_and_b32 v13, 1, v1
  v_lshlrev_b32 v13, 6, v13
  v_lshrrev_b32 v3, 4, v1
  v_lshl_add_u32 v13, v3, 4, v13
  s_lshl_b32 s49, s5, 7
  s_add_u32 s49, s49, s58
  v_add_u32 v13, s49, v13
  v_bfe_u32 v3, v1, 1, 1
  v_lshl_add_u32 v13, v3, 16, v13
  v_mov_b32 v36, 0xff
  global_load_dword v11, v13, s[42:43] sc1
  s_waitcnt vmcnt(0)
  s_add_u32 s77, s77, 4
  v_mov_b32 v9, 1
  s_mov_b64 exec, 1
  ds_add_u32 v38, v9 offset:312
  s_mov_b64 exec, -1
  s_mov_b32 s70, 0
L_hy_45:
  ds_read_b32 v9, v38 offset:312
  s_waitcnt lgkmcnt(0)
  v_cmp_gt_u32 vcc, s77, v9
  s_cmp_eq_u64 vcc, 0
  s_cbranch_scc1 L_hyd_46
  s_sleep 4
  s_add_u32 s70, s70, 1
  s_cmp_lt_u32 s70, 2097152
  s_cbranch_scc1 L_hy_45
L_hyd_46:
  v_lshrrev_b32 v2, 2, v1
  v_bfe_u32 v3, v1, 1, 1
  s_lshl_b32 s49, s5, 1
  v_or_b32 v3, s49, v3
  v_and_b32 v10, 6, v2
  v_xor_b32 v3, v3, v10
  v_lshlrev_b32 v2, 7, v2
  v_lshl_add_u32 v2, v3, 4, v2
  v_and_b32 v3, 1, v1
  v_lshl_add_u32 v2, v3, 3, v2
  v_add_u32 v2, 12288, v2
  ds_read_b64_tr_b16 v[40:41], v2 offset:0
  ds_read_b64_tr_b16 v[42:43], v2 offset:2048
  ds_read_b64_tr_b16 v[44:45], v2 offset:4096
  ds_read_b64_tr_b16 v[46:47], v2 offset:6144
  ds_read_b64_tr_b16 v[48:49], v2 offset:8192
  ds_read_b64_tr_b16 v[50:51], v2 offset:10240
  ds_read_b64_tr_b16 v[52:53], v2 offset:12288
  ds_read_b64_tr_b16 v[54:55], v2 offset:14336
  ds_read_b64_tr_b16 v[56:57], v2 offset:16384
  ds_read_b64_tr_b16 v[58:59], v2 offset:18432
  ds_read_b64_tr_b16 v[60:61], v2 offset:20480
  ds_read_b64_tr_b16 v[62:63], v2 offset:22528
  s_waitcnt lgkmcnt(10)
  ds_read_b64_tr_b16 v[64:65], v2 offset:24576
  ds_read_b64_tr_b16 v[66:67], v2 offset:26624
  s_waitcnt lgkmcnt(10)
  ds_read_b64_tr_b16 v[68:69], v2 offset:28672
  ds_read_b64_tr_b16 v[70:71], v2 offset:30720
  s_waitcnt lgkmcnt(10)
  ds_read_b64_tr_b16 v[72:73], v2 offset:32768
  ds_read_b64_tr_b16 v[74:75], v2 offset:34816
  s_waitcnt lgkmcnt(10)
  ds_read_b64_tr_b16 v[76:77], v2 offset:36864
  ds_read_b64_tr_b16 v[78:79], v2 offset:38912
  s_waitcnt lgkmcnt(10)
  ds_read_b64_tr_b16 v[80:81], v2 offset:40960
  ds_read_b64_tr_b16 v[82:83], v2 offset:43008
  s_waitcnt lgkmcnt(10)
  ds_read_b64_tr_b16 v[84:85], v2 offset:45056
  ds_read_b64_tr_b16 v[86:87], v2 offset:47104
  s_waitcnt lgkmcnt(10)
  ds_read_b64_tr_b16 v[88:89], v2 offset:49152
  ds_read_b64_tr_b16 v[90:91], v2 offset:51200
  s_waitcnt lgkmcnt(10)
  ds_read_b64_tr_b16 v[92:93], v2 offset:53248
  ds_read_b64_tr_b16 v[94:95], v2 offset:55296
  s_waitcnt lgkmcnt(10)
  ds_read_b64_tr_b16 v[96:97], v2 offset:57344
  ds_read_b64_tr_b16 v[98:99], v2 offset:59392
  s_waitcnt lgkmcnt(10)
  ds_read_b64_tr_b16 v[100:101], v2 offset:61440
  ds_read_b64_tr_b16 v[102:103], v2 offset:63488
  s_waitcnt lgkmcnt(10)
  s_waitcnt lgkmcnt(0)
  s_mov_b32 s70, 0
L_pl_47:
  ds_read_b32 v8, v38 offset:256
  s_waitcnt lgkmcnt(0)
  v_cmp_eq_u32 vcc, -1, v8
  s_cmp_eq_u64 vcc, 0
  s_cbranch_scc1 L_pld_48
  s_sleep 8
  s_add_u32 s70, s70, 1
  s_cmp_lt_u32 s70, 1048576
  s_cbranch_scc1 L_pl_47
L_pld_48:
  s_mov_b64 s[20:21], -1
  s_mov_b64 s[22:23], -1
  s_mov_b64 s[24:25], -1
  s_mov_b64 exec, s[20:21]
  global_load_dwordx4 v[152:155], v15, s[42:43] offset:0 sc1
  s_mov_b64 exec, s[22:23]
  global_load_dwordx4 v[156:159], v15, s[42:43] offset:512 sc1
  s_mov_b64 exec, s[24:25]
  global_load_dwordx4 v[160:163], v15, s[42:43] offset:1024 sc1
  s_mov_b64 exec, -1
  s_waitcnt vmcnt(0)
  s_mov_b32 s70, 0
  s_branch L_wo_c
L_wo_:
  s_mov_b64 exec, s[20:21]
  global_load_dwordx4 v[152:155], v15, s[42:43] offset:0 sc1
  s_mov_b64 exec, s[22:23]
  global_load_dwordx4 v[156:159], v15, s[42:43] offset:512 sc1
  s_mov_b64 exec, s[24:25]
  global_load_dwordx4 v[160:163], v15, s[42:43] offset:1024 sc1
  s_mov_b64 exec, -1
  s_waitcnt vmcnt(0)
L_wo_c:
  v_xor_b32 v136, s32, v152
  v_xor_b32 v137, s33, v153
  v_xor_b32 v138, s34, v154
  v_xor_b32 v139, s35, v155
  v_xor_b32 v140, s32, v156
  v_xor_b32 v141, s33, v157
  v_xor_b32 v142, s34, v158
  v_xor_b32 v143, s35, v159
  v_xor_b32 v144, s32, v160
  v_xor_b32 v145, s33, v161
  v_xor_b32 v146, s34, v162
  v_xor_b32 v147, s35, v163
  v_or3_b32 v28, v136, v137, v138
  v_or3_b32 v29, v140, v141, v142
  v_or3_b32 v30, v144, v145, v146
  v_or_b32 v28, v28, v139
  v_or_b32 v29, v29, v143
  v_or_b32 v30, v30, v147
  v_cmp_ne_u32_sdwa s[20:21], v28, v38 src0_sel:BYTE_0 src1_sel:DWORD
  v_cmp_ne_u32_sdwa s[22:23], v29, v38 src0_sel:BYTE_0 src1_sel:DWORD
  v_cmp_ne_u32_sdwa s[24:25], v30, v38 src0_sel:BYTE_0 src1_sel:DWORD
  v_or_b32 v136, 0x80, v136
  v_or_b32 v137, 0x80, v137
  v_or_b32 v138, 0x80, v138
  v_or_b32 v139, 0x80, v139
  v_or_b32 v140, 0x80, v140
  v_or_b32 v141, 0x80, v141
  v_or_b32 v142, 0x80, v142
  v_or_b32 v143, 0x80, v143
  v_or_b32 v144, 0x80, v144
  v_or_b32 v145, 0x80, v145
  v_or_b32 v146, 0x80, v146
  v_or_b32 v147, 0x80, v147
  v_pk_add_f32 v[16:17], v[136:137], v[140:141]
  v_pk_add_f32 v[18:19], v[138:139], v[142:143]
  v_pk_add_f32 v[16:17], v[16:17], v[144:145]
  v_pk_add_f32 v[18:19], v[18:19], v[146:147]
  s_mov_b64 vcc, s[20:21]
  s_or_b64 vcc, vcc, s[22:23]
  s_or_b64 vcc, vcc, s[24:25]
  s_or_b32 s20, s20, 1
  s_or_b32 s22, s22, 1
  s_or_b32 s24, s24, 1
  s_cmp_eq_u64 vcc, 0
  s_cbranch_scc1 L_wo_ok
  s_add_u32 s70, s70, 1
  s_cmp_lt_u32 s70, 262144
  s_cbranch_scc1 L_wo_
L_wo_ok:
  v_cvt_pk_bf16_f32 v8, v16, v17
  v_cvt_pk_bf16_f32 v9, v18, v19
  ds_write_b64 v12, v[8:9] offset:1024
  s_add_u32 s77, s77, 4
  v_mov_b32 v3, 1
  s_mov_b64 exec, 1
  ds_add_u32 v38, v3 offset:312
  s_mov_b64 exec, -1
  s_mov_b32 s70, 0
L_hy_49:
  ds_read_b32 v3, v38 offset:312
  ds_read_b128 v[104:107], v14 offset:0
  ds_read_b128 v[108:111], v14 offset:64
  ds_read_b128 v[112:115], v14 offset:128
  ds_read_b128 v[116:119], v14 offset:192
  s_waitcnt lgkmcnt(4)
  v_cmp_gt_u32 vcc, s77, v3
  s_cmp_eq_u64 vcc, 0
  s_cbranch_scc1 L_hyd_50
  s_waitcnt lgkmcnt(0)
  s_add_u32 s70, s70, 1
  s_cmp_lt_u32 s70, 2097152
  s_cbranch_scc1 L_hy_49
L_hyd_50:
  ds_read_b128 v[120:123], v14 offset:256
  ds_read_b128 v[124:127], v14 offset:320
  ds_read_b128 v[128:131], v14 offset:384
  ds_read_b128 v[132:135], v14 offset:448
  ds_read_b128 v[136:139], v14 offset:512
  ds_read_b128 v[140:143], v14 offset:576
  ds_read_b128 v[144:147], v14 offset:640
  ds_read_b128 v[148:151], v14 offset:704
  s_waitcnt lgkmcnt(11)
  v_mfma_f32_16x16x32_bf16 v[8:11], v[40:43], v[104:107], 0
  s_waitcnt lgkmcnt(10)
  v_mfma_f32_16x16x32_bf16 v[8:11], v[44:47], v[108:111], v[8:11]
  ds_read_b128 v[104:107], v14 offset:768
  s_waitcnt lgkmcnt(10)
  v_mfma_f32_16x16x32_bf16 v[8:11], v[48:51], v[112:115], v[8:11]
  ds_read_b128 v[108:111], v14 offset:832
  s_waitcnt lgkmcnt(10)
  v_mfma_f32_16x16x32_bf16 v[8:11], v[52:55], v[116:119], v[8:11]
  ds_read_b128 v[112:115], v14 offset:896
  s_waitcnt lgkmcnt(10)
  v_mfma_f32_16x16x32_bf16 v[8:11], v[56:59], v[120:123], v[8:11]
  ds_read_b128 v[116:119], v14 offset:960
  s_waitcnt lgkmcnt(10)
  v_mfma_f32_16x16x32_bf16 v[8:11], v[60:63], v[124:127], v[8:11]
  s_waitcnt lgkmcnt(9)
  v_mfma_f32_16x16x32_bf16 v[8:11], v[64:67], v[128:131], v[8:11]
  s_waitcnt lgkmcnt(8)
  v_mfma_f32_16x16x32_bf16 v[8:11], v[68:71], v[132:135], v[8:11]
  s_waitcnt lgkmcnt(7)
  v_mfma_f32_16x16x32_bf16 v[8:11], v[72:75], v[136:139], v[8:11]
  s_waitcnt lgkmcnt(6)
  v_mfma_f32_16x16x32_bf16 v[8:11], v[76:79], v[140:143], v[8:11]
  s_waitcnt lgkmcnt(5)
  v_mfma_f32_16x16x32_bf16 v[8:11], v[80:83], v[144:147], v[8:11]
  s_waitcnt lgkmcnt(4)
  v_mfma_f32_16x16x32_bf16 v[8:11], v[84:87], v[148:151], v[8:11]
  s_waitcnt lgkmcnt(3)
  v_mfma_f32_16x16x32_bf16 v[8:11], v[88:91], v[104:107], v[8:11]
  s_waitcnt lgkmcnt(2)
  v_mfma_f32_16x16x32_bf16 v[8:11], v[92:95], v[108:111], v[8:11]
  s_waitcnt lgkmcnt(1)
  v_mfma_f32_16x16x32_bf16 v[8:11], v[96:99], v[112:115], v[8:11]
  s_waitcnt lgkmcnt(0)
  v_mfma_f32_16x16x32_bf16 v[8:11], v[100:103], v[116:119], v[8:11]
  s_nop 7
  v_bfi_b32 v8, v36, s32, v8
  v_bfi_b32 v9, v36, s33, v9
  v_bfi_b32 v10, v36, s34, v10
  v_bfi_b32 v11, v36, s35, v11
  s_mov_b32 exec_lo, 0x000f000f
  s_mov_b32 exec_hi, exec_lo
  global_store_dwordx4 v13, v[8:11], s[42:43] sc1
  v_mov_b32 v3, 1
  s_mov_b64 exec, 1
  ds_add_u32 v38, v3 offset:264
  s_mov_b64 exec, -1
  s_branch L_fin
L_r_mod:
  global_load_dwordx2 v[14:15], v37, s[34:35]
  s_mov_b32 s44, s36
  s_mov_b32 s45, s37
  s_mov_b32 s46, 3145728
  s_mov_b32 s47, 0x20000
  s_cmp_ge_u32 s60, 2
  s_cbranch_scc1 L_mod2
  s_lshl1_add_u32 s61, s8, s60
  s_lshl_b32 s48, s61, 7
  s_lshl_b32 s58, s61, 9
  s_add_u32 s58, s58, 917504
  v_lshrrev_b32 v2, 3, v1
  v_and_b32 v3, 6, v2
  v_xor_b32 v3, v3, v1
  v_mul_u32_u24 v2, 6144, v2
  v_and_b32 v3, 7, v3
  v_lshl_add_u32 v2, v3, 4, v2
  s_mul_i32 s49, s5, 786432
  s_lshl_b32 s50, s5, 14
  s_add_u32 s49, s49, s48
  s_add_u32 s50, s50, 77824
  s_add_u32 s51, s50, 16384
L_dma_51:
  s_mov_b32 m0, s50
  s_add_u32 s50, s50, 1024
  buffer_load_dwordx4 v2, s[44:47], s49 offen nt lds
  s_add_u32 s49, s49, 49152
  s_cmp_lt_u32 s50, s51
  s_cbranch_scc1 L_dma_51
L_dmae_52:
  v_mov_b32 v3, 1
  s_mov_b64 exec, 1
  ds_add_u32 v38, v3 offset:268
  s_mov_b64 exec, -1
  s_getpc_b64 s[56:57]
L_pc_53:
  s_lshr_b32 s3, s2, 5
  s_lshl3_add_u32 s3, s3, s8
  s_lshl_b32 s3, s3, 2
  s_add_u32 s3, s3, L_table-L_pc_53
  s_load_dword s14, s[56:57], s3
  s_waitcnt lgkmcnt(0)
  s_mul_i32 s74, s74, 0x9e3779b1
  s_add_u32 s74, s74, 0x7f4a7c15
  s_waitcnt vmcnt(16)
  v_lshlrev_b32 v16, 16, v14
  v_and_b32 v17, s73, v14
  v_lshlrev_b32 v18, 16, v15
  v_and_b32 v19, s73, v15
  v_mul_f32 v20, 0xbfb8aa3b, v16
  v_mul_f32 v21, 0xbfb8aa3b, v17
  v_mul_f32 v22, 0xbfb8aa3b, v18
  v_mul_f32 v23, 0xbfb8aa3b, v19
  v_exp_f32 v20, v20
  v_exp_f32 v21, v21
  v_exp_f32 v22, v22
  v_exp_f32 v23, v23
  s_nop 0
  v_add_f32 v20, 1.0, v20
  v_add_f32 v21, 1.0, v21
  v_add_f32 v22, 1.0, v22
  v_add_f32 v23, 1.0, v23
  v_rcp_f32 v20, v20
  v_rcp_f32 v21, v21
  v_rcp_f32 v22, v22
  v_rcp_f32 v23, v23
  s_nop 0
  v_mul_f32 v16, v16, v20
  v_mul_f32 v17, v17, v21
  v_mul_f32 v18, v18, v22
  v_mul_f32 v19, v19, v23
  v_cvt_pk_bf16_f32 v14, v16, v17
  v_cvt_pk_bf16_f32 v15, v18, v19
  ds_write_b64 v12, v[14:15] offset:3200
  v_and_b32 v13, 1, v1
  v_lshlrev_b32 v13, 6, v13
  v_lshrrev_b32 v3, 4, v1
  v_lshl_add_u32 v13, v3, 4, v13
  s_lshl_b32 s49, s5, 7
  s_add_u32 s49, s49, s58
  v_add_u32 v13, s49, v13
  v_bfe_u32 v3, v1, 1, 3
  v_lshl_add_u32 v13, v3, 13, v13
  v_and_b32 v14, 1, v1
  v_mul_u32_u24 v14, 1056, v14
  v_lshrrev_b32 v3, 4, v1
  v_lshl_add_u32 v14, v3, 4, v14
  v_add_u32 v14, 3200, v14
  v_lshrrev_b32 v2, 2, v1
  v_bfe_u32 v3, v1, 1, 1
  s_lshl_b32 s49, s5, 1
  v_or_b32 v3, s49, v3
  v_and_b32 v10, 6, v2
  v_xor_b32 v3, v3, v10
  v_lshlrev_b32 v2, 7, v2
  v_lshl_add_u32 v2, v3, 4, v2
  v_and_b32 v3, 1, v1
  v_lshl_add_u32 v2, v3, 3, v2
  v_add_u32 v2, 77824, v2
  s_waitcnt vmcnt(0) lgkmcnt(0)
  s_add_u32 s77, s77, 4
  v_mov_b32 v9, 1
  s_mov_b64 exec, 1
  ds_add_u32 v38, v9 offset:316
  s_mov_b64 exec, -1
  s_mov_b32 s70, 0
L_hy_54:
  ds_read_b32 v9, v38 offset:316
  s_waitcnt lgkmcnt(0)
  v_cmp_gt_u32 vcc, s77, v9
  s_cmp_eq_u64 vcc, 0
  s_cbranch_scc1 L_hyd_55
  s_add_u32 s70, s70, 1
  s_cmp_lt_u32 s70, 2097152
  s_cbranch_scc1 L_hy_54
L_hyd_55:
  ds_read_b64_tr_b16 v[40:41], v2 offset:0
  ds_read_b64_tr_b16 v[42:43], v2 offset:2048
  ds_read_b128 v[104:107], v14 offset:0
  ds_read_b64_tr_b16 v[44:45], v2 offset:4096
  ds_read_b64_tr_b16 v[46:47], v2 offset:6144
  ds_read_b128 v[108:111], v14 offset:64
  ds_read_b64_tr_b16 v[48:49], v2 offset:8192
  ds_read_b64_tr_b16 v[50:51], v2 offset:10240
  ds_read_b128 v[112:115], v14 offset:128
  ds_read_b64_tr_b16 v[52:53], v2 offset:12288
  ds_read_b64_tr_b16 v[54:55], v2 offset:14336
  ds_read_b128 v[116:119], v14 offset:192
  ds_read_b64_tr_b16 v[56:57], v2 offset:16384
  ds_read_b64_tr_b16 v[58:59], v2 offset:18432
  ds_read_b128 v[120:123], v14 offset:256
  s_waitcnt lgkmcnt(12)
  v_mfma_f32_16x16x32_bf16 v[8:11], v[40:43], v[104:107], 0
  ds_read_b64_tr_b16 v[60:61], v2 offset:20480
  ds_read_b64_tr_b16 v[62:63], v2 offset:22528
  ds_read_b128 v[124:127], v14 offset:320
  s_waitcnt lgkmcnt(12)
  v_mfma_f32_16x16x32_bf16 v[8:11], v[44:47], v[108:111], v[8:11]
  ds_read_b64_tr_b16 v[64:65], v2 offset:24576
  ds_read_b64_tr_b16 v[66:67], v2 offset:26624
  ds_read_b128 v[128:131], v14 offset:384
  s_waitcnt lgkmcnt(12)
  v_mfma_f32_16x16x32_bf16 v[8:11], v[48:51], v[112:115], v[8:11]
  ds_read_b64_tr_b16 v[68:69], v2 offset:28672
  ds_read_b64_tr_b16 v[70:71], v2 offset:30720
  ds_read_b128 v[132:135], v14 offset:448
  s_waitcnt lgkmcnt(12)
  v_mfma_f32_16x16x32_bf16 v[8:11], v[52:55], v[116:119], v[8:11]
  ds_read_b64_tr_b16 v[72:73], v2 offset:32768
  ds_read_b64_tr_b16 v[74:75], v2 offset:34816
  ds_read_b128 v[136:139], v14 offset:512
  s_waitcnt lgkmcnt(12)
  v_mfma_f32_16x16x32_bf16 v[8:11], v[56:59], v[120:123], v[8:11]
  ds_read_b64_tr_b16 v[76:77], v2 offset:36864
  ds_read_b64_tr_b16 v[78:79], v2 offset:38912
  ds_read_b128 v[140:143], v14 offset:576
  s_waitcnt lgkmcnt(12)
  v_mfma_f32_16x16x32_bf16 v[8:11], v[60:63], v[124:127], v[8:11]
  ds_read_b64_tr_b16 v[80:81], v2 offset:40960
  ds_read_b64_tr_b16 v[82:83], v2 offset:43008
  ds_read_b128 v[144:147], v14 offset:640
  s_waitcnt lgkmcnt(12)
  v_mfma_f32_16x16x32_bf16 v[8:11], v[64:67], v[128:131], v[8:11]
  ds_read_b64_tr_b16 v[84:85], v2 offset:45056
  ds_read_b64_tr_b16 v[86:87], v2 offset:47104
  ds_read_b128 v[148:151], v14 offset:704
  s_waitcnt lgkmcnt(12)
  v_mfma_f32_16x16x32_bf16 v[8:11], v[68:71], v[132:135], v[8:11]
  ds_read_b64_tr_b16 v[88:89], v2 offset:49152
  ds_read_b64_tr_b16 v[90:91], v2 offset:51200
  ds_read_b128 v[152:155], v14 offset:768
  s_waitcnt lgkmcnt(12)
  v_mfma_f32_16x16x32_bf16 v[8:11], v[72:75], v[136:139], v[8:11]
  ds_read_b64_tr_b16 v[92:93], v2 offset:53248
  ds_read_b64_tr_b16 v[94:95], v2 offset:55296
  ds_read_b128 v[156:159], v14 offset:832
  s_waitcnt lgkmcnt(12)
  v_mfma_f32_16x16x32_bf16 v[8:11], v[76:79], v[140:143], v[8:11]
  ds_read_b64_tr_b16 v[96:97], v2 offset:57344
  ds_read_b64_tr_b16 v[98:99], v2 offset:59392
  ds_read_b128 v[160:163], v14 offset:896
  s_waitcnt lgkmcnt(12)
  v_mfma_f32_16x16x32_bf16 v[8:11], v[80:83], v[144:147], v[8:11]
  ds_read_b64_tr_b16 v[100:101], v2 offset:61440
  ds_read_b64_tr_b16 v[102:103], v2 offset:63488
  ds_read_b128 v[164:167], v14 offset:960
  s_waitcnt lgkmcnt(12)
  v_mfma_f32_16x16x32_bf16 v[8:11], v[84:87], v[148:151], v[8:11]
  s_waitcnt lgkmcnt(9)
  v_mfma_f32_16x16x32_bf16 v[8:11], v[88:91], v[152:155], v[8:11]
  s_waitcnt lgkmcnt(6)
  v_mfma_f32_16x16x32_bf16 v[8:11], v[92:95], v[156:159], v[8:11]
  s_waitcnt lgkmcnt(3)
  v_mfma_f32_16x16x32_bf16 v[8:11], v[96:99], v[160:163], v[8:11]
  s_waitcnt lgkmcnt(0)
  v_mfma_f32_16x16x32_bf16 v[8:11], v[100:103], v[164:167], v[8:11]
  s_nop 7
  v_cvt_pk_bf16_f32 v8, v8, v9
  v_cvt_pk_bf16_f32 v10, v10, v11
  v_mov_b32 v9, s74
  v_mov_b32 v11, s74
  global_store_dwordx4 v13, v[8:11], s[42:43] sc1
  s_mov_b64 exec, -1
  s_add_u32 s77, s77, 4
  v_mov_b32 v9, 1
  s_mov_b64 exec, 1
  ds_add_u32 v38, v9 offset:316
  s_mov_b64 exec, -1
  s_mov_b32 s70, 0
L_hy_56:
  ds_read_b32 v9, v38 offset:316
  s_waitcnt lgkmcnt(0)
  v_cmp_gt_u32 vcc, s77, v9
  s_cmp_eq_u64 vcc, 0
  s_cbranch_scc1 L_hyd_57
  s_add_u32 s70, s70, 1
  s_cmp_lt_u32 s70, 2097152
  s_cbranch_scc1 L_hy_56
L_hyd_57:
  s_branch L_mod3
L_mod2:
  s_getpc_b64 s[56:57]
L_pc_58:
  s_lshr_b32 s3, s2, 5
  s_lshl3_add_u32 s3, s3, s8
  s_lshl_b32 s3, s3, 2
  s_add_u32 s3, s3, L_table-L_pc_58
  s_load_dword s14, s[56:57], s3
  s_waitcnt lgkmcnt(0)
  s_mul_i32 s74, s74, 0x9e3779b1
  s_add_u32 s74, s74, 0x7f4a7c15
  s_waitcnt vmcnt(0)
  v_lshlrev_b32 v16, 16, v14
  v_and_b32 v17, s73, v14
  v_lshlrev_b32 v18, 16, v15
  v_and_b32 v19, s73, v15
  v_mul_f32 v20, 0xbfb8aa3b, v16
  v_mul_f32 v21, 0xbfb8aa3b, v17
  v_mul_f32 v22, 0xbfb8aa3b, v18
  v_mul_f32 v23, 0xbfb8aa3b, v19
  v_exp_f32 v20, v20
  v_exp_f32 v21, v21
  v_exp_f32 v22, v22
  v_exp_f32 v23, v23
  s_nop 0
  v_add_f32 v20, 1.0, v20
  v_add_f32 v21, 1.0, v21
  v_add_f32 v22, 1.0, v22
  v_add_f32 v23, 1.0, v23
  v_rcp_f32 v20, v20
  v_rcp_f32 v21, v21
  v_rcp_f32 v22, v22
  v_rcp_f32 v23, v23
  s_nop 0
  v_mul_f32 v16, v16, v20
  v_mul_f32 v17, v17, v21
  v_mul_f32 v18, v18, v22
  v_mul_f32 v19, v19, v23
  v_cvt_pk_bf16_f32 v14, v16, v17
  v_cvt_pk_bf16_f32 v15, v18, v19
  ds_write_b64 v12, v[14:15] offset:3200
L_mod3:
  s_mov_b32 s70, 0
L_sn_59:
  ds_read_b32 v8, v38 offset:264
  s_waitcnt lgkmcnt(0)
  v_cmp_gt_u32 vcc, 0x4, v8
  s_cmp_eq_u64 vcc, 0
  s_cbranch_scc1 L_snd_60
  s_sleep 4
  s_add_u32 s70, s70, 1
  s_cmp_lt_u32 s70, 2097152
  s_cbranch_scc1 L_sn_59
L_snd_60:
  s_and_b32 s61, s14, 0xff
  s_cmp_ge_u32 s61, 48
  s_cbranch_scc1 L_r_f1
  s_mov_b32 s70, 0
L_sn_61:
  ds_read_b32 v8, v38 offset:312
  s_waitcnt lgkmcnt(0)
  v_cmp_gt_u32 vcc, 0x8, v8
  s_cmp_eq_u64 vcc, 0
  s_cbranch_scc1 L_snd_62
  s_sleep 4
  s_add_u32 s70, s70, 1
  s_cmp_lt_u32 s70, 2097152
  s_cbranch_scc1 L_sn_61
L_snd_62:
  s_and_b32 s61, s14, 0xff
L_mod4:
  s_cmp_ge_u32 s61, 48
  s_cbranch_scc1 L_r_f1
  s_lshl_b32 s48, s61, 7
  s_lshl_b32 s58, s61, 9
  s_add_u32 s58, s58, 4096
  v_lshrrev_b32 v2, 3, v1
  v_and_b32 v3, 6, v2
  v_xor_b32 v3, v3, v1
  v_mul_u32_u24 v2, 6144, v2
  v_and_b32 v3, 7, v3
  v_lshl_add_u32 v2, v3, 4, v2
  s_mul_i32 s49, s5, 786432
  s_lshl_b32 s50, s5, 14
  s_add_u32 s49, s49, s48
  s_add_u32 s50, s50, 77824
  s_add_u32 s51, s50, 16384
L_dma_63:
  s_mov_b32 m0, s50
  s_add_u32 s50, s50, 1024
  buffer_load_dwordx4 v2, s[44:47], s49 offen nt lds
  s_add_u32 s49, s49, 49152
  s_waitcnt vmcnt(5)
  s_cmp_lt_u32 s50, s51
  s_cbranch_scc1 L_dma_63
L_dmae_64:
  v_and_b32 v13, 1, v1
  v_lshlrev_b32 v13, 6, v13
  v_lshrrev_b32 v3, 4, v1
  v_lshl_add_u32 v13, v3, 4, v13
  s_lshl_b32 s49, s5, 7
  s_add_u32 s49, s49, s58
  v_add_u32 v13, s49, v13
  v_and_b32 v14, 1, v1
  v_mul_u32_u24 v14, 1056, v14
  v_lshrrev_b32 v3, 4, v1
  v_lshl_add_u32 v14, v3, 4, v14
  v_add_u32 v14, 3200, v14
  v_lshrrev_b32 v2, 2, v1
  v_bfe_u32 v3, v1, 1, 1
  s_lshl_b32 s49, s5, 1
  v_or_b32 v3, s49, v3
  v_and_b32 v10, 6, v2
  v_xor_b32 v3, v3, v10
  v_lshlrev_b32 v2, 7, v2
  v_lshl_add_u32 v2, v3, 4, v2
  v_and_b32 v3, 1, v1
  v_lshl_add_u32 v2, v3, 3, v2
  v_add_u32 v2, 77824, v2
  s_waitcnt vmcnt(0) lgkmcnt(0)
  s_add_u32 s77, s77, 4
  v_mov_b32 v9, 1
  s_mov_b64 exec, 1
  ds_add_u32 v38, v9 offset:316
  s_mov_b64 exec, -1
  s_mov_b32 s70, 0
L_hy_65:
  ds_read_b32 v9, v38 offset:316
  s_waitcnt lgkmcnt(0)
  v_cmp_gt_u32 vcc, s77, v9
  s_cmp_eq_u64 vcc, 0
  s_cbranch_scc1 L_hyd_66
  s_sleep 4
  s_add_u32 s70, s70, 1
  s_cmp_lt_u32 s70, 2097152
  s_cbranch_scc1 L_hy_65
L_hyd_66:
  ds_read_b64_tr_b16 v[40:41], v2 offset:0
  ds_read_b64_tr_b16 v[42:43], v2 offset:2048
  ds_read_b128 v[104:107], v14 offset:0
  ds_read_b64_tr_b16 v[44:45], v2 offset:4096
  ds_read_b64_tr_b16 v[46:47], v2 offset:6144
  ds_read_b128 v[108:111], v14 offset:64
  ds_read_b64_tr_b16 v[48:49], v2 offset:8192
  ds_read_b64_tr_b16 v[50:51], v2 offset:10240
  ds_read_b128 v[112:115], v14 offset:128
  ds_read_b64_tr_b16 v[52:53], v2 offset:12288
  ds_read_b64_tr_b16 v[54:55], v2 offset:14336
  ds_read_b128 v[116:119], v14 offset:192
  ds_read_b64_tr_b16 v[56:57], v2 offset:16384
  ds_read_b64_tr_b16 v[58:59], v2 offset:18432
  ds_read_b128 v[120:123], v14 offset:256
  s_waitcnt lgkmcnt(12)
  v_mfma_f32_16x16x32_bf16 v[8:11], v[40:43], v[104:107], 0
  ds_read_b64_tr_b16 v[60:61], v2 offset:20480
  ds_read_b64_tr_b16 v[62:63], v2 offset:22528
  ds_read_b128 v[124:127], v14 offset:320
  s_waitcnt lgkmcnt(12)
  v_mfma_f32_16x16x32_bf16 v[8:11], v[44:47], v[108:111], v[8:11]
  ds_read_b64_tr_b16 v[64:65], v2 offset:24576
  ds_read_b64_tr_b16 v[66:67], v2 offset:26624
  ds_read_b128 v[128:131], v14 offset:384
  s_waitcnt lgkmcnt(12)
  v_mfma_f32_16x16x32_bf16 v[8:11], v[48:51], v[112:115], v[8:11]
  ds_read_b64_tr_b16 v[68:69], v2 offset:28672
  ds_read_b64_tr_b16 v[70:71], v2 offset:30720
  ds_read_b128 v[132:135], v14 offset:448
  s_waitcnt lgkmcnt(12)
  v_mfma_f32_16x16x32_bf16 v[8:11], v[52:55], v[116:119], v[8:11]
  ds_read_b64_tr_b16 v[72:73], v2 offset:32768
  ds_read_b64_tr_b16 v[74:75], v2 offset:34816
  ds_read_b128 v[136:139], v14 offset:512
  s_waitcnt lgkmcnt(12)
  v_mfma_f32_16x16x32_bf16 v[8:11], v[56:59], v[120:123], v[8:11]
  ds_read_b64_tr_b16 v[76:77], v2 offset:36864
  ds_read_b64_tr_b16 v[78:79], v2 offset:38912
  ds_read_b128 v[140:143], v14 offset:576
  s_waitcnt lgkmcnt(12)
  v_mfma_f32_16x16x32_bf16 v[8:11], v[60:63], v[124:127], v[8:11]
  ds_read_b64_tr_b16 v[80:81], v2 offset:40960
  ds_read_b64_tr_b16 v[82:83], v2 offset:43008
  ds_read_b128 v[144:147], v14 offset:640
  s_waitcnt lgkmcnt(12)
  v_mfma_f32_16x16x32_bf16 v[8:11], v[64:67], v[128:131], v[8:11]
  ds_read_b64_tr_b16 v[84:85], v2 offset:45056
  ds_read_b64_tr_b16 v[86:87], v2 offset:47104
  ds_read_b128 v[148:151], v14 offset:704
  s_waitcnt lgkmcnt(12)
  v_mfma_f32_16x16x32_bf16 v[8:11], v[68:71], v[132:135], v[8:11]
  ds_read_b64_tr_b16 v[88:89], v2 offset:49152
  ds_read_b64_tr_b16 v[90:91], v2 offset:51200
  ds_read_b128 v[152:155], v14 offset:768
  s_waitcnt lgkmcnt(12)
  v_mfma_f32_16x16x32_bf16 v[8:11], v[72:75], v[136:139], v[8:11]
  ds_read_b64_tr_b16 v[92:93], v2 offset:53248
  ds_read_b64_tr_b16 v[94:95], v2 offset:55296
  ds_read_b128 v[156:159], v14 offset:832
  s_waitcnt lgkmcnt(12)
  v_mfma_f32_16x16x32_bf16 v[8:11], v[76:79], v[140:143], v[8:11]
  ds_read_b64_tr_b16 v[96:97], v2 offset:57344
  ds_read_b64_tr_b16 v[98:99], v2 offset:59392
  ds_read_b128 v[160:163], v14 offset:896
  s_waitcnt lgkmcnt(12)
  v_mfma_f32_16x16x32_bf16 v[8:11], v[80:83], v[144:147], v[8:11]
  ds_read_b64_tr_b16 v[100:101], v2 offset:61440
  ds_read_b64_tr_b16 v[102:103], v2 offset:63488
  ds_read_b128 v[164:167], v14 offset:960
  s_waitcnt lgkmcnt(12)
  v_mfma_f32_16x16x32_bf16 v[8:11], v[84:87], v[148:151], v[8:11]
  s_waitcnt lgkmcnt(9)
  v_mfma_f32_16x16x32_bf16 v[8:11], v[88:91], v[152:155], v[8:11]
  s_waitcnt lgkmcnt(6)
  v_mfma_f32_16x16x32_bf16 v[8:11], v[92:95], v[156:159], v[8:11]
  s_waitcnt lgkmcnt(3)
  v_mfma_f32_16x16x32_bf16 v[8:11], v[96:99], v[160:163], v[8:11]
  s_waitcnt lgkmcnt(0)
  v_mfma_f32_16x16x32_bf16 v[8:11], v[100:103], v[164:167], v[8:11]
  s_nop 7
  v_cvt_pk_bf16_f32 v8, v8, v9
  v_cvt_pk_bf16_f32 v10, v10, v11
  v_mov_b32 v9, s74
  v_mov_b32 v11, s74
  s_mov_b32 exec_lo, 0x00030003
  s_mov_b32 exec_hi, 0x00030003
  global_store_dwordx4 v13, v[8:11], s[42:43] sc1
  s_mov_b64 exec, -1
  s_add_u32 s77, s77, 4
  v_mov_b32 v9, 1
  s_mov_b64 exec, 1
  ds_add_u32 v38, v9 offset:316
  s_mov_b64 exec, -1
  s_mov_b32 s70, 0
L_hy_67:
  ds_read_b32 v9, v38 offset:316
  s_waitcnt lgkmcnt(0)
  v_cmp_gt_u32 vcc, s77, v9
  s_cmp_eq_u64 vcc, 0
  s_cbranch_scc1 L_hyd_68
  s_add_u32 s70, s70, 1
  s_cmp_lt_u32 s70, 2097152
  s_cbranch_scc1 L_hy_67
L_hyd_68:
  s_lshr_b32 s61, s14, 24
  s_or_b32 s14, s14, 0xff000000
  s_branch L_mod4
L_r_f1:
  s_bfe_u32 s61, s14, 0x80008
  s_cmp_ge_u32 s61, 43
  s_cbranch_scc1 L_fin
  s_lshl_b32 s48, s61, 6
  s_lshl_b32 s58, s61, 7
  s_add_u32 s58, s58, 1572864
  s_cmp_lt_u32 s5, 2
  s_cselect_b32 s44, s28, s30
  s_cselect_b32 s45, s29, s31
  s_mov_b32 s46, 1409024
  s_and_b32 s54, s61, 1
  v_lshrrev_b32 v2, 2, v1
  v_mul_u32_u24 v2, 5504, v2
  s_and_b32 s49, s5, 2
  s_or_b32 s49, s49, s54
  v_xor_b32 v3, s49, v1
  v_and_b32 v3, 3, v3
  v_lshl_add_u32 v2, v3, 4, v2
  s_and_b32 s55, s5, 1
  s_mul_i32 s49, s55, 704512
  s_add_u32 s49, s49, s48
  s_mul_i32 s50, s54, 2752
  s_add_u32 s49, s49, s50
  s_lshr_b32 s50, s5, 1
  s_lshl_b32 s50, s50, 15
  s_lshl_b32 s54, s54, 14
  s_add_u32 s50, s50, s54
  s_lshl_b32 s55, s55, 13
  s_add_u32 s50, s50, s55
  s_add_u32 s50, s50, 77824
  s_mov_b32 s70, 0
L_sn_69:
  ds_read_b32 v8, v38 offset:260
  s_waitcnt lgkmcnt(0)
  v_cmp_gt_u32 vcc, 0x1, v8
  s_cmp_eq_u64 vcc, 0
  s_cbranch_scc1 L_snd_70
  s_sleep 8
  s_add_u32 s70, s70, 1
  s_cmp_lt_u32 s70, 2097152
  s_cbranch_scc1 L_sn_69
L_snd_70:
  s_add_u32 s51, s50, 8192
L_dma_71:
  s_mov_b32 m0, s50
  s_add_u32 s50, s50, 1024
  buffer_load_dwordx4 v2, s[44:47], s49 offen  lds
  s_add_u32 s49, s49, 88064
  s_waitcnt vmcnt(3)
  s_cmp_lt_u32 s50, s51
  s_cbranch_scc1 L_dma_71
L_dmae_72:
  s_andn2_b32 s54, 1, s61
  v_lshrrev_b32 v2, 2, v1
  v_mul_u32_u24 v2, 5504, v2
  s_and_b32 s49, s5, 2
  s_or_b32 s49, s49, s54
  v_xor_b32 v3, s49, v1
  v_and_b32 v3, 3, v3
  v_lshl_add_u32 v2, v3, 4, v2
  s_and_b32 s55, s5, 1
  s_mul_i32 s49, s55, 704512
  s_add_u32 s49, s49, s48
  s_mul_i32 s50, s54, 2752
  s_add_u32 s49, s49, s50
  s_lshr_b32 s50, s5, 1
  s_lshl_b32 s50, s50, 15
  s_lshl_b32 s54, s54, 14
  s_add_u32 s50, s50, s54
  s_lshl_b32 s55, s55, 13
  s_add_u32 s50, s50, s55
  s_add_u32 s50, s50, 77824
  s_add_u32 s51, s50, 8192
L_dma_73:
  s_mov_b32 m0, s50
  s_add_u32 s50, s50, 1024
  buffer_load_dwordx4 v2, s[44:47], s49 offen nt lds
  s_add_u32 s49, s49, 88064
  s_waitcnt vmcnt(3)
  s_cmp_lt_u32 s50, s51
  s_cbranch_scc1 L_dma_73
L_dmae_74:
  v_lshlrev_b32 v15, 4, v0
  v_add_u32 v39, 16384, v15
  s_and_b32 s59, s2, 1
  s_lshl_b32 s59, s59, 16
  s_add_u32 s59, s59, 2101248
  v_add_u32 v15, s59, v15
  v_lshrrev_b32 v5, 2, v0
  v_lshlrev_b32 v5, 3, v5
  v_add_u32 v5, 9536, v5
  v_lshlrev_b32 v7, 3, v1
  v_add_u32 v7, 9536, v7
  v_and_b32 v14, 7, v1
  v_mul_u32_u24 v14, 1056, v14
  v_lshrrev_b32 v3, 4, v1
  v_lshl_add_u32 v14, v3, 4, v14
  v_bfe_u32 v6, v1, 2, 2
  v_lshl_add_u32 v6, v3, 3, v6
  v_mul_u32_u24 v6, 1056, v6
  v_and_b32 v8, 3, v1
  v_lshl_add_u32 v6, v8, 3, v6
  s_lshl_b32 s49, s5, 8
  s_add_u32 s49, s49, 77824
  v_add_u32 v6, s49, v6
  v_lshlrev_b32 v10, 3, v0
  v_add_u32 v10, 10048, v10
  v_mov_b32 v8, 0
  v_mov_b32 v9, 0
  ds_write_b64 v10, v[8:9]
  v_and_b32 v13, 1, v1
  v_lshlrev_b32 v13, 6, v13
  v_lshrrev_b32 v3, 4, v1
  v_lshl_add_u32 v13, v3, 4, v13
  s_lshl_b32 s49, s5, 17
  s_add_u32 s49, s49, s58
  v_add_u32 v13, s49, v13
  v_bfe_u32 v3, v1, 1, 3
  v_lshl_add_u32 v13, v3, 14, v13
  v_lshrrev_b32 v2, 3, v1
  v_lshlrev_b32 v2, 6, v2
  v_bfe_u32 v3, v1, 2, 1
  v_lshl_add_u32 v2, v3, 14, v2
  v_and_b32 v8, 2, v1
  v_or_b32 v3, v3, v8
  v_xor_b32 v3, s5, v3
  v_lshl_add_u32 v2, v3, 4, v2
  v_lshl_add_u32 v2, v8, 14, v2
  v_and_b32 v3, 1, v1
  v_lshl_add_u32 v2, v3, 3, v2
  v_add_u32 v2, 77824, v2
  s_waitcnt vmcnt(0)
  s_add_u32 s77, s77, 4
  v_mov_b32 v9, 1
  s_mov_b64 exec, 1
  ds_add_u32 v38, v9 offset:316
  s_mov_b64 exec, -1
  s_mov_b32 s70, 0
L_hy_75:
  ds_read_b32 v9, v38 offset:316
  s_waitcnt lgkmcnt(0)
  v_cmp_gt_u32 vcc, s77, v9
  s_cmp_eq_u64 vcc, 0
  s_cbranch_scc1 L_hyd_76
  s_sleep 4
  s_add_u32 s70, s70, 1
  s_cmp_lt_u32 s70, 2097152
  s_cbranch_scc1 L_hy_75
L_hyd_76:
  ds_read_b64_tr_b16 v[40:41], v2 offset:0
  ds_read_b64_tr_b16 v[42:43], v2 offset:512
  ds_read_b64_tr_b16 v[44:45], v2 offset:1024
  ds_read_b64_tr_b16 v[46:47], v2 offset:1536
  ds_read_b64_tr_b16 v[48:49], v2 offset:2048
  ds_read_b64_tr_b16 v[50:51], v2 offset:2560
  ds_read_b64_tr_b16 v[52:53], v2 offset:3072
  ds_read_b64_tr_b16 v[54:55], v2 offset:3584
  ds_read_b64_tr_b16 v[56:57], v2 offset:4096
  ds_read_b64_tr_b16 v[58:59], v2 offset:4608
  ds_read_b64_tr_b16 v[60:61], v2 offset:5120
  ds_read_b64_tr_b16 v[62:63], v2 offset:5632
  s_waitcnt lgkmcnt(10)
  ds_read_b64_tr_b16 v[64:65], v2 offset:6144
  ds_read_b64_tr_b16 v[66:67], v2 offset:6656
  s_waitcnt lgkmcnt(10)
  ds_read_b64_tr_b16 v[68:69], v2 offset:7168
  ds_read_b64_tr_b16 v[70:71], v2 offset:7680
  s_waitcnt lgkmcnt(10)
  ds_read_b64_tr_b16 v[72:73], v2 offset:8192
  ds_read_b64_tr_b16 v[74:75], v2 offset:8704
  s_waitcnt lgkmcnt(10)
  ds_read_b64_tr_b16 v[76:77], v2 offset:9216
  ds_read_b64_tr_b16 v[78:79], v2 offset:9728
  s_waitcnt lgkmcnt(10)
  ds_read_b64_tr_b16 v[80:81], v2 offset:10240
  ds_read_b64_tr_b16 v[82:83], v2 offset:10752
  s_waitcnt lgkmcnt(10)
  ds_read_b64_tr_b16 v[84:85], v2 offset:11264
  ds_read_b64_tr_b16 v[86:87], v2 offset:11776
  s_waitcnt lgkmcnt(10)
  ds_read_b64_tr_b16 v[88:89], v2 offset:12288
  ds_read_b64_tr_b16 v[90:91], v2 offset:12800
  s_waitcnt lgkmcnt(10)
  ds_read_b64_tr_b16 v[92:93], v2 offset:13312
  ds_read_b64_tr_b16 v[94:95], v2 offset:13824
  s_waitcnt lgkmcnt(10)
  ds_read_b64_tr_b16 v[96:97], v2 offset:14336
  ds_read_b64_tr_b16 v[98:99], v2 offset:14848
  s_waitcnt lgkmcnt(10)
  ds_read_b64_tr_b16 v[100:101], v2 offset:15360
  ds_read_b64_tr_b16 v[102:103], v2 offset:15872
  s_waitcnt lgkmcnt(10)
  s_waitcnt lgkmcnt(0)
  s_add_u32 s77, s77, 4
  v_mov_b32 v9, 1
  s_mov_b64 exec, 1
  ds_add_u32 v38, v9 offset:316
  s_mov_b64 exec, -1
  s_mov_b32 s70, 0
L_hy_77:
  ds_read_b32 v9, v38 offset:316
  s_waitcnt lgkmcnt(0)
  v_cmp_gt_u32 vcc, s77, v9
  s_cmp_eq_u64 vcc, 0
  s_cbranch_scc1 L_hyd_78
  s_add_u32 s70, s70, 1
  s_cmp_lt_u32 s70, 2097152
  s_cbranch_scc1 L_hy_77
L_hyd_78:
  s_mov_b32 s44, s32
  s_mov_b32 s45, s33
  s_mov_b32 s46, 1409024
  s_mov_b32 s47, 0x20000
  v_lshlrev_b32 v2, 4, v1
  s_lshl2_add_u32 s49, s61, s5
  s_lshl_b32 s49, s49, 13
  s_mul_i32 s50, s5, 8448
  s_add_u32 s50, s50, 77824
  s_add_u32 s51, s50, 8448
L_dma_79:
  s_mov_b32 m0, s50
  s_add_u32 s50, s50, 1056
  buffer_load_dwordx4 v2, s[44:47], s49 offen nt lds
  s_add_u32 s49, s49, 1024
  s_waitcnt vmcnt(3)
  s_cmp_lt_u32 s50, s51
  s_cbranch_scc1 L_dma_79
L_dmae_80:
  s_bfe_u32 s32, s74, 0x80000
  s_bfe_u32 s33, s74, 0x80008
  s_bfe_u32 s34, s74, 0x80010
  s_bfe_u32 s35, s74, 0x80018
  v_add_u32 v4, 16384, v15
  v_add_u32 v0, 32768, v15
  v_add_u32 v36, 49152, v15
  global_load_dwordx2 v[8:9], v37, s[16:17]
  s_mov_b32 s70, 0
L_pg_81:
  global_load_dwordx4 v[136:139], v39, s[42:43] offset:-4096 sc1
  global_load_dwordx4 v[140:143], v39, s[42:43] offset:0 sc1
  v_add_u32 v3, 4096, v39
  global_load_dwordx4 v[144:147], v3, s[42:43] sc1
  s_waitcnt vmcnt(0)
  s_mov_b64 vcc, 0
  v_cmp_ne_u32 s[68:69], s74, v137
  s_or_b64 vcc, vcc, s[68:69]
  v_cmp_ne_u32 s[68:69], s74, v139
  s_or_b64 vcc, vcc, s[68:69]
  v_cmp_ne_u32 s[68:69], s74, v141
  s_or_b64 vcc, vcc, s[68:69]
  v_cmp_ne_u32 s[68:69], s74, v143
  s_or_b64 vcc, vcc, s[68:69]
  v_cmp_ne_u32 s[68:69], s74, v145
  s_or_b64 vcc, vcc, s[68:69]
  v_cmp_ne_u32 s[68:69], s74, v147
  s_or_b64 vcc, vcc, s[68:69]
  s_cmp_eq_u64 vcc, 0
  s_cbranch_scc1 L_pge_82
  s_sleep 8
  s_add_u32 s70, s70, 1
  s_cmp_lt_u32 s70, 262144
  s_cbranch_scc1 L_pg_81
L_pge_82:
  v_and_b32 v39, 1, v1
  v_lshlrev_b32 v39, 6, v39
  v_add_u32 v39, 10944, v39
  v_lshrrev_b32 v3, 4, v1
  v_lshl_add_u32 v37, v3, 4, v39
  v_bfe_u32 v3, v1, 1, 3
  v_lshlrev_b32 v3, 7, v3
  v_sub_u32 v37, v37, v3
  v_bfe_u32 v3, v1, 4, 1
  v_lshl_add_u32 v39, v3, 3, v39
  v_lshrrev_b32 v3, 5, v1
  v_lshl_add_u32 v39, v3, 2, v39
  s_lshl_b32 s49, s5, 4
  v_add_u32 v39, s49, v39
  v_lshlrev_b32 v16, 16, v8
  v_and_b32 v17, s73, v8
  v_lshlrev_b32 v18, 16, v9
  v_and_b32 v19, s73, v9
  v_lshlrev_b32 v20, 16, v136
  v_and_b32 v21, s73, v136
  v_lshlrev_b32 v22, 16, v138
  v_and_b32 v23, s73, v138
  v_lshlrev_b32 v28, 16, v144
  v_and_b32 v29, s73, v144
  v_lshlrev_b32 v30, 16, v146
  v_and_b32 v31, s73, v146
  v_add_f32 v28, 1.0, v28
  v_add_f32 v29, 1.0, v29
  v_add_f32 v30, 1.0, v30
  v_add_f32 v31, 1.0, v31
  v_cvt_pk_bf16_f32 v8, v28, v29
  v_cvt_pk_bf16_f32 v9, v30, v31
  v_mov_b32 v141, v142
  ds_write_b64 v12, v[8:9] offset:5312
  ds_write_b64 v12, v[140:141] offset:7424
  v_cvt_pk_bf16_f32 v28, 0, v28
  v_cvt_pk_bf16_f32 v29, 0, v29
  v_cvt_pk_bf16_f32 v30, 0, v30
  v_cvt_pk_bf16_f32 v31, 0, v31
  v_mul_f32 v24, v20, v28
  v_mul_f32 v25, v21, v29
  v_mul_f32 v26, v22, v30
  v_mul_f32 v27, v23, v31
  v_mul_f32 v28, v16, v28
  v_mul_f32 v29, v17, v29
  v_mul_f32 v30, v18, v30
  v_mul_f32 v31, v19, v31
  s_waitcnt lgkmcnt(0)
  s_waitcnt vmcnt(0)
  s_mov_b32 s70, 0
L_sn_83:
  ds_read_b32 v8, v38 offset:264
  s_waitcnt lgkmcnt(0)
  v_cmp_gt_u32 vcc, 0x8, v8
  s_cmp_eq_u64 vcc, 0
  s_cbranch_scc1 L_snd_84
  s_sleep 2
  s_add_u32 s70, s70, 1
  s_cmp_lt_u32 s70, 2097152
  s_cbranch_scc1 L_sn_83
L_snd_84:
  s_mov_b32 s70, 0
  s_movk_i32 s71, 0xff
  s_mov_b32 s63, s71
  s_branch L_f1_l
L_f1_p:
  s_add_u32 s70, s70, 1
  s_cmp_ge_u32 s70, 262144
  s_cbranch_scc1 L_f1_ok
  s_mov_b32 s63, s71
L_f1_l:
  s_bitcmp1_b32 s63, 0
  s_cbranch_scc0 L_fl_85
  global_load_dwordx4 v[104:107], v15, s[42:43] offset:-4096 sc1
L_fl_85:
  s_bitcmp1_b32 s63, 1
  s_cbranch_scc0 L_fl_86
  global_load_dwordx4 v[108:111], v15, s[42:43] offset:0 sc1
L_fl_86:
  s_bitcmp1_b32 s63, 2
  s_cbranch_scc0 L_fl_87
  global_load_dwordx4 v[112:115], v4, s[42:43] offset:-4096 sc1
L_fl_87:
  s_bitcmp1_b32 s63, 3
  s_cbranch_scc0 L_fl_88
  global_load_dwordx4 v[116:119], v4, s[42:43] offset:0 sc1
L_fl_88:
  s_bitcmp1_b32 s63, 4
  s_cbranch_scc0 L_fl_89
  global_load_dwordx4 v[120:123], v0, s[42:43] offset:-4096 sc1
L_fl_89:
  s_bitcmp1_b32 s63, 5
  s_cbranch_scc0 L_fl_90
  global_load_dwordx4 v[124:127], v0, s[42:43] offset:0 sc1
L_fl_90:
  s_bitcmp1_b32 s63, 6
  s_cbranch_scc0 L_fl_91
  global_load_dwordx4 v[128:131], v36, s[42:43] offset:-4096 sc1
L_fl_91:
  s_bitcmp1_b32 s63, 7
  s_cbranch_scc0 L_fl_92
  global_load_dwordx4 v[132:135], v36, s[42:43] offset:0 sc1
L_fl_92:
  s_waitcnt vmcnt(0)
  s_bitcmp1_b32 s63, 0
  s_cbranch_scc0 L_fc_93
  v_xor_b32 v104, s32, v104
  v_xor_b32 v105, s33, v105
  v_xor_b32 v106, s34, v106
  v_xor_b32 v107, s35, v107
  v_or3_b32 v8, v104, v105, v106
  v_or_b32 v8, v8, v107
  v_cmp_ne_u32_sdwa vcc, v8, v38 src0_sel:BYTE_0 src1_sel:DWORD
  s_cmp_lg_u64 vcc, 0
  s_cbranch_scc1 L_fc_93
  s_bitset0_b32 s71, 0
L_fc_93:
  s_bitcmp1_b32 s63, 1
  s_cbranch_scc0 L_fc_94
  v_xor_b32 v108, s32, v108
  v_xor_b32 v109, s33, v109
  v_xor_b32 v110, s34, v110
  v_xor_b32 v111, s35, v111
  v_or3_b32 v8, v108, v109, v110
  v_or_b32 v8, v8, v111
  v_cmp_ne_u32_sdwa vcc, v8, v38 src0_sel:BYTE_0 src1_sel:DWORD
  s_cmp_lg_u64 vcc, 0
  s_cbranch_scc1 L_fc_94
  s_bitset0_b32 s71, 1
L_fc_94:
  s_bitcmp1_b32 s63, 2
  s_cbranch_scc0 L_fc_95
  v_xor_b32 v112, s32, v112
  v_xor_b32 v113, s33, v113
  v_xor_b32 v114, s34, v114
  v_xor_b32 v115, s35, v115
  v_or3_b32 v8, v112, v113, v114
  v_or_b32 v8, v8, v115
  v_cmp_ne_u32_sdwa vcc, v8, v38 src0_sel:BYTE_0 src1_sel:DWORD
  s_cmp_lg_u64 vcc, 0
  s_cbranch_scc1 L_fc_95
  s_bitset0_b32 s71, 2
L_fc_95:
  s_bitcmp1_b32 s63, 3
  s_cbranch_scc0 L_fc_96
  v_xor_b32 v116, s32, v116
  v_xor_b32 v117, s33, v117
  v_xor_b32 v118, s34, v118
  v_xor_b32 v119, s35, v119
  v_or3_b32 v8, v116, v117, v118
  v_or_b32 v8, v8, v119
  v_cmp_ne_u32_sdwa vcc, v8, v38 src0_sel:BYTE_0 src1_sel:DWORD
  s_cmp_lg_u64 vcc, 0
  s_cbranch_scc1 L_fc_96
  s_bitset0_b32 s71, 3
L_fc_96:
  s_bitcmp1_b32 s63, 4
  s_cbranch_scc0 L_fc_97
  v_xor_b32 v120, s32, v120
  v_xor_b32 v121, s33, v121
  v_xor_b32 v122, s34, v122
  v_xor_b32 v123, s35, v123
  v_or3_b32 v8, v120, v121, v122
  v_or_b32 v8, v8, v123
  v_cmp_ne_u32_sdwa vcc, v8, v38 src0_sel:BYTE_0 src1_sel:DWORD
  s_cmp_lg_u64 vcc, 0
  s_cbranch_scc1 L_fc_97
  s_bitset0_b32 s71, 4
L_fc_97:
  s_bitcmp1_b32 s63, 5
  s_cbranch_scc0 L_fc_98
  v_xor_b32 v124, s32, v124
  v_xor_b32 v125, s33, v125
  v_xor_b32 v126, s34, v126
  v_xor_b32 v127, s35, v127
  v_or3_b32 v8, v124, v125, v126
  v_or_b32 v8, v8, v127
  v_cmp_ne_u32_sdwa vcc, v8, v38 src0_sel:BYTE_0 src1_sel:DWORD
  s_cmp_lg_u64 vcc, 0
  s_cbranch_scc1 L_fc_98
  s_bitset0_b32 s71, 5
L_fc_98:
  s_bitcmp1_b32 s63, 6
  s_cbranch_scc0 L_fc_99
  v_xor_b32 v128, s32, v128
  v_xor_b32 v129, s33, v129
  v_xor_b32 v130, s34, v130
  v_xor_b32 v131, s35, v131
  v_or3_b32 v8, v128, v129, v130
  v_or_b32 v8, v8, v131
  v_cmp_ne_u32_sdwa vcc, v8, v38 src0_sel:BYTE_0 src1_sel:DWORD
  s_cmp_lg_u64 vcc, 0
  s_cbranch_scc1 L_fc_99
  s_bitset0_b32 s71, 6
L_fc_99:
  s_bitcmp1_b32 s63, 7
  s_cbranch_scc0 L_fc_100
  v_xor_b32 v132, s32, v132
  v_xor_b32 v133, s33, v133
  v_xor_b32 v134, s34, v134
  v_xor_b32 v135, s35, v135
  v_or3_b32 v8, v132, v133, v134
  v_or_b32 v8, v8, v135
  v_cmp_ne_u32_sdwa vcc, v8, v38 src0_sel:BYTE_0 src1_sel:DWORD
  s_cmp_lg_u64 vcc, 0
  s_cbranch_scc1 L_fc_100
  s_bitset0_b32 s71, 7
L_fc_100:
  s_cmp_lg_u32 s71, 0
  s_cbranch_scc1 L_f1_p
L_f1_ok:
  v_pk_add_f32 v[136:137], v[104:105], v[108:109]
  v_pk_add_f32 v[138:139], v[106:107], v[110:111]
  v_pk_add_f32 v[144:145], v[112:113], v[116:117]
  v_pk_add_f32 v[146:147], v[114:115], v[118:119]
  v_pk_add_f32 v[152:153], v[120:121], v[124:125]
  v_pk_add_f32 v[154:155], v[122:123], v[126:127]
  v_pk_add_f32 v[160:161], v[128:129], v[132:133]
  v_pk_add_f32 v[162:163], v[130:131], v[134:135]
  v_pk_add_f32 v[136:137], v[136:137], v[144:145]
  v_pk_add_f32 v[138:139], v[138:139], v[146:147]
  v_pk_add_f32 v[152:153], v[152:153], v[160:161]
  v_pk_add_f32 v[154:155], v[154:155], v[162:163]
  v_pk_add_f32 v[136:137], v[136:137], v[152:153]
  v_pk_add_f32 v[138:139], v[138:139], v[154:155]
  v_pk_fma_f32 v[8:9], v[136:137], v[24:25], v[28:29]
  v_pk_fma_f32 v[10:11], v[138:139], v[26:27], v[30:31]
  v_cvt_pk_bf16_f32 v8, v8, v9
  v_cvt_pk_bf16_f32 v9, v10, v11
  ds_write_b64 v12, v[8:9] offset:3200
  v_pk_fma_f32 v[16:17], v[136:137], v[20:21], v[16:17]
  v_pk_fma_f32 v[18:19], v[138:139], v[22:23], v[18:19]
  v_add_f32 v24, v16, v17
  v_mul_f32 v25, v16, v16
  v_add_f32 v26, v18, v19
  v_mul_f32 v27, v18, v18
  v_fmac_f32 v25, v17, v17
  v_fmac_f32 v27, v19, v19
  v_pk_add_f32 v[24:25], v[24:25], v[26:27]
  s_nop 1
  v_add_f32_dpp v24, v24, v24 quad_perm:[1,0,3,2] row_mask:0xf bank_mask:0xf
  v_add_f32_dpp v25, v25, v25 quad_perm:[1,0,3,2] row_mask:0xf bank_mask:0xf
  s_nop 0
  v_add_f32_dpp v24, v24, v24 quad_perm:[2,3,0,1] row_mask:0xf bank_mask:0xf
  v_add_f32_dpp v25, v25, v25 quad_perm:[2,3,0,1] row_mask:0xf bank_mask:0xf
  ds_write_b64 v5, v[24:25]
  s_add_u32 s77, s77, 4
  v_mov_b32 v10, 1
  s_mov_b64 exec, 1
  ds_add_u32 v38, v10 offset:316
  s_mov_b64 exec, -1
  s_mov_b32 s70, 0
L_hy_101:
  ds_read_b32 v10, v38 offset:316
  ds_read_b128 v[136:139], v14 offset:3200
  ds_read_b128 v[140:143], v14 offset:3264
  ds_read_b128 v[144:147], v14 offset:3328
  ds_read_b128 v[148:151], v14 offset:3392
  s_waitcnt lgkmcnt(4)
  v_cmp_gt_u32 vcc, s77, v10
  s_cmp_eq_u64 vcc, 0
  s_cbranch_scc1 L_hyd_102
  s_waitcnt lgkmcnt(0)
  s_add_u32 s70, s70, 1
  s_cmp_lt_u32 s70, 2097152
  s_cbranch_scc1 L_hy_101
L_hyd_102:
  ds_read_b64 v[20:21], v7
  ds_read_b128 v[152:155], v14 offset:3456
  ds_read_b128 v[156:159], v14 offset:3520
  ds_read_b128 v[160:163], v14 offset:3584
  ds_read_b128 v[164:167], v14 offset:3648
  s_waitcnt lgkmcnt(8)
  v_mfma_f32_16x16x32_bf16 v[32:35], v[40:43], v[136:139], 0
  s_waitcnt lgkmcnt(7)
  v_mfma_f32_16x16x32_bf16 v[32:35], v[44:47], v[140:143], v[32:35]
  ds_read_b128 v[136:139], v14 offset:3712
  s_waitcnt lgkmcnt(7)
  v_mfma_f32_16x16x32_bf16 v[32:35], v[48:51], v[144:147], v[32:35]
  ds_read_b128 v[140:143], v14 offset:3776
  s_waitcnt lgkmcnt(7)
  v_mfma_f32_16x16x32_bf16 v[32:35], v[52:55], v[148:151], v[32:35]
  ds_read_b128 v[144:147], v14 offset:3840
  s_waitcnt lgkmcnt(6)
  v_mfma_f32_16x16x32_bf16 v[32:35], v[56:59], v[152:155], v[32:35]
  ds_read_b128 v[148:151], v14 offset:3904
  v_add_f32_dpp v20, v20, v20 quad_perm:[2,3,0,1] row_mask:0xf bank_mask:0xf
  v_add_f32_dpp v21, v21, v21 quad_perm:[2,3,0,1] row_mask:0xf bank_mask:0xf
  s_waitcnt lgkmcnt(6)
  v_mfma_f32_16x16x32_bf16 v[32:35], v[60:63], v[156:159], v[32:35]
  ds_read_b128 v[152:155], v14 offset:3968
  v_add_f32_dpp v20, v20, v20 row_ror:4 row_mask:0xf bank_mask:0xf
  v_add_f32_dpp v21, v21, v21 row_ror:4 row_mask:0xf bank_mask:0xf
  s_waitcnt lgkmcnt(6)
  v_mfma_f32_16x16x32_bf16 v[32:35], v[64:67], v[160:163], v[32:35]
  ds_read_b128 v[156:159], v14 offset:4032
  v_add_f32_dpp v20, v20, v20 row_ror:8 row_mask:0xf bank_mask:0xf
  v_add_f32_dpp v21, v21, v21 row_ror:8 row_mask:0xf bank_mask:0xf
  s_waitcnt lgkmcnt(6)
  v_mfma_f32_16x16x32_bf16 v[32:35], v[68:71], v[164:167], v[32:35]
  ds_read_b128 v[160:163], v14 offset:4096
  v_mov_b32 v22, v20
  v_mov_b32 v23, v21
  s_waitcnt lgkmcnt(6)
  v_mfma_f32_16x16x32_bf16 v[32:35], v[72:75], v[136:139], v[32:35]
  ds_read_b128 v[164:167], v14 offset:4160
  v_permlane16_swap_b32 v22, v20
  v_permlane16_swap_b32 v23, v21
  s_waitcnt lgkmcnt(6)
  v_mfma_f32_16x16x32_bf16 v[32:35], v[76:79], v[140:143], v[32:35]
  v_pk_add_f32 v[20:21], v[20:21], v[22:23]
  v_mov_b32 v22, v20
  v_mov_b32 v23, v21
  s_waitcnt lgkmcnt(5)
  v_mfma_f32_16x16x32_bf16 v[32:35], v[80:83], v[144:147], v[32:35]
  v_permlane32_swap_b32 v22, v20
  v_permlane32_swap_b32 v23, v21
  s_waitcnt lgkmcnt(4)
  v_mfma_f32_16x16x32_bf16 v[32:35], v[84:87], v[148:151], v[32:35]
  v_pk_add_f32 v[20:21], v[20:21], v[22:23]
  v_mul_f32 v20, 0xbb000000, v20
  s_waitcnt lgkmcnt(3)
  v_mfma_f32_16x16x32_bf16 v[32:35], v[88:91], v[152:155], v[32:35]
  v_mul_f32 v21, 0x3b000000, v21
  v_fma_f32 v21, -v20, v20, v21
  s_waitcnt lgkmcnt(2)
  v_mfma_f32_16x16x32_bf16 v[32:35], v[92:95], v[156:159], v[32:35]
  v_max_f32 v21, 0, v21
  v_add_f32 v21, 0x3727c5ac, v21
  s_waitcnt lgkmcnt(1)
  v_mfma_f32_16x16x32_bf16 v[32:35], v[96:99], v[160:163], v[32:35]
  v_rsq_f32 v21, v21
  s_waitcnt lgkmcnt(0)
  v_mfma_f32_16x16x32_bf16 v[32:35], v[100:103], v[164:167], v[32:35]
  ds_read_b64_tr_b16 v[40:41], v6 offset:0
  ds_read_b64_tr_b16 v[42:43], v6 offset:4224
  ds_read_b64_tr_b16 v[44:45], v6 offset:32
  ds_read_b64_tr_b16 v[46:47], v6 offset:4256
  ds_read_b64_tr_b16 v[48:49], v6 offset:64
  ds_read_b64_tr_b16 v[50:51], v6 offset:4288
  ds_read_b64_tr_b16 v[52:53], v6 offset:96
  ds_read_b64_tr_b16 v[54:55], v6 offset:4320
  v_fmac_f32_dpp v32, v32, v20 row_shl:2 row_mask:0xf bank_mask:0x1
  v_fmac_f32_dpp v33, v33, v20 row_shl:2 row_mask:0xf bank_mask:0x1
  v_fmac_f32_dpp v34, v34, v20 row_shl:2 row_mask:0xf bank_mask:0x1
  v_fmac_f32_dpp v35, v35, v20 row_shl:2 row_mask:0xf bank_mask:0x1
  v_mul_f32 v8, v32, v21
  v_mul_f32 v9, v33, v21
  v_mul_f32 v10, v34, v21
  v_mul_f32 v11, v35, v21
  v_add_f32_dpp v8, v32, v8 row_shl:4 row_mask:0xf bank_mask:0xf
  v_add_f32_dpp v9, v33, v9 row_shl:4 row_mask:0xf bank_mask:0xf
  v_add_f32_dpp v10, v34, v10 row_shl:4 row_mask:0xf bank_mask:0xf
  v_add_f32_dpp v11, v35, v11 row_shl:4 row_mask:0xf bank_mask:0xf
  s_waitcnt lgkmcnt(4)
  ds_read_b64_tr_b16 v[56:57], v6 offset:128
  ds_read_b64_tr_b16 v[58:59], v6 offset:4352
  ds_read_b64_tr_b16 v[60:61], v6 offset:160
  ds_read_b64_tr_b16 v[62:63], v6 offset:4384
  ds_read_b64_tr_b16 v[64:65], v6 offset:192
  ds_read_b64_tr_b16 v[66:67], v6 offset:4416
  ds_read_b64_tr_b16 v[68:69], v6 offset:224
  ds_read_b64_tr_b16 v[70:71], v6 offset:4448
  v_permlane32_swap_b32 v8, v10
  v_permlane32_swap_b32 v9, v11
  v_mul_f32 v20, 0xbfb8aa3b, v8
  v_mul_f32 v21, 0xbfb8aa3b, v9
  v_exp_f32 v20, v20
  v_exp_f32 v21, v21
  v_mul_f32 v8, v8, v10
  v_mul_f32 v9, v9, v11
  v_add_f32 v20, 1.0, v20
  v_add_f32 v21, 1.0, v21
  v_rcp_f32 v20, v20
  v_rcp_f32 v21, v21
  s_mov_b32 exec_lo, 0x00030003
  s_mov_b32 exec_hi, 0x00030003
  v_mul_f32 v8, v8, v20
  v_mul_f32 v9, v9, v21
  v_cvt_pk_bf16_f32 v8, v8, v9
  ds_write_b32 v39, v8
  s_mov_b64 exec, -1
  s_waitcnt lgkmcnt(4)
  s_add_u32 s77, s77, 4
  v_mov_b32 v10, 1
  s_mov_b64 exec, 1
  ds_add_u32 v38, v10 offset:316
  s_mov_b64 exec, -1
  s_mov_b32 s70, 0
L_hy_103:
  ds_read_b32 v10, v38 offset:316
  ds_read_b128 v[136:139], v37 offset:0
  ds_read_b128 v[140:143], v37 offset:128
  ds_read_b128 v[144:147], v37 offset:256
  ds_read_b128 v[148:151], v37 offset:384
  s_waitcnt lgkmcnt(4)
  v_cmp_gt_u32 vcc, s77, v10
  s_cmp_eq_u64 vcc, 0
  s_cbranch_scc1 L_hyd_104
  s_waitcnt lgkmcnt(0)
  s_add_u32 s70, s70, 1
  s_cmp_lt_u32 s70, 2097152
  s_cbranch_scc1 L_hy_103
L_hyd_104:
  ds_read_b128 v[152:155], v37 offset:512
  ds_read_b128 v[156:159], v37 offset:640
  ds_read_b128 v[160:163], v37 offset:768
  ds_read_b128 v[164:167], v37 offset:896
  v_mov_b32 v3, 0xff
  s_waitcnt lgkmcnt(7)
  v_mfma_f32_16x16x32_bf16 v[8:11], v[40:43], v[136:139], 0
  s_waitcnt lgkmcnt(6)
  v_mfma_f32_16x16x32_bf16 v[8:11], v[44:47], v[140:143], v[8:11]
  s_waitcnt lgkmcnt(5)
  v_mfma_f32_16x16x32_bf16 v[8:11], v[48:51], v[144:147], v[8:11]
  s_waitcnt lgkmcnt(4)
  v_mfma_f32_16x16x32_bf16 v[8:11], v[52:55], v[148:151], v[8:11]
  s_waitcnt lgkmcnt(3)
  v_mfma_f32_16x16x32_bf16 v[8:11], v[56:59], v[152:155], v[8:11]
  s_waitcnt lgkmcnt(2)
  v_mfma_f32_16x16x32_bf16 v[8:11], v[60:63], v[156:159], v[8:11]
  s_waitcnt lgkmcnt(1)
  v_mfma_f32_16x16x32_bf16 v[8:11], v[64:67], v[160:163], v[8:11]
  s_waitcnt lgkmcnt(0)
  v_mfma_f32_16x16x32_bf16 v[8:11], v[68:71], v[164:167], v[8:11]
  s_nop 7
  v_bfi_b32 v8, v3, s32, v8
  v_bfi_b32 v9, v3, s33, v9
  v_bfi_b32 v10, v3, s34, v10
  v_bfi_b32 v11, v3, s35, v11
  global_store_dwordx4 v13, v[8:11], s[42:43] sc1
  s_branch L_fin
L_r_f2:
  v_bfe_u32 v12, v1, 2, 1
  v_and_b32 v14, 3, v1
  s_lshl_b32 s49, s61, 5
  v_lshl_add_u32 v3, v14, 3, s49
  v_lshl_add_u32 v37, v12, 10, v3
  v_and_b32 v15, 7, v1
  s_lshl_b32 s49, s61, 7
  v_lshl_add_u32 v15, v15, 4, s49
  v_add_u32 v39, 16384, v15
  v_bfe_u32 v3, v1, 3, 1
  v_lshl_add_u32 v15, v3, 12, v15
  v_lshrrev_b32 v3, 4, v1
  v_lshl_add_u32 v15, v3, 14, v15
  s_and_b32 s59, s2, 1
  s_lshl_b32 s59, s59, 16
  s_add_u32 s59, s59, 2097152
  v_add_u32 v15, s59, v15
  s_lshl_b32 s49, s61, 14
  s_add_u32 s49, s49, 1574912
  v_lshl_add_u32 v36, v1, 4, s49
  global_load_dword v11, v37, s[38:39]
  s_lshl_b32 s49, s61, 14
  s_add_u32 s49, s49, 1572864
  v_min_u32 v10, 42, v1
  v_lshl_add_u32 v10, v10, 7, s49
  global_load_dword v11, v10, s[42:43] sc1
  s_lshl_b32 s49, s61, 7
  s_add_u32 s49, s49, 28672
  v_mov_b32 v10, s49
  global_load_dword v11, v10, s[42:43] sc1
  global_load_dwordx2 v[8:9], v37, s[16:17]
  s_mov_b32 s70, 0
L_pg_105:
  global_load_dwordx4 v[136:139], v39, s[42:43] offset:-4096 sc1
  v_add_u32 v3, 8192, v39
  global_load_dwordx4 v[140:143], v3, s[42:43] sc1
  s_waitcnt vmcnt(0)
  s_mov_b64 vcc, 0
  v_cmp_ne_u32 s[68:69], s74, v137
  s_or_b64 vcc, vcc, s[68:69]
  v_cmp_ne_u32 s[68:69], s74, v139
  s_or_b64 vcc, vcc, s[68:69]
  v_cmp_ne_u32 s[68:69], s74, v141
  s_or_b64 vcc, vcc, s[68:69]
  v_cmp_ne_u32 s[68:69], s74, v143
  s_or_b64 vcc, vcc, s[68:69]
  s_cmp_eq_u64 vcc, 0
  s_cbranch_scc1 L_pge_106
  s_sleep 8
  s_add_u32 s70, s70, 1
  s_cmp_lt_u32 s70, 262144
  s_cbranch_scc1 L_pg_105
L_pge_106:
  v_lshlrev_b32 v16, 16, v8
  v_and_b32 v17, s73, v8
  v_lshlrev_b32 v18, 16, v9
  v_and_b32 v19, s73, v9
  v_lshlrev_b32 v20, 16, v136
  v_and_b32 v21, s73, v136
  v_lshlrev_b32 v22, 16, v138
  v_and_b32 v23, s73, v138
  v_lshlrev_b32 v24, 16, v140
  v_and_b32 v25, s73, v140
  v_lshlrev_b32 v26, 16, v142
  v_and_b32 v27, s73, v142
  s_mov_b32 s70, 0
L_sn_107:
  ds_read_b32 v8, v38 offset:264
  s_waitcnt lgkmcnt(0)
  v_cmp_gt_u32 vcc, 0x8, v8
  s_cmp_eq_u64 vcc, 0
  s_cbranch_scc1 L_snd_108
  s_sleep 2
  s_add_u32 s70, s70, 1
  s_cmp_lt_u32 s70, 2097152
  s_cbranch_scc1 L_sn_107
L_snd_108:
  s_mov_b32 s70, 0
L_f2_a:
  global_load_dwordx4 v[136:139], v15, s[42:43] sc1
  s_waitcnt vmcnt(0)
  v_xor_b32 v136, s32, v136
  v_xor_b32 v137, s33, v137
  v_xor_b32 v138, s34, v138
  v_xor_b32 v139, s35, v139
  v_or3_b32 v3, v136, v137, v138
  v_or_b32 v3, v3, v139
  v_lshlrev_b32 v3, 24, v3
  v_cmp_ne_u32 vcc, 0, v3
  s_cmp_eq_u64 vcc, 0
  s_cbranch_scc1 L_f2_ad
  s_sleep 4
  s_add_u32 s70, s70, 1
  s_cmp_lt_u32 s70, 262144
  s_cbranch_scc1 L_f2_a
L_f2_ad:
  s_cmp_lg_u32 s61, 0
  s_cbranch_scc1 L_f2_e
  v_mov_b32 v10, s74
  s_mov_b64 exec, 1
  global_store_dword v38, v10, s[42:43] offset:0 sc1
  s_mov_b64 exec, -1
L_f2_e:
  s_nop 1
  v_add_f32_dpp v136, v136, v136 row_ror:8 row_mask:0xf bank_mask:0xf
  v_add_f32_dpp v137, v137, v137 row_ror:8 row_mask:0xf bank_mask:0xf
  v_add_f32_dpp v138, v138, v138 row_ror:8 row_mask:0xf bank_mask:0xf
  v_add_f32_dpp v139, v139, v139 row_ror:8 row_mask:0xf bank_mask:0xf
  v_mov_b32 v140, v136
  v_mov_b32 v141, v137
  v_mov_b32 v142, v138
  v_mov_b32 v143, v139
  v_permlane16_swap_b32 v140, v136
  v_permlane16_swap_b32 v141, v137
  v_permlane16_swap_b32 v142, v138
  v_permlane16_swap_b32 v143, v139
  v_add_f32 v136, v136, v140
  v_add_f32 v137, v137, v141
  v_add_f32 v138, v138, v142
  v_add_f32 v139, v139, v143
  v_mov_b32 v140, v136
  v_mov_b32 v141, v137
  v_mov_b32 v142, v138
  v_mov_b32 v143, v139
  v_permlane32_swap_b32 v140, v136
  v_permlane32_swap_b32 v141, v137
  v_permlane32_swap_b32 v142, v138
  v_permlane32_swap_b32 v143, v139
  v_add_f32 v136, v136, v140
  v_add_f32 v137, v137, v141
  v_add_f32 v138, v138, v142
  v_add_f32 v139, v139, v143
  v_cvt_pk_bf16_f32 v136, 0, v136
  v_cvt_pk_bf16_f32 v137, 0, v137
  v_cvt_pk_bf16_f32 v138, 0, v138
  v_cvt_pk_bf16_f32 v139, 0, v139
  v_mul_f32 v136, v136, v20
  v_mul_f32 v137, v137, v21
  v_mul_f32 v138, v138, v22
  v_mul_f32 v139, v139, v23
  v_cvt_pk_bf16_f32 v136, 0, v136
  v_cvt_pk_bf16_f32 v137, 0, v137
  v_cvt_pk_bf16_f32 v138, 0, v138
  v_cvt_pk_bf16_f32 v139, 0, v139
  v_add_f32 v16, v16, v136
  v_add_f32 v17, v17, v137
  v_add_f32 v18, v18, v138
  v_add_f32 v19, v19, v139
  v_cvt_pk_bf16_f32 v16, 0, v16
  v_cvt_pk_bf16_f32 v17, 0, v17
  v_cvt_pk_bf16_f32 v18, 0, v18
  v_cvt_pk_bf16_f32 v19, 0, v19
  v_mov_b32 v156, s32
  v_mov_b32 v157, s33
  v_mov_b32 v158, s34
  v_mov_b32 v159, s35
  s_mov_b64 s[20:21], -1
  s_mov_b64 s[22:23], -1
  s_mov_b64 s[24:25], -1
  s_mov_b64 s[26:27], -1
  s_mov_b64 s[28:29], -1
  s_mov_b64 s[30:31], 0xffffff
  s_mov_b64 exec, s[20:21]
  global_load_dwordx4 v[136:139], v36, s[42:43] offset:-2048 sc1
  s_mov_b64 exec, s[22:23]
  global_load_dwordx4 v[140:143], v36, s[42:43] offset:-1024 sc1
  s_mov_b64 exec, s[24:25]
  global_load_dwordx4 v[144:147], v36, s[42:43] offset:0 sc1
  s_mov_b64 exec, s[26:27]
  global_load_dwordx4 v[148:151], v36, s[42:43] offset:1024 sc1
  s_mov_b64 exec, s[28:29]
  global_load_dwordx4 v[152:155], v36, s[42:43] offset:2048 sc1
  s_mov_b64 exec, s[30:31]
  global_load_dwordx4 v[156:159], v36, s[42:43] offset:3072 sc1
  s_mov_b64 exec, -1
  s_waitcnt vmcnt(0)
  s_mov_b32 s70, 0
  s_branch L_f2_pc
L_f2_p:
  s_mov_b64 exec, s[20:21]
  global_load_dwordx4 v[136:139], v36, s[42:43] offset:-2048 sc1
  s_mov_b64 exec, s[22:23]
  global_load_dwordx4 v[140:143], v36, s[42:43] offset:-1024 sc1
  s_mov_b64 exec, s[24:25]
  global_load_dwordx4 v[144:147], v36, s[42:43] offset:0 sc1
  s_mov_b64 exec, s[26:27]
  global_load_dwordx4 v[148:151], v36, s[42:43] offset:1024 sc1
  s_mov_b64 exec, s[28:29]
  global_load_dwordx4 v[152:155], v36, s[42:43] offset:2048 sc1
  s_mov_b64 exec, s[30:31]
  global_load_dwordx4 v[156:159], v36, s[42:43] offset:3072 sc1
  s_mov_b64 exec, -1
  s_waitcnt vmcnt(0)
L_f2_pc:
  v_xor_b32 v104, s32, v136
  v_xor_b32 v105, s33, v137
  v_xor_b32 v106, s34, v138
  v_xor_b32 v107, s35, v139
  v_xor_b32 v108, s32, v140
  v_xor_b32 v109, s33, v141
  v_xor_b32 v110, s34, v142
  v_xor_b32 v111, s35, v143
  v_xor_b32 v112, s32, v144
  v_xor_b32 v113, s33, v145
  v_xor_b32 v114, s34, v146
  v_xor_b32 v115, s35, v147
  v_xor_b32 v116, s32, v148
  v_xor_b32 v117, s33, v149
  v_xor_b32 v118, s34, v150
  v_xor_b32 v119, s35, v151
  v_xor_b32 v120, s32, v152
  v_xor_b32 v121, s33, v153
  v_xor_b32 v122, s34, v154
  v_xor_b32 v123, s35, v155
  v_xor_b32 v124, s32, v156
  v_xor_b32 v125, s33, v157
  v_xor_b32 v126, s34, v158
  v_xor_b32 v127, s35, v159
  v_or3_b32 v28, v104, v105, v106
  v_or3_b32 v29, v108, v109, v110
  v_or3_b32 v30, v112, v113, v114
  v_or3_b32 v31, v116, v117, v118
  v_or3_b32 v32, v120, v121, v122
  v_or3_b32 v33, v124, v125, v126
  v_or_b32 v28, v28, v107
  v_or_b32 v29, v29, v111
  v_or_b32 v30, v30, v115
  v_or_b32 v31, v31, v119
  v_or_b32 v32, v32, v123
  v_or_b32 v33, v33, v127
  v_cmp_ne_u32_sdwa s[20:21], v28, v38 src0_sel:BYTE_0 src1_sel:DWORD
  v_cmp_ne_u32_sdwa s[22:23], v29, v38 src0_sel:BYTE_0 src1_sel:DWORD
  v_cmp_ne_u32_sdwa s[24:25], v30, v38 src0_sel:BYTE_0 src1_sel:DWORD
  v_cmp_ne_u32_sdwa s[26:27], v31, v38 src0_sel:BYTE_0 src1_sel:DWORD
  v_cmp_ne_u32_sdwa s[28:29], v32, v38 src0_sel:BYTE_0 src1_sel:DWORD
  v_cmp_ne_u32_sdwa s[30:31], v33, v38 src0_sel:BYTE_0 src1_sel:DWORD
  v_pk_add_f32 v[104:105], v[104:105], v[108:109]
  v_pk_add_f32 v[106:107], v[106:107], v[110:111]
  v_pk_add_f32 v[112:113], v[112:113], v[116:117]
  v_pk_add_f32 v[114:115], v[114:115], v[118:119]
  v_pk_add_f32 v[120:121], v[120:121], v[124:125]
  v_pk_add_f32 v[122:123], v[122:123], v[126:127]
  v_pk_add_f32 v[104:105], v[104:105], v[112:113]
  v_pk_add_f32 v[106:107], v[106:107], v[114:115]
  v_pk_add_f32 v[104:105], v[104:105], v[120:121]
  v_pk_add_f32 v[106:107], v[106:107], v[122:123]
  s_mov_b64 vcc, s[20:21]
  s_or_b64 vcc, vcc, s[22:23]
  s_or_b64 vcc, vcc, s[24:25]
  s_or_b64 vcc, vcc, s[26:27]
  s_or_b64 vcc, vcc, s[28:29]
  s_or_b64 vcc, vcc, s[30:31]
  s_or_b32 s20, s20, 1
  s_or_b32 s22, s22, 1
  s_or_b32 s24, s24, 1
  s_or_b32 s26, s26, 1
  s_or_b32 s28, s28, 1
  s_or_b32 s30, s30, 1
  s_cmp_eq_u64 vcc, 0
  s_cbranch_scc1 L_f2_pok
  s_add_u32 s70, s70, 1
  s_cmp_lt_u32 s70, 262144
  s_cbranch_scc1 L_f2_p
L_f2_pok:
  s_nop 1
  v_add_f32_dpp v104, v104, v104 row_ror:8 row_mask:0xf bank_mask:0xf
  v_add_f32_dpp v105, v105, v105 row_ror:8 row_mask:0xf bank_mask:0xf
  v_add_f32_dpp v106, v106, v106 row_ror:8 row_mask:0xf bank_mask:0xf
  v_add_f32_dpp v107, v107, v107 row_ror:8 row_mask:0xf bank_mask:0xf
  v_mov_b32 v108, v104
  v_mov_b32 v109, v105
  v_mov_b32 v110, v106
  v_mov_b32 v111, v107
  v_permlane16_swap_b32 v108, v104
  v_permlane16_swap_b32 v109, v105
  v_permlane16_swap_b32 v110, v106
  v_permlane16_swap_b32 v111, v107
  v_add_f32 v104, v104, v108
  v_add_f32 v105, v105, v109
  v_add_f32 v106, v106, v110
  v_add_f32 v107, v107, v111
  v_mov_b32 v108, v104
  v_mov_b32 v109, v105
  v_mov_b32 v110, v106
  v_mov_b32 v111, v107
  v_permlane32_swap_b32 v108, v104
  v_permlane32_swap_b32 v109, v105
  v_permlane32_swap_b32 v110, v106
  v_permlane32_swap_b32 v111, v107
  v_add_f32 v104, v104, v108
  v_add_f32 v105, v105, v109
  v_add_f32 v106, v106, v110
  v_add_f32 v107, v107, v111
  v_cvt_pk_bf16_f32 v104, 0, v104
  v_cvt_pk_bf16_f32 v105, 0, v105
  v_cvt_pk_bf16_f32 v106, 0, v106
  v_cvt_pk_bf16_f32 v107, 0, v107
  v_mul_f32 v104, v104, v24
  v_mul_f32 v105, v105, v25
  v_mul_f32 v106, v106, v26
  v_mul_f32 v107, v107, v27
  v_cvt_pk_bf16_f32 v104, 0, v104
  v_cvt_pk_bf16_f32 v105, 0, v105
  v_cvt_pk_bf16_f32 v106, 0, v106
  v_cvt_pk_bf16_f32 v107, 0, v107
  v_add_f32 v8, v104, v16
  v_add_f32 v9, v105, v17
  v_add_f32 v10, v106, v18
  v_add_f32 v11, v107, v19
  v_cvt_pk_bf16_f32 v8, v8, v9
  v_cvt_pk_bf16_f32 v9, v10, v11
  s_mov_b64 exec, 0xff
  global_store_dwordx2 v37, v[8:9], s[38:39] sc1
  s_mov_b64 exec, 1
  v_mov_b32 v10, s74
  s_lshl_b32 s49, s61, 7
  s_add_u32 s49, s49, 28672
  v_mov_b32 v11, s49
  global_store_dword v11, v10, s[42:43] sc1
L_fin:
L_end:
  s_endpgm
.p2align 7
L_table:
  .long 0xff00ff13, 0x1504ff14, 0xff08ff1b, 0x1d0cff1c, 0xff10ff23, 0xff14ff24, 0xff18ff2b, 0x2d1cff2c
  .long 0xff01ff10, 0x1705ff16, 0xff09ff18, 0x1f0dff1e, 0xff11ff20, 0xff15ff25, 0xff19ff28, 0x2f1dff2e
  .long 0x1202ff11, 0xff0605ff, 0x1a0aff19, 0xff0e10ff, 0x2212ff21, 0x2716ff26, 0x2a1aff29, 0xff1e25ff
  .long 0xffff00ff, 0xffff06ff, 0xffff0bff, 0xffff11ff, 0xffff16ff, 0xffff1bff, 0xffff20ff, 0xffff26ff
  .long 0xffff01ff, 0xffff07ff, 0xffff0cff, 0xffff12ff, 0xffff17ff, 0xffff1cff, 0xffff21ff, 0xffff27ff
  .long 0xffff02ff, 0xffff08ff, 0xffff0dff, 0xffff13ff, 0xffff18ff, 0xffff1dff, 0xffff22ff, 0xffff28ff
  .long 0xffff03ff, 0xffff09ff, 0xffff0eff, 0xffff14ff, 0xffff19ff, 0xffff1eff, 0xffff23ff, 0xffff29ff
  .long 0xff0304ff, 0xff070aff, 0xff0b0fff, 0xff0f15ff, 0xff131aff, 0xff171fff, 0xff1b24ff, 0xff1f2aff
L_touch:
  .long 0x80804101, 0x80804909, 0x80804303, 0x80808080, 0x80804b0b, 0x80804505, 0x80804d0d, 0x80808080
  .long 0x80804707, 0x80804f0f, 0x80805900, 0x80808080, 0x80805b08, 0x80805d02, 0x80805f0a, 0x80808080
  .long 0x80805804, 0x80805a0c, 0x80805c06, 0x80808080, 0x80805e0e, 0x80805140, 0x80806148, 0x80808080
  .long 0x80806942, 0x8080714a, 0x80807944, 0x80808080, 0x8080534c, 0x80806346, 0x80806b4e, 0x80808080
.section .rodata,"a"
.p2align 6
.amdhsa_kernel adaLN_cond__sliding_block_cached__glu_gated_swiglu__decode_kernel
  .amdhsa_next_free_vgpr 168
  .amdhsa_next_free_sgpr 102
  .amdhsa_accum_offset 168
  .amdhsa_group_segment_fixed_size 0
  .amdhsa_kernarg_size 112
  .amdhsa_user_sgpr_count 2
  .amdhsa_user_sgpr_kernarg_segment_ptr 1
  .amdhsa_system_sgpr_workgroup_id_x 1
.end_amdhsa_kernel
```

```asm
; @launch grid=(256,1,1) block=(768,1,1) lds=143360
.amdgcn_target "amdgcn-amd-amdhsa--gfx950"
.text
.globl adaLN_cond__sliding_block_cached__glu_gated_swiglu__decode_kernel
.p2align 8
.type adaLN_cond__sliding_block_cached__glu_gated_swiglu__decode_kernel,@function
adaLN_cond__sliding_block_cached__glu_gated_swiglu__decode_kernel:
  s_cmp_ge_u32 s2, 256
  s_cbranch_scc1 L_end
  s_load_dwordx16 s[16:31], s[0:1], 0
  s_load_dwordx8 s[32:39], s[0:1], 64
  s_load_dwordx4 s[40:43], s[0:1], 96
  v_lshrrev_b32 v2, 6, v0
  v_and_b32 v1, 63, v0
  v_readfirstlane_b32 s13, v2
  s_bfe_u32 s7, s2, 0x20003
  s_bfe_u32 s6, s2, 0x20005
  s_and_b32 s8, s2, 7
  s_lshl2_add_u32 s6, s8, s6
  s_and_b32 s9, s2, 0x80
  s_lshr_b32 s9, s9, 2
  s_add_u32 s6, s6, s9
  s_mov_b32 s72, 0xfffffffe
  s_mov_b32 s73, 0xffff0000
  s_cmp_eq_u32 s7, 3
  s_cbranch_scc1 L_serv
  s_cmp_eq_u32 s13, 0
  s_cbranch_scc1 L_pub
L_stream:
  s_sub_u32 s9, s13, 1
  s_lshl_b32 s11, s9, 10
  s_mul_i32 s4, s7, 349184
  s_lshl_b32 s10, s6, 22
  s_add_u32 s10, s10, s4
  s_add_u32 s10, s10, 0x300000
  v_and_b32 v0, 15, v1
  v_lshl_add_u32 v0, v0, 6, s11
  v_and_b32 v3, 48, v1
  v_add_u32 v0, v3, v0
  s_lshr_b32 s12, s2, 3
  s_mul_i32 s12, s12, 5
  s_mul_i32 s15, s8, 3
  s_add_u32 s12, s12, s15
  s_and_b32 s15, s12, 31
  s_min_u32 s15, s15, 30
  s_mul_i32 s12, s15, 11264
  s_lshr_b32 s46, s7, 1
  s_lshl_b32 s46, s46, 10
  s_add_u32 s46, s46, 349184
  s_mov_b32 s47, 0x20000
  s_mov_b32 s14, 349184
  s_waitcnt lgkmcnt(0)
  s_add_u32 s44, s18, s10
  s_addc_u32 s45, s19, 0
  buffer_load_dwordx4 v[44:47], v0, s[44:47], s12 offen nt
  s_add_u32 s12, s12, 11264
  s_cmp_eq_u32 s12, s14
  s_cselect_b32 s12, 0, s12
  buffer_load_dwordx4 v[48:51], v0, s[44:47], s12 offen nt
  s_add_u32 s12, s12, 11264
  s_cmp_eq_u32 s12, s14
  s_cselect_b32 s12, 0, s12
  buffer_load_dwordx4 v[52:55], v0, s[44:47], s12 offen nt
  s_add_u32 s12, s12, 11264
  s_cmp_eq_u32 s12, s14
  s_cselect_b32 s12, 0, s12
  buffer_load_dwordx4 v[40:43], v0, s[44:47], s14 offen nt
  s_add_u32 s48, s20, s10
  s_addc_u32 s49, s21, 0
  s_mov_b32 s50, s46
  s_mov_b32 s51, 0x20000
  s_mov_b32 s52, 0xcccccccc
  s_mov_b32 s53, 0xcccccccc
  s_mov_b32 s54, 0xaaaaaaaa
  s_mov_b32 s55, 0xaaaaaaaa
  v_and_b32 v38, 15, v1
  v_lshlrev_b32 v38, 4, v38
  s_lshl_b32 s10, s9, 11
  s_add_u32 s10, s10, 12288
  v_lshl_add_u32 v3, v1, 3, s10
  v_mov_b32 v4, 0x7fff0000
  v_mov_b32 v5, 0xff800000
  ds_write_b64 v3, v[4:5] offset:0
  ds_write_b64 v3, v[4:5] offset:512
  ds_write_b64 v3, v[4:5] offset:1024
  v_lshrrev_b32 v3, 4, v1
  v_lshl_add_u32 v39, v38, 1, s10
  v_lshl_add_u32 v39, v3, 3, v39
  s_sub_u32 s68, s15, 1
  v_bfrev_b32 v4, v1
  v_lshrrev_b32 v4, 28, v4
  v_lshl_add_u32 v3, v3, 8, s11
  v_cmp_eq_u32 s[70:71], 0, v4
  v_add_u32 v24, s68, v4
  v_subrev_u32 v5, 31, v24
  v_min_u32 v24, v5, v24
  v_cndmask_b32 v24, v24, 31, s[70:71]
  v_mul_u32_u24 v24, 11264, v24
  v_add_u32 v24, v3, v24
  v_add_u32 v26, s68, v4
  v_add_u32 v26, 16, v26
  v_subrev_u32 v5, 31, v26
  v_min_u32 v26, v5, v26
  v_mul_u32_u24 v26, 11264, v26
  v_add_u32 v26, v3, v26
  s_lshl_b32 s11, s9, 9
  s_sub_u32 s11, s11, s10
  s_mov_b32 s32, 4
  s_mul_i32 s33, s9, 0x60000000
  s_add_u32 s33, s33, 0x10000000
  s_mov_b64 s[64:65], 0
  s_mov_b64 s[66:67], 0
  s_mov_b32 s38, 0
  s_mov_b32 s39, 2
  s_mov_b32 s75, 0
  s_mov_b32 s61, 0
  v_and_b32 v3, 1, v1
  v_lshlrev_b32 v3, 4, v3
  v_mov_b32 v20, 0xffff
  v_lshlrev_b32 v3, v3, v20
  v_bfe_u32 v20, v1, 1, 3
  v_cmp_eq_u32 vcc, 0, v20
  s_nop 1
  v_cndmask_b32 v34, 0, v3, vcc
  v_cmp_eq_u32 vcc, 1, v20
  s_nop 1
  v_cndmask_b32 v35, 0, v3, vcc
  v_cmp_eq_u32 vcc, 2, v20
  s_nop 1
  v_cndmask_b32 v36, 0, v3, vcc
  s_barrier
  s_waitcnt lgkmcnt(0)
  s_mov_b32 s56, s10
  s_mov_b32 s41, 5
  s_mov_b32 s57, 0
  s_mov_b32 s76, 20480
  s_mov_b32 s34, 174694
  s_mov_b32 s77, 0
  s_mov_b32 s35, 28
  s_mov_b32 s59, 0
  v_mov_b32 v22, 1332
  v_mov_b32 v23, 0
  v_mov_b32 v2, 0
  s_call_b64 s[62:63], L_kq
  buffer_load_dwordx4 v[56:59], v0, s[44:47], s12 offen nt
  s_add_u32 s12, s12, 11264
  s_cmp_eq_u32 s12, s14
  s_cselect_b32 s12, 0, s12
  s_call_b64 s[62:63], L_kq
  buffer_load_dwordx4 v[60:63], v0, s[44:47], s12 offen nt
  s_add_u32 s12, s12, 11264
  s_cmp_eq_u32 s12, s14
  s_cselect_b32 s12, 0, s12
  s_call_b64 s[62:63], L_kq
  buffer_load_dwordx4 v[64:67], v0, s[44:47], s12 offen nt
  s_add_u32 s12, s12, 11264
  s_cmp_eq_u32 s12, s14
  s_cselect_b32 s12, 0, s12
  s_call_b64 s[62:63], L_kq
  buffer_load_dwordx4 v[68:71], v0, s[44:47], s12 offen nt
  s_add_u32 s12, s12, 11264
  s_cmp_eq_u32 s12, s14
  s_cselect_b32 s12, 0, s12
  s_call_b64 s[62:63], L_kq
  buffer_load_dwordx4 v[72:75], v0, s[44:47], s12 offen nt
  s_add_u32 s12, s12, 11264
  s_cmp_eq_u32 s12, s14
  s_cselect_b32 s12, 0, s12
  s_call_b64 s[62:63], L_kq
  buffer_load_dwordx4 v[76:79], v0, s[44:47], s12 offen nt
  s_add_u32 s12, s12, 11264
  s_cmp_eq_u32 s12, s14
  s_cselect_b32 s12, 0, s12
  s_call_b64 s[62:63], L_kq
  buffer_load_dwordx4 v[80:83], v0, s[44:47], s12 offen nt
  s_add_u32 s12, s12, 11264
  s_cmp_eq_u32 s12, s14
  s_cselect_b32 s12, 0, s12
  s_call_b64 s[62:63], L_kq
  buffer_load_dwordx4 v[84:87], v0, s[44:47], s12 offen nt
  s_add_u32 s12, s12, 11264
  s_cmp_eq_u32 s12, s14
  s_cselect_b32 s12, 0, s12
  s_call_b64 s[62:63], L_kq
  buffer_load_dwordx4 v[88:91], v0, s[44:47], s12 offen nt
  s_add_u32 s12, s12, 11264
  s_cmp_eq_u32 s12, s14
  s_cselect_b32 s12, 0, s12
  s_call_b64 s[62:63], L_kq
  buffer_load_dwordx4 v[92:95], v0, s[44:47], s12 offen nt
  s_add_u32 s12, s12, 11264
  s_cmp_eq_u32 s12, s14
  s_cselect_b32 s12, 0, s12
  s_call_b64 s[62:63], L_kq
  buffer_load_dwordx4 v[96:99], v0, s[44:47], s12 offen nt
  s_add_u32 s12, s12, 11264
  s_cmp_eq_u32 s12, s14
  s_cselect_b32 s12, 0, s12
  s_call_b64 s[62:63], L_ks
  buffer_load_dwordx4 v[100:103], v0, s[44:47], s12 offen nt
  s_add_u32 s12, s12, 11264
  s_cmp_eq_u32 s12, s14
  s_cselect_b32 s12, 0, s12
  s_call_b64 s[62:63], L_ks
  buffer_load_dwordx4 v[104:107], v0, s[44:47], s12 offen nt
  s_add_u32 s12, s12, 11264
  s_cmp_eq_u32 s12, s14
  s_cselect_b32 s12, 0, s12
  s_call_b64 s[62:63], L_ks
  buffer_load_dwordx4 v[108:111], v0, s[44:47], s12 offen nt
  s_add_u32 s12, s12, 11264
  s_cmp_eq_u32 s12, s14
  s_cselect_b32 s12, 0, s12
  s_call_b64 s[62:63], L_ks
  buffer_load_dwordx4 v[112:115], v0, s[44:47], s12 offen nt
  s_add_u32 s12, s12, 11264
  s_cmp_eq_u32 s12, s14
  s_cselect_b32 s12, 0, s12
  s_call_b64 s[62:63], L_ks
  buffer_load_dwordx4 v[116:119], v0, s[44:47], s12 offen nt
  s_add_u32 s12, s12, 11264
  s_cmp_eq_u32 s12, s14
  s_cselect_b32 s12, 0, s12
  s_call_b64 s[62:63], L_ks
  buffer_load_dwordx4 v[120:123], v0, s[44:47], s12 offen nt
  s_add_u32 s12, s12, 11264
  s_cmp_eq_u32 s12, s14
  s_cselect_b32 s12, 0, s12
  s_call_b64 s[62:63], L_ks
  buffer_load_dwordx4 v[124:127], v0, s[44:47], s12 offen nt
  s_add_u32 s12, s12, 11264
  s_cmp_eq_u32 s12, s14
  s_cselect_b32 s12, 0, s12
  s_call_b64 s[62:63], L_ks
  buffer_load_dwordx4 v[128:131], v0, s[44:47], s12 offen nt
  s_add_u32 s12, s12, 11264
  s_cmp_eq_u32 s12, s14
  s_cselect_b32 s12, 0, s12
  s_call_b64 s[62:63], L_ks
  buffer_load_dwordx4 v[132:135], v0, s[44:47], s12 offen nt
  s_add_u32 s12, s12, 11264
  s_cmp_eq_u32 s12, s14
  s_cselect_b32 s12, 0, s12
  s_call_b64 s[62:63], L_ks
  buffer_load_dwordx4 v[136:139], v0, s[44:47], s12 offen nt
  s_add_u32 s12, s12, 11264
  s_cmp_eq_u32 s12, s14
  s_cselect_b32 s12, 0, s12
  s_call_b64 s[62:63], L_ks
  buffer_load_dwordx4 v[140:143], v0, s[44:47], s12 offen nt
  s_add_u32 s12, s12, 11264
  s_cmp_eq_u32 s12, s14
  s_cselect_b32 s12, 0, s12
  s_call_b64 s[62:63], L_ks
  buffer_load_dwordx4 v[144:147], v0, s[44:47], s12 offen nt
  s_add_u32 s12, s12, 11264
  s_cmp_eq_u32 s12, s14
  s_cselect_b32 s12, 0, s12
  s_call_b64 s[62:63], L_ks
  buffer_load_dwordx4 v[148:151], v0, s[44:47], s12 offen nt
  s_add_u32 s12, s12, 11264
  s_cmp_eq_u32 s12, s14
  s_cselect_b32 s12, 0, s12
  s_call_b64 s[62:63], L_ks
  buffer_load_dwordx4 v[152:155], v0, s[44:47], s12 offen nt
  s_add_u32 s12, s12, 11264
  s_cmp_eq_u32 s12, s14
  s_cselect_b32 s12, 0, s12
  s_call_b64 s[62:63], L_ks
  buffer_load_dwordx4 v[156:159], v0, s[44:47], s12 offen nt
  s_add_u32 s12, s12, 11264
  s_cmp_eq_u32 s12, s14
  s_cselect_b32 s12, 0, s12
  s_call_b64 s[62:63], L_ks
  buffer_load_dwordx4 v[160:163], v0, s[44:47], s12 offen nt
  s_add_u32 s12, s12, 11264
  s_cmp_eq_u32 s12, s14
  s_cselect_b32 s12, 0, s12
  s_call_b64 s[62:63], L_ks
  buffer_load_dwordx4 v[164:167], v0, s[44:47], s12 offen nt
  s_add_u32 s12, s12, 11264
  s_cmp_eq_u32 s12, s14
  s_cselect_b32 s12, 0, s12
  s_mov_b32 s10, 0
L_kw:
  s_cmp_ge_u32 s39, 6
  s_cbranch_scc1 L_v0
  s_call_b64 s[100:101], L_work
  s_sleep 1
  s_add_u32 s10, s10, 1
  s_cmp_lt_u32 s10, 262144
  s_cbranch_scc1 L_kw
L_v0:
  s_mov_b32 s32, 0
  v_mov_b32 v2, 8
  s_mov_b32 s35, s59
  ds_read_b64 v[22:23], v2 offset:288
  v_mov_b32_dpp v0, v36 row_shr:2 row_mask:0xf bank_mask:0xf bound_ctrl:0
  s_mov_b32 s77, 61
  s_mov_b32 s76, 12288
  s_mov_b32 s34, 164659
  s_waitcnt lgkmcnt(0)
  s_call_b64 s[62:63], L_vs
  v_add_u32_dpp v3, v28, v38 row_newbcast:0 row_mask:0xf bank_mask:0xf
  buffer_load_dwordx4 v[40:43], v3, s[48:51], 0 offen nt
  s_mov_b64 vcc, s[54:55]
  v_mfma_f32_16x16x32_bf16 v[8:11], v[136:139], v[4:7], 0
  v_mfma_f32_16x16x32_bf16 v[136:139], v[140:143], v[4:7], 0
  v_mfma_f32_16x16x32_bf16 v[140:143], v[144:147], v[4:7], 0
  v_mfma_f32_16x16x32_bf16 v[144:147], v[148:151], v[4:7], 0
  s_nop 4
  v_cndmask_b32_dpp v12, v8, v9, vcc quad_perm:[0,1,2,3] row_mask:0xf bank_mask:0x1
  v_cndmask_b32_dpp v13, v10, v11, vcc quad_perm:[0,1,2,3] row_mask:0xf bank_mask:0x1
  v_cndmask_b32_dpp v12, v136, v137, vcc quad_perm:[0,1,2,3] row_mask:0xf bank_mask:0x4
  v_cndmask_b32_dpp v13, v138, v139, vcc quad_perm:[0,1,2,3] row_mask:0xf bank_mask:0x4
  v_cndmask_b32_dpp v12, v140, v141, vcc quad_perm:[0,1,2,3] row_mask:0xf bank_mask:0x2
  v_cndmask_b32_dpp v13, v142, v143, vcc quad_perm:[0,1,2,3] row_mask:0xf bank_mask:0x2
  v_cndmask_b32_dpp v12, v144, v145, vcc quad_perm:[0,1,2,3] row_mask:0xf bank_mask:0x8
  v_cndmask_b32_dpp v13, v146, v147, vcc quad_perm:[0,1,2,3] row_mask:0xf bank_mask:0x8
  v_cndmask_b32 v18, v12, v13, s[52:53]
  s_call_b64 s[62:63], L_vs
  s_cbranch_scc0 L_dr5
  v_add_u32_dpp v3, v28, v38 row_newbcast:1 row_mask:0xf bank_mask:0xf
  buffer_load_dwordx4 v[44:47], v3, s[48:51], 0 offen nt
  s_call_b64 s[62:63], L_vs
  s_cbranch_scc0 L_dr5
  v_add_u32_dpp v3, v28, v38 row_newbcast:2 row_mask:0xf bank_mask:0xf
  buffer_load_dwordx4 v[48:51], v3, s[48:51], 0 offen nt
  s_call_b64 s[62:63], L_vs
  s_cbranch_scc0 L_dr5
  v_add_u32_dpp v3, v28, v38 row_newbcast:3 row_mask:0xf bank_mask:0xf
  buffer_load_dwordx4 v[52:55], v3, s[48:51], 0 offen nt
  s_call_b64 s[62:63], L_vs
  s_cbranch_scc0 L_dr5
  v_add_u32_dpp v3, v28, v38 row_newbcast:4 row_mask:0xf bank_mask:0xf
  buffer_load_dwordx4 v[56:59], v3, s[48:51], 0 offen nt
  s_call_b64 s[62:63], L_vs
  s_cbranch_scc0 L_dr5
  v_add_u32_dpp v3, v28, v38 row_newbcast:5 row_mask:0xf bank_mask:0xf
  buffer_load_dwordx4 v[60:63], v3, s[48:51], 0 offen nt
  v_and_b32_dpp v12, v29, v34 row_newbcast:0 row_mask:0xf bank_mask:0xf
  v_and_b32_dpp v13, v29, v35 row_newbcast:0 row_mask:0xf bank_mask:0xf
  v_and_b32_dpp v14, v29, v36 row_newbcast:0 row_mask:0xf bank_mask:0xf
  v_and_b32_dpp v15, v29, v0 row_newbcast:0 row_mask:0xf bank_mask:0xf
  s_nop 1
  v_mfma_f32_16x16x32_bf16 v[8:11], v[12:15], v[40:43], v[8:11]
  s_call_b64 s[62:63], L_vs
  s_cbranch_scc0 L_dr6
  v_add_u32_dpp v3, v28, v38 row_newbcast:6 row_mask:0xf bank_mask:0xf
  buffer_load_dwordx4 v[64:67], v3, s[48:51], 0 offen nt
  v_and_b32_dpp v12, v29, v34 row_newbcast:1 row_mask:0xf bank_mask:0xf
  v_and_b32_dpp v13, v29, v35 row_newbcast:1 row_mask:0xf bank_mask:0xf
  v_and_b32_dpp v14, v29, v36 row_newbcast:1 row_mask:0xf bank_mask:0xf
  v_and_b32_dpp v15, v29, v0 row_newbcast:1 row_mask:0xf bank_mask:0xf
  s_nop 1
  v_mfma_f32_16x16x32_bf16 v[8:11], v[12:15], v[44:47], v[8:11]
  s_call_b64 s[62:63], L_vs
  s_cbranch_scc0 L_dr7
  v_add_u32_dpp v3, v28, v38 row_newbcast:7 row_mask:0xf bank_mask:0xf
  buffer_load_dwordx4 v[68:71], v3, s[48:51], 0 offen nt
  v_and_b32_dpp v12, v29, v34 row_newbcast:2 row_mask:0xf bank_mask:0xf
  v_and_b32_dpp v13, v29, v35 row_newbcast:2 row_mask:0xf bank_mask:0xf
  v_and_b32_dpp v14, v29, v36 row_newbcast:2 row_mask:0xf bank_mask:0xf
  v_and_b32_dpp v15, v29, v0 row_newbcast:2 row_mask:0xf bank_mask:0xf
  s_nop 1
  v_mfma_f32_16x16x32_bf16 v[8:11], v[12:15], v[48:51], v[8:11]
  s_call_b64 s[62:63], L_vs
  s_cbranch_scc0 L_dr8
  v_add_u32_dpp v3, v28, v38 row_newbcast:8 row_mask:0xf bank_mask:0xf
  buffer_load_dwordx4 v[72:75], v3, s[48:51], 0 offen nt
  v_and_b32_dpp v12, v29, v34 row_newbcast:3 row_mask:0xf bank_mask:0xf
  v_and_b32_dpp v13, v29, v35 row_newbcast:3 row_mask:0xf bank_mask:0xf
  v_and_b32_dpp v14, v29, v36 row_newbcast:3 row_mask:0xf bank_mask:0xf
  v_and_b32_dpp v15, v29, v0 row_newbcast:3 row_mask:0xf bank_mask:0xf
  s_nop 1
  v_mfma_f32_16x16x32_bf16 v[8:11], v[12:15], v[52:55], v[8:11]
  s_call_b64 s[62:63], L_vs
  s_cbranch_scc0 L_dr9
  v_add_u32_dpp v3, v28, v38 row_newbcast:9 row_mask:0xf bank_mask:0xf
  buffer_load_dwordx4 v[76:79], v3, s[48:51], 0 offen nt
  v_and_b32_dpp v12, v29, v34 row_newbcast:4 row_mask:0xf bank_mask:0xf
  v_and_b32_dpp v13, v29, v35 row_newbcast:4 row_mask:0xf bank_mask:0xf
  v_and_b32_dpp v14, v29, v36 row_newbcast:4 row_mask:0xf bank_mask:0xf
  v_and_b32_dpp v15, v29, v0 row_newbcast:4 row_mask:0xf bank_mask:0xf
  s_nop 1
  v_mfma_f32_16x16x32_bf16 v[8:11], v[12:15], v[56:59], v[8:11]
  s_call_b64 s[62:63], L_vs
  s_cbranch_scc0 L_dr10
  v_add_u32_dpp v3, v28, v38 row_newbcast:10 row_mask:0xf bank_mask:0xf
  buffer_load_dwordx4 v[80:83], v3, s[48:51], 0 offen nt
  v_and_b32_dpp v12, v29, v34 row_newbcast:5 row_mask:0xf bank_mask:0xf
  v_and_b32_dpp v13, v29, v35 row_newbcast:5 row_mask:0xf bank_mask:0xf
  v_and_b32_dpp v14, v29, v36 row_newbcast:5 row_mask:0xf bank_mask:0xf
  v_and_b32_dpp v15, v29, v0 row_newbcast:5 row_mask:0xf bank_mask:0xf
  s_nop 1
  v_mfma_f32_16x16x32_bf16 v[8:11], v[12:15], v[60:63], v[8:11]
  s_call_b64 s[62:63], L_vq
  s_cbranch_scc0 L_dr11
  v_add_u32_dpp v3, v28, v38 row_newbcast:11 row_mask:0xf bank_mask:0xf
  buffer_load_dwordx4 v[84:87], v3, s[48:51], 0 offen nt
  v_and_b32_dpp v12, v29, v34 row_newbcast:6 row_mask:0xf bank_mask:0xf
  v_and_b32_dpp v13, v29, v35 row_newbcast:6 row_mask:0xf bank_mask:0xf
  v_and_b32_dpp v14, v29, v36 row_newbcast:6 row_mask:0xf bank_mask:0xf
  v_and_b32_dpp v15, v29, v0 row_newbcast:6 row_mask:0xf bank_mask:0xf
  s_nop 1
  v_mfma_f32_16x16x32_bf16 v[8:11], v[12:15], v[64:67], v[8:11]
  s_call_b64 s[62:63], L_vq
  s_cbranch_scc0 L_dr12
  v_add_u32_dpp v3, v28, v38 row_newbcast:12 row_mask:0xf bank_mask:0xf
  buffer_load_dwordx4 v[88:91], v3, s[48:51], 0 offen nt
  v_and_b32_dpp v12, v29, v34 row_newbcast:7 row_mask:0xf bank_mask:0xf
  v_and_b32_dpp v13, v29, v35 row_newbcast:7 row_mask:0xf bank_mask:0xf
  v_and_b32_dpp v14, v29, v36 row_newbcast:7 row_mask:0xf bank_mask:0xf
  v_and_b32_dpp v15, v29, v0 row_newbcast:7 row_mask:0xf bank_mask:0xf
  s_nop 1
  v_mfma_f32_16x16x32_bf16 v[8:11], v[12:15], v[68:71], v[8:11]
  s_call_b64 s[62:63], L_vq
  s_cbranch_scc0 L_dr13
  v_add_u32_dpp v3, v28, v38 row_newbcast:13 row_mask:0xf bank_mask:0xf
  buffer_load_dwordx4 v[92:95], v3, s[48:51], 0 offen nt
  v_and_b32_dpp v12, v29, v34 row_newbcast:8 row_mask:0xf bank_mask:0xf
  v_and_b32_dpp v13, v29, v35 row_newbcast:8 row_mask:0xf bank_mask:0xf
  v_and_b32_dpp v14, v29, v36 row_newbcast:8 row_mask:0xf bank_mask:0xf
  v_and_b32_dpp v15, v29, v0 row_newbcast:8 row_mask:0xf bank_mask:0xf
  s_nop 1
  v_mfma_f32_16x16x32_bf16 v[8:11], v[12:15], v[72:75], v[8:11]
  s_call_b64 s[62:63], L_vq
  s_cbranch_scc0 L_dr14
  v_add_u32_dpp v3, v28, v38 row_newbcast:14 row_mask:0xf bank_mask:0xf
  buffer_load_dwordx4 v[96:99], v3, s[48:51], 0 offen nt
  v_and_b32_dpp v12, v29, v34 row_newbcast:9 row_mask:0xf bank_mask:0xf
  v_and_b32_dpp v13, v29, v35 row_newbcast:9 row_mask:0xf bank_mask:0xf
  v_and_b32_dpp v14, v29, v36 row_newbcast:9 row_mask:0xf bank_mask:0xf
  v_and_b32_dpp v15, v29, v0 row_newbcast:9 row_mask:0xf bank_mask:0xf
  s_nop 1
  v_mfma_f32_16x16x32_bf16 v[8:11], v[12:15], v[76:79], v[8:11]
  s_call_b64 s[62:63], L_vq
  s_cbranch_scc0 L_dr15
  v_add_u32_dpp v3, v28, v38 row_newbcast:15 row_mask:0xf bank_mask:0xf
  buffer_load_dwordx4 v[100:103], v3, s[48:51], 0 offen nt
  v_and_b32_dpp v12, v29, v34 row_newbcast:10 row_mask:0xf bank_mask:0xf
  v_and_b32_dpp v13, v29, v35 row_newbcast:10 row_mask:0xf bank_mask:0xf
  v_and_b32_dpp v14, v29, v36 row_newbcast:10 row_mask:0xf bank_mask:0xf
  v_and_b32_dpp v15, v29, v0 row_newbcast:10 row_mask:0xf bank_mask:0xf
  s_nop 1
  v_mfma_f32_16x16x32_bf16 v[8:11], v[12:15], v[80:83], v[8:11]
  s_call_b64 s[62:63], L_vq
  s_cbranch_scc0 L_dr16
  v_add_u32_dpp v3, v30, v38 row_newbcast:0 row_mask:0xf bank_mask:0xf
  buffer_load_dwordx4 v[104:107], v3, s[48:51], 0 offen nt
  v_and_b32_dpp v12, v29, v34 row_newbcast:11 row_mask:0xf bank_mask:0xf
  v_and_b32_dpp v13, v29, v35 row_newbcast:11 row_mask:0xf bank_mask:0xf
  v_and_b32_dpp v14, v29, v36 row_newbcast:11 row_mask:0xf bank_mask:0xf
  v_and_b32_dpp v15, v29, v0 row_newbcast:11 row_mask:0xf bank_mask:0xf
  s_nop 1
  v_mfma_f32_16x16x32_bf16 v[8:11], v[12:15], v[84:87], v[8:11]
  s_call_b64 s[62:63], L_vq
  s_cbranch_scc0 L_dr17
  v_add_u32_dpp v3, v30, v38 row_newbcast:1 row_mask:0xf bank_mask:0xf
  buffer_load_dwordx4 v[108:111], v3, s[48:51], 0 offen nt
  v_and_b32_dpp v12, v29, v34 row_newbcast:12 row_mask:0xf bank_mask:0xf
  v_and_b32_dpp v13, v29, v35 row_newbcast:12 row_mask:0xf bank_mask:0xf
  v_and_b32_dpp v14, v29, v36 row_newbcast:12 row_mask:0xf bank_mask:0xf
  v_and_b32_dpp v15, v29, v0 row_newbcast:12 row_mask:0xf bank_mask:0xf
  s_nop 1
  v_mfma_f32_16x16x32_bf16 v[8:11], v[12:15], v[88:91], v[8:11]
  s_call_b64 s[62:63], L_vq
  s_cbranch_scc0 L_dr18
  v_add_u32_dpp v3, v30, v38 row_newbcast:2 row_mask:0xf bank_mask:0xf
  buffer_load_dwordx4 v[112:115], v3, s[48:51], 0 offen nt
  v_and_b32_dpp v12, v29, v34 row_newbcast:13 row_mask:0xf bank_mask:0xf
  v_and_b32_dpp v13, v29, v35 row_newbcast:13 row_mask:0xf bank_mask:0xf
  v_and_b32_dpp v14, v29, v36 row_newbcast:13 row_mask:0xf bank_mask:0xf
  v_and_b32_dpp v15, v29, v0 row_newbcast:13 row_mask:0xf bank_mask:0xf
  s_nop 1
  v_mfma_f32_16x16x32_bf16 v[8:11], v[12:15], v[92:95], v[8:11]
  s_call_b64 s[62:63], L_vq
  s_cbranch_scc0 L_dr19
  v_add_u32_dpp v3, v30, v38 row_newbcast:3 row_mask:0xf bank_mask:0xf
  buffer_load_dwordx4 v[116:119], v3, s[48:51], 0 offen nt
  v_and_b32_dpp v12, v29, v34 row_newbcast:14 row_mask:0xf bank_mask:0xf
  v_and_b32_dpp v13, v29, v35 row_newbcast:14 row_mask:0xf bank_mask:0xf
  v_and_b32_dpp v14, v29, v36 row_newbcast:14 row_mask:0xf bank_mask:0xf
  v_and_b32_dpp v15, v29, v0 row_newbcast:14 row_mask:0xf bank_mask:0xf
  s_nop 1
  v_mfma_f32_16x16x32_bf16 v[8:11], v[12:15], v[96:99], v[8:11]
  s_call_b64 s[62:63], L_vq
  s_cbranch_scc0 L_dr20
  v_add_u32_dpp v3, v30, v38 row_newbcast:4 row_mask:0xf bank_mask:0xf
  buffer_load_dwordx4 v[120:123], v3, s[48:51], 0 offen nt
  v_and_b32_dpp v12, v29, v34 row_newbcast:15 row_mask:0xf bank_mask:0xf
  v_and_b32_dpp v13, v29, v35 row_newbcast:15 row_mask:0xf bank_mask:0xf
  v_and_b32_dpp v14, v29, v36 row_newbcast:15 row_mask:0xf bank_mask:0xf
  v_and_b32_dpp v15, v29, v0 row_newbcast:15 row_mask:0xf bank_mask:0xf
  s_nop 1
  v_mfma_f32_16x16x32_bf16 v[8:11], v[12:15], v[100:103], v[8:11]
  s_call_b64 s[62:63], L_vq
  s_cbranch_scc0 L_dr21
  v_add_u32_dpp v3, v30, v38 row_newbcast:5 row_mask:0xf bank_mask:0xf
  buffer_load_dwordx4 v[124:127], v3, s[48:51], 0 offen nt
  v_and_b32_dpp v12, v31, v34 row_newbcast:0 row_mask:0xf bank_mask:0xf
  v_and_b32_dpp v13, v31, v35 row_newbcast:0 row_mask:0xf bank_mask:0xf
  v_and_b32_dpp v14, v31, v36 row_newbcast:0 row_mask:0xf bank_mask:0xf
  v_and_b32_dpp v15, v31, v0 row_newbcast:0 row_mask:0xf bank_mask:0xf
  s_nop 1
  v_mfma_f32_16x16x32_bf16 v[8:11], v[12:15], v[104:107], v[8:11]
  s_call_b64 s[62:63], L_vq
  s_cbranch_scc0 L_dr22
  v_add_u32_dpp v3, v30, v38 row_newbcast:6 row_mask:0xf bank_mask:0xf
  buffer_load_dwordx4 v[128:131], v3, s[48:51], 0 offen nt
  v_and_b32_dpp v12, v31, v34 row_newbcast:1 row_mask:0xf bank_mask:0xf
  v_and_b32_dpp v13, v31, v35 row_newbcast:1 row_mask:0xf bank_mask:0xf
  v_and_b32_dpp v14, v31, v36 row_newbcast:1 row_mask:0xf bank_mask:0xf
  v_and_b32_dpp v15, v31, v0 row_newbcast:1 row_mask:0xf bank_mask:0xf
  s_nop 1
  v_mfma_f32_16x16x32_bf16 v[8:11], v[12:15], v[108:111], v[8:11]
  s_call_b64 s[62:63], L_vq
  s_cbranch_scc0 L_dr23
  v_add_u32_dpp v3, v30, v38 row_newbcast:7 row_mask:0xf bank_mask:0xf
  buffer_load_dwordx4 v[132:135], v3, s[48:51], 0 offen nt
  v_and_b32_dpp v12, v31, v34 row_newbcast:2 row_mask:0xf bank_mask:0xf
  v_and_b32_dpp v13, v31, v35 row_newbcast:2 row_mask:0xf bank_mask:0xf
  v_and_b32_dpp v14, v31, v36 row_newbcast:2 row_mask:0xf bank_mask:0xf
  v_and_b32_dpp v15, v31, v0 row_newbcast:2 row_mask:0xf bank_mask:0xf
  s_nop 1
  v_mfma_f32_16x16x32_bf16 v[8:11], v[12:15], v[112:115], v[8:11]
  s_call_b64 s[62:63], L_vq
  s_cbranch_scc0 L_dr24
  v_add_u32_dpp v3, v30, v38 row_newbcast:8 row_mask:0xf bank_mask:0xf
  buffer_load_dwordx4 v[136:139], v3, s[48:51], 0 offen nt
  v_and_b32_dpp v12, v31, v34 row_newbcast:3 row_mask:0xf bank_mask:0xf
  v_and_b32_dpp v13, v31, v35 row_newbcast:3 row_mask:0xf bank_mask:0xf
  v_and_b32_dpp v14, v31, v36 row_newbcast:3 row_mask:0xf bank_mask:0xf
  v_and_b32_dpp v15, v31, v0 row_newbcast:3 row_mask:0xf bank_mask:0xf
  s_nop 1
  v_mfma_f32_16x16x32_bf16 v[8:11], v[12:15], v[116:119], v[8:11]
  s_call_b64 s[62:63], L_vq
  s_cbranch_scc0 L_dr25
  v_add_u32_dpp v3, v30, v38 row_newbcast:9 row_mask:0xf bank_mask:0xf
  buffer_load_dwordx4 v[140:143], v3, s[48:51], 0 offen nt
  v_and_b32_dpp v12, v31, v34 row_newbcast:4 row_mask:0xf bank_mask:0xf
  v_and_b32_dpp v13, v31, v35 row_newbcast:4 row_mask:0xf bank_mask:0xf
  v_and_b32_dpp v14, v31, v36 row_newbcast:4 row_mask:0xf bank_mask:0xf
  v_and_b32_dpp v15, v31, v0 row_newbcast:4 row_mask:0xf bank_mask:0xf
  s_nop 1
  v_mfma_f32_16x16x32_bf16 v[8:11], v[12:15], v[120:123], v[8:11]
  s_call_b64 s[62:63], L_vq
  s_cbranch_scc0 L_dr26
  v_add_u32_dpp v3, v30, v38 row_newbcast:10 row_mask:0xf bank_mask:0xf
  buffer_load_dwordx4 v[144:147], v3, s[48:51], 0 offen nt
  v_and_b32_dpp v12, v31, v34 row_newbcast:5 row_mask:0xf bank_mask:0xf
  v_and_b32_dpp v13, v31, v35 row_newbcast:5 row_mask:0xf bank_mask:0xf
  v_and_b32_dpp v14, v31, v36 row_newbcast:5 row_mask:0xf bank_mask:0xf
  v_and_b32_dpp v15, v31, v0 row_newbcast:5 row_mask:0xf bank_mask:0xf
  s_nop 1
  v_mfma_f32_16x16x32_bf16 v[8:11], v[12:15], v[124:127], v[8:11]
  s_call_b64 s[62:63], L_vq
  s_cbranch_scc0 L_dr27
  v_add_u32_dpp v3, v30, v38 row_newbcast:11 row_mask:0xf bank_mask:0xf
  buffer_load_dwordx4 v[148:151], v3, s[48:51], 0 offen nt
  v_and_b32_dpp v12, v31, v34 row_newbcast:6 row_mask:0xf bank_mask:0xf
  v_and_b32_dpp v13, v31, v35 row_newbcast:6 row_mask:0xf bank_mask:0xf
  v_and_b32_dpp v14, v31, v36 row_newbcast:6 row_mask:0xf bank_mask:0xf
  v_and_b32_dpp v15, v31, v0 row_newbcast:6 row_mask:0xf bank_mask:0xf
  s_nop 1
  v_mfma_f32_16x16x32_bf16 v[8:11], v[12:15], v[128:131], v[8:11]
  s_call_b64 s[62:63], L_vq
  s_cbranch_scc0 L_dr28
  v_add_u32_dpp v3, v30, v38 row_newbcast:12 row_mask:0xf bank_mask:0xf
  buffer_load_dwordx4 v[152:155], v3, s[48:51], 0 offen nt
  v_and_b32_dpp v12, v31, v34 row_newbcast:7 row_mask:0xf bank_mask:0xf
  v_and_b32_dpp v13, v31, v35 row_newbcast:7 row_mask:0xf bank_mask:0xf
  v_and_b32_dpp v14, v31, v36 row_newbcast:7 row_mask:0xf bank_mask:0xf
  v_and_b32_dpp v15, v31, v0 row_newbcast:7 row_mask:0xf bank_mask:0xf
  s_nop 1
  v_mfma_f32_16x16x32_bf16 v[8:11], v[12:15], v[132:135], v[8:11]
  s_call_b64 s[62:63], L_vq
  s_cbranch_scc0 L_dr29
  v_add_u32_dpp v3, v30, v38 row_newbcast:13 row_mask:0xf bank_mask:0xf
  buffer_load_dwordx4 v[156:159], v3, s[48:51], 0 offen nt
  v_and_b32_dpp v12, v31, v34 row_newbcast:8 row_mask:0xf bank_mask:0xf
  v_and_b32_dpp v13, v31, v35 row_newbcast:8 row_mask:0xf bank_mask:0xf
  v_and_b32_dpp v14, v31, v36 row_newbcast:8 row_mask:0xf bank_mask:0xf
  v_and_b32_dpp v15, v31, v0 row_newbcast:8 row_mask:0xf bank_mask:0xf
  s_nop 1
  v_mfma_f32_16x16x32_bf16 v[8:11], v[12:15], v[136:139], v[8:11]
  s_call_b64 s[62:63], L_vq
  s_cbranch_scc0 L_dr30
  v_add_u32_dpp v3, v30, v38 row_newbcast:14 row_mask:0xf bank_mask:0xf
  buffer_load_dwordx4 v[160:163], v3, s[48:51], 0 offen nt
  v_and_b32_dpp v12, v31, v34 row_newbcast:9 row_mask:0xf bank_mask:0xf
  v_and_b32_dpp v13, v31, v35 row_newbcast:9 row_mask:0xf bank_mask:0xf
  v_and_b32_dpp v14, v31, v36 row_newbcast:9 row_mask:0xf bank_mask:0xf
  v_and_b32_dpp v15, v31, v0 row_newbcast:9 row_mask:0xf bank_mask:0xf
  s_nop 1
  v_mfma_f32_16x16x32_bf16 v[8:11], v[12:15], v[140:143], v[8:11]
  s_call_b64 s[62:63], L_vq
  s_cbranch_scc0 L_dr31
  v_add_u32_dpp v3, v30, v38 row_newbcast:15 row_mask:0xf bank_mask:0xf
  buffer_load_dwordx4 v[164:167], v3, s[48:51], 0 offen nt
  v_and_b32_dpp v12, v31, v34 row_newbcast:10 row_mask:0xf bank_mask:0xf
  v_and_b32_dpp v13, v31, v35 row_newbcast:10 row_mask:0xf bank_mask:0xf
  v_and_b32_dpp v14, v31, v36 row_newbcast:10 row_mask:0xf bank_mask:0xf
  v_and_b32_dpp v15, v31, v0 row_newbcast:10 row_mask:0xf bank_mask:0xf
  s_nop 1
  v_mfma_f32_16x16x32_bf16 v[8:11], v[12:15], v[144:147], v[8:11]
  s_call_b64 s[62:63], L_vq
  s_cbranch_scc0 L_dr32
  v_add_u32_dpp v3, v32, v38 row_newbcast:0 row_mask:0xf bank_mask:0xf
  buffer_load_dwordx4 v[40:43], v3, s[48:51], 0 offen nt
  v_and_b32_dpp v12, v31, v34 row_newbcast:11 row_mask:0xf bank_mask:0xf
  v_and_b32_dpp v13, v31, v35 row_newbcast:11 row_mask:0xf bank_mask:0xf
  v_and_b32_dpp v14, v31, v36 row_newbcast:11 row_mask:0xf bank_mask:0xf
  v_and_b32_dpp v15, v31, v0 row_newbcast:11 row_mask:0xf bank_mask:0xf
  s_nop 1
  v_mfma_f32_16x16x32_bf16 v[8:11], v[12:15], v[148:151], v[8:11]
  s_call_b64 s[62:63], L_vq
  s_cbranch_scc0 L_dr33
  v_add_u32_dpp v3, v32, v38 row_newbcast:1 row_mask:0xf bank_mask:0xf
  buffer_load_dwordx4 v[44:47], v3, s[48:51], 0 offen nt
  v_and_b32_dpp v12, v31, v34 row_newbcast:12 row_mask:0xf bank_mask:0xf
  v_and_b32_dpp v13, v31, v35 row_newbcast:12 row_mask:0xf bank_mask:0xf
  v_and_b32_dpp v14, v31, v36 row_newbcast:12 row_mask:0xf bank_mask:0xf
  v_and_b32_dpp v15, v31, v0 row_newbcast:12 row_mask:0xf bank_mask:0xf
  s_nop 1
  v_mfma_f32_16x16x32_bf16 v[8:11], v[12:15], v[152:155], v[8:11]
  s_call_b64 s[62:63], L_vq
  s_cbranch_scc0 L_dr34
  v_add_u32_dpp v3, v32, v38 row_newbcast:2 row_mask:0xf bank_mask:0xf
  buffer_load_dwordx4 v[48:51], v3, s[48:51], 0 offen nt
  v_and_b32_dpp v12, v31, v34 row_newbcast:13 row_mask:0xf bank_mask:0xf
  v_and_b32_dpp v13, v31, v35 row_newbcast:13 row_mask:0xf bank_mask:0xf
  v_and_b32_dpp v14, v31, v36 row_newbcast:13 row_mask:0xf bank_mask:0xf
  v_and_b32_dpp v15, v31, v0 row_newbcast:13 row_mask:0xf bank_mask:0xf
  s_nop 1
  v_mfma_f32_16x16x32_bf16 v[8:11], v[12:15], v[156:159], v[8:11]
  s_call_b64 s[62:63], L_vq
  s_cbranch_scc0 L_dr35
  v_add_u32_dpp v3, v32, v38 row_newbcast:3 row_mask:0xf bank_mask:0xf
  buffer_load_dwordx4 v[52:55], v3, s[48:51], 0 offen nt
  v_and_b32_dpp v12, v31, v34 row_newbcast:14 row_mask:0xf bank_mask:0xf
  v_and_b32_dpp v13, v31, v35 row_newbcast:14 row_mask:0xf bank_mask:0xf
  v_and_b32_dpp v14, v31, v36 row_newbcast:14 row_mask:0xf bank_mask:0xf
  v_and_b32_dpp v15, v31, v0 row_newbcast:14 row_mask:0xf bank_mask:0xf
  s_nop 1
  v_mfma_f32_16x16x32_bf16 v[8:11], v[12:15], v[160:163], v[8:11]
  s_call_b64 s[62:63], L_vq
  s_cbranch_scc0 L_dr36
  v_add_u32_dpp v3, v32, v38 row_newbcast:4 row_mask:0xf bank_mask:0xf
  buffer_load_dwordx4 v[56:59], v3, s[48:51], 0 offen nt
  v_and_b32_dpp v12, v31, v34 row_newbcast:15 row_mask:0xf bank_mask:0xf
  v_and_b32_dpp v13, v31, v35 row_newbcast:15 row_mask:0xf bank_mask:0xf
  v_and_b32_dpp v14, v31, v36 row_newbcast:15 row_mask:0xf bank_mask:0xf
  v_and_b32_dpp v15, v31, v0 row_newbcast:15 row_mask:0xf bank_mask:0xf
  s_nop 1
  v_mfma_f32_16x16x32_bf16 v[8:11], v[12:15], v[164:167], v[8:11]
  s_call_b64 s[62:63], L_vq
  s_cbranch_scc0 L_dr37
  v_add_u32_dpp v3, v32, v38 row_newbcast:5 row_mask:0xf bank_mask:0xf
  buffer_load_dwordx4 v[60:63], v3, s[48:51], 0 offen nt
  v_and_b32_dpp v12, v33, v34 row_newbcast:0 row_mask:0xf bank_mask:0xf
  v_and_b32_dpp v13, v33, v35 row_newbcast:0 row_mask:0xf bank_mask:0xf
  v_and_b32_dpp v14, v33, v36 row_newbcast:0 row_mask:0xf bank_mask:0xf
  v_and_b32_dpp v15, v33, v0 row_newbcast:0 row_mask:0xf bank_mask:0xf
  s_nop 1
  v_mfma_f32_16x16x32_bf16 v[8:11], v[12:15], v[40:43], v[8:11]
  s_call_b64 s[62:63], L_vq
  s_branch L_dr38
L_dr5:
  v_and_b32_dpp v12, v29, v34 row_newbcast:0 row_mask:0xf bank_mask:0xf
  v_and_b32_dpp v13, v29, v35 row_newbcast:0 row_mask:0xf bank_mask:0xf
  v_and_b32_dpp v14, v29, v36 row_newbcast:0 row_mask:0xf bank_mask:0xf
  v_and_b32_dpp v15, v29, v0 row_newbcast:0 row_mask:0xf bank_mask:0xf
  s_nop 1
  v_mfma_f32_16x16x32_bf16 v[8:11], v[12:15], v[40:43], v[8:11]
  s_cmp_eq_u32 s75, 6
  s_cbranch_scc1 L_epi
L_dr6:
  v_and_b32_dpp v12, v29, v34 row_newbcast:1 row_mask:0xf bank_mask:0xf
  v_and_b32_dpp v13, v29, v35 row_newbcast:1 row_mask:0xf bank_mask:0xf
  v_and_b32_dpp v14, v29, v36 row_newbcast:1 row_mask:0xf bank_mask:0xf
  v_and_b32_dpp v15, v29, v0 row_newbcast:1 row_mask:0xf bank_mask:0xf
  s_nop 1
  v_mfma_f32_16x16x32_bf16 v[8:11], v[12:15], v[44:47], v[8:11]
  s_cmp_eq_u32 s75, 7
  s_cbranch_scc1 L_epi
L_dr7:
  v_and_b32_dpp v12, v29, v34 row_newbcast:2 row_mask:0xf bank_mask:0xf
  v_and_b32_dpp v13, v29, v35 row_newbcast:2 row_mask:0xf bank_mask:0xf
  v_and_b32_dpp v14, v29, v36 row_newbcast:2 row_mask:0xf bank_mask:0xf
  v_and_b32_dpp v15, v29, v0 row_newbcast:2 row_mask:0xf bank_mask:0xf
  s_nop 1
  v_mfma_f32_16x16x32_bf16 v[8:11], v[12:15], v[48:51], v[8:11]
  s_cmp_eq_u32 s75, 8
  s_cbranch_scc1 L_epi
L_dr8:
  v_and_b32_dpp v12, v29, v34 row_newbcast:3 row_mask:0xf bank_mask:0xf
  v_and_b32_dpp v13, v29, v35 row_newbcast:3 row_mask:0xf bank_mask:0xf
  v_and_b32_dpp v14, v29, v36 row_newbcast:3 row_mask:0xf bank_mask:0xf
  v_and_b32_dpp v15, v29, v0 row_newbcast:3 row_mask:0xf bank_mask:0xf
  s_nop 1
  v_mfma_f32_16x16x32_bf16 v[8:11], v[12:15], v[52:55], v[8:11]
  s_cmp_eq_u32 s75, 9
  s_cbranch_scc1 L_epi
L_dr9:
  v_and_b32_dpp v12, v29, v34 row_newbcast:4 row_mask:0xf bank_mask:0xf
  v_and_b32_dpp v13, v29, v35 row_newbcast:4 row_mask:0xf bank_mask:0xf
  v_and_b32_dpp v14, v29, v36 row_newbcast:4 row_mask:0xf bank_mask:0xf
  v_and_b32_dpp v15, v29, v0 row_newbcast:4 row_mask:0xf bank_mask:0xf
  s_nop 1
  v_mfma_f32_16x16x32_bf16 v[8:11], v[12:15], v[56:59], v[8:11]
  s_cmp_eq_u32 s75, 10
  s_cbranch_scc1 L_epi
L_dr10:
  v_and_b32_dpp v12, v29, v34 row_newbcast:5 row_mask:0xf bank_mask:0xf
  v_and_b32_dpp v13, v29, v35 row_newbcast:5 row_mask:0xf bank_mask:0xf
  v_and_b32_dpp v14, v29, v36 row_newbcast:5 row_mask:0xf bank_mask:0xf
  v_and_b32_dpp v15, v29, v0 row_newbcast:5 row_mask:0xf bank_mask:0xf
  s_nop 1
  v_mfma_f32_16x16x32_bf16 v[8:11], v[12:15], v[60:63], v[8:11]
  s_cmp_eq_u32 s75, 11
  s_cbranch_scc1 L_epi
L_dr11:
  v_and_b32_dpp v12, v29, v34 row_newbcast:6 row_mask:0xf bank_mask:0xf
  v_and_b32_dpp v13, v29, v35 row_newbcast:6 row_mask:0xf bank_mask:0xf
  v_and_b32_dpp v14, v29, v36 row_newbcast:6 row_mask:0xf bank_mask:0xf
  v_and_b32_dpp v15, v29, v0 row_newbcast:6 row_mask:0xf bank_mask:0xf
  s_nop 1
  v_mfma_f32_16x16x32_bf16 v[8:11], v[12:15], v[64:67], v[8:11]
  s_cmp_eq_u32 s75, 12
  s_cbranch_scc1 L_epi
L_dr12:
  v_and_b32_dpp v12, v29, v34 row_newbcast:7 row_mask:0xf bank_mask:0xf
  v_and_b32_dpp v13, v29, v35 row_newbcast:7 row_mask:0xf bank_mask:0xf
  v_and_b32_dpp v14, v29, v36 row_newbcast:7 row_mask:0xf bank_mask:0xf
  v_and_b32_dpp v15, v29, v0 row_newbcast:7 row_mask:0xf bank_mask:0xf
  s_nop 1
  v_mfma_f32_16x16x32_bf16 v[8:11], v[12:15], v[68:71], v[8:11]
  s_cmp_eq_u32 s75, 13
  s_cbranch_scc1 L_epi
L_dr13:
  v_and_b32_dpp v12, v29, v34 row_newbcast:8 row_mask:0xf bank_mask:0xf
  v_and_b32_dpp v13, v29, v35 row_newbcast:8 row_mask:0xf bank_mask:0xf
  v_and_b32_dpp v14, v29, v36 row_newbcast:8 row_mask:0xf bank_mask:0xf
  v_and_b32_dpp v15, v29, v0 row_newbcast:8 row_mask:0xf bank_mask:0xf
  s_nop 1
  v_mfma_f32_16x16x32_bf16 v[8:11], v[12:15], v[72:75], v[8:11]
  s_cmp_eq_u32 s75, 14
  s_cbranch_scc1 L_epi
L_dr14:
  v_and_b32_dpp v12, v29, v34 row_newbcast:9 row_mask:0xf bank_mask:0xf
  v_and_b32_dpp v13, v29, v35 row_newbcast:9 row_mask:0xf bank_mask:0xf
  v_and_b32_dpp v14, v29, v36 row_newbcast:9 row_mask:0xf bank_mask:0xf
  v_and_b32_dpp v15, v29, v0 row_newbcast:9 row_mask:0xf bank_mask:0xf
  s_nop 1
  v_mfma_f32_16x16x32_bf16 v[8:11], v[12:15], v[76:79], v[8:11]
  s_cmp_eq_u32 s75, 15
  s_cbranch_scc1 L_epi
L_dr15:
  v_and_b32_dpp v12, v29, v34 row_newbcast:10 row_mask:0xf bank_mask:0xf
  v_and_b32_dpp v13, v29, v35 row_newbcast:10 row_mask:0xf bank_mask:0xf
  v_and_b32_dpp v14, v29, v36 row_newbcast:10 row_mask:0xf bank_mask:0xf
  v_and_b32_dpp v15, v29, v0 row_newbcast:10 row_mask:0xf bank_mask:0xf
  s_nop 1
  v_mfma_f32_16x16x32_bf16 v[8:11], v[12:15], v[80:83], v[8:11]
  s_cmp_eq_u32 s75, 16
  s_cbranch_scc1 L_epi
L_dr16:
  v_and_b32_dpp v12, v29, v34 row_newbcast:11 row_mask:0xf bank_mask:0xf
  v_and_b32_dpp v13, v29, v35 row_newbcast:11 row_mask:0xf bank_mask:0xf
  v_and_b32_dpp v14, v29, v36 row_newbcast:11 row_mask:0xf bank_mask:0xf
  v_and_b32_dpp v15, v29, v0 row_newbcast:11 row_mask:0xf bank_mask:0xf
  s_nop 1
  v_mfma_f32_16x16x32_bf16 v[8:11], v[12:15], v[84:87], v[8:11]
  s_cmp_eq_u32 s75, 17
  s_cbranch_scc1 L_epi
L_dr17:
  v_and_b32_dpp v12, v29, v34 row_newbcast:12 row_mask:0xf bank_mask:0xf
  v_and_b32_dpp v13, v29, v35 row_newbcast:12 row_mask:0xf bank_mask:0xf
  v_and_b32_dpp v14, v29, v36 row_newbcast:12 row_mask:0xf bank_mask:0xf
  v_and_b32_dpp v15, v29, v0 row_newbcast:12 row_mask:0xf bank_mask:0xf
  s_nop 1
  v_mfma_f32_16x16x32_bf16 v[8:11], v[12:15], v[88:91], v[8:11]
  s_cmp_eq_u32 s75, 18
  s_cbranch_scc1 L_epi
L_dr18:
  v_and_b32_dpp v12, v29, v34 row_newbcast:13 row_mask:0xf bank_mask:0xf
  v_and_b32_dpp v13, v29, v35 row_newbcast:13 row_mask:0xf bank_mask:0xf
  v_and_b32_dpp v14, v29, v36 row_newbcast:13 row_mask:0xf bank_mask:0xf
  v_and_b32_dpp v15, v29, v0 row_newbcast:13 row_mask:0xf bank_mask:0xf
  s_nop 1
  v_mfma_f32_16x16x32_bf16 v[8:11], v[12:15], v[92:95], v[8:11]
  s_cmp_eq_u32 s75, 19
  s_cbranch_scc1 L_epi
L_dr19:
  v_and_b32_dpp v12, v29, v34 row_newbcast:14 row_mask:0xf bank_mask:0xf
  v_and_b32_dpp v13, v29, v35 row_newbcast:14 row_mask:0xf bank_mask:0xf
  v_and_b32_dpp v14, v29, v36 row_newbcast:14 row_mask:0xf bank_mask:0xf
  v_and_b32_dpp v15, v29, v0 row_newbcast:14 row_mask:0xf bank_mask:0xf
  s_nop 1
  v_mfma_f32_16x16x32_bf16 v[8:11], v[12:15], v[96:99], v[8:11]
  s_cmp_eq_u32 s75, 20
  s_cbranch_scc1 L_epi
L_dr20:
  v_and_b32_dpp v12, v29, v34 row_newbcast:15 row_mask:0xf bank_mask:0xf
  v_and_b32_dpp v13, v29, v35 row_newbcast:15 row_mask:0xf bank_mask:0xf
  v_and_b32_dpp v14, v29, v36 row_newbcast:15 row_mask:0xf bank_mask:0xf
  v_and_b32_dpp v15, v29, v0 row_newbcast:15 row_mask:0xf bank_mask:0xf
  s_nop 1
  v_mfma_f32_16x16x32_bf16 v[8:11], v[12:15], v[100:103], v[8:11]
  s_cmp_eq_u32 s75, 21
  s_cbranch_scc1 L_epi
L_dr21:
  v_and_b32_dpp v12, v31, v34 row_newbcast:0 row_mask:0xf bank_mask:0xf
  v_and_b32_dpp v13, v31, v35 row_newbcast:0 row_mask:0xf bank_mask:0xf
  v_and_b32_dpp v14, v31, v36 row_newbcast:0 row_mask:0xf bank_mask:0xf
  v_and_b32_dpp v15, v31, v0 row_newbcast:0 row_mask:0xf bank_mask:0xf
  s_nop 1
  v_mfma_f32_16x16x32_bf16 v[8:11], v[12:15], v[104:107], v[8:11]
  s_cmp_eq_u32 s75, 22
  s_cbranch_scc1 L_epi
L_dr22:
  v_and_b32_dpp v12, v31, v34 row_newbcast:1 row_mask:0xf bank_mask:0xf
  v_and_b32_dpp v13, v31, v35 row_newbcast:1 row_mask:0xf bank_mask:0xf
  v_and_b32_dpp v14, v31, v36 row_newbcast:1 row_mask:0xf bank_mask:0xf
  v_and_b32_dpp v15, v31, v0 row_newbcast:1 row_mask:0xf bank_mask:0xf
  s_nop 1
  v_mfma_f32_16x16x32_bf16 v[8:11], v[12:15], v[108:111], v[8:11]
  s_cmp_eq_u32 s75, 23
  s_cbranch_scc1 L_epi
L_dr23:
  v_and_b32_dpp v12, v31, v34 row_newbcast:2 row_mask:0xf bank_mask:0xf
  v_and_b32_dpp v13, v31, v35 row_newbcast:2 row_mask:0xf bank_mask:0xf
  v_and_b32_dpp v14, v31, v36 row_newbcast:2 row_mask:0xf bank_mask:0xf
  v_and_b32_dpp v15, v31, v0 row_newbcast:2 row_mask:0xf bank_mask:0xf
  s_nop 1
  v_mfma_f32_16x16x32_bf16 v[8:11], v[12:15], v[112:115], v[8:11]
  s_cmp_eq_u32 s75, 24
  s_cbranch_scc1 L_epi
L_dr24:
  v_and_b32_dpp v12, v31, v34 row_newbcast:3 row_mask:0xf bank_mask:0xf
  v_and_b32_dpp v13, v31, v35 row_newbcast:3 row_mask:0xf bank_mask:0xf
  v_and_b32_dpp v14, v31, v36 row_newbcast:3 row_mask:0xf bank_mask:0xf
  v_and_b32_dpp v15, v31, v0 row_newbcast:3 row_mask:0xf bank_mask:0xf
  s_nop 1
  v_mfma_f32_16x16x32_bf16 v[8:11], v[12:15], v[116:119], v[8:11]
  s_cmp_eq_u32 s75, 25
  s_cbranch_scc1 L_epi
L_dr25:
  v_and_b32_dpp v12, v31, v34 row_newbcast:4 row_mask:0xf bank_mask:0xf
  v_and_b32_dpp v13, v31, v35 row_newbcast:4 row_mask:0xf bank_mask:0xf
  v_and_b32_dpp v14, v31, v36 row_newbcast:4 row_mask:0xf bank_mask:0xf
  v_and_b32_dpp v15, v31, v0 row_newbcast:4 row_mask:0xf bank_mask:0xf
  s_nop 1
  v_mfma_f32_16x16x32_bf16 v[8:11], v[12:15], v[120:123], v[8:11]
  s_cmp_eq_u32 s75, 26
  s_cbranch_scc1 L_epi
L_dr26:
  v_and_b32_dpp v12, v31, v34 row_newbcast:5 row_mask:0xf bank_mask:0xf
  v_and_b32_dpp v13, v31, v35 row_newbcast:5 row_mask:0xf bank_mask:0xf
  v_and_b32_dpp v14, v31, v36 row_newbcast:5 row_mask:0xf bank_mask:0xf
  v_and_b32_dpp v15, v31, v0 row_newbcast:5 row_mask:0xf bank_mask:0xf
  s_nop 1
  v_mfma_f32_16x16x32_bf16 v[8:11], v[12:15], v[124:127], v[8:11]
  s_cmp_eq_u32 s75, 27
  s_cbranch_scc1 L_epi
L_dr27:
  v_and_b32_dpp v12, v31, v34 row_newbcast:6 row_mask:0xf bank_mask:0xf
  v_and_b32_dpp v13, v31, v35 row_newbcast:6 row_mask:0xf bank_mask:0xf
  v_and_b32_dpp v14, v31, v36 row_newbcast:6 row_mask:0xf bank_mask:0xf
  v_and_b32_dpp v15, v31, v0 row_newbcast:6 row_mask:0xf bank_mask:0xf
  s_nop 1
  v_mfma_f32_16x16x32_bf16 v[8:11], v[12:15], v[128:131], v[8:11]
  s_cmp_eq_u32 s75, 28
  s_cbranch_scc1 L_epi
L_dr28:
  v_and_b32_dpp v12, v31, v34 row_newbcast:7 row_mask:0xf bank_mask:0xf
  v_and_b32_dpp v13, v31, v35 row_newbcast:7 row_mask:0xf bank_mask:0xf
  v_and_b32_dpp v14, v31, v36 row_newbcast:7 row_mask:0xf bank_mask:0xf
  v_and_b32_dpp v15, v31, v0 row_newbcast:7 row_mask:0xf bank_mask:0xf
  s_nop 1
  v_mfma_f32_16x16x32_bf16 v[8:11], v[12:15], v[132:135], v[8:11]
  s_cmp_eq_u32 s75, 29
  s_cbranch_scc1 L_epi
L_dr29:
  v_and_b32_dpp v12, v31, v34 row_newbcast:8 row_mask:0xf bank_mask:0xf
  v_and_b32_dpp v13, v31, v35 row_newbcast:8 row_mask:0xf bank_mask:0xf
  v_and_b32_dpp v14, v31, v36 row_newbcast:8 row_mask:0xf bank_mask:0xf
  v_and_b32_dpp v15, v31, v0 row_newbcast:8 row_mask:0xf bank_mask:0xf
  s_nop 1
  v_mfma_f32_16x16x32_bf16 v[8:11], v[12:15], v[136:139], v[8:11]
  s_cmp_eq_u32 s75, 30
  s_cbranch_scc1 L_epi
L_dr30:
  v_and_b32_dpp v12, v31, v34 row_newbcast:9 row_mask:0xf bank_mask:0xf
  v_and_b32_dpp v13, v31, v35 row_newbcast:9 row_mask:0xf bank_mask:0xf
  v_and_b32_dpp v14, v31, v36 row_newbcast:9 row_mask:0xf bank_mask:0xf
  v_and_b32_dpp v15, v31, v0 row_newbcast:9 row_mask:0xf bank_mask:0xf
  s_nop 1
  v_mfma_f32_16x16x32_bf16 v[8:11], v[12:15], v[140:143], v[8:11]
  s_cmp_eq_u32 s75, 31
  s_cbranch_scc1 L_epi
L_dr31:
  v_and_b32_dpp v12, v31, v34 row_newbcast:10 row_mask:0xf bank_mask:0xf
  v_and_b32_dpp v13, v31, v35 row_newbcast:10 row_mask:0xf bank_mask:0xf
  v_and_b32_dpp v14, v31, v36 row_newbcast:10 row_mask:0xf bank_mask:0xf
  v_and_b32_dpp v15, v31, v0 row_newbcast:10 row_mask:0xf bank_mask:0xf
  s_nop 1
  v_mfma_f32_16x16x32_bf16 v[8:11], v[12:15], v[144:147], v[8:11]
  s_cmp_eq_u32 s75, 32
  s_cbranch_scc1 L_epi
L_dr32:
  v_and_b32_dpp v12, v31, v34 row_newbcast:11 row_mask:0xf bank_mask:0xf
  v_and_b32_dpp v13, v31, v35 row_newbcast:11 row_mask:0xf bank_mask:0xf
  v_and_b32_dpp v14, v31, v36 row_newbcast:11 row_mask:0xf bank_mask:0xf
  v_and_b32_dpp v15, v31, v0 row_newbcast:11 row_mask:0xf bank_mask:0xf
  s_nop 1
  v_mfma_f32_16x16x32_bf16 v[8:11], v[12:15], v[148:151], v[8:11]
  s_cmp_eq_u32 s75, 33
  s_cbranch_scc1 L_epi
L_dr33:
  v_and_b32_dpp v12, v31, v34 row_newbcast:12 row_mask:0xf bank_mask:0xf
  v_and_b32_dpp v13, v31, v35 row_newbcast:12 row_mask:0xf bank_mask:0xf
  v_and_b32_dpp v14, v31, v36 row_newbcast:12 row_mask:0xf bank_mask:0xf
  v_and_b32_dpp v15, v31, v0 row_newbcast:12 row_mask:0xf bank_mask:0xf
  s_nop 1
  v_mfma_f32_16x16x32_bf16 v[8:11], v[12:15], v[152:155], v[8:11]
  s_cmp_eq_u32 s75, 34
  s_cbranch_scc1 L_epi
L_dr34:
  v_and_b32_dpp v12, v31, v34 row_newbcast:13 row_mask:0xf bank_mask:0xf
  v_and_b32_dpp v13, v31, v35 row_newbcast:13 row_mask:0xf bank_mask:0xf
  v_and_b32_dpp v14, v31, v36 row_newbcast:13 row_mask:0xf bank_mask:0xf
  v_and_b32_dpp v15, v31, v0 row_newbcast:13 row_mask:0xf bank_mask:0xf
  s_nop 1
  v_mfma_f32_16x16x32_bf16 v[8:11], v[12:15], v[156:159], v[8:11]
  s_cmp_eq_u32 s75, 35
  s_cbranch_scc1 L_epi
L_dr35:
  v_and_b32_dpp v12, v31, v34 row_newbcast:14 row_mask:0xf bank_mask:0xf
  v_and_b32_dpp v13, v31, v35 row_newbcast:14 row_mask:0xf bank_mask:0xf
  v_and_b32_dpp v14, v31, v36 row_newbcast:14 row_mask:0xf bank_mask:0xf
  v_and_b32_dpp v15, v31, v0 row_newbcast:14 row_mask:0xf bank_mask:0xf
  s_nop 1
  v_mfma_f32_16x16x32_bf16 v[8:11], v[12:15], v[160:163], v[8:11]
  s_cmp_eq_u32 s75, 36
  s_cbranch_scc1 L_epi
L_dr36:
  v_and_b32_dpp v12, v31, v34 row_newbcast:15 row_mask:0xf bank_mask:0xf
  v_and_b32_dpp v13, v31, v35 row_newbcast:15 row_mask:0xf bank_mask:0xf
  v_and_b32_dpp v14, v31, v36 row_newbcast:15 row_mask:0xf bank_mask:0xf
  v_and_b32_dpp v15, v31, v0 row_newbcast:15 row_mask:0xf bank_mask:0xf
  s_nop 1
  v_mfma_f32_16x16x32_bf16 v[8:11], v[12:15], v[164:167], v[8:11]
  s_cmp_eq_u32 s75, 37
  s_cbranch_scc1 L_epi
L_dr37:
  v_and_b32_dpp v12, v33, v34 row_newbcast:0 row_mask:0xf bank_mask:0xf
  v_and_b32_dpp v13, v33, v35 row_newbcast:0 row_mask:0xf bank_mask:0xf
  v_and_b32_dpp v14, v33, v36 row_newbcast:0 row_mask:0xf bank_mask:0xf
  v_and_b32_dpp v15, v33, v0 row_newbcast:0 row_mask:0xf bank_mask:0xf
  s_nop 1
  v_mfma_f32_16x16x32_bf16 v[8:11], v[12:15], v[40:43], v[8:11]
  s_cmp_eq_u32 s75, 38
  s_cbranch_scc1 L_epi
L_dr38:
  v_and_b32_dpp v12, v33, v34 row_newbcast:1 row_mask:0xf bank_mask:0xf
  v_and_b32_dpp v13, v33, v35 row_newbcast:1 row_mask:0xf bank_mask:0xf
  v_and_b32_dpp v14, v33, v36 row_newbcast:1 row_mask:0xf bank_mask:0xf
  v_and_b32_dpp v15, v33, v0 row_newbcast:1 row_mask:0xf bank_mask:0xf
  s_nop 1
  v_mfma_f32_16x16x32_bf16 v[8:11], v[12:15], v[44:47], v[8:11]
  s_cmp_eq_u32 s75, 39
  s_cbranch_scc1 L_epi
L_dr39:
  v_and_b32_dpp v12, v33, v34 row_newbcast:2 row_mask:0xf bank_mask:0xf
  v_and_b32_dpp v13, v33, v35 row_newbcast:2 row_mask:0xf bank_mask:0xf
  v_and_b32_dpp v14, v33, v36 row_newbcast:2 row_mask:0xf bank_mask:0xf
  v_and_b32_dpp v15, v33, v0 row_newbcast:2 row_mask:0xf bank_mask:0xf
  s_nop 1
  v_mfma_f32_16x16x32_bf16 v[8:11], v[12:15], v[48:51], v[8:11]
  s_cmp_eq_u32 s75, 40
  s_cbranch_scc1 L_epi
L_dr40:
  v_and_b32_dpp v12, v33, v34 row_newbcast:3 row_mask:0xf bank_mask:0xf
  v_and_b32_dpp v13, v33, v35 row_newbcast:3 row_mask:0xf bank_mask:0xf
  v_and_b32_dpp v14, v33, v36 row_newbcast:3 row_mask:0xf bank_mask:0xf
  v_and_b32_dpp v15, v33, v0 row_newbcast:3 row_mask:0xf bank_mask:0xf
  s_nop 1
  v_mfma_f32_16x16x32_bf16 v[8:11], v[12:15], v[52:55], v[8:11]
  s_cmp_eq_u32 s75, 41
  s_cbranch_scc1 L_epi
L_dr41:
  v_and_b32_dpp v12, v33, v34 row_newbcast:4 row_mask:0xf bank_mask:0xf
  v_and_b32_dpp v13, v33, v35 row_newbcast:4 row_mask:0xf bank_mask:0xf
  v_and_b32_dpp v14, v33, v36 row_newbcast:4 row_mask:0xf bank_mask:0xf
  v_and_b32_dpp v15, v33, v0 row_newbcast:4 row_mask:0xf bank_mask:0xf
  s_nop 1
  v_mfma_f32_16x16x32_bf16 v[8:11], v[12:15], v[56:59], v[8:11]
  s_cmp_eq_u32 s75, 42
  s_cbranch_scc1 L_epi
L_dr42:
  v_and_b32_dpp v12, v33, v34 row_newbcast:5 row_mask:0xf bank_mask:0xf
  v_and_b32_dpp v13, v33, v35 row_newbcast:5 row_mask:0xf bank_mask:0xf
  v_and_b32_dpp v14, v33, v36 row_newbcast:5 row_mask:0xf bank_mask:0xf
  v_and_b32_dpp v15, v33, v0 row_newbcast:5 row_mask:0xf bank_mask:0xf
  s_nop 1
  v_mfma_f32_16x16x32_bf16 v[8:11], v[12:15], v[60:63], v[8:11]
  s_cmp_eq_u32 s75, 43
  s_cbranch_scc1 L_epi
L_epi:
  v_lshrrev_b32 v3, 4, v1
  v_lshl_add_u32 v21, v3, 3, v39
  v_add_u32 v21, s11, v21
  v_mov_b32 v3, 1
  s_nop 3
  v_pk_add_f32 v[8:9], v[8:9], v[4:5]
  v_pk_add_f32 v[10:11], v[10:11], v[6:7]
  s_mov_b32 exec_hi, 0
  ds_write_b128 v21, v[8:11] offset:1024
  s_cmp_eq_u32 s21, 0
  s_cbranch_scc1 L_ep2
  s_mov_b32 exec_hi, 0
  ds_write_b128 v21, v[8:11] offset:6656
  s_mov_b64 exec, 1
  ds_add_u32 v1, v3 offset:304
  s_mov_b64 exec, -1
L_ep2:
  s_mov_b64 exec, 1
  ds_add_u32 v1, v3 offset:308
L_send:
  s_endpgm
L_ks:
  s_cmp_lt_u32 s32, s57
  s_cbranch_scc1 L_kq
  s_call_b64 s[100:101], L_work
L_kq:
  v_readfirstlane_b32 s78, v22
  v_readfirstlane_b32 s79, v23
L_ks2:
  s_mov_b64 exec, 1
  ds_dec_u32 v2, v39 offset:288
  ds_read_b64 v[22:23], v2 offset:288
  s_mov_b64 exec, -1
  s_mul_i32 s68, s35, 11
  s_and_b32 s69, s79, 0xffff
  s_sub_i32 s68, s68, s78
  s_mul_i32 s69, s69, s77
  s_mul_i32 s68, s68, 160
  s_sub_u32 s35, s35, 1
  s_add_i32 s68, s68, s69
  s_add_i32 s68, s68, s34
  s_max_i32 s68, s68, 4915
  s_min_i32 s68, s68, s76
  s_lshr_b32 s37, s68, 12
  s_lshl_b32 s58, s68, 20
L_kl:
  s_add_u32 s32, s32, 1
  s_add_u32 s33, s33, 0x20000000
  s_add_u32 s68, s33, s58
  s_addc_u32 s41, s37, 0
  s_cmp_eq_u32 s41, 3
  s_cbranch_scc1 L_wt3
  s_cmp_eq_u32 s41, 2
  s_cbranch_scc1 L_wt2
  s_cmp_eq_u32 s41, 4
  s_cbranch_scc1 L_wt4
  s_cmp_eq_u32 s41, 1
  s_cbranch_scc1 L_wt1
L_wtx:
  s_cmp_eq_u32 s32, s32
L_wt5:
  s_waitcnt vmcnt(4)
  s_setpc_b64 s[62:63]
L_wt3:
  s_waitcnt vmcnt(2)
  s_setpc_b64 s[62:63]
L_wt2:
  s_waitcnt vmcnt(1)
  s_setpc_b64 s[62:63]
L_wt4:
  s_waitcnt vmcnt(3)
  s_setpc_b64 s[62:63]
L_wt1:
  s_waitcnt vmcnt(0)
  s_setpc_b64 s[62:63]
L_kq2:
  v_readfirstlane_b32 s78, v22
  v_readfirstlane_b32 s79, v23
L_ks3:
  s_mov_b64 exec, 1
  ds_dec_u32 v2, v39 offset:288
  ds_dec_u32 v2, v39 offset:288
  ds_read_b64 v[22:23], v2 offset:288
  s_mov_b64 exec, -1
  s_mul_i32 s68, s35, 11
  s_and_b32 s69, s79, 0xffff
  s_sub_i32 s68, s68, s78
  s_mul_i32 s69, s69, s77
  s_mul_i32 s68, s68, 160
  s_sub_u32 s35, s35, 2
  s_add_i32 s68, s68, s69
  s_add_i32 s68, s68, s34
  s_max_i32 s68, s68, 4915
  s_min_i32 s68, s68, s76
  s_lshr_b32 s37, s68, 12
  s_lshl_b32 s58, s68, 20
  s_branch L_kl
L_vl:
  s_cmp_lt_u32 s32, s36
  s_cbranch_scc1 L_kl
  s_branch L_ev
L_vq2:
  v_readfirstlane_b32 s78, v22
  v_readfirstlane_b32 s79, v23
  s_cmp_lt_u32 s32, s36
  s_cbranch_scc1 L_ks3
  s_branch L_ev
L_vs:
  v_readfirstlane_b32 s78, v22
  v_readfirstlane_b32 s79, v23
  s_cmp_eq_u32 s61, 2
  s_cbranch_scc1 L_vs1
  s_cmp_eq_u32 s61, 1
  s_cbranch_scc1 L_x3
  s_cmp_gt_u32 s41, s32
  s_cbranch_scc1 L_ks2
L_x1:
  s_mov_b64 vcc, s[54:55]
  v_mfma_f32_16x16x32_bf16 v[8:11], v[152:155], v[4:7], 0
  v_mfma_f32_16x16x32_bf16 v[152:155], v[156:159], v[4:7], 0
  v_mfma_f32_16x16x32_bf16 v[156:159], v[160:163], v[4:7], 0
  v_mfma_f32_16x16x32_bf16 v[160:163], v[164:167], v[4:7], 0
  s_nop 4
  v_cndmask_b32_dpp v12, v8, v9, vcc quad_perm:[0,1,2,3] row_mask:0xf bank_mask:0x1
  v_cndmask_b32_dpp v13, v10, v11, vcc quad_perm:[0,1,2,3] row_mask:0xf bank_mask:0x1
  v_cndmask_b32_dpp v12, v152, v153, vcc quad_perm:[0,1,2,3] row_mask:0xf bank_mask:0x4
  v_cndmask_b32_dpp v13, v154, v155, vcc quad_perm:[0,1,2,3] row_mask:0xf bank_mask:0x4
  v_cndmask_b32_dpp v12, v156, v157, vcc quad_perm:[0,1,2,3] row_mask:0xf bank_mask:0x2
  v_cndmask_b32_dpp v13, v158, v159, vcc quad_perm:[0,1,2,3] row_mask:0xf bank_mask:0x2
  v_cndmask_b32_dpp v12, v160, v161, vcc quad_perm:[0,1,2,3] row_mask:0xf bank_mask:0x8
  v_cndmask_b32_dpp v13, v162, v163, vcc quad_perm:[0,1,2,3] row_mask:0xf bank_mask:0x8
  v_cndmask_b32 v19, v12, v13, s[52:53]
  s_lshl_b32 s68, s20, 3
  s_add_u32 s68, s68, s56
  v_add_f32_dpp v16, v16, v16 quad_perm:[2,3,0,1] row_mask:0xf bank_mask:0xf
  v_add_f32_dpp v17, v17, v17 quad_perm:[2,3,0,1] row_mask:0xf bank_mask:0xf
  v_add_f32_dpp v18, v18, v18 quad_perm:[2,3,0,1] row_mask:0xf bank_mask:0xf
  v_add_f32_dpp v19, v19, v19 quad_perm:[2,3,0,1] row_mask:0xf bank_mask:0xf
  v_cndmask_b32 v8, v16, v17, s[52:53]
  v_cndmask_b32 v9, v18, v19, s[52:53]
  v_mov_b32 v20, 64
  v_lshlrev_b32 v21, 3, s9
  v_add_f32_dpp v8, v8, v8 quad_perm:[1,0,3,2] row_mask:0xf bank_mask:0xf
  v_add_f32_dpp v9, v9, v9 quad_perm:[1,0,3,2] row_mask:0xf bank_mask:0xf
  v_cndmask_b32 v27, v8, v9, s[54:55]
  v_cvt_pk_bf16_f32 v27, 0, v27
  v_mul_f32 v27, 0x3db504f3, v27
  v_cvt_pk_bf16_f32 v27, 0, v27
  v_max_f32 v37, v37, v27
  v_cmp_ngt_f32 vcc, s22, v27
  v_mov_b32 v4, 0
  v_max_f32_dpp v37, v37, v37 row_ror:8 row_mask:0xf bank_mask:0xf
  s_bcnt1_i32_b64 s69, vcc
  s_add_u32 s69, s69, s20
  v_max_f32_dpp v37, v37, v37 row_ror:4 row_mask:0xf bank_mask:0xf
  s_cmp_gt_u32 s69, 32
  s_cselect_b32 s21, 1, s21
  v_max_f32_dpp v37, v37, v37 row_ror:2 row_mask:0xf bank_mask:0xf
  s_cmp_eq_u32 s21, 0
  s_cselect_b64 s[66:67], vcc, 0
  s_cselect_b32 s20, s69, s20
  v_max_f32_dpp v37, v37, v37 row_ror:1 row_mask:0xf bank_mask:0xf
  v_mbcnt_lo_u32_b32 v3, s66, 0
  v_mov_b32 v8, v37
  v_mbcnt_hi_u32_b32 v3, s67, v3
  v_lshl_add_u32 v3, v3, 3, s68
  v_permlane16_swap_b32 v8, v37
  s_mov_b64 exec, s[66:67]
  ds_write_b64 v3, v[26:27] offset:1280
  s_mov_b64 exec, -1
  ds_read_b32 v32, v39 offset:1024
  v_max_f32 v37, v37, v8
  v_mov_b32 v8, v37
  v_mov_b32 v5, 0
  s_mov_b32 s18, s32
  v_permlane32_swap_b32 v8, v37
  v_max_f32 v37, v37, v8
  v_sub_f32 v17, v25, v37
  v_sub_f32 v18, v27, v37
  v_mul_f32 v17, 0x3fb8aa3b, v17
  v_mul_f32 v18, 0x3fb8aa3b, v18
  v_exp_f32 v17, v17
  v_exp_f32 v18, v18
  s_lshl_b32 s68, s9, 9
  v_lshl_add_u32 v16, v1, 2, s68
  v_add_f32 v17, v17, v18
  s_waitcnt lgkmcnt(0)
  s_cmp_le_u32 s20, 0
  s_cbranch_scc1 L_x2
  v_add_u32_dpp v3, v32, v38 row_newbcast:8 row_mask:0xf bank_mask:0xf
  buffer_load_dwordx4 v[136:139], v3, s[48:51], 0 offen nt
  s_cmp_le_u32 s20, 4
  s_cbranch_scc1 L_x2
  v_add_u32_dpp v3, v32, v38 row_newbcast:9 row_mask:0xf bank_mask:0xf
  buffer_load_dwordx4 v[140:143], v3, s[48:51], 0 offen nt
  s_cmp_le_u32 s20, 8
  s_cbranch_scc1 L_x2
  v_add_u32_dpp v3, v32, v38 row_newbcast:10 row_mask:0xf bank_mask:0xf
  buffer_load_dwordx4 v[144:147], v3, s[48:51], 0 offen nt
  s_cmp_le_u32 s20, 12
  s_cbranch_scc1 L_x2
  v_add_u32_dpp v3, v32, v38 row_newbcast:11 row_mask:0xf bank_mask:0xf
  buffer_load_dwordx4 v[148:151], v3, s[48:51], 0 offen nt
  s_cmp_le_u32 s20, 16
  s_cbranch_scc1 L_x2
  v_add_u32_dpp v3, v32, v38 row_newbcast:12 row_mask:0xf bank_mask:0xf
  buffer_load_dwordx4 v[152:155], v3, s[48:51], 0 offen nt
  s_cmp_le_u32 s20, 20
  s_cbranch_scc1 L_x2
  v_add_u32_dpp v3, v32, v38 row_newbcast:13 row_mask:0xf bank_mask:0xf
  buffer_load_dwordx4 v[156:159], v3, s[48:51], 0 offen nt
  s_cmp_le_u32 s20, 24
  s_cbranch_scc1 L_x2
  v_add_u32_dpp v3, v32, v38 row_newbcast:14 row_mask:0xf bank_mask:0xf
  buffer_load_dwordx4 v[160:163], v3, s[48:51], 0 offen nt
  s_cmp_le_u32 s20, 28
  s_cbranch_scc1 L_x2
  v_add_u32_dpp v3, v32, v38 row_newbcast:15 row_mask:0xf bank_mask:0xf
  buffer_load_dwordx4 v[164:167], v3, s[48:51], 0 offen nt
L_x2:
  ds_write_b32 v16, v17 offset:1024
  s_mov_b64 exec, 1
  ds_write_b32 v21, v37 offset:512
  ds_add_u32 v1, v20 offset:272
  s_mov_b64 exec, -1
  s_mov_b32 s61, 1
  s_mov_b32 s19, 1
  s_add_i32 s34, s34, 820
  s_cmp_lt_u32 s32, 5
  s_cbranch_scc1 L_ks2
L_x3:
  v_max_f32 v21, s23, v37
  s_add_u32 s38, s38, 3
  s_lshr_b32 s38, s38, 2
  v_add_f32 v21, 0xc2a60000, v21
  s_max_u32 s38, s38, s32
  s_lshl_b32 s38, s38, 2
  v_cmp_nlt_f32 vcc, v27, v21
  s_lshl_b32 s68, s38, 3
  s_add_u32 s68, s68, s56
  s_andn2_b64 s[70:71], vcc, s[66:67]
  v_mbcnt_lo_u32_b32 v3, s70, 0
  v_mbcnt_hi_u32_b32 v3, s71, v3
  s_bcnt1_i32_b64 s69, s[70:71]
  v_lshl_add_u32 v3, v3, 3, s68
  s_mov_b64 exec, s[70:71]
  ds_write_b64 v3, v[26:27]
  s_mov_b64 exec, -1
  s_or_b64 s[66:67], s[66:67], s[70:71]
  s_add_u32 s38, s38, s69
  ds_read_b64 v[28:29], v39 offset:0
  ds_read_b64 v[30:31], v39 offset:512
  ds_read_b64 v[32:33], v39 offset:1024
  v_mov_b32 v8, 0
  v_mov_b32 v9, 0
  v_mov_b32 v10, 0
  v_mov_b32 v11, 0
  v_mov_b32 v6, 0
  v_mov_b32 v7, 0
  s_lshr_b32 s36, s38, 2
  s_mov_b32 s61, 2
  s_add_u32 s68, s38, 13
  s_lshr_b32 s68, s68, 2
  s_sub_u32 s69, s68, s59
  s_mov_b32 s59, s68
  s_add_u32 s35, s35, s69
  s_add_u32 s78, s78, s69
  v_mov_b32 v3, s69
  s_mov_b64 exec, 1
  ds_add_u32 v1, v3 offset:296
  ds_add_u32 v1, v3 offset:300
  s_mov_b64 exec, -1
  s_waitcnt lgkmcnt(0)
  v_sub_f32 v29, v29, v37
  v_sub_f32 v31, v31, v37
  v_sub_f32 v33, v33, v37
  v_mul_f32 v29, 0x3fb8aa3b, v29
  v_mul_f32 v31, 0x3fb8aa3b, v31
  v_mul_f32 v33, 0x3fb8aa3b, v33
  v_exp_f32 v29, v29
  v_exp_f32 v31, v31
  v_exp_f32 v33, v33
  s_nop 0
  v_cvt_pk_bf16_f32 v29, v29, v29
  v_cvt_pk_bf16_f32 v31, v31, v31
  v_cvt_pk_bf16_f32 v33, v33, v33
  s_cmp_eq_u32 s20, 0
  s_cselect_b32 s41, 0, s41
L_vs1:
  s_cmp_eq_u32 s19, 0
  s_cbranch_scc1 L_vs1b
  s_sub_u32 s68, s32, s18
  s_cmp_le_u32 s41, s68
  s_cbranch_scc1 L_snap
  s_cmp_lt_u32 s32, s36
  s_cbranch_scc1 L_ks2
  s_waitcnt vmcnt(0)
L_snap:
  s_cmp_le_u32 s20, 0
  s_cbranch_scc1 L_snp2
  v_and_b32_dpp v12, v33, v34 row_newbcast:8 row_mask:0xf bank_mask:0xf
  v_and_b32_dpp v13, v33, v35 row_newbcast:8 row_mask:0xf bank_mask:0xf
  v_and_b32_dpp v14, v33, v36 row_newbcast:8 row_mask:0xf bank_mask:0xf
  v_and_b32_dpp v15, v33, v0 row_newbcast:8 row_mask:0xf bank_mask:0xf
  s_nop 1
  v_mfma_f32_16x16x32_bf16 v[4:7], v[12:15], v[136:139], v[4:7]
  s_cmp_le_u32 s20, 4
  s_cbranch_scc1 L_snp2
  v_and_b32_dpp v12, v33, v34 row_newbcast:9 row_mask:0xf bank_mask:0xf
  v_and_b32_dpp v13, v33, v35 row_newbcast:9 row_mask:0xf bank_mask:0xf
  v_and_b32_dpp v14, v33, v36 row_newbcast:9 row_mask:0xf bank_mask:0xf
  v_and_b32_dpp v15, v33, v0 row_newbcast:9 row_mask:0xf bank_mask:0xf
  s_nop 1
  v_mfma_f32_16x16x32_bf16 v[4:7], v[12:15], v[140:143], v[4:7]
  s_cmp_le_u32 s20, 8
  s_cbranch_scc1 L_snp2
  v_and_b32_dpp v12, v33, v34 row_newbcast:10 row_mask:0xf bank_mask:0xf
  v_and_b32_dpp v13, v33, v35 row_newbcast:10 row_mask:0xf bank_mask:0xf
  v_and_b32_dpp v14, v33, v36 row_newbcast:10 row_mask:0xf bank_mask:0xf
  v_and_b32_dpp v15, v33, v0 row_newbcast:10 row_mask:0xf bank_mask:0xf
  s_nop 1
  v_mfma_f32_16x16x32_bf16 v[4:7], v[12:15], v[144:147], v[4:7]
  s_cmp_le_u32 s20, 12
  s_cbranch_scc1 L_snp2
  v_and_b32_dpp v12, v33, v34 row_newbcast:11 row_mask:0xf bank_mask:0xf
  v_and_b32_dpp v13, v33, v35 row_newbcast:11 row_mask:0xf bank_mask:0xf
  v_and_b32_dpp v14, v33, v36 row_newbcast:11 row_mask:0xf bank_mask:0xf
  v_and_b32_dpp v15, v33, v0 row_newbcast:11 row_mask:0xf bank_mask:0xf
  s_nop 1
  v_mfma_f32_16x16x32_bf16 v[4:7], v[12:15], v[148:151], v[4:7]
  s_cmp_le_u32 s20, 16
  s_cbranch_scc1 L_snp2
  v_and_b32_dpp v12, v33, v34 row_newbcast:12 row_mask:0xf bank_mask:0xf
  v_and_b32_dpp v13, v33, v35 row_newbcast:12 row_mask:0xf bank_mask:0xf
  v_and_b32_dpp v14, v33, v36 row_newbcast:12 row_mask:0xf bank_mask:0xf
  v_and_b32_dpp v15, v33, v0 row_newbcast:12 row_mask:0xf bank_mask:0xf
  s_nop 1
  v_mfma_f32_16x16x32_bf16 v[4:7], v[12:15], v[152:155], v[4:7]
  s_cmp_le_u32 s20, 20
  s_cbranch_scc1 L_snp2
  v_and_b32_dpp v12, v33, v34 row_newbcast:13 row_mask:0xf bank_mask:0xf
  v_and_b32_dpp v13, v33, v35 row_newbcast:13 row_mask:0xf bank_mask:0xf
  v_and_b32_dpp v14, v33, v36 row_newbcast:13 row_mask:0xf bank_mask:0xf
  v_and_b32_dpp v15, v33, v0 row_newbcast:13 row_mask:0xf bank_mask:0xf
  s_nop 1
  v_mfma_f32_16x16x32_bf16 v[4:7], v[12:15], v[156:159], v[4:7]
  s_cmp_le_u32 s20, 24
  s_cbranch_scc1 L_snp2
  v_and_b32_dpp v12, v33, v34 row_newbcast:14 row_mask:0xf bank_mask:0xf
  v_and_b32_dpp v13, v33, v35 row_newbcast:14 row_mask:0xf bank_mask:0xf
  v_and_b32_dpp v14, v33, v36 row_newbcast:14 row_mask:0xf bank_mask:0xf
  v_and_b32_dpp v15, v33, v0 row_newbcast:14 row_mask:0xf bank_mask:0xf
  s_nop 1
  v_mfma_f32_16x16x32_bf16 v[4:7], v[12:15], v[160:163], v[4:7]
  s_cmp_le_u32 s20, 28
  s_cbranch_scc1 L_snp2
  v_and_b32_dpp v12, v33, v34 row_newbcast:15 row_mask:0xf bank_mask:0xf
  v_and_b32_dpp v13, v33, v35 row_newbcast:15 row_mask:0xf bank_mask:0xf
  v_and_b32_dpp v14, v33, v36 row_newbcast:15 row_mask:0xf bank_mask:0xf
  v_and_b32_dpp v15, v33, v0 row_newbcast:15 row_mask:0xf bank_mask:0xf
  s_nop 1
  v_mfma_f32_16x16x32_bf16 v[4:7], v[12:15], v[164:167], v[4:7]
L_snp2:
  v_lshrrev_b32 v3, 4, v1
  v_lshl_add_u32 v21, v3, 3, v39
  v_add_u32 v21, s11, v21
  v_mov_b32 v3, 1
  s_nop 0
  s_mov_b32 s19, 0
  s_sub_i32 s34, s34, 2458
  s_mov_b32 s76, 20480
  s_cmp_lg_u32 s21, 0
  s_cbranch_scc1 L_vs1b
  s_mov_b32 exec_hi, 0
  ds_write_b128 v21, v[4:7] offset:6656
  s_mov_b64 exec, 1
  ds_add_u32 v1, v3 offset:304
  s_mov_b64 exec, -1
  s_branch L_vs1b
L_vq:
  v_readfirstlane_b32 s78, v22
  v_readfirstlane_b32 s79, v23
L_vs1b:
L_vs2:
  s_cmp_lt_u32 s32, s36
  s_cbranch_scc1 L_ks2
L_ev:
  s_cmp_eq_u32 s75, 0
  s_cbranch_scc1 L_hand
  s_add_u32 s68, s32, 5
  s_cmp_lt_u32 s68, s75
  s_cbranch_scc0 L_wt1
  s_add_u32 s32, s32, 1
  s_mov_b64 exec, 1
  ds_dec_u32 v2, v39 offset:288
  s_mov_b64 exec, -1
  s_branch L_wtx
L_hand:
  v_mov_b32 v3, 0
  s_mov_b32 s70, 0
L_sn_1:
  ds_read_b64 v[18:19], v3 offset:272
  s_waitcnt lgkmcnt(0)
  v_cmp_gt_u32 vcc, 0x102c0, v18
  s_cmp_eq_u64 vcc, 0
  s_cbranch_scc1 L_snd_2
  s_sleep 1
  s_add_u32 s70, s70, 1
  s_cmp_lt_u32 s70, 2097152
  s_cbranch_scc1 L_sn_1
L_snd_2:
  v_add_f32 v21, 0xc2ba0000, v19
  v_cmp_nlt_f32 vcc, v25, v21
  s_lshl_b32 s68, s38, 3
  s_add_u32 s68, s68, s56
  s_andn2_b64 s[70:71], vcc, s[64:65]
  v_mbcnt_lo_u32_b32 v3, s70, 0
  v_mbcnt_hi_u32_b32 v3, s71, v3
  s_bcnt1_i32_b64 s69, s[70:71]
  v_lshl_add_u32 v3, v3, 3, s68
  s_mov_b64 exec, s[70:71]
  ds_write_b64 v3, v[24:25]
  s_mov_b64 exec, -1
  s_or_b64 s[64:65], s[64:65], s[70:71]
  s_add_u32 s38, s38, s69
  v_cmp_nlt_f32 vcc, v27, v21
  s_lshl_b32 s68, s38, 3
  s_add_u32 s68, s68, s56
  s_andn2_b64 s[70:71], vcc, s[66:67]
  v_mbcnt_lo_u32_b32 v3, s70, 0
  v_mbcnt_hi_u32_b32 v3, s71, v3
  s_bcnt1_i32_b64 s69, s[70:71]
  v_lshl_add_u32 v3, v3, 3, s68
  s_mov_b64 exec, s[70:71]
  ds_write_b64 v3, v[26:27]
  s_mov_b64 exec, -1
  s_or_b64 s[66:67], s[66:67], s[70:71]
  s_add_u32 s38, s38, s69
  ds_read_b64 v[28:29], v39 offset:0
  ds_read_b64 v[30:31], v39 offset:512
  ds_read_b64 v[32:33], v39 offset:1024
  s_add_u32 s75, s38, 23
  s_lshr_b32 s75, s75, 2
  s_sub_u32 s36, s75, 8
  s_max_i32 s36, s36, 0
  s_add_u32 s68, s38, 3
  s_lshr_b32 s68, s68, 2
  s_sub_u32 s69, s68, s59
  s_mov_b32 s59, s68
  s_add_u32 s35, s35, s69
  s_add_u32 s78, s78, s69
  v_mov_b32 v3, s69
  s_mov_b64 exec, 1
  ds_add_u32 v1, v3 offset:296
  ds_add_u32 v1, v3 offset:300
  s_mov_b64 exec, -1
  s_waitcnt lgkmcnt(0)
  v_sub_f32 v29, v29, v37
  v_sub_f32 v31, v31, v37
  v_sub_f32 v33, v33, v37
  v_mul_f32 v29, 0x3fb8aa3b, v29
  v_mul_f32 v31, 0x3fb8aa3b, v31
  v_mul_f32 v33, 0x3fb8aa3b, v33
  v_exp_f32 v29, v29
  v_exp_f32 v31, v31
  v_exp_f32 v33, v33
  s_nop 0
  v_cvt_pk_bf16_f32 v29, v29, v29
  v_cvt_pk_bf16_f32 v31, v31, v31
  v_cvt_pk_bf16_f32 v33, v33, v33
  s_branch L_vs2
L_work:
  s_cmp_eq_u32 s39, 4
  s_cbranch_scc1 L_w3
  s_cmp_eq_u32 s39, 3
  s_cbranch_scc1 L_w2b
  s_cmp_eq_u32 s39, 5
  s_cbranch_scc1 L_w5
L_w2:
  v_and_b32 v3, 0xf0, v0
  ds_read_b128 v[4:7], v3 offset:0
  s_waitcnt lgkmcnt(0)
  v_max3_u32 v8, v4, v5, v6
  v_max_u32 v8, v8, v7
  v_cmp_eq_u32 vcc, -1, v8
  s_cmp_lg_u64 vcc, 0
  s_cbranch_scc1 L_wr
  s_mov_b64 vcc, s[54:55]
  v_mfma_f32_16x16x32_bf16 v[8:11], v[40:43], v[4:7], 0
  v_mfma_f32_16x16x32_bf16 v[40:43], v[44:47], v[4:7], 0
  v_mfma_f32_16x16x32_bf16 v[44:47], v[48:51], v[4:7], 0
  v_mfma_f32_16x16x32_bf16 v[48:51], v[52:55], v[4:7], 0
  v_mfma_f32_16x16x32_bf16 v[52:55], v[56:59], v[4:7], 0
  v_mfma_f32_16x16x32_bf16 v[56:59], v[60:63], v[4:7], 0
  v_mfma_f32_16x16x32_bf16 v[60:63], v[64:67], v[4:7], 0
  v_mfma_f32_16x16x32_bf16 v[64:67], v[68:71], v[4:7], 0
  s_nop 0
  v_cndmask_b32_dpp v12, v8, v9, vcc quad_perm:[0,1,2,3] row_mask:0xf bank_mask:0x1
  v_cndmask_b32_dpp v13, v10, v11, vcc quad_perm:[0,1,2,3] row_mask:0xf bank_mask:0x1
  v_cndmask_b32_dpp v12, v40, v41, vcc quad_perm:[0,1,2,3] row_mask:0xf bank_mask:0x4
  v_cndmask_b32_dpp v13, v42, v43, vcc quad_perm:[0,1,2,3] row_mask:0xf bank_mask:0x4
  v_cndmask_b32_dpp v12, v44, v45, vcc quad_perm:[0,1,2,3] row_mask:0xf bank_mask:0x2
  v_cndmask_b32_dpp v13, v46, v47, vcc quad_perm:[0,1,2,3] row_mask:0xf bank_mask:0x2
  v_cndmask_b32_dpp v12, v48, v49, vcc quad_perm:[0,1,2,3] row_mask:0xf bank_mask:0x8
  v_cndmask_b32_dpp v13, v50, v51, vcc quad_perm:[0,1,2,3] row_mask:0xf bank_mask:0x8
  v_cndmask_b32 v16, v12, v13, s[52:53]
  v_cndmask_b32_dpp v12, v52, v53, vcc quad_perm:[0,1,2,3] row_mask:0xf bank_mask:0x1
  v_cndmask_b32_dpp v13, v54, v55, vcc quad_perm:[0,1,2,3] row_mask:0xf bank_mask:0x1
  v_cndmask_b32_dpp v12, v56, v57, vcc quad_perm:[0,1,2,3] row_mask:0xf bank_mask:0x4
  v_cndmask_b32_dpp v13, v58, v59, vcc quad_perm:[0,1,2,3] row_mask:0xf bank_mask:0x4
  v_cndmask_b32_dpp v12, v60, v61, vcc quad_perm:[0,1,2,3] row_mask:0xf bank_mask:0x2
  v_cndmask_b32_dpp v13, v62, v63, vcc quad_perm:[0,1,2,3] row_mask:0xf bank_mask:0x2
  v_cndmask_b32_dpp v12, v64, v65, vcc quad_perm:[0,1,2,3] row_mask:0xf bank_mask:0x8
  v_cndmask_b32_dpp v13, v66, v67, vcc quad_perm:[0,1,2,3] row_mask:0xf bank_mask:0x8
  v_cndmask_b32 v17, v12, v13, s[52:53]
  s_mov_b32 s39, 3
  s_mov_b32 s57, 17
L_wr:
  s_setpc_b64 s[100:101]
L_w2b:
  s_add_u32 s68, s41, 16
  s_cmp_lt_u32 s32, s68
  s_cbranch_scc1 L_wr
  s_mov_b64 vcc, s[54:55]
  v_mfma_f32_16x16x32_bf16 v[8:11], v[72:75], v[4:7], 0
  v_mfma_f32_16x16x32_bf16 v[72:75], v[76:79], v[4:7], 0
  v_mfma_f32_16x16x32_bf16 v[76:79], v[80:83], v[4:7], 0
  v_mfma_f32_16x16x32_bf16 v[80:83], v[84:87], v[4:7], 0
  v_mfma_f32_16x16x32_bf16 v[84:87], v[88:91], v[4:7], 0
  v_mfma_f32_16x16x32_bf16 v[88:91], v[92:95], v[4:7], 0
  v_mfma_f32_16x16x32_bf16 v[92:95], v[96:99], v[4:7], 0
  v_mfma_f32_16x16x32_bf16 v[96:99], v[100:103], v[4:7], 0
  s_nop 0
  v_cndmask_b32_dpp v12, v8, v9, vcc quad_perm:[0,1,2,3] row_mask:0xf bank_mask:0x1
  v_cndmask_b32_dpp v13, v10, v11, vcc quad_perm:[0,1,2,3] row_mask:0xf bank_mask:0x1
  v_cndmask_b32_dpp v12, v72, v73, vcc quad_perm:[0,1,2,3] row_mask:0xf bank_mask:0x4
  v_cndmask_b32_dpp v13, v74, v75, vcc quad_perm:[0,1,2,3] row_mask:0xf bank_mask:0x4
  v_cndmask_b32_dpp v12, v76, v77, vcc quad_perm:[0,1,2,3] row_mask:0xf bank_mask:0x2
  v_cndmask_b32_dpp v13, v78, v79, vcc quad_perm:[0,1,2,3] row_mask:0xf bank_mask:0x2
  v_cndmask_b32_dpp v12, v80, v81, vcc quad_perm:[0,1,2,3] row_mask:0xf bank_mask:0x8
  v_cndmask_b32_dpp v13, v82, v83, vcc quad_perm:[0,1,2,3] row_mask:0xf bank_mask:0x8
  v_cndmask_b32 v18, v12, v13, s[52:53]
  v_cndmask_b32_dpp v12, v84, v85, vcc quad_perm:[0,1,2,3] row_mask:0xf bank_mask:0x1
  v_cndmask_b32_dpp v13, v86, v87, vcc quad_perm:[0,1,2,3] row_mask:0xf bank_mask:0x1
  v_cndmask_b32_dpp v12, v88, v89, vcc quad_perm:[0,1,2,3] row_mask:0xf bank_mask:0x4
  v_cndmask_b32_dpp v13, v90, v91, vcc quad_perm:[0,1,2,3] row_mask:0xf bank_mask:0x4
  v_cndmask_b32_dpp v12, v92, v93, vcc quad_perm:[0,1,2,3] row_mask:0xf bank_mask:0x2
  v_cndmask_b32_dpp v13, v94, v95, vcc quad_perm:[0,1,2,3] row_mask:0xf bank_mask:0x2
  v_cndmask_b32_dpp v12, v96, v97, vcc quad_perm:[0,1,2,3] row_mask:0xf bank_mask:0x8
  v_cndmask_b32_dpp v13, v98, v99, vcc quad_perm:[0,1,2,3] row_mask:0xf bank_mask:0x8
  v_cndmask_b32 v19, v12, v13, s[52:53]
  v_mov_b32 v3, 0
  v_mov_b32 v20, 64
  v_add_f32_dpp v16, v16, v16 quad_perm:[2,3,0,1] row_mask:0xf bank_mask:0xf
  v_add_f32_dpp v17, v17, v17 quad_perm:[2,3,0,1] row_mask:0xf bank_mask:0xf
  v_add_f32_dpp v18, v18, v18 quad_perm:[2,3,0,1] row_mask:0xf bank_mask:0xf
  v_add_f32_dpp v19, v19, v19 quad_perm:[2,3,0,1] row_mask:0xf bank_mask:0xf
  v_cndmask_b32 v8, v16, v17, s[52:53]
  v_cndmask_b32 v9, v18, v19, s[52:53]
  s_nop 0
  v_lshlrev_b32 v21, 3, s9
  v_add_f32_dpp v8, v8, v8 quad_perm:[1,0,3,2] row_mask:0xf bank_mask:0xf
  v_add_f32_dpp v9, v9, v9 quad_perm:[1,0,3,2] row_mask:0xf bank_mask:0xf
  v_cndmask_b32 v25, v8, v9, s[54:55]
  v_cvt_pk_bf16_f32 v25, 0, v25
  v_mul_f32 v25, 0x3db504f3, v25
  v_cvt_pk_bf16_f32 v25, 0, v25
  v_cmp_gt_u32 vcc, s46, v24
  v_mov_b32 v37, 0xff800000
  s_nop 0
  v_cndmask_b32 v25, v37, v25, vcc
  v_mov_b32 v37, v25
  s_nop 1
  v_max_f32_dpp v37, v37, v37 row_ror:8 row_mask:0xf bank_mask:0xf
  s_nop 1
  v_max_f32_dpp v37, v37, v37 row_ror:4 row_mask:0xf bank_mask:0xf
  s_nop 1
  v_max_f32_dpp v37, v37, v37 row_ror:2 row_mask:0xf bank_mask:0xf
  s_nop 1
  v_max_f32_dpp v37, v37, v37 row_ror:1 row_mask:0xf bank_mask:0xf
  v_mov_b32 v8, v37
  s_nop 1
  v_permlane16_swap_b32 v8, v37
  v_max_f32 v37, v37, v8
  v_mov_b32 v8, v37
  s_nop 1
  v_permlane32_swap_b32 v8, v37
  v_max_f32 v37, v37, v8
  s_mov_b64 exec, 1
  ds_max_f32 v3, v37 offset:284
  ds_add_u32 v3, v20 offset:280
  s_mov_b64 exec, -1
  s_mov_b32 s39, 4
  s_mov_b32 s19, 0
  s_setpc_b64 s[100:101]
L_w5:
  s_add_u32 s68, s41, 24
  s_cmp_lt_u32 s32, s68
  s_cbranch_scc1 L_wr
  s_mov_b64 vcc, s[54:55]
  v_mfma_f32_16x16x32_bf16 v[8:11], v[104:107], v[4:7], 0
  v_mfma_f32_16x16x32_bf16 v[104:107], v[108:111], v[4:7], 0
  v_mfma_f32_16x16x32_bf16 v[108:111], v[112:115], v[4:7], 0
  v_mfma_f32_16x16x32_bf16 v[112:115], v[116:119], v[4:7], 0
  v_mfma_f32_16x16x32_bf16 v[116:119], v[120:123], v[4:7], 0
  v_mfma_f32_16x16x32_bf16 v[120:123], v[124:127], v[4:7], 0
  v_mfma_f32_16x16x32_bf16 v[124:127], v[128:131], v[4:7], 0
  v_mfma_f32_16x16x32_bf16 v[128:131], v[132:135], v[4:7], 0
  s_nop 0
  v_cndmask_b32_dpp v12, v8, v9, vcc quad_perm:[0,1,2,3] row_mask:0xf bank_mask:0x1
  v_cndmask_b32_dpp v13, v10, v11, vcc quad_perm:[0,1,2,3] row_mask:0xf bank_mask:0x1
  v_cndmask_b32_dpp v12, v104, v105, vcc quad_perm:[0,1,2,3] row_mask:0xf bank_mask:0x4
  v_cndmask_b32_dpp v13, v106, v107, vcc quad_perm:[0,1,2,3] row_mask:0xf bank_mask:0x4
  v_cndmask_b32_dpp v12, v108, v109, vcc quad_perm:[0,1,2,3] row_mask:0xf bank_mask:0x2
  v_cndmask_b32_dpp v13, v110, v111, vcc quad_perm:[0,1,2,3] row_mask:0xf bank_mask:0x2
  v_cndmask_b32_dpp v12, v112, v113, vcc quad_perm:[0,1,2,3] row_mask:0xf bank_mask:0x8
  v_cndmask_b32_dpp v13, v114, v115, vcc quad_perm:[0,1,2,3] row_mask:0xf bank_mask:0x8
  v_cndmask_b32 v16, v12, v13, s[52:53]
  v_cndmask_b32_dpp v12, v116, v117, vcc quad_perm:[0,1,2,3] row_mask:0xf bank_mask:0x1
  v_cndmask_b32_dpp v13, v118, v119, vcc quad_perm:[0,1,2,3] row_mask:0xf bank_mask:0x1
  v_cndmask_b32_dpp v12, v120, v121, vcc quad_perm:[0,1,2,3] row_mask:0xf bank_mask:0x4
  v_cndmask_b32_dpp v13, v122, v123, vcc quad_perm:[0,1,2,3] row_mask:0xf bank_mask:0x4
  v_cndmask_b32_dpp v12, v124, v125, vcc quad_perm:[0,1,2,3] row_mask:0xf bank_mask:0x2
  v_cndmask_b32_dpp v13, v126, v127, vcc quad_perm:[0,1,2,3] row_mask:0xf bank_mask:0x2
  v_cndmask_b32_dpp v12, v128, v129, vcc quad_perm:[0,1,2,3] row_mask:0xf bank_mask:0x8
  v_cndmask_b32_dpp v13, v130, v131, vcc quad_perm:[0,1,2,3] row_mask:0xf bank_mask:0x8
  v_cndmask_b32 v17, v12, v13, s[52:53]
  s_mov_b32 s39, 6
  s_mov_b32 s57, 99
  s_setpc_b64 s[100:101]
L_w3:
  v_mov_b32 v3, 0
  ds_read_b64 v[18:19], v3 offset:280
  s_waitcnt lgkmcnt(0)
  v_cmp_gt_u32 vcc, 0x102c0, v18
  s_cmp_lg_u64 vcc, 0
  s_cbranch_scc1 L_wr
  ds_read_b64 v[20:21], v3 offset:320
  s_waitcnt lgkmcnt(0)
  v_add_f32 v21, 0xc1c00000, v21
  v_cmp_nlt_f32 vcc, v25, v21
  v_readfirstlane_b32 s22, v21
  v_readfirstlane_b32 s23, v20
  s_mov_b32 s20, 0
  s_bcnt1_i32_b64 s68, vcc
  s_cmp_gt_u32 s68, 32
  s_cselect_b32 s21, 1, 0
  s_cbranch_scc1 L_w4
  s_mov_b32 s38, 160
  v_cmp_nlt_f32 vcc, v25, v21
  s_lshl_b32 s68, s38, 3
  s_add_u32 s68, s68, s56
  s_andn2_b64 s[70:71], vcc, s[64:65]
  v_mbcnt_lo_u32_b32 v3, s70, 0
  v_mbcnt_hi_u32_b32 v3, s71, v3
  s_bcnt1_i32_b64 s69, s[70:71]
  v_lshl_add_u32 v3, v3, 3, s68
  s_mov_b64 exec, s[70:71]
  ds_write_b64 v3, v[24:25]
  s_mov_b64 exec, -1
  s_or_b64 s[64:65], s[64:65], s[70:71]
  s_add_u32 s38, s38, s69
  s_mov_b32 s20, s69
  s_mov_b32 s38, 0
L_w4:
  v_add_f32 v21, 0xc2a60000, v20
  v_cmp_nlt_f32 vcc, v25, v21
  s_lshl_b32 s68, s38, 3
  s_add_u32 s68, s68, s56
  s_andn2_b64 s[70:71], vcc, s[64:65]
  v_mbcnt_lo_u32_b32 v3, s70, 0
  v_mbcnt_hi_u32_b32 v3, s71, v3
  s_bcnt1_i32_b64 s69, s[70:71]
  v_lshl_add_u32 v3, v3, 3, s68
  s_mov_b64 exec, s[70:71]
  ds_write_b64 v3, v[24:25]
  s_mov_b64 exec, -1
  s_or_b64 s[64:65], s[64:65], s[70:71]
  s_add_u32 s38, s38, s69
  s_add_u32 s68, s38, 6
  s_lshr_b32 s68, s68, 1
  s_sub_u32 s69, s68, s59
  s_mov_b32 s59, s68
  v_mov_b32 v3, s69
  s_mov_b64 exec, 1
  ds_add_u32 v1, v3 offset:296
  ds_add_u32 v1, v3 offset:300
  s_mov_b64 exec, -1
  s_sub_i32 s68, s59, 20
  s_max_i32 s68, s68, -4
  s_mul_i32 s68, s68, 245
  s_add_i32 s34, s34, s68
  s_mov_b32 s39, 5
  s_mov_b32 s57, 25
  ds_read_b64 v[28:29], v39 offset:0
  s_waitcnt lgkmcnt(0)
  s_setpc_b64 s[100:101]
L_pub:
  s_getpc_b64 s[56:57]
L_pct:
  s_lshr_b32 s3, s2, 3
  s_lshl_b32 s3, s3, 2
  s_add_u32 s3, s3, L_touch-L_pct
  s_load_dword s14, s[56:57], s3
  s_waitcnt lgkmcnt(0)
  s_bfe_u32 s48, s14, 0x30000
  s_lshl_b32 s48, s48, 6
  v_add_u32 v2, s48, v1
  s_bfe_u32 s48, s14, 0x30003
  s_bitcmp1_b32 s14, 7
  s_cbranch_scc1 L_te_4
  s_bitcmp1_b32 s14, 6
  s_cbranch_scc1 L_tq_3
  s_lshl1_add_u32 s48, s8, s48
  s_lshl_b32 s48, s48, 7
  v_mul_u32_u24 v2, 6144, v2
  v_add_u32 v2, s48, v2
  global_load_dword v167, v2, s[36:37]
  s_branch L_te_4
L_tq_3:
  s_lshl3_add_u32 s48, s8, s48
  s_lshl_b32 s48, s48, 7
  v_lshl_add_u32 v2, v2, 13, s48
  global_load_dword v167, v2, s[22:23]
L_te_4:
  s_bfe_u32 s48, s14, 0x30008
  s_lshl_b32 s48, s48, 6
  v_add_u32 v2, s48, v1
  s_bfe_u32 s48, s14, 0x3000b
  s_bitcmp1_b32 s14, 15
  s_cbranch_scc1 L_te_6
  s_bitcmp1_b32 s14, 14
  s_cbranch_scc1 L_tq_5
  s_lshl1_add_u32 s48, s8, s48
  s_lshl_b32 s48, s48, 7
  v_mul_u32_u24 v2, 6144, v2
  v_add_u32 v2, s48, v2
  global_load_dword v167, v2, s[36:37]
  s_branch L_te_6
L_tq_5:
  s_lshl3_add_u32 s48, s8, s48
  s_lshl_b32 s48, s48, 7
  v_lshl_add_u32 v2, v2, 13, s48
  global_load_dword v167, v2, s[22:23]
L_te_6:
  v_mov_b32 v38, 0
  v_mov_b32 v4, -1
  v_mov_b32 v8, 0xff800000
  v_mov_b32 v9, 0
  v_lshlrev_b32 v2, 3, v1
  ds_write_b64 v2, v[8:9] offset:448
  v_mov_b32 v5, 0
  v_mov_b32 v6, 0
  v_mov_b32 v7, 0
  v_lshlrev_b32 v2, 2, v1
  ds_write_b32 v2, v4 offset:0
  ds_write_b128 v38, v[4:7] offset:256
  v_mov_b32 v10, 0
  v_mov_b32 v11, v8
  v_mov_b32 v12, 0
  v_mov_b32 v13, v8
  ds_write_b128 v38, v[10:13] offset:272
  v_mov_b32 v10, 1332
  v_mov_b32 v11, 0
  v_mov_b32 v12, 1024
  v_mov_b32 v13, 0
  ds_write_b128 v38, v[10:13] offset:288
  v_mov_b32 v4, 0
  ds_write_b128 v38, v[4:7] offset:304
  s_getreg_b32 s76, hwreg(HW_REG_XCC_ID, 0, 4)
  s_waitcnt lgkmcnt(0)
  s_load_dword s74, s[42:43], 0
  s_barrier
  s_waitcnt lgkmcnt(0)
  s_mul_i32 s74, s74, 0x9e3779b1
  s_add_u32 s74, s74, 0x7f4a7c15
  s_add_u32 s76, s76, s74
  s_lshl2_add_u32 s64, s6, s7
  s_lshl_b32 s64, s64, 7
  s_add_u32 s64, s64, 65536
  v_mov_b32 v18, s64
  v_add_u32 v19, 32768, v18
  v_mov_b32 v17, 0x10000
  s_lshl2_add_u32 s49, s6, s7
  s_lshl_b32 s49, s49, 9
  s_add_u32 s49, s49, 131072
  v_and_b32 v10, 3, v1
  v_lshl_add_u32 v10, v10, 7, s49
  v_bfe_u32 v11, v1, 2, 1
  v_mul_u32_u24 v11, 393216, v11
  v_add_u32 v10, v10, v11
  s_mov_b64 exec, 0xff
  global_load_dword v166, v10, s[42:43] sc1
  s_mov_b64 exec, 1
  global_load_dword v166, v18, s[42:43] sc1
  global_load_dword v166, v19, s[42:43] sc1
  s_mov_b64 exec, -1
  s_mov_b32 s70, 0
L_qw_7:
  ds_read_b32 v8, v38 offset:288
  s_waitcnt lgkmcnt(0)
  v_cmp_lt_u32 vcc, 1233, v8
  s_cmp_eq_u64 vcc, 0
  s_cbranch_scc1 L_qw_7d
  s_sleep 4
  s_add_u32 s70, s70, 1
  s_cmp_lt_u32 s70, 2097152
  s_cbranch_scc1 L_qw_7
L_qw_7d:
  s_lshl_b32 s3, s6, 9
  s_mov_b64 exec, 1
  s_mov_b32 s70, 0
L_qp0:
  s_load_dwordx16 s[8:23], s[42:43], s3 offset:32768 glc
  s_load_dwordx16 s[24:39], s[42:43], s3 offset:32832 glc
  s_load_dwordx16 s[44:59], s[42:43], s3 offset:32896 glc
  s_load_dwordx16 s[84:99], s[42:43], s3 offset:32960 glc
  s_mov_b32 s62, -1
  s_mov_b32 s63, 0
  s_waitcnt lgkmcnt(0)
  s_and_b32 s62, s62, s9
  s_or_b32 s63, s63, s9
  s_and_b32 s62, s62, s11
  s_or_b32 s63, s63, s11
  s_and_b32 s62, s62, s13
  s_or_b32 s63, s63, s13
  s_and_b32 s62, s62, s15
  s_or_b32 s63, s63, s15
  s_and_b32 s62, s62, s17
  s_or_b32 s63, s63, s17
  s_and_b32 s62, s62, s19
  s_or_b32 s63, s63, s19
  s_and_b32 s62, s62, s21
  s_or_b32 s63, s63, s21
  s_and_b32 s62, s62, s23
  s_or_b32 s63, s63, s23
  s_and_b32 s62, s62, s25
  s_or_b32 s63, s63, s25
  s_and_b32 s62, s62, s27
  s_or_b32 s63, s63, s27
  s_and_b32 s62, s62, s29
  s_or_b32 s63, s63, s29
  s_and_b32 s62, s62, s31
  s_or_b32 s63, s63, s31
  s_and_b32 s62, s62, s33
  s_or_b32 s63, s63, s33
  s_and_b32 s62, s62, s35
  s_or_b32 s63, s63, s35
  s_and_b32 s62, s62, s37
  s_or_b32 s63, s63, s37
  s_and_b32 s62, s62, s39
  s_or_b32 s63, s63, s39
  s_and_b32 s62, s62, s45
  s_or_b32 s63, s63, s45
  s_and_b32 s62, s62, s47
  s_or_b32 s63, s63, s47
  s_and_b32 s62, s62, s49
  s_or_b32 s63, s63, s49
  s_and_b32 s62, s62, s51
  s_or_b32 s63, s63, s51
  s_and_b32 s62, s62, s53
  s_or_b32 s63, s63, s53
  s_and_b32 s62, s62, s55
  s_or_b32 s63, s63, s55
  s_and_b32 s62, s62, s57
  s_or_b32 s63, s63, s57
  s_and_b32 s62, s62, s59
  s_or_b32 s63, s63, s59
  s_and_b32 s62, s62, s85
  s_or_b32 s63, s63, s85
  s_and_b32 s62, s62, s87
  s_or_b32 s63, s63, s87
  s_and_b32 s62, s62, s89
  s_or_b32 s63, s63, s89
  s_and_b32 s62, s62, s91
  s_or_b32 s63, s63, s91
  s_and_b32 s62, s62, s93
  s_or_b32 s63, s63, s93
  s_and_b32 s62, s62, s95
  s_or_b32 s63, s63, s95
  s_and_b32 s62, s62, s97
  s_or_b32 s63, s63, s97
  s_and_b32 s62, s62, s99
  s_or_b32 s63, s63, s99
  s_xor_b32 s62, s62, s74
  s_xor_b32 s63, s63, s74
  s_or_b32 s62, s62, s63
  s_cbranch_scc0 L_qp0d
  s_sleep 2
  s_add_u32 s70, s70, 1
  s_cmp_lt_u32 s70, 262144
  s_cbranch_scc1 L_qp0
L_qp0d:
  v_mov_b32 v40, s8
  v_mov_b32 v41, s10
  v_mov_b32 v42, s12
  v_mov_b32 v43, s14
  v_mov_b32 v44, s16
  v_mov_b32 v45, s18
  v_mov_b32 v46, s20
  v_mov_b32 v47, s22
  v_mov_b32 v48, s24
  v_mov_b32 v49, s26
  v_mov_b32 v50, s28
  v_mov_b32 v51, s30
  v_mov_b32 v52, s32
  v_mov_b32 v53, s34
  v_mov_b32 v54, s36
  v_mov_b32 v55, s38
  v_mov_b32 v56, s44
  v_mov_b32 v57, s46
  v_mov_b32 v58, s48
  v_mov_b32 v59, s50
  v_mov_b32 v60, s52
  v_mov_b32 v61, s54
  v_mov_b32 v62, s56
  v_mov_b32 v63, s58
  v_mov_b32 v64, s84
  v_mov_b32 v65, s86
  v_mov_b32 v66, s88
  v_mov_b32 v67, s90
  v_mov_b32 v68, s92
  v_mov_b32 v69, s94
  v_mov_b32 v70, s96
  v_mov_b32 v71, s98
  s_mov_b32 s70, 0
L_qp1:
  s_load_dwordx16 s[8:23], s[42:43], s3 offset:33024 glc
  s_load_dwordx16 s[24:39], s[42:43], s3 offset:33088 glc
  s_load_dwordx16 s[44:59], s[42:43], s3 offset:33152 glc
  s_load_dwordx16 s[84:99], s[42:43], s3 offset:33216 glc
  s_mov_b32 s62, -1
  s_mov_b32 s63, 0
  s_waitcnt lgkmcnt(0)
  s_and_b32 s62, s62, s9
  s_or_b32 s63, s63, s9
  s_and_b32 s62, s62, s11
  s_or_b32 s63, s63, s11
  s_and_b32 s62, s62, s13
  s_or_b32 s63, s63, s13
  s_and_b32 s62, s62, s15
  s_or_b32 s63, s63, s15
  s_and_b32 s62, s62, s17
  s_or_b32 s63, s63, s17
  s_and_b32 s62, s62, s19
  s_or_b32 s63, s63, s19
  s_and_b32 s62, s62, s21
  s_or_b32 s63, s63, s21
  s_and_b32 s62, s62, s23
  s_or_b32 s63, s63, s23
  s_and_b32 s62, s62, s25
  s_or_b32 s63, s63, s25
  s_and_b32 s62, s62, s27
  s_or_b32 s63, s63, s27
  s_and_b32 s62, s62, s29
  s_or_b32 s63, s63, s29
  s_and_b32 s62, s62, s31
  s_or_b32 s63, s63, s31
  s_and_b32 s62, s62, s33
  s_or_b32 s63, s63, s33
  s_and_b32 s62, s62, s35
  s_or_b32 s63, s63, s35
  s_and_b32 s62, s62, s37
  s_or_b32 s63, s63, s37
  s_and_b32 s62, s62, s39
  s_or_b32 s63, s63, s39
  s_and_b32 s62, s62, s45
  s_or_b32 s63, s63, s45
  s_and_b32 s62, s62, s47
  s_or_b32 s63, s63, s47
  s_and_b32 s62, s62, s49
  s_or_b32 s63, s63, s49
  s_and_b32 s62, s62, s51
  s_or_b32 s63, s63, s51
  s_and_b32 s62, s62, s53
  s_or_b32 s63, s63, s53
  s_and_b32 s62, s62, s55
  s_or_b32 s63, s63, s55
  s_and_b32 s62, s62, s57
  s_or_b32 s63, s63, s57
  s_and_b32 s62, s62, s59
  s_or_b32 s63, s63, s59
  s_and_b32 s62, s62, s85
  s_or_b32 s63, s63, s85
  s_and_b32 s62, s62, s87
  s_or_b32 s63, s63, s87
  s_and_b32 s62, s62, s89
  s_or_b32 s63, s63, s89
  s_and_b32 s62, s62, s91
  s_or_b32 s63, s63, s91
  s_and_b32 s62, s62, s93
  s_or_b32 s63, s63, s93
  s_and_b32 s62, s62, s95
  s_or_b32 s63, s63, s95
  s_and_b32 s62, s62, s97
  s_or_b32 s63, s63, s97
  s_and_b32 s62, s62, s99
  s_or_b32 s63, s63, s99
  s_xor_b32 s62, s62, s74
  s_xor_b32 s63, s63, s74
  s_or_b32 s62, s62, s63
  s_cbranch_scc0 L_qp1d
  s_sleep 2
  s_add_u32 s70, s70, 1
  s_cmp_lt_u32 s70, 262144
  s_cbranch_scc1 L_qp1
L_qp1d:
  v_mov_b32 v72, s8
  v_mov_b32 v73, s10
  v_mov_b32 v74, s12
  v_mov_b32 v75, s14
  v_mov_b32 v76, s16
  v_mov_b32 v77, s18
  v_mov_b32 v78, s20
  v_mov_b32 v79, s22
  v_mov_b32 v80, s24
  v_mov_b32 v81, s26
  v_mov_b32 v82, s28
  v_mov_b32 v83, s30
  v_mov_b32 v84, s32
  v_mov_b32 v85, s34
  v_mov_b32 v86, s36
  v_mov_b32 v87, s38
  v_mov_b32 v88, s44
  v_mov_b32 v89, s46
  v_mov_b32 v90, s48
  v_mov_b32 v91, s50
  v_mov_b32 v92, s52
  v_mov_b32 v93, s54
  v_mov_b32 v94, s56
  v_mov_b32 v95, s58
  v_mov_b32 v96, s84
  v_mov_b32 v97, s86
  v_mov_b32 v98, s88
  v_mov_b32 v99, s90
  v_mov_b32 v100, s92
  v_mov_b32 v101, s94
  v_mov_b32 v102, s96
  v_mov_b32 v103, s98
  ds_write_b128 v38, v[40:43] offset:0
  ds_write_b128 v38, v[44:47] offset:16
  ds_write_b128 v38, v[48:51] offset:32
  ds_write_b128 v38, v[52:55] offset:48
  ds_write_b128 v38, v[56:59] offset:64
  ds_write_b128 v38, v[60:63] offset:80
  ds_write_b128 v38, v[64:67] offset:96
  ds_write_b128 v38, v[68:71] offset:112
  ds_write_b128 v38, v[72:75] offset:128
  ds_write_b128 v38, v[76:79] offset:144
  ds_write_b128 v38, v[80:83] offset:160
  ds_write_b128 v38, v[84:87] offset:176
  ds_write_b128 v38, v[88:91] offset:192
  ds_write_b128 v38, v[92:95] offset:208
  ds_write_b128 v38, v[96:99] offset:224
  ds_write_b128 v38, v[100:103] offset:240
  s_mov_b64 exec, -1
  s_and_b32 s8, s2, 7
  s_mov_b32 s13, 0
  s_add_u32 s52, s7, 1
  s_cmp_eq_u32 s52, 3
  s_cselect_b32 s52, 0, s52
  s_add_u32 s53, s52, s7
  s_sub_u32 s53, 3, s53
  s_lshl2_add_u32 s54, s6, s52
  s_lshl_b32 s54, s54, 7
  s_lshl2_add_u32 s55, s6, s53
  s_lshl_b32 s55, s55, 7
  s_mov_b32 s70, 0
L_sn_8:
  ds_read_b64 v[8:9], v38 offset:280
  s_waitcnt lgkmcnt(0)
  v_cmp_gt_u32 vcc, 0x2c0, v8
  s_cmp_eq_u64 vcc, 0
  s_cbranch_scc1 L_snd_9
  s_sleep 2
  s_add_u32 s70, s70, 1
  s_cmp_lt_u32 s70, 2097152
  s_cbranch_scc1 L_sn_8
L_snd_9:
  s_load_dwordx2 s[20:21], s[42:43], s54 offset:65536 glc
  s_load_dwordx2 s[24:25], s[42:43], s55 offset:65536 glc
  v_mov_b32 v8, v9
  v_mov_b32 v9, s74
  s_mov_b64 exec, 1
  global_store_dwordx2 v18, v[8:9], s[42:43] sc1
  s_mov_b32 s70, 0
  s_branch L_s3ec
L_s3e:
  s_load_dwordx2 s[20:21], s[42:43], s54 offset:65536 glc
  s_load_dwordx2 s[24:25], s[42:43], s55 offset:65536 glc
L_s3ec:
  s_waitcnt lgkmcnt(0)
  s_xor_b32 s68, s21, s74
  s_xor_b32 s69, s25, s74
  s_or_b32 s68, s68, s69
  s_cbranch_scc0 L_s3ed
  s_sleep 2
  s_add_u32 s70, s70, 1
  s_cmp_lt_u32 s70, 262144
  s_cbranch_scc1 L_s3e
L_s3ed:
  v_mov_b32 v12, s20
  v_max3_f32 v10, v8, v12, s24
  v_min3_f32 v11, v8, v12, s24
  ds_write_b64 v38, v[10:11] offset:320
  ds_add_u32 v38, v17 offset:280
  s_mov_b64 exec, -1
  s_lshl_b32 s64, s8, 7
  s_load_dwordx8 s[20:27], s[42:43], s64 offset:1024 glc
  s_waitcnt lgkmcnt(0)
  s_xor_b32 s68, s20, s76
  s_xor_b32 s69, s21, s76
  s_or_b32 s68, s68, s69
  s_xor_b32 s69, s22, s76
  s_or_b32 s68, s68, s69
  s_xor_b32 s69, s23, s76
  s_or_b32 s68, s68, s69
  s_xor_b32 s69, s24, s76
  s_or_b32 s68, s68, s69
  s_xor_b32 s69, s25, s76
  s_or_b32 s68, s68, s69
  s_xor_b32 s69, s26, s76
  s_or_b32 s68, s68, s69
  s_xor_b32 s69, s27, s76
  s_or_b32 s68, s68, s69
  s_cselect_b32 s75, 0, 1
  v_lshlrev_b32 v20, 3, s7
  v_lshlrev_b32 v21, 3, s52
  v_lshlrev_b32 v22, 3, s53
  v_and_b32 v9, 15, v1
  v_lshlrev_b32 v9, 3, v9
  v_lshlrev_b32 v11, 2, v1
  s_mov_b32 s70, 0
L_sn_10:
  ds_read_b32 v8, v38 offset:272
  s_waitcnt lgkmcnt(0)
  v_cmp_gt_u32 vcc, 0x280, v8
  s_cmp_eq_u64 vcc, 0
  s_cbranch_scc1 L_snd_11
  s_sleep 1
  s_add_u32 s70, s70, 1
  s_cmp_lt_u32 s70, 2097152
  s_cbranch_scc1 L_sn_10
L_snd_11:
  s_mov_b32 s70, 0
L_wt_12:
  ds_read_b32 v8, v38 offset:272
  ds_read_b32 v16, v9 offset:512
  ds_read_b32 v40, v11 offset:1024
  ds_read_b32 v41, v11 offset:1536
  ds_read_b32 v42, v11 offset:2048
  ds_read_b32 v43, v11 offset:2560
  ds_read_b32 v44, v11 offset:3072
  ds_read_b32 v45, v11 offset:3584
  ds_read_b32 v46, v11 offset:4096
  ds_read_b32 v47, v11 offset:4608
  ds_read_b32 v48, v11 offset:5120
  ds_read_b32 v49, v11 offset:5632
  ds_read_b32 v50, v11 offset:6144
  s_waitcnt lgkmcnt(12)
  v_cmp_gt_u32 vcc, 0x2c0, v8
  s_cmp_eq_u64 vcc, 0
  s_cbranch_scc1 L_wtd_13
  s_waitcnt lgkmcnt(0)
  s_add_u32 s70, s70, 1
  s_cmp_lt_u32 s70, 2097152
  s_cbranch_scc1 L_wt_12
L_wtd_13:
  s_waitcnt lgkmcnt(11)
  v_max_f32_dpp v8, v16, v16 quad_perm:[1,0,3,2] row_mask:0xf bank_mask:0xf
  s_nop 1
  v_max_f32_dpp v8, v8, v8 quad_perm:[2,3,0,1] row_mask:0xf bank_mask:0xf
  s_nop 1
  v_max_f32_dpp v8, v8, v8 row_half_mirror row_mask:0xf bank_mask:0xf
  s_nop 1
  v_max_f32_dpp v8, v8, v8 row_mirror row_mask:0xf bank_mask:0xf
  v_sub_f32 v9, v16, v8
  v_mul_f32 v9, 0x3fb8aa3b, v9
  v_exp_f32 v9, v9
  s_waitcnt lgkmcnt(0)
  s_nop 0
  v_mul_f32_dpp v10, v9, v40 row_newbcast:0 row_mask:0xf bank_mask:0xf
  v_mul_f32_dpp v12, v9, v41 row_newbcast:1 row_mask:0xf bank_mask:0xf
  v_fmac_f32_dpp v10, v9, v42 row_newbcast:2 row_mask:0xf bank_mask:0xf
  v_fmac_f32_dpp v12, v9, v43 row_newbcast:3 row_mask:0xf bank_mask:0xf
  v_fmac_f32_dpp v10, v9, v44 row_newbcast:4 row_mask:0xf bank_mask:0xf
  v_fmac_f32_dpp v12, v9, v45 row_newbcast:5 row_mask:0xf bank_mask:0xf
  v_fmac_f32_dpp v10, v9, v46 row_newbcast:6 row_mask:0xf bank_mask:0xf
  v_fmac_f32_dpp v12, v9, v47 row_newbcast:7 row_mask:0xf bank_mask:0xf
  v_fmac_f32_dpp v10, v9, v48 row_newbcast:8 row_mask:0xf bank_mask:0xf
  v_fmac_f32_dpp v12, v9, v49 row_newbcast:9 row_mask:0xf bank_mask:0xf
  v_fmac_f32_dpp v10, v9, v50 row_newbcast:10 row_mask:0xf bank_mask:0xf
  v_add_f32 v10, v10, v12
  s_nop 1
  v_add_f32_dpp v10, v10, v10 row_ror:8 row_mask:0xf bank_mask:0xf
  s_nop 1
  v_add_f32_dpp v10, v10, v10 row_ror:4 row_mask:0xf bank_mask:0xf
  s_nop 1
  v_add_f32_dpp v10, v10, v10 row_ror:2 row_mask:0xf bank_mask:0xf
  s_nop 1
  v_add_f32_dpp v10, v10, v10 row_ror:1 row_mask:0xf bank_mask:0xf
  v_mov_b32 v12, v10
  s_nop 1
  v_permlane16_swap_b32 v12, v10
  v_add_f32 v10, v10, v12
  v_mov_b32 v12, v10
  s_nop 1
  v_permlane32_swap_b32 v12, v10
  v_add_f32 v10, v10, v12
  s_load_dwordx4 s[20:23], s[42:43], s54 offset:98304 glc
  s_load_dwordx4 s[24:27], s[42:43], s55 offset:98304 glc
  v_mov_b32 v9, s74
  v_mov_b32 v11, s74
  s_mov_b64 exec, 1
  global_store_dwordx4 v19, v[8:11], s[42:43] sc1
  ds_write_b32 v20, v8 offset:448
  ds_write_b32 v20, v10 offset:452
  s_mov_b32 s70, 0
  s_branch L_s3pc
L_s3p:
  s_load_dwordx4 s[20:23], s[42:43], s54 offset:98304 glc
  s_load_dwordx4 s[24:27], s[42:43], s55 offset:98304 glc
L_s3pc:
  s_waitcnt lgkmcnt(0)
  s_xor_b32 s68, s21, s74
  s_xor_b32 s69, s23, s74
  s_or_b32 s68, s68, s69
  s_xor_b32 s69, s25, s74
  s_or_b32 s68, s68, s69
  s_xor_b32 s69, s27, s74
  s_or_b32 s68, s68, s69
  s_cbranch_scc0 L_s3pd
  s_sleep 2
  s_add_u32 s70, s70, 1
  s_cmp_lt_u32 s70, 262144
  s_cbranch_scc1 L_s3p
L_s3pd:
  v_mov_b32 v12, s20
  v_mov_b32 v13, s22
  v_mov_b32 v14, s24
  v_mov_b32 v15, s26
  v_max3_f32 v23, v12, v14, v8
  ds_write_b32 v38, v23 offset:276
  ds_add_u32 v38, v17 offset:272
  ds_add_u32 v38, v17 offset:300
  ds_write_b64 v21, v[12:13] offset:448
  ds_write_b64 v22, v[14:15] offset:448
  s_mov_b64 exec, -1
  v_and_b32 v9, 3, v1
  v_lshlrev_b32 v9, 3, v9
  ds_read_b64 v[10:11], v9 offset:448
  s_waitcnt lgkmcnt(0)
  v_max_f32_dpp v8, v10, v10 quad_perm:[1,0,3,2] row_mask:0xf bank_mask:0xf
  s_nop 1
  v_max_f32_dpp v8, v8, v8 quad_perm:[2,3,0,1] row_mask:0xf bank_mask:0xf
  v_sub_f32 v9, v10, v8
  v_mul_f32 v9, 0x3fb8aa3b, v9
  v_exp_f32 v9, v9
  s_nop 0
  v_mul_f32 v10, v9, v11
  s_nop 1
  v_add_f32_dpp v10, v10, v10 quad_perm:[1,0,3,2] row_mask:0xf bank_mask:0xf
  s_nop 1
  v_add_f32_dpp v10, v10, v10 quad_perm:[2,3,0,1] row_mask:0xf bank_mask:0xf
  v_sub_f32 v9, v16, v8
  v_rcp_f32 v10, v10
  v_mul_f32 v9, 0x3fb8aa3b, v9
  v_exp_f32 v9, v9
  v_lshlrev_b32 v8, 2, v1
  v_mul_f32 v9, v9, v10
  s_mov_b64 exec, 0xffff
  ds_write_b32 v8, v9 offset:384
  s_mov_b64 exec, -1
  ds_write_b32 v38, v38 offset:256
  ds_read_b128 v[62:65], v38 offset:384
  ds_read_b128 v[66:69], v38 offset:400
  ds_read_b128 v[70:73], v38 offset:416
  v_lshlrev_b32 v77, 3, v1
  s_lshl2_add_u32 s68, s6, s7
  s_lshl_b32 s68, s68, 9
  s_add_u32 s68, s68, 131072
  v_add_u32 v74, s68, v77
  v_and_b32 v75, 1, v1
  v_lshlrev_b32 v75, 4, v75
  v_lshrrev_b32 v75, v75, s74
  v_lshrrev_b32 v76, 8, v75
  s_mov_b32 s70, 0
L_sn_14:
  ds_read_b32 v8, v38 offset:304
  s_waitcnt lgkmcnt(0)
  v_cmp_gt_u32 vcc, 0xa, v8
  s_cmp_eq_u64 vcc, 0
  s_cbranch_scc1 L_snd_15
  s_sleep 1
  s_add_u32 s70, s70, 1
  s_cmp_lt_u32 s70, 2097152
  s_cbranch_scc1 L_sn_14
L_snd_15:
  s_mov_b32 s70, 0
L_wt_16:
  ds_read_b32 v8, v38 offset:304
  ds_read_b64 v[40:41], v77 offset:6656
  ds_read_b64 v[42:43], v77 offset:7168
  ds_read_b64 v[44:45], v77 offset:7680
  ds_read_b64 v[46:47], v77 offset:8192
  ds_read_b64 v[48:49], v77 offset:8704
  ds_read_b64 v[50:51], v77 offset:9216
  ds_read_b64 v[52:53], v77 offset:9728
  ds_read_b64 v[54:55], v77 offset:10240
  ds_read_b64 v[56:57], v77 offset:10752
  ds_read_b64 v[58:59], v77 offset:11264
  ds_read_b64 v[60:61], v77 offset:11776
  s_waitcnt lgkmcnt(11)
  v_cmp_gt_u32 vcc, 0xb, v8
  s_cmp_eq_u64 vcc, 0
  s_cbranch_scc1 L_wtd_17
  s_waitcnt lgkmcnt(0)
  s_add_u32 s70, s70, 1
  s_cmp_lt_u32 s70, 2097152
  s_cbranch_scc1 L_wt_16
L_wtd_17:
  s_movk_i32 s69, 0xff
  s_waitcnt lgkmcnt(10)
  v_pk_mul_f32 v[40:41], v[40:41], v[62:63] op_sel:[0,0] op_sel_hi:[1,0]
  s_waitcnt lgkmcnt(9)
  v_pk_mul_f32 v[42:43], v[42:43], v[62:63] op_sel:[0,1] op_sel_hi:[1,1]
  s_waitcnt lgkmcnt(8)
  v_pk_fma_f32 v[40:41], v[44:45], v[64:65], v[40:41] op_sel:[0,0,0] op_sel_hi:[1,0,1]
  s_waitcnt lgkmcnt(7)
  v_pk_fma_f32 v[42:43], v[46:47], v[64:65], v[42:43] op_sel:[0,1,0] op_sel_hi:[1,1,1]
  s_waitcnt lgkmcnt(6)
  v_pk_fma_f32 v[40:41], v[48:49], v[66:67], v[40:41] op_sel:[0,0,0] op_sel_hi:[1,0,1]
  s_waitcnt lgkmcnt(5)
  v_pk_fma_f32 v[42:43], v[50:51], v[66:67], v[42:43] op_sel:[0,1,0] op_sel_hi:[1,1,1]
  s_waitcnt lgkmcnt(4)
  v_pk_fma_f32 v[40:41], v[52:53], v[68:69], v[40:41] op_sel:[0,0,0] op_sel_hi:[1,0,1]
  s_waitcnt lgkmcnt(3)
  v_pk_fma_f32 v[42:43], v[54:55], v[68:69], v[42:43] op_sel:[0,1,0] op_sel_hi:[1,1,1]
  s_waitcnt lgkmcnt(2)
  v_pk_fma_f32 v[40:41], v[56:57], v[70:71], v[40:41] op_sel:[0,0,0] op_sel_hi:[1,0,1]
  s_waitcnt lgkmcnt(1)
  v_pk_fma_f32 v[42:43], v[58:59], v[70:71], v[42:43] op_sel:[0,1,0] op_sel_hi:[1,1,1]
  s_waitcnt lgkmcnt(0)
  v_pk_fma_f32 v[40:41], v[60:61], v[72:73], v[40:41] op_sel:[0,0,0] op_sel_hi:[1,0,1]
  v_pk_add_f32 v[40:41], v[40:41], v[42:43]
  v_bfi_b32 v40, s69, v75, v40
  v_bfi_b32 v41, s69, v76, v41
  s_cmp_eq_u32 s75, 1
  s_cbranch_scc0 L_pf_18
  global_store_dwordx2 v74, v[40:41], s[42:43]
  s_branch L_pe_19
L_pf_18:
  global_store_dwordx2 v74, v[40:41], s[42:43] sc1
L_pe_19:
  ds_read_b128 v[102:105], v38 offset:384
  ds_read_b128 v[106:109], v38 offset:400
  ds_read_b128 v[110:113], v38 offset:416
  v_lshlrev_b32 v117, 3, v1
  s_lshl2_add_u32 s68, s6, s7
  s_lshl_b32 s68, s68, 9
  s_add_u32 s68, s68, 524288
  v_add_u32 v114, s68, v117
  v_and_b32 v115, 1, v1
  v_lshlrev_b32 v115, 4, v115
  v_lshrrev_b32 v115, v115, s74
  v_lshrrev_b32 v116, 8, v115
  s_waitcnt vmcnt(0)
  s_mov_b32 s70, 0
L_sn_20:
  ds_read_b32 v8, v38 offset:308
  s_waitcnt lgkmcnt(0)
  v_cmp_gt_u32 vcc, 0x1, v8
  s_cmp_eq_u64 vcc, 0
  s_cbranch_scc1 L_snd_21
  s_sleep 4
  s_add_u32 s70, s70, 1
  s_cmp_lt_u32 s70, 2097152
  s_cbranch_scc1 L_sn_20
L_snd_21:
  global_store_dwordx2 v74, v[40:41], s[42:43] sc1
  s_cmp_eq_u32 s7, 2
  s_cbranch_scc1 L_chk
  s_mov_b32 s70, 0
L_sn_22:
  ds_read_b32 v8, v38 offset:308
  s_waitcnt lgkmcnt(0)
  v_cmp_gt_u32 vcc, 0xa, v8
  s_cmp_eq_u64 vcc, 0
  s_cbranch_scc1 L_snd_23
  s_sleep 1
  s_add_u32 s70, s70, 1
  s_cmp_lt_u32 s70, 2097152
  s_cbranch_scc1 L_sn_22
L_snd_23:
  s_mov_b32 s70, 0
L_wt_24:
  ds_read_b32 v8, v38 offset:308
  ds_read_b64 v[80:81], v117 offset:1024
  ds_read_b64 v[82:83], v117 offset:1536
  ds_read_b64 v[84:85], v117 offset:2048
  ds_read_b64 v[86:87], v117 offset:2560
  ds_read_b64 v[88:89], v117 offset:3072
  ds_read_b64 v[90:91], v117 offset:3584
  ds_read_b64 v[92:93], v117 offset:4096
  ds_read_b64 v[94:95], v117 offset:4608
  ds_read_b64 v[96:97], v117 offset:5120
  ds_read_b64 v[98:99], v117 offset:5632
  ds_read_b64 v[100:101], v117 offset:6144
  s_waitcnt lgkmcnt(11)
  v_cmp_gt_u32 vcc, 0xb, v8
  s_cmp_eq_u64 vcc, 0
  s_cbranch_scc1 L_wtd_25
  s_waitcnt lgkmcnt(0)
  s_add_u32 s70, s70, 1
  s_cmp_lt_u32 s70, 2097152
  s_cbranch_scc1 L_wt_24
L_wtd_25:
  s_movk_i32 s69, 0xff
  s_waitcnt lgkmcnt(10)
  v_pk_mul_f32 v[80:81], v[80:81], v[102:103] op_sel:[0,0] op_sel_hi:[1,0]
  s_waitcnt lgkmcnt(9)
  v_pk_mul_f32 v[82:83], v[82:83], v[102:103] op_sel:[0,1] op_sel_hi:[1,1]
  s_waitcnt lgkmcnt(8)
  v_pk_fma_f32 v[80:81], v[84:85], v[104:105], v[80:81] op_sel:[0,0,0] op_sel_hi:[1,0,1]
  s_waitcnt lgkmcnt(7)
  v_pk_fma_f32 v[82:83], v[86:87], v[104:105], v[82:83] op_sel:[0,1,0] op_sel_hi:[1,1,1]
  s_waitcnt lgkmcnt(6)
  v_pk_fma_f32 v[80:81], v[88:89], v[106:107], v[80:81] op_sel:[0,0,0] op_sel_hi:[1,0,1]
  s_waitcnt lgkmcnt(5)
  v_pk_fma_f32 v[82:83], v[90:91], v[106:107], v[82:83] op_sel:[0,1,0] op_sel_hi:[1,1,1]
  s_waitcnt lgkmcnt(4)
  v_pk_fma_f32 v[80:81], v[92:93], v[108:109], v[80:81] op_sel:[0,0,0] op_sel_hi:[1,0,1]
  s_waitcnt lgkmcnt(3)
  v_pk_fma_f32 v[82:83], v[94:95], v[108:109], v[82:83] op_sel:[0,1,0] op_sel_hi:[1,1,1]
  s_waitcnt lgkmcnt(2)
  v_pk_fma_f32 v[80:81], v[96:97], v[110:111], v[80:81] op_sel:[0,0,0] op_sel_hi:[1,0,1]
  s_waitcnt lgkmcnt(1)
  v_pk_fma_f32 v[82:83], v[98:99], v[110:111], v[82:83] op_sel:[0,1,0] op_sel_hi:[1,1,1]
  s_waitcnt lgkmcnt(0)
  v_pk_fma_f32 v[80:81], v[100:101], v[112:113], v[80:81] op_sel:[0,0,0] op_sel_hi:[1,0,1]
  v_pk_add_f32 v[80:81], v[80:81], v[82:83]
  v_bfi_b32 v80, s69, v115, v80
  v_bfi_b32 v81, s69, v116, v81
  global_store_dwordx2 v114, v[80:81], s[42:43] sc1
  s_branch L_fin
L_chk:
  v_and_b32 v160, 0xff, v75
  v_and_b32 v161, 0xff, v76
  s_lshl_b32 s10, s6, 11
  s_add_u32 s10, s10, 131072
  v_lshl_add_u32 v2, v1, 3, s10
  global_load_dwordx2 v[154:155], v2, s[42:43] offset:0 sc1
  global_load_dwordx2 v[156:157], v2, s[42:43] offset:512 sc1
  v_add_u32 v3, 393216, v2
  s_mov_b32 s70, 0
L_sn_26:
  ds_read_b32 v8, v38 offset:308
  s_waitcnt lgkmcnt(0)
  v_cmp_gt_u32 vcc, 0xa, v8
  s_cmp_eq_u64 vcc, 0
  s_cbranch_scc1 L_snd_27
  s_sleep 1
  s_add_u32 s70, s70, 1
  s_cmp_lt_u32 s70, 2097152
  s_cbranch_scc1 L_sn_26
L_snd_27:
  s_mov_b32 s70, 0
L_wt_28:
  ds_read_b32 v8, v38 offset:308
  ds_read_b64 v[80:81], v117 offset:1024
  ds_read_b64 v[82:83], v117 offset:1536
  ds_read_b64 v[84:85], v117 offset:2048
  ds_read_b64 v[86:87], v117 offset:2560
  ds_read_b64 v[88:89], v117 offset:3072
  ds_read_b64 v[90:91], v117 offset:3584
  ds_read_b64 v[92:93], v117 offset:4096
  ds_read_b64 v[94:95], v117 offset:4608
  ds_read_b64 v[96:97], v117 offset:5120
  ds_read_b64 v[98:99], v117 offset:5632
  ds_read_b64 v[100:101], v117 offset:6144
  s_waitcnt lgkmcnt(11)
  v_cmp_gt_u32 vcc, 0xb, v8
  s_cmp_eq_u64 vcc, 0
  s_cbranch_scc1 L_wtd_29
  s_waitcnt lgkmcnt(0)
  s_add_u32 s70, s70, 1
  s_cmp_lt_u32 s70, 2097152
  s_cbranch_scc1 L_wt_28
L_wtd_29:
  global_load_dwordx2 v[130:131], v3, s[42:43] offset:0 sc1
  global_load_dwordx2 v[132:133], v3, s[42:43] offset:512 sc1
  s_movk_i32 s69, 0xff
  s_waitcnt lgkmcnt(10)
  v_pk_mul_f32 v[80:81], v[80:81], v[102:103] op_sel:[0,0] op_sel_hi:[1,0]
  s_waitcnt lgkmcnt(9)
  v_pk_mul_f32 v[82:83], v[82:83], v[102:103] op_sel:[0,1] op_sel_hi:[1,1]
  s_waitcnt lgkmcnt(8)
  v_pk_fma_f32 v[80:81], v[84:85], v[104:105], v[80:81] op_sel:[0,0,0] op_sel_hi:[1,0,1]
  s_waitcnt lgkmcnt(7)
  v_pk_fma_f32 v[82:83], v[86:87], v[104:105], v[82:83] op_sel:[0,1,0] op_sel_hi:[1,1,1]
  s_waitcnt lgkmcnt(6)
  v_pk_fma_f32 v[80:81], v[88:89], v[106:107], v[80:81] op_sel:[0,0,0] op_sel_hi:[1,0,1]
  s_waitcnt lgkmcnt(5)
  v_pk_fma_f32 v[82:83], v[90:91], v[106:107], v[82:83] op_sel:[0,1,0] op_sel_hi:[1,1,1]
  s_waitcnt lgkmcnt(4)
  v_pk_fma_f32 v[80:81], v[92:93], v[108:109], v[80:81] op_sel:[0,0,0] op_sel_hi:[1,0,1]
  s_waitcnt lgkmcnt(3)
  v_pk_fma_f32 v[82:83], v[94:95], v[108:109], v[82:83] op_sel:[0,1,0] op_sel_hi:[1,1,1]
  s_waitcnt lgkmcnt(2)
  v_pk_fma_f32 v[80:81], v[96:97], v[110:111], v[80:81] op_sel:[0,0,0] op_sel_hi:[1,0,1]
  s_waitcnt lgkmcnt(1)
  v_pk_fma_f32 v[82:83], v[98:99], v[110:111], v[82:83] op_sel:[0,1,0] op_sel_hi:[1,1,1]
  s_waitcnt lgkmcnt(0)
  v_pk_fma_f32 v[80:81], v[100:101], v[112:113], v[80:81] op_sel:[0,0,0] op_sel_hi:[1,0,1]
  v_pk_add_f32 v[80:81], v[80:81], v[82:83]
  v_bfi_b32 v80, s69, v115, v80
  v_bfi_b32 v81, s69, v116, v81
  global_store_dwordx2 v114, v[80:81], s[42:43] sc1
  s_waitcnt vmcnt(1)
  s_mov_b32 s70, 0
  s_branch L_cp0c
L_cp0:
  global_load_dwordx2 v[154:155], v2, s[42:43] offset:0 sc1
  global_load_dwordx2 v[156:157], v2, s[42:43] offset:512 sc1
  s_sleep 4
  s_waitcnt vmcnt(0)
L_cp0c:
  v_xor_b32 v136, v154, v160
  v_xor_b32 v137, v155, v161
  v_xor_b32 v138, v156, v160
  v_xor_b32 v139, v157, v161
  v_xor_b32 v140, v40, v160
  v_xor_b32 v141, v41, v161
  v_or3_b32 v152, v136, v137, v138
  v_or3_b32 v153, v139, v140, v141
  v_or_b32 v136, 0x80, v136
  v_or_b32 v137, 0x80, v137
  v_or_b32 v138, 0x80, v138
  v_or_b32 v139, 0x80, v139
  v_or_b32 v140, 0x80, v140
  v_or_b32 v141, 0x80, v141
  v_or_b32 v152, v152, v153
  v_pk_add_f32 v[136:137], v[136:137], v[138:139]
  v_lshlrev_b32 v152, 24, v152
  v_pk_add_f32 v[136:137], v[136:137], v[140:141]
  v_cmp_ne_u32 vcc, 0, v152
  v_cvt_pk_bf16_f32 v136, v136, v137
  s_cmp_eq_u64 vcc, 0
  s_cbranch_scc1 L_cp0d
  s_add_u32 s70, s70, 1
  s_cmp_lt_u32 s70, 262144
  s_cbranch_scc1 L_cp0
L_cp0d:
  v_add_u32 v2, 393216, v2
  s_mov_b32 s70, 0
  s_branch L_cp1c
L_cp1:
  global_load_dwordx2 v[130:131], v2, s[42:43] offset:0 sc1
  global_load_dwordx2 v[132:133], v2, s[42:43] offset:512 sc1
  s_waitcnt vmcnt(0)
L_cp1c:
  v_xor_b32 v144, v130, v160
  v_xor_b32 v145, v131, v161
  v_xor_b32 v146, v132, v160
  v_xor_b32 v147, v133, v161
  v_xor_b32 v148, v80, v160
  v_xor_b32 v149, v81, v161
  v_or3_b32 v152, v144, v145, v146
  v_or3_b32 v153, v147, v148, v149
  v_or_b32 v144, 0x80, v144
  v_or_b32 v145, 0x80, v145
  v_or_b32 v146, 0x80, v146
  v_or_b32 v147, 0x80, v147
  v_or_b32 v148, 0x80, v148
  v_or_b32 v149, 0x80, v149
  v_or_b32 v152, v152, v153
  v_pk_add_f32 v[144:145], v[144:145], v[146:147]
  v_lshlrev_b32 v152, 24, v152
  v_pk_add_f32 v[144:145], v[144:145], v[148:149]
  v_cmp_ne_u32 vcc, 0, v152
  v_cvt_pk_bf16_f32 v144, v144, v145
  s_cmp_eq_u64 vcc, 0
  s_cbranch_scc1 L_cp1d
  s_add_u32 s70, s70, 1
  s_cmp_lt_u32 s70, 262144
  s_cbranch_scc1 L_cp1
L_cp1d:
  v_cmp_ne_u32 vcc, v136, v144
  s_cmp_eq_u64 vcc, 0
  s_cbranch_scc1 L_fin
  s_waitcnt vmcnt(0)
L_slow:
  s_mov_b32 s47, 0x20000
  s_load_dwordx16 s[16:31], s[0:1], 0
  s_load_dwordx8 s[32:39], s[0:1], 64
  v_and_b32 v2, 31, v1
  v_lshlrev_b32 v2, 7, v2
  v_add_u32 v2, 28672, v2
  s_mov_b32 s70, 0
L_sl_d:
  global_load_dword v3, v2, s[42:43] sc1
  s_waitcnt vmcnt(0) lgkmcnt(0)
  v_cmp_ne_u32 vcc, s74, v3
  s_cmp_eq_u64 vcc, 0
  s_cbranch_scc1 L_sl_dd
  s_sleep 8
  s_add_u32 s70, s70, 1
  s_cmp_lt_u32 s70, 262144
  s_cbranch_scc1 L_sl_d
L_sl_dd:
  v_lshlrev_b32 v2, 3, v1
  v_add_u32 v2, 524288, v2
  v_lshlrev_b32 v0, 2, v1
  v_add_u32 v0, 12288, v0
  s_mov_b32 s10, 0
L_sl_h:
  s_mov_b32 s70, 0
L_sl_hp:
  global_load_dwordx2 v[40:41], v2, s[42:43] offset:0 sc1
  global_load_dwordx2 v[42:43], v2, s[42:43] offset:512 sc1
  global_load_dwordx2 v[44:45], v2, s[42:43] offset:1024 sc1
  s_waitcnt vmcnt(0)
  v_xor_b32 v40, v40, v160
  v_xor_b32 v41, v41, v161
  v_xor_b32 v42, v42, v160
  v_xor_b32 v43, v43, v161
  v_xor_b32 v44, v44, v160
  v_xor_b32 v45, v45, v161
  v_or3_b32 v48, v40, v41, v42
  v_or3_b32 v49, v43, v44, v45
  v_or_b32 v40, 0x80, v40
  v_or_b32 v41, 0x80, v41
  v_or_b32 v42, 0x80, v42
  v_or_b32 v43, 0x80, v43
  v_or_b32 v44, 0x80, v44
  v_or_b32 v45, 0x80, v45
  v_or_b32 v48, v48, v49
  v_pk_add_f32 v[40:41], v[40:41], v[42:43]
  v_lshlrev_b32 v48, 24, v48
  v_pk_add_f32 v[40:41], v[40:41], v[44:45]
  v_cmp_ne_u32 vcc, 0, v48
  v_cvt_pk_bf16_f32 v40, v40, v41
  s_cmp_eq_u64 vcc, 0
  s_cbranch_scc1 L_sl_hd
  s_sleep 8
  s_add_u32 s70, s70, 1
  s_cmp_lt_u32 s70, 262144
  s_cbranch_scc1 L_sl_hp
L_sl_hd:
  ds_write_b32 v0, v40
  v_add_u32 v2, 2048, v2
  v_add_u32 v0, 256, v0
  s_add_u32 s10, s10, 1
  s_cmp_lt_u32 s10, 64
  s_cbranch_scc1 L_sl_h
  s_mov_b32 s44, s24
  s_mov_b32 s45, s25
  s_mov_b32 s46, 4194304
  s_mov_b32 s11, 1024
  s_mov_b32 s12, 4194304
  v_mov_b32 v4, 12288
  v_mov_b32 v5, 20480
  v_lshlrev_b32 v2, 4, v1
  s_call_b64 s[62:63], L_gv
  v_lshlrev_b32 v0, 4, v1
  global_load_dwordx4 v[40:43], v0, s[16:17] offset:0
  global_load_dwordx4 v[44:47], v0, s[16:17] offset:1024
  s_waitcnt vmcnt(0)
  v_lshlrev_b32 v104, 16, v40
  v_and_b32 v105, s73, v40
  v_lshlrev_b32 v106, 16, v41
  v_and_b32 v107, s73, v41
  v_lshlrev_b32 v108, 16, v42
  v_and_b32 v109, s73, v42
  v_lshlrev_b32 v110, 16, v43
  v_and_b32 v111, s73, v43
  v_lshlrev_b32 v112, 16, v44
  v_and_b32 v113, s73, v44
  v_lshlrev_b32 v114, 16, v45
  v_and_b32 v115, s73, v45
  v_lshlrev_b32 v116, 16, v46
  v_and_b32 v117, s73, v46
  v_lshlrev_b32 v118, 16, v47
  v_and_b32 v119, s73, v47
  v_lshrrev_b32 v2, 1, v1
  v_lshlrev_b32 v2, 7, v2
  v_and_b32 v3, 1, v1
  v_lshl_add_u32 v2, v3, 5, v2
  v_add_u32 v2, 12288, v2
  global_load_dwordx4 v[40:43], v2, s[42:43] offset:0 sc1
  global_load_dwordx4 v[44:47], v2, s[42:43] offset:16 sc1
  global_load_dwordx4 v[48:51], v2, s[42:43] offset:64 sc1
  global_load_dwordx4 v[52:55], v2, s[42:43] offset:80 sc1
  s_waitcnt vmcnt(0)
  v_lshlrev_b32 v88, 16, v40
  v_and_b32 v89, s73, v40
  v_lshlrev_b32 v90, 16, v42
  v_and_b32 v91, s73, v42
  v_lshlrev_b32 v92, 16, v44
  v_and_b32 v93, s73, v44
  v_lshlrev_b32 v94, 16, v46
  v_and_b32 v95, s73, v46
  v_lshlrev_b32 v96, 16, v48
  v_and_b32 v97, s73, v48
  v_lshlrev_b32 v98, 16, v50
  v_and_b32 v99, s73, v50
  v_lshlrev_b32 v100, 16, v52
  v_and_b32 v101, s73, v52
  v_lshlrev_b32 v102, 16, v54
  v_and_b32 v103, s73, v54
  v_cvt_pk_bf16_f32 v72, 0, v72
  v_cvt_pk_bf16_f32 v73, 0, v73
  v_cvt_pk_bf16_f32 v74, 0, v74
  v_cvt_pk_bf16_f32 v75, 0, v75
  v_cvt_pk_bf16_f32 v76, 0, v76
  v_cvt_pk_bf16_f32 v77, 0, v77
  v_cvt_pk_bf16_f32 v78, 0, v78
  v_cvt_pk_bf16_f32 v79, 0, v79
  v_cvt_pk_bf16_f32 v80, 0, v80
  v_cvt_pk_bf16_f32 v81, 0, v81
  v_cvt_pk_bf16_f32 v82, 0, v82
  v_cvt_pk_bf16_f32 v83, 0, v83
  v_cvt_pk_bf16_f32 v84, 0, v84
  v_cvt_pk_bf16_f32 v85, 0, v85
  v_cvt_pk_bf16_f32 v86, 0, v86
  v_cvt_pk_bf16_f32 v87, 0, v87
  v_mul_f32 v72, v72, v88
  v_mul_f32 v73, v73, v89
  v_mul_f32 v74, v74, v90
  v_mul_f32 v75, v75, v91
  v_mul_f32 v76, v76, v92
  v_mul_f32 v77, v77, v93
  v_mul_f32 v78, v78, v94
  v_mul_f32 v79, v79, v95
  v_mul_f32 v80, v80, v96
  v_mul_f32 v81, v81, v97
  v_mul_f32 v82, v82, v98
  v_mul_f32 v83, v83, v99
  v_mul_f32 v84, v84, v100
  v_mul_f32 v85, v85, v101
  v_mul_f32 v86, v86, v102
  v_mul_f32 v87, v87, v103
  v_cvt_pk_bf16_f32 v72, 0, v72
  v_cvt_pk_bf16_f32 v73, 0, v73
  v_cvt_pk_bf16_f32 v74, 0, v74
  v_cvt_pk_bf16_f32 v75, 0, v75
  v_cvt_pk_bf16_f32 v76, 0, v76
  v_cvt_pk_bf16_f32 v77, 0, v77
  v_cvt_pk_bf16_f32 v78, 0, v78
  v_cvt_pk_bf16_f32 v79, 0, v79
  v_cvt_pk_bf16_f32 v80, 0, v80
  v_cvt_pk_bf16_f32 v81, 0, v81
  v_cvt_pk_bf16_f32 v82, 0, v82
  v_cvt_pk_bf16_f32 v83, 0, v83
  v_cvt_pk_bf16_f32 v84, 0, v84
  v_cvt_pk_bf16_f32 v85, 0, v85
  v_cvt_pk_bf16_f32 v86, 0, v86
  v_cvt_pk_bf16_f32 v87, 0, v87
  v_add_f32 v104, v104, v72
  v_add_f32 v105, v105, v73
  v_add_f32 v106, v106, v74
  v_add_f32 v107, v107, v75
  v_add_f32 v108, v108, v76
  v_add_f32 v109, v109, v77
  v_add_f32 v110, v110, v78
  v_add_f32 v111, v111, v79
  v_add_f32 v112, v112, v80
  v_add_f32 v113, v113, v81
  v_add_f32 v114, v114, v82
  v_add_f32 v115, v115, v83
  v_add_f32 v116, v116, v84
  v_add_f32 v117, v117, v85
  v_add_f32 v118, v118, v86
  v_add_f32 v119, v119, v87
  v_cvt_pk_bf16_f32 v104, 0, v104
  v_cvt_pk_bf16_f32 v105, 0, v105
  v_cvt_pk_bf16_f32 v106, 0, v106
  v_cvt_pk_bf16_f32 v107, 0, v107
  v_cvt_pk_bf16_f32 v108, 0, v108
  v_cvt_pk_bf16_f32 v109, 0, v109
  v_cvt_pk_bf16_f32 v110, 0, v110
  v_cvt_pk_bf16_f32 v111, 0, v111
  v_cvt_pk_bf16_f32 v112, 0, v112
  v_cvt_pk_bf16_f32 v113, 0, v113
  v_cvt_pk_bf16_f32 v114, 0, v114
  v_cvt_pk_bf16_f32 v115, 0, v115
  v_cvt_pk_bf16_f32 v116, 0, v116
  v_cvt_pk_bf16_f32 v117, 0, v117
  v_cvt_pk_bf16_f32 v118, 0, v118
  v_cvt_pk_bf16_f32 v119, 0, v119
  v_add_f32 v8, v104, v105
  v_add_f32 v8, v8, v106
  v_add_f32 v8, v8, v107
  v_add_f32 v8, v8, v108
  v_add_f32 v8, v8, v109
  v_add_f32 v8, v8, v110
  v_add_f32 v8, v8, v111
  s_nop 1
  v_add_f32_dpp v8, v8, v8 row_ror:8 row_mask:0xf bank_mask:0xf
  s_nop 1
  v_add_f32_dpp v8, v8, v8 row_ror:4 row_mask:0xf bank_mask:0xf
  s_nop 1
  v_add_f32_dpp v8, v8, v8 row_ror:2 row_mask:0xf bank_mask:0xf
  s_nop 1
  v_add_f32_dpp v8, v8, v8 row_ror:1 row_mask:0xf bank_mask:0xf
  v_mov_b32 v9, v8
  s_nop 1
  v_permlane16_swap_b32 v9, v8
  v_add_f32 v8, v8, v9
  v_mov_b32 v9, v8
  s_nop 1
  v_permlane32_swap_b32 v9, v8
  v_add_f32 v8, v8, v9
  v_mul_f32 v8, 0x3b000000, v8
  v_sub_f32 v72, v104, v8
  v_sub_f32 v73, v105, v8
  v_sub_f32 v74, v106, v8
  v_sub_f32 v75, v107, v8
  v_sub_f32 v76, v108, v8
  v_sub_f32 v77, v109, v8
  v_sub_f32 v78, v110, v8
  v_sub_f32 v79, v111, v8
  v_mul_f32 v10, v72, v72
  v_fmac_f32 v10, v73, v73
  v_fmac_f32 v10, v74, v74
  v_fmac_f32 v10, v75, v75
  v_fmac_f32 v10, v76, v76
  v_fmac_f32 v10, v77, v77
  v_fmac_f32 v10, v78, v78
  v_fmac_f32 v10, v79, v79
  s_nop 1
  v_add_f32_dpp v10, v10, v10 row_ror:8 row_mask:0xf bank_mask:0xf
  s_nop 1
  v_add_f32_dpp v10, v10, v10 row_ror:4 row_mask:0xf bank_mask:0xf
  s_nop 1
  v_add_f32_dpp v10, v10, v10 row_ror:2 row_mask:0xf bank_mask:0xf
  s_nop 1
  v_add_f32_dpp v10, v10, v10 row_ror:1 row_mask:0xf bank_mask:0xf
  v_mov_b32 v9, v10
  s_nop 1
  v_permlane16_swap_b32 v9, v10
  v_add_f32 v10, v10, v9
  v_mov_b32 v9, v10
  s_nop 1
  v_permlane32_swap_b32 v9, v10
  v_add_f32 v10, v10, v9
  v_mul_f32 v10, 0x3b000000, v10
  v_cvt_pk_bf16_f32 v8, 0, v8
  v_cvt_pk_bf16_f32 v10, 0, v10
  v_add_f32 v10, 0x3727c5ac, v10
  v_cvt_pk_bf16_f32 v10, 0, v10
  v_sqrt_f32 v10, v10
  v_sub_f32 v72, v104, v8
  v_sub_f32 v73, v105, v8
  v_sub_f32 v74, v106, v8
  v_sub_f32 v75, v107, v8
  v_sub_f32 v76, v108, v8
  v_sub_f32 v77, v109, v8
  v_sub_f32 v78, v110, v8
  v_sub_f32 v79, v111, v8
  v_cvt_pk_bf16_f32 v10, 0, v10
  v_cvt_pk_bf16_f32 v72, 0, v72
  v_cvt_pk_bf16_f32 v73, 0, v73
  v_cvt_pk_bf16_f32 v74, 0, v74
  v_cvt_pk_bf16_f32 v75, 0, v75
  v_cvt_pk_bf16_f32 v76, 0, v76
  v_cvt_pk_bf16_f32 v77, 0, v77
  v_cvt_pk_bf16_f32 v78, 0, v78
  v_cvt_pk_bf16_f32 v79, 0, v79
  v_rcp_f32 v10, v10
  s_nop 0
  v_mul_f32 v72, v72, v10
  v_mul_f32 v73, v73, v10
  v_mul_f32 v74, v74, v10
  v_mul_f32 v75, v75, v10
  v_mul_f32 v76, v76, v10
  v_mul_f32 v77, v77, v10
  v_mul_f32 v78, v78, v10
  v_mul_f32 v79, v79, v10
  v_cvt_pk_bf16_f32 v72, 0, v72
  v_cvt_pk_bf16_f32 v73, 0, v73
  v_cvt_pk_bf16_f32 v74, 0, v74
  v_cvt_pk_bf16_f32 v75, 0, v75
  v_cvt_pk_bf16_f32 v76, 0, v76
  v_cvt_pk_bf16_f32 v77, 0, v77
  v_cvt_pk_bf16_f32 v78, 0, v78
  v_cvt_pk_bf16_f32 v79, 0, v79
  v_add_f32 v8, v112, v113
  v_add_f32 v8, v8, v114
  v_add_f32 v8, v8, v115
  v_add_f32 v8, v8, v116
  v_add_f32 v8, v8, v117
  v_add_f32 v8, v8, v118
  v_add_f32 v8, v8, v119
  s_nop 1
  v_add_f32_dpp v8, v8, v8 row_ror:8 row_mask:0xf bank_mask:0xf
  s_nop 1
  v_add_f32_dpp v8, v8, v8 row_ror:4 row_mask:0xf bank_mask:0xf
  s_nop 1
  v_add_f32_dpp v8, v8, v8 row_ror:2 row_mask:0xf bank_mask:0xf
  s_nop 1
  v_add_f32_dpp v8, v8, v8 row_ror:1 row_mask:0xf bank_mask:0xf
  v_mov_b32 v9, v8
  s_nop 1
  v_permlane16_swap_b32 v9, v8
  v_add_f32 v8, v8, v9
  v_mov_b32 v9, v8
  s_nop 1
  v_permlane32_swap_b32 v9, v8
  v_add_f32 v8, v8, v9
  v_mul_f32 v8, 0x3b000000, v8
  v_sub_f32 v80, v112, v8
  v_sub_f32 v81, v113, v8
  v_sub_f32 v82, v114, v8
  v_sub_f32 v83, v115, v8
  v_sub_f32 v84, v116, v8
  v_sub_f32 v85, v117, v8
  v_sub_f32 v86, v118, v8
  v_sub_f32 v87, v119, v8
  v_mul_f32 v10, v80, v80
  v_fmac_f32 v10, v81, v81
  v_fmac_f32 v10, v82, v82
  v_fmac_f32 v10, v83, v83
  v_fmac_f32 v10, v84, v84
  v_fmac_f32 v10, v85, v85
  v_fmac_f32 v10, v86, v86
  v_fmac_f32 v10, v87, v87
  s_nop 1
  v_add_f32_dpp v10, v10, v10 row_ror:8 row_mask:0xf bank_mask:0xf
  s_nop 1
  v_add_f32_dpp v10, v10, v10 row_ror:4 row_mask:0xf bank_mask:0xf
  s_nop 1
  v_add_f32_dpp v10, v10, v10 row_ror:2 row_mask:0xf bank_mask:0xf
  s_nop 1
  v_add_f32_dpp v10, v10, v10 row_ror:1 row_mask:0xf bank_mask:0xf
  v_mov_b32 v9, v10
  s_nop 1
  v_permlane16_swap_b32 v9, v10
  v_add_f32 v10, v10, v9
  v_mov_b32 v9, v10
  s_nop 1
  v_permlane32_swap_b32 v9, v10
  v_add_f32 v10, v10, v9
  v_mul_f32 v10, 0x3b000000, v10
  v_cvt_pk_bf16_f32 v8, 0, v8
  v_cvt_pk_bf16_f32 v10, 0, v10
  v_add_f32 v10, 0x3727c5ac, v10
  v_cvt_pk_bf16_f32 v10, 0, v10
  v_sqrt_f32 v10, v10
  v_sub_f32 v80, v112, v8
  v_sub_f32 v81, v113, v8
  v_sub_f32 v82, v114, v8
  v_sub_f32 v83, v115, v8
  v_sub_f32 v84, v116, v8
  v_sub_f32 v85, v117, v8
  v_sub_f32 v86, v118, v8
  v_sub_f32 v87, v119, v8
  v_cvt_pk_bf16_f32 v10, 0, v10
  v_cvt_pk_bf16_f32 v80, 0, v80
  v_cvt_pk_bf16_f32 v81, 0, v81
  v_cvt_pk_bf16_f32 v82, 0, v82
  v_cvt_pk_bf16_f32 v83, 0, v83
  v_cvt_pk_bf16_f32 v84, 0, v84
  v_cvt_pk_bf16_f32 v85, 0, v85
  v_cvt_pk_bf16_f32 v86, 0, v86
  v_cvt_pk_bf16_f32 v87, 0, v87
  v_rcp_f32 v10, v10
  s_nop 0
  v_mul_f32 v80, v80, v10
  v_mul_f32 v81, v81, v10
  v_mul_f32 v82, v82, v10
  v_mul_f32 v83, v83, v10
  v_mul_f32 v84, v84, v10
  v_mul_f32 v85, v85, v10
  v_mul_f32 v86, v86, v10
  v_mul_f32 v87, v87, v10
  v_cvt_pk_bf16_f32 v80, 0, v80
  v_cvt_pk_bf16_f32 v81, 0, v81
  v_cvt_pk_bf16_f32 v82, 0, v82
  v_cvt_pk_bf16_f32 v83, 0, v83
  v_cvt_pk_bf16_f32 v84, 0, v84
  v_cvt_pk_bf16_f32 v85, 0, v85
  v_cvt_pk_bf16_f32 v86, 0, v86
  v_cvt_pk_bf16_f32 v87, 0, v87
  v_lshrrev_b32 v2, 1, v1
  v_lshlrev_b32 v2, 7, v2
  v_and_b32 v3, 1, v1
  v_lshl_add_u32 v2, v3, 5, v2
  v_add_u32 v2, 20480, v2
  global_load_dwordx4 v[40:43], v2, s[42:43] offset:0 sc1
  global_load_dwordx4 v[44:47], v2, s[42:43] offset:16 sc1
  global_load_dwordx4 v[48:51], v2, s[42:43] offset:64 sc1
  global_load_dwordx4 v[52:55], v2, s[42:43] offset:80 sc1
  s_waitcnt vmcnt(0)
  v_lshlrev_b32 v88, 16, v40
  v_and_b32 v89, s73, v40
  v_lshlrev_b32 v90, 16, v42
  v_and_b32 v91, s73, v42
  v_lshlrev_b32 v92, 16, v44
  v_and_b32 v93, s73, v44
  v_lshlrev_b32 v94, 16, v46
  v_and_b32 v95, s73, v46
  v_lshlrev_b32 v96, 16, v48
  v_and_b32 v97, s73, v48
  v_lshlrev_b32 v98, 16, v50
  v_and_b32 v99, s73, v50
  v_lshlrev_b32 v100, 16, v52
  v_and_b32 v101, s73, v52
  v_lshlrev_b32 v102, 16, v54
  v_and_b32 v103, s73, v54
  v_add_f32 v88, 1.0, v88
  v_add_f32 v89, 1.0, v89
  v_add_f32 v90, 1.0, v90
  v_add_f32 v91, 1.0, v91
  v_add_f32 v92, 1.0, v92
  v_add_f32 v93, 1.0, v93
  v_add_f32 v94, 1.0, v94
  v_add_f32 v95, 1.0, v95
  v_add_f32 v96, 1.0, v96
  v_add_f32 v97, 1.0, v97
  v_add_f32 v98, 1.0, v98
  v_add_f32 v99, 1.0, v99
  v_add_f32 v100, 1.0, v100
  v_add_f32 v101, 1.0, v101
  v_add_f32 v102, 1.0, v102
  v_add_f32 v103, 1.0, v103
  v_cvt_pk_bf16_f32 v88, 0, v88
  v_cvt_pk_bf16_f32 v89, 0, v89
  v_cvt_pk_bf16_f32 v90, 0, v90
  v_cvt_pk_bf16_f32 v91, 0, v91
  v_cvt_pk_bf16_f32 v92, 0, v92
  v_cvt_pk_bf16_f32 v93, 0, v93
  v_cvt_pk_bf16_f32 v94, 0, v94
  v_cvt_pk_bf16_f32 v95, 0, v95
  v_cvt_pk_bf16_f32 v96, 0, v96
  v_cvt_pk_bf16_f32 v97, 0, v97
  v_cvt_pk_bf16_f32 v98, 0, v98
  v_cvt_pk_bf16_f32 v99, 0, v99
  v_cvt_pk_bf16_f32 v100, 0, v100
  v_cvt_pk_bf16_f32 v101, 0, v101
  v_cvt_pk_bf16_f32 v102, 0, v102
  v_cvt_pk_bf16_f32 v103, 0, v103
  v_mul_f32 v72, v72, v88
  v_mul_f32 v73, v73, v89
  v_mul_f32 v74, v74, v90
  v_mul_f32 v75, v75, v91
  v_mul_f32 v76, v76, v92
  v_mul_f32 v77, v77, v93
  v_mul_f32 v78, v78, v94
  v_mul_f32 v79, v79, v95
  v_mul_f32 v80, v80, v96
  v_mul_f32 v81, v81, v97
  v_mul_f32 v82, v82, v98
  v_mul_f32 v83, v83, v99
  v_mul_f32 v84, v84, v100
  v_mul_f32 v85, v85, v101
  v_mul_f32 v86, v86, v102
  v_mul_f32 v87, v87, v103
  v_cvt_pk_bf16_f32 v72, 0, v72
  v_cvt_pk_bf16_f32 v73, 0, v73
  v_cvt_pk_bf16_f32 v74, 0, v74
  v_cvt_pk_bf16_f32 v75, 0, v75
  v_cvt_pk_bf16_f32 v76, 0, v76
  v_cvt_pk_bf16_f32 v77, 0, v77
  v_cvt_pk_bf16_f32 v78, 0, v78
  v_cvt_pk_bf16_f32 v79, 0, v79
  v_cvt_pk_bf16_f32 v80, 0, v80
  v_cvt_pk_bf16_f32 v81, 0, v81
  v_cvt_pk_bf16_f32 v82, 0, v82
  v_cvt_pk_bf16_f32 v83, 0, v83
  v_cvt_pk_bf16_f32 v84, 0, v84
  v_cvt_pk_bf16_f32 v85, 0, v85
  v_cvt_pk_bf16_f32 v86, 0, v86
  v_cvt_pk_bf16_f32 v87, 0, v87
  v_lshrrev_b32 v2, 1, v1
  v_lshlrev_b32 v2, 7, v2
  v_and_b32 v3, 1, v1
  v_lshl_add_u32 v2, v3, 5, v2
  v_add_u32 v2, 16384, v2
  global_load_dwordx4 v[40:43], v2, s[42:43] offset:0 sc1
  global_load_dwordx4 v[44:47], v2, s[42:43] offset:16 sc1
  global_load_dwordx4 v[48:51], v2, s[42:43] offset:64 sc1
  global_load_dwordx4 v[52:55], v2, s[42:43] offset:80 sc1
  s_waitcnt vmcnt(0)
  v_lshlrev_b32 v88, 16, v40
  v_and_b32 v89, s73, v40
  v_lshlrev_b32 v90, 16, v42
  v_and_b32 v91, s73, v42
  v_lshlrev_b32 v92, 16, v44
  v_and_b32 v93, s73, v44
  v_lshlrev_b32 v94, 16, v46
  v_and_b32 v95, s73, v46
  v_lshlrev_b32 v96, 16, v48
  v_and_b32 v97, s73, v48
  v_lshlrev_b32 v98, 16, v50
  v_and_b32 v99, s73, v50
  v_lshlrev_b32 v100, 16, v52
  v_and_b32 v101, s73, v52
  v_lshlrev_b32 v102, 16, v54
  v_and_b32 v103, s73, v54
  v_add_f32 v72, v72, v88
  v_add_f32 v73, v73, v89
  v_add_f32 v74, v74, v90
  v_add_f32 v75, v75, v91
  v_add_f32 v76, v76, v92
  v_add_f32 v77, v77, v93
  v_add_f32 v78, v78, v94
  v_add_f32 v79, v79, v95
  v_add_f32 v80, v80, v96
  v_add_f32 v81, v81, v97
  v_add_f32 v82, v82, v98
  v_add_f32 v83, v83, v99
  v_add_f32 v84, v84, v100
  v_add_f32 v85, v85, v101
  v_add_f32 v86, v86, v102
  v_add_f32 v87, v87, v103
  v_cvt_pk_bf16_f32 v40, v72, v73
  v_cvt_pk_bf16_f32 v41, v74, v75
  v_cvt_pk_bf16_f32 v42, v76, v77
  v_cvt_pk_bf16_f32 v43, v78, v79
  v_cvt_pk_bf16_f32 v44, v80, v81
  v_cvt_pk_bf16_f32 v45, v82, v83
  v_cvt_pk_bf16_f32 v46, v84, v85
  v_cvt_pk_bf16_f32 v47, v86, v87
  v_add_u32 v3, 12288, v0
  ds_write_b128 v3, v[40:43] offset:0
  ds_write_b128 v3, v[44:47] offset:1024
  s_mov_b32 s44, s28
  s_mov_b32 s45, s29
  s_mov_b32 s46, 1409024
  s_mov_b32 s11, 2752
  s_mov_b32 s12, 1409024
  v_mov_b32 v4, 12288
  v_mov_b32 v5, 13312
  v_lshlrev_b32 v2, 4, v1
  s_call_b64 s[62:63], L_gv
  v_cvt_pk_bf16_f32 v120, 0, v72
  v_cvt_pk_bf16_f32 v121, 0, v73
  v_cvt_pk_bf16_f32 v122, 0, v74
  v_cvt_pk_bf16_f32 v123, 0, v75
  v_cvt_pk_bf16_f32 v124, 0, v76
  v_cvt_pk_bf16_f32 v125, 0, v77
  v_cvt_pk_bf16_f32 v126, 0, v78
  v_cvt_pk_bf16_f32 v127, 0, v79
  v_cvt_pk_bf16_f32 v128, 0, v80
  v_cvt_pk_bf16_f32 v129, 0, v81
  v_cvt_pk_bf16_f32 v130, 0, v82
  v_cvt_pk_bf16_f32 v131, 0, v83
  v_cvt_pk_bf16_f32 v132, 0, v84
  v_cvt_pk_bf16_f32 v133, 0, v85
  v_cvt_pk_bf16_f32 v134, 0, v86
  v_cvt_pk_bf16_f32 v135, 0, v87
  s_mov_b32 s44, s30
  s_mov_b32 s45, s31
  s_mov_b32 s46, 1409024
  s_mov_b32 s11, 2752
  s_mov_b32 s12, 1409024
  v_mov_b32 v4, 12288
  v_mov_b32 v5, 13312
  v_lshlrev_b32 v2, 4, v1
  s_call_b64 s[62:63], L_gv
  v_mul_f32 v88, 0xbfb8aa3b, v120
  v_mul_f32 v89, 0xbfb8aa3b, v121
  v_mul_f32 v90, 0xbfb8aa3b, v122
  v_mul_f32 v91, 0xbfb8aa3b, v123
  v_exp_f32 v88, v88
  v_exp_f32 v89, v89
  v_exp_f32 v90, v90
  v_exp_f32 v91, v91
  s_nop 0
  v_add_f32 v88, 1.0, v88
  v_add_f32 v89, 1.0, v89
  v_add_f32 v90, 1.0, v90
  v_add_f32 v91, 1.0, v91
  v_rcp_f32 v88, v88
  v_rcp_f32 v89, v89
  v_rcp_f32 v90, v90
  v_rcp_f32 v91, v91
  s_nop 0
  v_mul_f32 v120, v120, v88
  v_mul_f32 v121, v121, v89
  v_mul_f32 v122, v122, v90
  v_mul_f32 v123, v123, v91
  v_mul_f32 v88, 0xbfb8aa3b, v124
  v_mul_f32 v89, 0xbfb8aa3b, v125
  v_mul_f32 v90, 0xbfb8aa3b, v126
  v_mul_f32 v91, 0xbfb8aa3b, v127
  v_exp_f32 v88, v88
  v_exp_f32 v89, v89
  v_exp_f32 v90, v90
  v_exp_f32 v91, v91
  s_nop 0
  v_add_f32 v88, 1.0, v88
  v_add_f32 v89, 1.0, v89
  v_add_f32 v90, 1.0, v90
  v_add_f32 v91, 1.0, v91
  v_rcp_f32 v88, v88
  v_rcp_f32 v89, v89
  v_rcp_f32 v90, v90
  v_rcp_f32 v91, v91
  s_nop 0
  v_mul_f32 v124, v124, v88
  v_mul_f32 v125, v125, v89
  v_mul_f32 v126, v126, v90
  v_mul_f32 v127, v127, v91
  v_mul_f32 v88, 0xbfb8aa3b, v128
  v_mul_f32 v89, 0xbfb8aa3b, v129
  v_mul_f32 v90, 0xbfb8aa3b, v130
  v_mul_f32 v91, 0xbfb8aa3b, v131
  v_exp_f32 v88, v88
  v_exp_f32 v89, v89
  v_exp_f32 v90, v90
  v_exp_f32 v91, v91
  s_nop 0
  v_add_f32 v88, 1.0, v88
  v_add_f32 v89, 1.0, v89
  v_add_f32 v90, 1.0, v90
  v_add_f32 v91, 1.0, v91
  v_rcp_f32 v88, v88
  v_rcp_f32 v89, v89
  v_rcp_f32 v90, v90
  v_rcp_f32 v91, v91
  s_nop 0
  v_mul_f32 v128, v128, v88
  v_mul_f32 v129, v129, v89
  v_mul_f32 v130, v130, v90
  v_mul_f32 v131, v131, v91
  v_mul_f32 v88, 0xbfb8aa3b, v132
  v_mul_f32 v89, 0xbfb8aa3b, v133
  v_mul_f32 v90, 0xbfb8aa3b, v134
  v_mul_f32 v91, 0xbfb8aa3b, v135
  v_exp_f32 v88, v88
  v_exp_f32 v89, v89
  v_exp_f32 v90, v90
  v_exp_f32 v91, v91
  s_nop 0
  v_add_f32 v88, 1.0, v88
  v_add_f32 v89, 1.0, v89
  v_add_f32 v90, 1.0, v90
  v_add_f32 v91, 1.0, v91
  v_rcp_f32 v88, v88
  v_rcp_f32 v89, v89
  v_rcp_f32 v90, v90
  v_rcp_f32 v91, v91
  s_nop 0
  v_mul_f32 v132, v132, v88
  v_mul_f32 v133, v133, v89
  v_mul_f32 v134, v134, v90
  v_mul_f32 v135, v135, v91
  v_cvt_pk_bf16_f32 v120, 0, v120
  v_cvt_pk_bf16_f32 v121, 0, v121
  v_cvt_pk_bf16_f32 v122, 0, v122
  v_cvt_pk_bf16_f32 v123, 0, v123
  v_cvt_pk_bf16_f32 v124, 0, v124
  v_cvt_pk_bf16_f32 v125, 0, v125
  v_cvt_pk_bf16_f32 v126, 0, v126
  v_cvt_pk_bf16_f32 v127, 0, v127
  v_cvt_pk_bf16_f32 v128, 0, v128
  v_cvt_pk_bf16_f32 v129, 0, v129
  v_cvt_pk_bf16_f32 v130, 0, v130
  v_cvt_pk_bf16_f32 v131, 0, v131
  v_cvt_pk_bf16_f32 v132, 0, v132
  v_cvt_pk_bf16_f32 v133, 0, v133
  v_cvt_pk_bf16_f32 v134, 0, v134
  v_cvt_pk_bf16_f32 v135, 0, v135
  v_cvt_pk_bf16_f32 v72, 0, v72
  v_cvt_pk_bf16_f32 v73, 0, v73
  v_cvt_pk_bf16_f32 v74, 0, v74
  v_cvt_pk_bf16_f32 v75, 0, v75
  v_cvt_pk_bf16_f32 v76, 0, v76
  v_cvt_pk_bf16_f32 v77, 0, v77
  v_cvt_pk_bf16_f32 v78, 0, v78
  v_cvt_pk_bf16_f32 v79, 0, v79
  v_cvt_pk_bf16_f32 v80, 0, v80
  v_cvt_pk_bf16_f32 v81, 0, v81
  v_cvt_pk_bf16_f32 v82, 0, v82
  v_cvt_pk_bf16_f32 v83, 0, v83
  v_cvt_pk_bf16_f32 v84, 0, v84
  v_cvt_pk_bf16_f32 v85, 0, v85
  v_cvt_pk_bf16_f32 v86, 0, v86
  v_cvt_pk_bf16_f32 v87, 0, v87
  v_mul_f32 v72, v72, v120
  v_mul_f32 v73, v73, v121
  v_mul_f32 v74, v74, v122
  v_mul_f32 v75, v75, v123
  v_mul_f32 v76, v76, v124
  v_mul_f32 v77, v77, v125
  v_mul_f32 v78, v78, v126
  v_mul_f32 v79, v79, v127
  v_mul_f32 v80, v80, v128
  v_mul_f32 v81, v81, v129
  v_mul_f32 v82, v82, v130
  v_mul_f32 v83, v83, v131
  v_mul_f32 v84, v84, v132
  v_mul_f32 v85, v85, v133
  v_mul_f32 v86, v86, v134
  v_mul_f32 v87, v87, v135
  v_cvt_pk_bf16_f32 v40, v72, v73
  v_cvt_pk_bf16_f32 v41, v74, v75
  v_cvt_pk_bf16_f32 v42, v76, v77
  v_cvt_pk_bf16_f32 v43, v78, v79
  v_cvt_pk_bf16_f32 v44, v80, v81
  v_cvt_pk_bf16_f32 v45, v82, v83
  v_cvt_pk_bf16_f32 v46, v84, v85
  v_cvt_pk_bf16_f32 v47, v86, v87
  v_add_u32 v3, 14336, v0
  ds_write_b128 v3, v[40:43] offset:0
  ds_write_b128 v3, v[44:47] offset:3072
  s_mov_b32 s44, s28
  s_mov_b32 s45, s29
  s_mov_b32 s46, 1409024
  s_mov_b32 s11, 2752
  s_mov_b32 s12, 1409024
  v_mov_b32 v4, 12288
  v_mov_b32 v5, 13312
  v_lshlrev_b32 v2, 4, v1
  v_add_u32 v2, 1024, v2
  s_call_b64 s[62:63], L_gv
  v_cvt_pk_bf16_f32 v120, 0, v72
  v_cvt_pk_bf16_f32 v121, 0, v73
  v_cvt_pk_bf16_f32 v122, 0, v74
  v_cvt_pk_bf16_f32 v123, 0, v75
  v_cvt_pk_bf16_f32 v124, 0, v76
  v_cvt_pk_bf16_f32 v125, 0, v77
  v_cvt_pk_bf16_f32 v126, 0, v78
  v_cvt_pk_bf16_f32 v127, 0, v79
  v_cvt_pk_bf16_f32 v128, 0, v80
  v_cvt_pk_bf16_f32 v129, 0, v81
  v_cvt_pk_bf16_f32 v130, 0, v82
  v_cvt_pk_bf16_f32 v131, 0, v83
  v_cvt_pk_bf16_f32 v132, 0, v84
  v_cvt_pk_bf16_f32 v133, 0, v85
  v_cvt_pk_bf16_f32 v134, 0, v86
  v_cvt_pk_bf16_f32 v135, 0, v87
  s_mov_b32 s44, s30
  s_mov_b32 s45, s31
  s_mov_b32 s46, 1409024
  s_mov_b32 s11, 2752
  s_mov_b32 s12, 1409024
  v_mov_b32 v4, 12288
  v_mov_b32 v5, 13312
  v_lshlrev_b32 v2, 4, v1
  v_add_u32 v2, 1024, v2
  s_call_b64 s[62:63], L_gv
  v_mul_f32 v88, 0xbfb8aa3b, v120
  v_mul_f32 v89, 0xbfb8aa3b, v121
  v_mul_f32 v90, 0xbfb8aa3b, v122
  v_mul_f32 v91, 0xbfb8aa3b, v123
  v_exp_f32 v88, v88
  v_exp_f32 v89, v89
  v_exp_f32 v90, v90
  v_exp_f32 v91, v91
  s_nop 0
  v_add_f32 v88, 1.0, v88
  v_add_f32 v89, 1.0, v89
  v_add_f32 v90, 1.0, v90
  v_add_f32 v91, 1.0, v91
  v_rcp_f32 v88, v88
  v_rcp_f32 v89, v89
  v_rcp_f32 v90, v90
  v_rcp_f32 v91, v91
  s_nop 0
  v_mul_f32 v120, v120, v88
  v_mul_f32 v121, v121, v89
  v_mul_f32 v122, v122, v90
  v_mul_f32 v123, v123, v91
  v_mul_f32 v88, 0xbfb8aa3b, v124
  v_mul_f32 v89, 0xbfb8aa3b, v125
  v_mul_f32 v90, 0xbfb8aa3b, v126
  v_mul_f32 v91, 0xbfb8aa3b, v127
  v_exp_f32 v88, v88
  v_exp_f32 v89, v89
  v_exp_f32 v90, v90
  v_exp_f32 v91, v91
  s_nop 0
  v_add_f32 v88, 1.0, v88
  v_add_f32 v89, 1.0, v89
  v_add_f32 v90, 1.0, v90
  v_add_f32 v91, 1.0, v91
  v_rcp_f32 v88, v88
  v_rcp_f32 v89, v89
  v_rcp_f32 v90, v90
  v_rcp_f32 v91, v91
  s_nop 0
  v_mul_f32 v124, v124, v88
  v_mul_f32 v125, v125, v89
  v_mul_f32 v126, v126, v90
  v_mul_f32 v127, v127, v91
  v_mul_f32 v88, 0xbfb8aa3b, v128
  v_mul_f32 v89, 0xbfb8aa3b, v129
  v_mul_f32 v90, 0xbfb8aa3b, v130
  v_mul_f32 v91, 0xbfb8aa3b, v131
  v_exp_f32 v88, v88
  v_exp_f32 v89, v89
  v_exp_f32 v90, v90
  v_exp_f32 v91, v91
  s_nop 0
  v_add_f32 v88, 1.0, v88
  v_add_f32 v89, 1.0, v89
  v_add_f32 v90, 1.0, v90
  v_add_f32 v91, 1.0, v91
  v_rcp_f32 v88, v88
  v_rcp_f32 v89, v89
  v_rcp_f32 v90, v90
  v_rcp_f32 v91, v91
  s_nop 0
  v_mul_f32 v128, v128, v88
  v_mul_f32 v129, v129, v89
  v_mul_f32 v130, v130, v90
  v_mul_f32 v131, v131, v91
  v_mul_f32 v88, 0xbfb8aa3b, v132
  v_mul_f32 v89, 0xbfb8aa3b, v133
  v_mul_f32 v90, 0xbfb8aa3b, v134
  v_mul_f32 v91, 0xbfb8aa3b, v135
  v_exp_f32 v88, v88
  v_exp_f32 v89, v89
  v_exp_f32 v90, v90
  v_exp_f32 v91, v91
  s_nop 0
  v_add_f32 v88, 1.0, v88
  v_add_f32 v89, 1.0, v89
  v_add_f32 v90, 1.0, v90
  v_add_f32 v91, 1.0, v91
  v_rcp_f32 v88, v88
  v_rcp_f32 v89, v89
  v_rcp_f32 v90, v90
  v_rcp_f32 v91, v91
  s_nop 0
  v_mul_f32 v132, v132, v88
  v_mul_f32 v133, v133, v89
  v_mul_f32 v134, v134, v90
  v_mul_f32 v135, v135, v91
  v_cvt_pk_bf16_f32 v120, 0, v120
  v_cvt_pk_bf16_f32 v121, 0, v121
  v_cvt_pk_bf16_f32 v122, 0, v122
  v_cvt_pk_bf16_f32 v123, 0, v123
  v_cvt_pk_bf16_f32 v124, 0, v124
  v_cvt_pk_bf16_f32 v125, 0, v125
  v_cvt_pk_bf16_f32 v126, 0, v126
  v_cvt_pk_bf16_f32 v127, 0, v127
  v_cvt_pk_bf16_f32 v128, 0, v128
  v_cvt_pk_bf16_f32 v129, 0, v129
  v_cvt_pk_bf16_f32 v130, 0, v130
  v_cvt_pk_bf16_f32 v131, 0, v131
  v_cvt_pk_bf16_f32 v132, 0, v132
  v_cvt_pk_bf16_f32 v133, 0, v133
  v_cvt_pk_bf16_f32 v134, 0, v134
  v_cvt_pk_bf16_f32 v135, 0, v135
  v_cvt_pk_bf16_f32 v72, 0, v72
  v_cvt_pk_bf16_f32 v73, 0, v73
  v_cvt_pk_bf16_f32 v74, 0, v74
  v_cvt_pk_bf16_f32 v75, 0, v75
  v_cvt_pk_bf16_f32 v76, 0, v76
  v_cvt_pk_bf16_f32 v77, 0, v77
  v_cvt_pk_bf16_f32 v78, 0, v78
  v_cvt_pk_bf16_f32 v79, 0, v79
  v_cvt_pk_bf16_f32 v80, 0, v80
  v_cvt_pk_bf16_f32 v81, 0, v81
  v_cvt_pk_bf16_f32 v82, 0, v82
  v_cvt_pk_bf16_f32 v83, 0, v83
  v_cvt_pk_bf16_f32 v84, 0, v84
  v_cvt_pk_bf16_f32 v85, 0, v85
  v_cvt_pk_bf16_f32 v86, 0, v86
  v_cvt_pk_bf16_f32 v87, 0, v87
  v_mul_f32 v72, v72, v120
  v_mul_f32 v73, v73, v121
  v_mul_f32 v74, v74, v122
  v_mul_f32 v75, v75, v123
  v_mul_f32 v76, v76, v124
  v_mul_f32 v77, v77, v125
  v_mul_f32 v78, v78, v126
  v_mul_f32 v79, v79, v127
  v_mul_f32 v80, v80, v128
  v_mul_f32 v81, v81, v129
  v_mul_f32 v82, v82, v130
  v_mul_f32 v83, v83, v131
  v_mul_f32 v84, v84, v132
  v_mul_f32 v85, v85, v133
  v_mul_f32 v86, v86, v134
  v_mul_f32 v87, v87, v135
  v_cvt_pk_bf16_f32 v40, v72, v73
  v_cvt_pk_bf16_f32 v41, v74, v75
  v_cvt_pk_bf16_f32 v42, v76, v77
  v_cvt_pk_bf16_f32 v43, v78, v79
  v_cvt_pk_bf16_f32 v44, v80, v81
  v_cvt_pk_bf16_f32 v45, v82, v83
  v_cvt_pk_bf16_f32 v46, v84, v85
  v_cvt_pk_bf16_f32 v47, v86, v87
  v_add_u32 v3, 15360, v0
  ds_write_b128 v3, v[40:43] offset:0
  ds_write_b128 v3, v[44:47] offset:3072
  s_mov_b32 s44, s28
  s_mov_b32 s45, s29
  s_mov_b32 s46, 1409024
  s_mov_b32 s11, 2752
  s_mov_b32 s12, 1409024
  v_mov_b32 v4, 12288
  v_mov_b32 v5, 13312
  v_lshlrev_b32 v2, 4, v1
  v_add_u32 v2, 2048, v2
  s_call_b64 s[62:63], L_gv
  v_cvt_pk_bf16_f32 v120, 0, v72
  v_cvt_pk_bf16_f32 v121, 0, v73
  v_cvt_pk_bf16_f32 v122, 0, v74
  v_cvt_pk_bf16_f32 v123, 0, v75
  v_cvt_pk_bf16_f32 v124, 0, v76
  v_cvt_pk_bf16_f32 v125, 0, v77
  v_cvt_pk_bf16_f32 v126, 0, v78
  v_cvt_pk_bf16_f32 v127, 0, v79
  v_cvt_pk_bf16_f32 v128, 0, v80
  v_cvt_pk_bf16_f32 v129, 0, v81
  v_cvt_pk_bf16_f32 v130, 0, v82
  v_cvt_pk_bf16_f32 v131, 0, v83
  v_cvt_pk_bf16_f32 v132, 0, v84
  v_cvt_pk_bf16_f32 v133, 0, v85
  v_cvt_pk_bf16_f32 v134, 0, v86
  v_cvt_pk_bf16_f32 v135, 0, v87
  s_mov_b32 s44, s30
  s_mov_b32 s45, s31
  s_mov_b32 s46, 1409024
  s_mov_b32 s11, 2752
  s_mov_b32 s12, 1409024
  v_mov_b32 v4, 12288
  v_mov_b32 v5, 13312
  v_lshlrev_b32 v2, 4, v1
  v_add_u32 v2, 2048, v2
  s_call_b64 s[62:63], L_gv
  v_mul_f32 v88, 0xbfb8aa3b, v120
  v_mul_f32 v89, 0xbfb8aa3b, v121
  v_mul_f32 v90, 0xbfb8aa3b, v122
  v_mul_f32 v91, 0xbfb8aa3b, v123
  v_exp_f32 v88, v88
  v_exp_f32 v89, v89
  v_exp_f32 v90, v90
  v_exp_f32 v91, v91
  s_nop 0
  v_add_f32 v88, 1.0, v88
  v_add_f32 v89, 1.0, v89
  v_add_f32 v90, 1.0, v90
  v_add_f32 v91, 1.0, v91
  v_rcp_f32 v88, v88
  v_rcp_f32 v89, v89
  v_rcp_f32 v90, v90
  v_rcp_f32 v91, v91
  s_nop 0
  v_mul_f32 v120, v120, v88
  v_mul_f32 v121, v121, v89
  v_mul_f32 v122, v122, v90
  v_mul_f32 v123, v123, v91
  v_mul_f32 v88, 0xbfb8aa3b, v124
  v_mul_f32 v89, 0xbfb8aa3b, v125
  v_mul_f32 v90, 0xbfb8aa3b, v126
  v_mul_f32 v91, 0xbfb8aa3b, v127
  v_exp_f32 v88, v88
  v_exp_f32 v89, v89
  v_exp_f32 v90, v90
  v_exp_f32 v91, v91
  s_nop 0
  v_add_f32 v88, 1.0, v88
  v_add_f32 v89, 1.0, v89
  v_add_f32 v90, 1.0, v90
  v_add_f32 v91, 1.0, v91
  v_rcp_f32 v88, v88
  v_rcp_f32 v89, v89
  v_rcp_f32 v90, v90
  v_rcp_f32 v91, v91
  s_nop 0
  v_mul_f32 v124, v124, v88
  v_mul_f32 v125, v125, v89
  v_mul_f32 v126, v126, v90
  v_mul_f32 v127, v127, v91
  v_mul_f32 v88, 0xbfb8aa3b, v128
  v_mul_f32 v89, 0xbfb8aa3b, v129
  v_mul_f32 v90, 0xbfb8aa3b, v130
  v_mul_f32 v91, 0xbfb8aa3b, v131
  v_exp_f32 v88, v88
  v_exp_f32 v89, v89
  v_exp_f32 v90, v90
  v_exp_f32 v91, v91
  s_nop 0
  v_add_f32 v88, 1.0, v88
  v_add_f32 v89, 1.0, v89
  v_add_f32 v90, 1.0, v90
  v_add_f32 v91, 1.0, v91
  v_rcp_f32 v88, v88
  v_rcp_f32 v89, v89
  v_rcp_f32 v90, v90
  v_rcp_f32 v91, v91
  s_nop 0
  v_mul_f32 v128, v128, v88
  v_mul_f32 v129, v129, v89
  v_mul_f32 v130, v130, v90
  v_mul_f32 v131, v131, v91
  v_mul_f32 v88, 0xbfb8aa3b, v132
  v_mul_f32 v89, 0xbfb8aa3b, v133
  v_mul_f32 v90, 0xbfb8aa3b, v134
  v_mul_f32 v91, 0xbfb8aa3b, v135
  v_exp_f32 v88, v88
  v_exp_f32 v89, v89
  v_exp_f32 v90, v90
  v_exp_f32 v91, v91
  s_nop 0
  v_add_f32 v88, 1.0, v88
  v_add_f32 v89, 1.0, v89
  v_add_f32 v90, 1.0, v90
  v_add_f32 v91, 1.0, v91
  v_rcp_f32 v88, v88
  v_rcp_f32 v89, v89
  v_rcp_f32 v90, v90
  v_rcp_f32 v91, v91
  s_nop 0
  v_mul_f32 v132, v132, v88
  v_mul_f32 v133, v133, v89
  v_mul_f32 v134, v134, v90
  v_mul_f32 v135, v135, v91
  v_cvt_pk_bf16_f32 v120, 0, v120
  v_cvt_pk_bf16_f32 v121, 0, v121
  v_cvt_pk_bf16_f32 v122, 0, v122
  v_cvt_pk_bf16_f32 v123, 0, v123
  v_cvt_pk_bf16_f32 v124, 0, v124
  v_cvt_pk_bf16_f32 v125, 0, v125
  v_cvt_pk_bf16_f32 v126, 0, v126
  v_cvt_pk_bf16_f32 v127, 0, v127
  v_cvt_pk_bf16_f32 v128, 0, v128
  v_cvt_pk_bf16_f32 v129, 0, v129
  v_cvt_pk_bf16_f32 v130, 0, v130
  v_cvt_pk_bf16_f32 v131, 0, v131
  v_cvt_pk_bf16_f32 v132, 0, v132
  v_cvt_pk_bf16_f32 v133, 0, v133
  v_cvt_pk_bf16_f32 v134, 0, v134
  v_cvt_pk_bf16_f32 v135, 0, v135
  v_cvt_pk_bf16_f32 v72, 0, v72
  v_cvt_pk_bf16_f32 v73, 0, v73
  v_cvt_pk_bf16_f32 v74, 0, v74
  v_cvt_pk_bf16_f32 v75, 0, v75
  v_cvt_pk_bf16_f32 v76, 0, v76
  v_cvt_pk_bf16_f32 v77, 0, v77
  v_cvt_pk_bf16_f32 v78, 0, v78
  v_cvt_pk_bf16_f32 v79, 0, v79
  v_cvt_pk_bf16_f32 v80, 0, v80
  v_cvt_pk_bf16_f32 v81, 0, v81
  v_cvt_pk_bf16_f32 v82, 0, v82
  v_cvt_pk_bf16_f32 v83, 0, v83
  v_cvt_pk_bf16_f32 v84, 0, v84
  v_cvt_pk_bf16_f32 v85, 0, v85
  v_cvt_pk_bf16_f32 v86, 0, v86
  v_cvt_pk_bf16_f32 v87, 0, v87
  v_mul_f32 v72, v72, v120
  v_mul_f32 v73, v73, v121
  v_mul_f32 v74, v74, v122
  v_mul_f32 v75, v75, v123
  v_mul_f32 v76, v76, v124
  v_mul_f32 v77, v77, v125
  v_mul_f32 v78, v78, v126
  v_mul_f32 v79, v79, v127
  v_mul_f32 v80, v80, v128
  v_mul_f32 v81, v81, v129
  v_mul_f32 v82, v82, v130
  v_mul_f32 v83, v83, v131
  v_mul_f32 v84, v84, v132
  v_mul_f32 v85, v85, v133
  v_mul_f32 v86, v86, v134
  v_mul_f32 v87, v87, v135
  v_cvt_pk_bf16_f32 v40, v72, v73
  v_cvt_pk_bf16_f32 v41, v74, v75
  v_cvt_pk_bf16_f32 v42, v76, v77
  v_cvt_pk_bf16_f32 v43, v78, v79
  v_cvt_pk_bf16_f32 v44, v80, v81
  v_cvt_pk_bf16_f32 v45, v82, v83
  v_cvt_pk_bf16_f32 v46, v84, v85
  v_cvt_pk_bf16_f32 v47, v86, v87
  v_add_u32 v3, 16384, v0
  ds_write_b128 v3, v[40:43] offset:0
  ds_write_b128 v3, v[44:47] offset:3072
  s_mov_b32 s44, s32
  s_mov_b32 s45, s33
  s_mov_b32 s46, 1409024
  s_mov_b32 s11, 1024
  s_mov_b32 s12, 1409024
  v_mov_b32 v4, 14336
  v_mov_b32 v5, 17408
  v_lshlrev_b32 v2, 4, v1
  s_call_b64 s[62:63], L_gv
  v_lshrrev_b32 v2, 1, v1
  v_lshlrev_b32 v2, 7, v2
  v_and_b32 v3, 1, v1
  v_lshl_add_u32 v2, v3, 5, v2
  v_add_u32 v2, 24576, v2
  global_load_dwordx4 v[40:43], v2, s[42:43] offset:0 sc1
  global_load_dwordx4 v[44:47], v2, s[42:43] offset:16 sc1
  global_load_dwordx4 v[48:51], v2, s[42:43] offset:64 sc1
  global_load_dwordx4 v[52:55], v2, s[42:43] offset:80 sc1
  s_waitcnt vmcnt(0)
  v_lshlrev_b32 v88, 16, v40
  v_and_b32 v89, s73, v40
  v_lshlrev_b32 v90, 16, v42
  v_and_b32 v91, s73, v42
  v_lshlrev_b32 v92, 16, v44
  v_and_b32 v93, s73, v44
  v_lshlrev_b32 v94, 16, v46
  v_and_b32 v95, s73, v46
  v_lshlrev_b32 v96, 16, v48
  v_and_b32 v97, s73, v48
  v_lshlrev_b32 v98, 16, v50
  v_and_b32 v99, s73, v50
  v_lshlrev_b32 v100, 16, v52
  v_and_b32 v101, s73, v52
  v_lshlrev_b32 v102, 16, v54
  v_and_b32 v103, s73, v54
  v_cvt_pk_bf16_f32 v72, 0, v72
  v_cvt_pk_bf16_f32 v73, 0, v73
  v_cvt_pk_bf16_f32 v74, 0, v74
  v_cvt_pk_bf16_f32 v75, 0, v75
  v_cvt_pk_bf16_f32 v76, 0, v76
  v_cvt_pk_bf16_f32 v77, 0, v77
  v_cvt_pk_bf16_f32 v78, 0, v78
  v_cvt_pk_bf16_f32 v79, 0, v79
  v_cvt_pk_bf16_f32 v80, 0, v80
  v_cvt_pk_bf16_f32 v81, 0, v81
  v_cvt_pk_bf16_f32 v82, 0, v82
  v_cvt_pk_bf16_f32 v83, 0, v83
  v_cvt_pk_bf16_f32 v84, 0, v84
  v_cvt_pk_bf16_f32 v85, 0, v85
  v_cvt_pk_bf16_f32 v86, 0, v86
  v_cvt_pk_bf16_f32 v87, 0, v87
  v_mul_f32 v72, v72, v88
  v_mul_f32 v73, v73, v89
  v_mul_f32 v74, v74, v90
  v_mul_f32 v75, v75, v91
  v_mul_f32 v76, v76, v92
  v_mul_f32 v77, v77, v93
  v_mul_f32 v78, v78, v94
  v_mul_f32 v79, v79, v95
  v_mul_f32 v80, v80, v96
  v_mul_f32 v81, v81, v97
  v_mul_f32 v82, v82, v98
  v_mul_f32 v83, v83, v99
  v_mul_f32 v84, v84, v100
  v_mul_f32 v85, v85, v101
  v_mul_f32 v86, v86, v102
  v_mul_f32 v87, v87, v103
  v_cvt_pk_bf16_f32 v72, 0, v72
  v_cvt_pk_bf16_f32 v73, 0, v73
  v_cvt_pk_bf16_f32 v74, 0, v74
  v_cvt_pk_bf16_f32 v75, 0, v75
  v_cvt_pk_bf16_f32 v76, 0, v76
  v_cvt_pk_bf16_f32 v77, 0, v77
  v_cvt_pk_bf16_f32 v78, 0, v78
  v_cvt_pk_bf16_f32 v79, 0, v79
  v_cvt_pk_bf16_f32 v80, 0, v80
  v_cvt_pk_bf16_f32 v81, 0, v81
  v_cvt_pk_bf16_f32 v82, 0, v82
  v_cvt_pk_bf16_f32 v83, 0, v83
  v_cvt_pk_bf16_f32 v84, 0, v84
  v_cvt_pk_bf16_f32 v85, 0, v85
  v_cvt_pk_bf16_f32 v86, 0, v86
  v_cvt_pk_bf16_f32 v87, 0, v87
  v_add_f32 v104, v104, v72
  v_add_f32 v105, v105, v73
  v_add_f32 v106, v106, v74
  v_add_f32 v107, v107, v75
  v_add_f32 v108, v108, v76
  v_add_f32 v109, v109, v77
  v_add_f32 v110, v110, v78
  v_add_f32 v111, v111, v79
  v_add_f32 v112, v112, v80
  v_add_f32 v113, v113, v81
  v_add_f32 v114, v114, v82
  v_add_f32 v115, v115, v83
  v_add_f32 v116, v116, v84
  v_add_f32 v117, v117, v85
  v_add_f32 v118, v118, v86
  v_add_f32 v119, v119, v87
  v_cvt_pk_bf16_f32 v104, 0, v104
  v_cvt_pk_bf16_f32 v105, 0, v105
  v_cvt_pk_bf16_f32 v106, 0, v106
  v_cvt_pk_bf16_f32 v107, 0, v107
  v_cvt_pk_bf16_f32 v108, 0, v108
  v_cvt_pk_bf16_f32 v109, 0, v109
  v_cvt_pk_bf16_f32 v110, 0, v110
  v_cvt_pk_bf16_f32 v111, 0, v111
  v_cvt_pk_bf16_f32 v112, 0, v112
  v_cvt_pk_bf16_f32 v113, 0, v113
  v_cvt_pk_bf16_f32 v114, 0, v114
  v_cvt_pk_bf16_f32 v115, 0, v115
  v_cvt_pk_bf16_f32 v116, 0, v116
  v_cvt_pk_bf16_f32 v117, 0, v117
  v_cvt_pk_bf16_f32 v118, 0, v118
  v_cvt_pk_bf16_f32 v119, 0, v119
  v_cvt_pk_bf16_f32 v40, v104, v105
  v_cvt_pk_bf16_f32 v41, v106, v107
  v_cvt_pk_bf16_f32 v42, v108, v109
  v_cvt_pk_bf16_f32 v43, v110, v111
  v_cvt_pk_bf16_f32 v44, v112, v113
  v_cvt_pk_bf16_f32 v45, v114, v115
  v_cvt_pk_bf16_f32 v46, v116, v117
  v_cvt_pk_bf16_f32 v47, v118, v119
  global_store_dwordx4 v0, v[40:43], s[38:39] offset:0 sc1
  global_store_dwordx4 v0, v[44:47], s[38:39] offset:1024 sc1
  s_endpgm
L_gv:
  v_mov_b32 v72, 0
  v_mov_b32 v73, 0
  v_mov_b32 v74, 0
  v_mov_b32 v75, 0
  v_mov_b32 v76, 0
  v_mov_b32 v77, 0
  v_mov_b32 v78, 0
  v_mov_b32 v79, 0
  v_mov_b32 v80, 0
  v_mov_b32 v81, 0
  v_mov_b32 v82, 0
  v_mov_b32 v83, 0
  v_mov_b32 v84, 0
  v_mov_b32 v85, 0
  v_mov_b32 v86, 0
  v_mov_b32 v87, 0
  s_mov_b32 s10, 0
L_gvl:
  buffer_load_dwordx4 v[40:43], v2, s[44:47], s10 offen
  s_add_u32 s10, s10, s11
  buffer_load_dwordx4 v[44:47], v2, s[44:47], s10 offen
  s_add_u32 s10, s10, s11
  buffer_load_dwordx4 v[48:51], v2, s[44:47], s10 offen
  s_add_u32 s10, s10, s11
  buffer_load_dwordx4 v[52:55], v2, s[44:47], s10 offen
  s_add_u32 s10, s10, s11
  buffer_load_dwordx4 v[56:59], v2, s[44:47], s10 offen
  s_add_u32 s10, s10, s11
  buffer_load_dwordx4 v[60:63], v2, s[44:47], s10 offen
  s_add_u32 s10, s10, s11
  buffer_load_dwordx4 v[64:67], v2, s[44:47], s10 offen
  s_add_u32 s10, s10, s11
  buffer_load_dwordx4 v[68:71], v2, s[44:47], s10 offen
  s_add_u32 s10, s10, s11
  ds_read_b128 v[88:91], v4
  ds_read_b128 v[92:95], v5
  v_add_u32 v4, 16, v4
  v_add_u32 v5, 16, v5
  s_waitcnt lgkmcnt(0)
  v_and_b32 v8, 0xffff, v88
  v_lshlrev_b32 v9, 16, v88
  v_and_b32 v10, 0xffff, v92
  v_lshlrev_b32 v11, 16, v92
  s_waitcnt vmcnt(7)
  v_dot2c_f32_bf16 v72, v8, v40
  v_dot2c_f32_bf16 v73, v9, v40
  v_dot2c_f32_bf16 v74, v8, v41
  v_dot2c_f32_bf16 v75, v9, v41
  v_dot2c_f32_bf16 v76, v8, v42
  v_dot2c_f32_bf16 v77, v9, v42
  v_dot2c_f32_bf16 v78, v8, v43
  v_dot2c_f32_bf16 v79, v9, v43
  v_dot2c_f32_bf16 v80, v10, v40
  v_dot2c_f32_bf16 v81, v11, v40
  v_dot2c_f32_bf16 v82, v10, v41
  v_dot2c_f32_bf16 v83, v11, v41
  v_dot2c_f32_bf16 v84, v10, v42
  v_dot2c_f32_bf16 v85, v11, v42
  v_dot2c_f32_bf16 v86, v10, v43
  v_dot2c_f32_bf16 v87, v11, v43
  v_lshrrev_b32 v8, 16, v88
  v_and_b32 v9, s73, v88
  v_lshrrev_b32 v10, 16, v92
  v_and_b32 v11, s73, v92
  s_waitcnt vmcnt(6)
  v_dot2c_f32_bf16 v72, v8, v44
  v_dot2c_f32_bf16 v73, v9, v44
  v_dot2c_f32_bf16 v74, v8, v45
  v_dot2c_f32_bf16 v75, v9, v45
  v_dot2c_f32_bf16 v76, v8, v46
  v_dot2c_f32_bf16 v77, v9, v46
  v_dot2c_f32_bf16 v78, v8, v47
  v_dot2c_f32_bf16 v79, v9, v47
  v_dot2c_f32_bf16 v80, v10, v44
  v_dot2c_f32_bf16 v81, v11, v44
  v_dot2c_f32_bf16 v82, v10, v45
  v_dot2c_f32_bf16 v83, v11, v45
  v_dot2c_f32_bf16 v84, v10, v46
  v_dot2c_f32_bf16 v85, v11, v46
  v_dot2c_f32_bf16 v86, v10, v47
  v_dot2c_f32_bf16 v87, v11, v47
  v_and_b32 v8, 0xffff, v89
  v_lshlrev_b32 v9, 16, v89
  v_and_b32 v10, 0xffff, v93
  v_lshlrev_b32 v11, 16, v93
  s_waitcnt vmcnt(5)
  v_dot2c_f32_bf16 v72, v8, v48
  v_dot2c_f32_bf16 v73, v9, v48
  v_dot2c_f32_bf16 v74, v8, v49
  v_dot2c_f32_bf16 v75, v9, v49
  v_dot2c_f32_bf16 v76, v8, v50
  v_dot2c_f32_bf16 v77, v9, v50
  v_dot2c_f32_bf16 v78, v8, v51
  v_dot2c_f32_bf16 v79, v9, v51
  v_dot2c_f32_bf16 v80, v10, v48
  v_dot2c_f32_bf16 v81, v11, v48
  v_dot2c_f32_bf16 v82, v10, v49
  v_dot2c_f32_bf16 v83, v11, v49
  v_dot2c_f32_bf16 v84, v10, v50
  v_dot2c_f32_bf16 v85, v11, v50
  v_dot2c_f32_bf16 v86, v10, v51
  v_dot2c_f32_bf16 v87, v11, v51
  v_lshrrev_b32 v8, 16, v89
  v_and_b32 v9, s73, v89
  v_lshrrev_b32 v10, 16, v93
  v_and_b32 v11, s73, v93
  s_waitcnt vmcnt(4)
  v_dot2c_f32_bf16 v72, v8, v52
  v_dot2c_f32_bf16 v73, v9, v52
  v_dot2c_f32_bf16 v74, v8, v53
  v_dot2c_f32_bf16 v75, v9, v53
  v_dot2c_f32_bf16 v76, v8, v54
  v_dot2c_f32_bf16 v77, v9, v54
  v_dot2c_f32_bf16 v78, v8, v55
  v_dot2c_f32_bf16 v79, v9, v55
  v_dot2c_f32_bf16 v80, v10, v52
  v_dot2c_f32_bf16 v81, v11, v52
  v_dot2c_f32_bf16 v82, v10, v53
  v_dot2c_f32_bf16 v83, v11, v53
  v_dot2c_f32_bf16 v84, v10, v54
  v_dot2c_f32_bf16 v85, v11, v54
  v_dot2c_f32_bf16 v86, v10, v55
  v_dot2c_f32_bf16 v87, v11, v55
  v_and_b32 v8, 0xffff, v90
  v_lshlrev_b32 v9, 16, v90
  v_and_b32 v10, 0xffff, v94
  v_lshlrev_b32 v11, 16, v94
  s_waitcnt vmcnt(3)
  v_dot2c_f32_bf16 v72, v8, v56
  v_dot2c_f32_bf16 v73, v9, v56
  v_dot2c_f32_bf16 v74, v8, v57
  v_dot2c_f32_bf16 v75, v9, v57
  v_dot2c_f32_bf16 v76, v8, v58
  v_dot2c_f32_bf16 v77, v9, v58
  v_dot2c_f32_bf16 v78, v8, v59
  v_dot2c_f32_bf16 v79, v9, v59
  v_dot2c_f32_bf16 v80, v10, v56
  v_dot2c_f32_bf16 v81, v11, v56
  v_dot2c_f32_bf16 v82, v10, v57
  v_dot2c_f32_bf16 v83, v11, v57
  v_dot2c_f32_bf16 v84, v10, v58
  v_dot2c_f32_bf16 v85, v11, v58
  v_dot2c_f32_bf16 v86, v10, v59
  v_dot2c_f32_bf16 v87, v11, v59
  v_lshrrev_b32 v8, 16, v90
  v_and_b32 v9, s73, v90
  v_lshrrev_b32 v10, 16, v94
  v_and_b32 v11, s73, v94
  s_waitcnt vmcnt(2)
  v_dot2c_f32_bf16 v72, v8, v60
  v_dot2c_f32_bf16 v73, v9, v60
  v_dot2c_f32_bf16 v74, v8, v61
  v_dot2c_f32_bf16 v75, v9, v61
  v_dot2c_f32_bf16 v76, v8, v62
  v_dot2c_f32_bf16 v77, v9, v62
  v_dot2c_f32_bf16 v78, v8, v63
  v_dot2c_f32_bf16 v79, v9, v63
  v_dot2c_f32_bf16 v80, v10, v60
  v_dot2c_f32_bf16 v81, v11, v60
  v_dot2c_f32_bf16 v82, v10, v61
  v_dot2c_f32_bf16 v83, v11, v61
  v_dot2c_f32_bf16 v84, v10, v62
  v_dot2c_f32_bf16 v85, v11, v62
  v_dot2c_f32_bf16 v86, v10, v63
  v_dot2c_f32_bf16 v87, v11, v63
  v_and_b32 v8, 0xffff, v91
  v_lshlrev_b32 v9, 16, v91
  v_and_b32 v10, 0xffff, v95
  v_lshlrev_b32 v11, 16, v95
  s_waitcnt vmcnt(1)
  v_dot2c_f32_bf16 v72, v8, v64
  v_dot2c_f32_bf16 v73, v9, v64
  v_dot2c_f32_bf16 v74, v8, v65
  v_dot2c_f32_bf16 v75, v9, v65
  v_dot2c_f32_bf16 v76, v8, v66
  v_dot2c_f32_bf16 v77, v9, v66
  v_dot2c_f32_bf16 v78, v8, v67
  v_dot2c_f32_bf16 v79, v9, v67
  v_dot2c_f32_bf16 v80, v10, v64
  v_dot2c_f32_bf16 v81, v11, v64
  v_dot2c_f32_bf16 v82, v10, v65
  v_dot2c_f32_bf16 v83, v11, v65
  v_dot2c_f32_bf16 v84, v10, v66
  v_dot2c_f32_bf16 v85, v11, v66
  v_dot2c_f32_bf16 v86, v10, v67
  v_dot2c_f32_bf16 v87, v11, v67
  v_lshrrev_b32 v8, 16, v91
  v_and_b32 v9, s73, v91
  v_lshrrev_b32 v10, 16, v95
  v_and_b32 v11, s73, v95
  s_waitcnt vmcnt(0)
  v_dot2c_f32_bf16 v72, v8, v68
  v_dot2c_f32_bf16 v73, v9, v68
  v_dot2c_f32_bf16 v74, v8, v69
  v_dot2c_f32_bf16 v75, v9, v69
  v_dot2c_f32_bf16 v76, v8, v70
  v_dot2c_f32_bf16 v77, v9, v70
  v_dot2c_f32_bf16 v78, v8, v71
  v_dot2c_f32_bf16 v79, v9, v71
  v_dot2c_f32_bf16 v80, v10, v68
  v_dot2c_f32_bf16 v81, v11, v68
  v_dot2c_f32_bf16 v82, v10, v69
  v_dot2c_f32_bf16 v83, v11, v69
  v_dot2c_f32_bf16 v84, v10, v70
  v_dot2c_f32_bf16 v85, v11, v70
  v_dot2c_f32_bf16 v86, v10, v71
  v_dot2c_f32_bf16 v87, v11, v71
  s_cmp_lt_u32 s10, s12
  s_cbranch_scc1 L_gvl
  s_nop 1
  s_setpc_b64 s[62:63]
L_serv:
  s_cmp_ge_u32 s13, 4
  s_cbranch_scc1 L_team
  s_cmp_lt_u32 s13, 2
  s_cbranch_scc1 L_sv1
  s_getpc_b64 s[56:57]
L_pcc:
  s_sub_u32 s56, s56, L_pcc-adaLN_cond__sliding_block_cached__glu_gated_swiglu__decode_kernel
  s_subb_u32 s57, s57, 0
  s_lshr_b32 s3, s2, 5
  s_lshl1_add_u32 s3, s3, s13
  s_sub_u32 s3, s3, 2
  s_lshl_b32 s3, s3, 12
  v_lshl_add_u32 v2, v1, 6, s3
  v_min_u32 v2, L_end-adaLN_cond__sliding_block_cached__glu_gated_swiglu__decode_kernel, v2
  global_load_dword v3, v2, s[56:57]
  s_endpgm
L_sv1:
  v_mov_b32 v38, 0
  v_mov_b32 v4, -1
  v_mov_b32 v5, 0
  v_mov_b32 v6, 0
  v_mov_b32 v7, 0
  ds_write_b128 v38, v[4:7] offset:256
  ds_write_b64 v38, v[6:7] offset:312
  s_getreg_b32 s76, hwreg(HW_REG_XCC_ID, 0, 4)
  s_waitcnt lgkmcnt(0)
  s_load_dword s74, s[42:43], 0
  s_getpc_b64 s[56:57]
L_pc_30:
  s_lshr_b32 s3, s2, 5
  s_lshl3_add_u32 s3, s3, s8
  s_lshl_b32 s3, s3, 2
  s_add_u32 s3, s3, L_table-L_pc_30
  s_load_dword s14, s[56:57], s3
  s_barrier
  s_waitcnt lgkmcnt(0)
  s_mul_i32 s74, s74, 0x9e3779b1
  s_add_u32 s74, s74, 0x7f4a7c15
  s_bfe_u32 s32, s74, 0x80000
  s_bfe_u32 s33, s74, 0x80008
  s_bfe_u32 s34, s74, 0x80010
  s_bfe_u32 s35, s74, 0x80018
  s_cmp_eq_u32 s13, 0
  s_cbranch_scc1 L_sv0
  s_bfe_u32 s61, s14, 0x80010
  s_cmp_ge_u32 s61, 32
  s_cbranch_scc1 L_fin
  s_mov_b32 s70, 0
L_pl_31:
  ds_read_b32 v8, v38 offset:256
  s_waitcnt lgkmcnt(0)
  v_cmp_eq_u32 vcc, -1, v8
  s_cmp_eq_u64 vcc, 0
  s_cbranch_scc1 L_pld_32
  s_sleep 16
  s_add_u32 s70, s70, 1
  s_cmp_lt_u32 s70, 1048576
  s_cbranch_scc1 L_pl_31
L_pld_32:
  s_branch L_r_f2
L_sv0:
  s_add_u32 s76, s76, s74
  s_lshr_b32 s49, s2, 5
  s_lshl_b32 s50, s8, 5
  s_add_u32 s49, s49, s50
  s_lshl_b32 s49, s49, 2
  v_mov_b32 v8, s49
  v_mov_b32 v9, s76
  s_mov_b64 exec, 1
  global_store_dword v8, v9, s[42:43] offset:1024 sc1
  s_mov_b64 exec, -1
  s_lshl_b32 s54, s6, 9
  s_add_u32 s54, s54, 0
  s_lshl_b32 s55, s6, 9
  s_add_u32 s55, s55, 128
  s_lshl_b32 s56, s6, 9
  s_add_u32 s56, s56, 256
  s_mov_b32 s70, 0
L_sn_33:
  ds_read_b32 v8, v38 offset:312
  s_waitcnt lgkmcnt(0)
  v_cmp_gt_u32 vcc, 0x8, v8
  s_cmp_eq_u64 vcc, 0
  s_cbranch_scc1 L_snd_34
  s_sleep 16
  s_add_u32 s70, s70, 1
  s_cmp_lt_u32 s70, 2097152
  s_cbranch_scc1 L_sn_33
L_snd_34:
  s_load_dwordx2 s[20:21], s[42:43], s54 offset:65536 glc
  s_mov_b32 s70, 0
  s_branch L_s3wc
L_s3w:
  s_load_dwordx2 s[20:21], s[42:43], s54 offset:65536 glc
L_s3wc:
  s_waitcnt lgkmcnt(0)
  s_xor_b32 s68, s21, s74
  s_cbranch_scc0 L_s3wd
  s_sleep 8
  s_add_u32 s70, s70, 1
  s_cmp_lt_u32 s70, 262144
  s_cbranch_scc1 L_s3w
L_s3wd:
  v_mov_b32 v8, 1
  ds_write_b32 v38, v8 offset:260
  s_mov_b32 s70, 0
L_sn_35:
  ds_read_b32 v8, v38 offset:312
  s_waitcnt lgkmcnt(0)
  v_cmp_gt_u32 vcc, 0xc, v8
  s_cmp_eq_u64 vcc, 0
  s_cbranch_scc1 L_snd_36
  s_sleep 16
  s_add_u32 s70, s70, 1
  s_cmp_lt_u32 s70, 2097152
  s_cbranch_scc1 L_sn_35
L_snd_36:
  s_load_dwordx2 s[20:21], s[42:43], s54 offset:98304 glc
  s_load_dwordx2 s[24:25], s[42:43], s55 offset:98304 glc
  s_load_dwordx2 s[28:29], s[42:43], s56 offset:98304 glc
  s_mov_b32 s70, 0
  s_branch L_s3sc
L_s3s:
  s_load_dwordx2 s[20:21], s[42:43], s54 offset:98304 glc
  s_load_dwordx2 s[24:25], s[42:43], s55 offset:98304 glc
  s_load_dwordx2 s[28:29], s[42:43], s56 offset:98304 glc
L_s3sc:
  s_waitcnt lgkmcnt(0)
  s_xor_b32 s68, s21, s74
  s_xor_b32 s69, s25, s74
  s_or_b32 s68, s68, s69
  s_xor_b32 s69, s29, s74
  s_or_b32 s68, s68, s69
  s_cbranch_scc0 L_s3sd
  s_sleep 8
  s_add_u32 s70, s70, 1
  s_cmp_lt_u32 s70, 262144
  s_cbranch_scc1 L_s3s
L_s3sd:
  ds_write_b32 v38, v38 offset:256
  s_branch L_fin
L_team:
  s_and_b32 s5, s13, 3
  v_and_b32 v0, 0xff, v0
  v_mov_b32 v38, 0
  s_mov_b32 s77, 0
  s_lshr_b32 s60, s2, 5
  v_lshrrev_b32 v12, 3, v0
  v_lshlrev_b32 v12, 5, v12
  v_bfe_u32 v3, v1, 2, 1
  v_lshl_add_u32 v12, v3, 10, v12
  v_and_b32 v8, 3, v1
  v_lshl_add_u32 v37, v8, 3, v12
  v_and_b32 v12, 0xffffffdf, v12
  v_lshl_add_u32 v12, v8, 4, v12
  v_bfe_u32 v8, v1, 3, 1
  v_lshl_add_u32 v12, v8, 3, v12
  v_lshl_add_u32 v12, v3, 5, v12
  s_waitcnt lgkmcnt(0)
  s_load_dword s74, s[42:43], 0
  s_barrier
  s_cmp_ge_u32 s13, 8
  s_cbranch_scc1 L_r_mod
L_r_q:
  s_lshl3_add_u32 s61, s8, s60
  s_lshl_b32 s48, s61, 7
  s_lshl_b32 s58, s61, 8
  s_add_u32 s58, s58, 32768
  global_load_dwordx2 v[14:15], v37, s[16:17]
  s_mov_b32 s44, s22
  s_mov_b32 s45, s23
  s_mov_b32 s46, 4194304
  s_mov_b32 s47, 0x20000
  s_cmp_ge_u32 s60, 2
  s_cbranch_scc1 L_q_go
  s_mov_b32 s70, 0
L_sn_37:
  ds_read_b32 v8, v38 offset:268
  s_waitcnt lgkmcnt(0)
  v_cmp_gt_u32 vcc, 0x4, v8
  s_cmp_eq_u64 vcc, 0
  s_cbranch_scc1 L_snd_38
  s_sleep 1
  s_add_u32 s70, s70, 1
  s_cmp_lt_u32 s70, 2097152
  s_cbranch_scc1 L_sn_37
L_snd_38:
L_q_go:
  v_lshrrev_b32 v2, 3, v1
  v_and_b32 v3, 6, v2
  v_xor_b32 v3, v3, v1
  v_mul_u32_u24 v2, 8192, v2
  v_and_b32 v3, 7, v3
  v_lshl_add_u32 v2, v3, 4, v2
  s_mul_i32 s49, s5, 1048576
  s_lshl_b32 s50, s5, 14
  s_add_u32 s49, s49, s48
  s_add_u32 s50, s50, 12288
  s_add_u32 s51, s50, 16384
L_dma_39:
  s_mov_b32 m0, s50
  s_add_u32 s50, s50, 1024
  buffer_load_dwordx4 v2, s[44:47], s49 offen nt lds
  s_add_u32 s49, s49, 65536
  s_cmp_lt_u32 s50, s51
  s_cbranch_scc1 L_dma_39
L_dmae_40:
  v_mov_b32 v3, 1
  s_mov_b64 exec, 1
  ds_add_u32 v38, v3 offset:264
  s_mov_b64 exec, -1
  s_waitcnt lgkmcnt(0)
  s_mul_i32 s74, s74, 0x9e3779b1
  s_add_u32 s74, s74, 0x7f4a7c15
  v_bfe_u32 v6, v1, 2, 1
  v_lshlrev_b32 v6, 5, v6
  v_add_u32 v6, 3136, v6
  s_lshl_b32 s49, s5, 3
  v_add_u32 v5, s49, v6
  s_waitcnt vmcnt(16)
  v_lshlrev_b32 v20, 16, v14
  v_and_b32 v21, s73, v14
  v_lshlrev_b32 v22, 16, v15
  v_and_b32 v23, s73, v15
  v_add_f32 v8, v20, v21
  v_mul_f32 v9, v20, v20
  v_add_f32 v10, v22, v23
  v_mul_f32 v11, v22, v22
  v_fmac_f32 v9, v21, v21
  v_fmac_f32 v11, v23, v23
  v_add_f32 v8, v8, v10
  v_add_f32 v9, v9, v11
  s_nop 0
  v_add_f32_dpp v8, v8, v8 quad_perm:[1,0,3,2] row_mask:0xf bank_mask:0xf
  v_add_f32_dpp v9, v9, v9 quad_perm:[1,0,3,2] row_mask:0xf bank_mask:0xf
  s_nop 0
  v_add_f32_dpp v8, v8, v8 quad_perm:[2,3,0,1] row_mask:0xf bank_mask:0xf
  v_add_f32_dpp v9, v9, v9 quad_perm:[2,3,0,1] row_mask:0xf bank_mask:0xf
  s_nop 0
  v_add_f32_dpp v8, v8, v8 row_ror:8 row_mask:0xf bank_mask:0xf
  v_add_f32_dpp v9, v9, v9 row_ror:8 row_mask:0xf bank_mask:0xf
  s_nop 0
  v_mov_b32 v10, v8
  v_mov_b32 v11, v9
  s_nop 0
  v_permlane16_swap_b32 v10, v8
  v_permlane16_swap_b32 v11, v9
  v_add_f32 v8, v8, v10
  v_add_f32 v9, v9, v11
  v_mov_b32 v10, v8
  v_mov_b32 v11, v9
  s_nop 0
  v_permlane32_swap_b32 v10, v8
  v_permlane32_swap_b32 v11, v9
  v_add_f32 v8, v8, v10
  v_add_f32 v9, v9, v11
  ds_write_b64 v5, v[8:9]
  s_waitcnt vmcnt(0) lgkmcnt(0)
  s_add_u32 s77, s77, 4
  v_mov_b32 v9, 1
  s_mov_b64 exec, 1
  ds_add_u32 v38, v9 offset:312
  s_mov_b64 exec, -1
  s_mov_b32 s70, 0
L_hy_41:
  ds_read_b32 v9, v38 offset:312
  s_waitcnt lgkmcnt(0)
  v_cmp_gt_u32 vcc, s77, v9
  s_cmp_eq_u64 vcc, 0
  s_cbranch_scc1 L_hyd_42
  s_add_u32 s70, s70, 1
  s_cmp_lt_u32 s70, 2097152
  s_cbranch_scc1 L_hy_41
L_hyd_42:
  ds_read_b128 v[24:27], v6
  ds_read_b128 v[28:31], v6 offset:16
  s_waitcnt lgkmcnt(0)
  v_pk_add_f32 v[24:25], v[24:25], v[26:27]
  v_pk_add_f32 v[28:29], v[28:29], v[30:31]
  v_pk_add_f32 v[24:25], v[24:25], v[28:29]
  v_mul_f32 v8, 0x3b000000, v24
  v_mul_f32 v9, 0x3b000000, v25
  v_fma_f32 v9, -v8, v8, v9
  v_cvt_pk_bf16_f32 v8, 0, v8
  v_max_f32 v9, 0, v9
  v_cvt_pk_bf16_f32 v9, 0, v9
  v_sub_f32 v20, v20, v8
  v_sub_f32 v21, v21, v8
  v_add_f32 v9, 0x3727c5ac, v9
  v_sub_f32 v22, v22, v8
  v_sub_f32 v23, v23, v8
  v_cvt_pk_bf16_f32 v9, 0, v9
  v_cvt_pk_bf16_f32 v20, 0, v20
  v_sqrt_f32 v9, v9
  v_cvt_pk_bf16_f32 v21, 0, v21
  v_cvt_pk_bf16_f32 v9, 0, v9
  v_cvt_pk_bf16_f32 v22, 0, v22
  v_rcp_f32 v9, v9
  v_cvt_pk_bf16_f32 v23, 0, v23
  v_mul_f32 v20, v20, v9
  v_mul_f32 v21, v21, v9
  v_mul_f32 v22, v22, v9
  v_mul_f32 v23, v23, v9
  v_cvt_pk_bf16_f32 v20, 0, v20
  v_cvt_pk_bf16_f32 v21, 0, v21
  v_cvt_pk_bf16_f32 v22, 0, v22
  v_cvt_pk_bf16_f32 v23, 0, v23
  s_lshl_b32 s49, s8, 13
  s_add_u32 s49, s49, 917504
  v_lshl_add_u32 v15, v0, 4, s49
  v_add_u32 v36, 0x1000, v15
  s_mov_b64 s[64:65], -1
  s_mov_b64 s[66:67], -1
  s_mov_b64 exec, s[64:65]
  global_load_dwordx4 v[16:19], v15, s[42:43] sc1
  s_mov_b64 exec, s[66:67]
  global_load_dwordx4 v[32:35], v36, s[42:43] sc1
  s_mov_b64 exec, -1
  v_lshrrev_b32 v2, 2, v1
  v_bfe_u32 v3, v1, 1, 1
  s_lshl_b32 s49, s5, 1
  v_or_b32 v3, s49, v3
  v_and_b32 v10, 6, v2
  v_xor_b32 v3, v3, v10
  v_lshlrev_b32 v2, 7, v2
  v_lshl_add_u32 v2, v3, 4, v2
  v_and_b32 v3, 1, v1
  v_lshl_add_u32 v2, v3, 3, v2
  v_add_u32 v2, 12288, v2
  ds_read_b64_tr_b16 v[40:41], v2 offset:0
  ds_read_b64_tr_b16 v[42:43], v2 offset:2048
  ds_read_b64_tr_b16 v[44:45], v2 offset:4096
  ds_read_b64_tr_b16 v[46:47], v2 offset:6144
  ds_read_b64_tr_b16 v[48:49], v2 offset:8192
  ds_read_b64_tr_b16 v[50:51], v2 offset:10240
  ds_read_b64_tr_b16 v[52:53], v2 offset:12288
  ds_read_b64_tr_b16 v[54:55], v2 offset:14336
  ds_read_b64_tr_b16 v[56:57], v2 offset:16384
  ds_read_b64_tr_b16 v[58:59], v2 offset:18432
  ds_read_b64_tr_b16 v[60:61], v2 offset:20480
  ds_read_b64_tr_b16 v[62:63], v2 offset:22528
  s_waitcnt lgkmcnt(10)
  ds_read_b64_tr_b16 v[64:65], v2 offset:24576
  ds_read_b64_tr_b16 v[66:67], v2 offset:26624
  s_waitcnt lgkmcnt(10)
  ds_read_b64_tr_b16 v[68:69], v2 offset:28672
  ds_read_b64_tr_b16 v[70:71], v2 offset:30720
  s_waitcnt lgkmcnt(10)
  ds_read_b64_tr_b16 v[72:73], v2 offset:32768
  ds_read_b64_tr_b16 v[74:75], v2 offset:34816
  s_waitcnt lgkmcnt(10)
  ds_read_b64_tr_b16 v[76:77], v2 offset:36864
  ds_read_b64_tr_b16 v[78:79], v2 offset:38912
  s_waitcnt lgkmcnt(10)
  ds_read_b64_tr_b16 v[80:81], v2 offset:40960
  ds_read_b64_tr_b16 v[82:83], v2 offset:43008
  s_waitcnt lgkmcnt(10)
  ds_read_b64_tr_b16 v[84:85], v2 offset:45056
  ds_read_b64_tr_b16 v[86:87], v2 offset:47104
  s_waitcnt lgkmcnt(10)
  ds_read_b64_tr_b16 v[88:89], v2 offset:49152
  ds_read_b64_tr_b16 v[90:91], v2 offset:51200
  s_waitcnt lgkmcnt(10)
  ds_read_b64_tr_b16 v[92:93], v2 offset:53248
  ds_read_b64_tr_b16 v[94:95], v2 offset:55296
  s_waitcnt lgkmcnt(10)
  ds_read_b64_tr_b16 v[96:97], v2 offset:57344
  ds_read_b64_tr_b16 v[98:99], v2 offset:59392
  s_waitcnt lgkmcnt(10)
  ds_read_b64_tr_b16 v[100:101], v2 offset:61440
  ds_read_b64_tr_b16 v[102:103], v2 offset:63488
  s_waitcnt lgkmcnt(10)
  s_waitcnt lgkmcnt(0)
  v_and_b32 v13, 1, v1
  v_lshlrev_b32 v13, 14, v13
  v_lshrrev_b32 v3, 4, v1
  v_lshl_add_u32 v13, v3, 4, v13
  s_lshl_b32 s49, s5, 6
  s_add_u32 s49, s49, s58
  v_add_u32 v13, s49, v13
  v_and_b32 v14, 1, v1
  v_mul_u32_u24 v14, 1056, v14
  v_lshrrev_b32 v3, 4, v1
  v_lshl_add_u32 v14, v3, 4, v14
  v_add_u32 v14, 1024, v14
  s_mov_b32 s70, 0
  s_branch L_q_c
L_q_p:
  s_mov_b64 exec, s[64:65]
  global_load_dwordx4 v[16:19], v15, s[42:43] sc1
  s_mov_b64 exec, s[66:67]
  global_load_dwordx4 v[32:35], v36, s[42:43] sc1
  s_mov_b64 exec, -1
L_q_c:
  s_waitcnt vmcnt(0)
  v_cmp_ne_u32 s[64:65], s74, v17
  v_cmp_ne_u32 s[68:69], s74, v19
  s_or_b64 s[64:65], s[64:65], s[68:69]
  v_cmp_ne_u32 s[66:67], s74, v33
  v_cmp_ne_u32 s[68:69], s74, v35
  s_or_b64 s[66:67], s[66:67], s[68:69]
  s_or_b64 vcc, s[64:65], s[66:67]
  s_or_b32 s64, s64, 1
  s_or_b32 s66, s66, 1
  s_cmp_eq_u64 vcc, 0
  s_cbranch_scc1 L_q_ok
  s_sleep 2
  s_add_u32 s70, s70, 1
  s_cmp_lt_u32 s70, 262144
  s_cbranch_scc1 L_q_p
L_q_ok:
  v_lshlrev_b32 v28, 16, v32
  v_and_b32 v29, s73, v32
  v_lshlrev_b32 v30, 16, v34
  v_and_b32 v31, s73, v34
  v_lshlrev_b32 v24, 16, v16
  v_and_b32 v25, s73, v16
  v_lshlrev_b32 v26, 16, v18
  v_and_b32 v27, s73, v18
  v_add_f32 v28, 1.0, v28
  v_add_f32 v29, 1.0, v29
  v_add_f32 v30, 1.0, v30
  v_add_f32 v31, 1.0, v31
  v_cvt_pk_bf16_f32 v28, 0, v28
  v_cvt_pk_bf16_f32 v29, 0, v29
  v_cvt_pk_bf16_f32 v30, 0, v30
  v_cvt_pk_bf16_f32 v31, 0, v31
  v_mul_f32 v20, v20, v28
  v_mul_f32 v21, v21, v29
  v_mul_f32 v22, v22, v30
  v_mul_f32 v23, v23, v31
  v_cvt_pk_bf16_f32 v20, 0, v20
  v_cvt_pk_bf16_f32 v21, 0, v21
  v_cvt_pk_bf16_f32 v22, 0, v22
  v_cvt_pk_bf16_f32 v23, 0, v23
  v_add_f32 v20, v20, v24
  v_add_f32 v21, v21, v25
  v_add_f32 v22, v22, v26
  v_add_f32 v23, v23, v27
  v_cvt_pk_bf16_f32 v16, v20, v21
  v_cvt_pk_bf16_f32 v17, v22, v23
  ds_write_b64 v12, v[16:17] offset:1024
  s_add_u32 s77, s77, 4
  v_mov_b32 v9, 1
  s_mov_b64 exec, 1
  ds_add_u32 v38, v9 offset:312
  s_mov_b64 exec, -1
  s_mov_b32 s70, 0
L_hy_43:
  ds_read_b32 v9, v38 offset:312
  s_waitcnt lgkmcnt(0)
  v_cmp_gt_u32 vcc, s77, v9
  s_cmp_eq_u64 vcc, 0
  s_cbranch_scc1 L_hyd_44
  s_add_u32 s70, s70, 1
  s_cmp_lt_u32 s70, 2097152
  s_cbranch_scc1 L_hy_43
L_hyd_44:
  ds_read_b128 v[104:107], v14 offset:0
  ds_read_b128 v[108:111], v14 offset:64
  ds_read_b128 v[112:115], v14 offset:128
  ds_read_b128 v[116:119], v14 offset:192
  ds_read_b128 v[120:123], v14 offset:256
  ds_read_b128 v[124:127], v14 offset:320
  ds_read_b128 v[128:131], v14 offset:384
  ds_read_b128 v[132:135], v14 offset:448
  ds_read_b128 v[136:139], v14 offset:512
  ds_read_b128 v[140:143], v14 offset:576
  ds_read_b128 v[144:147], v14 offset:640
  ds_read_b128 v[148:151], v14 offset:704
  s_waitcnt lgkmcnt(11)
  v_mfma_f32_16x16x32_bf16 v[8:11], v[40:43], v[104:107], 0
  ds_read_b128 v[152:155], v14 offset:768
  s_waitcnt lgkmcnt(11)
  v_mfma_f32_16x16x32_bf16 v[8:11], v[44:47], v[108:111], v[8:11]
  ds_read_b128 v[156:159], v14 offset:832
  s_waitcnt lgkmcnt(11)
  v_mfma_f32_16x16x32_bf16 v[8:11], v[48:51], v[112:115], v[8:11]
  ds_read_b128 v[160:163], v14 offset:896
  s_waitcnt lgkmcnt(11)
  v_mfma_f32_16x16x32_bf16 v[8:11], v[52:55], v[116:119], v[8:11]
  ds_read_b128 v[164:167], v14 offset:960
  s_waitcnt lgkmcnt(11)
  v_mfma_f32_16x16x32_bf16 v[8:11], v[56:59], v[120:123], v[8:11]
  s_waitcnt lgkmcnt(10)
  v_mfma_f32_16x16x32_bf16 v[8:11], v[60:63], v[124:127], v[8:11]
  s_waitcnt lgkmcnt(9)
  v_mfma_f32_16x16x32_bf16 v[8:11], v[64:67], v[128:131], v[8:11]
  s_waitcnt lgkmcnt(8)
  v_mfma_f32_16x16x32_bf16 v[8:11], v[68:71], v[132:135], v[8:11]
  s_waitcnt lgkmcnt(7)
  v_mfma_f32_16x16x32_bf16 v[8:11], v[72:75], v[136:139], v[8:11]
  s_waitcnt lgkmcnt(6)
  v_mfma_f32_16x16x32_bf16 v[8:11], v[76:79], v[140:143], v[8:11]
  s_waitcnt lgkmcnt(5)
  v_mfma_f32_16x16x32_bf16 v[8:11], v[80:83], v[144:147], v[8:11]
  s_waitcnt lgkmcnt(4)
  v_mfma_f32_16x16x32_bf16 v[8:11], v[84:87], v[148:151], v[8:11]
  s_waitcnt lgkmcnt(3)
  v_mfma_f32_16x16x32_bf16 v[8:11], v[88:91], v[152:155], v[8:11]
  s_waitcnt lgkmcnt(2)
  v_mfma_f32_16x16x32_bf16 v[8:11], v[92:95], v[156:159], v[8:11]
  s_waitcnt lgkmcnt(1)
  v_mfma_f32_16x16x32_bf16 v[8:11], v[96:99], v[160:163], v[8:11]
  s_waitcnt lgkmcnt(0)
  v_mfma_f32_16x16x32_bf16 v[8:11], v[100:103], v[164:167], v[8:11]
  s_nop 7
  v_cvt_pk_bf16_f32 v8, v8, v9
  v_cvt_pk_bf16_f32 v10, v10, v11
  v_mov_b32 v9, s74
  v_mov_b32 v11, s74
  v_min_u32 v8, s72, v8
  v_min_u32 v10, s72, v10
  s_mov_b32 exec_lo, 0x00030003
  s_mov_b32 exec_hi, 0x00030003
  global_store_dwordx4 v13, v[8:11], s[42:43] sc1
  s_mov_b64 exec, -1
L_r_wo:
  s_xor_b32 s61, s60, 1
  s_lshl_b32 s48, s8, 19
  s_lshl_b32 s49, s61, 7
  s_add_u32 s48, s48, s49
  s_lshr_b32 s58, s8, 1
  s_lshl_b32 s58, s58, 14
  s_and_b32 s49, s8, 1
  s_lshl_b32 s49, s49, 12
  s_add_u32 s58, s58, s49
  s_lshl_b32 s49, s61, 9
  s_add_u32 s58, s58, s49
  s_add_u32 s58, s58, 2097152
  s_mov_b32 s44, s24
  s_mov_b32 s45, s25
  s_mov_b32 s46, 4194304
  s_mov_b32 s47, 0x20000
  v_lshrrev_b32 v2, 3, v1
  v_and_b32 v3, 6, v2
  v_xor_b32 v3, v3, v1
  v_mul_u32_u24 v2, 1024, v2
  v_and_b32 v3, 7, v3
  v_lshl_add_u32 v2, v3, 4, v2
  s_mul_i32 s49, s5, 131072
  s_lshl_b32 s50, s5, 14
  s_add_u32 s49, s49, s48
  s_add_u32 s50, s50, 12288
  s_add_u32 s51, s50, 16384
L_dma_45:
  s_mov_b32 m0, s50
  s_add_u32 s50, s50, 1024
  buffer_load_dwordx4 v2, s[44:47], s49 offen nt lds
  s_add_u32 s49, s49, 8192
  s_waitcnt vmcnt(2)
  s_cmp_lt_u32 s50, s51
  s_cbranch_scc1 L_dma_45
L_dmae_46:
  s_bfe_u32 s32, s74, 0x80000
  s_bfe_u32 s33, s74, 0x80008
  s_bfe_u32 s34, s74, 0x80010
  s_bfe_u32 s35, s74, 0x80018
  s_lshl2_add_u32 s49, s8, s5
  s_lshl_b32 s49, s49, 11
  s_add_u32 s49, s49, 131072
  v_lshrrev_b32 v12, 5, v1
  v_and_b32 v16, 31, v1
  v_lshlrev_b32 v15, 16, v12
  v_lshl_add_u32 v15, v16, 4, v15
  v_add_u32 v15, s49, v15
  v_mul_u32_u24 v12, 1056, v12
  v_bfe_u32 v16, v1, 3, 2
  v_lshl_add_u32 v12, v16, 6, v12
  v_and_b32 v16, 3, v1
  v_lshl_add_u32 v12, v16, 4, v12
  v_bfe_u32 v16, v1, 2, 1
  v_lshl_add_u32 v12, v16, 3, v12
  s_lshl_b32 s49, s5, 8
  v_add_u32 v12, s49, v12
  v_and_b32 v13, 1, v1
  v_lshlrev_b32 v13, 6, v13
  v_lshrrev_b32 v3, 4, v1
  v_lshl_add_u32 v13, v3, 4, v13
  s_lshl_b32 s49, s5, 7
  s_add_u32 s49, s49, s58
  v_add_u32 v13, s49, v13
  v_bfe_u32 v3, v1, 1, 1
  v_lshl_add_u32 v13, v3, 16, v13
  v_mov_b32 v36, 0xff
  global_load_dword v11, v13, s[42:43] sc1
  s_waitcnt vmcnt(0)
  s_add_u32 s77, s77, 4
  v_mov_b32 v9, 1
  s_mov_b64 exec, 1
  ds_add_u32 v38, v9 offset:312
  s_mov_b64 exec, -1
  s_mov_b32 s70, 0
L_hy_47:
  ds_read_b32 v9, v38 offset:312
  s_waitcnt lgkmcnt(0)
  v_cmp_gt_u32 vcc, s77, v9
  s_cmp_eq_u64 vcc, 0
  s_cbranch_scc1 L_hyd_48
  s_sleep 4
  s_add_u32 s70, s70, 1
  s_cmp_lt_u32 s70, 2097152
  s_cbranch_scc1 L_hy_47
L_hyd_48:
  v_lshrrev_b32 v2, 2, v1
  v_bfe_u32 v3, v1, 1, 1
  s_lshl_b32 s49, s5, 1
  v_or_b32 v3, s49, v3
  v_and_b32 v10, 6, v2
  v_xor_b32 v3, v3, v10
  v_lshlrev_b32 v2, 7, v2
  v_lshl_add_u32 v2, v3, 4, v2
  v_and_b32 v3, 1, v1
  v_lshl_add_u32 v2, v3, 3, v2
  v_add_u32 v2, 12288, v2
  ds_read_b64_tr_b16 v[40:41], v2 offset:0
  ds_read_b64_tr_b16 v[42:43], v2 offset:2048
  ds_read_b64_tr_b16 v[44:45], v2 offset:4096
  ds_read_b64_tr_b16 v[46:47], v2 offset:6144
  ds_read_b64_tr_b16 v[48:49], v2 offset:8192
  ds_read_b64_tr_b16 v[50:51], v2 offset:10240
  ds_read_b64_tr_b16 v[52:53], v2 offset:12288
  ds_read_b64_tr_b16 v[54:55], v2 offset:14336
  ds_read_b64_tr_b16 v[56:57], v2 offset:16384
  ds_read_b64_tr_b16 v[58:59], v2 offset:18432
  ds_read_b64_tr_b16 v[60:61], v2 offset:20480
  ds_read_b64_tr_b16 v[62:63], v2 offset:22528
  s_waitcnt lgkmcnt(10)
  ds_read_b64_tr_b16 v[64:65], v2 offset:24576
  ds_read_b64_tr_b16 v[66:67], v2 offset:26624
  s_waitcnt lgkmcnt(10)
  ds_read_b64_tr_b16 v[68:69], v2 offset:28672
  ds_read_b64_tr_b16 v[70:71], v2 offset:30720
  s_waitcnt lgkmcnt(10)
  ds_read_b64_tr_b16 v[72:73], v2 offset:32768
  ds_read_b64_tr_b16 v[74:75], v2 offset:34816
  s_waitcnt lgkmcnt(10)
  ds_read_b64_tr_b16 v[76:77], v2 offset:36864
  ds_read_b64_tr_b16 v[78:79], v2 offset:38912
  s_waitcnt lgkmcnt(10)
  ds_read_b64_tr_b16 v[80:81], v2 offset:40960
  ds_read_b64_tr_b16 v[82:83], v2 offset:43008
  s_waitcnt lgkmcnt(10)
  ds_read_b64_tr_b16 v[84:85], v2 offset:45056
  ds_read_b64_tr_b16 v[86:87], v2 offset:47104
  s_waitcnt lgkmcnt(10)
  ds_read_b64_tr_b16 v[88:89], v2 offset:49152
  ds_read_b64_tr_b16 v[90:91], v2 offset:51200
  s_waitcnt lgkmcnt(10)
  ds_read_b64_tr_b16 v[92:93], v2 offset:53248
  ds_read_b64_tr_b16 v[94:95], v2 offset:55296
  s_waitcnt lgkmcnt(10)
  ds_read_b64_tr_b16 v[96:97], v2 offset:57344
  ds_read_b64_tr_b16 v[98:99], v2 offset:59392
  s_waitcnt lgkmcnt(10)
  ds_read_b64_tr_b16 v[100:101], v2 offset:61440
  ds_read_b64_tr_b16 v[102:103], v2 offset:63488
  s_waitcnt lgkmcnt(10)
  s_waitcnt lgkmcnt(0)
  s_mov_b32 s70, 0
L_pl_49:
  ds_read_b32 v8, v38 offset:256
  s_waitcnt lgkmcnt(0)
  v_cmp_eq_u32 vcc, -1, v8
  s_cmp_eq_u64 vcc, 0
  s_cbranch_scc1 L_pld_50
  s_sleep 8
  s_add_u32 s70, s70, 1
  s_cmp_lt_u32 s70, 1048576
  s_cbranch_scc1 L_pl_49
L_pld_50:
  s_mov_b64 s[20:21], -1
  s_mov_b64 s[22:23], -1
  s_mov_b64 s[24:25], -1
  s_mov_b64 exec, s[20:21]
  global_load_dwordx4 v[152:155], v15, s[42:43] offset:0 sc1
  s_mov_b64 exec, s[22:23]
  global_load_dwordx4 v[156:159], v15, s[42:43] offset:512 sc1
  s_mov_b64 exec, s[24:25]
  global_load_dwordx4 v[160:163], v15, s[42:43] offset:1024 sc1
  s_mov_b64 exec, -1
  s_waitcnt vmcnt(0)
  s_mov_b32 s70, 0
  s_branch L_wo_c
L_wo_:
  s_mov_b64 exec, s[20:21]
  global_load_dwordx4 v[152:155], v15, s[42:43] offset:0 sc1
  s_mov_b64 exec, s[22:23]
  global_load_dwordx4 v[156:159], v15, s[42:43] offset:512 sc1
  s_mov_b64 exec, s[24:25]
  global_load_dwordx4 v[160:163], v15, s[42:43] offset:1024 sc1
  s_mov_b64 exec, -1
  s_waitcnt vmcnt(0)
L_wo_c:
  v_xor_b32 v136, s32, v152
  v_xor_b32 v137, s33, v153
  v_xor_b32 v138, s34, v154
  v_xor_b32 v139, s35, v155
  v_xor_b32 v140, s32, v156
  v_xor_b32 v141, s33, v157
  v_xor_b32 v142, s34, v158
  v_xor_b32 v143, s35, v159
  v_xor_b32 v144, s32, v160
  v_xor_b32 v145, s33, v161
  v_xor_b32 v146, s34, v162
  v_xor_b32 v147, s35, v163
  v_or3_b32 v28, v136, v137, v138
  v_or3_b32 v29, v140, v141, v142
  v_or3_b32 v30, v144, v145, v146
  v_or_b32 v28, v28, v139
  v_or_b32 v29, v29, v143
  v_or_b32 v30, v30, v147
  v_cmp_ne_u32_sdwa s[20:21], v28, v38 src0_sel:BYTE_0 src1_sel:DWORD
  v_cmp_ne_u32_sdwa s[22:23], v29, v38 src0_sel:BYTE_0 src1_sel:DWORD
  v_cmp_ne_u32_sdwa s[24:25], v30, v38 src0_sel:BYTE_0 src1_sel:DWORD
  v_or_b32 v136, 0x80, v136
  v_or_b32 v137, 0x80, v137
  v_or_b32 v138, 0x80, v138
  v_or_b32 v139, 0x80, v139
  v_or_b32 v140, 0x80, v140
  v_or_b32 v141, 0x80, v141
  v_or_b32 v142, 0x80, v142
  v_or_b32 v143, 0x80, v143
  v_or_b32 v144, 0x80, v144
  v_or_b32 v145, 0x80, v145
  v_or_b32 v146, 0x80, v146
  v_or_b32 v147, 0x80, v147
  v_pk_add_f32 v[16:17], v[136:137], v[140:141]
  v_pk_add_f32 v[18:19], v[138:139], v[142:143]
  v_pk_add_f32 v[16:17], v[16:17], v[144:145]
  v_pk_add_f32 v[18:19], v[18:19], v[146:147]
  s_mov_b64 vcc, s[20:21]
  s_or_b64 vcc, vcc, s[22:23]
  s_or_b64 vcc, vcc, s[24:25]
  s_or_b32 s20, s20, 1
  s_or_b32 s22, s22, 1
  s_or_b32 s24, s24, 1
  s_cmp_eq_u64 vcc, 0
  s_cbranch_scc1 L_wo_ok
  s_add_u32 s70, s70, 1
  s_cmp_lt_u32 s70, 262144
  s_cbranch_scc1 L_wo_
L_wo_ok:
  v_cvt_pk_bf16_f32 v8, v16, v17
  v_cvt_pk_bf16_f32 v9, v18, v19
  ds_write_b64 v12, v[8:9] offset:1024
  s_add_u32 s77, s77, 4
  v_mov_b32 v3, 1
  s_mov_b64 exec, 1
  ds_add_u32 v38, v3 offset:312
  s_mov_b64 exec, -1
  s_mov_b32 s70, 0
L_hy_51:
  ds_read_b32 v3, v38 offset:312
  ds_read_b128 v[104:107], v14 offset:0
  ds_read_b128 v[108:111], v14 offset:64
  ds_read_b128 v[112:115], v14 offset:128
  ds_read_b128 v[116:119], v14 offset:192
  s_waitcnt lgkmcnt(4)
  v_cmp_gt_u32 vcc, s77, v3
  s_cmp_eq_u64 vcc, 0
  s_cbranch_scc1 L_hyd_52
  s_waitcnt lgkmcnt(0)
  s_add_u32 s70, s70, 1
  s_cmp_lt_u32 s70, 2097152
  s_cbranch_scc1 L_hy_51
L_hyd_52:
  ds_read_b128 v[120:123], v14 offset:256
  ds_read_b128 v[124:127], v14 offset:320
  ds_read_b128 v[128:131], v14 offset:384
  ds_read_b128 v[132:135], v14 offset:448
  ds_read_b128 v[136:139], v14 offset:512
  ds_read_b128 v[140:143], v14 offset:576
  ds_read_b128 v[144:147], v14 offset:640
  ds_read_b128 v[148:151], v14 offset:704
  s_waitcnt lgkmcnt(11)
  v_mfma_f32_16x16x32_bf16 v[8:11], v[40:43], v[104:107], 0
  s_waitcnt lgkmcnt(10)
  v_mfma_f32_16x16x32_bf16 v[8:11], v[44:47], v[108:111], v[8:11]
  ds_read_b128 v[104:107], v14 offset:768
  s_waitcnt lgkmcnt(10)
  v_mfma_f32_16x16x32_bf16 v[8:11], v[48:51], v[112:115], v[8:11]
  ds_read_b128 v[108:111], v14 offset:832
  s_waitcnt lgkmcnt(10)
  v_mfma_f32_16x16x32_bf16 v[8:11], v[52:55], v[116:119], v[8:11]
  ds_read_b128 v[112:115], v14 offset:896
  s_waitcnt lgkmcnt(10)
  v_mfma_f32_16x16x32_bf16 v[8:11], v[56:59], v[120:123], v[8:11]
  ds_read_b128 v[116:119], v14 offset:960
  s_waitcnt lgkmcnt(10)
  v_mfma_f32_16x16x32_bf16 v[8:11], v[60:63], v[124:127], v[8:11]
  s_waitcnt lgkmcnt(9)
  v_mfma_f32_16x16x32_bf16 v[8:11], v[64:67], v[128:131], v[8:11]
  s_waitcnt lgkmcnt(8)
  v_mfma_f32_16x16x32_bf16 v[8:11], v[68:71], v[132:135], v[8:11]
  s_waitcnt lgkmcnt(7)
  v_mfma_f32_16x16x32_bf16 v[8:11], v[72:75], v[136:139], v[8:11]
  s_waitcnt lgkmcnt(6)
  v_mfma_f32_16x16x32_bf16 v[8:11], v[76:79], v[140:143], v[8:11]
  s_waitcnt lgkmcnt(5)
  v_mfma_f32_16x16x32_bf16 v[8:11], v[80:83], v[144:147], v[8:11]
  s_waitcnt lgkmcnt(4)
  v_mfma_f32_16x16x32_bf16 v[8:11], v[84:87], v[148:151], v[8:11]
  s_waitcnt lgkmcnt(3)
  v_mfma_f32_16x16x32_bf16 v[8:11], v[88:91], v[104:107], v[8:11]
  s_waitcnt lgkmcnt(2)
  v_mfma_f32_16x16x32_bf16 v[8:11], v[92:95], v[108:111], v[8:11]
  s_waitcnt lgkmcnt(1)
  v_mfma_f32_16x16x32_bf16 v[8:11], v[96:99], v[112:115], v[8:11]
  s_waitcnt lgkmcnt(0)
  v_mfma_f32_16x16x32_bf16 v[8:11], v[100:103], v[116:119], v[8:11]
  s_nop 7
  v_bfi_b32 v8, v36, s32, v8
  v_bfi_b32 v9, v36, s33, v9
  v_bfi_b32 v10, v36, s34, v10
  v_bfi_b32 v11, v36, s35, v11
  s_mov_b32 exec_lo, 0x000f000f
  s_mov_b32 exec_hi, exec_lo
  global_store_dwordx4 v13, v[8:11], s[42:43] sc1
  v_mov_b32 v3, 1
  s_mov_b64 exec, 1
  ds_add_u32 v38, v3 offset:264
  s_mov_b64 exec, -1
  s_branch L_fin
L_r_mod:
  global_load_dwordx2 v[14:15], v37, s[34:35]
  s_mov_b32 s44, s36
  s_mov_b32 s45, s37
  s_mov_b32 s46, 3145728
  s_mov_b32 s47, 0x20000
  s_cmp_ge_u32 s60, 2
  s_cbranch_scc1 L_mod2
  s_lshl1_add_u32 s61, s8, s60
  s_lshl_b32 s48, s61, 7
  s_lshl_b32 s58, s61, 9
  s_add_u32 s58, s58, 917504
  v_lshrrev_b32 v2, 3, v1
  v_and_b32 v3, 6, v2
  v_xor_b32 v3, v3, v1
  v_mul_u32_u24 v2, 6144, v2
  v_and_b32 v3, 7, v3
  v_lshl_add_u32 v2, v3, 4, v2
  s_mul_i32 s49, s5, 786432
  s_lshl_b32 s50, s5, 14
  s_add_u32 s49, s49, s48
  s_add_u32 s50, s50, 77824
  s_add_u32 s51, s50, 16384
L_dma_53:
  s_mov_b32 m0, s50
  s_add_u32 s50, s50, 1024
  buffer_load_dwordx4 v2, s[44:47], s49 offen nt lds
  s_add_u32 s49, s49, 49152
  s_cmp_lt_u32 s50, s51
  s_cbranch_scc1 L_dma_53
L_dmae_54:
  v_mov_b32 v3, 1
  s_mov_b64 exec, 1
  ds_add_u32 v38, v3 offset:268
  s_mov_b64 exec, -1
  s_getpc_b64 s[56:57]
L_pc_55:
  s_lshr_b32 s3, s2, 5
  s_lshl3_add_u32 s3, s3, s8
  s_lshl_b32 s3, s3, 2
  s_add_u32 s3, s3, L_table-L_pc_55
  s_load_dword s14, s[56:57], s3
  s_waitcnt lgkmcnt(0)
  s_mul_i32 s74, s74, 0x9e3779b1
  s_add_u32 s74, s74, 0x7f4a7c15
  s_waitcnt vmcnt(16)
  v_lshlrev_b32 v16, 16, v14
  v_and_b32 v17, s73, v14
  v_lshlrev_b32 v18, 16, v15
  v_and_b32 v19, s73, v15
  v_mul_f32 v20, 0xbfb8aa3b, v16
  v_mul_f32 v21, 0xbfb8aa3b, v17
  v_mul_f32 v22, 0xbfb8aa3b, v18
  v_mul_f32 v23, 0xbfb8aa3b, v19
  v_exp_f32 v20, v20
  v_exp_f32 v21, v21
  v_exp_f32 v22, v22
  v_exp_f32 v23, v23
  s_nop 0
  v_add_f32 v20, 1.0, v20
  v_add_f32 v21, 1.0, v21
  v_add_f32 v22, 1.0, v22
  v_add_f32 v23, 1.0, v23
  v_rcp_f32 v20, v20
  v_rcp_f32 v21, v21
  v_rcp_f32 v22, v22
  v_rcp_f32 v23, v23
  s_nop 0
  v_mul_f32 v16, v16, v20
  v_mul_f32 v17, v17, v21
  v_mul_f32 v18, v18, v22
  v_mul_f32 v19, v19, v23
  v_cvt_pk_bf16_f32 v14, v16, v17
  v_cvt_pk_bf16_f32 v15, v18, v19
  ds_write_b64 v12, v[14:15] offset:3200
  v_and_b32 v13, 1, v1
  v_lshlrev_b32 v13, 6, v13
  v_lshrrev_b32 v3, 4, v1
  v_lshl_add_u32 v13, v3, 4, v13
  s_lshl_b32 s49, s5, 7
  s_add_u32 s49, s49, s58
  v_add_u32 v13, s49, v13
  v_bfe_u32 v3, v1, 1, 3
  v_lshl_add_u32 v13, v3, 13, v13
  v_and_b32 v14, 1, v1
  v_mul_u32_u24 v14, 1056, v14
  v_lshrrev_b32 v3, 4, v1
  v_lshl_add_u32 v14, v3, 4, v14
  v_add_u32 v14, 3200, v14
  v_lshrrev_b32 v2, 2, v1
  v_bfe_u32 v3, v1, 1, 1
  s_lshl_b32 s49, s5, 1
  v_or_b32 v3, s49, v3
  v_and_b32 v10, 6, v2
  v_xor_b32 v3, v3, v10
  v_lshlrev_b32 v2, 7, v2
  v_lshl_add_u32 v2, v3, 4, v2
  v_and_b32 v3, 1, v1
  v_lshl_add_u32 v2, v3, 3, v2
  v_add_u32 v2, 77824, v2
  s_waitcnt vmcnt(0) lgkmcnt(0)
  s_add_u32 s77, s77, 4
  v_mov_b32 v9, 1
  s_mov_b64 exec, 1
  ds_add_u32 v38, v9 offset:316
  s_mov_b64 exec, -1
  s_mov_b32 s70, 0
L_hy_56:
  ds_read_b32 v9, v38 offset:316
  s_waitcnt lgkmcnt(0)
  v_cmp_gt_u32 vcc, s77, v9
  s_cmp_eq_u64 vcc, 0
  s_cbranch_scc1 L_hyd_57
  s_add_u32 s70, s70, 1
  s_cmp_lt_u32 s70, 2097152
  s_cbranch_scc1 L_hy_56
L_hyd_57:
  ds_read_b64_tr_b16 v[40:41], v2 offset:0
  ds_read_b64_tr_b16 v[42:43], v2 offset:2048
  ds_read_b128 v[104:107], v14 offset:0
  ds_read_b64_tr_b16 v[44:45], v2 offset:4096
  ds_read_b64_tr_b16 v[46:47], v2 offset:6144
  ds_read_b128 v[108:111], v14 offset:64
  ds_read_b64_tr_b16 v[48:49], v2 offset:8192
  ds_read_b64_tr_b16 v[50:51], v2 offset:10240
  ds_read_b128 v[112:115], v14 offset:128
  ds_read_b64_tr_b16 v[52:53], v2 offset:12288
  ds_read_b64_tr_b16 v[54:55], v2 offset:14336
  ds_read_b128 v[116:119], v14 offset:192
  ds_read_b64_tr_b16 v[56:57], v2 offset:16384
  ds_read_b64_tr_b16 v[58:59], v2 offset:18432
  ds_read_b128 v[120:123], v14 offset:256
  s_waitcnt lgkmcnt(12)
  v_mfma_f32_16x16x32_bf16 v[8:11], v[40:43], v[104:107], 0
  ds_read_b64_tr_b16 v[60:61], v2 offset:20480
  ds_read_b64_tr_b16 v[62:63], v2 offset:22528
  ds_read_b128 v[124:127], v14 offset:320
  s_waitcnt lgkmcnt(12)
  v_mfma_f32_16x16x32_bf16 v[8:11], v[44:47], v[108:111], v[8:11]
  ds_read_b64_tr_b16 v[64:65], v2 offset:24576
  ds_read_b64_tr_b16 v[66:67], v2 offset:26624
  ds_read_b128 v[128:131], v14 offset:384
  s_waitcnt lgkmcnt(12)
  v_mfma_f32_16x16x32_bf16 v[8:11], v[48:51], v[112:115], v[8:11]
  ds_read_b64_tr_b16 v[68:69], v2 offset:28672
  ds_read_b64_tr_b16 v[70:71], v2 offset:30720
  ds_read_b128 v[132:135], v14 offset:448
  s_waitcnt lgkmcnt(12)
  v_mfma_f32_16x16x32_bf16 v[8:11], v[52:55], v[116:119], v[8:11]
  ds_read_b64_tr_b16 v[72:73], v2 offset:32768
  ds_read_b64_tr_b16 v[74:75], v2 offset:34816
  ds_read_b128 v[136:139], v14 offset:512
  s_waitcnt lgkmcnt(12)
  v_mfma_f32_16x16x32_bf16 v[8:11], v[56:59], v[120:123], v[8:11]
  ds_read_b64_tr_b16 v[76:77], v2 offset:36864
  ds_read_b64_tr_b16 v[78:79], v2 offset:38912
  ds_read_b128 v[140:143], v14 offset:576
  s_waitcnt lgkmcnt(12)
  v_mfma_f32_16x16x32_bf16 v[8:11], v[60:63], v[124:127], v[8:11]
  ds_read_b64_tr_b16 v[80:81], v2 offset:40960
  ds_read_b64_tr_b16 v[82:83], v2 offset:43008
  ds_read_b128 v[144:147], v14 offset:640
  s_waitcnt lgkmcnt(12)
  v_mfma_f32_16x16x32_bf16 v[8:11], v[64:67], v[128:131], v[8:11]
  ds_read_b64_tr_b16 v[84:85], v2 offset:45056
  ds_read_b64_tr_b16 v[86:87], v2 offset:47104
  ds_read_b128 v[148:151], v14 offset:704
  s_waitcnt lgkmcnt(12)
  v_mfma_f32_16x16x32_bf16 v[8:11], v[68:71], v[132:135], v[8:11]
  ds_read_b64_tr_b16 v[88:89], v2 offset:49152
  ds_read_b64_tr_b16 v[90:91], v2 offset:51200
  ds_read_b128 v[152:155], v14 offset:768
  s_waitcnt lgkmcnt(12)
  v_mfma_f32_16x16x32_bf16 v[8:11], v[72:75], v[136:139], v[8:11]
  ds_read_b64_tr_b16 v[92:93], v2 offset:53248
  ds_read_b64_tr_b16 v[94:95], v2 offset:55296
  ds_read_b128 v[156:159], v14 offset:832
  s_waitcnt lgkmcnt(12)
  v_mfma_f32_16x16x32_bf16 v[8:11], v[76:79], v[140:143], v[8:11]
  ds_read_b64_tr_b16 v[96:97], v2 offset:57344
  ds_read_b64_tr_b16 v[98:99], v2 offset:59392
  ds_read_b128 v[160:163], v14 offset:896
  s_waitcnt lgkmcnt(12)
  v_mfma_f32_16x16x32_bf16 v[8:11], v[80:83], v[144:147], v[8:11]
  ds_read_b64_tr_b16 v[100:101], v2 offset:61440
  ds_read_b64_tr_b16 v[102:103], v2 offset:63488
  ds_read_b128 v[164:167], v14 offset:960
  s_waitcnt lgkmcnt(12)
  v_mfma_f32_16x16x32_bf16 v[8:11], v[84:87], v[148:151], v[8:11]
  s_waitcnt lgkmcnt(9)
  v_mfma_f32_16x16x32_bf16 v[8:11], v[88:91], v[152:155], v[8:11]
  s_waitcnt lgkmcnt(6)
  v_mfma_f32_16x16x32_bf16 v[8:11], v[92:95], v[156:159], v[8:11]
  s_waitcnt lgkmcnt(3)
  v_mfma_f32_16x16x32_bf16 v[8:11], v[96:99], v[160:163], v[8:11]
  s_waitcnt lgkmcnt(0)
  v_mfma_f32_16x16x32_bf16 v[8:11], v[100:103], v[164:167], v[8:11]
  s_nop 7
  v_cvt_pk_bf16_f32 v8, v8, v9
  v_cvt_pk_bf16_f32 v10, v10, v11
  v_mov_b32 v9, s74
  v_mov_b32 v11, s74
  global_store_dwordx4 v13, v[8:11], s[42:43] sc1
  s_mov_b64 exec, -1
  s_add_u32 s77, s77, 4
  v_mov_b32 v9, 1
  s_mov_b64 exec, 1
  ds_add_u32 v38, v9 offset:316
  s_mov_b64 exec, -1
  s_mov_b32 s70, 0
L_hy_58:
  ds_read_b32 v9, v38 offset:316
  s_waitcnt lgkmcnt(0)
  v_cmp_gt_u32 vcc, s77, v9
  s_cmp_eq_u64 vcc, 0
  s_cbranch_scc1 L_hyd_59
  s_add_u32 s70, s70, 1
  s_cmp_lt_u32 s70, 2097152
  s_cbranch_scc1 L_hy_58
L_hyd_59:
  s_branch L_mod3
L_mod2:
  s_getpc_b64 s[56:57]
L_pc_60:
  s_lshr_b32 s3, s2, 5
  s_lshl3_add_u32 s3, s3, s8
  s_lshl_b32 s3, s3, 2
  s_add_u32 s3, s3, L_table-L_pc_60
  s_load_dword s14, s[56:57], s3
  s_waitcnt lgkmcnt(0)
  s_mul_i32 s74, s74, 0x9e3779b1
  s_add_u32 s74, s74, 0x7f4a7c15
  s_waitcnt vmcnt(0)
  v_lshlrev_b32 v16, 16, v14
  v_and_b32 v17, s73, v14
  v_lshlrev_b32 v18, 16, v15
  v_and_b32 v19, s73, v15
  v_mul_f32 v20, 0xbfb8aa3b, v16
  v_mul_f32 v21, 0xbfb8aa3b, v17
  v_mul_f32 v22, 0xbfb8aa3b, v18
  v_mul_f32 v23, 0xbfb8aa3b, v19
  v_exp_f32 v20, v20
  v_exp_f32 v21, v21
  v_exp_f32 v22, v22
  v_exp_f32 v23, v23
  s_nop 0
  v_add_f32 v20, 1.0, v20
  v_add_f32 v21, 1.0, v21
  v_add_f32 v22, 1.0, v22
  v_add_f32 v23, 1.0, v23
  v_rcp_f32 v20, v20
  v_rcp_f32 v21, v21
  v_rcp_f32 v22, v22
  v_rcp_f32 v23, v23
  s_nop 0
  v_mul_f32 v16, v16, v20
  v_mul_f32 v17, v17, v21
  v_mul_f32 v18, v18, v22
  v_mul_f32 v19, v19, v23
  v_cvt_pk_bf16_f32 v14, v16, v17
  v_cvt_pk_bf16_f32 v15, v18, v19
  ds_write_b64 v12, v[14:15] offset:3200
L_mod3:
  s_mov_b32 s70, 0
L_sn_61:
  ds_read_b32 v8, v38 offset:264
  s_waitcnt lgkmcnt(0)
  v_cmp_gt_u32 vcc, 0x4, v8
  s_cmp_eq_u64 vcc, 0
  s_cbranch_scc1 L_snd_62
  s_sleep 4
  s_add_u32 s70, s70, 1
  s_cmp_lt_u32 s70, 2097152
  s_cbranch_scc1 L_sn_61
L_snd_62:
  s_and_b32 s61, s14, 0xff
  s_cmp_ge_u32 s61, 48
  s_cbranch_scc1 L_r_f1
  s_mov_b32 s70, 0
L_sn_63:
  ds_read_b32 v8, v38 offset:312
  s_waitcnt lgkmcnt(0)
  v_cmp_gt_u32 vcc, 0x8, v8
  s_cmp_eq_u64 vcc, 0
  s_cbranch_scc1 L_snd_64
  s_sleep 4
  s_add_u32 s70, s70, 1
  s_cmp_lt_u32 s70, 2097152
  s_cbranch_scc1 L_sn_63
L_snd_64:
  s_and_b32 s61, s14, 0xff
L_mod4:
  s_cmp_ge_u32 s61, 48
  s_cbranch_scc1 L_r_f1
  s_lshl_b32 s48, s61, 7
  s_lshl_b32 s58, s61, 9
  s_add_u32 s58, s58, 4096
  v_lshrrev_b32 v2, 3, v1
  v_and_b32 v3, 6, v2
  v_xor_b32 v3, v3, v1
  v_mul_u32_u24 v2, 6144, v2
  v_and_b32 v3, 7, v3
  v_lshl_add_u32 v2, v3, 4, v2
  s_mul_i32 s49, s5, 786432
  s_lshl_b32 s50, s5, 14
  s_add_u32 s49, s49, s48
  s_add_u32 s50, s50, 77824
  s_add_u32 s51, s50, 16384
L_dma_65:
  s_mov_b32 m0, s50
  s_add_u32 s50, s50, 1024
  buffer_load_dwordx4 v2, s[44:47], s49 offen nt lds
  s_add_u32 s49, s49, 49152
  s_waitcnt vmcnt(5)
  s_cmp_lt_u32 s50, s51
  s_cbranch_scc1 L_dma_65
L_dmae_66:
  v_and_b32 v13, 1, v1
  v_lshlrev_b32 v13, 6, v13
  v_lshrrev_b32 v3, 4, v1
  v_lshl_add_u32 v13, v3, 4, v13
  s_lshl_b32 s49, s5, 7
  s_add_u32 s49, s49, s58
  v_add_u32 v13, s49, v13
  v_and_b32 v14, 1, v1
  v_mul_u32_u24 v14, 1056, v14
  v_lshrrev_b32 v3, 4, v1
  v_lshl_add_u32 v14, v3, 4, v14
  v_add_u32 v14, 3200, v14
  v_lshrrev_b32 v2, 2, v1
  v_bfe_u32 v3, v1, 1, 1
  s_lshl_b32 s49, s5, 1
  v_or_b32 v3, s49, v3
  v_and_b32 v10, 6, v2
  v_xor_b32 v3, v3, v10
  v_lshlrev_b32 v2, 7, v2
  v_lshl_add_u32 v2, v3, 4, v2
  v_and_b32 v3, 1, v1
  v_lshl_add_u32 v2, v3, 3, v2
  v_add_u32 v2, 77824, v2
  s_waitcnt vmcnt(0) lgkmcnt(0)
  s_add_u32 s77, s77, 4
  v_mov_b32 v9, 1
  s_mov_b64 exec, 1
  ds_add_u32 v38, v9 offset:316
  s_mov_b64 exec, -1
  s_mov_b32 s70, 0
L_hy_67:
  ds_read_b32 v9, v38 offset:316
  s_waitcnt lgkmcnt(0)
  v_cmp_gt_u32 vcc, s77, v9
  s_cmp_eq_u64 vcc, 0
  s_cbranch_scc1 L_hyd_68
  s_sleep 4
  s_add_u32 s70, s70, 1
  s_cmp_lt_u32 s70, 2097152
  s_cbranch_scc1 L_hy_67
L_hyd_68:
  ds_read_b64_tr_b16 v[40:41], v2 offset:0
  ds_read_b64_tr_b16 v[42:43], v2 offset:2048
  ds_read_b128 v[104:107], v14 offset:0
  ds_read_b64_tr_b16 v[44:45], v2 offset:4096
  ds_read_b64_tr_b16 v[46:47], v2 offset:6144
  ds_read_b128 v[108:111], v14 offset:64
  ds_read_b64_tr_b16 v[48:49], v2 offset:8192
  ds_read_b64_tr_b16 v[50:51], v2 offset:10240
  ds_read_b128 v[112:115], v14 offset:128
  ds_read_b64_tr_b16 v[52:53], v2 offset:12288
  ds_read_b64_tr_b16 v[54:55], v2 offset:14336
  ds_read_b128 v[116:119], v14 offset:192
  ds_read_b64_tr_b16 v[56:57], v2 offset:16384
  ds_read_b64_tr_b16 v[58:59], v2 offset:18432
  ds_read_b128 v[120:123], v14 offset:256
  s_waitcnt lgkmcnt(12)
  v_mfma_f32_16x16x32_bf16 v[8:11], v[40:43], v[104:107], 0
  ds_read_b64_tr_b16 v[60:61], v2 offset:20480
  ds_read_b64_tr_b16 v[62:63], v2 offset:22528
  ds_read_b128 v[124:127], v14 offset:320
  s_waitcnt lgkmcnt(12)
  v_mfma_f32_16x16x32_bf16 v[8:11], v[44:47], v[108:111], v[8:11]
  ds_read_b64_tr_b16 v[64:65], v2 offset:24576
  ds_read_b64_tr_b16 v[66:67], v2 offset:26624
  ds_read_b128 v[128:131], v14 offset:384
  s_waitcnt lgkmcnt(12)
  v_mfma_f32_16x16x32_bf16 v[8:11], v[48:51], v[112:115], v[8:11]
  ds_read_b64_tr_b16 v[68:69], v2 offset:28672
  ds_read_b64_tr_b16 v[70:71], v2 offset:30720
  ds_read_b128 v[132:135], v14 offset:448
  s_waitcnt lgkmcnt(12)
  v_mfma_f32_16x16x32_bf16 v[8:11], v[52:55], v[116:119], v[8:11]
  ds_read_b64_tr_b16 v[72:73], v2 offset:32768
  ds_read_b64_tr_b16 v[74:75], v2 offset:34816
  ds_read_b128 v[136:139], v14 offset:512
  s_waitcnt lgkmcnt(12)
  v_mfma_f32_16x16x32_bf16 v[8:11], v[56:59], v[120:123], v[8:11]
  ds_read_b64_tr_b16 v[76:77], v2 offset:36864
  ds_read_b64_tr_b16 v[78:79], v2 offset:38912
  ds_read_b128 v[140:143], v14 offset:576
  s_waitcnt lgkmcnt(12)
  v_mfma_f32_16x16x32_bf16 v[8:11], v[60:63], v[124:127], v[8:11]
  ds_read_b64_tr_b16 v[80:81], v2 offset:40960
  ds_read_b64_tr_b16 v[82:83], v2 offset:43008
  ds_read_b128 v[144:147], v14 offset:640
  s_waitcnt lgkmcnt(12)
  v_mfma_f32_16x16x32_bf16 v[8:11], v[64:67], v[128:131], v[8:11]
  ds_read_b64_tr_b16 v[84:85], v2 offset:45056
  ds_read_b64_tr_b16 v[86:87], v2 offset:47104
  ds_read_b128 v[148:151], v14 offset:704
  s_waitcnt lgkmcnt(12)
  v_mfma_f32_16x16x32_bf16 v[8:11], v[68:71], v[132:135], v[8:11]
  ds_read_b64_tr_b16 v[88:89], v2 offset:49152
  ds_read_b64_tr_b16 v[90:91], v2 offset:51200
  ds_read_b128 v[152:155], v14 offset:768
  s_waitcnt lgkmcnt(12)
  v_mfma_f32_16x16x32_bf16 v[8:11], v[72:75], v[136:139], v[8:11]
  ds_read_b64_tr_b16 v[92:93], v2 offset:53248
  ds_read_b64_tr_b16 v[94:95], v2 offset:55296
  ds_read_b128 v[156:159], v14 offset:832
  s_waitcnt lgkmcnt(12)
  v_mfma_f32_16x16x32_bf16 v[8:11], v[76:79], v[140:143], v[8:11]
  ds_read_b64_tr_b16 v[96:97], v2 offset:57344
  ds_read_b64_tr_b16 v[98:99], v2 offset:59392
  ds_read_b128 v[160:163], v14 offset:896
  s_waitcnt lgkmcnt(12)
  v_mfma_f32_16x16x32_bf16 v[8:11], v[80:83], v[144:147], v[8:11]
  ds_read_b64_tr_b16 v[100:101], v2 offset:61440
  ds_read_b64_tr_b16 v[102:103], v2 offset:63488
  ds_read_b128 v[164:167], v14 offset:960
  s_waitcnt lgkmcnt(12)
  v_mfma_f32_16x16x32_bf16 v[8:11], v[84:87], v[148:151], v[8:11]
  s_waitcnt lgkmcnt(9)
  v_mfma_f32_16x16x32_bf16 v[8:11], v[88:91], v[152:155], v[8:11]
  s_waitcnt lgkmcnt(6)
  v_mfma_f32_16x16x32_bf16 v[8:11], v[92:95], v[156:159], v[8:11]
  s_waitcnt lgkmcnt(3)
  v_mfma_f32_16x16x32_bf16 v[8:11], v[96:99], v[160:163], v[8:11]
  s_waitcnt lgkmcnt(0)
  v_mfma_f32_16x16x32_bf16 v[8:11], v[100:103], v[164:167], v[8:11]
  s_nop 7
  v_cvt_pk_bf16_f32 v8, v8, v9
  v_cvt_pk_bf16_f32 v10, v10, v11
  v_mov_b32 v9, s74
  v_mov_b32 v11, s74
  s_mov_b32 exec_lo, 0x00030003
  s_mov_b32 exec_hi, 0x00030003
  global_store_dwordx4 v13, v[8:11], s[42:43] sc1
  s_mov_b64 exec, -1
  s_add_u32 s77, s77, 4
  v_mov_b32 v9, 1
  s_mov_b64 exec, 1
  ds_add_u32 v38, v9 offset:316
  s_mov_b64 exec, -1
  s_mov_b32 s70, 0
L_hy_69:
  ds_read_b32 v9, v38 offset:316
  s_waitcnt lgkmcnt(0)
  v_cmp_gt_u32 vcc, s77, v9
  s_cmp_eq_u64 vcc, 0
  s_cbranch_scc1 L_hyd_70
  s_add_u32 s70, s70, 1
  s_cmp_lt_u32 s70, 2097152
  s_cbranch_scc1 L_hy_69
L_hyd_70:
  s_lshr_b32 s61, s14, 24
  s_or_b32 s14, s14, 0xff000000
  s_branch L_mod4
L_r_f1:
  s_bfe_u32 s61, s14, 0x80008
  s_cmp_ge_u32 s61, 43
  s_cbranch_scc1 L_fin
  s_lshl_b32 s48, s61, 6
  s_lshl_b32 s58, s61, 7
  s_add_u32 s58, s58, 1572864
  s_cmp_lt_u32 s5, 2
  s_cselect_b32 s44, s28, s30
  s_cselect_b32 s45, s29, s31
  s_mov_b32 s46, 1409024
  s_and_b32 s54, s61, 1
  v_lshrrev_b32 v2, 2, v1
  v_mul_u32_u24 v2, 5504, v2
  s_and_b32 s49, s5, 2
  s_or_b32 s49, s49, s54
  v_xor_b32 v3, s49, v1
  v_and_b32 v3, 3, v3
  v_lshl_add_u32 v2, v3, 4, v2
  s_and_b32 s55, s5, 1
  s_mul_i32 s49, s55, 704512
  s_add_u32 s49, s49, s48
  s_mul_i32 s50, s54, 2752
  s_add_u32 s49, s49, s50
  s_lshr_b32 s50, s5, 1
  s_lshl_b32 s50, s50, 15
  s_lshl_b32 s54, s54, 14
  s_add_u32 s50, s50, s54
  s_lshl_b32 s55, s55, 13
  s_add_u32 s50, s50, s55
  s_add_u32 s50, s50, 77824
  s_mov_b32 s70, 0
L_sn_71:
  ds_read_b32 v8, v38 offset:260
  s_waitcnt lgkmcnt(0)
  v_cmp_gt_u32 vcc, 0x1, v8
  s_cmp_eq_u64 vcc, 0
  s_cbranch_scc1 L_snd_72
  s_sleep 8
  s_add_u32 s70, s70, 1
  s_cmp_lt_u32 s70, 2097152
  s_cbranch_scc1 L_sn_71
L_snd_72:
  s_add_u32 s51, s50, 8192
L_dma_73:
  s_mov_b32 m0, s50
  s_add_u32 s50, s50, 1024
  buffer_load_dwordx4 v2, s[44:47], s49 offen  lds
  s_add_u32 s49, s49, 88064
  s_waitcnt vmcnt(3)
  s_cmp_lt_u32 s50, s51
  s_cbranch_scc1 L_dma_73
L_dmae_74:
  s_andn2_b32 s54, 1, s61
  v_lshrrev_b32 v2, 2, v1
  v_mul_u32_u24 v2, 5504, v2
  s_and_b32 s49, s5, 2
  s_or_b32 s49, s49, s54
  v_xor_b32 v3, s49, v1
  v_and_b32 v3, 3, v3
  v_lshl_add_u32 v2, v3, 4, v2
  s_and_b32 s55, s5, 1
  s_mul_i32 s49, s55, 704512
  s_add_u32 s49, s49, s48
  s_mul_i32 s50, s54, 2752
  s_add_u32 s49, s49, s50
  s_lshr_b32 s50, s5, 1
  s_lshl_b32 s50, s50, 15
  s_lshl_b32 s54, s54, 14
  s_add_u32 s50, s50, s54
  s_lshl_b32 s55, s55, 13
  s_add_u32 s50, s50, s55
  s_add_u32 s50, s50, 77824
  s_add_u32 s51, s50, 8192
L_dma_75:
  s_mov_b32 m0, s50
  s_add_u32 s50, s50, 1024
  buffer_load_dwordx4 v2, s[44:47], s49 offen nt lds
  s_add_u32 s49, s49, 88064
  s_waitcnt vmcnt(3)
  s_cmp_lt_u32 s50, s51
  s_cbranch_scc1 L_dma_75
L_dmae_76:
  v_lshlrev_b32 v15, 4, v0
  v_add_u32 v39, 16384, v15
  s_and_b32 s59, s2, 1
  s_lshl_b32 s59, s59, 16
  s_add_u32 s59, s59, 2101248
  v_add_u32 v15, s59, v15
  v_lshrrev_b32 v5, 2, v0
  v_lshlrev_b32 v5, 3, v5
  v_add_u32 v5, 9536, v5
  v_lshlrev_b32 v7, 3, v1
  v_add_u32 v7, 9536, v7
  v_and_b32 v14, 7, v1
  v_mul_u32_u24 v14, 1056, v14
  v_lshrrev_b32 v3, 4, v1
  v_lshl_add_u32 v14, v3, 4, v14
  v_bfe_u32 v6, v1, 2, 2
  v_lshl_add_u32 v6, v3, 3, v6
  v_mul_u32_u24 v6, 1056, v6
  v_and_b32 v8, 3, v1
  v_lshl_add_u32 v6, v8, 3, v6
  s_lshl_b32 s49, s5, 8
  s_add_u32 s49, s49, 77824
  v_add_u32 v6, s49, v6
  v_lshlrev_b32 v10, 3, v0
  v_add_u32 v10, 10048, v10
  v_mov_b32 v8, 0
  v_mov_b32 v9, 0
  ds_write_b64 v10, v[8:9]
  v_and_b32 v13, 1, v1
  v_lshlrev_b32 v13, 6, v13
  v_lshrrev_b32 v3, 4, v1
  v_lshl_add_u32 v13, v3, 4, v13
  s_lshl_b32 s49, s5, 17
  s_add_u32 s49, s49, s58
  v_add_u32 v13, s49, v13
  v_bfe_u32 v3, v1, 1, 3
  v_lshl_add_u32 v13, v3, 14, v13
  v_lshrrev_b32 v2, 3, v1
  v_lshlrev_b32 v2, 6, v2
  v_bfe_u32 v3, v1, 2, 1
  v_lshl_add_u32 v2, v3, 14, v2
  v_and_b32 v8, 2, v1
  v_or_b32 v3, v3, v8
  v_xor_b32 v3, s5, v3
  v_lshl_add_u32 v2, v3, 4, v2
  v_lshl_add_u32 v2, v8, 14, v2
  v_and_b32 v3, 1, v1
  v_lshl_add_u32 v2, v3, 3, v2
  v_add_u32 v2, 77824, v2
  s_waitcnt vmcnt(0)
  s_add_u32 s77, s77, 4
  v_mov_b32 v9, 1
  s_mov_b64 exec, 1
  ds_add_u32 v38, v9 offset:316
  s_mov_b64 exec, -1
  s_mov_b32 s70, 0
L_hy_77:
  ds_read_b32 v9, v38 offset:316
  s_waitcnt lgkmcnt(0)
  v_cmp_gt_u32 vcc, s77, v9
  s_cmp_eq_u64 vcc, 0
  s_cbranch_scc1 L_hyd_78
  s_sleep 4
  s_add_u32 s70, s70, 1
  s_cmp_lt_u32 s70, 2097152
  s_cbranch_scc1 L_hy_77
L_hyd_78:
  ds_read_b64_tr_b16 v[40:41], v2 offset:0
  ds_read_b64_tr_b16 v[42:43], v2 offset:512
  ds_read_b64_tr_b16 v[44:45], v2 offset:1024
  ds_read_b64_tr_b16 v[46:47], v2 offset:1536
  ds_read_b64_tr_b16 v[48:49], v2 offset:2048
  ds_read_b64_tr_b16 v[50:51], v2 offset:2560
  ds_read_b64_tr_b16 v[52:53], v2 offset:3072
  ds_read_b64_tr_b16 v[54:55], v2 offset:3584
  ds_read_b64_tr_b16 v[56:57], v2 offset:4096
  ds_read_b64_tr_b16 v[58:59], v2 offset:4608
  ds_read_b64_tr_b16 v[60:61], v2 offset:5120
  ds_read_b64_tr_b16 v[62:63], v2 offset:5632
  s_waitcnt lgkmcnt(10)
  ds_read_b64_tr_b16 v[64:65], v2 offset:6144
  ds_read_b64_tr_b16 v[66:67], v2 offset:6656
  s_waitcnt lgkmcnt(10)
  ds_read_b64_tr_b16 v[68:69], v2 offset:7168
  ds_read_b64_tr_b16 v[70:71], v2 offset:7680
  s_waitcnt lgkmcnt(10)
  ds_read_b64_tr_b16 v[72:73], v2 offset:8192
  ds_read_b64_tr_b16 v[74:75], v2 offset:8704
  s_waitcnt lgkmcnt(10)
  ds_read_b64_tr_b16 v[76:77], v2 offset:9216
  ds_read_b64_tr_b16 v[78:79], v2 offset:9728
  s_waitcnt lgkmcnt(10)
  ds_read_b64_tr_b16 v[80:81], v2 offset:10240
  ds_read_b64_tr_b16 v[82:83], v2 offset:10752
  s_waitcnt lgkmcnt(10)
  ds_read_b64_tr_b16 v[84:85], v2 offset:11264
  ds_read_b64_tr_b16 v[86:87], v2 offset:11776
  s_waitcnt lgkmcnt(10)
  ds_read_b64_tr_b16 v[88:89], v2 offset:12288
  ds_read_b64_tr_b16 v[90:91], v2 offset:12800
  s_waitcnt lgkmcnt(10)
  ds_read_b64_tr_b16 v[92:93], v2 offset:13312
  ds_read_b64_tr_b16 v[94:95], v2 offset:13824
  s_waitcnt lgkmcnt(10)
  ds_read_b64_tr_b16 v[96:97], v2 offset:14336
  ds_read_b64_tr_b16 v[98:99], v2 offset:14848
  s_waitcnt lgkmcnt(10)
  ds_read_b64_tr_b16 v[100:101], v2 offset:15360
  ds_read_b64_tr_b16 v[102:103], v2 offset:15872
  s_waitcnt lgkmcnt(10)
  s_waitcnt lgkmcnt(0)
  s_add_u32 s77, s77, 4
  v_mov_b32 v9, 1
  s_mov_b64 exec, 1
  ds_add_u32 v38, v9 offset:316
  s_mov_b64 exec, -1
  s_mov_b32 s70, 0
L_hy_79:
  ds_read_b32 v9, v38 offset:316
  s_waitcnt lgkmcnt(0)
  v_cmp_gt_u32 vcc, s77, v9
  s_cmp_eq_u64 vcc, 0
  s_cbranch_scc1 L_hyd_80
  s_add_u32 s70, s70, 1
  s_cmp_lt_u32 s70, 2097152
  s_cbranch_scc1 L_hy_79
L_hyd_80:
  s_mov_b32 s44, s32
  s_mov_b32 s45, s33
  s_mov_b32 s46, 1409024
  s_mov_b32 s47, 0x20000
  v_lshlrev_b32 v2, 4, v1
  s_lshl2_add_u32 s49, s61, s5
  s_lshl_b32 s49, s49, 13
  s_mul_i32 s50, s5, 8448
  s_add_u32 s50, s50, 77824
  s_add_u32 s51, s50, 8448
L_dma_81:
  s_mov_b32 m0, s50
  s_add_u32 s50, s50, 1056
  buffer_load_dwordx4 v2, s[44:47], s49 offen nt lds
  s_add_u32 s49, s49, 1024
  s_waitcnt vmcnt(3)
  s_cmp_lt_u32 s50, s51
  s_cbranch_scc1 L_dma_81
L_dmae_82:
  s_bfe_u32 s32, s74, 0x80000
  s_bfe_u32 s33, s74, 0x80008
  s_bfe_u32 s34, s74, 0x80010
  s_bfe_u32 s35, s74, 0x80018
  v_add_u32 v4, 16384, v15
  v_add_u32 v0, 32768, v15
  v_add_u32 v36, 49152, v15
  global_load_dwordx2 v[8:9], v37, s[16:17]
  s_mov_b32 s70, 0
L_pg_83:
  global_load_dwordx4 v[136:139], v39, s[42:43] offset:-4096 sc1
  global_load_dwordx4 v[140:143], v39, s[42:43] offset:0 sc1
  v_add_u32 v3, 4096, v39
  global_load_dwordx4 v[144:147], v3, s[42:43] sc1
  s_waitcnt vmcnt(0)
  s_mov_b64 vcc, 0
  v_cmp_ne_u32 s[68:69], s74, v137
  s_or_b64 vcc, vcc, s[68:69]
  v_cmp_ne_u32 s[68:69], s74, v139
  s_or_b64 vcc, vcc, s[68:69]
  v_cmp_ne_u32 s[68:69], s74, v141
  s_or_b64 vcc, vcc, s[68:69]
  v_cmp_ne_u32 s[68:69], s74, v143
  s_or_b64 vcc, vcc, s[68:69]
  v_cmp_ne_u32 s[68:69], s74, v145
  s_or_b64 vcc, vcc, s[68:69]
  v_cmp_ne_u32 s[68:69], s74, v147
  s_or_b64 vcc, vcc, s[68:69]
  s_cmp_eq_u64 vcc, 0
  s_cbranch_scc1 L_pge_84
  s_sleep 8
  s_add_u32 s70, s70, 1
  s_cmp_lt_u32 s70, 262144
  s_cbranch_scc1 L_pg_83
L_pge_84:
  v_and_b32 v39, 1, v1
  v_lshlrev_b32 v39, 6, v39
  v_add_u32 v39, 10944, v39
  v_lshrrev_b32 v3, 4, v1
  v_lshl_add_u32 v37, v3, 4, v39
  v_bfe_u32 v3, v1, 1, 3
  v_lshlrev_b32 v3, 7, v3
  v_sub_u32 v37, v37, v3
  v_bfe_u32 v3, v1, 4, 1
  v_lshl_add_u32 v39, v3, 3, v39
  v_lshrrev_b32 v3, 5, v1
  v_lshl_add_u32 v39, v3, 2, v39
  s_lshl_b32 s49, s5, 4
  v_add_u32 v39, s49, v39
  v_lshlrev_b32 v16, 16, v8
  v_and_b32 v17, s73, v8
  v_lshlrev_b32 v18, 16, v9
  v_and_b32 v19, s73, v9
  v_lshlrev_b32 v20, 16, v136
  v_and_b32 v21, s73, v136
  v_lshlrev_b32 v22, 16, v138
  v_and_b32 v23, s73, v138
  v_lshlrev_b32 v28, 16, v144
  v_and_b32 v29, s73, v144
  v_lshlrev_b32 v30, 16, v146
  v_and_b32 v31, s73, v146
  v_add_f32 v28, 1.0, v28
  v_add_f32 v29, 1.0, v29
  v_add_f32 v30, 1.0, v30
  v_add_f32 v31, 1.0, v31
  v_cvt_pk_bf16_f32 v8, v28, v29
  v_cvt_pk_bf16_f32 v9, v30, v31
  v_mov_b32 v141, v142
  ds_write_b64 v12, v[8:9] offset:5312
  ds_write_b64 v12, v[140:141] offset:7424
  v_cvt_pk_bf16_f32 v28, 0, v28
  v_cvt_pk_bf16_f32 v29, 0, v29
  v_cvt_pk_bf16_f32 v30, 0, v30
  v_cvt_pk_bf16_f32 v31, 0, v31
  v_mul_f32 v24, v20, v28
  v_mul_f32 v25, v21, v29
  v_mul_f32 v26, v22, v30
  v_mul_f32 v27, v23, v31
  v_mul_f32 v28, v16, v28
  v_mul_f32 v29, v17, v29
  v_mul_f32 v30, v18, v30
  v_mul_f32 v31, v19, v31
  s_waitcnt lgkmcnt(0)
  s_waitcnt vmcnt(0)
  s_mov_b32 s70, 0
L_sn_85:
  ds_read_b32 v8, v38 offset:264
  s_waitcnt lgkmcnt(0)
  v_cmp_gt_u32 vcc, 0x8, v8
  s_cmp_eq_u64 vcc, 0
  s_cbranch_scc1 L_snd_86
  s_sleep 2
  s_add_u32 s70, s70, 1
  s_cmp_lt_u32 s70, 2097152
  s_cbranch_scc1 L_sn_85
L_snd_86:
  s_mov_b32 s70, 0
  s_movk_i32 s71, 0xff
  s_mov_b32 s63, s71
  s_branch L_f1_l
L_f1_p:
  s_add_u32 s70, s70, 1
  s_cmp_ge_u32 s70, 262144
  s_cbranch_scc1 L_f1_ok
  s_mov_b32 s63, s71
L_f1_l:
  s_bitcmp1_b32 s63, 0
  s_cbranch_scc0 L_fl_87
  global_load_dwordx4 v[104:107], v15, s[42:43] offset:-4096 sc1
L_fl_87:
  s_bitcmp1_b32 s63, 1
  s_cbranch_scc0 L_fl_88
  global_load_dwordx4 v[108:111], v15, s[42:43] offset:0 sc1
L_fl_88:
  s_bitcmp1_b32 s63, 2
  s_cbranch_scc0 L_fl_89
  global_load_dwordx4 v[112:115], v4, s[42:43] offset:-4096 sc1
L_fl_89:
  s_bitcmp1_b32 s63, 3
  s_cbranch_scc0 L_fl_90
  global_load_dwordx4 v[116:119], v4, s[42:43] offset:0 sc1
L_fl_90:
  s_bitcmp1_b32 s63, 4
  s_cbranch_scc0 L_fl_91
  global_load_dwordx4 v[120:123], v0, s[42:43] offset:-4096 sc1
L_fl_91:
  s_bitcmp1_b32 s63, 5
  s_cbranch_scc0 L_fl_92
  global_load_dwordx4 v[124:127], v0, s[42:43] offset:0 sc1
L_fl_92:
  s_bitcmp1_b32 s63, 6
  s_cbranch_scc0 L_fl_93
  global_load_dwordx4 v[128:131], v36, s[42:43] offset:-4096 sc1
L_fl_93:
  s_bitcmp1_b32 s63, 7
  s_cbranch_scc0 L_fl_94
  global_load_dwordx4 v[132:135], v36, s[42:43] offset:0 sc1
L_fl_94:
  s_waitcnt vmcnt(0)
  s_bitcmp1_b32 s63, 0
  s_cbranch_scc0 L_fc_95
  v_xor_b32 v104, s32, v104
  v_xor_b32 v105, s33, v105
  v_xor_b32 v106, s34, v106
  v_xor_b32 v107, s35, v107
  v_or3_b32 v8, v104, v105, v106
  v_or_b32 v8, v8, v107
  v_cmp_ne_u32_sdwa vcc, v8, v38 src0_sel:BYTE_0 src1_sel:DWORD
  s_cmp_lg_u64 vcc, 0
  s_cbranch_scc1 L_fc_95
  s_bitset0_b32 s71, 0
L_fc_95:
  s_bitcmp1_b32 s63, 1
  s_cbranch_scc0 L_fc_96
  v_xor_b32 v108, s32, v108
  v_xor_b32 v109, s33, v109
  v_xor_b32 v110, s34, v110
  v_xor_b32 v111, s35, v111
  v_or3_b32 v8, v108, v109, v110
  v_or_b32 v8, v8, v111
  v_cmp_ne_u32_sdwa vcc, v8, v38 src0_sel:BYTE_0 src1_sel:DWORD
  s_cmp_lg_u64 vcc, 0
  s_cbranch_scc1 L_fc_96
  s_bitset0_b32 s71, 1
L_fc_96:
  s_bitcmp1_b32 s63, 2
  s_cbranch_scc0 L_fc_97
  v_xor_b32 v112, s32, v112
  v_xor_b32 v113, s33, v113
  v_xor_b32 v114, s34, v114
  v_xor_b32 v115, s35, v115
  v_or3_b32 v8, v112, v113, v114
  v_or_b32 v8, v8, v115
  v_cmp_ne_u32_sdwa vcc, v8, v38 src0_sel:BYTE_0 src1_sel:DWORD
  s_cmp_lg_u64 vcc, 0
  s_cbranch_scc1 L_fc_97
  s_bitset0_b32 s71, 2
L_fc_97:
  s_bitcmp1_b32 s63, 3
  s_cbranch_scc0 L_fc_98
  v_xor_b32 v116, s32, v116
  v_xor_b32 v117, s33, v117
  v_xor_b32 v118, s34, v118
  v_xor_b32 v119, s35, v119
  v_or3_b32 v8, v116, v117, v118
  v_or_b32 v8, v8, v119
  v_cmp_ne_u32_sdwa vcc, v8, v38 src0_sel:BYTE_0 src1_sel:DWORD
  s_cmp_lg_u64 vcc, 0
  s_cbranch_scc1 L_fc_98
  s_bitset0_b32 s71, 3
L_fc_98:
  s_bitcmp1_b32 s63, 4
  s_cbranch_scc0 L_fc_99
  v_xor_b32 v120, s32, v120
  v_xor_b32 v121, s33, v121
  v_xor_b32 v122, s34, v122
  v_xor_b32 v123, s35, v123
  v_or3_b32 v8, v120, v121, v122
  v_or_b32 v8, v8, v123
  v_cmp_ne_u32_sdwa vcc, v8, v38 src0_sel:BYTE_0 src1_sel:DWORD
  s_cmp_lg_u64 vcc, 0
  s_cbranch_scc1 L_fc_99
  s_bitset0_b32 s71, 4
L_fc_99:
  s_bitcmp1_b32 s63, 5
  s_cbranch_scc0 L_fc_100
  v_xor_b32 v124, s32, v124
  v_xor_b32 v125, s33, v125
  v_xor_b32 v126, s34, v126
  v_xor_b32 v127, s35, v127
  v_or3_b32 v8, v124, v125, v126
  v_or_b32 v8, v8, v127
  v_cmp_ne_u32_sdwa vcc, v8, v38 src0_sel:BYTE_0 src1_sel:DWORD
  s_cmp_lg_u64 vcc, 0
  s_cbranch_scc1 L_fc_100
  s_bitset0_b32 s71, 5
L_fc_100:
  s_bitcmp1_b32 s63, 6
  s_cbranch_scc0 L_fc_101
  v_xor_b32 v128, s32, v128
  v_xor_b32 v129, s33, v129
  v_xor_b32 v130, s34, v130
  v_xor_b32 v131, s35, v131
  v_or3_b32 v8, v128, v129, v130
  v_or_b32 v8, v8, v131
  v_cmp_ne_u32_sdwa vcc, v8, v38 src0_sel:BYTE_0 src1_sel:DWORD
  s_cmp_lg_u64 vcc, 0
  s_cbranch_scc1 L_fc_101
  s_bitset0_b32 s71, 6
L_fc_101:
  s_bitcmp1_b32 s63, 7
  s_cbranch_scc0 L_fc_102
  v_xor_b32 v132, s32, v132
  v_xor_b32 v133, s33, v133
  v_xor_b32 v134, s34, v134
  v_xor_b32 v135, s35, v135
  v_or3_b32 v8, v132, v133, v134
  v_or_b32 v8, v8, v135
  v_cmp_ne_u32_sdwa vcc, v8, v38 src0_sel:BYTE_0 src1_sel:DWORD
  s_cmp_lg_u64 vcc, 0
  s_cbranch_scc1 L_fc_102
  s_bitset0_b32 s71, 7
L_fc_102:
  s_cmp_lg_u32 s71, 0
  s_cbranch_scc1 L_f1_p
L_f1_ok:
  v_pk_add_f32 v[136:137], v[104:105], v[108:109]
  v_pk_add_f32 v[138:139], v[106:107], v[110:111]
  v_pk_add_f32 v[144:145], v[112:113], v[116:117]
  v_pk_add_f32 v[146:147], v[114:115], v[118:119]
  v_pk_add_f32 v[152:153], v[120:121], v[124:125]
  v_pk_add_f32 v[154:155], v[122:123], v[126:127]
  v_pk_add_f32 v[160:161], v[128:129], v[132:133]
  v_pk_add_f32 v[162:163], v[130:131], v[134:135]
  v_pk_add_f32 v[136:137], v[136:137], v[144:145]
  v_pk_add_f32 v[138:139], v[138:139], v[146:147]
  v_pk_add_f32 v[152:153], v[152:153], v[160:161]
  v_pk_add_f32 v[154:155], v[154:155], v[162:163]
  v_pk_add_f32 v[136:137], v[136:137], v[152:153]
  v_pk_add_f32 v[138:139], v[138:139], v[154:155]
  v_pk_fma_f32 v[8:9], v[136:137], v[24:25], v[28:29]
  v_pk_fma_f32 v[10:11], v[138:139], v[26:27], v[30:31]
  v_cvt_pk_bf16_f32 v8, v8, v9
  v_cvt_pk_bf16_f32 v9, v10, v11
  ds_write_b64 v12, v[8:9] offset:3200
  v_pk_fma_f32 v[16:17], v[136:137], v[20:21], v[16:17]
  v_pk_fma_f32 v[18:19], v[138:139], v[22:23], v[18:19]
  v_add_f32 v24, v16, v17
  v_mul_f32 v25, v16, v16
  v_add_f32 v26, v18, v19
  v_mul_f32 v27, v18, v18
  v_fmac_f32 v25, v17, v17
  v_fmac_f32 v27, v19, v19
  v_pk_add_f32 v[24:25], v[24:25], v[26:27]
  s_nop 1
  v_add_f32_dpp v24, v24, v24 quad_perm:[1,0,3,2] row_mask:0xf bank_mask:0xf
  v_add_f32_dpp v25, v25, v25 quad_perm:[1,0,3,2] row_mask:0xf bank_mask:0xf
  s_nop 0
  v_add_f32_dpp v24, v24, v24 quad_perm:[2,3,0,1] row_mask:0xf bank_mask:0xf
  v_add_f32_dpp v25, v25, v25 quad_perm:[2,3,0,1] row_mask:0xf bank_mask:0xf
  ds_write_b64 v5, v[24:25]
  s_add_u32 s77, s77, 4
  v_mov_b32 v10, 1
  s_mov_b64 exec, 1
  ds_add_u32 v38, v10 offset:316
  s_mov_b64 exec, -1
  s_mov_b32 s70, 0
L_hy_103:
  ds_read_b32 v10, v38 offset:316
  ds_read_b128 v[136:139], v14 offset:3200
  ds_read_b128 v[140:143], v14 offset:3264
  ds_read_b128 v[144:147], v14 offset:3328
  ds_read_b128 v[148:151], v14 offset:3392
  s_waitcnt lgkmcnt(4)
  v_cmp_gt_u32 vcc, s77, v10
  s_cmp_eq_u64 vcc, 0
  s_cbranch_scc1 L_hyd_104
  s_waitcnt lgkmcnt(0)
  s_add_u32 s70, s70, 1
  s_cmp_lt_u32 s70, 2097152
  s_cbranch_scc1 L_hy_103
L_hyd_104:
  ds_read_b64 v[20:21], v7
  ds_read_b128 v[152:155], v14 offset:3456
  ds_read_b128 v[156:159], v14 offset:3520
  ds_read_b128 v[160:163], v14 offset:3584
  ds_read_b128 v[164:167], v14 offset:3648
  s_waitcnt lgkmcnt(8)
  v_mfma_f32_16x16x32_bf16 v[32:35], v[40:43], v[136:139], 0
  s_waitcnt lgkmcnt(7)
  v_mfma_f32_16x16x32_bf16 v[32:35], v[44:47], v[140:143], v[32:35]
  ds_read_b128 v[136:139], v14 offset:3712
  s_waitcnt lgkmcnt(7)
  v_mfma_f32_16x16x32_bf16 v[32:35], v[48:51], v[144:147], v[32:35]
  ds_read_b128 v[140:143], v14 offset:3776
  s_waitcnt lgkmcnt(7)
  v_mfma_f32_16x16x32_bf16 v[32:35], v[52:55], v[148:151], v[32:35]
  ds_read_b128 v[144:147], v14 offset:3840
  s_waitcnt lgkmcnt(6)
  v_mfma_f32_16x16x32_bf16 v[32:35], v[56:59], v[152:155], v[32:35]
  ds_read_b128 v[148:151], v14 offset:3904
  v_add_f32_dpp v20, v20, v20 quad_perm:[2,3,0,1] row_mask:0xf bank_mask:0xf
  v_add_f32_dpp v21, v21, v21 quad_perm:[2,3,0,1] row_mask:0xf bank_mask:0xf
  s_waitcnt lgkmcnt(6)
  v_mfma_f32_16x16x32_bf16 v[32:35], v[60:63], v[156:159], v[32:35]
  ds_read_b128 v[152:155], v14 offset:3968
  v_add_f32_dpp v20, v20, v20 row_ror:4 row_mask:0xf bank_mask:0xf
  v_add_f32_dpp v21, v21, v21 row_ror:4 row_mask:0xf bank_mask:0xf
  s_waitcnt lgkmcnt(6)
  v_mfma_f32_16x16x32_bf16 v[32:35], v[64:67], v[160:163], v[32:35]
  ds_read_b128 v[156:159], v14 offset:4032
  v_add_f32_dpp v20, v20, v20 row_ror:8 row_mask:0xf bank_mask:0xf
  v_add_f32_dpp v21, v21, v21 row_ror:8 row_mask:0xf bank_mask:0xf
  s_waitcnt lgkmcnt(6)
  v_mfma_f32_16x16x32_bf16 v[32:35], v[68:71], v[164:167], v[32:35]
  ds_read_b128 v[160:163], v14 offset:4096
  v_mov_b32 v22, v20
  v_mov_b32 v23, v21
  s_waitcnt lgkmcnt(6)
  v_mfma_f32_16x16x32_bf16 v[32:35], v[72:75], v[136:139], v[32:35]
  ds_read_b128 v[164:167], v14 offset:4160
  v_permlane16_swap_b32 v22, v20
  v_permlane16_swap_b32 v23, v21
  s_waitcnt lgkmcnt(6)
  v_mfma_f32_16x16x32_bf16 v[32:35], v[76:79], v[140:143], v[32:35]
  v_pk_add_f32 v[20:21], v[20:21], v[22:23]
  v_mov_b32 v22, v20
  v_mov_b32 v23, v21
  s_waitcnt lgkmcnt(5)
  v_mfma_f32_16x16x32_bf16 v[32:35], v[80:83], v[144:147], v[32:35]
  v_permlane32_swap_b32 v22, v20
  v_permlane32_swap_b32 v23, v21
  s_waitcnt lgkmcnt(4)
  v_mfma_f32_16x16x32_bf16 v[32:35], v[84:87], v[148:151], v[32:35]
  v_pk_add_f32 v[20:21], v[20:21], v[22:23]
  v_mul_f32 v20, 0xbb000000, v20
  s_waitcnt lgkmcnt(3)
  v_mfma_f32_16x16x32_bf16 v[32:35], v[88:91], v[152:155], v[32:35]
  v_mul_f32 v21, 0x3b000000, v21
  v_fma_f32 v21, -v20, v20, v21
  s_waitcnt lgkmcnt(2)
  v_mfma_f32_16x16x32_bf16 v[32:35], v[92:95], v[156:159], v[32:35]
  v_max_f32 v21, 0, v21
  v_add_f32 v21, 0x3727c5ac, v21
  s_waitcnt lgkmcnt(1)
  v_mfma_f32_16x16x32_bf16 v[32:35], v[96:99], v[160:163], v[32:35]
  v_rsq_f32 v21, v21
  s_waitcnt lgkmcnt(0)
  v_mfma_f32_16x16x32_bf16 v[32:35], v[100:103], v[164:167], v[32:35]
  ds_read_b64_tr_b16 v[40:41], v6 offset:0
  ds_read_b64_tr_b16 v[42:43], v6 offset:4224
  ds_read_b64_tr_b16 v[44:45], v6 offset:32
  ds_read_b64_tr_b16 v[46:47], v6 offset:4256
  ds_read_b64_tr_b16 v[48:49], v6 offset:64
  ds_read_b64_tr_b16 v[50:51], v6 offset:4288
  ds_read_b64_tr_b16 v[52:53], v6 offset:96
  ds_read_b64_tr_b16 v[54:55], v6 offset:4320
  v_fmac_f32_dpp v32, v32, v20 row_shl:2 row_mask:0xf bank_mask:0x1
  v_fmac_f32_dpp v33, v33, v20 row_shl:2 row_mask:0xf bank_mask:0x1
  v_fmac_f32_dpp v34, v34, v20 row_shl:2 row_mask:0xf bank_mask:0x1
  v_fmac_f32_dpp v35, v35, v20 row_shl:2 row_mask:0xf bank_mask:0x1
  v_mul_f32 v8, v32, v21
  v_mul_f32 v9, v33, v21
  v_mul_f32 v10, v34, v21
  v_mul_f32 v11, v35, v21
  v_add_f32_dpp v8, v32, v8 row_shl:4 row_mask:0xf bank_mask:0xf
  v_add_f32_dpp v9, v33, v9 row_shl:4 row_mask:0xf bank_mask:0xf
  v_add_f32_dpp v10, v34, v10 row_shl:4 row_mask:0xf bank_mask:0xf
  v_add_f32_dpp v11, v35, v11 row_shl:4 row_mask:0xf bank_mask:0xf
  s_waitcnt lgkmcnt(4)
  ds_read_b64_tr_b16 v[56:57], v6 offset:128
  ds_read_b64_tr_b16 v[58:59], v6 offset:4352
  ds_read_b64_tr_b16 v[60:61], v6 offset:160
  ds_read_b64_tr_b16 v[62:63], v6 offset:4384
  ds_read_b64_tr_b16 v[64:65], v6 offset:192
  ds_read_b64_tr_b16 v[66:67], v6 offset:4416
  ds_read_b64_tr_b16 v[68:69], v6 offset:224
  ds_read_b64_tr_b16 v[70:71], v6 offset:4448
  v_permlane32_swap_b32 v8, v10
  v_permlane32_swap_b32 v9, v11
  v_mul_f32 v20, 0xbfb8aa3b, v8
  v_mul_f32 v21, 0xbfb8aa3b, v9
  v_exp_f32 v20, v20
  v_exp_f32 v21, v21
  v_mul_f32 v8, v8, v10
  v_mul_f32 v9, v9, v11
  v_add_f32 v20, 1.0, v20
  v_add_f32 v21, 1.0, v21
  v_rcp_f32 v20, v20
  v_rcp_f32 v21, v21
  s_mov_b32 exec_lo, 0x00030003
  s_mov_b32 exec_hi, 0x00030003
  v_mul_f32 v8, v8, v20
  v_mul_f32 v9, v9, v21
  v_cvt_pk_bf16_f32 v8, v8, v9
  ds_write_b32 v39, v8
  s_mov_b64 exec, -1
  s_waitcnt lgkmcnt(4)
  s_add_u32 s77, s77, 4
  v_mov_b32 v10, 1
  s_mov_b64 exec, 1
  ds_add_u32 v38, v10 offset:316
  s_mov_b64 exec, -1
  s_mov_b32 s70, 0
L_hy_105:
  ds_read_b32 v10, v38 offset:316
  ds_read_b128 v[136:139], v37 offset:0
  ds_read_b128 v[140:143], v37 offset:128
  ds_read_b128 v[144:147], v37 offset:256
  ds_read_b128 v[148:151], v37 offset:384
  s_waitcnt lgkmcnt(4)
  v_cmp_gt_u32 vcc, s77, v10
  s_cmp_eq_u64 vcc, 0
  s_cbranch_scc1 L_hyd_106
  s_waitcnt lgkmcnt(0)
  s_add_u32 s70, s70, 1
  s_cmp_lt_u32 s70, 2097152
  s_cbranch_scc1 L_hy_105
L_hyd_106:
  ds_read_b128 v[152:155], v37 offset:512
  ds_read_b128 v[156:159], v37 offset:640
  ds_read_b128 v[160:163], v37 offset:768
  ds_read_b128 v[164:167], v37 offset:896
  v_mov_b32 v3, 0xff
  s_waitcnt lgkmcnt(7)
  v_mfma_f32_16x16x32_bf16 v[8:11], v[40:43], v[136:139], 0
  s_waitcnt lgkmcnt(6)
  v_mfma_f32_16x16x32_bf16 v[8:11], v[44:47], v[140:143], v[8:11]
  s_waitcnt lgkmcnt(5)
  v_mfma_f32_16x16x32_bf16 v[8:11], v[48:51], v[144:147], v[8:11]
  s_waitcnt lgkmcnt(4)
  v_mfma_f32_16x16x32_bf16 v[8:11], v[52:55], v[148:151], v[8:11]
  s_waitcnt lgkmcnt(3)
  v_mfma_f32_16x16x32_bf16 v[8:11], v[56:59], v[152:155], v[8:11]
  s_waitcnt lgkmcnt(2)
  v_mfma_f32_16x16x32_bf16 v[8:11], v[60:63], v[156:159], v[8:11]
  s_waitcnt lgkmcnt(1)
  v_mfma_f32_16x16x32_bf16 v[8:11], v[64:67], v[160:163], v[8:11]
  s_waitcnt lgkmcnt(0)
  v_mfma_f32_16x16x32_bf16 v[8:11], v[68:71], v[164:167], v[8:11]
  s_nop 7
  v_bfi_b32 v8, v3, s32, v8
  v_bfi_b32 v9, v3, s33, v9
  v_bfi_b32 v10, v3, s34, v10
  v_bfi_b32 v11, v3, s35, v11
  global_store_dwordx4 v13, v[8:11], s[42:43] sc1
  s_branch L_fin
L_r_f2:
  v_bfe_u32 v12, v1, 2, 1
  v_and_b32 v14, 3, v1
  s_lshl_b32 s49, s61, 5
  v_lshl_add_u32 v3, v14, 3, s49
  v_lshl_add_u32 v37, v12, 10, v3
  v_and_b32 v15, 7, v1
  s_lshl_b32 s49, s61, 7
  v_lshl_add_u32 v15, v15, 4, s49
  v_add_u32 v39, 16384, v15
  v_bfe_u32 v3, v1, 3, 1
  v_lshl_add_u32 v15, v3, 12, v15
  v_lshrrev_b32 v3, 4, v1
  v_lshl_add_u32 v15, v3, 14, v15
  s_and_b32 s59, s2, 1
  s_lshl_b32 s59, s59, 16
  s_add_u32 s59, s59, 2097152
  v_add_u32 v15, s59, v15
  s_lshl_b32 s49, s61, 14
  s_add_u32 s49, s49, 1574912
  v_lshl_add_u32 v36, v1, 4, s49
  global_load_dword v11, v37, s[38:39]
  s_lshl_b32 s49, s61, 14
  s_add_u32 s49, s49, 1572864
  v_min_u32 v10, 42, v1
  v_lshl_add_u32 v10, v10, 7, s49
  global_load_dword v11, v10, s[42:43] sc1
  s_lshl_b32 s49, s61, 7
  s_add_u32 s49, s49, 28672
  v_mov_b32 v10, s49
  global_load_dword v11, v10, s[42:43] sc1
  global_load_dwordx2 v[8:9], v37, s[16:17]
  s_mov_b32 s70, 0
L_pg_107:
  global_load_dwordx4 v[136:139], v39, s[42:43] offset:-4096 sc1
  v_add_u32 v3, 8192, v39
  global_load_dwordx4 v[140:143], v3, s[42:43] sc1
  s_waitcnt vmcnt(0)
  s_mov_b64 vcc, 0
  v_cmp_ne_u32 s[68:69], s74, v137
  s_or_b64 vcc, vcc, s[68:69]
  v_cmp_ne_u32 s[68:69], s74, v139
  s_or_b64 vcc, vcc, s[68:69]
  v_cmp_ne_u32 s[68:69], s74, v141
  s_or_b64 vcc, vcc, s[68:69]
  v_cmp_ne_u32 s[68:69], s74, v143
  s_or_b64 vcc, vcc, s[68:69]
  s_cmp_eq_u64 vcc, 0
  s_cbranch_scc1 L_pge_108
  s_sleep 8
  s_add_u32 s70, s70, 1
  s_cmp_lt_u32 s70, 262144
  s_cbranch_scc1 L_pg_107
L_pge_108:
  v_lshlrev_b32 v16, 16, v8
  v_and_b32 v17, s73, v8
  v_lshlrev_b32 v18, 16, v9
  v_and_b32 v19, s73, v9
  v_lshlrev_b32 v20, 16, v136
  v_and_b32 v21, s73, v136
  v_lshlrev_b32 v22, 16, v138
  v_and_b32 v23, s73, v138
  v_lshlrev_b32 v24, 16, v140
  v_and_b32 v25, s73, v140
  v_lshlrev_b32 v26, 16, v142
  v_and_b32 v27, s73, v142
  s_mov_b32 s70, 0
L_sn_109:
  ds_read_b32 v8, v38 offset:264
  s_waitcnt lgkmcnt(0)
  v_cmp_gt_u32 vcc, 0x8, v8
  s_cmp_eq_u64 vcc, 0
  s_cbranch_scc1 L_snd_110
  s_sleep 2
  s_add_u32 s70, s70, 1
  s_cmp_lt_u32 s70, 2097152
  s_cbranch_scc1 L_sn_109
L_snd_110:
  s_mov_b32 s70, 0
L_f2_a:
  global_load_dwordx4 v[136:139], v15, s[42:43] sc1
  s_waitcnt vmcnt(0)
  v_xor_b32 v136, s32, v136
  v_xor_b32 v137, s33, v137
  v_xor_b32 v138, s34, v138
  v_xor_b32 v139, s35, v139
  v_or3_b32 v3, v136, v137, v138
  v_or_b32 v3, v3, v139
  v_lshlrev_b32 v3, 24, v3
  v_cmp_ne_u32 vcc, 0, v3
  s_cmp_eq_u64 vcc, 0
  s_cbranch_scc1 L_f2_ad
  s_sleep 4
  s_add_u32 s70, s70, 1
  s_cmp_lt_u32 s70, 262144
  s_cbranch_scc1 L_f2_a
L_f2_ad:
  s_cmp_lg_u32 s61, 0
  s_cbranch_scc1 L_f2_e
  v_mov_b32 v10, s74
  s_mov_b64 exec, 1
  global_store_dword v38, v10, s[42:43] offset:0 sc1
  s_mov_b64 exec, -1
L_f2_e:
  s_nop 1
  v_add_f32_dpp v136, v136, v136 row_ror:8 row_mask:0xf bank_mask:0xf
  v_add_f32_dpp v137, v137, v137 row_ror:8 row_mask:0xf bank_mask:0xf
  v_add_f32_dpp v138, v138, v138 row_ror:8 row_mask:0xf bank_mask:0xf
  v_add_f32_dpp v139, v139, v139 row_ror:8 row_mask:0xf bank_mask:0xf
  v_mov_b32 v140, v136
  v_mov_b32 v141, v137
  v_mov_b32 v142, v138
  v_mov_b32 v143, v139
  v_permlane16_swap_b32 v140, v136
  v_permlane16_swap_b32 v141, v137
  v_permlane16_swap_b32 v142, v138
  v_permlane16_swap_b32 v143, v139
  v_add_f32 v136, v136, v140
  v_add_f32 v137, v137, v141
  v_add_f32 v138, v138, v142
  v_add_f32 v139, v139, v143
  v_mov_b32 v140, v136
  v_mov_b32 v141, v137
  v_mov_b32 v142, v138
  v_mov_b32 v143, v139
  v_permlane32_swap_b32 v140, v136
  v_permlane32_swap_b32 v141, v137
  v_permlane32_swap_b32 v142, v138
  v_permlane32_swap_b32 v143, v139
  v_add_f32 v136, v136, v140
  v_add_f32 v137, v137, v141
  v_add_f32 v138, v138, v142
  v_add_f32 v139, v139, v143
  v_cvt_pk_bf16_f32 v136, 0, v136
  v_cvt_pk_bf16_f32 v137, 0, v137
  v_cvt_pk_bf16_f32 v138, 0, v138
  v_cvt_pk_bf16_f32 v139, 0, v139
  v_mul_f32 v136, v136, v20
  v_mul_f32 v137, v137, v21
  v_mul_f32 v138, v138, v22
  v_mul_f32 v139, v139, v23
  v_cvt_pk_bf16_f32 v136, 0, v136
  v_cvt_pk_bf16_f32 v137, 0, v137
  v_cvt_pk_bf16_f32 v138, 0, v138
  v_cvt_pk_bf16_f32 v139, 0, v139
  v_add_f32 v16, v16, v136
  v_add_f32 v17, v17, v137
  v_add_f32 v18, v18, v138
  v_add_f32 v19, v19, v139
  v_cvt_pk_bf16_f32 v16, 0, v16
  v_cvt_pk_bf16_f32 v17, 0, v17
  v_cvt_pk_bf16_f32 v18, 0, v18
  v_cvt_pk_bf16_f32 v19, 0, v19
  v_mov_b32 v156, s32
  v_mov_b32 v157, s33
  v_mov_b32 v158, s34
  v_mov_b32 v159, s35
  s_mov_b64 s[20:21], -1
  s_mov_b64 s[22:23], -1
  s_mov_b64 s[24:25], -1
  s_mov_b64 s[26:27], -1
  s_mov_b64 s[28:29], -1
  s_mov_b64 s[30:31], 0xffffff
  s_mov_b64 exec, s[20:21]
  global_load_dwordx4 v[136:139], v36, s[42:43] offset:-2048 sc1
  s_mov_b64 exec, s[22:23]
  global_load_dwordx4 v[140:143], v36, s[42:43] offset:-1024 sc1
  s_mov_b64 exec, s[24:25]
  global_load_dwordx4 v[144:147], v36, s[42:43] offset:0 sc1
  s_mov_b64 exec, s[26:27]
  global_load_dwordx4 v[148:151], v36, s[42:43] offset:1024 sc1
  s_mov_b64 exec, s[28:29]
  global_load_dwordx4 v[152:155], v36, s[42:43] offset:2048 sc1
  s_mov_b64 exec, s[30:31]
  global_load_dwordx4 v[156:159], v36, s[42:43] offset:3072 sc1
  s_mov_b64 exec, -1
  s_waitcnt vmcnt(0)
  s_mov_b32 s70, 0
  s_branch L_f2_pc
L_f2_p:
  s_mov_b64 exec, s[20:21]
  global_load_dwordx4 v[136:139], v36, s[42:43] offset:-2048 sc1
  s_mov_b64 exec, s[22:23]
  global_load_dwordx4 v[140:143], v36, s[42:43] offset:-1024 sc1
  s_mov_b64 exec, s[24:25]
  global_load_dwordx4 v[144:147], v36, s[42:43] offset:0 sc1
  s_mov_b64 exec, s[26:27]
  global_load_dwordx4 v[148:151], v36, s[42:43] offset:1024 sc1
  s_mov_b64 exec, s[28:29]
  global_load_dwordx4 v[152:155], v36, s[42:43] offset:2048 sc1
  s_mov_b64 exec, s[30:31]
  global_load_dwordx4 v[156:159], v36, s[42:43] offset:3072 sc1
  s_mov_b64 exec, -1
  s_waitcnt vmcnt(0)
L_f2_pc:
  v_xor_b32 v104, s32, v136
  v_xor_b32 v105, s33, v137
  v_xor_b32 v106, s34, v138
  v_xor_b32 v107, s35, v139
  v_xor_b32 v108, s32, v140
  v_xor_b32 v109, s33, v141
  v_xor_b32 v110, s34, v142
  v_xor_b32 v111, s35, v143
  v_xor_b32 v112, s32, v144
  v_xor_b32 v113, s33, v145
  v_xor_b32 v114, s34, v146
  v_xor_b32 v115, s35, v147
  v_xor_b32 v116, s32, v148
  v_xor_b32 v117, s33, v149
  v_xor_b32 v118, s34, v150
  v_xor_b32 v119, s35, v151
  v_xor_b32 v120, s32, v152
  v_xor_b32 v121, s33, v153
  v_xor_b32 v122, s34, v154
  v_xor_b32 v123, s35, v155
  v_xor_b32 v124, s32, v156
  v_xor_b32 v125, s33, v157
  v_xor_b32 v126, s34, v158
  v_xor_b32 v127, s35, v159
  v_or3_b32 v28, v104, v105, v106
  v_or3_b32 v29, v108, v109, v110
  v_or3_b32 v30, v112, v113, v114
  v_or3_b32 v31, v116, v117, v118
  v_or3_b32 v32, v120, v121, v122
  v_or3_b32 v33, v124, v125, v126
  v_or_b32 v28, v28, v107
  v_or_b32 v29, v29, v111
  v_or_b32 v30, v30, v115
  v_or_b32 v31, v31, v119
  v_or_b32 v32, v32, v123
  v_or_b32 v33, v33, v127
  v_cmp_ne_u32_sdwa s[20:21], v28, v38 src0_sel:BYTE_0 src1_sel:DWORD
  v_cmp_ne_u32_sdwa s[22:23], v29, v38 src0_sel:BYTE_0 src1_sel:DWORD
  v_cmp_ne_u32_sdwa s[24:25], v30, v38 src0_sel:BYTE_0 src1_sel:DWORD
  v_cmp_ne_u32_sdwa s[26:27], v31, v38 src0_sel:BYTE_0 src1_sel:DWORD
  v_cmp_ne_u32_sdwa s[28:29], v32, v38 src0_sel:BYTE_0 src1_sel:DWORD
  v_cmp_ne_u32_sdwa s[30:31], v33, v38 src0_sel:BYTE_0 src1_sel:DWORD
  v_pk_add_f32 v[104:105], v[104:105], v[108:109]
  v_pk_add_f32 v[106:107], v[106:107], v[110:111]
  v_pk_add_f32 v[112:113], v[112:113], v[116:117]
  v_pk_add_f32 v[114:115], v[114:115], v[118:119]
  v_pk_add_f32 v[120:121], v[120:121], v[124:125]
  v_pk_add_f32 v[122:123], v[122:123], v[126:127]
  v_pk_add_f32 v[104:105], v[104:105], v[112:113]
  v_pk_add_f32 v[106:107], v[106:107], v[114:115]
  v_pk_add_f32 v[104:105], v[104:105], v[120:121]
  v_pk_add_f32 v[106:107], v[106:107], v[122:123]
  s_mov_b64 vcc, s[20:21]
  s_or_b64 vcc, vcc, s[22:23]
  s_or_b64 vcc, vcc, s[24:25]
  s_or_b64 vcc, vcc, s[26:27]
  s_or_b64 vcc, vcc, s[28:29]
  s_or_b64 vcc, vcc, s[30:31]
  s_or_b32 s20, s20, 1
  s_or_b32 s22, s22, 1
  s_or_b32 s24, s24, 1
  s_or_b32 s26, s26, 1
  s_or_b32 s28, s28, 1
  s_or_b32 s30, s30, 1
  s_cmp_eq_u64 vcc, 0
  s_cbranch_scc1 L_f2_pok
  s_add_u32 s70, s70, 1
  s_cmp_lt_u32 s70, 262144
  s_cbranch_scc1 L_f2_p
L_f2_pok:
  s_nop 1
  v_add_f32_dpp v104, v104, v104 row_ror:8 row_mask:0xf bank_mask:0xf
  v_add_f32_dpp v105, v105, v105 row_ror:8 row_mask:0xf bank_mask:0xf
  v_add_f32_dpp v106, v106, v106 row_ror:8 row_mask:0xf bank_mask:0xf
  v_add_f32_dpp v107, v107, v107 row_ror:8 row_mask:0xf bank_mask:0xf
  v_mov_b32 v108, v104
  v_mov_b32 v109, v105
  v_mov_b32 v110, v106
  v_mov_b32 v111, v107
  v_permlane16_swap_b32 v108, v104
  v_permlane16_swap_b32 v109, v105
  v_permlane16_swap_b32 v110, v106
  v_permlane16_swap_b32 v111, v107
  v_add_f32 v104, v104, v108
  v_add_f32 v105, v105, v109
  v_add_f32 v106, v106, v110
  v_add_f32 v107, v107, v111
  v_mov_b32 v108, v104
  v_mov_b32 v109, v105
  v_mov_b32 v110, v106
  v_mov_b32 v111, v107
  v_permlane32_swap_b32 v108, v104
  v_permlane32_swap_b32 v109, v105
  v_permlane32_swap_b32 v110, v106
  v_permlane32_swap_b32 v111, v107
  v_add_f32 v104, v104, v108
  v_add_f32 v105, v105, v109
  v_add_f32 v106, v106, v110
  v_add_f32 v107, v107, v111
  v_cvt_pk_bf16_f32 v104, 0, v104
  v_cvt_pk_bf16_f32 v105, 0, v105
  v_cvt_pk_bf16_f32 v106, 0, v106
  v_cvt_pk_bf16_f32 v107, 0, v107
  v_mul_f32 v104, v104, v24
  v_mul_f32 v105, v105, v25
  v_mul_f32 v106, v106, v26
  v_mul_f32 v107, v107, v27
  v_cvt_pk_bf16_f32 v104, 0, v104
  v_cvt_pk_bf16_f32 v105, 0, v105
  v_cvt_pk_bf16_f32 v106, 0, v106
  v_cvt_pk_bf16_f32 v107, 0, v107
  v_add_f32 v8, v104, v16
  v_add_f32 v9, v105, v17
  v_add_f32 v10, v106, v18
  v_add_f32 v11, v107, v19
  v_cvt_pk_bf16_f32 v8, v8, v9
  v_cvt_pk_bf16_f32 v9, v10, v11
  s_mov_b64 exec, 0xff
  global_store_dwordx2 v37, v[8:9], s[38:39] sc1
  s_mov_b64 exec, 1
  v_mov_b32 v10, s74
  s_lshl_b32 s49, s61, 7
  s_add_u32 s49, s49, 28672
  v_mov_b32 v11, s49
  global_store_dword v11, v10, s[42:43] sc1
L_fin:
L_end:
  s_endpgm
.p2align 7
L_table:
  .long 0xff00ff13, 0x1504ff14, 0xff08ff1b, 0x1d0cff1c, 0xff10ff23, 0xff14ff24, 0xff18ff2b, 0x2d1cff2c
  .long 0xff01ff10, 0x1705ff16, 0xff09ff18, 0x1f0dff1e, 0xff11ff20, 0xff15ff25, 0xff19ff28, 0x2f1dff2e
  .long 0x1202ff11, 0xff0605ff, 0x1a0aff19, 0xff0e10ff, 0x2212ff21, 0x2716ff26, 0x2a1aff29, 0xff1e25ff
  .long 0xffff00ff, 0xffff06ff, 0xffff0bff, 0xffff11ff, 0xffff16ff, 0xffff1bff, 0xffff20ff, 0xffff26ff
  .long 0xffff01ff, 0xffff07ff, 0xffff0cff, 0xffff12ff, 0xffff17ff, 0xffff1cff, 0xffff21ff, 0xffff27ff
  .long 0xffff02ff, 0xffff08ff, 0xffff0dff, 0xffff13ff, 0xffff18ff, 0xffff1dff, 0xffff22ff, 0xffff28ff
  .long 0xffff03ff, 0xffff09ff, 0xffff0eff, 0xffff14ff, 0xffff19ff, 0xffff1eff, 0xffff23ff, 0xffff29ff
  .long 0xff0304ff, 0xff070aff, 0xff0b0fff, 0xff0f15ff, 0xff131aff, 0xff171fff, 0xff1b24ff, 0xff1f2aff
L_touch:
  .long 0x80804101, 0x80804909, 0x80804303, 0x80808080, 0x80804b0b, 0x80804505, 0x80804d0d, 0x80808080
  .long 0x80804707, 0x80804f0f, 0x80805900, 0x80808080, 0x80805b08, 0x80805d02, 0x80805f0a, 0x80808080
  .long 0x80805804, 0x80805a0c, 0x80805c06, 0x80808080, 0x80805e0e, 0x80805140, 0x80806148, 0x80808080
  .long 0x80806942, 0x8080714a, 0x80807944, 0x80808080, 0x8080534c, 0x80806346, 0x80806b4e, 0x80808080
.section .rodata,"a"
.p2align 6
.amdhsa_kernel adaLN_cond__sliding_block_cached__glu_gated_swiglu__decode_kernel
  .amdhsa_next_free_vgpr 168
  .amdhsa_next_free_sgpr 102
  .amdhsa_accum_offset 168
  .amdhsa_group_segment_fixed_size 0
  .amdhsa_kernarg_size 112
  .amdhsa_user_sgpr_count 2
  .amdhsa_user_sgpr_kernarg_segment_ptr 1
  .amdhsa_system_sgpr_workgroup_id_x 1
.end_amdhsa_kernel
```

```asm
; @launch grid=(256,1,1) block=(768,1,1) lds=143360
.amdgcn_target "amdgcn-amd-amdhsa--gfx950"
.text
.globl adaLN_cond__sliding_block_cached__glu_gated_swiglu__decode_kernel
.p2align 8
.type adaLN_cond__sliding_block_cached__glu_gated_swiglu__decode_kernel,@function
adaLN_cond__sliding_block_cached__glu_gated_swiglu__decode_kernel:
  s_cmp_ge_u32 s2, 256
  s_cbranch_scc1 L_end
  s_load_dwordx16 s[16:31], s[0:1], 0
  s_load_dwordx8 s[32:39], s[0:1], 64
  s_load_dwordx4 s[40:43], s[0:1], 96
  v_lshrrev_b32 v2, 6, v0
  v_and_b32 v1, 63, v0
  v_readfirstlane_b32 s13, v2
  s_bfe_u32 s7, s2, 0x20003
  s_bfe_u32 s6, s2, 0x20005
  s_and_b32 s8, s2, 7
  s_lshl2_add_u32 s6, s8, s6
  s_and_b32 s9, s2, 0x80
  s_lshr_b32 s9, s9, 2
  s_add_u32 s6, s6, s9
  s_mov_b32 s72, 0xfffffffe
  s_mov_b32 s73, 0xffff0000
  s_cmp_eq_u32 s7, 3
  s_cbranch_scc1 L_serv
  s_cmp_eq_u32 s13, 0
  s_cbranch_scc1 L_pub
L_stream:
  s_sub_u32 s9, s13, 1
  s_lshl_b32 s11, s9, 10
  s_mul_i32 s4, s7, 349184
  s_lshl_b32 s10, s6, 22
  s_add_u32 s10, s10, s4
  s_add_u32 s10, s10, 0x300000
  v_and_b32 v0, 15, v1
  v_lshl_add_u32 v0, v0, 6, s11
  v_and_b32 v3, 48, v1
  v_add_u32 v0, v3, v0
  s_lshr_b32 s12, s2, 3
  s_mul_i32 s12, s12, 5
  s_mul_i32 s15, s8, 3
  s_add_u32 s12, s12, s15
  s_and_b32 s15, s12, 31
  s_min_u32 s15, s15, 30
  s_mul_i32 s12, s15, 11264
  s_lshr_b32 s46, s7, 1
  s_lshl_b32 s46, s46, 10
  s_add_u32 s46, s46, 349184
  s_mov_b32 s47, 0x20000
  s_mov_b32 s14, 349184
  s_waitcnt lgkmcnt(0)
  s_add_u32 s44, s18, s10
  s_addc_u32 s45, s19, 0
  buffer_load_dwordx4 v[44:47], v0, s[44:47], s12 offen nt
  s_add_u32 s12, s12, 11264
  s_cmp_eq_u32 s12, s14
  s_cselect_b32 s12, 0, s12
  buffer_load_dwordx4 v[48:51], v0, s[44:47], s12 offen nt
  s_add_u32 s12, s12, 11264
  s_cmp_eq_u32 s12, s14
  s_cselect_b32 s12, 0, s12
  buffer_load_dwordx4 v[52:55], v0, s[44:47], s12 offen nt
  s_add_u32 s12, s12, 11264
  s_cmp_eq_u32 s12, s14
  s_cselect_b32 s12, 0, s12
  buffer_load_dwordx4 v[40:43], v0, s[44:47], s14 offen nt
  s_add_u32 s48, s20, s10
  s_addc_u32 s49, s21, 0
  s_mov_b32 s50, s46
  s_mov_b32 s51, 0x20000
  s_mov_b32 s52, 0xcccccccc
  s_mov_b32 s53, 0xcccccccc
  s_mov_b32 s54, 0xaaaaaaaa
  s_mov_b32 s55, 0xaaaaaaaa
  v_and_b32 v38, 15, v1
  v_lshlrev_b32 v38, 4, v38
  s_lshl_b32 s10, s9, 11
  s_add_u32 s10, s10, 12288
  v_lshl_add_u32 v3, v1, 3, s10
  v_mov_b32 v4, 0x7fff0000
  v_mov_b32 v5, 0xff800000
  ds_write_b64 v3, v[4:5] offset:0
  ds_write_b64 v3, v[4:5] offset:512
  ds_write_b64 v3, v[4:5] offset:1024
  v_lshrrev_b32 v3, 4, v1
  v_lshl_add_u32 v39, v38, 1, s10
  v_lshl_add_u32 v39, v3, 3, v39
  s_sub_u32 s68, s15, 1
  v_bfrev_b32 v4, v1
  v_lshrrev_b32 v4, 28, v4
  v_lshl_add_u32 v3, v3, 8, s11
  v_cmp_eq_u32 s[70:71], 0, v4
  v_add_u32 v24, s68, v4
  v_subrev_u32 v5, 31, v24
  v_min_u32 v24, v5, v24
  v_cndmask_b32 v24, v24, 31, s[70:71]
  v_mul_u32_u24 v24, 11264, v24
  v_add_u32 v24, v3, v24
  v_add_u32 v26, s68, v4
  v_add_u32 v26, 16, v26
  v_subrev_u32 v5, 31, v26
  v_min_u32 v26, v5, v26
  v_mul_u32_u24 v26, 11264, v26
  v_add_u32 v26, v3, v26
  s_lshl_b32 s11, s9, 9
  s_sub_u32 s11, s11, s10
  s_mov_b32 s32, 4
  s_mul_i32 s33, s9, 0x60000000
  s_add_u32 s33, s33, 0x10000000
  s_mov_b64 s[64:65], 0
  s_mov_b64 s[66:67], 0
  s_mov_b32 s38, 0
  s_mov_b32 s39, 2
  s_mov_b32 s75, 0
  s_mov_b32 s61, 0
  v_and_b32 v3, 1, v1
  v_lshlrev_b32 v3, 4, v3
  v_mov_b32 v20, 0xffff
  v_lshlrev_b32 v3, v3, v20
  v_bfe_u32 v20, v1, 1, 3
  v_cmp_eq_u32 vcc, 0, v20
  s_nop 1
  v_cndmask_b32 v34, 0, v3, vcc
  v_cmp_eq_u32 vcc, 1, v20
  s_nop 1
  v_cndmask_b32 v35, 0, v3, vcc
  v_cmp_eq_u32 vcc, 2, v20
  s_nop 1
  v_cndmask_b32 v36, 0, v3, vcc
  s_barrier
  s_waitcnt lgkmcnt(0)
  s_mov_b32 s56, s10
  s_mov_b32 s41, 5
  s_mov_b32 s57, 0
  s_mov_b32 s76, 20480
  s_mov_b32 s34, 175104
  s_mov_b32 s77, 0
  s_mov_b32 s35, 28
  s_mov_b32 s59, 0
  v_mov_b32 v22, 1332
  v_mov_b32 v23, 0
  v_mov_b32 v2, 0
  s_call_b64 s[62:63], L_kq
  buffer_load_dwordx4 v[56:59], v0, s[44:47], s12 offen nt
  s_add_u32 s12, s12, 11264
  s_cmp_eq_u32 s12, s14
  s_cselect_b32 s12, 0, s12
  s_call_b64 s[62:63], L_kq
  buffer_load_dwordx4 v[60:63], v0, s[44:47], s12 offen nt
  s_add_u32 s12, s12, 11264
  s_cmp_eq_u32 s12, s14
  s_cselect_b32 s12, 0, s12
  s_call_b64 s[62:63], L_kq
  buffer_load_dwordx4 v[64:67], v0, s[44:47], s12 offen nt
  s_add_u32 s12, s12, 11264
  s_cmp_eq_u32 s12, s14
  s_cselect_b32 s12, 0, s12
  s_call_b64 s[62:63], L_kq
  buffer_load_dwordx4 v[68:71], v0, s[44:47], s12 offen nt
  s_add_u32 s12, s12, 11264
  s_cmp_eq_u32 s12, s14
  s_cselect_b32 s12, 0, s12
  s_call_b64 s[62:63], L_kq
  buffer_load_dwordx4 v[72:75], v0, s[44:47], s12 offen nt
  s_add_u32 s12, s12, 11264
  s_cmp_eq_u32 s12, s14
  s_cselect_b32 s12, 0, s12
  s_call_b64 s[62:63], L_kq
  buffer_load_dwordx4 v[76:79], v0, s[44:47], s12 offen nt
  s_add_u32 s12, s12, 11264
  s_cmp_eq_u32 s12, s14
  s_cselect_b32 s12, 0, s12
  s_call_b64 s[62:63], L_kq
  buffer_load_dwordx4 v[80:83], v0, s[44:47], s12 offen nt
  s_add_u32 s12, s12, 11264
  s_cmp_eq_u32 s12, s14
  s_cselect_b32 s12, 0, s12
  s_call_b64 s[62:63], L_kq
  buffer_load_dwordx4 v[84:87], v0, s[44:47], s12 offen nt
  s_add_u32 s12, s12, 11264
  s_cmp_eq_u32 s12, s14
  s_cselect_b32 s12, 0, s12
  s_call_b64 s[62:63], L_kq
  buffer_load_dwordx4 v[88:91], v0, s[44:47], s12 offen nt
  s_add_u32 s12, s12, 11264
  s_cmp_eq_u32 s12, s14
  s_cselect_b32 s12, 0, s12
  s_call_b64 s[62:63], L_kq
  buffer_load_dwordx4 v[92:95], v0, s[44:47], s12 offen nt
  s_add_u32 s12, s12, 11264
  s_cmp_eq_u32 s12, s14
  s_cselect_b32 s12, 0, s12
  s_call_b64 s[62:63], L_kq
  buffer_load_dwordx4 v[96:99], v0, s[44:47], s12 offen nt
  s_add_u32 s12, s12, 11264
  s_cmp_eq_u32 s12, s14
  s_cselect_b32 s12, 0, s12
  s_call_b64 s[62:63], L_ks
  buffer_load_dwordx4 v[100:103], v0, s[44:47], s12 offen nt
  s_add_u32 s12, s12, 11264
  s_cmp_eq_u32 s12, s14
  s_cselect_b32 s12, 0, s12
  s_call_b64 s[62:63], L_ks
  buffer_load_dwordx4 v[104:107], v0, s[44:47], s12 offen nt
  s_add_u32 s12, s12, 11264
  s_cmp_eq_u32 s12, s14
  s_cselect_b32 s12, 0, s12
  s_call_b64 s[62:63], L_ks
  buffer_load_dwordx4 v[108:111], v0, s[44:47], s12 offen nt
  s_add_u32 s12, s12, 11264
  s_cmp_eq_u32 s12, s14
  s_cselect_b32 s12, 0, s12
  s_call_b64 s[62:63], L_ks
  buffer_load_dwordx4 v[112:115], v0, s[44:47], s12 offen nt
  s_add_u32 s12, s12, 11264
  s_cmp_eq_u32 s12, s14
  s_cselect_b32 s12, 0, s12
  s_call_b64 s[62:63], L_ks
  buffer_load_dwordx4 v[116:119], v0, s[44:47], s12 offen nt
  s_add_u32 s12, s12, 11264
  s_cmp_eq_u32 s12, s14
  s_cselect_b32 s12, 0, s12
  s_call_b64 s[62:63], L_ks
  buffer_load_dwordx4 v[120:123], v0, s[44:47], s12 offen nt
  s_add_u32 s12, s12, 11264
  s_cmp_eq_u32 s12, s14
  s_cselect_b32 s12, 0, s12
  s_call_b64 s[62:63], L_ks
  buffer_load_dwordx4 v[124:127], v0, s[44:47], s12 offen nt
  s_add_u32 s12, s12, 11264
  s_cmp_eq_u32 s12, s14
  s_cselect_b32 s12, 0, s12
  s_call_b64 s[62:63], L_ks
  buffer_load_dwordx4 v[128:131], v0, s[44:47], s12 offen nt
  s_add_u32 s12, s12, 11264
  s_cmp_eq_u32 s12, s14
  s_cselect_b32 s12, 0, s12
  s_call_b64 s[62:63], L_ks
  buffer_load_dwordx4 v[132:135], v0, s[44:47], s12 offen nt
  s_add_u32 s12, s12, 11264
  s_cmp_eq_u32 s12, s14
  s_cselect_b32 s12, 0, s12
  s_call_b64 s[62:63], L_ks
  buffer_load_dwordx4 v[136:139], v0, s[44:47], s12 offen nt
  s_add_u32 s12, s12, 11264
  s_cmp_eq_u32 s12, s14
  s_cselect_b32 s12, 0, s12
  s_call_b64 s[62:63], L_ks
  buffer_load_dwordx4 v[140:143], v0, s[44:47], s12 offen nt
  s_add_u32 s12, s12, 11264
  s_cmp_eq_u32 s12, s14
  s_cselect_b32 s12, 0, s12
  s_call_b64 s[62:63], L_ks
  buffer_load_dwordx4 v[144:147], v0, s[44:47], s12 offen nt
  s_add_u32 s12, s12, 11264
  s_cmp_eq_u32 s12, s14
  s_cselect_b32 s12, 0, s12
  s_call_b64 s[62:63], L_ks
  buffer_load_dwordx4 v[148:151], v0, s[44:47], s12 offen nt
  s_add_u32 s12, s12, 11264
  s_cmp_eq_u32 s12, s14
  s_cselect_b32 s12, 0, s12
  s_call_b64 s[62:63], L_ks
  buffer_load_dwordx4 v[152:155], v0, s[44:47], s12 offen nt
  s_add_u32 s12, s12, 11264
  s_cmp_eq_u32 s12, s14
  s_cselect_b32 s12, 0, s12
  s_call_b64 s[62:63], L_ks
  buffer_load_dwordx4 v[156:159], v0, s[44:47], s12 offen nt
  s_add_u32 s12, s12, 11264
  s_cmp_eq_u32 s12, s14
  s_cselect_b32 s12, 0, s12
  s_call_b64 s[62:63], L_ks
  buffer_load_dwordx4 v[160:163], v0, s[44:47], s12 offen nt
  s_add_u32 s12, s12, 11264
  s_cmp_eq_u32 s12, s14
  s_cselect_b32 s12, 0, s12
  s_call_b64 s[62:63], L_ks
  buffer_load_dwordx4 v[164:167], v0, s[44:47], s12 offen nt
  s_add_u32 s12, s12, 11264
  s_cmp_eq_u32 s12, s14
  s_cselect_b32 s12, 0, s12
  s_mov_b32 s10, 0
L_kw:
  s_cmp_ge_u32 s39, 6
  s_cbranch_scc1 L_v0
  s_call_b64 s[100:101], L_work
  s_sleep 1
  s_add_u32 s10, s10, 1
  s_cmp_lt_u32 s10, 262144
  s_cbranch_scc1 L_kw
L_v0:
  s_mov_b32 s32, 0
  v_mov_b32 v2, 8
  s_mov_b32 s35, s59
  ds_read_b64 v[22:23], v2 offset:288
  v_mov_b32_dpp v0, v36 row_shr:2 row_mask:0xf bank_mask:0xf bound_ctrl:0
  s_mov_b32 s77, 62
  s_mov_b32 s76, 12288
  s_mov_b32 s34, 164659
  s_waitcnt lgkmcnt(0)
  s_call_b64 s[62:63], L_vs
  v_add_u32_dpp v3, v28, v38 row_newbcast:0 row_mask:0xf bank_mask:0xf
  buffer_load_dwordx4 v[40:43], v3, s[48:51], 0 offen nt
  s_mov_b64 vcc, s[54:55]
  v_mfma_f32_16x16x32_bf16 v[8:11], v[136:139], v[4:7], 0
  v_mfma_f32_16x16x32_bf16 v[136:139], v[140:143], v[4:7], 0
  v_mfma_f32_16x16x32_bf16 v[140:143], v[144:147], v[4:7], 0
  v_mfma_f32_16x16x32_bf16 v[144:147], v[148:151], v[4:7], 0
  s_nop 4
  v_cndmask_b32_dpp v12, v8, v9, vcc quad_perm:[0,1,2,3] row_mask:0xf bank_mask:0x1
  v_cndmask_b32_dpp v13, v10, v11, vcc quad_perm:[0,1,2,3] row_mask:0xf bank_mask:0x1
  v_cndmask_b32_dpp v12, v136, v137, vcc quad_perm:[0,1,2,3] row_mask:0xf bank_mask:0x4
  v_cndmask_b32_dpp v13, v138, v139, vcc quad_perm:[0,1,2,3] row_mask:0xf bank_mask:0x4
  v_cndmask_b32_dpp v12, v140, v141, vcc quad_perm:[0,1,2,3] row_mask:0xf bank_mask:0x2
  v_cndmask_b32_dpp v13, v142, v143, vcc quad_perm:[0,1,2,3] row_mask:0xf bank_mask:0x2
  v_cndmask_b32_dpp v12, v144, v145, vcc quad_perm:[0,1,2,3] row_mask:0xf bank_mask:0x8
  v_cndmask_b32_dpp v13, v146, v147, vcc quad_perm:[0,1,2,3] row_mask:0xf bank_mask:0x8
  v_cndmask_b32 v18, v12, v13, s[52:53]
  s_call_b64 s[62:63], L_vs
  s_cbranch_scc0 L_dr5
  v_add_u32_dpp v3, v28, v38 row_newbcast:1 row_mask:0xf bank_mask:0xf
  buffer_load_dwordx4 v[44:47], v3, s[48:51], 0 offen nt
  s_call_b64 s[62:63], L_vs
  s_cbranch_scc0 L_dr5
  v_add_u32_dpp v3, v28, v38 row_newbcast:2 row_mask:0xf bank_mask:0xf
  buffer_load_dwordx4 v[48:51], v3, s[48:51], 0 offen nt
  s_call_b64 s[62:63], L_vs
  s_cbranch_scc0 L_dr5
  v_add_u32_dpp v3, v28, v38 row_newbcast:3 row_mask:0xf bank_mask:0xf
  buffer_load_dwordx4 v[52:55], v3, s[48:51], 0 offen nt
  s_call_b64 s[62:63], L_vs
  s_cbranch_scc0 L_dr5
  v_add_u32_dpp v3, v28, v38 row_newbcast:4 row_mask:0xf bank_mask:0xf
  buffer_load_dwordx4 v[56:59], v3, s[48:51], 0 offen nt
  s_call_b64 s[62:63], L_vs
  s_cbranch_scc0 L_dr5
  v_add_u32_dpp v3, v28, v38 row_newbcast:5 row_mask:0xf bank_mask:0xf
  buffer_load_dwordx4 v[60:63], v3, s[48:51], 0 offen nt
  v_and_b32_dpp v12, v29, v34 row_newbcast:0 row_mask:0xf bank_mask:0xf
  v_and_b32_dpp v13, v29, v35 row_newbcast:0 row_mask:0xf bank_mask:0xf
  v_and_b32_dpp v14, v29, v36 row_newbcast:0 row_mask:0xf bank_mask:0xf
  v_and_b32_dpp v15, v29, v0 row_newbcast:0 row_mask:0xf bank_mask:0xf
  s_nop 1
  v_mfma_f32_16x16x32_bf16 v[8:11], v[12:15], v[40:43], v[8:11]
  s_call_b64 s[62:63], L_vs
  s_cbranch_scc0 L_dr6
  v_add_u32_dpp v3, v28, v38 row_newbcast:6 row_mask:0xf bank_mask:0xf
  buffer_load_dwordx4 v[64:67], v3, s[48:51], 0 offen nt
  v_and_b32_dpp v12, v29, v34 row_newbcast:1 row_mask:0xf bank_mask:0xf
  v_and_b32_dpp v13, v29, v35 row_newbcast:1 row_mask:0xf bank_mask:0xf
  v_and_b32_dpp v14, v29, v36 row_newbcast:1 row_mask:0xf bank_mask:0xf
  v_and_b32_dpp v15, v29, v0 row_newbcast:1 row_mask:0xf bank_mask:0xf
  s_nop 1
  v_mfma_f32_16x16x32_bf16 v[8:11], v[12:15], v[44:47], v[8:11]
  s_call_b64 s[62:63], L_vs
  s_cbranch_scc0 L_dr7
  v_add_u32_dpp v3, v28, v38 row_newbcast:7 row_mask:0xf bank_mask:0xf
  buffer_load_dwordx4 v[68:71], v3, s[48:51], 0 offen nt
  v_and_b32_dpp v12, v29, v34 row_newbcast:2 row_mask:0xf bank_mask:0xf
  v_and_b32_dpp v13, v29, v35 row_newbcast:2 row_mask:0xf bank_mask:0xf
  v_and_b32_dpp v14, v29, v36 row_newbcast:2 row_mask:0xf bank_mask:0xf
  v_and_b32_dpp v15, v29, v0 row_newbcast:2 row_mask:0xf bank_mask:0xf
  s_nop 1
  v_mfma_f32_16x16x32_bf16 v[8:11], v[12:15], v[48:51], v[8:11]
  s_call_b64 s[62:63], L_vs
  s_cbranch_scc0 L_dr8
  v_add_u32_dpp v3, v28, v38 row_newbcast:8 row_mask:0xf bank_mask:0xf
  buffer_load_dwordx4 v[72:75], v3, s[48:51], 0 offen nt
  v_and_b32_dpp v12, v29, v34 row_newbcast:3 row_mask:0xf bank_mask:0xf
  v_and_b32_dpp v13, v29, v35 row_newbcast:3 row_mask:0xf bank_mask:0xf
  v_and_b32_dpp v14, v29, v36 row_newbcast:3 row_mask:0xf bank_mask:0xf
  v_and_b32_dpp v15, v29, v0 row_newbcast:3 row_mask:0xf bank_mask:0xf
  s_nop 1
  v_mfma_f32_16x16x32_bf16 v[8:11], v[12:15], v[52:55], v[8:11]
  s_call_b64 s[62:63], L_vs
  s_cbranch_scc0 L_dr9
  v_add_u32_dpp v3, v28, v38 row_newbcast:9 row_mask:0xf bank_mask:0xf
  buffer_load_dwordx4 v[76:79], v3, s[48:51], 0 offen nt
  v_and_b32_dpp v12, v29, v34 row_newbcast:4 row_mask:0xf bank_mask:0xf
  v_and_b32_dpp v13, v29, v35 row_newbcast:4 row_mask:0xf bank_mask:0xf
  v_and_b32_dpp v14, v29, v36 row_newbcast:4 row_mask:0xf bank_mask:0xf
  v_and_b32_dpp v15, v29, v0 row_newbcast:4 row_mask:0xf bank_mask:0xf
  s_nop 1
  v_mfma_f32_16x16x32_bf16 v[8:11], v[12:15], v[56:59], v[8:11]
  s_call_b64 s[62:63], L_vs
  s_cbranch_scc0 L_dr10
  v_add_u32_dpp v3, v28, v38 row_newbcast:10 row_mask:0xf bank_mask:0xf
  buffer_load_dwordx4 v[80:83], v3, s[48:51], 0 offen nt
  v_and_b32_dpp v12, v29, v34 row_newbcast:5 row_mask:0xf bank_mask:0xf
  v_and_b32_dpp v13, v29, v35 row_newbcast:5 row_mask:0xf bank_mask:0xf
  v_and_b32_dpp v14, v29, v36 row_newbcast:5 row_mask:0xf bank_mask:0xf
  v_and_b32_dpp v15, v29, v0 row_newbcast:5 row_mask:0xf bank_mask:0xf
  s_nop 1
  v_mfma_f32_16x16x32_bf16 v[8:11], v[12:15], v[60:63], v[8:11]
  s_call_b64 s[62:63], L_vq
  s_cbranch_scc0 L_dr11
  v_add_u32_dpp v3, v28, v38 row_newbcast:11 row_mask:0xf bank_mask:0xf
  buffer_load_dwordx4 v[84:87], v3, s[48:51], 0 offen nt
  v_and_b32_dpp v12, v29, v34 row_newbcast:6 row_mask:0xf bank_mask:0xf
  v_and_b32_dpp v13, v29, v35 row_newbcast:6 row_mask:0xf bank_mask:0xf
  v_and_b32_dpp v14, v29, v36 row_newbcast:6 row_mask:0xf bank_mask:0xf
  v_and_b32_dpp v15, v29, v0 row_newbcast:6 row_mask:0xf bank_mask:0xf
  s_nop 1
  v_mfma_f32_16x16x32_bf16 v[8:11], v[12:15], v[64:67], v[8:11]
  s_call_b64 s[62:63], L_vq
  s_cbranch_scc0 L_dr12
  v_add_u32_dpp v3, v28, v38 row_newbcast:12 row_mask:0xf bank_mask:0xf
  buffer_load_dwordx4 v[88:91], v3, s[48:51], 0 offen nt
  v_and_b32_dpp v12, v29, v34 row_newbcast:7 row_mask:0xf bank_mask:0xf
  v_and_b32_dpp v13, v29, v35 row_newbcast:7 row_mask:0xf bank_mask:0xf
  v_and_b32_dpp v14, v29, v36 row_newbcast:7 row_mask:0xf bank_mask:0xf
  v_and_b32_dpp v15, v29, v0 row_newbcast:7 row_mask:0xf bank_mask:0xf
  s_nop 1
  v_mfma_f32_16x16x32_bf16 v[8:11], v[12:15], v[68:71], v[8:11]
  s_call_b64 s[62:63], L_vq
  s_cbranch_scc0 L_dr13
  v_add_u32_dpp v3, v28, v38 row_newbcast:13 row_mask:0xf bank_mask:0xf
  buffer_load_dwordx4 v[92:95], v3, s[48:51], 0 offen nt
  v_and_b32_dpp v12, v29, v34 row_newbcast:8 row_mask:0xf bank_mask:0xf
  v_and_b32_dpp v13, v29, v35 row_newbcast:8 row_mask:0xf bank_mask:0xf
  v_and_b32_dpp v14, v29, v36 row_newbcast:8 row_mask:0xf bank_mask:0xf
  v_and_b32_dpp v15, v29, v0 row_newbcast:8 row_mask:0xf bank_mask:0xf
  s_nop 1
  v_mfma_f32_16x16x32_bf16 v[8:11], v[12:15], v[72:75], v[8:11]
  s_call_b64 s[62:63], L_vq
  s_cbranch_scc0 L_dr14
  v_add_u32_dpp v3, v28, v38 row_newbcast:14 row_mask:0xf bank_mask:0xf
  buffer_load_dwordx4 v[96:99], v3, s[48:51], 0 offen nt
  v_and_b32_dpp v12, v29, v34 row_newbcast:9 row_mask:0xf bank_mask:0xf
  v_and_b32_dpp v13, v29, v35 row_newbcast:9 row_mask:0xf bank_mask:0xf
  v_and_b32_dpp v14, v29, v36 row_newbcast:9 row_mask:0xf bank_mask:0xf
  v_and_b32_dpp v15, v29, v0 row_newbcast:9 row_mask:0xf bank_mask:0xf
  s_nop 1
  v_mfma_f32_16x16x32_bf16 v[8:11], v[12:15], v[76:79], v[8:11]
  s_call_b64 s[62:63], L_vq
  s_cbranch_scc0 L_dr15
  v_add_u32_dpp v3, v28, v38 row_newbcast:15 row_mask:0xf bank_mask:0xf
  buffer_load_dwordx4 v[100:103], v3, s[48:51], 0 offen nt
  v_and_b32_dpp v12, v29, v34 row_newbcast:10 row_mask:0xf bank_mask:0xf
  v_and_b32_dpp v13, v29, v35 row_newbcast:10 row_mask:0xf bank_mask:0xf
  v_and_b32_dpp v14, v29, v36 row_newbcast:10 row_mask:0xf bank_mask:0xf
  v_and_b32_dpp v15, v29, v0 row_newbcast:10 row_mask:0xf bank_mask:0xf
  s_nop 1
  v_mfma_f32_16x16x32_bf16 v[8:11], v[12:15], v[80:83], v[8:11]
  s_call_b64 s[62:63], L_vq
  s_cbranch_scc0 L_dr16
  v_add_u32_dpp v3, v30, v38 row_newbcast:0 row_mask:0xf bank_mask:0xf
  buffer_load_dwordx4 v[104:107], v3, s[48:51], 0 offen nt
  v_and_b32_dpp v12, v29, v34 row_newbcast:11 row_mask:0xf bank_mask:0xf
  v_and_b32_dpp v13, v29, v35 row_newbcast:11 row_mask:0xf bank_mask:0xf
  v_and_b32_dpp v14, v29, v36 row_newbcast:11 row_mask:0xf bank_mask:0xf
  v_and_b32_dpp v15, v29, v0 row_newbcast:11 row_mask:0xf bank_mask:0xf
  s_nop 1
  v_mfma_f32_16x16x32_bf16 v[8:11], v[12:15], v[84:87], v[8:11]
  s_call_b64 s[62:63], L_vq
  s_cbranch_scc0 L_dr17
  v_add_u32_dpp v3, v30, v38 row_newbcast:1 row_mask:0xf bank_mask:0xf
  buffer_load_dwordx4 v[108:111], v3, s[48:51], 0 offen nt
  v_and_b32_dpp v12, v29, v34 row_newbcast:12 row_mask:0xf bank_mask:0xf
  v_and_b32_dpp v13, v29, v35 row_newbcast:12 row_mask:0xf bank_mask:0xf
  v_and_b32_dpp v14, v29, v36 row_newbcast:12 row_mask:0xf bank_mask:0xf
  v_and_b32_dpp v15, v29, v0 row_newbcast:12 row_mask:0xf bank_mask:0xf
  s_nop 1
  v_mfma_f32_16x16x32_bf16 v[8:11], v[12:15], v[88:91], v[8:11]
  s_call_b64 s[62:63], L_vq
  s_cbranch_scc0 L_dr18
  v_add_u32_dpp v3, v30, v38 row_newbcast:2 row_mask:0xf bank_mask:0xf
  buffer_load_dwordx4 v[112:115], v3, s[48:51], 0 offen nt
  v_and_b32_dpp v12, v29, v34 row_newbcast:13 row_mask:0xf bank_mask:0xf
  v_and_b32_dpp v13, v29, v35 row_newbcast:13 row_mask:0xf bank_mask:0xf
  v_and_b32_dpp v14, v29, v36 row_newbcast:13 row_mask:0xf bank_mask:0xf
  v_and_b32_dpp v15, v29, v0 row_newbcast:13 row_mask:0xf bank_mask:0xf
  s_nop 1
  v_mfma_f32_16x16x32_bf16 v[8:11], v[12:15], v[92:95], v[8:11]
  s_call_b64 s[62:63], L_vq
  s_cbranch_scc0 L_dr19
  v_add_u32_dpp v3, v30, v38 row_newbcast:3 row_mask:0xf bank_mask:0xf
  buffer_load_dwordx4 v[116:119], v3, s[48:51], 0 offen nt
  v_and_b32_dpp v12, v29, v34 row_newbcast:14 row_mask:0xf bank_mask:0xf
  v_and_b32_dpp v13, v29, v35 row_newbcast:14 row_mask:0xf bank_mask:0xf
  v_and_b32_dpp v14, v29, v36 row_newbcast:14 row_mask:0xf bank_mask:0xf
  v_and_b32_dpp v15, v29, v0 row_newbcast:14 row_mask:0xf bank_mask:0xf
  s_nop 1
  v_mfma_f32_16x16x32_bf16 v[8:11], v[12:15], v[96:99], v[8:11]
  s_call_b64 s[62:63], L_vq
  s_cbranch_scc0 L_dr20
  v_add_u32_dpp v3, v30, v38 row_newbcast:4 row_mask:0xf bank_mask:0xf
  buffer_load_dwordx4 v[120:123], v3, s[48:51], 0 offen nt
  v_and_b32_dpp v12, v29, v34 row_newbcast:15 row_mask:0xf bank_mask:0xf
  v_and_b32_dpp v13, v29, v35 row_newbcast:15 row_mask:0xf bank_mask:0xf
  v_and_b32_dpp v14, v29, v36 row_newbcast:15 row_mask:0xf bank_mask:0xf
  v_and_b32_dpp v15, v29, v0 row_newbcast:15 row_mask:0xf bank_mask:0xf
  s_nop 1
  v_mfma_f32_16x16x32_bf16 v[8:11], v[12:15], v[100:103], v[8:11]
  s_call_b64 s[62:63], L_vq
  s_cbranch_scc0 L_dr21
  v_add_u32_dpp v3, v30, v38 row_newbcast:5 row_mask:0xf bank_mask:0xf
  buffer_load_dwordx4 v[124:127], v3, s[48:51], 0 offen nt
  v_and_b32_dpp v12, v31, v34 row_newbcast:0 row_mask:0xf bank_mask:0xf
  v_and_b32_dpp v13, v31, v35 row_newbcast:0 row_mask:0xf bank_mask:0xf
  v_and_b32_dpp v14, v31, v36 row_newbcast:0 row_mask:0xf bank_mask:0xf
  v_and_b32_dpp v15, v31, v0 row_newbcast:0 row_mask:0xf bank_mask:0xf
  s_nop 1
  v_mfma_f32_16x16x32_bf16 v[8:11], v[12:15], v[104:107], v[8:11]
  s_call_b64 s[62:63], L_vq
  s_cbranch_scc0 L_dr22
  v_add_u32_dpp v3, v30, v38 row_newbcast:6 row_mask:0xf bank_mask:0xf
  buffer_load_dwordx4 v[128:131], v3, s[48:51], 0 offen nt
  v_and_b32_dpp v12, v31, v34 row_newbcast:1 row_mask:0xf bank_mask:0xf
  v_and_b32_dpp v13, v31, v35 row_newbcast:1 row_mask:0xf bank_mask:0xf
  v_and_b32_dpp v14, v31, v36 row_newbcast:1 row_mask:0xf bank_mask:0xf
  v_and_b32_dpp v15, v31, v0 row_newbcast:1 row_mask:0xf bank_mask:0xf
  s_nop 1
  v_mfma_f32_16x16x32_bf16 v[8:11], v[12:15], v[108:111], v[8:11]
  s_call_b64 s[62:63], L_vq
  s_cbranch_scc0 L_dr23
  v_add_u32_dpp v3, v30, v38 row_newbcast:7 row_mask:0xf bank_mask:0xf
  buffer_load_dwordx4 v[132:135], v3, s[48:51], 0 offen nt
  v_and_b32_dpp v12, v31, v34 row_newbcast:2 row_mask:0xf bank_mask:0xf
  v_and_b32_dpp v13, v31, v35 row_newbcast:2 row_mask:0xf bank_mask:0xf
  v_and_b32_dpp v14, v31, v36 row_newbcast:2 row_mask:0xf bank_mask:0xf
  v_and_b32_dpp v15, v31, v0 row_newbcast:2 row_mask:0xf bank_mask:0xf
  s_nop 1
  v_mfma_f32_16x16x32_bf16 v[8:11], v[12:15], v[112:115], v[8:11]
  s_call_b64 s[62:63], L_vq
  s_cbranch_scc0 L_dr24
  v_add_u32_dpp v3, v30, v38 row_newbcast:8 row_mask:0xf bank_mask:0xf
  buffer_load_dwordx4 v[136:139], v3, s[48:51], 0 offen nt
  v_and_b32_dpp v12, v31, v34 row_newbcast:3 row_mask:0xf bank_mask:0xf
  v_and_b32_dpp v13, v31, v35 row_newbcast:3 row_mask:0xf bank_mask:0xf
  v_and_b32_dpp v14, v31, v36 row_newbcast:3 row_mask:0xf bank_mask:0xf
  v_and_b32_dpp v15, v31, v0 row_newbcast:3 row_mask:0xf bank_mask:0xf
  s_nop 1
  v_mfma_f32_16x16x32_bf16 v[8:11], v[12:15], v[116:119], v[8:11]
  s_call_b64 s[62:63], L_vq
  s_cbranch_scc0 L_dr25
  v_add_u32_dpp v3, v30, v38 row_newbcast:9 row_mask:0xf bank_mask:0xf
  buffer_load_dwordx4 v[140:143], v3, s[48:51], 0 offen nt
  v_and_b32_dpp v12, v31, v34 row_newbcast:4 row_mask:0xf bank_mask:0xf
  v_and_b32_dpp v13, v31, v35 row_newbcast:4 row_mask:0xf bank_mask:0xf
  v_and_b32_dpp v14, v31, v36 row_newbcast:4 row_mask:0xf bank_mask:0xf
  v_and_b32_dpp v15, v31, v0 row_newbcast:4 row_mask:0xf bank_mask:0xf
  s_nop 1
  v_mfma_f32_16x16x32_bf16 v[8:11], v[12:15], v[120:123], v[8:11]
  s_call_b64 s[62:63], L_vq
  s_cbranch_scc0 L_dr26
  v_add_u32_dpp v3, v30, v38 row_newbcast:10 row_mask:0xf bank_mask:0xf
  buffer_load_dwordx4 v[144:147], v3, s[48:51], 0 offen nt
  v_and_b32_dpp v12, v31, v34 row_newbcast:5 row_mask:0xf bank_mask:0xf
  v_and_b32_dpp v13, v31, v35 row_newbcast:5 row_mask:0xf bank_mask:0xf
  v_and_b32_dpp v14, v31, v36 row_newbcast:5 row_mask:0xf bank_mask:0xf
  v_and_b32_dpp v15, v31, v0 row_newbcast:5 row_mask:0xf bank_mask:0xf
  s_nop 1
  v_mfma_f32_16x16x32_bf16 v[8:11], v[12:15], v[124:127], v[8:11]
  s_call_b64 s[62:63], L_vq
  s_cbranch_scc0 L_dr27
  v_add_u32_dpp v3, v30, v38 row_newbcast:11 row_mask:0xf bank_mask:0xf
  buffer_load_dwordx4 v[148:151], v3, s[48:51], 0 offen nt
  v_and_b32_dpp v12, v31, v34 row_newbcast:6 row_mask:0xf bank_mask:0xf
  v_and_b32_dpp v13, v31, v35 row_newbcast:6 row_mask:0xf bank_mask:0xf
  v_and_b32_dpp v14, v31, v36 row_newbcast:6 row_mask:0xf bank_mask:0xf
  v_and_b32_dpp v15, v31, v0 row_newbcast:6 row_mask:0xf bank_mask:0xf
  s_nop 1
  v_mfma_f32_16x16x32_bf16 v[8:11], v[12:15], v[128:131], v[8:11]
  s_call_b64 s[62:63], L_vq
  s_cbranch_scc0 L_dr28
  v_add_u32_dpp v3, v30, v38 row_newbcast:12 row_mask:0xf bank_mask:0xf
  buffer_load_dwordx4 v[152:155], v3, s[48:51], 0 offen nt
  v_and_b32_dpp v12, v31, v34 row_newbcast:7 row_mask:0xf bank_mask:0xf
  v_and_b32_dpp v13, v31, v35 row_newbcast:7 row_mask:0xf bank_mask:0xf
  v_and_b32_dpp v14, v31, v36 row_newbcast:7 row_mask:0xf bank_mask:0xf
  v_and_b32_dpp v15, v31, v0 row_newbcast:7 row_mask:0xf bank_mask:0xf
  s_nop 1
  v_mfma_f32_16x16x32_bf16 v[8:11], v[12:15], v[132:135], v[8:11]
  s_call_b64 s[62:63], L_vq
  s_cbranch_scc0 L_dr29
  v_add_u32_dpp v3, v30, v38 row_newbcast:13 row_mask:0xf bank_mask:0xf
  buffer_load_dwordx4 v[156:159], v3, s[48:51], 0 offen nt
  v_and_b32_dpp v12, v31, v34 row_newbcast:8 row_mask:0xf bank_mask:0xf
  v_and_b32_dpp v13, v31, v35 row_newbcast:8 row_mask:0xf bank_mask:0xf
  v_and_b32_dpp v14, v31, v36 row_newbcast:8 row_mask:0xf bank_mask:0xf
  v_and_b32_dpp v15, v31, v0 row_newbcast:8 row_mask:0xf bank_mask:0xf
  s_nop 1
  v_mfma_f32_16x16x32_bf16 v[8:11], v[12:15], v[136:139], v[8:11]
  s_call_b64 s[62:63], L_vq
  s_cbranch_scc0 L_dr30
  v_add_u32_dpp v3, v30, v38 row_newbcast:14 row_mask:0xf bank_mask:0xf
  buffer_load_dwordx4 v[160:163], v3, s[48:51], 0 offen nt
  v_and_b32_dpp v12, v31, v34 row_newbcast:9 row_mask:0xf bank_mask:0xf
  v_and_b32_dpp v13, v31, v35 row_newbcast:9 row_mask:0xf bank_mask:0xf
  v_and_b32_dpp v14, v31, v36 row_newbcast:9 row_mask:0xf bank_mask:0xf
  v_and_b32_dpp v15, v31, v0 row_newbcast:9 row_mask:0xf bank_mask:0xf
  s_nop 1
  v_mfma_f32_16x16x32_bf16 v[8:11], v[12:15], v[140:143], v[8:11]
  s_call_b64 s[62:63], L_vq
  s_cbranch_scc0 L_dr31
  v_add_u32_dpp v3, v30, v38 row_newbcast:15 row_mask:0xf bank_mask:0xf
  buffer_load_dwordx4 v[164:167], v3, s[48:51], 0 offen nt
  v_and_b32_dpp v12, v31, v34 row_newbcast:10 row_mask:0xf bank_mask:0xf
  v_and_b32_dpp v13, v31, v35 row_newbcast:10 row_mask:0xf bank_mask:0xf
  v_and_b32_dpp v14, v31, v36 row_newbcast:10 row_mask:0xf bank_mask:0xf
  v_and_b32_dpp v15, v31, v0 row_newbcast:10 row_mask:0xf bank_mask:0xf
  s_nop 1
  v_mfma_f32_16x16x32_bf16 v[8:11], v[12:15], v[144:147], v[8:11]
  s_call_b64 s[62:63], L_vq
  s_cbranch_scc0 L_dr32
  v_add_u32_dpp v3, v32, v38 row_newbcast:0 row_mask:0xf bank_mask:0xf
  buffer_load_dwordx4 v[40:43], v3, s[48:51], 0 offen nt
  v_and_b32_dpp v12, v31, v34 row_newbcast:11 row_mask:0xf bank_mask:0xf
  v_and_b32_dpp v13, v31, v35 row_newbcast:11 row_mask:0xf bank_mask:0xf
  v_and_b32_dpp v14, v31, v36 row_newbcast:11 row_mask:0xf bank_mask:0xf
  v_and_b32_dpp v15, v31, v0 row_newbcast:11 row_mask:0xf bank_mask:0xf
  s_nop 1
  v_mfma_f32_16x16x32_bf16 v[8:11], v[12:15], v[148:151], v[8:11]
  s_call_b64 s[62:63], L_vq
  s_cbranch_scc0 L_dr33
  v_add_u32_dpp v3, v32, v38 row_newbcast:1 row_mask:0xf bank_mask:0xf
  buffer_load_dwordx4 v[44:47], v3, s[48:51], 0 offen nt
  v_and_b32_dpp v12, v31, v34 row_newbcast:12 row_mask:0xf bank_mask:0xf
  v_and_b32_dpp v13, v31, v35 row_newbcast:12 row_mask:0xf bank_mask:0xf
  v_and_b32_dpp v14, v31, v36 row_newbcast:12 row_mask:0xf bank_mask:0xf
  v_and_b32_dpp v15, v31, v0 row_newbcast:12 row_mask:0xf bank_mask:0xf
  s_nop 1
  v_mfma_f32_16x16x32_bf16 v[8:11], v[12:15], v[152:155], v[8:11]
  s_call_b64 s[62:63], L_vq
  s_cbranch_scc0 L_dr34
  v_add_u32_dpp v3, v32, v38 row_newbcast:2 row_mask:0xf bank_mask:0xf
  buffer_load_dwordx4 v[48:51], v3, s[48:51], 0 offen nt
  v_and_b32_dpp v12, v31, v34 row_newbcast:13 row_mask:0xf bank_mask:0xf
  v_and_b32_dpp v13, v31, v35 row_newbcast:13 row_mask:0xf bank_mask:0xf
  v_and_b32_dpp v14, v31, v36 row_newbcast:13 row_mask:0xf bank_mask:0xf
  v_and_b32_dpp v15, v31, v0 row_newbcast:13 row_mask:0xf bank_mask:0xf
  s_nop 1
  v_mfma_f32_16x16x32_bf16 v[8:11], v[12:15], v[156:159], v[8:11]
  s_call_b64 s[62:63], L_vq
  s_cbranch_scc0 L_dr35
  v_add_u32_dpp v3, v32, v38 row_newbcast:3 row_mask:0xf bank_mask:0xf
  buffer_load_dwordx4 v[52:55], v3, s[48:51], 0 offen nt
  v_and_b32_dpp v12, v31, v34 row_newbcast:14 row_mask:0xf bank_mask:0xf
  v_and_b32_dpp v13, v31, v35 row_newbcast:14 row_mask:0xf bank_mask:0xf
  v_and_b32_dpp v14, v31, v36 row_newbcast:14 row_mask:0xf bank_mask:0xf
  v_and_b32_dpp v15, v31, v0 row_newbcast:14 row_mask:0xf bank_mask:0xf
  s_nop 1
  v_mfma_f32_16x16x32_bf16 v[8:11], v[12:15], v[160:163], v[8:11]
  s_call_b64 s[62:63], L_vq
  s_cbranch_scc0 L_dr36
  v_add_u32_dpp v3, v32, v38 row_newbcast:4 row_mask:0xf bank_mask:0xf
  buffer_load_dwordx4 v[56:59], v3, s[48:51], 0 offen nt
  v_and_b32_dpp v12, v31, v34 row_newbcast:15 row_mask:0xf bank_mask:0xf
  v_and_b32_dpp v13, v31, v35 row_newbcast:15 row_mask:0xf bank_mask:0xf
  v_and_b32_dpp v14, v31, v36 row_newbcast:15 row_mask:0xf bank_mask:0xf
  v_and_b32_dpp v15, v31, v0 row_newbcast:15 row_mask:0xf bank_mask:0xf
  s_nop 1
  v_mfma_f32_16x16x32_bf16 v[8:11], v[12:15], v[164:167], v[8:11]
  s_call_b64 s[62:63], L_vq
  s_cbranch_scc0 L_dr37
  v_add_u32_dpp v3, v32, v38 row_newbcast:5 row_mask:0xf bank_mask:0xf
  buffer_load_dwordx4 v[60:63], v3, s[48:51], 0 offen nt
  v_and_b32_dpp v12, v33, v34 row_newbcast:0 row_mask:0xf bank_mask:0xf
  v_and_b32_dpp v13, v33, v35 row_newbcast:0 row_mask:0xf bank_mask:0xf
  v_and_b32_dpp v14, v33, v36 row_newbcast:0 row_mask:0xf bank_mask:0xf
  v_and_b32_dpp v15, v33, v0 row_newbcast:0 row_mask:0xf bank_mask:0xf
  s_nop 1
  v_mfma_f32_16x16x32_bf16 v[8:11], v[12:15], v[40:43], v[8:11]
  s_call_b64 s[62:63], L_vq
  s_branch L_dr38
L_dr5:
  v_and_b32_dpp v12, v29, v34 row_newbcast:0 row_mask:0xf bank_mask:0xf
  v_and_b32_dpp v13, v29, v35 row_newbcast:0 row_mask:0xf bank_mask:0xf
  v_and_b32_dpp v14, v29, v36 row_newbcast:0 row_mask:0xf bank_mask:0xf
  v_and_b32_dpp v15, v29, v0 row_newbcast:0 row_mask:0xf bank_mask:0xf
  s_nop 1
  v_mfma_f32_16x16x32_bf16 v[8:11], v[12:15], v[40:43], v[8:11]
  s_cmp_eq_u32 s75, 6
  s_cbranch_scc1 L_epi
L_dr6:
  v_and_b32_dpp v12, v29, v34 row_newbcast:1 row_mask:0xf bank_mask:0xf
  v_and_b32_dpp v13, v29, v35 row_newbcast:1 row_mask:0xf bank_mask:0xf
  v_and_b32_dpp v14, v29, v36 row_newbcast:1 row_mask:0xf bank_mask:0xf
  v_and_b32_dpp v15, v29, v0 row_newbcast:1 row_mask:0xf bank_mask:0xf
  s_nop 1
  v_mfma_f32_16x16x32_bf16 v[8:11], v[12:15], v[44:47], v[8:11]
  s_cmp_eq_u32 s75, 7
  s_cbranch_scc1 L_epi
L_dr7:
  v_and_b32_dpp v12, v29, v34 row_newbcast:2 row_mask:0xf bank_mask:0xf
  v_and_b32_dpp v13, v29, v35 row_newbcast:2 row_mask:0xf bank_mask:0xf
  v_and_b32_dpp v14, v29, v36 row_newbcast:2 row_mask:0xf bank_mask:0xf
  v_and_b32_dpp v15, v29, v0 row_newbcast:2 row_mask:0xf bank_mask:0xf
  s_nop 1
  v_mfma_f32_16x16x32_bf16 v[8:11], v[12:15], v[48:51], v[8:11]
  s_cmp_eq_u32 s75, 8
  s_cbranch_scc1 L_epi
L_dr8:
  v_and_b32_dpp v12, v29, v34 row_newbcast:3 row_mask:0xf bank_mask:0xf
  v_and_b32_dpp v13, v29, v35 row_newbcast:3 row_mask:0xf bank_mask:0xf
  v_and_b32_dpp v14, v29, v36 row_newbcast:3 row_mask:0xf bank_mask:0xf
  v_and_b32_dpp v15, v29, v0 row_newbcast:3 row_mask:0xf bank_mask:0xf
  s_nop 1
  v_mfma_f32_16x16x32_bf16 v[8:11], v[12:15], v[52:55], v[8:11]
  s_cmp_eq_u32 s75, 9
  s_cbranch_scc1 L_epi
L_dr9:
  v_and_b32_dpp v12, v29, v34 row_newbcast:4 row_mask:0xf bank_mask:0xf
  v_and_b32_dpp v13, v29, v35 row_newbcast:4 row_mask:0xf bank_mask:0xf
  v_and_b32_dpp v14, v29, v36 row_newbcast:4 row_mask:0xf bank_mask:0xf
  v_and_b32_dpp v15, v29, v0 row_newbcast:4 row_mask:0xf bank_mask:0xf
  s_nop 1
  v_mfma_f32_16x16x32_bf16 v[8:11], v[12:15], v[56:59], v[8:11]
  s_cmp_eq_u32 s75, 10
  s_cbranch_scc1 L_epi
L_dr10:
  v_and_b32_dpp v12, v29, v34 row_newbcast:5 row_mask:0xf bank_mask:0xf
  v_and_b32_dpp v13, v29, v35 row_newbcast:5 row_mask:0xf bank_mask:0xf
  v_and_b32_dpp v14, v29, v36 row_newbcast:5 row_mask:0xf bank_mask:0xf
  v_and_b32_dpp v15, v29, v0 row_newbcast:5 row_mask:0xf bank_mask:0xf
  s_nop 1
  v_mfma_f32_16x16x32_bf16 v[8:11], v[12:15], v[60:63], v[8:11]
  s_cmp_eq_u32 s75, 11
  s_cbranch_scc1 L_epi
L_dr11:
  v_and_b32_dpp v12, v29, v34 row_newbcast:6 row_mask:0xf bank_mask:0xf
  v_and_b32_dpp v13, v29, v35 row_newbcast:6 row_mask:0xf bank_mask:0xf
  v_and_b32_dpp v14, v29, v36 row_newbcast:6 row_mask:0xf bank_mask:0xf
  v_and_b32_dpp v15, v29, v0 row_newbcast:6 row_mask:0xf bank_mask:0xf
  s_nop 1
  v_mfma_f32_16x16x32_bf16 v[8:11], v[12:15], v[64:67], v[8:11]
  s_cmp_eq_u32 s75, 12
  s_cbranch_scc1 L_epi
L_dr12:
  v_and_b32_dpp v12, v29, v34 row_newbcast:7 row_mask:0xf bank_mask:0xf
  v_and_b32_dpp v13, v29, v35 row_newbcast:7 row_mask:0xf bank_mask:0xf
  v_and_b32_dpp v14, v29, v36 row_newbcast:7 row_mask:0xf bank_mask:0xf
  v_and_b32_dpp v15, v29, v0 row_newbcast:7 row_mask:0xf bank_mask:0xf
  s_nop 1
  v_mfma_f32_16x16x32_bf16 v[8:11], v[12:15], v[68:71], v[8:11]
  s_cmp_eq_u32 s75, 13
  s_cbranch_scc1 L_epi
L_dr13:
  v_and_b32_dpp v12, v29, v34 row_newbcast:8 row_mask:0xf bank_mask:0xf
  v_and_b32_dpp v13, v29, v35 row_newbcast:8 row_mask:0xf bank_mask:0xf
  v_and_b32_dpp v14, v29, v36 row_newbcast:8 row_mask:0xf bank_mask:0xf
  v_and_b32_dpp v15, v29, v0 row_newbcast:8 row_mask:0xf bank_mask:0xf
  s_nop 1
  v_mfma_f32_16x16x32_bf16 v[8:11], v[12:15], v[72:75], v[8:11]
  s_cmp_eq_u32 s75, 14
  s_cbranch_scc1 L_epi
L_dr14:
  v_and_b32_dpp v12, v29, v34 row_newbcast:9 row_mask:0xf bank_mask:0xf
  v_and_b32_dpp v13, v29, v35 row_newbcast:9 row_mask:0xf bank_mask:0xf
  v_and_b32_dpp v14, v29, v36 row_newbcast:9 row_mask:0xf bank_mask:0xf
  v_and_b32_dpp v15, v29, v0 row_newbcast:9 row_mask:0xf bank_mask:0xf
  s_nop 1
  v_mfma_f32_16x16x32_bf16 v[8:11], v[12:15], v[76:79], v[8:11]
  s_cmp_eq_u32 s75, 15
  s_cbranch_scc1 L_epi
L_dr15:
  v_and_b32_dpp v12, v29, v34 row_newbcast:10 row_mask:0xf bank_mask:0xf
  v_and_b32_dpp v13, v29, v35 row_newbcast:10 row_mask:0xf bank_mask:0xf
  v_and_b32_dpp v14, v29, v36 row_newbcast:10 row_mask:0xf bank_mask:0xf
  v_and_b32_dpp v15, v29, v0 row_newbcast:10 row_mask:0xf bank_mask:0xf
  s_nop 1
  v_mfma_f32_16x16x32_bf16 v[8:11], v[12:15], v[80:83], v[8:11]
  s_cmp_eq_u32 s75, 16
  s_cbranch_scc1 L_epi
L_dr16:
  v_and_b32_dpp v12, v29, v34 row_newbcast:11 row_mask:0xf bank_mask:0xf
  v_and_b32_dpp v13, v29, v35 row_newbcast:11 row_mask:0xf bank_mask:0xf
  v_and_b32_dpp v14, v29, v36 row_newbcast:11 row_mask:0xf bank_mask:0xf
  v_and_b32_dpp v15, v29, v0 row_newbcast:11 row_mask:0xf bank_mask:0xf
  s_nop 1
  v_mfma_f32_16x16x32_bf16 v[8:11], v[12:15], v[84:87], v[8:11]
  s_cmp_eq_u32 s75, 17
  s_cbranch_scc1 L_epi
L_dr17:
  v_and_b32_dpp v12, v29, v34 row_newbcast:12 row_mask:0xf bank_mask:0xf
  v_and_b32_dpp v13, v29, v35 row_newbcast:12 row_mask:0xf bank_mask:0xf
  v_and_b32_dpp v14, v29, v36 row_newbcast:12 row_mask:0xf bank_mask:0xf
  v_and_b32_dpp v15, v29, v0 row_newbcast:12 row_mask:0xf bank_mask:0xf
  s_nop 1
  v_mfma_f32_16x16x32_bf16 v[8:11], v[12:15], v[88:91], v[8:11]
  s_cmp_eq_u32 s75, 18
  s_cbranch_scc1 L_epi
L_dr18:
  v_and_b32_dpp v12, v29, v34 row_newbcast:13 row_mask:0xf bank_mask:0xf
  v_and_b32_dpp v13, v29, v35 row_newbcast:13 row_mask:0xf bank_mask:0xf
  v_and_b32_dpp v14, v29, v36 row_newbcast:13 row_mask:0xf bank_mask:0xf
  v_and_b32_dpp v15, v29, v0 row_newbcast:13 row_mask:0xf bank_mask:0xf
  s_nop 1
  v_mfma_f32_16x16x32_bf16 v[8:11], v[12:15], v[92:95], v[8:11]
  s_cmp_eq_u32 s75, 19
  s_cbranch_scc1 L_epi
L_dr19:
  v_and_b32_dpp v12, v29, v34 row_newbcast:14 row_mask:0xf bank_mask:0xf
  v_and_b32_dpp v13, v29, v35 row_newbcast:14 row_mask:0xf bank_mask:0xf
  v_and_b32_dpp v14, v29, v36 row_newbcast:14 row_mask:0xf bank_mask:0xf
  v_and_b32_dpp v15, v29, v0 row_newbcast:14 row_mask:0xf bank_mask:0xf
  s_nop 1
  v_mfma_f32_16x16x32_bf16 v[8:11], v[12:15], v[96:99], v[8:11]
  s_cmp_eq_u32 s75, 20
  s_cbranch_scc1 L_epi
L_dr20:
  v_and_b32_dpp v12, v29, v34 row_newbcast:15 row_mask:0xf bank_mask:0xf
  v_and_b32_dpp v13, v29, v35 row_newbcast:15 row_mask:0xf bank_mask:0xf
  v_and_b32_dpp v14, v29, v36 row_newbcast:15 row_mask:0xf bank_mask:0xf
  v_and_b32_dpp v15, v29, v0 row_newbcast:15 row_mask:0xf bank_mask:0xf
  s_nop 1
  v_mfma_f32_16x16x32_bf16 v[8:11], v[12:15], v[100:103], v[8:11]
  s_cmp_eq_u32 s75, 21
  s_cbranch_scc1 L_epi
L_dr21:
  v_and_b32_dpp v12, v31, v34 row_newbcast:0 row_mask:0xf bank_mask:0xf
  v_and_b32_dpp v13, v31, v35 row_newbcast:0 row_mask:0xf bank_mask:0xf
  v_and_b32_dpp v14, v31, v36 row_newbcast:0 row_mask:0xf bank_mask:0xf
  v_and_b32_dpp v15, v31, v0 row_newbcast:0 row_mask:0xf bank_mask:0xf
  s_nop 1
  v_mfma_f32_16x16x32_bf16 v[8:11], v[12:15], v[104:107], v[8:11]
  s_cmp_eq_u32 s75, 22
  s_cbranch_scc1 L_epi
L_dr22:
  v_and_b32_dpp v12, v31, v34 row_newbcast:1 row_mask:0xf bank_mask:0xf
  v_and_b32_dpp v13, v31, v35 row_newbcast:1 row_mask:0xf bank_mask:0xf
  v_and_b32_dpp v14, v31, v36 row_newbcast:1 row_mask:0xf bank_mask:0xf
  v_and_b32_dpp v15, v31, v0 row_newbcast:1 row_mask:0xf bank_mask:0xf
  s_nop 1
  v_mfma_f32_16x16x32_bf16 v[8:11], v[12:15], v[108:111], v[8:11]
  s_cmp_eq_u32 s75, 23
  s_cbranch_scc1 L_epi
L_dr23:
  v_and_b32_dpp v12, v31, v34 row_newbcast:2 row_mask:0xf bank_mask:0xf
  v_and_b32_dpp v13, v31, v35 row_newbcast:2 row_mask:0xf bank_mask:0xf
  v_and_b32_dpp v14, v31, v36 row_newbcast:2 row_mask:0xf bank_mask:0xf
  v_and_b32_dpp v15, v31, v0 row_newbcast:2 row_mask:0xf bank_mask:0xf
  s_nop 1
  v_mfma_f32_16x16x32_bf16 v[8:11], v[12:15], v[112:115], v[8:11]
  s_cmp_eq_u32 s75, 24
  s_cbranch_scc1 L_epi
L_dr24:
  v_and_b32_dpp v12, v31, v34 row_newbcast:3 row_mask:0xf bank_mask:0xf
  v_and_b32_dpp v13, v31, v35 row_newbcast:3 row_mask:0xf bank_mask:0xf
  v_and_b32_dpp v14, v31, v36 row_newbcast:3 row_mask:0xf bank_mask:0xf
  v_and_b32_dpp v15, v31, v0 row_newbcast:3 row_mask:0xf bank_mask:0xf
  s_nop 1
  v_mfma_f32_16x16x32_bf16 v[8:11], v[12:15], v[116:119], v[8:11]
  s_cmp_eq_u32 s75, 25
  s_cbranch_scc1 L_epi
L_dr25:
  v_and_b32_dpp v12, v31, v34 row_newbcast:4 row_mask:0xf bank_mask:0xf
  v_and_b32_dpp v13, v31, v35 row_newbcast:4 row_mask:0xf bank_mask:0xf
  v_and_b32_dpp v14, v31, v36 row_newbcast:4 row_mask:0xf bank_mask:0xf
  v_and_b32_dpp v15, v31, v0 row_newbcast:4 row_mask:0xf bank_mask:0xf
  s_nop 1
  v_mfma_f32_16x16x32_bf16 v[8:11], v[12:15], v[120:123], v[8:11]
  s_cmp_eq_u32 s75, 26
  s_cbranch_scc1 L_epi
L_dr26:
  v_and_b32_dpp v12, v31, v34 row_newbcast:5 row_mask:0xf bank_mask:0xf
  v_and_b32_dpp v13, v31, v35 row_newbcast:5 row_mask:0xf bank_mask:0xf
  v_and_b32_dpp v14, v31, v36 row_newbcast:5 row_mask:0xf bank_mask:0xf
  v_and_b32_dpp v15, v31, v0 row_newbcast:5 row_mask:0xf bank_mask:0xf
  s_nop 1
  v_mfma_f32_16x16x32_bf16 v[8:11], v[12:15], v[124:127], v[8:11]
  s_cmp_eq_u32 s75, 27
  s_cbranch_scc1 L_epi
L_dr27:
  v_and_b32_dpp v12, v31, v34 row_newbcast:6 row_mask:0xf bank_mask:0xf
  v_and_b32_dpp v13, v31, v35 row_newbcast:6 row_mask:0xf bank_mask:0xf
  v_and_b32_dpp v14, v31, v36 row_newbcast:6 row_mask:0xf bank_mask:0xf
  v_and_b32_dpp v15, v31, v0 row_newbcast:6 row_mask:0xf bank_mask:0xf
  s_nop 1
  v_mfma_f32_16x16x32_bf16 v[8:11], v[12:15], v[128:131], v[8:11]
  s_cmp_eq_u32 s75, 28
  s_cbranch_scc1 L_epi
L_dr28:
  v_and_b32_dpp v12, v31, v34 row_newbcast:7 row_mask:0xf bank_mask:0xf
  v_and_b32_dpp v13, v31, v35 row_newbcast:7 row_mask:0xf bank_mask:0xf
  v_and_b32_dpp v14, v31, v36 row_newbcast:7 row_mask:0xf bank_mask:0xf
  v_and_b32_dpp v15, v31, v0 row_newbcast:7 row_mask:0xf bank_mask:0xf
  s_nop 1
  v_mfma_f32_16x16x32_bf16 v[8:11], v[12:15], v[132:135], v[8:11]
  s_cmp_eq_u32 s75, 29
  s_cbranch_scc1 L_epi
L_dr29:
  v_and_b32_dpp v12, v31, v34 row_newbcast:8 row_mask:0xf bank_mask:0xf
  v_and_b32_dpp v13, v31, v35 row_newbcast:8 row_mask:0xf bank_mask:0xf
  v_and_b32_dpp v14, v31, v36 row_newbcast:8 row_mask:0xf bank_mask:0xf
  v_and_b32_dpp v15, v31, v0 row_newbcast:8 row_mask:0xf bank_mask:0xf
  s_nop 1
  v_mfma_f32_16x16x32_bf16 v[8:11], v[12:15], v[136:139], v[8:11]
  s_cmp_eq_u32 s75, 30
  s_cbranch_scc1 L_epi
L_dr30:
  v_and_b32_dpp v12, v31, v34 row_newbcast:9 row_mask:0xf bank_mask:0xf
  v_and_b32_dpp v13, v31, v35 row_newbcast:9 row_mask:0xf bank_mask:0xf
  v_and_b32_dpp v14, v31, v36 row_newbcast:9 row_mask:0xf bank_mask:0xf
  v_and_b32_dpp v15, v31, v0 row_newbcast:9 row_mask:0xf bank_mask:0xf
  s_nop 1
  v_mfma_f32_16x16x32_bf16 v[8:11], v[12:15], v[140:143], v[8:11]
  s_cmp_eq_u32 s75, 31
  s_cbranch_scc1 L_epi
L_dr31:
  v_and_b32_dpp v12, v31, v34 row_newbcast:10 row_mask:0xf bank_mask:0xf
  v_and_b32_dpp v13, v31, v35 row_newbcast:10 row_mask:0xf bank_mask:0xf
  v_and_b32_dpp v14, v31, v36 row_newbcast:10 row_mask:0xf bank_mask:0xf
  v_and_b32_dpp v15, v31, v0 row_newbcast:10 row_mask:0xf bank_mask:0xf
  s_nop 1
  v_mfma_f32_16x16x32_bf16 v[8:11], v[12:15], v[144:147], v[8:11]
  s_cmp_eq_u32 s75, 32
  s_cbranch_scc1 L_epi
L_dr32:
  v_and_b32_dpp v12, v31, v34 row_newbcast:11 row_mask:0xf bank_mask:0xf
  v_and_b32_dpp v13, v31, v35 row_newbcast:11 row_mask:0xf bank_mask:0xf
  v_and_b32_dpp v14, v31, v36 row_newbcast:11 row_mask:0xf bank_mask:0xf
  v_and_b32_dpp v15, v31, v0 row_newbcast:11 row_mask:0xf bank_mask:0xf
  s_nop 1
  v_mfma_f32_16x16x32_bf16 v[8:11], v[12:15], v[148:151], v[8:11]
  s_cmp_eq_u32 s75, 33
  s_cbranch_scc1 L_epi
L_dr33:
  v_and_b32_dpp v12, v31, v34 row_newbcast:12 row_mask:0xf bank_mask:0xf
  v_and_b32_dpp v13, v31, v35 row_newbcast:12 row_mask:0xf bank_mask:0xf
  v_and_b32_dpp v14, v31, v36 row_newbcast:12 row_mask:0xf bank_mask:0xf
  v_and_b32_dpp v15, v31, v0 row_newbcast:12 row_mask:0xf bank_mask:0xf
  s_nop 1
  v_mfma_f32_16x16x32_bf16 v[8:11], v[12:15], v[152:155], v[8:11]
  s_cmp_eq_u32 s75, 34
  s_cbranch_scc1 L_epi
L_dr34:
  v_and_b32_dpp v12, v31, v34 row_newbcast:13 row_mask:0xf bank_mask:0xf
  v_and_b32_dpp v13, v31, v35 row_newbcast:13 row_mask:0xf bank_mask:0xf
  v_and_b32_dpp v14, v31, v36 row_newbcast:13 row_mask:0xf bank_mask:0xf
  v_and_b32_dpp v15, v31, v0 row_newbcast:13 row_mask:0xf bank_mask:0xf
  s_nop 1
  v_mfma_f32_16x16x32_bf16 v[8:11], v[12:15], v[156:159], v[8:11]
  s_cmp_eq_u32 s75, 35
  s_cbranch_scc1 L_epi
L_dr35:
  v_and_b32_dpp v12, v31, v34 row_newbcast:14 row_mask:0xf bank_mask:0xf
  v_and_b32_dpp v13, v31, v35 row_newbcast:14 row_mask:0xf bank_mask:0xf
  v_and_b32_dpp v14, v31, v36 row_newbcast:14 row_mask:0xf bank_mask:0xf
  v_and_b32_dpp v15, v31, v0 row_newbcast:14 row_mask:0xf bank_mask:0xf
  s_nop 1
  v_mfma_f32_16x16x32_bf16 v[8:11], v[12:15], v[160:163], v[8:11]
  s_cmp_eq_u32 s75, 36
  s_cbranch_scc1 L_epi
L_dr36:
  v_and_b32_dpp v12, v31, v34 row_newbcast:15 row_mask:0xf bank_mask:0xf
  v_and_b32_dpp v13, v31, v35 row_newbcast:15 row_mask:0xf bank_mask:0xf
  v_and_b32_dpp v14, v31, v36 row_newbcast:15 row_mask:0xf bank_mask:0xf
  v_and_b32_dpp v15, v31, v0 row_newbcast:15 row_mask:0xf bank_mask:0xf
  s_nop 1
  v_mfma_f32_16x16x32_bf16 v[8:11], v[12:15], v[164:167], v[8:11]
  s_cmp_eq_u32 s75, 37
  s_cbranch_scc1 L_epi
L_dr37:
  v_and_b32_dpp v12, v33, v34 row_newbcast:0 row_mask:0xf bank_mask:0xf
  v_and_b32_dpp v13, v33, v35 row_newbcast:0 row_mask:0xf bank_mask:0xf
  v_and_b32_dpp v14, v33, v36 row_newbcast:0 row_mask:0xf bank_mask:0xf
  v_and_b32_dpp v15, v33, v0 row_newbcast:0 row_mask:0xf bank_mask:0xf
  s_nop 1
  v_mfma_f32_16x16x32_bf16 v[8:11], v[12:15], v[40:43], v[8:11]
  s_cmp_eq_u32 s75, 38
  s_cbranch_scc1 L_epi
L_dr38:
  v_and_b32_dpp v12, v33, v34 row_newbcast:1 row_mask:0xf bank_mask:0xf
  v_and_b32_dpp v13, v33, v35 row_newbcast:1 row_mask:0xf bank_mask:0xf
  v_and_b32_dpp v14, v33, v36 row_newbcast:1 row_mask:0xf bank_mask:0xf
  v_and_b32_dpp v15, v33, v0 row_newbcast:1 row_mask:0xf bank_mask:0xf
  s_nop 1
  v_mfma_f32_16x16x32_bf16 v[8:11], v[12:15], v[44:47], v[8:11]
  s_cmp_eq_u32 s75, 39
  s_cbranch_scc1 L_epi
L_dr39:
  v_and_b32_dpp v12, v33, v34 row_newbcast:2 row_mask:0xf bank_mask:0xf
  v_and_b32_dpp v13, v33, v35 row_newbcast:2 row_mask:0xf bank_mask:0xf
  v_and_b32_dpp v14, v33, v36 row_newbcast:2 row_mask:0xf bank_mask:0xf
  v_and_b32_dpp v15, v33, v0 row_newbcast:2 row_mask:0xf bank_mask:0xf
  s_nop 1
  v_mfma_f32_16x16x32_bf16 v[8:11], v[12:15], v[48:51], v[8:11]
  s_cmp_eq_u32 s75, 40
  s_cbranch_scc1 L_epi
L_dr40:
  v_and_b32_dpp v12, v33, v34 row_newbcast:3 row_mask:0xf bank_mask:0xf
  v_and_b32_dpp v13, v33, v35 row_newbcast:3 row_mask:0xf bank_mask:0xf
  v_and_b32_dpp v14, v33, v36 row_newbcast:3 row_mask:0xf bank_mask:0xf
  v_and_b32_dpp v15, v33, v0 row_newbcast:3 row_mask:0xf bank_mask:0xf
  s_nop 1
  v_mfma_f32_16x16x32_bf16 v[8:11], v[12:15], v[52:55], v[8:11]
  s_cmp_eq_u32 s75, 41
  s_cbranch_scc1 L_epi
L_dr41:
  v_and_b32_dpp v12, v33, v34 row_newbcast:4 row_mask:0xf bank_mask:0xf
  v_and_b32_dpp v13, v33, v35 row_newbcast:4 row_mask:0xf bank_mask:0xf
  v_and_b32_dpp v14, v33, v36 row_newbcast:4 row_mask:0xf bank_mask:0xf
  v_and_b32_dpp v15, v33, v0 row_newbcast:4 row_mask:0xf bank_mask:0xf
  s_nop 1
  v_mfma_f32_16x16x32_bf16 v[8:11], v[12:15], v[56:59], v[8:11]
  s_cmp_eq_u32 s75, 42
  s_cbranch_scc1 L_epi
L_dr42:
  v_and_b32_dpp v12, v33, v34 row_newbcast:5 row_mask:0xf bank_mask:0xf
  v_and_b32_dpp v13, v33, v35 row_newbcast:5 row_mask:0xf bank_mask:0xf
  v_and_b32_dpp v14, v33, v36 row_newbcast:5 row_mask:0xf bank_mask:0xf
  v_and_b32_dpp v15, v33, v0 row_newbcast:5 row_mask:0xf bank_mask:0xf
  s_nop 1
  v_mfma_f32_16x16x32_bf16 v[8:11], v[12:15], v[60:63], v[8:11]
  s_cmp_eq_u32 s75, 43
  s_cbranch_scc1 L_epi
L_epi:
  v_lshrrev_b32 v3, 4, v1
  v_lshl_add_u32 v21, v3, 3, v39
  v_add_u32 v21, s11, v21
  v_mov_b32 v3, 1
  s_nop 3
  v_pk_add_f32 v[8:9], v[8:9], v[4:5]
  v_pk_add_f32 v[10:11], v[10:11], v[6:7]
  s_mov_b32 exec_hi, 0
  ds_write_b128 v21, v[8:11] offset:1024
  s_cmp_eq_u32 s21, 0
  s_cbranch_scc1 L_ep2
  s_mov_b32 exec_hi, 0
  ds_write_b128 v21, v[8:11] offset:6656
  s_mov_b64 exec, 1
  ds_add_u32 v1, v3 offset:304
  s_mov_b64 exec, -1
L_ep2:
  s_mov_b64 exec, 1
  ds_add_u32 v1, v3 offset:308
L_send:
  s_endpgm
L_ks:
  s_cmp_lt_u32 s32, s57
  s_cbranch_scc1 L_kq
  s_call_b64 s[100:101], L_work
L_kq:
  v_readfirstlane_b32 s78, v22
  v_readfirstlane_b32 s79, v23
L_ks2:
  s_mov_b64 exec, 1
  ds_dec_u32 v2, v39 offset:288
  ds_read_b64 v[22:23], v2 offset:288
  s_mov_b64 exec, -1
  s_mul_i32 s68, s35, 11
  s_and_b32 s69, s79, 0xffff
  s_sub_i32 s68, s68, s78
  s_mul_i32 s69, s69, s77
  s_mul_i32 s68, s68, 160
  s_sub_u32 s35, s35, 1
  s_add_i32 s68, s68, s69
  s_add_i32 s68, s68, s34
  s_max_i32 s68, s68, 4915
  s_min_i32 s68, s68, s76
  s_lshr_b32 s37, s68, 12
  s_lshl_b32 s58, s68, 20
L_kl:
  s_add_u32 s32, s32, 1
  s_add_u32 s33, s33, 0x20000000
  s_add_u32 s68, s33, s58
  s_addc_u32 s41, s37, 0
  s_cmp_eq_u32 s41, 3
  s_cbranch_scc1 L_wt3
  s_cmp_eq_u32 s41, 2
  s_cbranch_scc1 L_wt2
  s_cmp_eq_u32 s41, 4
  s_cbranch_scc1 L_wt4
  s_cmp_eq_u32 s41, 1
  s_cbranch_scc1 L_wt1
L_wtx:
  s_cmp_eq_u32 s32, s32
L_wt5:
  s_waitcnt vmcnt(4)
  s_setpc_b64 s[62:63]
L_wt3:
  s_waitcnt vmcnt(2)
  s_setpc_b64 s[62:63]
L_wt2:
  s_waitcnt vmcnt(1)
  s_setpc_b64 s[62:63]
L_wt4:
  s_waitcnt vmcnt(3)
  s_setpc_b64 s[62:63]
L_wt1:
  s_waitcnt vmcnt(0)
  s_setpc_b64 s[62:63]
L_kq2:
  v_readfirstlane_b32 s78, v22
  v_readfirstlane_b32 s79, v23
L_ks3:
  s_mov_b64 exec, 1
  ds_dec_u32 v2, v39 offset:288
  ds_dec_u32 v2, v39 offset:288
  ds_read_b64 v[22:23], v2 offset:288
  s_mov_b64 exec, -1
  s_mul_i32 s68, s35, 11
  s_and_b32 s69, s79, 0xffff
  s_sub_i32 s68, s68, s78
  s_mul_i32 s69, s69, s77
  s_mul_i32 s68, s68, 160
  s_sub_u32 s35, s35, 2
  s_add_i32 s68, s68, s69
  s_add_i32 s68, s68, s34
  s_max_i32 s68, s68, 4915
  s_min_i32 s68, s68, s76
  s_lshr_b32 s37, s68, 12
  s_lshl_b32 s58, s68, 20
  s_branch L_kl
L_vl:
  s_cmp_lt_u32 s32, s36
  s_cbranch_scc1 L_kl
  s_branch L_ev
L_vq2:
  v_readfirstlane_b32 s78, v22
  v_readfirstlane_b32 s79, v23
  s_cmp_lt_u32 s32, s36
  s_cbranch_scc1 L_ks3
  s_branch L_ev
L_vs:
  v_readfirstlane_b32 s78, v22
  v_readfirstlane_b32 s79, v23
  s_cmp_eq_u32 s61, 2
  s_cbranch_scc1 L_vs1
  s_cmp_eq_u32 s61, 1
  s_cbranch_scc1 L_x3
  s_cmp_gt_u32 s41, s32
  s_cbranch_scc1 L_ks2
L_x1:
  s_mov_b64 vcc, s[54:55]
  v_mfma_f32_16x16x32_bf16 v[8:11], v[152:155], v[4:7], 0
  v_mfma_f32_16x16x32_bf16 v[152:155], v[156:159], v[4:7], 0
  v_mfma_f32_16x16x32_bf16 v[156:159], v[160:163], v[4:7], 0
  v_mfma_f32_16x16x32_bf16 v[160:163], v[164:167], v[4:7], 0
  s_nop 4
  v_cndmask_b32_dpp v12, v8, v9, vcc quad_perm:[0,1,2,3] row_mask:0xf bank_mask:0x1
  v_cndmask_b32_dpp v13, v10, v11, vcc quad_perm:[0,1,2,3] row_mask:0xf bank_mask:0x1
  v_cndmask_b32_dpp v12, v152, v153, vcc quad_perm:[0,1,2,3] row_mask:0xf bank_mask:0x4
  v_cndmask_b32_dpp v13, v154, v155, vcc quad_perm:[0,1,2,3] row_mask:0xf bank_mask:0x4
  v_cndmask_b32_dpp v12, v156, v157, vcc quad_perm:[0,1,2,3] row_mask:0xf bank_mask:0x2
  v_cndmask_b32_dpp v13, v158, v159, vcc quad_perm:[0,1,2,3] row_mask:0xf bank_mask:0x2
  v_cndmask_b32_dpp v12, v160, v161, vcc quad_perm:[0,1,2,3] row_mask:0xf bank_mask:0x8
  v_cndmask_b32_dpp v13, v162, v163, vcc quad_perm:[0,1,2,3] row_mask:0xf bank_mask:0x8
  v_cndmask_b32 v19, v12, v13, s[52:53]
  s_lshl_b32 s68, s20, 3
  s_add_u32 s68, s68, s56
  v_add_f32_dpp v16, v16, v16 quad_perm:[2,3,0,1] row_mask:0xf bank_mask:0xf
  v_add_f32_dpp v17, v17, v17 quad_perm:[2,3,0,1] row_mask:0xf bank_mask:0xf
  v_add_f32_dpp v18, v18, v18 quad_perm:[2,3,0,1] row_mask:0xf bank_mask:0xf
  v_add_f32_dpp v19, v19, v19 quad_perm:[2,3,0,1] row_mask:0xf bank_mask:0xf
  v_cndmask_b32 v8, v16, v17, s[52:53]
  v_cndmask_b32 v9, v18, v19, s[52:53]
  v_mov_b32 v20, 64
  v_lshlrev_b32 v21, 3, s9
  v_add_f32_dpp v8, v8, v8 quad_perm:[1,0,3,2] row_mask:0xf bank_mask:0xf
  v_add_f32_dpp v9, v9, v9 quad_perm:[1,0,3,2] row_mask:0xf bank_mask:0xf
  v_cndmask_b32 v27, v8, v9, s[54:55]
  v_cvt_pk_bf16_f32 v27, 0, v27
  v_mul_f32 v27, 0x3db504f3, v27
  v_cvt_pk_bf16_f32 v27, 0, v27
  v_max_f32 v37, v37, v27
  v_cmp_ngt_f32 vcc, s22, v27
  v_mov_b32 v4, 0
  v_max_f32_dpp v37, v37, v37 row_ror:8 row_mask:0xf bank_mask:0xf
  s_bcnt1_i32_b64 s69, vcc
  s_add_u32 s69, s69, s20
  v_max_f32_dpp v37, v37, v37 row_ror:4 row_mask:0xf bank_mask:0xf
  s_cmp_gt_u32 s69, 32
  s_cselect_b32 s21, 1, s21
  v_max_f32_dpp v37, v37, v37 row_ror:2 row_mask:0xf bank_mask:0xf
  s_cmp_eq_u32 s21, 0
  s_cselect_b64 s[66:67], vcc, 0
  s_cselect_b32 s20, s69, s20
  v_max_f32_dpp v37, v37, v37 row_ror:1 row_mask:0xf bank_mask:0xf
  v_mbcnt_lo_u32_b32 v3, s66, 0
  v_mov_b32 v8, v37
  v_mbcnt_hi_u32_b32 v3, s67, v3
  v_lshl_add_u32 v3, v3, 3, s68
  v_permlane16_swap_b32 v8, v37
  s_mov_b64 exec, s[66:67]
  ds_write_b64 v3, v[26:27] offset:1280
  s_mov_b64 exec, -1
  ds_read_b32 v32, v39 offset:1024
  v_max_f32 v37, v37, v8
  v_mov_b32 v8, v37
  v_mov_b32 v5, 0
  s_mov_b32 s18, s32
  v_permlane32_swap_b32 v8, v37
  v_max_f32 v37, v37, v8
  v_sub_f32 v17, v25, v37
  v_sub_f32 v18, v27, v37
  v_mul_f32 v17, 0x3fb8aa3b, v17
  v_mul_f32 v18, 0x3fb8aa3b, v18
  v_exp_f32 v17, v17
  v_exp_f32 v18, v18
  s_lshl_b32 s68, s9, 9
  v_lshl_add_u32 v16, v1, 2, s68
  v_add_f32 v17, v17, v18
  s_waitcnt lgkmcnt(0)
  s_cmp_le_u32 s20, 0
  s_cbranch_scc1 L_x2
  v_add_u32_dpp v3, v32, v38 row_newbcast:8 row_mask:0xf bank_mask:0xf
  buffer_load_dwordx4 v[136:139], v3, s[48:51], 0 offen nt
  s_cmp_le_u32 s20, 4
  s_cbranch_scc1 L_x2
  v_add_u32_dpp v3, v32, v38 row_newbcast:9 row_mask:0xf bank_mask:0xf
  buffer_load_dwordx4 v[140:143], v3, s[48:51], 0 offen nt
  s_cmp_le_u32 s20, 8
  s_cbranch_scc1 L_x2
  v_add_u32_dpp v3, v32, v38 row_newbcast:10 row_mask:0xf bank_mask:0xf
  buffer_load_dwordx4 v[144:147], v3, s[48:51], 0 offen nt
  s_cmp_le_u32 s20, 12
  s_cbranch_scc1 L_x2
  v_add_u32_dpp v3, v32, v38 row_newbcast:11 row_mask:0xf bank_mask:0xf
  buffer_load_dwordx4 v[148:151], v3, s[48:51], 0 offen nt
  s_cmp_le_u32 s20, 16
  s_cbranch_scc1 L_x2
  v_add_u32_dpp v3, v32, v38 row_newbcast:12 row_mask:0xf bank_mask:0xf
  buffer_load_dwordx4 v[152:155], v3, s[48:51], 0 offen nt
  s_cmp_le_u32 s20, 20
  s_cbranch_scc1 L_x2
  v_add_u32_dpp v3, v32, v38 row_newbcast:13 row_mask:0xf bank_mask:0xf
  buffer_load_dwordx4 v[156:159], v3, s[48:51], 0 offen nt
  s_cmp_le_u32 s20, 24
  s_cbranch_scc1 L_x2
  v_add_u32_dpp v3, v32, v38 row_newbcast:14 row_mask:0xf bank_mask:0xf
  buffer_load_dwordx4 v[160:163], v3, s[48:51], 0 offen nt
  s_cmp_le_u32 s20, 28
  s_cbranch_scc1 L_x2
  v_add_u32_dpp v3, v32, v38 row_newbcast:15 row_mask:0xf bank_mask:0xf
  buffer_load_dwordx4 v[164:167], v3, s[48:51], 0 offen nt
L_x2:
  ds_write_b32 v16, v17 offset:1024
  s_mov_b64 exec, 1
  ds_write_b32 v21, v37 offset:512
  ds_add_u32 v1, v20 offset:272
  s_mov_b64 exec, -1
  s_mov_b32 s61, 1
  s_mov_b32 s19, 1
  s_add_i32 s34, s34, 820
  s_cmp_lt_u32 s32, 5
  s_cbranch_scc1 L_ks2
L_x3:
  v_max_f32 v21, s23, v37
  s_add_u32 s38, s38, 3
  s_lshr_b32 s38, s38, 2
  v_add_f32 v21, 0xc2a5e666, v21
  s_max_u32 s38, s38, s32
  s_lshl_b32 s38, s38, 2
  v_cmp_nlt_f32 vcc, v27, v21
  s_lshl_b32 s68, s38, 3
  s_add_u32 s68, s68, s56
  s_andn2_b64 s[70:71], vcc, s[66:67]
  v_mbcnt_lo_u32_b32 v3, s70, 0
  v_mbcnt_hi_u32_b32 v3, s71, v3
  s_bcnt1_i32_b64 s69, s[70:71]
  v_lshl_add_u32 v3, v3, 3, s68
  s_mov_b64 exec, s[70:71]
  ds_write_b64 v3, v[26:27]
  s_mov_b64 exec, -1
  s_or_b64 s[66:67], s[66:67], s[70:71]
  s_add_u32 s38, s38, s69
  ds_read_b64 v[28:29], v39 offset:0
  ds_read_b64 v[30:31], v39 offset:512
  ds_read_b64 v[32:33], v39 offset:1024
  v_mov_b32 v8, 0
  v_mov_b32 v9, 0
  v_mov_b32 v10, 0
  v_mov_b32 v11, 0
  v_mov_b32 v6, 0
  v_mov_b32 v7, 0
  s_lshr_b32 s36, s38, 2
  s_mov_b32 s61, 2
  s_add_u32 s68, s38, 13
  s_lshr_b32 s68, s68, 2
  s_sub_u32 s69, s68, s59
  s_mov_b32 s59, s68
  s_add_u32 s35, s35, s69
  s_add_u32 s78, s78, s69
  v_mov_b32 v3, s69
  s_mov_b64 exec, 1
  ds_add_u32 v1, v3 offset:296
  ds_add_u32 v1, v3 offset:300
  s_mov_b64 exec, -1
  s_waitcnt lgkmcnt(0)
  v_sub_f32 v29, v29, v37
  v_sub_f32 v31, v31, v37
  v_sub_f32 v33, v33, v37
  v_mul_f32 v29, 0x3fb8aa3b, v29
  v_mul_f32 v31, 0x3fb8aa3b, v31
  v_mul_f32 v33, 0x3fb8aa3b, v33
  v_exp_f32 v29, v29
  v_exp_f32 v31, v31
  v_exp_f32 v33, v33
  s_nop 0
  v_cvt_pk_bf16_f32 v29, v29, v29
  v_cvt_pk_bf16_f32 v31, v31, v31
  v_cvt_pk_bf16_f32 v33, v33, v33
  s_cmp_eq_u32 s20, 0
  s_cselect_b32 s41, 0, s41
L_vs1:
  s_cmp_eq_u32 s19, 0
  s_cbranch_scc1 L_vs1b
  s_sub_u32 s68, s32, s18
  s_cmp_le_u32 s41, s68
  s_cbranch_scc1 L_snap
  s_cmp_lt_u32 s32, s36
  s_cbranch_scc1 L_ks2
  s_waitcnt vmcnt(0)
L_snap:
  s_cmp_le_u32 s20, 0
  s_cbranch_scc1 L_snp2
  v_and_b32_dpp v12, v33, v34 row_newbcast:8 row_mask:0xf bank_mask:0xf
  v_and_b32_dpp v13, v33, v35 row_newbcast:8 row_mask:0xf bank_mask:0xf
  v_and_b32_dpp v14, v33, v36 row_newbcast:8 row_mask:0xf bank_mask:0xf
  v_and_b32_dpp v15, v33, v0 row_newbcast:8 row_mask:0xf bank_mask:0xf
  s_nop 1
  v_mfma_f32_16x16x32_bf16 v[4:7], v[12:15], v[136:139], v[4:7]
  s_cmp_le_u32 s20, 4
  s_cbranch_scc1 L_snp2
  v_and_b32_dpp v12, v33, v34 row_newbcast:9 row_mask:0xf bank_mask:0xf
  v_and_b32_dpp v13, v33, v35 row_newbcast:9 row_mask:0xf bank_mask:0xf
  v_and_b32_dpp v14, v33, v36 row_newbcast:9 row_mask:0xf bank_mask:0xf
  v_and_b32_dpp v15, v33, v0 row_newbcast:9 row_mask:0xf bank_mask:0xf
  s_nop 1
  v_mfma_f32_16x16x32_bf16 v[4:7], v[12:15], v[140:143], v[4:7]
  s_cmp_le_u32 s20, 8
  s_cbranch_scc1 L_snp2
  v_and_b32_dpp v12, v33, v34 row_newbcast:10 row_mask:0xf bank_mask:0xf
  v_and_b32_dpp v13, v33, v35 row_newbcast:10 row_mask:0xf bank_mask:0xf
  v_and_b32_dpp v14, v33, v36 row_newbcast:10 row_mask:0xf bank_mask:0xf
  v_and_b32_dpp v15, v33, v0 row_newbcast:10 row_mask:0xf bank_mask:0xf
  s_nop 1
  v_mfma_f32_16x16x32_bf16 v[4:7], v[12:15], v[144:147], v[4:7]
  s_cmp_le_u32 s20, 12
  s_cbranch_scc1 L_snp2
  v_and_b32_dpp v12, v33, v34 row_newbcast:11 row_mask:0xf bank_mask:0xf
  v_and_b32_dpp v13, v33, v35 row_newbcast:11 row_mask:0xf bank_mask:0xf
  v_and_b32_dpp v14, v33, v36 row_newbcast:11 row_mask:0xf bank_mask:0xf
  v_and_b32_dpp v15, v33, v0 row_newbcast:11 row_mask:0xf bank_mask:0xf
  s_nop 1
  v_mfma_f32_16x16x32_bf16 v[4:7], v[12:15], v[148:151], v[4:7]
  s_cmp_le_u32 s20, 16
  s_cbranch_scc1 L_snp2
  v_and_b32_dpp v12, v33, v34 row_newbcast:12 row_mask:0xf bank_mask:0xf
  v_and_b32_dpp v13, v33, v35 row_newbcast:12 row_mask:0xf bank_mask:0xf
  v_and_b32_dpp v14, v33, v36 row_newbcast:12 row_mask:0xf bank_mask:0xf
  v_and_b32_dpp v15, v33, v0 row_newbcast:12 row_mask:0xf bank_mask:0xf
  s_nop 1
  v_mfma_f32_16x16x32_bf16 v[4:7], v[12:15], v[152:155], v[4:7]
  s_cmp_le_u32 s20, 20
  s_cbranch_scc1 L_snp2
  v_and_b32_dpp v12, v33, v34 row_newbcast:13 row_mask:0xf bank_mask:0xf
  v_and_b32_dpp v13, v33, v35 row_newbcast:13 row_mask:0xf bank_mask:0xf
  v_and_b32_dpp v14, v33, v36 row_newbcast:13 row_mask:0xf bank_mask:0xf
  v_and_b32_dpp v15, v33, v0 row_newbcast:13 row_mask:0xf bank_mask:0xf
  s_nop 1
  v_mfma_f32_16x16x32_bf16 v[4:7], v[12:15], v[156:159], v[4:7]
  s_cmp_le_u32 s20, 24
  s_cbranch_scc1 L_snp2
  v_and_b32_dpp v12, v33, v34 row_newbcast:14 row_mask:0xf bank_mask:0xf
  v_and_b32_dpp v13, v33, v35 row_newbcast:14 row_mask:0xf bank_mask:0xf
  v_and_b32_dpp v14, v33, v36 row_newbcast:14 row_mask:0xf bank_mask:0xf
  v_and_b32_dpp v15, v33, v0 row_newbcast:14 row_mask:0xf bank_mask:0xf
  s_nop 1
  v_mfma_f32_16x16x32_bf16 v[4:7], v[12:15], v[160:163], v[4:7]
  s_cmp_le_u32 s20, 28
  s_cbranch_scc1 L_snp2
  v_and_b32_dpp v12, v33, v34 row_newbcast:15 row_mask:0xf bank_mask:0xf
  v_and_b32_dpp v13, v33, v35 row_newbcast:15 row_mask:0xf bank_mask:0xf
  v_and_b32_dpp v14, v33, v36 row_newbcast:15 row_mask:0xf bank_mask:0xf
  v_and_b32_dpp v15, v33, v0 row_newbcast:15 row_mask:0xf bank_mask:0xf
  s_nop 1
  v_mfma_f32_16x16x32_bf16 v[4:7], v[12:15], v[164:167], v[4:7]
L_snp2:
  v_lshrrev_b32 v3, 4, v1
  v_lshl_add_u32 v21, v3, 3, v39
  v_add_u32 v21, s11, v21
  v_mov_b32 v3, 1
  s_nop 0
  s_mov_b32 s19, 0
  s_sub_i32 s34, s34, 2458
  s_mov_b32 s76, 20480
  s_cmp_lg_u32 s21, 0
  s_cbranch_scc1 L_vs1b
  s_mov_b32 exec_hi, 0
  ds_write_b128 v21, v[4:7] offset:6656
  s_mov_b64 exec, 1
  ds_add_u32 v1, v3 offset:304
  s_mov_b64 exec, -1
  s_branch L_vs1b
L_vq:
  v_readfirstlane_b32 s78, v22
  v_readfirstlane_b32 s79, v23
L_vs1b:
L_vs2:
  s_cmp_lt_u32 s32, s36
  s_cbranch_scc1 L_ks2
L_ev:
  s_cmp_eq_u32 s75, 0
  s_cbranch_scc1 L_hand
  s_add_u32 s68, s32, 5
  s_cmp_lt_u32 s68, s75
  s_cbranch_scc0 L_wt1
  s_add_u32 s32, s32, 1
  s_mov_b64 exec, 1
  ds_dec_u32 v2, v39 offset:288
  s_mov_b64 exec, -1
  s_branch L_wtx
L_hand:
  v_mov_b32 v3, 0
  s_mov_b32 s70, 0
L_sn_1:
  ds_read_b64 v[18:19], v3 offset:272
  s_waitcnt lgkmcnt(0)
  v_cmp_gt_u32 vcc, 0x102c0, v18
  s_cmp_eq_u64 vcc, 0
  s_cbranch_scc1 L_snd_2
  s_sleep 1
  s_add_u32 s70, s70, 1
  s_cmp_lt_u32 s70, 2097152
  s_cbranch_scc1 L_sn_1
L_snd_2:
  v_cmp_nlt_f32 vcc, v25, v19
  s_lshl_b32 s68, s38, 3
  s_add_u32 s68, s68, s56
  s_andn2_b64 s[70:71], vcc, s[64:65]
  v_mbcnt_lo_u32_b32 v3, s70, 0
  v_mbcnt_hi_u32_b32 v3, s71, v3
  s_bcnt1_i32_b64 s69, s[70:71]
  v_lshl_add_u32 v3, v3, 3, s68
  s_mov_b64 exec, s[70:71]
  ds_write_b64 v3, v[24:25]
  s_mov_b64 exec, -1
  s_or_b64 s[64:65], s[64:65], s[70:71]
  s_add_u32 s38, s38, s69
  v_cmp_nlt_f32 vcc, v27, v19
  s_lshl_b32 s68, s38, 3
  s_add_u32 s68, s68, s56
  s_andn2_b64 s[70:71], vcc, s[66:67]
  v_mbcnt_lo_u32_b32 v3, s70, 0
  v_mbcnt_hi_u32_b32 v3, s71, v3
  s_bcnt1_i32_b64 s69, s[70:71]
  v_lshl_add_u32 v3, v3, 3, s68
  s_mov_b64 exec, s[70:71]
  ds_write_b64 v3, v[26:27]
  s_mov_b64 exec, -1
  s_or_b64 s[66:67], s[66:67], s[70:71]
  s_add_u32 s38, s38, s69
  ds_read_b64 v[28:29], v39 offset:0
  ds_read_b64 v[30:31], v39 offset:512
  ds_read_b64 v[32:33], v39 offset:1024
  s_add_u32 s75, s38, 23
  s_lshr_b32 s75, s75, 2
  s_sub_u32 s36, s75, 8
  s_max_i32 s36, s36, 0
  s_add_u32 s68, s38, 3
  s_lshr_b32 s68, s68, 2
  s_sub_u32 s69, s68, s59
  s_mov_b32 s59, s68
  s_add_u32 s35, s35, s69
  s_add_u32 s78, s78, s69
  v_mov_b32 v3, s69
  s_mov_b64 exec, 1
  ds_add_u32 v1, v3 offset:296
  ds_add_u32 v1, v3 offset:300
  s_mov_b64 exec, -1
  s_waitcnt lgkmcnt(0)
  v_sub_f32 v29, v29, v37
  v_sub_f32 v31, v31, v37
  v_sub_f32 v33, v33, v37
  v_mul_f32 v29, 0x3fb8aa3b, v29
  v_mul_f32 v31, 0x3fb8aa3b, v31
  v_mul_f32 v33, 0x3fb8aa3b, v33
  v_exp_f32 v29, v29
  v_exp_f32 v31, v31
  v_exp_f32 v33, v33
  s_nop 0
  v_cvt_pk_bf16_f32 v29, v29, v29
  v_cvt_pk_bf16_f32 v31, v31, v31
  v_cvt_pk_bf16_f32 v33, v33, v33
  s_branch L_vs2
L_work:
  s_cmp_eq_u32 s39, 4
  s_cbranch_scc1 L_w3
  s_cmp_eq_u32 s39, 3
  s_cbranch_scc1 L_w2b
  s_cmp_eq_u32 s39, 5
  s_cbranch_scc1 L_w5
L_w2:
  v_and_b32 v3, 0xf0, v0
  ds_read_b128 v[4:7], v3 offset:0
  s_waitcnt lgkmcnt(0)
  v_max3_u32 v8, v4, v5, v6
  v_max_u32 v8, v8, v7
  v_cmp_eq_u32 vcc, -1, v8
  s_cmp_lg_u64 vcc, 0
  s_cbranch_scc1 L_wr
  s_mov_b64 vcc, s[54:55]
  v_mfma_f32_16x16x32_bf16 v[8:11], v[40:43], v[4:7], 0
  v_mfma_f32_16x16x32_bf16 v[40:43], v[44:47], v[4:7], 0
  v_mfma_f32_16x16x32_bf16 v[44:47], v[48:51], v[4:7], 0
  v_mfma_f32_16x16x32_bf16 v[48:51], v[52:55], v[4:7], 0
  v_mfma_f32_16x16x32_bf16 v[52:55], v[56:59], v[4:7], 0
  v_mfma_f32_16x16x32_bf16 v[56:59], v[60:63], v[4:7], 0
  v_mfma_f32_16x16x32_bf16 v[60:63], v[64:67], v[4:7], 0
  v_mfma_f32_16x16x32_bf16 v[64:67], v[68:71], v[4:7], 0
  s_nop 0
  v_cndmask_b32_dpp v12, v8, v9, vcc quad_perm:[0,1,2,3] row_mask:0xf bank_mask:0x1
  v_cndmask_b32_dpp v13, v10, v11, vcc quad_perm:[0,1,2,3] row_mask:0xf bank_mask:0x1
  v_cndmask_b32_dpp v12, v40, v41, vcc quad_perm:[0,1,2,3] row_mask:0xf bank_mask:0x4
  v_cndmask_b32_dpp v13, v42, v43, vcc quad_perm:[0,1,2,3] row_mask:0xf bank_mask:0x4
  v_cndmask_b32_dpp v12, v44, v45, vcc quad_perm:[0,1,2,3] row_mask:0xf bank_mask:0x2
  v_cndmask_b32_dpp v13, v46, v47, vcc quad_perm:[0,1,2,3] row_mask:0xf bank_mask:0x2
  v_cndmask_b32_dpp v12, v48, v49, vcc quad_perm:[0,1,2,3] row_mask:0xf bank_mask:0x8
  v_cndmask_b32_dpp v13, v50, v51, vcc quad_perm:[0,1,2,3] row_mask:0xf bank_mask:0x8
  v_cndmask_b32 v16, v12, v13, s[52:53]
  v_cndmask_b32_dpp v12, v52, v53, vcc quad_perm:[0,1,2,3] row_mask:0xf bank_mask:0x1
  v_cndmask_b32_dpp v13, v54, v55, vcc quad_perm:[0,1,2,3] row_mask:0xf bank_mask:0x1
  v_cndmask_b32_dpp v12, v56, v57, vcc quad_perm:[0,1,2,3] row_mask:0xf bank_mask:0x4
  v_cndmask_b32_dpp v13, v58, v59, vcc quad_perm:[0,1,2,3] row_mask:0xf bank_mask:0x4
  v_cndmask_b32_dpp v12, v60, v61, vcc quad_perm:[0,1,2,3] row_mask:0xf bank_mask:0x2
  v_cndmask_b32_dpp v13, v62, v63, vcc quad_perm:[0,1,2,3] row_mask:0xf bank_mask:0x2
  v_cndmask_b32_dpp v12, v64, v65, vcc quad_perm:[0,1,2,3] row_mask:0xf bank_mask:0x8
  v_cndmask_b32_dpp v13, v66, v67, vcc quad_perm:[0,1,2,3] row_mask:0xf bank_mask:0x8
  v_cndmask_b32 v17, v12, v13, s[52:53]
  s_mov_b32 s39, 3
  s_mov_b32 s57, 17
L_wr:
  s_setpc_b64 s[100:101]
L_w2b:
  s_add_u32 s68, s41, 16
  s_cmp_lt_u32 s32, s68
  s_cbranch_scc1 L_wr
  s_mov_b64 vcc, s[54:55]
  v_mfma_f32_16x16x32_bf16 v[8:11], v[72:75], v[4:7], 0
  v_mfma_f32_16x16x32_bf16 v[72:75], v[76:79], v[4:7], 0
  v_mfma_f32_16x16x32_bf16 v[76:79], v[80:83], v[4:7], 0
  v_mfma_f32_16x16x32_bf16 v[80:83], v[84:87], v[4:7], 0
  v_mfma_f32_16x16x32_bf16 v[84:87], v[88:91], v[4:7], 0
  v_mfma_f32_16x16x32_bf16 v[88:91], v[92:95], v[4:7], 0
  v_mfma_f32_16x16x32_bf16 v[92:95], v[96:99], v[4:7], 0
  v_mfma_f32_16x16x32_bf16 v[96:99], v[100:103], v[4:7], 0
  s_nop 0
  v_cndmask_b32_dpp v12, v8, v9, vcc quad_perm:[0,1,2,3] row_mask:0xf bank_mask:0x1
  v_cndmask_b32_dpp v13, v10, v11, vcc quad_perm:[0,1,2,3] row_mask:0xf bank_mask:0x1
  v_cndmask_b32_dpp v12, v72, v73, vcc quad_perm:[0,1,2,3] row_mask:0xf bank_mask:0x4
  v_cndmask_b32_dpp v13, v74, v75, vcc quad_perm:[0,1,2,3] row_mask:0xf bank_mask:0x4
  v_cndmask_b32_dpp v12, v76, v77, vcc quad_perm:[0,1,2,3] row_mask:0xf bank_mask:0x2
  v_cndmask_b32_dpp v13, v78, v79, vcc quad_perm:[0,1,2,3] row_mask:0xf bank_mask:0x2
  v_cndmask_b32_dpp v12, v80, v81, vcc quad_perm:[0,1,2,3] row_mask:0xf bank_mask:0x8
  v_cndmask_b32_dpp v13, v82, v83, vcc quad_perm:[0,1,2,3] row_mask:0xf bank_mask:0x8
  v_cndmask_b32 v18, v12, v13, s[52:53]
  v_cndmask_b32_dpp v12, v84, v85, vcc quad_perm:[0,1,2,3] row_mask:0xf bank_mask:0x1
  v_cndmask_b32_dpp v13, v86, v87, vcc quad_perm:[0,1,2,3] row_mask:0xf bank_mask:0x1
  v_cndmask_b32_dpp v12, v88, v89, vcc quad_perm:[0,1,2,3] row_mask:0xf bank_mask:0x4
  v_cndmask_b32_dpp v13, v90, v91, vcc quad_perm:[0,1,2,3] row_mask:0xf bank_mask:0x4
  v_cndmask_b32_dpp v12, v92, v93, vcc quad_perm:[0,1,2,3] row_mask:0xf bank_mask:0x2
  v_cndmask_b32_dpp v13, v94, v95, vcc quad_perm:[0,1,2,3] row_mask:0xf bank_mask:0x2
  v_cndmask_b32_dpp v12, v96, v97, vcc quad_perm:[0,1,2,3] row_mask:0xf bank_mask:0x8
  v_cndmask_b32_dpp v13, v98, v99, vcc quad_perm:[0,1,2,3] row_mask:0xf bank_mask:0x8
  v_cndmask_b32 v19, v12, v13, s[52:53]
  v_mov_b32 v3, 0
  v_mov_b32 v20, 64
  v_add_f32_dpp v16, v16, v16 quad_perm:[2,3,0,1] row_mask:0xf bank_mask:0xf
  v_add_f32_dpp v17, v17, v17 quad_perm:[2,3,0,1] row_mask:0xf bank_mask:0xf
  v_add_f32_dpp v18, v18, v18 quad_perm:[2,3,0,1] row_mask:0xf bank_mask:0xf
  v_add_f32_dpp v19, v19, v19 quad_perm:[2,3,0,1] row_mask:0xf bank_mask:0xf
  v_cndmask_b32 v8, v16, v17, s[52:53]
  v_cndmask_b32 v9, v18, v19, s[52:53]
  s_nop 0
  v_lshlrev_b32 v21, 3, s9
  v_add_f32_dpp v8, v8, v8 quad_perm:[1,0,3,2] row_mask:0xf bank_mask:0xf
  v_add_f32_dpp v9, v9, v9 quad_perm:[1,0,3,2] row_mask:0xf bank_mask:0xf
  v_cndmask_b32 v25, v8, v9, s[54:55]
  v_cvt_pk_bf16_f32 v25, 0, v25
  v_mul_f32 v25, 0x3db504f3, v25
  v_cvt_pk_bf16_f32 v25, 0, v25
  v_cmp_gt_u32 vcc, s46, v24
  v_mov_b32 v37, 0xff800000
  s_nop 0
  v_cndmask_b32 v25, v37, v25, vcc
  v_mov_b32 v37, v25
  s_nop 1
  v_max_f32_dpp v37, v37, v37 row_ror:8 row_mask:0xf bank_mask:0xf
  s_nop 1
  v_max_f32_dpp v37, v37, v37 row_ror:4 row_mask:0xf bank_mask:0xf
  s_nop 1
  v_max_f32_dpp v37, v37, v37 row_ror:2 row_mask:0xf bank_mask:0xf
  s_nop 1
  v_max_f32_dpp v37, v37, v37 row_ror:1 row_mask:0xf bank_mask:0xf
  v_mov_b32 v8, v37
  s_nop 1
  v_permlane16_swap_b32 v8, v37
  v_max_f32 v37, v37, v8
  v_mov_b32 v8, v37
  s_nop 1
  v_permlane32_swap_b32 v8, v37
  v_max_f32 v37, v37, v8
  s_mov_b64 exec, 1
  ds_max_f32 v3, v37 offset:284
  ds_add_u32 v3, v20 offset:280
  s_mov_b64 exec, -1
  s_mov_b32 s39, 4
  s_mov_b32 s19, 0
  s_setpc_b64 s[100:101]
L_w5:
  s_add_u32 s68, s41, 24
  s_cmp_lt_u32 s32, s68
  s_cbranch_scc1 L_wr
  s_mov_b64 vcc, s[54:55]
  v_mfma_f32_16x16x32_bf16 v[8:11], v[104:107], v[4:7], 0
  v_mfma_f32_16x16x32_bf16 v[104:107], v[108:111], v[4:7], 0
  v_mfma_f32_16x16x32_bf16 v[108:111], v[112:115], v[4:7], 0
  v_mfma_f32_16x16x32_bf16 v[112:115], v[116:119], v[4:7], 0
  v_mfma_f32_16x16x32_bf16 v[116:119], v[120:123], v[4:7], 0
  v_mfma_f32_16x16x32_bf16 v[120:123], v[124:127], v[4:7], 0
  v_mfma_f32_16x16x32_bf16 v[124:127], v[128:131], v[4:7], 0
  v_mfma_f32_16x16x32_bf16 v[128:131], v[132:135], v[4:7], 0
  s_nop 0
  v_cndmask_b32_dpp v12, v8, v9, vcc quad_perm:[0,1,2,3] row_mask:0xf bank_mask:0x1
  v_cndmask_b32_dpp v13, v10, v11, vcc quad_perm:[0,1,2,3] row_mask:0xf bank_mask:0x1
  v_cndmask_b32_dpp v12, v104, v105, vcc quad_perm:[0,1,2,3] row_mask:0xf bank_mask:0x4
  v_cndmask_b32_dpp v13, v106, v107, vcc quad_perm:[0,1,2,3] row_mask:0xf bank_mask:0x4
  v_cndmask_b32_dpp v12, v108, v109, vcc quad_perm:[0,1,2,3] row_mask:0xf bank_mask:0x2
  v_cndmask_b32_dpp v13, v110, v111, vcc quad_perm:[0,1,2,3] row_mask:0xf bank_mask:0x2
  v_cndmask_b32_dpp v12, v112, v113, vcc quad_perm:[0,1,2,3] row_mask:0xf bank_mask:0x8
  v_cndmask_b32_dpp v13, v114, v115, vcc quad_perm:[0,1,2,3] row_mask:0xf bank_mask:0x8
  v_cndmask_b32 v16, v12, v13, s[52:53]
  v_cndmask_b32_dpp v12, v116, v117, vcc quad_perm:[0,1,2,3] row_mask:0xf bank_mask:0x1
  v_cndmask_b32_dpp v13, v118, v119, vcc quad_perm:[0,1,2,3] row_mask:0xf bank_mask:0x1
  v_cndmask_b32_dpp v12, v120, v121, vcc quad_perm:[0,1,2,3] row_mask:0xf bank_mask:0x4
  v_cndmask_b32_dpp v13, v122, v123, vcc quad_perm:[0,1,2,3] row_mask:0xf bank_mask:0x4
  v_cndmask_b32_dpp v12, v124, v125, vcc quad_perm:[0,1,2,3] row_mask:0xf bank_mask:0x2
  v_cndmask_b32_dpp v13, v126, v127, vcc quad_perm:[0,1,2,3] row_mask:0xf bank_mask:0x2
  v_cndmask_b32_dpp v12, v128, v129, vcc quad_perm:[0,1,2,3] row_mask:0xf bank_mask:0x8
  v_cndmask_b32_dpp v13, v130, v131, vcc quad_perm:[0,1,2,3] row_mask:0xf bank_mask:0x8
  v_cndmask_b32 v17, v12, v13, s[52:53]
  s_mov_b32 s39, 6
  s_mov_b32 s57, 99
  s_setpc_b64 s[100:101]
L_w3:
  v_mov_b32 v3, 0
  ds_read_b64 v[18:19], v3 offset:280
  s_waitcnt lgkmcnt(0)
  v_cmp_gt_u32 vcc, 0x102c0, v18
  s_cmp_lg_u64 vcc, 0
  s_cbranch_scc1 L_wr
  ds_read_b64 v[20:21], v3 offset:320
  s_waitcnt lgkmcnt(0)
  v_add_f32 v21, 0xc1c00000, v21
  v_cmp_nlt_f32 vcc, v25, v21
  v_readfirstlane_b32 s22, v21
  v_readfirstlane_b32 s23, v20
  s_mov_b32 s20, 0
  s_bcnt1_i32_b64 s68, vcc
  s_cmp_gt_u32 s68, 32
  s_cselect_b32 s21, 1, 0
  s_cbranch_scc1 L_w4
  s_mov_b32 s38, 160
  v_cmp_nlt_f32 vcc, v25, v21
  s_lshl_b32 s68, s38, 3
  s_add_u32 s68, s68, s56
  s_andn2_b64 s[70:71], vcc, s[64:65]
  v_mbcnt_lo_u32_b32 v3, s70, 0
  v_mbcnt_hi_u32_b32 v3, s71, v3
  s_bcnt1_i32_b64 s69, s[70:71]
  v_lshl_add_u32 v3, v3, 3, s68
  s_mov_b64 exec, s[70:71]
  ds_write_b64 v3, v[24:25]
  s_mov_b64 exec, -1
  s_or_b64 s[64:65], s[64:65], s[70:71]
  s_add_u32 s38, s38, s69
  s_mov_b32 s20, s69
  s_mov_b32 s38, 0
L_w4:
  v_add_f32 v21, 0xc2a5e666, v20
  v_cmp_nlt_f32 vcc, v25, v21
  s_lshl_b32 s68, s38, 3
  s_add_u32 s68, s68, s56
  s_andn2_b64 s[70:71], vcc, s[64:65]
  v_mbcnt_lo_u32_b32 v3, s70, 0
  v_mbcnt_hi_u32_b32 v3, s71, v3
  s_bcnt1_i32_b64 s69, s[70:71]
  v_lshl_add_u32 v3, v3, 3, s68
  s_mov_b64 exec, s[70:71]
  ds_write_b64 v3, v[24:25]
  s_mov_b64 exec, -1
  s_or_b64 s[64:65], s[64:65], s[70:71]
  s_add_u32 s38, s38, s69
  s_add_u32 s68, s38, 6
  s_lshr_b32 s68, s68, 1
  s_sub_u32 s69, s68, s59
  s_mov_b32 s59, s68
  v_mov_b32 v3, s69
  s_mov_b64 exec, 1
  ds_add_u32 v1, v3 offset:296
  ds_add_u32 v1, v3 offset:300
  s_mov_b64 exec, -1
  s_sub_i32 s68, s59, 20
  s_max_i32 s68, s68, -4
  s_mul_i32 s68, s68, 245
  s_add_i32 s34, s34, s68
  s_mov_b32 s39, 5
  s_mov_b32 s57, 25
  ds_read_b64 v[28:29], v39 offset:0
  s_waitcnt lgkmcnt(0)
  s_setpc_b64 s[100:101]
L_pub:
  s_getpc_b64 s[56:57]
L_pct:
  s_lshr_b32 s3, s2, 3
  s_lshl_b32 s3, s3, 2
  s_add_u32 s3, s3, L_touch-L_pct
  s_load_dword s14, s[56:57], s3
  s_waitcnt lgkmcnt(0)
  s_bfe_u32 s48, s14, 0x30000
  s_lshl_b32 s48, s48, 6
  v_add_u32 v2, s48, v1
  s_bfe_u32 s48, s14, 0x30003
  s_bitcmp1_b32 s14, 7
  s_cbranch_scc1 L_te_4
  s_bitcmp1_b32 s14, 6
  s_cbranch_scc1 L_tq_3
  s_lshl1_add_u32 s48, s8, s48
  s_lshl_b32 s48, s48, 7
  v_mul_u32_u24 v2, 6144, v2
  v_add_u32 v2, s48, v2
  global_load_dword v167, v2, s[36:37]
  s_branch L_te_4
L_tq_3:
  s_lshl3_add_u32 s48, s8, s48
  s_lshl_b32 s48, s48, 7
  v_lshl_add_u32 v2, v2, 13, s48
  global_load_dword v167, v2, s[22:23]
L_te_4:
  s_bfe_u32 s48, s14, 0x30008
  s_lshl_b32 s48, s48, 6
  v_add_u32 v2, s48, v1
  s_bfe_u32 s48, s14, 0x3000b
  s_bitcmp1_b32 s14, 15
  s_cbranch_scc1 L_te_6
  s_bitcmp1_b32 s14, 14
  s_cbranch_scc1 L_tq_5
  s_lshl1_add_u32 s48, s8, s48
  s_lshl_b32 s48, s48, 7
  v_mul_u32_u24 v2, 6144, v2
  v_add_u32 v2, s48, v2
  global_load_dword v167, v2, s[36:37]
  s_branch L_te_6
L_tq_5:
  s_lshl3_add_u32 s48, s8, s48
  s_lshl_b32 s48, s48, 7
  v_lshl_add_u32 v2, v2, 13, s48
  global_load_dword v167, v2, s[22:23]
L_te_6:
  v_mov_b32 v38, 0
  v_mov_b32 v4, -1
  v_mov_b32 v8, 0xff800000
  v_mov_b32 v9, 0
  v_lshlrev_b32 v2, 3, v1
  ds_write_b64 v2, v[8:9] offset:448
  v_mov_b32 v5, 0
  v_mov_b32 v6, 0
  v_mov_b32 v7, 0
  v_lshlrev_b32 v2, 2, v1
  ds_write_b32 v2, v4 offset:0
  ds_write_b128 v38, v[4:7] offset:256
  v_mov_b32 v10, 0
  v_mov_b32 v11, v8
  v_mov_b32 v12, 0
  v_mov_b32 v13, v8
  ds_write_b128 v38, v[10:13] offset:272
  v_mov_b32 v10, 1332
  v_mov_b32 v11, 0
  v_mov_b32 v12, 1024
  v_mov_b32 v13, 0
  ds_write_b128 v38, v[10:13] offset:288
  v_mov_b32 v4, 0
  ds_write_b128 v38, v[4:7] offset:304
  s_getreg_b32 s76, hwreg(HW_REG_XCC_ID, 0, 4)
  s_waitcnt lgkmcnt(0)
  s_load_dword s74, s[42:43], 0
  s_barrier
  s_waitcnt lgkmcnt(0)
  s_mul_i32 s74, s74, 0x9e3779b1
  s_add_u32 s74, s74, 0x7f4a7c15
  s_add_u32 s76, s76, s74
  s_lshl2_add_u32 s64, s6, s7
  s_lshl_b32 s64, s64, 7
  s_add_u32 s64, s64, 65536
  v_mov_b32 v18, s64
  v_add_u32 v19, 32768, v18
  v_mov_b32 v17, 0x10000
  s_lshl2_add_u32 s49, s6, s7
  s_lshl_b32 s49, s49, 9
  s_add_u32 s49, s49, 131072
  v_and_b32 v10, 3, v1
  v_lshl_add_u32 v10, v10, 7, s49
  v_bfe_u32 v11, v1, 2, 1
  v_mul_u32_u24 v11, 393216, v11
  v_add_u32 v10, v10, v11
  s_mov_b64 exec, 0xff
  global_load_dword v166, v10, s[42:43] sc1
  s_mov_b64 exec, 1
  global_load_dword v166, v18, s[42:43] sc1
  global_load_dword v166, v19, s[42:43] sc1
  s_mov_b64 exec, -1
  s_mov_b32 s70, 0
L_qw_7:
  ds_read_b32 v8, v38 offset:288
  s_waitcnt lgkmcnt(0)
  v_cmp_lt_u32 vcc, 1233, v8
  s_cmp_eq_u64 vcc, 0
  s_cbranch_scc1 L_qw_7d
  s_sleep 4
  s_add_u32 s70, s70, 1
  s_cmp_lt_u32 s70, 2097152
  s_cbranch_scc1 L_qw_7
L_qw_7d:
  s_lshl_b32 s3, s6, 9
  s_mov_b64 exec, 1
  s_mov_b32 s70, 0
L_qp0:
  s_load_dwordx16 s[8:23], s[42:43], s3 offset:32768 glc
  s_load_dwordx16 s[24:39], s[42:43], s3 offset:32832 glc
  s_load_dwordx16 s[44:59], s[42:43], s3 offset:32896 glc
  s_load_dwordx16 s[84:99], s[42:43], s3 offset:32960 glc
  s_mov_b32 s62, -1
  s_mov_b32 s63, 0
  s_waitcnt lgkmcnt(0)
  s_and_b32 s62, s62, s9
  s_or_b32 s63, s63, s9
  s_and_b32 s62, s62, s11
  s_or_b32 s63, s63, s11
  s_and_b32 s62, s62, s13
  s_or_b32 s63, s63, s13
  s_and_b32 s62, s62, s15
  s_or_b32 s63, s63, s15
  s_and_b32 s62, s62, s17
  s_or_b32 s63, s63, s17
  s_and_b32 s62, s62, s19
  s_or_b32 s63, s63, s19
  s_and_b32 s62, s62, s21
  s_or_b32 s63, s63, s21
  s_and_b32 s62, s62, s23
  s_or_b32 s63, s63, s23
  s_and_b32 s62, s62, s25
  s_or_b32 s63, s63, s25
  s_and_b32 s62, s62, s27
  s_or_b32 s63, s63, s27
  s_and_b32 s62, s62, s29
  s_or_b32 s63, s63, s29
  s_and_b32 s62, s62, s31
  s_or_b32 s63, s63, s31
  s_and_b32 s62, s62, s33
  s_or_b32 s63, s63, s33
  s_and_b32 s62, s62, s35
  s_or_b32 s63, s63, s35
  s_and_b32 s62, s62, s37
  s_or_b32 s63, s63, s37
  s_and_b32 s62, s62, s39
  s_or_b32 s63, s63, s39
  s_and_b32 s62, s62, s45
  s_or_b32 s63, s63, s45
  s_and_b32 s62, s62, s47
  s_or_b32 s63, s63, s47
  s_and_b32 s62, s62, s49
  s_or_b32 s63, s63, s49
  s_and_b32 s62, s62, s51
  s_or_b32 s63, s63, s51
  s_and_b32 s62, s62, s53
  s_or_b32 s63, s63, s53
  s_and_b32 s62, s62, s55
  s_or_b32 s63, s63, s55
  s_and_b32 s62, s62, s57
  s_or_b32 s63, s63, s57
  s_and_b32 s62, s62, s59
  s_or_b32 s63, s63, s59
  s_and_b32 s62, s62, s85
  s_or_b32 s63, s63, s85
  s_and_b32 s62, s62, s87
  s_or_b32 s63, s63, s87
  s_and_b32 s62, s62, s89
  s_or_b32 s63, s63, s89
  s_and_b32 s62, s62, s91
  s_or_b32 s63, s63, s91
  s_and_b32 s62, s62, s93
  s_or_b32 s63, s63, s93
  s_and_b32 s62, s62, s95
  s_or_b32 s63, s63, s95
  s_and_b32 s62, s62, s97
  s_or_b32 s63, s63, s97
  s_and_b32 s62, s62, s99
  s_or_b32 s63, s63, s99
  s_xor_b32 s62, s62, s74
  s_xor_b32 s63, s63, s74
  s_or_b32 s62, s62, s63
  s_cbranch_scc0 L_qp0d
  s_sleep 2
  s_add_u32 s70, s70, 1
  s_cmp_lt_u32 s70, 262144
  s_cbranch_scc1 L_qp0
L_qp0d:
  v_mov_b32 v40, s8
  v_mov_b32 v41, s10
  v_mov_b32 v42, s12
  v_mov_b32 v43, s14
  v_mov_b32 v44, s16
  v_mov_b32 v45, s18
  v_mov_b32 v46, s20
  v_mov_b32 v47, s22
  v_mov_b32 v48, s24
  v_mov_b32 v49, s26
  v_mov_b32 v50, s28
  v_mov_b32 v51, s30
  v_mov_b32 v52, s32
  v_mov_b32 v53, s34
  v_mov_b32 v54, s36
  v_mov_b32 v55, s38
  v_mov_b32 v56, s44
  v_mov_b32 v57, s46
  v_mov_b32 v58, s48
  v_mov_b32 v59, s50
  v_mov_b32 v60, s52
  v_mov_b32 v61, s54
  v_mov_b32 v62, s56
  v_mov_b32 v63, s58
  v_mov_b32 v64, s84
  v_mov_b32 v65, s86
  v_mov_b32 v66, s88
  v_mov_b32 v67, s90
  v_mov_b32 v68, s92
  v_mov_b32 v69, s94
  v_mov_b32 v70, s96
  v_mov_b32 v71, s98
  s_mov_b32 s70, 0
L_qp1:
  s_load_dwordx16 s[8:23], s[42:43], s3 offset:33024 glc
  s_load_dwordx16 s[24:39], s[42:43], s3 offset:33088 glc
  s_load_dwordx16 s[44:59], s[42:43], s3 offset:33152 glc
  s_load_dwordx16 s[84:99], s[42:43], s3 offset:33216 glc
  s_mov_b32 s62, -1
  s_mov_b32 s63, 0
  s_waitcnt lgkmcnt(0)
  s_and_b32 s62, s62, s9
  s_or_b32 s63, s63, s9
  s_and_b32 s62, s62, s11
  s_or_b32 s63, s63, s11
  s_and_b32 s62, s62, s13
  s_or_b32 s63, s63, s13
  s_and_b32 s62, s62, s15
  s_or_b32 s63, s63, s15
  s_and_b32 s62, s62, s17
  s_or_b32 s63, s63, s17
  s_and_b32 s62, s62, s19
  s_or_b32 s63, s63, s19
  s_and_b32 s62, s62, s21
  s_or_b32 s63, s63, s21
  s_and_b32 s62, s62, s23
  s_or_b32 s63, s63, s23
  s_and_b32 s62, s62, s25
  s_or_b32 s63, s63, s25
  s_and_b32 s62, s62, s27
  s_or_b32 s63, s63, s27
  s_and_b32 s62, s62, s29
  s_or_b32 s63, s63, s29
  s_and_b32 s62, s62, s31
  s_or_b32 s63, s63, s31
  s_and_b32 s62, s62, s33
  s_or_b32 s63, s63, s33
  s_and_b32 s62, s62, s35
  s_or_b32 s63, s63, s35
  s_and_b32 s62, s62, s37
  s_or_b32 s63, s63, s37
  s_and_b32 s62, s62, s39
  s_or_b32 s63, s63, s39
  s_and_b32 s62, s62, s45
  s_or_b32 s63, s63, s45
  s_and_b32 s62, s62, s47
  s_or_b32 s63, s63, s47
  s_and_b32 s62, s62, s49
  s_or_b32 s63, s63, s49
  s_and_b32 s62, s62, s51
  s_or_b32 s63, s63, s51
  s_and_b32 s62, s62, s53
  s_or_b32 s63, s63, s53
  s_and_b32 s62, s62, s55
  s_or_b32 s63, s63, s55
  s_and_b32 s62, s62, s57
  s_or_b32 s63, s63, s57
  s_and_b32 s62, s62, s59
  s_or_b32 s63, s63, s59
  s_and_b32 s62, s62, s85
  s_or_b32 s63, s63, s85
  s_and_b32 s62, s62, s87
  s_or_b32 s63, s63, s87
  s_and_b32 s62, s62, s89
  s_or_b32 s63, s63, s89
  s_and_b32 s62, s62, s91
  s_or_b32 s63, s63, s91
  s_and_b32 s62, s62, s93
  s_or_b32 s63, s63, s93
  s_and_b32 s62, s62, s95
  s_or_b32 s63, s63, s95
  s_and_b32 s62, s62, s97
  s_or_b32 s63, s63, s97
  s_and_b32 s62, s62, s99
  s_or_b32 s63, s63, s99
  s_xor_b32 s62, s62, s74
  s_xor_b32 s63, s63, s74
  s_or_b32 s62, s62, s63
  s_cbranch_scc0 L_qp1d
  s_sleep 2
  s_add_u32 s70, s70, 1
  s_cmp_lt_u32 s70, 262144
  s_cbranch_scc1 L_qp1
L_qp1d:
  v_mov_b32 v72, s8
  v_mov_b32 v73, s10
  v_mov_b32 v74, s12
  v_mov_b32 v75, s14
  v_mov_b32 v76, s16
  v_mov_b32 v77, s18
  v_mov_b32 v78, s20
  v_mov_b32 v79, s22
  v_mov_b32 v80, s24
  v_mov_b32 v81, s26
  v_mov_b32 v82, s28
  v_mov_b32 v83, s30
  v_mov_b32 v84, s32
  v_mov_b32 v85, s34
  v_mov_b32 v86, s36
  v_mov_b32 v87, s38
  v_mov_b32 v88, s44
  v_mov_b32 v89, s46
  v_mov_b32 v90, s48
  v_mov_b32 v91, s50
  v_mov_b32 v92, s52
  v_mov_b32 v93, s54
  v_mov_b32 v94, s56
  v_mov_b32 v95, s58
  v_mov_b32 v96, s84
  v_mov_b32 v97, s86
  v_mov_b32 v98, s88
  v_mov_b32 v99, s90
  v_mov_b32 v100, s92
  v_mov_b32 v101, s94
  v_mov_b32 v102, s96
  v_mov_b32 v103, s98
  ds_write_b128 v38, v[40:43] offset:0
  ds_write_b128 v38, v[44:47] offset:16
  ds_write_b128 v38, v[48:51] offset:32
  ds_write_b128 v38, v[52:55] offset:48
  ds_write_b128 v38, v[56:59] offset:64
  ds_write_b128 v38, v[60:63] offset:80
  ds_write_b128 v38, v[64:67] offset:96
  ds_write_b128 v38, v[68:71] offset:112
  ds_write_b128 v38, v[72:75] offset:128
  ds_write_b128 v38, v[76:79] offset:144
  ds_write_b128 v38, v[80:83] offset:160
  ds_write_b128 v38, v[84:87] offset:176
  ds_write_b128 v38, v[88:91] offset:192
  ds_write_b128 v38, v[92:95] offset:208
  ds_write_b128 v38, v[96:99] offset:224
  ds_write_b128 v38, v[100:103] offset:240
  s_mov_b64 exec, -1
  s_and_b32 s8, s2, 7
  s_mov_b32 s13, 0
  s_add_u32 s52, s7, 1
  s_cmp_eq_u32 s52, 3
  s_cselect_b32 s52, 0, s52
  s_add_u32 s53, s52, s7
  s_sub_u32 s53, 3, s53
  s_lshl2_add_u32 s54, s6, s52
  s_lshl_b32 s54, s54, 7
  s_lshl2_add_u32 s55, s6, s53
  s_lshl_b32 s55, s55, 7
  s_mov_b32 s70, 0
L_sn_8:
  ds_read_b64 v[8:9], v38 offset:280
  s_waitcnt lgkmcnt(0)
  v_cmp_gt_u32 vcc, 0x2c0, v8
  s_cmp_eq_u64 vcc, 0
  s_cbranch_scc1 L_snd_9
  s_sleep 2
  s_add_u32 s70, s70, 1
  s_cmp_lt_u32 s70, 2097152
  s_cbranch_scc1 L_sn_8
L_snd_9:
  s_load_dwordx2 s[20:21], s[42:43], s54 offset:65536 glc
  s_load_dwordx2 s[24:25], s[42:43], s55 offset:65536 glc
  v_mov_b32 v8, v9
  v_mov_b32 v9, s74
  s_mov_b64 exec, 1
  global_store_dwordx2 v18, v[8:9], s[42:43] sc1
  s_mov_b32 s70, 0
  s_branch L_s3ec
L_s3e:
  s_load_dwordx2 s[20:21], s[42:43], s54 offset:65536 glc
  s_load_dwordx2 s[24:25], s[42:43], s55 offset:65536 glc
L_s3ec:
  s_waitcnt lgkmcnt(0)
  s_xor_b32 s68, s21, s74
  s_xor_b32 s69, s25, s74
  s_or_b32 s68, s68, s69
  s_cbranch_scc0 L_s3ed
  s_sleep 2
  s_add_u32 s70, s70, 1
  s_cmp_lt_u32 s70, 262144
  s_cbranch_scc1 L_s3e
L_s3ed:
  v_mov_b32 v12, s20
  v_max3_f32 v10, v8, v12, s24
  v_min3_f32 v11, v8, v12, s24
  ds_write_b64 v38, v[10:11] offset:320
  ds_add_u32 v38, v17 offset:280
  s_mov_b64 exec, -1
  s_lshl_b32 s64, s8, 7
  s_load_dwordx8 s[20:27], s[42:43], s64 offset:1024 glc
  s_waitcnt lgkmcnt(0)
  s_xor_b32 s68, s20, s76
  s_xor_b32 s69, s21, s76
  s_or_b32 s68, s68, s69
  s_xor_b32 s69, s22, s76
  s_or_b32 s68, s68, s69
  s_xor_b32 s69, s23, s76
  s_or_b32 s68, s68, s69
  s_xor_b32 s69, s24, s76
  s_or_b32 s68, s68, s69
  s_xor_b32 s69, s25, s76
  s_or_b32 s68, s68, s69
  s_xor_b32 s69, s26, s76
  s_or_b32 s68, s68, s69
  s_xor_b32 s69, s27, s76
  s_or_b32 s68, s68, s69
  s_cselect_b32 s75, 0, 1
  v_lshlrev_b32 v20, 3, s7
  v_lshlrev_b32 v21, 3, s52
  v_lshlrev_b32 v22, 3, s53
  v_and_b32 v9, 15, v1
  v_lshlrev_b32 v9, 3, v9
  v_lshlrev_b32 v11, 2, v1
  s_mov_b32 s70, 0
L_sn_10:
  ds_read_b32 v8, v38 offset:272
  s_waitcnt lgkmcnt(0)
  v_cmp_gt_u32 vcc, 0x280, v8
  s_cmp_eq_u64 vcc, 0
  s_cbranch_scc1 L_snd_11
  s_sleep 1
  s_add_u32 s70, s70, 1
  s_cmp_lt_u32 s70, 2097152
  s_cbranch_scc1 L_sn_10
L_snd_11:
  s_mov_b32 s70, 0
L_wt_12:
  ds_read_b32 v8, v38 offset:272
  ds_read_b32 v16, v9 offset:512
  ds_read_b32 v40, v11 offset:1024
  ds_read_b32 v41, v11 offset:1536
  ds_read_b32 v42, v11 offset:2048
  ds_read_b32 v43, v11 offset:2560
  ds_read_b32 v44, v11 offset:3072
  ds_read_b32 v45, v11 offset:3584
  ds_read_b32 v46, v11 offset:4096
  ds_read_b32 v47, v11 offset:4608
  ds_read_b32 v48, v11 offset:5120
  ds_read_b32 v49, v11 offset:5632
  ds_read_b32 v50, v11 offset:6144
  s_waitcnt lgkmcnt(12)
  v_cmp_gt_u32 vcc, 0x2c0, v8
  s_cmp_eq_u64 vcc, 0
  s_cbranch_scc1 L_wtd_13
  s_waitcnt lgkmcnt(0)
  s_add_u32 s70, s70, 1
  s_cmp_lt_u32 s70, 2097152
  s_cbranch_scc1 L_wt_12
L_wtd_13:
  s_waitcnt lgkmcnt(11)
  v_max_f32_dpp v8, v16, v16 quad_perm:[1,0,3,2] row_mask:0xf bank_mask:0xf
  s_nop 1
  v_max_f32_dpp v8, v8, v8 quad_perm:[2,3,0,1] row_mask:0xf bank_mask:0xf
  s_nop 1
  v_max_f32_dpp v8, v8, v8 row_half_mirror row_mask:0xf bank_mask:0xf
  s_nop 1
  v_max_f32_dpp v8, v8, v8 row_mirror row_mask:0xf bank_mask:0xf
  v_sub_f32 v9, v16, v8
  v_mul_f32 v9, 0x3fb8aa3b, v9
  v_exp_f32 v9, v9
  s_waitcnt lgkmcnt(0)
  s_nop 0
  v_mul_f32_dpp v10, v9, v40 row_newbcast:0 row_mask:0xf bank_mask:0xf
  v_mul_f32_dpp v12, v9, v41 row_newbcast:1 row_mask:0xf bank_mask:0xf
  v_fmac_f32_dpp v10, v9, v42 row_newbcast:2 row_mask:0xf bank_mask:0xf
  v_fmac_f32_dpp v12, v9, v43 row_newbcast:3 row_mask:0xf bank_mask:0xf
  v_fmac_f32_dpp v10, v9, v44 row_newbcast:4 row_mask:0xf bank_mask:0xf
  v_fmac_f32_dpp v12, v9, v45 row_newbcast:5 row_mask:0xf bank_mask:0xf
  v_fmac_f32_dpp v10, v9, v46 row_newbcast:6 row_mask:0xf bank_mask:0xf
  v_fmac_f32_dpp v12, v9, v47 row_newbcast:7 row_mask:0xf bank_mask:0xf
  v_fmac_f32_dpp v10, v9, v48 row_newbcast:8 row_mask:0xf bank_mask:0xf
  v_fmac_f32_dpp v12, v9, v49 row_newbcast:9 row_mask:0xf bank_mask:0xf
  v_fmac_f32_dpp v10, v9, v50 row_newbcast:10 row_mask:0xf bank_mask:0xf
  v_add_f32 v10, v10, v12
  s_nop 1
  v_add_f32_dpp v10, v10, v10 row_ror:8 row_mask:0xf bank_mask:0xf
  s_nop 1
  v_add_f32_dpp v10, v10, v10 row_ror:4 row_mask:0xf bank_mask:0xf
  s_nop 1
  v_add_f32_dpp v10, v10, v10 row_ror:2 row_mask:0xf bank_mask:0xf
  s_nop 1
  v_add_f32_dpp v10, v10, v10 row_ror:1 row_mask:0xf bank_mask:0xf
  v_mov_b32 v12, v10
  s_nop 1
  v_permlane16_swap_b32 v12, v10
  v_add_f32 v10, v10, v12
  v_mov_b32 v12, v10
  s_nop 1
  v_permlane32_swap_b32 v12, v10
  v_add_f32 v10, v10, v12
  s_load_dwordx4 s[20:23], s[42:43], s54 offset:98304 glc
  s_load_dwordx4 s[24:27], s[42:43], s55 offset:98304 glc
  v_mov_b32 v9, s74
  v_mov_b32 v11, s74
  s_mov_b64 exec, 1
  global_store_dwordx4 v19, v[8:11], s[42:43] sc1
  ds_write_b32 v20, v8 offset:448
  ds_write_b32 v20, v10 offset:452
  s_mov_b32 s70, 0
  s_branch L_s3pc
L_s3p:
  s_load_dwordx4 s[20:23], s[42:43], s54 offset:98304 glc
  s_load_dwordx4 s[24:27], s[42:43], s55 offset:98304 glc
L_s3pc:
  s_waitcnt lgkmcnt(0)
  s_xor_b32 s68, s21, s74
  s_xor_b32 s69, s23, s74
  s_or_b32 s68, s68, s69
  s_xor_b32 s69, s25, s74
  s_or_b32 s68, s68, s69
  s_xor_b32 s69, s27, s74
  s_or_b32 s68, s68, s69
  s_cbranch_scc0 L_s3pd
  s_sleep 2
  s_add_u32 s70, s70, 1
  s_cmp_lt_u32 s70, 262144
  s_cbranch_scc1 L_s3p
L_s3pd:
  v_mov_b32 v12, s20
  v_mov_b32 v13, s22
  v_mov_b32 v14, s24
  v_mov_b32 v15, s26
  ds_write_b64 v21, v[12:13] offset:448
  ds_write_b64 v22, v[14:15] offset:448
  s_mov_b64 exec, -1
  v_and_b32 v9, 3, v1
  v_lshlrev_b32 v9, 3, v9
  ds_read_b64 v[10:11], v9 offset:448
  s_waitcnt lgkmcnt(0)
  v_max_f32_dpp v8, v10, v10 quad_perm:[1,0,3,2] row_mask:0xf bank_mask:0xf
  s_nop 1
  v_max_f32_dpp v8, v8, v8 quad_perm:[2,3,0,1] row_mask:0xf bank_mask:0xf
  v_sub_f32 v9, v10, v8
  v_mul_f32 v9, 0x3fb8aa3b, v9
  v_exp_f32 v9, v9
  s_nop 0
  v_mul_f32 v10, v9, v11
  s_nop 1
  v_add_f32_dpp v10, v10, v10 quad_perm:[1,0,3,2] row_mask:0xf bank_mask:0xf
  s_nop 1
  v_add_f32_dpp v10, v10, v10 quad_perm:[2,3,0,1] row_mask:0xf bank_mask:0xf
  v_log_f32 v12, v10
  v_sub_f32 v9, v16, v8
  v_rcp_f32 v10, v10
  v_mul_f32 v9, 0x3fb8aa3b, v9
  v_exp_f32 v9, v9
  v_add_f32 v8, 0xc2b9e666, v8
  v_fmac_f32 v8, 0x3f317218, v12
  v_lshlrev_b32 v13, 2, v1
  v_mul_f32 v9, v9, v10
  s_mov_b64 exec, 0xffff
  ds_write_b32 v13, v9 offset:384
  s_mov_b64 exec, 1
  ds_write_b32 v38, v8 offset:276
  ds_add_u32 v38, v17 offset:272
  ds_add_u32 v38, v17 offset:300
  s_mov_b64 exec, -1
  ds_write_b32 v38, v38 offset:256
  ds_read_b128 v[62:65], v38 offset:384
  ds_read_b128 v[66:69], v38 offset:400
  ds_read_b128 v[70:73], v38 offset:416
  v_lshlrev_b32 v77, 3, v1
  s_lshl2_add_u32 s68, s6, s7
  s_lshl_b32 s68, s68, 9
  s_add_u32 s68, s68, 131072
  v_add_u32 v74, s68, v77
  v_and_b32 v75, 1, v1
  v_lshlrev_b32 v75, 4, v75
  v_lshrrev_b32 v75, v75, s74
  v_lshrrev_b32 v76, 8, v75
  s_mov_b32 s70, 0
L_sn_14:
  ds_read_b32 v8, v38 offset:304
  s_waitcnt lgkmcnt(0)
  v_cmp_gt_u32 vcc, 0xa, v8
  s_cmp_eq_u64 vcc, 0
  s_cbranch_scc1 L_snd_15
  s_sleep 1
  s_add_u32 s70, s70, 1
  s_cmp_lt_u32 s70, 2097152
  s_cbranch_scc1 L_sn_14
L_snd_15:
  s_mov_b32 s70, 0
L_wt_16:
  ds_read_b32 v8, v38 offset:304
  ds_read_b64 v[40:41], v77 offset:6656
  ds_read_b64 v[42:43], v77 offset:7168
  ds_read_b64 v[44:45], v77 offset:7680
  ds_read_b64 v[46:47], v77 offset:8192
  ds_read_b64 v[48:49], v77 offset:8704
  ds_read_b64 v[50:51], v77 offset:9216
  ds_read_b64 v[52:53], v77 offset:9728
  ds_read_b64 v[54:55], v77 offset:10240
  ds_read_b64 v[56:57], v77 offset:10752
  ds_read_b64 v[58:59], v77 offset:11264
  ds_read_b64 v[60:61], v77 offset:11776
  s_waitcnt lgkmcnt(11)
  v_cmp_gt_u32 vcc, 0xb, v8
  s_cmp_eq_u64 vcc, 0
  s_cbranch_scc1 L_wtd_17
  s_waitcnt lgkmcnt(0)
  s_add_u32 s70, s70, 1
  s_cmp_lt_u32 s70, 2097152
  s_cbranch_scc1 L_wt_16
L_wtd_17:
  s_movk_i32 s69, 0xff
  s_waitcnt lgkmcnt(10)
  v_pk_mul_f32 v[40:41], v[40:41], v[62:63] op_sel:[0,0] op_sel_hi:[1,0]
  s_waitcnt lgkmcnt(9)
  v_pk_mul_f32 v[42:43], v[42:43], v[62:63] op_sel:[0,1] op_sel_hi:[1,1]
  s_waitcnt lgkmcnt(8)
  v_pk_fma_f32 v[40:41], v[44:45], v[64:65], v[40:41] op_sel:[0,0,0] op_sel_hi:[1,0,1]
  s_waitcnt lgkmcnt(7)
  v_pk_fma_f32 v[42:43], v[46:47], v[64:65], v[42:43] op_sel:[0,1,0] op_sel_hi:[1,1,1]
  s_waitcnt lgkmcnt(6)
  v_pk_fma_f32 v[40:41], v[48:49], v[66:67], v[40:41] op_sel:[0,0,0] op_sel_hi:[1,0,1]
  s_waitcnt lgkmcnt(5)
  v_pk_fma_f32 v[42:43], v[50:51], v[66:67], v[42:43] op_sel:[0,1,0] op_sel_hi:[1,1,1]
  s_waitcnt lgkmcnt(4)
  v_pk_fma_f32 v[40:41], v[52:53], v[68:69], v[40:41] op_sel:[0,0,0] op_sel_hi:[1,0,1]
  s_waitcnt lgkmcnt(3)
  v_pk_fma_f32 v[42:43], v[54:55], v[68:69], v[42:43] op_sel:[0,1,0] op_sel_hi:[1,1,1]
  s_waitcnt lgkmcnt(2)
  v_pk_fma_f32 v[40:41], v[56:57], v[70:71], v[40:41] op_sel:[0,0,0] op_sel_hi:[1,0,1]
  s_waitcnt lgkmcnt(1)
  v_pk_fma_f32 v[42:43], v[58:59], v[70:71], v[42:43] op_sel:[0,1,0] op_sel_hi:[1,1,1]
  s_waitcnt lgkmcnt(0)
  v_pk_fma_f32 v[40:41], v[60:61], v[72:73], v[40:41] op_sel:[0,0,0] op_sel_hi:[1,0,1]
  v_pk_add_f32 v[40:41], v[40:41], v[42:43]
  v_bfi_b32 v40, s69, v75, v40
  v_bfi_b32 v41, s69, v76, v41
  s_cmp_eq_u32 s75, 1
  s_cbranch_scc0 L_pf_18
  global_store_dwordx2 v74, v[40:41], s[42:43]
  s_branch L_pe_19
L_pf_18:
  global_store_dwordx2 v74, v[40:41], s[42:43] sc1
L_pe_19:
  ds_read_b128 v[102:105], v38 offset:384
  ds_read_b128 v[106:109], v38 offset:400
  ds_read_b128 v[110:113], v38 offset:416
  v_lshlrev_b32 v117, 3, v1
  s_lshl2_add_u32 s68, s6, s7
  s_lshl_b32 s68, s68, 9
  s_add_u32 s68, s68, 524288
  v_add_u32 v114, s68, v117
  v_and_b32 v115, 1, v1
  v_lshlrev_b32 v115, 4, v115
  v_lshrrev_b32 v115, v115, s74
  v_lshrrev_b32 v116, 8, v115
  s_waitcnt vmcnt(0)
  s_mov_b32 s70, 0
L_sn_20:
  ds_read_b32 v8, v38 offset:308
  s_waitcnt lgkmcnt(0)
  v_cmp_gt_u32 vcc, 0x1, v8
  s_cmp_eq_u64 vcc, 0
  s_cbranch_scc1 L_snd_21
  s_sleep 4
  s_add_u32 s70, s70, 1
  s_cmp_lt_u32 s70, 2097152
  s_cbranch_scc1 L_sn_20
L_snd_21:
  global_store_dwordx2 v74, v[40:41], s[42:43] sc1
  s_cmp_eq_u32 s7, 2
  s_cbranch_scc1 L_chk
  s_mov_b32 s70, 0
L_sn_22:
  ds_read_b32 v8, v38 offset:308
  s_waitcnt lgkmcnt(0)
  v_cmp_gt_u32 vcc, 0xa, v8
  s_cmp_eq_u64 vcc, 0
  s_cbranch_scc1 L_snd_23
  s_sleep 1
  s_add_u32 s70, s70, 1
  s_cmp_lt_u32 s70, 2097152
  s_cbranch_scc1 L_sn_22
L_snd_23:
  s_mov_b32 s70, 0
L_wt_24:
  ds_read_b32 v8, v38 offset:308
  ds_read_b64 v[80:81], v117 offset:1024
  ds_read_b64 v[82:83], v117 offset:1536
  ds_read_b64 v[84:85], v117 offset:2048
  ds_read_b64 v[86:87], v117 offset:2560
  ds_read_b64 v[88:89], v117 offset:3072
  ds_read_b64 v[90:91], v117 offset:3584
  ds_read_b64 v[92:93], v117 offset:4096
  ds_read_b64 v[94:95], v117 offset:4608
  ds_read_b64 v[96:97], v117 offset:5120
  ds_read_b64 v[98:99], v117 offset:5632
  ds_read_b64 v[100:101], v117 offset:6144
  s_waitcnt lgkmcnt(11)
  v_cmp_gt_u32 vcc, 0xb, v8
  s_cmp_eq_u64 vcc, 0
  s_cbranch_scc1 L_wtd_25
  s_waitcnt lgkmcnt(0)
  s_add_u32 s70, s70, 1
  s_cmp_lt_u32 s70, 2097152
  s_cbranch_scc1 L_wt_24
L_wtd_25:
  s_movk_i32 s69, 0xff
  s_waitcnt lgkmcnt(10)
  v_pk_mul_f32 v[80:81], v[80:81], v[102:103] op_sel:[0,0] op_sel_hi:[1,0]
  s_waitcnt lgkmcnt(9)
  v_pk_mul_f32 v[82:83], v[82:83], v[102:103] op_sel:[0,1] op_sel_hi:[1,1]
  s_waitcnt lgkmcnt(8)
  v_pk_fma_f32 v[80:81], v[84:85], v[104:105], v[80:81] op_sel:[0,0,0] op_sel_hi:[1,0,1]
  s_waitcnt lgkmcnt(7)
  v_pk_fma_f32 v[82:83], v[86:87], v[104:105], v[82:83] op_sel:[0,1,0] op_sel_hi:[1,1,1]
  s_waitcnt lgkmcnt(6)
  v_pk_fma_f32 v[80:81], v[88:89], v[106:107], v[80:81] op_sel:[0,0,0] op_sel_hi:[1,0,1]
  s_waitcnt lgkmcnt(5)
  v_pk_fma_f32 v[82:83], v[90:91], v[106:107], v[82:83] op_sel:[0,1,0] op_sel_hi:[1,1,1]
  s_waitcnt lgkmcnt(4)
  v_pk_fma_f32 v[80:81], v[92:93], v[108:109], v[80:81] op_sel:[0,0,0] op_sel_hi:[1,0,1]
  s_waitcnt lgkmcnt(3)
  v_pk_fma_f32 v[82:83], v[94:95], v[108:109], v[82:83] op_sel:[0,1,0] op_sel_hi:[1,1,1]
  s_waitcnt lgkmcnt(2)
  v_pk_fma_f32 v[80:81], v[96:97], v[110:111], v[80:81] op_sel:[0,0,0] op_sel_hi:[1,0,1]
  s_waitcnt lgkmcnt(1)
  v_pk_fma_f32 v[82:83], v[98:99], v[110:111], v[82:83] op_sel:[0,1,0] op_sel_hi:[1,1,1]
  s_waitcnt lgkmcnt(0)
  v_pk_fma_f32 v[80:81], v[100:101], v[112:113], v[80:81] op_sel:[0,0,0] op_sel_hi:[1,0,1]
  v_pk_add_f32 v[80:81], v[80:81], v[82:83]
  v_bfi_b32 v80, s69, v115, v80
  v_bfi_b32 v81, s69, v116, v81
  global_store_dwordx2 v114, v[80:81], s[42:43] sc1
  s_branch L_fin
L_chk:
  v_and_b32 v160, 0xff, v75
  v_and_b32 v161, 0xff, v76
  s_lshl_b32 s10, s6, 11
  s_add_u32 s10, s10, 131072
  v_lshl_add_u32 v2, v1, 3, s10
  global_load_dwordx2 v[154:155], v2, s[42:43] offset:0 sc1
  global_load_dwordx2 v[156:157], v2, s[42:43] offset:512 sc1
  v_add_u32 v3, 393216, v2
  s_mov_b32 s70, 0
L_sn_26:
  ds_read_b32 v8, v38 offset:308
  s_waitcnt lgkmcnt(0)
  v_cmp_gt_u32 vcc, 0xa, v8
  s_cmp_eq_u64 vcc, 0
  s_cbranch_scc1 L_snd_27
  s_sleep 1
  s_add_u32 s70, s70, 1
  s_cmp_lt_u32 s70, 2097152
  s_cbranch_scc1 L_sn_26
L_snd_27:
  s_mov_b32 s70, 0
L_wt_28:
  ds_read_b32 v8, v38 offset:308
  ds_read_b64 v[80:81], v117 offset:1024
  ds_read_b64 v[82:83], v117 offset:1536
  ds_read_b64 v[84:85], v117 offset:2048
  ds_read_b64 v[86:87], v117 offset:2560
  ds_read_b64 v[88:89], v117 offset:3072
  ds_read_b64 v[90:91], v117 offset:3584
  ds_read_b64 v[92:93], v117 offset:4096
  ds_read_b64 v[94:95], v117 offset:4608
  ds_read_b64 v[96:97], v117 offset:5120
  ds_read_b64 v[98:99], v117 offset:5632
  ds_read_b64 v[100:101], v117 offset:6144
  s_waitcnt lgkmcnt(11)
  v_cmp_gt_u32 vcc, 0xb, v8
  s_cmp_eq_u64 vcc, 0
  s_cbranch_scc1 L_wtd_29
  s_waitcnt lgkmcnt(0)
  s_add_u32 s70, s70, 1
  s_cmp_lt_u32 s70, 2097152
  s_cbranch_scc1 L_wt_28
L_wtd_29:
  global_load_dwordx2 v[130:131], v3, s[42:43] offset:0 sc1
  global_load_dwordx2 v[132:133], v3, s[42:43] offset:512 sc1
  s_movk_i32 s69, 0xff
  s_waitcnt lgkmcnt(10)
  v_pk_mul_f32 v[80:81], v[80:81], v[102:103] op_sel:[0,0] op_sel_hi:[1,0]
  s_waitcnt lgkmcnt(9)
  v_pk_mul_f32 v[82:83], v[82:83], v[102:103] op_sel:[0,1] op_sel_hi:[1,1]
  s_waitcnt lgkmcnt(8)
  v_pk_fma_f32 v[80:81], v[84:85], v[104:105], v[80:81] op_sel:[0,0,0] op_sel_hi:[1,0,1]
  s_waitcnt lgkmcnt(7)
  v_pk_fma_f32 v[82:83], v[86:87], v[104:105], v[82:83] op_sel:[0,1,0] op_sel_hi:[1,1,1]
  s_waitcnt lgkmcnt(6)
  v_pk_fma_f32 v[80:81], v[88:89], v[106:107], v[80:81] op_sel:[0,0,0] op_sel_hi:[1,0,1]
  s_waitcnt lgkmcnt(5)
  v_pk_fma_f32 v[82:83], v[90:91], v[106:107], v[82:83] op_sel:[0,1,0] op_sel_hi:[1,1,1]
  s_waitcnt lgkmcnt(4)
  v_pk_fma_f32 v[80:81], v[92:93], v[108:109], v[80:81] op_sel:[0,0,0] op_sel_hi:[1,0,1]
  s_waitcnt lgkmcnt(3)
  v_pk_fma_f32 v[82:83], v[94:95], v[108:109], v[82:83] op_sel:[0,1,0] op_sel_hi:[1,1,1]
  s_waitcnt lgkmcnt(2)
  v_pk_fma_f32 v[80:81], v[96:97], v[110:111], v[80:81] op_sel:[0,0,0] op_sel_hi:[1,0,1]
  s_waitcnt lgkmcnt(1)
  v_pk_fma_f32 v[82:83], v[98:99], v[110:111], v[82:83] op_sel:[0,1,0] op_sel_hi:[1,1,1]
  s_waitcnt lgkmcnt(0)
  v_pk_fma_f32 v[80:81], v[100:101], v[112:113], v[80:81] op_sel:[0,0,0] op_sel_hi:[1,0,1]
  v_pk_add_f32 v[80:81], v[80:81], v[82:83]
  v_bfi_b32 v80, s69, v115, v80
  v_bfi_b32 v81, s69, v116, v81
  global_store_dwordx2 v114, v[80:81], s[42:43] sc1
  s_waitcnt vmcnt(1)
  s_mov_b32 s70, 0
  s_branch L_cp0c
L_cp0:
  global_load_dwordx2 v[154:155], v2, s[42:43] offset:0 sc1
  global_load_dwordx2 v[156:157], v2, s[42:43] offset:512 sc1
  s_sleep 4
  s_waitcnt vmcnt(0)
L_cp0c:
  v_xor_b32 v136, v154, v160
  v_xor_b32 v137, v155, v161
  v_xor_b32 v138, v156, v160
  v_xor_b32 v139, v157, v161
  v_xor_b32 v140, v40, v160
  v_xor_b32 v141, v41, v161
  v_or3_b32 v152, v136, v137, v138
  v_or3_b32 v153, v139, v140, v141
  v_or_b32 v136, 0x80, v136
  v_or_b32 v137, 0x80, v137
  v_or_b32 v138, 0x80, v138
  v_or_b32 v139, 0x80, v139
  v_or_b32 v140, 0x80, v140
  v_or_b32 v141, 0x80, v141
  v_or_b32 v152, v152, v153
  v_pk_add_f32 v[136:137], v[136:137], v[138:139]
  v_lshlrev_b32 v152, 24, v152
  v_pk_add_f32 v[136:137], v[136:137], v[140:141]
  v_cmp_ne_u32 vcc, 0, v152
  v_cvt_pk_bf16_f32 v136, v136, v137
  s_cmp_eq_u64 vcc, 0
  s_cbranch_scc1 L_cp0d
  s_add_u32 s70, s70, 1
  s_cmp_lt_u32 s70, 262144
  s_cbranch_scc1 L_cp0
L_cp0d:
  v_add_u32 v2, 393216, v2
  s_mov_b32 s70, 0
  s_branch L_cp1c
L_cp1:
  global_load_dwordx2 v[130:131], v2, s[42:43] offset:0 sc1
  global_load_dwordx2 v[132:133], v2, s[42:43] offset:512 sc1
  s_waitcnt vmcnt(0)
L_cp1c:
  v_xor_b32 v144, v130, v160
  v_xor_b32 v145, v131, v161
  v_xor_b32 v146, v132, v160
  v_xor_b32 v147, v133, v161
  v_xor_b32 v148, v80, v160
  v_xor_b32 v149, v81, v161
  v_or3_b32 v152, v144, v145, v146
  v_or3_b32 v153, v147, v148, v149
  v_or_b32 v144, 0x80, v144
  v_or_b32 v145, 0x80, v145
  v_or_b32 v146, 0x80, v146
  v_or_b32 v147, 0x80, v147
  v_or_b32 v148, 0x80, v148
  v_or_b32 v149, 0x80, v149
  v_or_b32 v152, v152, v153
  v_pk_add_f32 v[144:145], v[144:145], v[146:147]
  v_lshlrev_b32 v152, 24, v152
  v_pk_add_f32 v[144:145], v[144:145], v[148:149]
  v_cmp_ne_u32 vcc, 0, v152
  v_cvt_pk_bf16_f32 v144, v144, v145
  s_cmp_eq_u64 vcc, 0
  s_cbranch_scc1 L_cp1d
  s_add_u32 s70, s70, 1
  s_cmp_lt_u32 s70, 262144
  s_cbranch_scc1 L_cp1
L_cp1d:
  v_cmp_ne_u32 vcc, v136, v144
  s_cmp_eq_u64 vcc, 0
  s_cbranch_scc1 L_fin
  s_waitcnt vmcnt(0)
L_slow:
  s_mov_b32 s47, 0x20000
  s_load_dwordx16 s[16:31], s[0:1], 0
  s_load_dwordx8 s[32:39], s[0:1], 64
  v_and_b32 v2, 31, v1
  v_lshlrev_b32 v2, 7, v2
  v_add_u32 v2, 28672, v2
  s_mov_b32 s70, 0
L_sl_d:
  global_load_dword v3, v2, s[42:43] sc1
  s_waitcnt vmcnt(0) lgkmcnt(0)
  v_cmp_ne_u32 vcc, s74, v3
  s_cmp_eq_u64 vcc, 0
  s_cbranch_scc1 L_sl_dd
  s_sleep 8
  s_add_u32 s70, s70, 1
  s_cmp_lt_u32 s70, 262144
  s_cbranch_scc1 L_sl_d
L_sl_dd:
  v_lshlrev_b32 v2, 3, v1
  v_add_u32 v2, 524288, v2
  v_lshlrev_b32 v0, 2, v1
  v_add_u32 v0, 12288, v0
  s_mov_b32 s10, 0
L_sl_h:
  s_mov_b32 s70, 0
L_sl_hp:
  global_load_dwordx2 v[40:41], v2, s[42:43] offset:0 sc1
  global_load_dwordx2 v[42:43], v2, s[42:43] offset:512 sc1
  global_load_dwordx2 v[44:45], v2, s[42:43] offset:1024 sc1
  s_waitcnt vmcnt(0)
  v_xor_b32 v40, v40, v160
  v_xor_b32 v41, v41, v161
  v_xor_b32 v42, v42, v160
  v_xor_b32 v43, v43, v161
  v_xor_b32 v44, v44, v160
  v_xor_b32 v45, v45, v161
  v_or3_b32 v48, v40, v41, v42
  v_or3_b32 v49, v43, v44, v45
  v_or_b32 v40, 0x80, v40
  v_or_b32 v41, 0x80, v41
  v_or_b32 v42, 0x80, v42
  v_or_b32 v43, 0x80, v43
  v_or_b32 v44, 0x80, v44
  v_or_b32 v45, 0x80, v45
  v_or_b32 v48, v48, v49
  v_pk_add_f32 v[40:41], v[40:41], v[42:43]
  v_lshlrev_b32 v48, 24, v48
  v_pk_add_f32 v[40:41], v[40:41], v[44:45]
  v_cmp_ne_u32 vcc, 0, v48
  v_cvt_pk_bf16_f32 v40, v40, v41
  s_cmp_eq_u64 vcc, 0
  s_cbranch_scc1 L_sl_hd
  s_sleep 8
  s_add_u32 s70, s70, 1
  s_cmp_lt_u32 s70, 262144
  s_cbranch_scc1 L_sl_hp
L_sl_hd:
  ds_write_b32 v0, v40
  v_add_u32 v2, 2048, v2
  v_add_u32 v0, 256, v0
  s_add_u32 s10, s10, 1
  s_cmp_lt_u32 s10, 64
  s_cbranch_scc1 L_sl_h
  s_mov_b32 s44, s24
  s_mov_b32 s45, s25
  s_mov_b32 s46, 4194304
  s_mov_b32 s11, 1024
  s_mov_b32 s12, 4194304
  v_mov_b32 v4, 12288
  v_mov_b32 v5, 20480
  v_lshlrev_b32 v2, 4, v1
  s_call_b64 s[62:63], L_gv
  v_lshlrev_b32 v0, 4, v1
  global_load_dwordx4 v[40:43], v0, s[16:17] offset:0
  global_load_dwordx4 v[44:47], v0, s[16:17] offset:1024
  s_waitcnt vmcnt(0)
  v_lshlrev_b32 v104, 16, v40
  v_and_b32 v105, s73, v40
  v_lshlrev_b32 v106, 16, v41
  v_and_b32 v107, s73, v41
  v_lshlrev_b32 v108, 16, v42
  v_and_b32 v109, s73, v42
  v_lshlrev_b32 v110, 16, v43
  v_and_b32 v111, s73, v43
  v_lshlrev_b32 v112, 16, v44
  v_and_b32 v113, s73, v44
  v_lshlrev_b32 v114, 16, v45
  v_and_b32 v115, s73, v45
  v_lshlrev_b32 v116, 16, v46
  v_and_b32 v117, s73, v46
  v_lshlrev_b32 v118, 16, v47
  v_and_b32 v119, s73, v47
  v_lshrrev_b32 v2, 1, v1
  v_lshlrev_b32 v2, 7, v2
  v_and_b32 v3, 1, v1
  v_lshl_add_u32 v2, v3, 5, v2
  v_add_u32 v2, 12288, v2
  global_load_dwordx4 v[40:43], v2, s[42:43] offset:0 sc1
  global_load_dwordx4 v[44:47], v2, s[42:43] offset:16 sc1
  global_load_dwordx4 v[48:51], v2, s[42:43] offset:64 sc1
  global_load_dwordx4 v[52:55], v2, s[42:43] offset:80 sc1
  s_waitcnt vmcnt(0)
  v_lshlrev_b32 v88, 16, v40
  v_and_b32 v89, s73, v40
  v_lshlrev_b32 v90, 16, v42
  v_and_b32 v91, s73, v42
  v_lshlrev_b32 v92, 16, v44
  v_and_b32 v93, s73, v44
  v_lshlrev_b32 v94, 16, v46
  v_and_b32 v95, s73, v46
  v_lshlrev_b32 v96, 16, v48
  v_and_b32 v97, s73, v48
  v_lshlrev_b32 v98, 16, v50
  v_and_b32 v99, s73, v50
  v_lshlrev_b32 v100, 16, v52
  v_and_b32 v101, s73, v52
  v_lshlrev_b32 v102, 16, v54
  v_and_b32 v103, s73, v54
  v_cvt_pk_bf16_f32 v72, 0, v72
  v_cvt_pk_bf16_f32 v73, 0, v73
  v_cvt_pk_bf16_f32 v74, 0, v74
  v_cvt_pk_bf16_f32 v75, 0, v75
  v_cvt_pk_bf16_f32 v76, 0, v76
  v_cvt_pk_bf16_f32 v77, 0, v77
  v_cvt_pk_bf16_f32 v78, 0, v78
  v_cvt_pk_bf16_f32 v79, 0, v79
  v_cvt_pk_bf16_f32 v80, 0, v80
  v_cvt_pk_bf16_f32 v81, 0, v81
  v_cvt_pk_bf16_f32 v82, 0, v82
  v_cvt_pk_bf16_f32 v83, 0, v83
  v_cvt_pk_bf16_f32 v84, 0, v84
  v_cvt_pk_bf16_f32 v85, 0, v85
  v_cvt_pk_bf16_f32 v86, 0, v86
  v_cvt_pk_bf16_f32 v87, 0, v87
  v_mul_f32 v72, v72, v88
  v_mul_f32 v73, v73, v89
  v_mul_f32 v74, v74, v90
  v_mul_f32 v75, v75, v91
  v_mul_f32 v76, v76, v92
  v_mul_f32 v77, v77, v93
  v_mul_f32 v78, v78, v94
  v_mul_f32 v79, v79, v95
  v_mul_f32 v80, v80, v96
  v_mul_f32 v81, v81, v97
  v_mul_f32 v82, v82, v98
  v_mul_f32 v83, v83, v99
  v_mul_f32 v84, v84, v100
  v_mul_f32 v85, v85, v101
  v_mul_f32 v86, v86, v102
  v_mul_f32 v87, v87, v103
  v_cvt_pk_bf16_f32 v72, 0, v72
  v_cvt_pk_bf16_f32 v73, 0, v73
  v_cvt_pk_bf16_f32 v74, 0, v74
  v_cvt_pk_bf16_f32 v75, 0, v75
  v_cvt_pk_bf16_f32 v76, 0, v76
  v_cvt_pk_bf16_f32 v77, 0, v77
  v_cvt_pk_bf16_f32 v78, 0, v78
  v_cvt_pk_bf16_f32 v79, 0, v79
  v_cvt_pk_bf16_f32 v80, 0, v80
  v_cvt_pk_bf16_f32 v81, 0, v81
  v_cvt_pk_bf16_f32 v82, 0, v82
  v_cvt_pk_bf16_f32 v83, 0, v83
  v_cvt_pk_bf16_f32 v84, 0, v84
  v_cvt_pk_bf16_f32 v85, 0, v85
  v_cvt_pk_bf16_f32 v86, 0, v86
  v_cvt_pk_bf16_f32 v87, 0, v87
  v_add_f32 v104, v104, v72
  v_add_f32 v105, v105, v73
  v_add_f32 v106, v106, v74
  v_add_f32 v107, v107, v75
  v_add_f32 v108, v108, v76
  v_add_f32 v109, v109, v77
  v_add_f32 v110, v110, v78
  v_add_f32 v111, v111, v79
  v_add_f32 v112, v112, v80
  v_add_f32 v113, v113, v81
  v_add_f32 v114, v114, v82
  v_add_f32 v115, v115, v83
  v_add_f32 v116, v116, v84
  v_add_f32 v117, v117, v85
  v_add_f32 v118, v118, v86
  v_add_f32 v119, v119, v87
  v_cvt_pk_bf16_f32 v104, 0, v104
  v_cvt_pk_bf16_f32 v105, 0, v105
  v_cvt_pk_bf16_f32 v106, 0, v106
  v_cvt_pk_bf16_f32 v107, 0, v107
  v_cvt_pk_bf16_f32 v108, 0, v108
  v_cvt_pk_bf16_f32 v109, 0, v109
  v_cvt_pk_bf16_f32 v110, 0, v110
  v_cvt_pk_bf16_f32 v111, 0, v111
  v_cvt_pk_bf16_f32 v112, 0, v112
  v_cvt_pk_bf16_f32 v113, 0, v113
  v_cvt_pk_bf16_f32 v114, 0, v114
  v_cvt_pk_bf16_f32 v115, 0, v115
  v_cvt_pk_bf16_f32 v116, 0, v116
  v_cvt_pk_bf16_f32 v117, 0, v117
  v_cvt_pk_bf16_f32 v118, 0, v118
  v_cvt_pk_bf16_f32 v119, 0, v119
  v_add_f32 v8, v104, v105
  v_add_f32 v8, v8, v106
  v_add_f32 v8, v8, v107
  v_add_f32 v8, v8, v108
  v_add_f32 v8, v8, v109
  v_add_f32 v8, v8, v110
  v_add_f32 v8, v8, v111
  s_nop 1
  v_add_f32_dpp v8, v8, v8 row_ror:8 row_mask:0xf bank_mask:0xf
  s_nop 1
  v_add_f32_dpp v8, v8, v8 row_ror:4 row_mask:0xf bank_mask:0xf
  s_nop 1
  v_add_f32_dpp v8, v8, v8 row_ror:2 row_mask:0xf bank_mask:0xf
  s_nop 1
  v_add_f32_dpp v8, v8, v8 row_ror:1 row_mask:0xf bank_mask:0xf
  v_mov_b32 v9, v8
  s_nop 1
  v_permlane16_swap_b32 v9, v8
  v_add_f32 v8, v8, v9
  v_mov_b32 v9, v8
  s_nop 1
  v_permlane32_swap_b32 v9, v8
  v_add_f32 v8, v8, v9
  v_mul_f32 v8, 0x3b000000, v8
  v_sub_f32 v72, v104, v8
  v_sub_f32 v73, v105, v8
  v_sub_f32 v74, v106, v8
  v_sub_f32 v75, v107, v8
  v_sub_f32 v76, v108, v8
  v_sub_f32 v77, v109, v8
  v_sub_f32 v78, v110, v8
  v_sub_f32 v79, v111, v8
  v_mul_f32 v10, v72, v72
  v_fmac_f32 v10, v73, v73
  v_fmac_f32 v10, v74, v74
  v_fmac_f32 v10, v75, v75
  v_fmac_f32 v10, v76, v76
  v_fmac_f32 v10, v77, v77
  v_fmac_f32 v10, v78, v78
  v_fmac_f32 v10, v79, v79
  s_nop 1
  v_add_f32_dpp v10, v10, v10 row_ror:8 row_mask:0xf bank_mask:0xf
  s_nop 1
  v_add_f32_dpp v10, v10, v10 row_ror:4 row_mask:0xf bank_mask:0xf
  s_nop 1
  v_add_f32_dpp v10, v10, v10 row_ror:2 row_mask:0xf bank_mask:0xf
  s_nop 1
  v_add_f32_dpp v10, v10, v10 row_ror:1 row_mask:0xf bank_mask:0xf
  v_mov_b32 v9, v10
  s_nop 1
  v_permlane16_swap_b32 v9, v10
  v_add_f32 v10, v10, v9
  v_mov_b32 v9, v10
  s_nop 1
  v_permlane32_swap_b32 v9, v10
  v_add_f32 v10, v10, v9
  v_mul_f32 v10, 0x3b000000, v10
  v_cvt_pk_bf16_f32 v8, 0, v8
  v_cvt_pk_bf16_f32 v10, 0, v10
  v_add_f32 v10, 0x3727c5ac, v10
  v_cvt_pk_bf16_f32 v10, 0, v10
  v_sqrt_f32 v10, v10
  v_sub_f32 v72, v104, v8
  v_sub_f32 v73, v105, v8
  v_sub_f32 v74, v106, v8
  v_sub_f32 v75, v107, v8
  v_sub_f32 v76, v108, v8
  v_sub_f32 v77, v109, v8
  v_sub_f32 v78, v110, v8
  v_sub_f32 v79, v111, v8
  v_cvt_pk_bf16_f32 v10, 0, v10
  v_cvt_pk_bf16_f32 v72, 0, v72
  v_cvt_pk_bf16_f32 v73, 0, v73
  v_cvt_pk_bf16_f32 v74, 0, v74
  v_cvt_pk_bf16_f32 v75, 0, v75
  v_cvt_pk_bf16_f32 v76, 0, v76
  v_cvt_pk_bf16_f32 v77, 0, v77
  v_cvt_pk_bf16_f32 v78, 0, v78
  v_cvt_pk_bf16_f32 v79, 0, v79
  v_rcp_f32 v10, v10
  s_nop 0
  v_mul_f32 v72, v72, v10
  v_mul_f32 v73, v73, v10
  v_mul_f32 v74, v74, v10
  v_mul_f32 v75, v75, v10
  v_mul_f32 v76, v76, v10
  v_mul_f32 v77, v77, v10
  v_mul_f32 v78, v78, v10
  v_mul_f32 v79, v79, v10
  v_cvt_pk_bf16_f32 v72, 0, v72
  v_cvt_pk_bf16_f32 v73, 0, v73
  v_cvt_pk_bf16_f32 v74, 0, v74
  v_cvt_pk_bf16_f32 v75, 0, v75
  v_cvt_pk_bf16_f32 v76, 0, v76
  v_cvt_pk_bf16_f32 v77, 0, v77
  v_cvt_pk_bf16_f32 v78, 0, v78
  v_cvt_pk_bf16_f32 v79, 0, v79
  v_add_f32 v8, v112, v113
  v_add_f32 v8, v8, v114
  v_add_f32 v8, v8, v115
  v_add_f32 v8, v8, v116
  v_add_f32 v8, v8, v117
  v_add_f32 v8, v8, v118
  v_add_f32 v8, v8, v119
  s_nop 1
  v_add_f32_dpp v8, v8, v8 row_ror:8 row_mask:0xf bank_mask:0xf
  s_nop 1
  v_add_f32_dpp v8, v8, v8 row_ror:4 row_mask:0xf bank_mask:0xf
  s_nop 1
  v_add_f32_dpp v8, v8, v8 row_ror:2 row_mask:0xf bank_mask:0xf
  s_nop 1
  v_add_f32_dpp v8, v8, v8 row_ror:1 row_mask:0xf bank_mask:0xf
  v_mov_b32 v9, v8
  s_nop 1
  v_permlane16_swap_b32 v9, v8
  v_add_f32 v8, v8, v9
  v_mov_b32 v9, v8
  s_nop 1
  v_permlane32_swap_b32 v9, v8
  v_add_f32 v8, v8, v9
  v_mul_f32 v8, 0x3b000000, v8
  v_sub_f32 v80, v112, v8
  v_sub_f32 v81, v113, v8
  v_sub_f32 v82, v114, v8
  v_sub_f32 v83, v115, v8
  v_sub_f32 v84, v116, v8
  v_sub_f32 v85, v117, v8
  v_sub_f32 v86, v118, v8
  v_sub_f32 v87, v119, v8
  v_mul_f32 v10, v80, v80
  v_fmac_f32 v10, v81, v81
  v_fmac_f32 v10, v82, v82
  v_fmac_f32 v10, v83, v83
  v_fmac_f32 v10, v84, v84
  v_fmac_f32 v10, v85, v85
  v_fmac_f32 v10, v86, v86
  v_fmac_f32 v10, v87, v87
  s_nop 1
  v_add_f32_dpp v10, v10, v10 row_ror:8 row_mask:0xf bank_mask:0xf
  s_nop 1
  v_add_f32_dpp v10, v10, v10 row_ror:4 row_mask:0xf bank_mask:0xf
  s_nop 1
  v_add_f32_dpp v10, v10, v10 row_ror:2 row_mask:0xf bank_mask:0xf
  s_nop 1
  v_add_f32_dpp v10, v10, v10 row_ror:1 row_mask:0xf bank_mask:0xf
  v_mov_b32 v9, v10
  s_nop 1
  v_permlane16_swap_b32 v9, v10
  v_add_f32 v10, v10, v9
  v_mov_b32 v9, v10
  s_nop 1
  v_permlane32_swap_b32 v9, v10
  v_add_f32 v10, v10, v9
  v_mul_f32 v10, 0x3b000000, v10
  v_cvt_pk_bf16_f32 v8, 0, v8
  v_cvt_pk_bf16_f32 v10, 0, v10
  v_add_f32 v10, 0x3727c5ac, v10
  v_cvt_pk_bf16_f32 v10, 0, v10
  v_sqrt_f32 v10, v10
  v_sub_f32 v80, v112, v8
  v_sub_f32 v81, v113, v8
  v_sub_f32 v82, v114, v8
  v_sub_f32 v83, v115, v8
  v_sub_f32 v84, v116, v8
  v_sub_f32 v85, v117, v8
  v_sub_f32 v86, v118, v8
  v_sub_f32 v87, v119, v8
  v_cvt_pk_bf16_f32 v10, 0, v10
  v_cvt_pk_bf16_f32 v80, 0, v80
  v_cvt_pk_bf16_f32 v81, 0, v81
  v_cvt_pk_bf16_f32 v82, 0, v82
  v_cvt_pk_bf16_f32 v83, 0, v83
  v_cvt_pk_bf16_f32 v84, 0, v84
  v_cvt_pk_bf16_f32 v85, 0, v85
  v_cvt_pk_bf16_f32 v86, 0, v86
  v_cvt_pk_bf16_f32 v87, 0, v87
  v_rcp_f32 v10, v10
  s_nop 0
  v_mul_f32 v80, v80, v10
  v_mul_f32 v81, v81, v10
  v_mul_f32 v82, v82, v10
  v_mul_f32 v83, v83, v10
  v_mul_f32 v84, v84, v10
  v_mul_f32 v85, v85, v10
  v_mul_f32 v86, v86, v10
  v_mul_f32 v87, v87, v10
  v_cvt_pk_bf16_f32 v80, 0, v80
  v_cvt_pk_bf16_f32 v81, 0, v81
  v_cvt_pk_bf16_f32 v82, 0, v82
  v_cvt_pk_bf16_f32 v83, 0, v83
  v_cvt_pk_bf16_f32 v84, 0, v84
  v_cvt_pk_bf16_f32 v85, 0, v85
  v_cvt_pk_bf16_f32 v86, 0, v86
  v_cvt_pk_bf16_f32 v87, 0, v87
  v_lshrrev_b32 v2, 1, v1
  v_lshlrev_b32 v2, 7, v2
  v_and_b32 v3, 1, v1
  v_lshl_add_u32 v2, v3, 5, v2
  v_add_u32 v2, 20480, v2
  global_load_dwordx4 v[40:43], v2, s[42:43] offset:0 sc1
  global_load_dwordx4 v[44:47], v2, s[42:43] offset:16 sc1
  global_load_dwordx4 v[48:51], v2, s[42:43] offset:64 sc1
  global_load_dwordx4 v[52:55], v2, s[42:43] offset:80 sc1
  s_waitcnt vmcnt(0)
  v_lshlrev_b32 v88, 16, v40
  v_and_b32 v89, s73, v40
  v_lshlrev_b32 v90, 16, v42
  v_and_b32 v91, s73, v42
  v_lshlrev_b32 v92, 16, v44
  v_and_b32 v93, s73, v44
  v_lshlrev_b32 v94, 16, v46
  v_and_b32 v95, s73, v46
  v_lshlrev_b32 v96, 16, v48
  v_and_b32 v97, s73, v48
  v_lshlrev_b32 v98, 16, v50
  v_and_b32 v99, s73, v50
  v_lshlrev_b32 v100, 16, v52
  v_and_b32 v101, s73, v52
  v_lshlrev_b32 v102, 16, v54
  v_and_b32 v103, s73, v54
  v_add_f32 v88, 1.0, v88
  v_add_f32 v89, 1.0, v89
  v_add_f32 v90, 1.0, v90
  v_add_f32 v91, 1.0, v91
  v_add_f32 v92, 1.0, v92
  v_add_f32 v93, 1.0, v93
  v_add_f32 v94, 1.0, v94
  v_add_f32 v95, 1.0, v95
  v_add_f32 v96, 1.0, v96
  v_add_f32 v97, 1.0, v97
  v_add_f32 v98, 1.0, v98
  v_add_f32 v99, 1.0, v99
  v_add_f32 v100, 1.0, v100
  v_add_f32 v101, 1.0, v101
  v_add_f32 v102, 1.0, v102
  v_add_f32 v103, 1.0, v103
  v_cvt_pk_bf16_f32 v88, 0, v88
  v_cvt_pk_bf16_f32 v89, 0, v89
  v_cvt_pk_bf16_f32 v90, 0, v90
  v_cvt_pk_bf16_f32 v91, 0, v91
  v_cvt_pk_bf16_f32 v92, 0, v92
  v_cvt_pk_bf16_f32 v93, 0, v93
  v_cvt_pk_bf16_f32 v94, 0, v94
  v_cvt_pk_bf16_f32 v95, 0, v95
  v_cvt_pk_bf16_f32 v96, 0, v96
  v_cvt_pk_bf16_f32 v97, 0, v97
  v_cvt_pk_bf16_f32 v98, 0, v98
  v_cvt_pk_bf16_f32 v99, 0, v99
  v_cvt_pk_bf16_f32 v100, 0, v100
  v_cvt_pk_bf16_f32 v101, 0, v101
  v_cvt_pk_bf16_f32 v102, 0, v102
  v_cvt_pk_bf16_f32 v103, 0, v103
  v_mul_f32 v72, v72, v88
  v_mul_f32 v73, v73, v89
  v_mul_f32 v74, v74, v90
  v_mul_f32 v75, v75, v91
  v_mul_f32 v76, v76, v92
  v_mul_f32 v77, v77, v93
  v_mul_f32 v78, v78, v94
  v_mul_f32 v79, v79, v95
  v_mul_f32 v80, v80, v96
  v_mul_f32 v81, v81, v97
  v_mul_f32 v82, v82, v98
  v_mul_f32 v83, v83, v99
  v_mul_f32 v84, v84, v100
  v_mul_f32 v85, v85, v101
  v_mul_f32 v86, v86, v102
  v_mul_f32 v87, v87, v103
  v_cvt_pk_bf16_f32 v72, 0, v72
  v_cvt_pk_bf16_f32 v73, 0, v73
  v_cvt_pk_bf16_f32 v74, 0, v74
  v_cvt_pk_bf16_f32 v75, 0, v75
  v_cvt_pk_bf16_f32 v76, 0, v76
  v_cvt_pk_bf16_f32 v77, 0, v77
  v_cvt_pk_bf16_f32 v78, 0, v78
  v_cvt_pk_bf16_f32 v79, 0, v79
  v_cvt_pk_bf16_f32 v80, 0, v80
  v_cvt_pk_bf16_f32 v81, 0, v81
  v_cvt_pk_bf16_f32 v82, 0, v82
  v_cvt_pk_bf16_f32 v83, 0, v83
  v_cvt_pk_bf16_f32 v84, 0, v84
  v_cvt_pk_bf16_f32 v85, 0, v85
  v_cvt_pk_bf16_f32 v86, 0, v86
  v_cvt_pk_bf16_f32 v87, 0, v87
  v_lshrrev_b32 v2, 1, v1
  v_lshlrev_b32 v2, 7, v2
  v_and_b32 v3, 1, v1
  v_lshl_add_u32 v2, v3, 5, v2
  v_add_u32 v2, 16384, v2
  global_load_dwordx4 v[40:43], v2, s[42:43] offset:0 sc1
  global_load_dwordx4 v[44:47], v2, s[42:43] offset:16 sc1
  global_load_dwordx4 v[48:51], v2, s[42:43] offset:64 sc1
  global_load_dwordx4 v[52:55], v2, s[42:43] offset:80 sc1
  s_waitcnt vmcnt(0)
  v_lshlrev_b32 v88, 16, v40
  v_and_b32 v89, s73, v40
  v_lshlrev_b32 v90, 16, v42
  v_and_b32 v91, s73, v42
  v_lshlrev_b32 v92, 16, v44
  v_and_b32 v93, s73, v44
  v_lshlrev_b32 v94, 16, v46
  v_and_b32 v95, s73, v46
  v_lshlrev_b32 v96, 16, v48
  v_and_b32 v97, s73, v48
  v_lshlrev_b32 v98, 16, v50
  v_and_b32 v99, s73, v50
  v_lshlrev_b32 v100, 16, v52
  v_and_b32 v101, s73, v52
  v_lshlrev_b32 v102, 16, v54
  v_and_b32 v103, s73, v54
  v_add_f32 v72, v72, v88
  v_add_f32 v73, v73, v89
  v_add_f32 v74, v74, v90
  v_add_f32 v75, v75, v91
  v_add_f32 v76, v76, v92
  v_add_f32 v77, v77, v93
  v_add_f32 v78, v78, v94
  v_add_f32 v79, v79, v95
  v_add_f32 v80, v80, v96
  v_add_f32 v81, v81, v97
  v_add_f32 v82, v82, v98
  v_add_f32 v83, v83, v99
  v_add_f32 v84, v84, v100
  v_add_f32 v85, v85, v101
  v_add_f32 v86, v86, v102
  v_add_f32 v87, v87, v103
  v_cvt_pk_bf16_f32 v40, v72, v73
  v_cvt_pk_bf16_f32 v41, v74, v75
  v_cvt_pk_bf16_f32 v42, v76, v77
  v_cvt_pk_bf16_f32 v43, v78, v79
  v_cvt_pk_bf16_f32 v44, v80, v81
  v_cvt_pk_bf16_f32 v45, v82, v83
  v_cvt_pk_bf16_f32 v46, v84, v85
  v_cvt_pk_bf16_f32 v47, v86, v87
  v_add_u32 v3, 12288, v0
  ds_write_b128 v3, v[40:43] offset:0
  ds_write_b128 v3, v[44:47] offset:1024
  s_mov_b32 s44, s28
  s_mov_b32 s45, s29
  s_mov_b32 s46, 1409024
  s_mov_b32 s11, 2752
  s_mov_b32 s12, 1409024
  v_mov_b32 v4, 12288
  v_mov_b32 v5, 13312
  v_lshlrev_b32 v2, 4, v1
  s_call_b64 s[62:63], L_gv
  v_cvt_pk_bf16_f32 v120, 0, v72
  v_cvt_pk_bf16_f32 v121, 0, v73
  v_cvt_pk_bf16_f32 v122, 0, v74
  v_cvt_pk_bf16_f32 v123, 0, v75
  v_cvt_pk_bf16_f32 v124, 0, v76
  v_cvt_pk_bf16_f32 v125, 0, v77
  v_cvt_pk_bf16_f32 v126, 0, v78
  v_cvt_pk_bf16_f32 v127, 0, v79
  v_cvt_pk_bf16_f32 v128, 0, v80
  v_cvt_pk_bf16_f32 v129, 0, v81
  v_cvt_pk_bf16_f32 v130, 0, v82
  v_cvt_pk_bf16_f32 v131, 0, v83
  v_cvt_pk_bf16_f32 v132, 0, v84
  v_cvt_pk_bf16_f32 v133, 0, v85
  v_cvt_pk_bf16_f32 v134, 0, v86
  v_cvt_pk_bf16_f32 v135, 0, v87
  s_mov_b32 s44, s30
  s_mov_b32 s45, s31
  s_mov_b32 s46, 1409024
  s_mov_b32 s11, 2752
  s_mov_b32 s12, 1409024
  v_mov_b32 v4, 12288
  v_mov_b32 v5, 13312
  v_lshlrev_b32 v2, 4, v1
  s_call_b64 s[62:63], L_gv
  v_mul_f32 v88, 0xbfb8aa3b, v120
  v_mul_f32 v89, 0xbfb8aa3b, v121
  v_mul_f32 v90, 0xbfb8aa3b, v122
  v_mul_f32 v91, 0xbfb8aa3b, v123
  v_exp_f32 v88, v88
  v_exp_f32 v89, v89
  v_exp_f32 v90, v90
  v_exp_f32 v91, v91
  s_nop 0
  v_add_f32 v88, 1.0, v88
  v_add_f32 v89, 1.0, v89
  v_add_f32 v90, 1.0, v90
  v_add_f32 v91, 1.0, v91
  v_rcp_f32 v88, v88
  v_rcp_f32 v89, v89
  v_rcp_f32 v90, v90
  v_rcp_f32 v91, v91
  s_nop 0
  v_mul_f32 v120, v120, v88
  v_mul_f32 v121, v121, v89
  v_mul_f32 v122, v122, v90
  v_mul_f32 v123, v123, v91
  v_mul_f32 v88, 0xbfb8aa3b, v124
  v_mul_f32 v89, 0xbfb8aa3b, v125
  v_mul_f32 v90, 0xbfb8aa3b, v126
  v_mul_f32 v91, 0xbfb8aa3b, v127
  v_exp_f32 v88, v88
  v_exp_f32 v89, v89
  v_exp_f32 v90, v90
  v_exp_f32 v91, v91
  s_nop 0
  v_add_f32 v88, 1.0, v88
  v_add_f32 v89, 1.0, v89
  v_add_f32 v90, 1.0, v90
  v_add_f32 v91, 1.0, v91
  v_rcp_f32 v88, v88
  v_rcp_f32 v89, v89
  v_rcp_f32 v90, v90
  v_rcp_f32 v91, v91
  s_nop 0
  v_mul_f32 v124, v124, v88
  v_mul_f32 v125, v125, v89
  v_mul_f32 v126, v126, v90
  v_mul_f32 v127, v127, v91
  v_mul_f32 v88, 0xbfb8aa3b, v128
  v_mul_f32 v89, 0xbfb8aa3b, v129
  v_mul_f32 v90, 0xbfb8aa3b, v130
  v_mul_f32 v91, 0xbfb8aa3b, v131
  v_exp_f32 v88, v88
  v_exp_f32 v89, v89
  v_exp_f32 v90, v90
  v_exp_f32 v91, v91
  s_nop 0
  v_add_f32 v88, 1.0, v88
  v_add_f32 v89, 1.0, v89
  v_add_f32 v90, 1.0, v90
  v_add_f32 v91, 1.0, v91
  v_rcp_f32 v88, v88
  v_rcp_f32 v89, v89
  v_rcp_f32 v90, v90
  v_rcp_f32 v91, v91
  s_nop 0
  v_mul_f32 v128, v128, v88
  v_mul_f32 v129, v129, v89
  v_mul_f32 v130, v130, v90
  v_mul_f32 v131, v131, v91
  v_mul_f32 v88, 0xbfb8aa3b, v132
  v_mul_f32 v89, 0xbfb8aa3b, v133
  v_mul_f32 v90, 0xbfb8aa3b, v134
  v_mul_f32 v91, 0xbfb8aa3b, v135
  v_exp_f32 v88, v88
  v_exp_f32 v89, v89
  v_exp_f32 v90, v90
  v_exp_f32 v91, v91
  s_nop 0
  v_add_f32 v88, 1.0, v88
  v_add_f32 v89, 1.0, v89
  v_add_f32 v90, 1.0, v90
  v_add_f32 v91, 1.0, v91
  v_rcp_f32 v88, v88
  v_rcp_f32 v89, v89
  v_rcp_f32 v90, v90
  v_rcp_f32 v91, v91
  s_nop 0
  v_mul_f32 v132, v132, v88
  v_mul_f32 v133, v133, v89
  v_mul_f32 v134, v134, v90
  v_mul_f32 v135, v135, v91
  v_cvt_pk_bf16_f32 v120, 0, v120
  v_cvt_pk_bf16_f32 v121, 0, v121
  v_cvt_pk_bf16_f32 v122, 0, v122
  v_cvt_pk_bf16_f32 v123, 0, v123
  v_cvt_pk_bf16_f32 v124, 0, v124
  v_cvt_pk_bf16_f32 v125, 0, v125
  v_cvt_pk_bf16_f32 v126, 0, v126
  v_cvt_pk_bf16_f32 v127, 0, v127
  v_cvt_pk_bf16_f32 v128, 0, v128
  v_cvt_pk_bf16_f32 v129, 0, v129
  v_cvt_pk_bf16_f32 v130, 0, v130
  v_cvt_pk_bf16_f32 v131, 0, v131
  v_cvt_pk_bf16_f32 v132, 0, v132
  v_cvt_pk_bf16_f32 v133, 0, v133
  v_cvt_pk_bf16_f32 v134, 0, v134
  v_cvt_pk_bf16_f32 v135, 0, v135
  v_cvt_pk_bf16_f32 v72, 0, v72
  v_cvt_pk_bf16_f32 v73, 0, v73
  v_cvt_pk_bf16_f32 v74, 0, v74
  v_cvt_pk_bf16_f32 v75, 0, v75
  v_cvt_pk_bf16_f32 v76, 0, v76
  v_cvt_pk_bf16_f32 v77, 0, v77
  v_cvt_pk_bf16_f32 v78, 0, v78
  v_cvt_pk_bf16_f32 v79, 0, v79
  v_cvt_pk_bf16_f32 v80, 0, v80
  v_cvt_pk_bf16_f32 v81, 0, v81
  v_cvt_pk_bf16_f32 v82, 0, v82
  v_cvt_pk_bf16_f32 v83, 0, v83
  v_cvt_pk_bf16_f32 v84, 0, v84
  v_cvt_pk_bf16_f32 v85, 0, v85
  v_cvt_pk_bf16_f32 v86, 0, v86
  v_cvt_pk_bf16_f32 v87, 0, v87
  v_mul_f32 v72, v72, v120
  v_mul_f32 v73, v73, v121
  v_mul_f32 v74, v74, v122
  v_mul_f32 v75, v75, v123
  v_mul_f32 v76, v76, v124
  v_mul_f32 v77, v77, v125
  v_mul_f32 v78, v78, v126
  v_mul_f32 v79, v79, v127
  v_mul_f32 v80, v80, v128
  v_mul_f32 v81, v81, v129
  v_mul_f32 v82, v82, v130
  v_mul_f32 v83, v83, v131
  v_mul_f32 v84, v84, v132
  v_mul_f32 v85, v85, v133
  v_mul_f32 v86, v86, v134
  v_mul_f32 v87, v87, v135
  v_cvt_pk_bf16_f32 v40, v72, v73
  v_cvt_pk_bf16_f32 v41, v74, v75
  v_cvt_pk_bf16_f32 v42, v76, v77
  v_cvt_pk_bf16_f32 v43, v78, v79
  v_cvt_pk_bf16_f32 v44, v80, v81
  v_cvt_pk_bf16_f32 v45, v82, v83
  v_cvt_pk_bf16_f32 v46, v84, v85
  v_cvt_pk_bf16_f32 v47, v86, v87
  v_add_u32 v3, 14336, v0
  ds_write_b128 v3, v[40:43] offset:0
  ds_write_b128 v3, v[44:47] offset:3072
  s_mov_b32 s44, s28
  s_mov_b32 s45, s29
  s_mov_b32 s46, 1409024
  s_mov_b32 s11, 2752
  s_mov_b32 s12, 1409024
  v_mov_b32 v4, 12288
  v_mov_b32 v5, 13312
  v_lshlrev_b32 v2, 4, v1
  v_add_u32 v2, 1024, v2
  s_call_b64 s[62:63], L_gv
  v_cvt_pk_bf16_f32 v120, 0, v72
  v_cvt_pk_bf16_f32 v121, 0, v73
  v_cvt_pk_bf16_f32 v122, 0, v74
  v_cvt_pk_bf16_f32 v123, 0, v75
  v_cvt_pk_bf16_f32 v124, 0, v76
  v_cvt_pk_bf16_f32 v125, 0, v77
  v_cvt_pk_bf16_f32 v126, 0, v78
  v_cvt_pk_bf16_f32 v127, 0, v79
  v_cvt_pk_bf16_f32 v128, 0, v80
  v_cvt_pk_bf16_f32 v129, 0, v81
  v_cvt_pk_bf16_f32 v130, 0, v82
  v_cvt_pk_bf16_f32 v131, 0, v83
  v_cvt_pk_bf16_f32 v132, 0, v84
  v_cvt_pk_bf16_f32 v133, 0, v85
  v_cvt_pk_bf16_f32 v134, 0, v86
  v_cvt_pk_bf16_f32 v135, 0, v87
  s_mov_b32 s44, s30
  s_mov_b32 s45, s31
  s_mov_b32 s46, 1409024
  s_mov_b32 s11, 2752
  s_mov_b32 s12, 1409024
  v_mov_b32 v4, 12288
  v_mov_b32 v5, 13312
  v_lshlrev_b32 v2, 4, v1
  v_add_u32 v2, 1024, v2
  s_call_b64 s[62:63], L_gv
  v_mul_f32 v88, 0xbfb8aa3b, v120
  v_mul_f32 v89, 0xbfb8aa3b, v121
  v_mul_f32 v90, 0xbfb8aa3b, v122
  v_mul_f32 v91, 0xbfb8aa3b, v123
  v_exp_f32 v88, v88
  v_exp_f32 v89, v89
  v_exp_f32 v90, v90
  v_exp_f32 v91, v91
  s_nop 0
  v_add_f32 v88, 1.0, v88
  v_add_f32 v89, 1.0, v89
  v_add_f32 v90, 1.0, v90
  v_add_f32 v91, 1.0, v91
  v_rcp_f32 v88, v88
  v_rcp_f32 v89, v89
  v_rcp_f32 v90, v90
  v_rcp_f32 v91, v91
  s_nop 0
  v_mul_f32 v120, v120, v88
  v_mul_f32 v121, v121, v89
  v_mul_f32 v122, v122, v90
  v_mul_f32 v123, v123, v91
  v_mul_f32 v88, 0xbfb8aa3b, v124
  v_mul_f32 v89, 0xbfb8aa3b, v125
  v_mul_f32 v90, 0xbfb8aa3b, v126
  v_mul_f32 v91, 0xbfb8aa3b, v127
  v_exp_f32 v88, v88
  v_exp_f32 v89, v89
  v_exp_f32 v90, v90
  v_exp_f32 v91, v91
  s_nop 0
  v_add_f32 v88, 1.0, v88
  v_add_f32 v89, 1.0, v89
  v_add_f32 v90, 1.0, v90
  v_add_f32 v91, 1.0, v91
  v_rcp_f32 v88, v88
  v_rcp_f32 v89, v89
  v_rcp_f32 v90, v90
  v_rcp_f32 v91, v91
  s_nop 0
  v_mul_f32 v124, v124, v88
  v_mul_f32 v125, v125, v89
  v_mul_f32 v126, v126, v90
  v_mul_f32 v127, v127, v91
  v_mul_f32 v88, 0xbfb8aa3b, v128
  v_mul_f32 v89, 0xbfb8aa3b, v129
  v_mul_f32 v90, 0xbfb8aa3b, v130
  v_mul_f32 v91, 0xbfb8aa3b, v131
  v_exp_f32 v88, v88
  v_exp_f32 v89, v89
  v_exp_f32 v90, v90
  v_exp_f32 v91, v91
  s_nop 0
  v_add_f32 v88, 1.0, v88
  v_add_f32 v89, 1.0, v89
  v_add_f32 v90, 1.0, v90
  v_add_f32 v91, 1.0, v91
  v_rcp_f32 v88, v88
  v_rcp_f32 v89, v89
  v_rcp_f32 v90, v90
  v_rcp_f32 v91, v91
  s_nop 0
  v_mul_f32 v128, v128, v88
  v_mul_f32 v129, v129, v89
  v_mul_f32 v130, v130, v90
  v_mul_f32 v131, v131, v91
  v_mul_f32 v88, 0xbfb8aa3b, v132
  v_mul_f32 v89, 0xbfb8aa3b, v133
  v_mul_f32 v90, 0xbfb8aa3b, v134
  v_mul_f32 v91, 0xbfb8aa3b, v135
  v_exp_f32 v88, v88
  v_exp_f32 v89, v89
  v_exp_f32 v90, v90
  v_exp_f32 v91, v91
  s_nop 0
  v_add_f32 v88, 1.0, v88
  v_add_f32 v89, 1.0, v89
  v_add_f32 v90, 1.0, v90
  v_add_f32 v91, 1.0, v91
  v_rcp_f32 v88, v88
  v_rcp_f32 v89, v89
  v_rcp_f32 v90, v90
  v_rcp_f32 v91, v91
  s_nop 0
  v_mul_f32 v132, v132, v88
  v_mul_f32 v133, v133, v89
  v_mul_f32 v134, v134, v90
  v_mul_f32 v135, v135, v91
  v_cvt_pk_bf16_f32 v120, 0, v120
  v_cvt_pk_bf16_f32 v121, 0, v121
  v_cvt_pk_bf16_f32 v122, 0, v122
  v_cvt_pk_bf16_f32 v123, 0, v123
  v_cvt_pk_bf16_f32 v124, 0, v124
  v_cvt_pk_bf16_f32 v125, 0, v125
  v_cvt_pk_bf16_f32 v126, 0, v126
  v_cvt_pk_bf16_f32 v127, 0, v127
  v_cvt_pk_bf16_f32 v128, 0, v128
  v_cvt_pk_bf16_f32 v129, 0, v129
  v_cvt_pk_bf16_f32 v130, 0, v130
  v_cvt_pk_bf16_f32 v131, 0, v131
  v_cvt_pk_bf16_f32 v132, 0, v132
  v_cvt_pk_bf16_f32 v133, 0, v133
  v_cvt_pk_bf16_f32 v134, 0, v134
  v_cvt_pk_bf16_f32 v135, 0, v135
  v_cvt_pk_bf16_f32 v72, 0, v72
  v_cvt_pk_bf16_f32 v73, 0, v73
  v_cvt_pk_bf16_f32 v74, 0, v74
  v_cvt_pk_bf16_f32 v75, 0, v75
  v_cvt_pk_bf16_f32 v76, 0, v76
  v_cvt_pk_bf16_f32 v77, 0, v77
  v_cvt_pk_bf16_f32 v78, 0, v78
  v_cvt_pk_bf16_f32 v79, 0, v79
  v_cvt_pk_bf16_f32 v80, 0, v80
  v_cvt_pk_bf16_f32 v81, 0, v81
  v_cvt_pk_bf16_f32 v82, 0, v82
  v_cvt_pk_bf16_f32 v83, 0, v83
  v_cvt_pk_bf16_f32 v84, 0, v84
  v_cvt_pk_bf16_f32 v85, 0, v85
  v_cvt_pk_bf16_f32 v86, 0, v86
  v_cvt_pk_bf16_f32 v87, 0, v87
  v_mul_f32 v72, v72, v120
  v_mul_f32 v73, v73, v121
  v_mul_f32 v74, v74, v122
  v_mul_f32 v75, v75, v123
  v_mul_f32 v76, v76, v124
  v_mul_f32 v77, v77, v125
  v_mul_f32 v78, v78, v126
  v_mul_f32 v79, v79, v127
  v_mul_f32 v80, v80, v128
  v_mul_f32 v81, v81, v129
  v_mul_f32 v82, v82, v130
  v_mul_f32 v83, v83, v131
  v_mul_f32 v84, v84, v132
  v_mul_f32 v85, v85, v133
  v_mul_f32 v86, v86, v134
  v_mul_f32 v87, v87, v135
  v_cvt_pk_bf16_f32 v40, v72, v73
  v_cvt_pk_bf16_f32 v41, v74, v75
  v_cvt_pk_bf16_f32 v42, v76, v77
  v_cvt_pk_bf16_f32 v43, v78, v79
  v_cvt_pk_bf16_f32 v44, v80, v81
  v_cvt_pk_bf16_f32 v45, v82, v83
  v_cvt_pk_bf16_f32 v46, v84, v85
  v_cvt_pk_bf16_f32 v47, v86, v87
  v_add_u32 v3, 15360, v0
  ds_write_b128 v3, v[40:43] offset:0
  ds_write_b128 v3, v[44:47] offset:3072
  s_mov_b32 s44, s28
  s_mov_b32 s45, s29
  s_mov_b32 s46, 1409024
  s_mov_b32 s11, 2752
  s_mov_b32 s12, 1409024
  v_mov_b32 v4, 12288
  v_mov_b32 v5, 13312
  v_lshlrev_b32 v2, 4, v1
  v_add_u32 v2, 2048, v2
  s_call_b64 s[62:63], L_gv
  v_cvt_pk_bf16_f32 v120, 0, v72
  v_cvt_pk_bf16_f32 v121, 0, v73
  v_cvt_pk_bf16_f32 v122, 0, v74
  v_cvt_pk_bf16_f32 v123, 0, v75
  v_cvt_pk_bf16_f32 v124, 0, v76
  v_cvt_pk_bf16_f32 v125, 0, v77
  v_cvt_pk_bf16_f32 v126, 0, v78
  v_cvt_pk_bf16_f32 v127, 0, v79
  v_cvt_pk_bf16_f32 v128, 0, v80
  v_cvt_pk_bf16_f32 v129, 0, v81
  v_cvt_pk_bf16_f32 v130, 0, v82
  v_cvt_pk_bf16_f32 v131, 0, v83
  v_cvt_pk_bf16_f32 v132, 0, v84
  v_cvt_pk_bf16_f32 v133, 0, v85
  v_cvt_pk_bf16_f32 v134, 0, v86
  v_cvt_pk_bf16_f32 v135, 0, v87
  s_mov_b32 s44, s30
  s_mov_b32 s45, s31
  s_mov_b32 s46, 1409024
  s_mov_b32 s11, 2752
  s_mov_b32 s12, 1409024
  v_mov_b32 v4, 12288
  v_mov_b32 v5, 13312
  v_lshlrev_b32 v2, 4, v1
  v_add_u32 v2, 2048, v2
  s_call_b64 s[62:63], L_gv
  v_mul_f32 v88, 0xbfb8aa3b, v120
  v_mul_f32 v89, 0xbfb8aa3b, v121
  v_mul_f32 v90, 0xbfb8aa3b, v122
  v_mul_f32 v91, 0xbfb8aa3b, v123
  v_exp_f32 v88, v88
  v_exp_f32 v89, v89
  v_exp_f32 v90, v90
  v_exp_f32 v91, v91
  s_nop 0
  v_add_f32 v88, 1.0, v88
  v_add_f32 v89, 1.0, v89
  v_add_f32 v90, 1.0, v90
  v_add_f32 v91, 1.0, v91
  v_rcp_f32 v88, v88
  v_rcp_f32 v89, v89
  v_rcp_f32 v90, v90
  v_rcp_f32 v91, v91
  s_nop 0
  v_mul_f32 v120, v120, v88
  v_mul_f32 v121, v121, v89
  v_mul_f32 v122, v122, v90
  v_mul_f32 v123, v123, v91
  v_mul_f32 v88, 0xbfb8aa3b, v124
  v_mul_f32 v89, 0xbfb8aa3b, v125
  v_mul_f32 v90, 0xbfb8aa3b, v126
  v_mul_f32 v91, 0xbfb8aa3b, v127
  v_exp_f32 v88, v88
  v_exp_f32 v89, v89
  v_exp_f32 v90, v90
  v_exp_f32 v91, v91
  s_nop 0
  v_add_f32 v88, 1.0, v88
  v_add_f32 v89, 1.0, v89
  v_add_f32 v90, 1.0, v90
  v_add_f32 v91, 1.0, v91
  v_rcp_f32 v88, v88
  v_rcp_f32 v89, v89
  v_rcp_f32 v90, v90
  v_rcp_f32 v91, v91
  s_nop 0
  v_mul_f32 v124, v124, v88
  v_mul_f32 v125, v125, v89
  v_mul_f32 v126, v126, v90
  v_mul_f32 v127, v127, v91
  v_mul_f32 v88, 0xbfb8aa3b, v128
  v_mul_f32 v89, 0xbfb8aa3b, v129
  v_mul_f32 v90, 0xbfb8aa3b, v130
  v_mul_f32 v91, 0xbfb8aa3b, v131
  v_exp_f32 v88, v88
  v_exp_f32 v89, v89
  v_exp_f32 v90, v90
  v_exp_f32 v91, v91
  s_nop 0
  v_add_f32 v88, 1.0, v88
  v_add_f32 v89, 1.0, v89
  v_add_f32 v90, 1.0, v90
  v_add_f32 v91, 1.0, v91
  v_rcp_f32 v88, v88
  v_rcp_f32 v89, v89
  v_rcp_f32 v90, v90
  v_rcp_f32 v91, v91
  s_nop 0
  v_mul_f32 v128, v128, v88
  v_mul_f32 v129, v129, v89
  v_mul_f32 v130, v130, v90
  v_mul_f32 v131, v131, v91
  v_mul_f32 v88, 0xbfb8aa3b, v132
  v_mul_f32 v89, 0xbfb8aa3b, v133
  v_mul_f32 v90, 0xbfb8aa3b, v134
  v_mul_f32 v91, 0xbfb8aa3b, v135
  v_exp_f32 v88, v88
  v_exp_f32 v89, v89
  v_exp_f32 v90, v90
  v_exp_f32 v91, v91
  s_nop 0
  v_add_f32 v88, 1.0, v88
  v_add_f32 v89, 1.0, v89
  v_add_f32 v90, 1.0, v90
  v_add_f32 v91, 1.0, v91
  v_rcp_f32 v88, v88
  v_rcp_f32 v89, v89
  v_rcp_f32 v90, v90
  v_rcp_f32 v91, v91
  s_nop 0
  v_mul_f32 v132, v132, v88
  v_mul_f32 v133, v133, v89
  v_mul_f32 v134, v134, v90
  v_mul_f32 v135, v135, v91
  v_cvt_pk_bf16_f32 v120, 0, v120
  v_cvt_pk_bf16_f32 v121, 0, v121
  v_cvt_pk_bf16_f32 v122, 0, v122
  v_cvt_pk_bf16_f32 v123, 0, v123
  v_cvt_pk_bf16_f32 v124, 0, v124
  v_cvt_pk_bf16_f32 v125, 0, v125
  v_cvt_pk_bf16_f32 v126, 0, v126
  v_cvt_pk_bf16_f32 v127, 0, v127
  v_cvt_pk_bf16_f32 v128, 0, v128
  v_cvt_pk_bf16_f32 v129, 0, v129
  v_cvt_pk_bf16_f32 v130, 0, v130
  v_cvt_pk_bf16_f32 v131, 0, v131
  v_cvt_pk_bf16_f32 v132, 0, v132
  v_cvt_pk_bf16_f32 v133, 0, v133
  v_cvt_pk_bf16_f32 v134, 0, v134
  v_cvt_pk_bf16_f32 v135, 0, v135
  v_cvt_pk_bf16_f32 v72, 0, v72
  v_cvt_pk_bf16_f32 v73, 0, v73
  v_cvt_pk_bf16_f32 v74, 0, v74
  v_cvt_pk_bf16_f32 v75, 0, v75
  v_cvt_pk_bf16_f32 v76, 0, v76
  v_cvt_pk_bf16_f32 v77, 0, v77
  v_cvt_pk_bf16_f32 v78, 0, v78
  v_cvt_pk_bf16_f32 v79, 0, v79
  v_cvt_pk_bf16_f32 v80, 0, v80
  v_cvt_pk_bf16_f32 v81, 0, v81
  v_cvt_pk_bf16_f32 v82, 0, v82
  v_cvt_pk_bf16_f32 v83, 0, v83
  v_cvt_pk_bf16_f32 v84, 0, v84
  v_cvt_pk_bf16_f32 v85, 0, v85
  v_cvt_pk_bf16_f32 v86, 0, v86
  v_cvt_pk_bf16_f32 v87, 0, v87
  v_mul_f32 v72, v72, v120
  v_mul_f32 v73, v73, v121
  v_mul_f32 v74, v74, v122
  v_mul_f32 v75, v75, v123
  v_mul_f32 v76, v76, v124
  v_mul_f32 v77, v77, v125
  v_mul_f32 v78, v78, v126
  v_mul_f32 v79, v79, v127
  v_mul_f32 v80, v80, v128
  v_mul_f32 v81, v81, v129
  v_mul_f32 v82, v82, v130
  v_mul_f32 v83, v83, v131
  v_mul_f32 v84, v84, v132
  v_mul_f32 v85, v85, v133
  v_mul_f32 v86, v86, v134
  v_mul_f32 v87, v87, v135
  v_cvt_pk_bf16_f32 v40, v72, v73
  v_cvt_pk_bf16_f32 v41, v74, v75
  v_cvt_pk_bf16_f32 v42, v76, v77
  v_cvt_pk_bf16_f32 v43, v78, v79
  v_cvt_pk_bf16_f32 v44, v80, v81
  v_cvt_pk_bf16_f32 v45, v82, v83
  v_cvt_pk_bf16_f32 v46, v84, v85
  v_cvt_pk_bf16_f32 v47, v86, v87
  v_add_u32 v3, 16384, v0
  ds_write_b128 v3, v[40:43] offset:0
  ds_write_b128 v3, v[44:47] offset:3072
  s_mov_b32 s44, s32
  s_mov_b32 s45, s33
  s_mov_b32 s46, 1409024
  s_mov_b32 s11, 1024
  s_mov_b32 s12, 1409024
  v_mov_b32 v4, 14336
  v_mov_b32 v5, 17408
  v_lshlrev_b32 v2, 4, v1
  s_call_b64 s[62:63], L_gv
  v_lshrrev_b32 v2, 1, v1
  v_lshlrev_b32 v2, 7, v2
  v_and_b32 v3, 1, v1
  v_lshl_add_u32 v2, v3, 5, v2
  v_add_u32 v2, 24576, v2
  global_load_dwordx4 v[40:43], v2, s[42:43] offset:0 sc1
  global_load_dwordx4 v[44:47], v2, s[42:43] offset:16 sc1
  global_load_dwordx4 v[48:51], v2, s[42:43] offset:64 sc1
  global_load_dwordx4 v[52:55], v2, s[42:43] offset:80 sc1
  s_waitcnt vmcnt(0)
  v_lshlrev_b32 v88, 16, v40
  v_and_b32 v89, s73, v40
  v_lshlrev_b32 v90, 16, v42
  v_and_b32 v91, s73, v42
  v_lshlrev_b32 v92, 16, v44
  v_and_b32 v93, s73, v44
  v_lshlrev_b32 v94, 16, v46
  v_and_b32 v95, s73, v46
  v_lshlrev_b32 v96, 16, v48
  v_and_b32 v97, s73, v48
  v_lshlrev_b32 v98, 16, v50
  v_and_b32 v99, s73, v50
  v_lshlrev_b32 v100, 16, v52
  v_and_b32 v101, s73, v52
  v_lshlrev_b32 v102, 16, v54
  v_and_b32 v103, s73, v54
  v_cvt_pk_bf16_f32 v72, 0, v72
  v_cvt_pk_bf16_f32 v73, 0, v73
  v_cvt_pk_bf16_f32 v74, 0, v74
  v_cvt_pk_bf16_f32 v75, 0, v75
  v_cvt_pk_bf16_f32 v76, 0, v76
  v_cvt_pk_bf16_f32 v77, 0, v77
  v_cvt_pk_bf16_f32 v78, 0, v78
  v_cvt_pk_bf16_f32 v79, 0, v79
  v_cvt_pk_bf16_f32 v80, 0, v80
  v_cvt_pk_bf16_f32 v81, 0, v81
  v_cvt_pk_bf16_f32 v82, 0, v82
  v_cvt_pk_bf16_f32 v83, 0, v83
  v_cvt_pk_bf16_f32 v84, 0, v84
  v_cvt_pk_bf16_f32 v85, 0, v85
  v_cvt_pk_bf16_f32 v86, 0, v86
  v_cvt_pk_bf16_f32 v87, 0, v87
  v_mul_f32 v72, v72, v88
  v_mul_f32 v73, v73, v89
  v_mul_f32 v74, v74, v90
  v_mul_f32 v75, v75, v91
  v_mul_f32 v76, v76, v92
  v_mul_f32 v77, v77, v93
  v_mul_f32 v78, v78, v94
  v_mul_f32 v79, v79, v95
  v_mul_f32 v80, v80, v96
  v_mul_f32 v81, v81, v97
  v_mul_f32 v82, v82, v98
  v_mul_f32 v83, v83, v99
  v_mul_f32 v84, v84, v100
  v_mul_f32 v85, v85, v101
  v_mul_f32 v86, v86, v102
  v_mul_f32 v87, v87, v103
  v_cvt_pk_bf16_f32 v72, 0, v72
  v_cvt_pk_bf16_f32 v73, 0, v73
  v_cvt_pk_bf16_f32 v74, 0, v74
  v_cvt_pk_bf16_f32 v75, 0, v75
  v_cvt_pk_bf16_f32 v76, 0, v76
  v_cvt_pk_bf16_f32 v77, 0, v77
  v_cvt_pk_bf16_f32 v78, 0, v78
  v_cvt_pk_bf16_f32 v79, 0, v79
  v_cvt_pk_bf16_f32 v80, 0, v80
  v_cvt_pk_bf16_f32 v81, 0, v81
  v_cvt_pk_bf16_f32 v82, 0, v82
  v_cvt_pk_bf16_f32 v83, 0, v83
  v_cvt_pk_bf16_f32 v84, 0, v84
  v_cvt_pk_bf16_f32 v85, 0, v85
  v_cvt_pk_bf16_f32 v86, 0, v86
  v_cvt_pk_bf16_f32 v87, 0, v87
  v_add_f32 v104, v104, v72
  v_add_f32 v105, v105, v73
  v_add_f32 v106, v106, v74
  v_add_f32 v107, v107, v75
  v_add_f32 v108, v108, v76
  v_add_f32 v109, v109, v77
  v_add_f32 v110, v110, v78
  v_add_f32 v111, v111, v79
  v_add_f32 v112, v112, v80
  v_add_f32 v113, v113, v81
  v_add_f32 v114, v114, v82
  v_add_f32 v115, v115, v83
  v_add_f32 v116, v116, v84
  v_add_f32 v117, v117, v85
  v_add_f32 v118, v118, v86
  v_add_f32 v119, v119, v87
  v_cvt_pk_bf16_f32 v104, 0, v104
  v_cvt_pk_bf16_f32 v105, 0, v105
  v_cvt_pk_bf16_f32 v106, 0, v106
  v_cvt_pk_bf16_f32 v107, 0, v107
  v_cvt_pk_bf16_f32 v108, 0, v108
  v_cvt_pk_bf16_f32 v109, 0, v109
  v_cvt_pk_bf16_f32 v110, 0, v110
  v_cvt_pk_bf16_f32 v111, 0, v111
  v_cvt_pk_bf16_f32 v112, 0, v112
  v_cvt_pk_bf16_f32 v113, 0, v113
  v_cvt_pk_bf16_f32 v114, 0, v114
  v_cvt_pk_bf16_f32 v115, 0, v115
  v_cvt_pk_bf16_f32 v116, 0, v116
  v_cvt_pk_bf16_f32 v117, 0, v117
  v_cvt_pk_bf16_f32 v118, 0, v118
  v_cvt_pk_bf16_f32 v119, 0, v119
  v_cvt_pk_bf16_f32 v40, v104, v105
  v_cvt_pk_bf16_f32 v41, v106, v107
  v_cvt_pk_bf16_f32 v42, v108, v109
  v_cvt_pk_bf16_f32 v43, v110, v111
  v_cvt_pk_bf16_f32 v44, v112, v113
  v_cvt_pk_bf16_f32 v45, v114, v115
  v_cvt_pk_bf16_f32 v46, v116, v117
  v_cvt_pk_bf16_f32 v47, v118, v119
  global_store_dwordx4 v0, v[40:43], s[38:39] offset:0 sc1
  global_store_dwordx4 v0, v[44:47], s[38:39] offset:1024 sc1
  s_endpgm
L_gv:
  v_mov_b32 v72, 0
  v_mov_b32 v73, 0
  v_mov_b32 v74, 0
  v_mov_b32 v75, 0
  v_mov_b32 v76, 0
  v_mov_b32 v77, 0
  v_mov_b32 v78, 0
  v_mov_b32 v79, 0
  v_mov_b32 v80, 0
  v_mov_b32 v81, 0
  v_mov_b32 v82, 0
  v_mov_b32 v83, 0
  v_mov_b32 v84, 0
  v_mov_b32 v85, 0
  v_mov_b32 v86, 0
  v_mov_b32 v87, 0
  s_mov_b32 s10, 0
L_gvl:
  buffer_load_dwordx4 v[40:43], v2, s[44:47], s10 offen
  s_add_u32 s10, s10, s11
  buffer_load_dwordx4 v[44:47], v2, s[44:47], s10 offen
  s_add_u32 s10, s10, s11
  buffer_load_dwordx4 v[48:51], v2, s[44:47], s10 offen
  s_add_u32 s10, s10, s11
  buffer_load_dwordx4 v[52:55], v2, s[44:47], s10 offen
  s_add_u32 s10, s10, s11
  buffer_load_dwordx4 v[56:59], v2, s[44:47], s10 offen
  s_add_u32 s10, s10, s11
  buffer_load_dwordx4 v[60:63], v2, s[44:47], s10 offen
  s_add_u32 s10, s10, s11
  buffer_load_dwordx4 v[64:67], v2, s[44:47], s10 offen
  s_add_u32 s10, s10, s11
  buffer_load_dwordx4 v[68:71], v2, s[44:47], s10 offen
  s_add_u32 s10, s10, s11
  ds_read_b128 v[88:91], v4
  ds_read_b128 v[92:95], v5
  v_add_u32 v4, 16, v4
  v_add_u32 v5, 16, v5
  s_waitcnt lgkmcnt(0)
  v_and_b32 v8, 0xffff, v88
  v_lshlrev_b32 v9, 16, v88
  v_and_b32 v10, 0xffff, v92
  v_lshlrev_b32 v11, 16, v92
  s_waitcnt vmcnt(7)
  v_dot2c_f32_bf16 v72, v8, v40
  v_dot2c_f32_bf16 v73, v9, v40
  v_dot2c_f32_bf16 v74, v8, v41
  v_dot2c_f32_bf16 v75, v9, v41
  v_dot2c_f32_bf16 v76, v8, v42
  v_dot2c_f32_bf16 v77, v9, v42
  v_dot2c_f32_bf16 v78, v8, v43
  v_dot2c_f32_bf16 v79, v9, v43
  v_dot2c_f32_bf16 v80, v10, v40
  v_dot2c_f32_bf16 v81, v11, v40
  v_dot2c_f32_bf16 v82, v10, v41
  v_dot2c_f32_bf16 v83, v11, v41
  v_dot2c_f32_bf16 v84, v10, v42
  v_dot2c_f32_bf16 v85, v11, v42
  v_dot2c_f32_bf16 v86, v10, v43
  v_dot2c_f32_bf16 v87, v11, v43
  v_lshrrev_b32 v8, 16, v88
  v_and_b32 v9, s73, v88
  v_lshrrev_b32 v10, 16, v92
  v_and_b32 v11, s73, v92
  s_waitcnt vmcnt(6)
  v_dot2c_f32_bf16 v72, v8, v44
  v_dot2c_f32_bf16 v73, v9, v44
  v_dot2c_f32_bf16 v74, v8, v45
  v_dot2c_f32_bf16 v75, v9, v45
  v_dot2c_f32_bf16 v76, v8, v46
  v_dot2c_f32_bf16 v77, v9, v46
  v_dot2c_f32_bf16 v78, v8, v47
  v_dot2c_f32_bf16 v79, v9, v47
  v_dot2c_f32_bf16 v80, v10, v44
  v_dot2c_f32_bf16 v81, v11, v44
  v_dot2c_f32_bf16 v82, v10, v45
  v_dot2c_f32_bf16 v83, v11, v45
  v_dot2c_f32_bf16 v84, v10, v46
  v_dot2c_f32_bf16 v85, v11, v46
  v_dot2c_f32_bf16 v86, v10, v47
  v_dot2c_f32_bf16 v87, v11, v47
  v_and_b32 v8, 0xffff, v89
  v_lshlrev_b32 v9, 16, v89
  v_and_b32 v10, 0xffff, v93
  v_lshlrev_b32 v11, 16, v93
  s_waitcnt vmcnt(5)
  v_dot2c_f32_bf16 v72, v8, v48
  v_dot2c_f32_bf16 v73, v9, v48
  v_dot2c_f32_bf16 v74, v8, v49
  v_dot2c_f32_bf16 v75, v9, v49
  v_dot2c_f32_bf16 v76, v8, v50
  v_dot2c_f32_bf16 v77, v9, v50
  v_dot2c_f32_bf16 v78, v8, v51
  v_dot2c_f32_bf16 v79, v9, v51
  v_dot2c_f32_bf16 v80, v10, v48
  v_dot2c_f32_bf16 v81, v11, v48
  v_dot2c_f32_bf16 v82, v10, v49
  v_dot2c_f32_bf16 v83, v11, v49
  v_dot2c_f32_bf16 v84, v10, v50
  v_dot2c_f32_bf16 v85, v11, v50
  v_dot2c_f32_bf16 v86, v10, v51
  v_dot2c_f32_bf16 v87, v11, v51
  v_lshrrev_b32 v8, 16, v89
  v_and_b32 v9, s73, v89
  v_lshrrev_b32 v10, 16, v93
  v_and_b32 v11, s73, v93
  s_waitcnt vmcnt(4)
  v_dot2c_f32_bf16 v72, v8, v52
  v_dot2c_f32_bf16 v73, v9, v52
  v_dot2c_f32_bf16 v74, v8, v53
  v_dot2c_f32_bf16 v75, v9, v53
  v_dot2c_f32_bf16 v76, v8, v54
  v_dot2c_f32_bf16 v77, v9, v54
  v_dot2c_f32_bf16 v78, v8, v55
  v_dot2c_f32_bf16 v79, v9, v55
  v_dot2c_f32_bf16 v80, v10, v52
  v_dot2c_f32_bf16 v81, v11, v52
  v_dot2c_f32_bf16 v82, v10, v53
  v_dot2c_f32_bf16 v83, v11, v53
  v_dot2c_f32_bf16 v84, v10, v54
  v_dot2c_f32_bf16 v85, v11, v54
  v_dot2c_f32_bf16 v86, v10, v55
  v_dot2c_f32_bf16 v87, v11, v55
  v_and_b32 v8, 0xffff, v90
  v_lshlrev_b32 v9, 16, v90
  v_and_b32 v10, 0xffff, v94
  v_lshlrev_b32 v11, 16, v94
  s_waitcnt vmcnt(3)
  v_dot2c_f32_bf16 v72, v8, v56
  v_dot2c_f32_bf16 v73, v9, v56
  v_dot2c_f32_bf16 v74, v8, v57
  v_dot2c_f32_bf16 v75, v9, v57
  v_dot2c_f32_bf16 v76, v8, v58
  v_dot2c_f32_bf16 v77, v9, v58
  v_dot2c_f32_bf16 v78, v8, v59
  v_dot2c_f32_bf16 v79, v9, v59
  v_dot2c_f32_bf16 v80, v10, v56
  v_dot2c_f32_bf16 v81, v11, v56
  v_dot2c_f32_bf16 v82, v10, v57
  v_dot2c_f32_bf16 v83, v11, v57
  v_dot2c_f32_bf16 v84, v10, v58
  v_dot2c_f32_bf16 v85, v11, v58
  v_dot2c_f32_bf16 v86, v10, v59
  v_dot2c_f32_bf16 v87, v11, v59
  v_lshrrev_b32 v8, 16, v90
  v_and_b32 v9, s73, v90
  v_lshrrev_b32 v10, 16, v94
  v_and_b32 v11, s73, v94
  s_waitcnt vmcnt(2)
  v_dot2c_f32_bf16 v72, v8, v60
  v_dot2c_f32_bf16 v73, v9, v60
  v_dot2c_f32_bf16 v74, v8, v61
  v_dot2c_f32_bf16 v75, v9, v61
  v_dot2c_f32_bf16 v76, v8, v62
  v_dot2c_f32_bf16 v77, v9, v62
  v_dot2c_f32_bf16 v78, v8, v63
  v_dot2c_f32_bf16 v79, v9, v63
  v_dot2c_f32_bf16 v80, v10, v60
  v_dot2c_f32_bf16 v81, v11, v60
  v_dot2c_f32_bf16 v82, v10, v61
  v_dot2c_f32_bf16 v83, v11, v61
  v_dot2c_f32_bf16 v84, v10, v62
  v_dot2c_f32_bf16 v85, v11, v62
  v_dot2c_f32_bf16 v86, v10, v63
  v_dot2c_f32_bf16 v87, v11, v63
  v_and_b32 v8, 0xffff, v91
  v_lshlrev_b32 v9, 16, v91
  v_and_b32 v10, 0xffff, v95
  v_lshlrev_b32 v11, 16, v95
  s_waitcnt vmcnt(1)
  v_dot2c_f32_bf16 v72, v8, v64
  v_dot2c_f32_bf16 v73, v9, v64
  v_dot2c_f32_bf16 v74, v8, v65
  v_dot2c_f32_bf16 v75, v9, v65
  v_dot2c_f32_bf16 v76, v8, v66
  v_dot2c_f32_bf16 v77, v9, v66
  v_dot2c_f32_bf16 v78, v8, v67
  v_dot2c_f32_bf16 v79, v9, v67
  v_dot2c_f32_bf16 v80, v10, v64
  v_dot2c_f32_bf16 v81, v11, v64
  v_dot2c_f32_bf16 v82, v10, v65
  v_dot2c_f32_bf16 v83, v11, v65
  v_dot2c_f32_bf16 v84, v10, v66
  v_dot2c_f32_bf16 v85, v11, v66
  v_dot2c_f32_bf16 v86, v10, v67
  v_dot2c_f32_bf16 v87, v11, v67
  v_lshrrev_b32 v8, 16, v91
  v_and_b32 v9, s73, v91
  v_lshrrev_b32 v10, 16, v95
  v_and_b32 v11, s73, v95
  s_waitcnt vmcnt(0)
  v_dot2c_f32_bf16 v72, v8, v68
  v_dot2c_f32_bf16 v73, v9, v68
  v_dot2c_f32_bf16 v74, v8, v69
  v_dot2c_f32_bf16 v75, v9, v69
  v_dot2c_f32_bf16 v76, v8, v70
  v_dot2c_f32_bf16 v77, v9, v70
  v_dot2c_f32_bf16 v78, v8, v71
  v_dot2c_f32_bf16 v79, v9, v71
  v_dot2c_f32_bf16 v80, v10, v68
  v_dot2c_f32_bf16 v81, v11, v68
  v_dot2c_f32_bf16 v82, v10, v69
  v_dot2c_f32_bf16 v83, v11, v69
  v_dot2c_f32_bf16 v84, v10, v70
  v_dot2c_f32_bf16 v85, v11, v70
  v_dot2c_f32_bf16 v86, v10, v71
  v_dot2c_f32_bf16 v87, v11, v71
  s_cmp_lt_u32 s10, s12
  s_cbranch_scc1 L_gvl
  s_nop 1
  s_setpc_b64 s[62:63]
L_serv:
  s_cmp_ge_u32 s13, 4
  s_cbranch_scc1 L_team
  s_cmp_lt_u32 s13, 2
  s_cbranch_scc1 L_sv1
  s_getpc_b64 s[56:57]
L_pcc:
  s_sub_u32 s56, s56, L_pcc-adaLN_cond__sliding_block_cached__glu_gated_swiglu__decode_kernel
  s_subb_u32 s57, s57, 0
  s_lshr_b32 s3, s2, 5
  s_lshl1_add_u32 s3, s3, s13
  s_sub_u32 s3, s3, 2
  s_lshl_b32 s3, s3, 12
  v_lshl_add_u32 v2, v1, 6, s3
  v_min_u32 v2, L_end-adaLN_cond__sliding_block_cached__glu_gated_swiglu__decode_kernel, v2
  global_load_dword v3, v2, s[56:57]
  s_endpgm
L_sv1:
  v_mov_b32 v38, 0
  v_mov_b32 v4, -1
  v_mov_b32 v5, 0
  v_mov_b32 v6, 0
  v_mov_b32 v7, 0
  ds_write_b128 v38, v[4:7] offset:256
  ds_write_b64 v38, v[6:7] offset:312
  s_getreg_b32 s76, hwreg(HW_REG_XCC_ID, 0, 4)
  s_waitcnt lgkmcnt(0)
  s_load_dword s74, s[42:43], 0
  s_getpc_b64 s[56:57]
L_pc_30:
  s_lshr_b32 s3, s2, 5
  s_lshl3_add_u32 s3, s3, s8
  s_lshl_b32 s3, s3, 2
  s_add_u32 s3, s3, L_table-L_pc_30
  s_load_dword s14, s[56:57], s3
  s_barrier
  s_waitcnt lgkmcnt(0)
  s_mul_i32 s74, s74, 0x9e3779b1
  s_add_u32 s74, s74, 0x7f4a7c15
  s_bfe_u32 s32, s74, 0x80000
  s_bfe_u32 s33, s74, 0x80008
  s_bfe_u32 s34, s74, 0x80010
  s_bfe_u32 s35, s74, 0x80018
  s_cmp_eq_u32 s13, 0
  s_cbranch_scc1 L_sv0
  s_bfe_u32 s61, s14, 0x80010
  s_cmp_ge_u32 s61, 32
  s_cbranch_scc1 L_fin
  s_mov_b32 s70, 0
L_pl_31:
  ds_read_b32 v8, v38 offset:256
  s_waitcnt lgkmcnt(0)
  v_cmp_eq_u32 vcc, -1, v8
  s_cmp_eq_u64 vcc, 0
  s_cbranch_scc1 L_pld_32
  s_sleep 16
  s_add_u32 s70, s70, 1
  s_cmp_lt_u32 s70, 1048576
  s_cbranch_scc1 L_pl_31
L_pld_32:
  s_branch L_r_f2
L_sv0:
  s_add_u32 s76, s76, s74
  s_lshr_b32 s49, s2, 5
  s_lshl_b32 s50, s8, 5
  s_add_u32 s49, s49, s50
  s_lshl_b32 s49, s49, 2
  v_mov_b32 v8, s49
  v_mov_b32 v9, s76
  s_mov_b64 exec, 1
  global_store_dword v8, v9, s[42:43] offset:1024 sc1
  s_mov_b64 exec, -1
  s_lshl_b32 s54, s6, 9
  s_add_u32 s54, s54, 0
  s_lshl_b32 s55, s6, 9
  s_add_u32 s55, s55, 128
  s_lshl_b32 s56, s6, 9
  s_add_u32 s56, s56, 256
  s_mov_b32 s70, 0
L_sn_33:
  ds_read_b32 v8, v38 offset:312
  s_waitcnt lgkmcnt(0)
  v_cmp_gt_u32 vcc, 0x8, v8
  s_cmp_eq_u64 vcc, 0
  s_cbranch_scc1 L_snd_34
  s_sleep 16
  s_add_u32 s70, s70, 1
  s_cmp_lt_u32 s70, 2097152
  s_cbranch_scc1 L_sn_33
L_snd_34:
  s_load_dwordx2 s[20:21], s[42:43], s54 offset:65536 glc
  s_mov_b32 s70, 0
  s_branch L_s3wc
L_s3w:
  s_load_dwordx2 s[20:21], s[42:43], s54 offset:65536 glc
L_s3wc:
  s_waitcnt lgkmcnt(0)
  s_xor_b32 s68, s21, s74
  s_cbranch_scc0 L_s3wd
  s_sleep 8
  s_add_u32 s70, s70, 1
  s_cmp_lt_u32 s70, 262144
  s_cbranch_scc1 L_s3w
L_s3wd:
  v_mov_b32 v8, 1
  ds_write_b32 v38, v8 offset:260
  s_mov_b32 s70, 0
L_sn_35:
  ds_read_b32 v8, v38 offset:312
  s_waitcnt lgkmcnt(0)
  v_cmp_gt_u32 vcc, 0xc, v8
  s_cmp_eq_u64 vcc, 0
  s_cbranch_scc1 L_snd_36
  s_sleep 16
  s_add_u32 s70, s70, 1
  s_cmp_lt_u32 s70, 2097152
  s_cbranch_scc1 L_sn_35
L_snd_36:
  s_load_dwordx2 s[20:21], s[42:43], s54 offset:98304 glc
  s_load_dwordx2 s[24:25], s[42:43], s55 offset:98304 glc
  s_load_dwordx2 s[28:29], s[42:43], s56 offset:98304 glc
  s_mov_b32 s70, 0
  s_branch L_s3sc
L_s3s:
  s_load_dwordx2 s[20:21], s[42:43], s54 offset:98304 glc
  s_load_dwordx2 s[24:25], s[42:43], s55 offset:98304 glc
  s_load_dwordx2 s[28:29], s[42:43], s56 offset:98304 glc
L_s3sc:
  s_waitcnt lgkmcnt(0)
  s_xor_b32 s68, s21, s74
  s_xor_b32 s69, s25, s74
  s_or_b32 s68, s68, s69
  s_xor_b32 s69, s29, s74
  s_or_b32 s68, s68, s69
  s_cbranch_scc0 L_s3sd
  s_sleep 8
  s_add_u32 s70, s70, 1
  s_cmp_lt_u32 s70, 262144
  s_cbranch_scc1 L_s3s
L_s3sd:
  ds_write_b32 v38, v38 offset:256
  s_branch L_fin
L_team:
  s_and_b32 s5, s13, 3
  v_and_b32 v0, 0xff, v0
  v_mov_b32 v38, 0
  s_mov_b32 s77, 0
  s_lshr_b32 s60, s2, 5
  v_lshrrev_b32 v12, 3, v0
  v_lshlrev_b32 v12, 5, v12
  v_bfe_u32 v3, v1, 2, 1
  v_lshl_add_u32 v12, v3, 10, v12
  v_and_b32 v8, 3, v1
  v_lshl_add_u32 v37, v8, 3, v12
  v_and_b32 v12, 0xffffffdf, v12
  v_lshl_add_u32 v12, v8, 4, v12
  v_bfe_u32 v8, v1, 3, 1
  v_lshl_add_u32 v12, v8, 3, v12
  v_lshl_add_u32 v12, v3, 5, v12
  s_waitcnt lgkmcnt(0)
  s_load_dword s74, s[42:43], 0
  s_barrier
  s_cmp_ge_u32 s13, 8
  s_cbranch_scc1 L_r_mod
L_r_q:
  s_lshl3_add_u32 s61, s8, s60
  s_lshl_b32 s48, s61, 7
  s_lshl_b32 s58, s61, 8
  s_add_u32 s58, s58, 32768
  global_load_dwordx2 v[14:15], v37, s[16:17]
  s_mov_b32 s44, s22
  s_mov_b32 s45, s23
  s_mov_b32 s46, 4194304
  s_mov_b32 s47, 0x20000
  s_cmp_ge_u32 s60, 2
  s_cbranch_scc1 L_q_go
  s_mov_b32 s70, 0
L_sn_37:
  ds_read_b32 v8, v38 offset:268
  s_waitcnt lgkmcnt(0)
  v_cmp_gt_u32 vcc, 0x4, v8
  s_cmp_eq_u64 vcc, 0
  s_cbranch_scc1 L_snd_38
  s_sleep 1
  s_add_u32 s70, s70, 1
  s_cmp_lt_u32 s70, 2097152
  s_cbranch_scc1 L_sn_37
L_snd_38:
L_q_go:
  v_lshrrev_b32 v2, 3, v1
  v_and_b32 v3, 6, v2
  v_xor_b32 v3, v3, v1
  v_mul_u32_u24 v2, 8192, v2
  v_and_b32 v3, 7, v3
  v_lshl_add_u32 v2, v3, 4, v2
  s_mul_i32 s49, s5, 1048576
  s_lshl_b32 s50, s5, 14
  s_add_u32 s49, s49, s48
  s_add_u32 s50, s50, 12288
  s_add_u32 s51, s50, 16384
L_dma_39:
  s_mov_b32 m0, s50
  s_add_u32 s50, s50, 1024
  buffer_load_dwordx4 v2, s[44:47], s49 offen nt lds
  s_add_u32 s49, s49, 65536
  s_cmp_lt_u32 s50, s51
  s_cbranch_scc1 L_dma_39
L_dmae_40:
  v_mov_b32 v3, 1
  s_mov_b64 exec, 1
  ds_add_u32 v38, v3 offset:264
  s_mov_b64 exec, -1
  s_waitcnt lgkmcnt(0)
  s_mul_i32 s74, s74, 0x9e3779b1
  s_add_u32 s74, s74, 0x7f4a7c15
  v_bfe_u32 v6, v1, 2, 1
  v_lshlrev_b32 v6, 5, v6
  v_add_u32 v6, 3136, v6
  s_lshl_b32 s49, s5, 3
  v_add_u32 v5, s49, v6
  s_waitcnt vmcnt(16)
  v_lshlrev_b32 v20, 16, v14
  v_and_b32 v21, s73, v14
  v_lshlrev_b32 v22, 16, v15
  v_and_b32 v23, s73, v15
  v_add_f32 v8, v20, v21
  v_mul_f32 v9, v20, v20
  v_add_f32 v10, v22, v23
  v_mul_f32 v11, v22, v22
  v_fmac_f32 v9, v21, v21
  v_fmac_f32 v11, v23, v23
  v_add_f32 v8, v8, v10
  v_add_f32 v9, v9, v11
  s_nop 0
  v_add_f32_dpp v8, v8, v8 quad_perm:[1,0,3,2] row_mask:0xf bank_mask:0xf
  v_add_f32_dpp v9, v9, v9 quad_perm:[1,0,3,2] row_mask:0xf bank_mask:0xf
  s_nop 0
  v_add_f32_dpp v8, v8, v8 quad_perm:[2,3,0,1] row_mask:0xf bank_mask:0xf
  v_add_f32_dpp v9, v9, v9 quad_perm:[2,3,0,1] row_mask:0xf bank_mask:0xf
  s_nop 0
  v_add_f32_dpp v8, v8, v8 row_ror:8 row_mask:0xf bank_mask:0xf
  v_add_f32_dpp v9, v9, v9 row_ror:8 row_mask:0xf bank_mask:0xf
  s_nop 0
  v_mov_b32 v10, v8
  v_mov_b32 v11, v9
  s_nop 0
  v_permlane16_swap_b32 v10, v8
  v_permlane16_swap_b32 v11, v9
  v_add_f32 v8, v8, v10
  v_add_f32 v9, v9, v11
  v_mov_b32 v10, v8
  v_mov_b32 v11, v9
  s_nop 0
  v_permlane32_swap_b32 v10, v8
  v_permlane32_swap_b32 v11, v9
  v_add_f32 v8, v8, v10
  v_add_f32 v9, v9, v11
  ds_write_b64 v5, v[8:9]
  s_waitcnt vmcnt(0) lgkmcnt(0)
  s_add_u32 s77, s77, 4
  v_mov_b32 v9, 1
  s_mov_b64 exec, 1
  ds_add_u32 v38, v9 offset:312
  s_mov_b64 exec, -1
  s_mov_b32 s70, 0
L_hy_41:
  ds_read_b32 v9, v38 offset:312
  s_waitcnt lgkmcnt(0)
  v_cmp_gt_u32 vcc, s77, v9
  s_cmp_eq_u64 vcc, 0
  s_cbranch_scc1 L_hyd_42
  s_add_u32 s70, s70, 1
  s_cmp_lt_u32 s70, 2097152
  s_cbranch_scc1 L_hy_41
L_hyd_42:
  ds_read_b128 v[24:27], v6
  ds_read_b128 v[28:31], v6 offset:16
  s_waitcnt lgkmcnt(0)
  v_pk_add_f32 v[24:25], v[24:25], v[26:27]
  v_pk_add_f32 v[28:29], v[28:29], v[30:31]
  v_pk_add_f32 v[24:25], v[24:25], v[28:29]
  v_mul_f32 v8, 0x3b000000, v24
  v_mul_f32 v9, 0x3b000000, v25
  v_fma_f32 v9, -v8, v8, v9
  v_cvt_pk_bf16_f32 v8, 0, v8
  v_max_f32 v9, 0, v9
  v_cvt_pk_bf16_f32 v9, 0, v9
  v_sub_f32 v20, v20, v8
  v_sub_f32 v21, v21, v8
  v_add_f32 v9, 0x3727c5ac, v9
  v_sub_f32 v22, v22, v8
  v_sub_f32 v23, v23, v8
  v_cvt_pk_bf16_f32 v9, 0, v9
  v_cvt_pk_bf16_f32 v20, 0, v20
  v_sqrt_f32 v9, v9
  v_cvt_pk_bf16_f32 v21, 0, v21
  v_cvt_pk_bf16_f32 v9, 0, v9
  v_cvt_pk_bf16_f32 v22, 0, v22
  v_rcp_f32 v9, v9
  v_cvt_pk_bf16_f32 v23, 0, v23
  v_mul_f32 v20, v20, v9
  v_mul_f32 v21, v21, v9
  v_mul_f32 v22, v22, v9
  v_mul_f32 v23, v23, v9
  v_cvt_pk_bf16_f32 v20, 0, v20
  v_cvt_pk_bf16_f32 v21, 0, v21
  v_cvt_pk_bf16_f32 v22, 0, v22
  v_cvt_pk_bf16_f32 v23, 0, v23
  s_lshl_b32 s49, s8, 13
  s_add_u32 s49, s49, 917504
  v_lshl_add_u32 v15, v0, 4, s49
  v_add_u32 v36, 0x1000, v15
  s_mov_b64 s[64:65], -1
  s_mov_b64 s[66:67], -1
  s_mov_b64 exec, s[64:65]
  global_load_dwordx4 v[16:19], v15, s[42:43] sc1
  s_mov_b64 exec, s[66:67]
  global_load_dwordx4 v[32:35], v36, s[42:43] sc1
  s_mov_b64 exec, -1
  v_lshrrev_b32 v2, 2, v1
  v_bfe_u32 v3, v1, 1, 1
  s_lshl_b32 s49, s5, 1
  v_or_b32 v3, s49, v3
  v_and_b32 v10, 6, v2
  v_xor_b32 v3, v3, v10
  v_lshlrev_b32 v2, 7, v2
  v_lshl_add_u32 v2, v3, 4, v2
  v_and_b32 v3, 1, v1
  v_lshl_add_u32 v2, v3, 3, v2
  v_add_u32 v2, 12288, v2
  ds_read_b64_tr_b16 v[40:41], v2 offset:0
  ds_read_b64_tr_b16 v[42:43], v2 offset:2048
  ds_read_b64_tr_b16 v[44:45], v2 offset:4096
  ds_read_b64_tr_b16 v[46:47], v2 offset:6144
  ds_read_b64_tr_b16 v[48:49], v2 offset:8192
  ds_read_b64_tr_b16 v[50:51], v2 offset:10240
  ds_read_b64_tr_b16 v[52:53], v2 offset:12288
  ds_read_b64_tr_b16 v[54:55], v2 offset:14336
  ds_read_b64_tr_b16 v[56:57], v2 offset:16384
  ds_read_b64_tr_b16 v[58:59], v2 offset:18432
  ds_read_b64_tr_b16 v[60:61], v2 offset:20480
  ds_read_b64_tr_b16 v[62:63], v2 offset:22528
  s_waitcnt lgkmcnt(10)
  ds_read_b64_tr_b16 v[64:65], v2 offset:24576
  ds_read_b64_tr_b16 v[66:67], v2 offset:26624
  s_waitcnt lgkmcnt(10)
  ds_read_b64_tr_b16 v[68:69], v2 offset:28672
  ds_read_b64_tr_b16 v[70:71], v2 offset:30720
  s_waitcnt lgkmcnt(10)
  ds_read_b64_tr_b16 v[72:73], v2 offset:32768
  ds_read_b64_tr_b16 v[74:75], v2 offset:34816
  s_waitcnt lgkmcnt(10)
  ds_read_b64_tr_b16 v[76:77], v2 offset:36864
  ds_read_b64_tr_b16 v[78:79], v2 offset:38912
  s_waitcnt lgkmcnt(10)
  ds_read_b64_tr_b16 v[80:81], v2 offset:40960
  ds_read_b64_tr_b16 v[82:83], v2 offset:43008
  s_waitcnt lgkmcnt(10)
  ds_read_b64_tr_b16 v[84:85], v2 offset:45056
  ds_read_b64_tr_b16 v[86:87], v2 offset:47104
  s_waitcnt lgkmcnt(10)
  ds_read_b64_tr_b16 v[88:89], v2 offset:49152
  ds_read_b64_tr_b16 v[90:91], v2 offset:51200
  s_waitcnt lgkmcnt(10)
  ds_read_b64_tr_b16 v[92:93], v2 offset:53248
  ds_read_b64_tr_b16 v[94:95], v2 offset:55296
  s_waitcnt lgkmcnt(10)
  ds_read_b64_tr_b16 v[96:97], v2 offset:57344
  ds_read_b64_tr_b16 v[98:99], v2 offset:59392
  s_waitcnt lgkmcnt(10)
  ds_read_b64_tr_b16 v[100:101], v2 offset:61440
  ds_read_b64_tr_b16 v[102:103], v2 offset:63488
  s_waitcnt lgkmcnt(10)
  s_waitcnt lgkmcnt(0)
  v_and_b32 v13, 1, v1
  v_lshlrev_b32 v13, 14, v13
  v_lshrrev_b32 v3, 4, v1
  v_lshl_add_u32 v13, v3, 4, v13
  s_lshl_b32 s49, s5, 6
  s_add_u32 s49, s49, s58
  v_add_u32 v13, s49, v13
  v_and_b32 v14, 1, v1
  v_mul_u32_u24 v14, 1056, v14
  v_lshrrev_b32 v3, 4, v1
  v_lshl_add_u32 v14, v3, 4, v14
  v_add_u32 v14, 1024, v14
  s_mov_b32 s70, 0
  s_branch L_q_c
L_q_p:
  s_mov_b64 exec, s[64:65]
  global_load_dwordx4 v[16:19], v15, s[42:43] sc1
  s_mov_b64 exec, s[66:67]
  global_load_dwordx4 v[32:35], v36, s[42:43] sc1
  s_mov_b64 exec, -1
L_q_c:
  s_waitcnt vmcnt(0)
  v_cmp_ne_u32 s[64:65], s74, v17
  v_cmp_ne_u32 s[68:69], s74, v19
  s_or_b64 s[64:65], s[64:65], s[68:69]
  v_cmp_ne_u32 s[66:67], s74, v33
  v_cmp_ne_u32 s[68:69], s74, v35
  s_or_b64 s[66:67], s[66:67], s[68:69]
  s_or_b64 vcc, s[64:65], s[66:67]
  s_or_b32 s64, s64, 1
  s_or_b32 s66, s66, 1
  s_cmp_eq_u64 vcc, 0
  s_cbranch_scc1 L_q_ok
  s_sleep 2
  s_add_u32 s70, s70, 1
  s_cmp_lt_u32 s70, 262144
  s_cbranch_scc1 L_q_p
L_q_ok:
  v_lshlrev_b32 v28, 16, v32
  v_and_b32 v29, s73, v32
  v_lshlrev_b32 v30, 16, v34
  v_and_b32 v31, s73, v34
  v_lshlrev_b32 v24, 16, v16
  v_and_b32 v25, s73, v16
  v_lshlrev_b32 v26, 16, v18
  v_and_b32 v27, s73, v18
  v_add_f32 v28, 1.0, v28
  v_add_f32 v29, 1.0, v29
  v_add_f32 v30, 1.0, v30
  v_add_f32 v31, 1.0, v31
  v_cvt_pk_bf16_f32 v28, 0, v28
  v_cvt_pk_bf16_f32 v29, 0, v29
  v_cvt_pk_bf16_f32 v30, 0, v30
  v_cvt_pk_bf16_f32 v31, 0, v31
  v_mul_f32 v20, v20, v28
  v_mul_f32 v21, v21, v29
  v_mul_f32 v22, v22, v30
  v_mul_f32 v23, v23, v31
  v_cvt_pk_bf16_f32 v20, 0, v20
  v_cvt_pk_bf16_f32 v21, 0, v21
  v_cvt_pk_bf16_f32 v22, 0, v22
  v_cvt_pk_bf16_f32 v23, 0, v23
  v_add_f32 v20, v20, v24
  v_add_f32 v21, v21, v25
  v_add_f32 v22, v22, v26
  v_add_f32 v23, v23, v27
  v_cvt_pk_bf16_f32 v16, v20, v21
  v_cvt_pk_bf16_f32 v17, v22, v23
  ds_write_b64 v12, v[16:17] offset:1024
  s_add_u32 s77, s77, 4
  v_mov_b32 v9, 1
  s_mov_b64 exec, 1
  ds_add_u32 v38, v9 offset:312
  s_mov_b64 exec, -1
  s_mov_b32 s70, 0
L_hy_43:
  ds_read_b32 v9, v38 offset:312
  s_waitcnt lgkmcnt(0)
  v_cmp_gt_u32 vcc, s77, v9
  s_cmp_eq_u64 vcc, 0
  s_cbranch_scc1 L_hyd_44
  s_add_u32 s70, s70, 1
  s_cmp_lt_u32 s70, 2097152
  s_cbranch_scc1 L_hy_43
L_hyd_44:
  ds_read_b128 v[104:107], v14 offset:0
  ds_read_b128 v[108:111], v14 offset:64
  ds_read_b128 v[112:115], v14 offset:128
  ds_read_b128 v[116:119], v14 offset:192
  ds_read_b128 v[120:123], v14 offset:256
  ds_read_b128 v[124:127], v14 offset:320
  ds_read_b128 v[128:131], v14 offset:384
  ds_read_b128 v[132:135], v14 offset:448
  ds_read_b128 v[136:139], v14 offset:512
  ds_read_b128 v[140:143], v14 offset:576
  ds_read_b128 v[144:147], v14 offset:640
  ds_read_b128 v[148:151], v14 offset:704
  s_waitcnt lgkmcnt(11)
  v_mfma_f32_16x16x32_bf16 v[8:11], v[40:43], v[104:107], 0
  ds_read_b128 v[152:155], v14 offset:768
  s_waitcnt lgkmcnt(11)
  v_mfma_f32_16x16x32_bf16 v[8:11], v[44:47], v[108:111], v[8:11]
  ds_read_b128 v[156:159], v14 offset:832
  s_waitcnt lgkmcnt(11)
  v_mfma_f32_16x16x32_bf16 v[8:11], v[48:51], v[112:115], v[8:11]
  ds_read_b128 v[160:163], v14 offset:896
  s_waitcnt lgkmcnt(11)
  v_mfma_f32_16x16x32_bf16 v[8:11], v[52:55], v[116:119], v[8:11]
  ds_read_b128 v[164:167], v14 offset:960
  s_waitcnt lgkmcnt(11)
  v_mfma_f32_16x16x32_bf16 v[8:11], v[56:59], v[120:123], v[8:11]
  s_waitcnt lgkmcnt(10)
  v_mfma_f32_16x16x32_bf16 v[8:11], v[60:63], v[124:127], v[8:11]
  s_waitcnt lgkmcnt(9)
  v_mfma_f32_16x16x32_bf16 v[8:11], v[64:67], v[128:131], v[8:11]
  s_waitcnt lgkmcnt(8)
  v_mfma_f32_16x16x32_bf16 v[8:11], v[68:71], v[132:135], v[8:11]
  s_waitcnt lgkmcnt(7)
  v_mfma_f32_16x16x32_bf16 v[8:11], v[72:75], v[136:139], v[8:11]
  s_waitcnt lgkmcnt(6)
  v_mfma_f32_16x16x32_bf16 v[8:11], v[76:79], v[140:143], v[8:11]
  s_waitcnt lgkmcnt(5)
  v_mfma_f32_16x16x32_bf16 v[8:11], v[80:83], v[144:147], v[8:11]
  s_waitcnt lgkmcnt(4)
  v_mfma_f32_16x16x32_bf16 v[8:11], v[84:87], v[148:151], v[8:11]
  s_waitcnt lgkmcnt(3)
  v_mfma_f32_16x16x32_bf16 v[8:11], v[88:91], v[152:155], v[8:11]
  s_waitcnt lgkmcnt(2)
  v_mfma_f32_16x16x32_bf16 v[8:11], v[92:95], v[156:159], v[8:11]
  s_waitcnt lgkmcnt(1)
  v_mfma_f32_16x16x32_bf16 v[8:11], v[96:99], v[160:163], v[8:11]
  s_waitcnt lgkmcnt(0)
  v_mfma_f32_16x16x32_bf16 v[8:11], v[100:103], v[164:167], v[8:11]
  s_nop 7
  v_cvt_pk_bf16_f32 v8, v8, v9
  v_cvt_pk_bf16_f32 v10, v10, v11
  v_mov_b32 v9, s74
  v_mov_b32 v11, s74
  v_min_u32 v8, s72, v8
  v_min_u32 v10, s72, v10
  s_mov_b32 exec_lo, 0x00030003
  s_mov_b32 exec_hi, 0x00030003
  global_store_dwordx4 v13, v[8:11], s[42:43] sc1
  s_mov_b64 exec, -1
L_r_wo:
  s_xor_b32 s61, s60, 1
  s_lshl_b32 s48, s8, 19
  s_lshl_b32 s49, s61, 7
  s_add_u32 s48, s48, s49
  s_lshr_b32 s58, s8, 1
  s_lshl_b32 s58, s58, 14
  s_and_b32 s49, s8, 1
  s_lshl_b32 s49, s49, 12
  s_add_u32 s58, s58, s49
  s_lshl_b32 s49, s61, 9
  s_add_u32 s58, s58, s49
  s_add_u32 s58, s58, 2097152
  s_mov_b32 s44, s24
  s_mov_b32 s45, s25
  s_mov_b32 s46, 4194304
  s_mov_b32 s47, 0x20000
  v_lshrrev_b32 v2, 3, v1
  v_and_b32 v3, 6, v2
  v_xor_b32 v3, v3, v1
  v_mul_u32_u24 v2, 1024, v2
  v_and_b32 v3, 7, v3
  v_lshl_add_u32 v2, v3, 4, v2
  s_mul_i32 s49, s5, 131072
  s_lshl_b32 s50, s5, 14
  s_add_u32 s49, s49, s48
  s_add_u32 s50, s50, 12288
  s_add_u32 s51, s50, 16384
L_dma_45:
  s_mov_b32 m0, s50
  s_add_u32 s50, s50, 1024
  buffer_load_dwordx4 v2, s[44:47], s49 offen nt lds
  s_add_u32 s49, s49, 8192
  s_waitcnt vmcnt(2)
  s_cmp_lt_u32 s50, s51
  s_cbranch_scc1 L_dma_45
L_dmae_46:
  s_bfe_u32 s32, s74, 0x80000
  s_bfe_u32 s33, s74, 0x80008
  s_bfe_u32 s34, s74, 0x80010
  s_bfe_u32 s35, s74, 0x80018
  s_lshl2_add_u32 s49, s8, s5
  s_lshl_b32 s49, s49, 11
  s_add_u32 s49, s49, 131072
  v_lshrrev_b32 v12, 5, v1
  v_and_b32 v16, 31, v1
  v_lshlrev_b32 v15, 16, v12
  v_lshl_add_u32 v15, v16, 4, v15
  v_add_u32 v15, s49, v15
  v_mul_u32_u24 v12, 1056, v12
  v_bfe_u32 v16, v1, 3, 2
  v_lshl_add_u32 v12, v16, 6, v12
  v_and_b32 v16, 3, v1
  v_lshl_add_u32 v12, v16, 4, v12
  v_bfe_u32 v16, v1, 2, 1
  v_lshl_add_u32 v12, v16, 3, v12
  s_lshl_b32 s49, s5, 8
  v_add_u32 v12, s49, v12
  v_and_b32 v13, 1, v1
  v_lshlrev_b32 v13, 6, v13
  v_lshrrev_b32 v3, 4, v1
  v_lshl_add_u32 v13, v3, 4, v13
  s_lshl_b32 s49, s5, 7
  s_add_u32 s49, s49, s58
  v_add_u32 v13, s49, v13
  v_bfe_u32 v3, v1, 1, 1
  v_lshl_add_u32 v13, v3, 16, v13
  v_mov_b32 v36, 0xff
  global_load_dword v11, v13, s[42:43] sc1
  s_waitcnt vmcnt(0)
  s_add_u32 s77, s77, 4
  v_mov_b32 v9, 1
  s_mov_b64 exec, 1
  ds_add_u32 v38, v9 offset:312
  s_mov_b64 exec, -1
  s_mov_b32 s70, 0
L_hy_47:
  ds_read_b32 v9, v38 offset:312
  s_waitcnt lgkmcnt(0)
  v_cmp_gt_u32 vcc, s77, v9
  s_cmp_eq_u64 vcc, 0
  s_cbranch_scc1 L_hyd_48
  s_sleep 4
  s_add_u32 s70, s70, 1
  s_cmp_lt_u32 s70, 2097152
  s_cbranch_scc1 L_hy_47
L_hyd_48:
  v_lshrrev_b32 v2, 2, v1
  v_bfe_u32 v3, v1, 1, 1
  s_lshl_b32 s49, s5, 1
  v_or_b32 v3, s49, v3
  v_and_b32 v10, 6, v2
  v_xor_b32 v3, v3, v10
  v_lshlrev_b32 v2, 7, v2
  v_lshl_add_u32 v2, v3, 4, v2
  v_and_b32 v3, 1, v1
  v_lshl_add_u32 v2, v3, 3, v2
  v_add_u32 v2, 12288, v2
  ds_read_b64_tr_b16 v[40:41], v2 offset:0
  ds_read_b64_tr_b16 v[42:43], v2 offset:2048
  ds_read_b64_tr_b16 v[44:45], v2 offset:4096
  ds_read_b64_tr_b16 v[46:47], v2 offset:6144
  ds_read_b64_tr_b16 v[48:49], v2 offset:8192
  ds_read_b64_tr_b16 v[50:51], v2 offset:10240
  ds_read_b64_tr_b16 v[52:53], v2 offset:12288
  ds_read_b64_tr_b16 v[54:55], v2 offset:14336
  ds_read_b64_tr_b16 v[56:57], v2 offset:16384
  ds_read_b64_tr_b16 v[58:59], v2 offset:18432
  ds_read_b64_tr_b16 v[60:61], v2 offset:20480
  ds_read_b64_tr_b16 v[62:63], v2 offset:22528
  s_waitcnt lgkmcnt(10)
  ds_read_b64_tr_b16 v[64:65], v2 offset:24576
  ds_read_b64_tr_b16 v[66:67], v2 offset:26624
  s_waitcnt lgkmcnt(10)
  ds_read_b64_tr_b16 v[68:69], v2 offset:28672
  ds_read_b64_tr_b16 v[70:71], v2 offset:30720
  s_waitcnt lgkmcnt(10)
  ds_read_b64_tr_b16 v[72:73], v2 offset:32768
  ds_read_b64_tr_b16 v[74:75], v2 offset:34816
  s_waitcnt lgkmcnt(10)
  ds_read_b64_tr_b16 v[76:77], v2 offset:36864
  ds_read_b64_tr_b16 v[78:79], v2 offset:38912
  s_waitcnt lgkmcnt(10)
  ds_read_b64_tr_b16 v[80:81], v2 offset:40960
  ds_read_b64_tr_b16 v[82:83], v2 offset:43008
  s_waitcnt lgkmcnt(10)
  ds_read_b64_tr_b16 v[84:85], v2 offset:45056
  ds_read_b64_tr_b16 v[86:87], v2 offset:47104
  s_waitcnt lgkmcnt(10)
  ds_read_b64_tr_b16 v[88:89], v2 offset:49152
  ds_read_b64_tr_b16 v[90:91], v2 offset:51200
  s_waitcnt lgkmcnt(10)
  ds_read_b64_tr_b16 v[92:93], v2 offset:53248
  ds_read_b64_tr_b16 v[94:95], v2 offset:55296
  s_waitcnt lgkmcnt(10)
  ds_read_b64_tr_b16 v[96:97], v2 offset:57344
  ds_read_b64_tr_b16 v[98:99], v2 offset:59392
  s_waitcnt lgkmcnt(10)
  ds_read_b64_tr_b16 v[100:101], v2 offset:61440
  ds_read_b64_tr_b16 v[102:103], v2 offset:63488
  s_waitcnt lgkmcnt(10)
  s_waitcnt lgkmcnt(0)
  s_mov_b32 s70, 0
L_pl_49:
  ds_read_b32 v8, v38 offset:256
  s_waitcnt lgkmcnt(0)
  v_cmp_eq_u32 vcc, -1, v8
  s_cmp_eq_u64 vcc, 0
  s_cbranch_scc1 L_pld_50
  s_sleep 8
  s_add_u32 s70, s70, 1
  s_cmp_lt_u32 s70, 1048576
  s_cbranch_scc1 L_pl_49
L_pld_50:
  s_mov_b64 s[20:21], -1
  s_mov_b64 s[22:23], -1
  s_mov_b64 s[24:25], -1
  s_mov_b64 exec, s[20:21]
  global_load_dwordx4 v[152:155], v15, s[42:43] offset:0 sc1
  s_mov_b64 exec, s[22:23]
  global_load_dwordx4 v[156:159], v15, s[42:43] offset:512 sc1
  s_mov_b64 exec, s[24:25]
  global_load_dwordx4 v[160:163], v15, s[42:43] offset:1024 sc1
  s_mov_b64 exec, -1
  s_waitcnt vmcnt(0)
  s_mov_b32 s70, 0
  s_branch L_wo_c
L_wo_:
  s_mov_b64 exec, s[20:21]
  global_load_dwordx4 v[152:155], v15, s[42:43] offset:0 sc1
  s_mov_b64 exec, s[22:23]
  global_load_dwordx4 v[156:159], v15, s[42:43] offset:512 sc1
  s_mov_b64 exec, s[24:25]
  global_load_dwordx4 v[160:163], v15, s[42:43] offset:1024 sc1
  s_mov_b64 exec, -1
  s_waitcnt vmcnt(0)
L_wo_c:
  v_xor_b32 v136, s32, v152
  v_xor_b32 v137, s33, v153
  v_xor_b32 v138, s34, v154
  v_xor_b32 v139, s35, v155
  v_xor_b32 v140, s32, v156
  v_xor_b32 v141, s33, v157
  v_xor_b32 v142, s34, v158
  v_xor_b32 v143, s35, v159
  v_xor_b32 v144, s32, v160
  v_xor_b32 v145, s33, v161
  v_xor_b32 v146, s34, v162
  v_xor_b32 v147, s35, v163
  v_or3_b32 v28, v136, v137, v138
  v_or3_b32 v29, v140, v141, v142
  v_or3_b32 v30, v144, v145, v146
  v_or_b32 v28, v28, v139
  v_or_b32 v29, v29, v143
  v_or_b32 v30, v30, v147
  v_cmp_ne_u32_sdwa s[20:21], v28, v38 src0_sel:BYTE_0 src1_sel:DWORD
  v_cmp_ne_u32_sdwa s[22:23], v29, v38 src0_sel:BYTE_0 src1_sel:DWORD
  v_cmp_ne_u32_sdwa s[24:25], v30, v38 src0_sel:BYTE_0 src1_sel:DWORD
  v_or_b32 v136, 0x80, v136
  v_or_b32 v137, 0x80, v137
  v_or_b32 v138, 0x80, v138
  v_or_b32 v139, 0x80, v139
  v_or_b32 v140, 0x80, v140
  v_or_b32 v141, 0x80, v141
  v_or_b32 v142, 0x80, v142
  v_or_b32 v143, 0x80, v143
  v_or_b32 v144, 0x80, v144
  v_or_b32 v145, 0x80, v145
  v_or_b32 v146, 0x80, v146
  v_or_b32 v147, 0x80, v147
  v_pk_add_f32 v[16:17], v[136:137], v[140:141]
  v_pk_add_f32 v[18:19], v[138:139], v[142:143]
  v_pk_add_f32 v[16:17], v[16:17], v[144:145]
  v_pk_add_f32 v[18:19], v[18:19], v[146:147]
  s_mov_b64 vcc, s[20:21]
  s_or_b64 vcc, vcc, s[22:23]
  s_or_b64 vcc, vcc, s[24:25]
  s_or_b32 s20, s20, 1
  s_or_b32 s22, s22, 1
  s_or_b32 s24, s24, 1
  s_cmp_eq_u64 vcc, 0
  s_cbranch_scc1 L_wo_ok
  s_add_u32 s70, s70, 1
  s_cmp_lt_u32 s70, 262144
  s_cbranch_scc1 L_wo_
L_wo_ok:
  v_cvt_pk_bf16_f32 v8, v16, v17
  v_cvt_pk_bf16_f32 v9, v18, v19
  ds_write_b64 v12, v[8:9] offset:1024
  s_add_u32 s77, s77, 4
  v_mov_b32 v3, 1
  s_mov_b64 exec, 1
  ds_add_u32 v38, v3 offset:312
  s_mov_b64 exec, -1
  s_mov_b32 s70, 0
L_hy_51:
  ds_read_b32 v3, v38 offset:312
  ds_read_b128 v[104:107], v14 offset:0
  ds_read_b128 v[108:111], v14 offset:64
  ds_read_b128 v[112:115], v14 offset:128
  ds_read_b128 v[116:119], v14 offset:192
  s_waitcnt lgkmcnt(4)
  v_cmp_gt_u32 vcc, s77, v3
  s_cmp_eq_u64 vcc, 0
  s_cbranch_scc1 L_hyd_52
  s_waitcnt lgkmcnt(0)
  s_add_u32 s70, s70, 1
  s_cmp_lt_u32 s70, 2097152
  s_cbranch_scc1 L_hy_51
L_hyd_52:
  ds_read_b128 v[120:123], v14 offset:256
  ds_read_b128 v[124:127], v14 offset:320
  ds_read_b128 v[128:131], v14 offset:384
  ds_read_b128 v[132:135], v14 offset:448
  ds_read_b128 v[136:139], v14 offset:512
  ds_read_b128 v[140:143], v14 offset:576
  ds_read_b128 v[144:147], v14 offset:640
  ds_read_b128 v[148:151], v14 offset:704
  s_waitcnt lgkmcnt(11)
  v_mfma_f32_16x16x32_bf16 v[8:11], v[40:43], v[104:107], 0
  s_waitcnt lgkmcnt(10)
  v_mfma_f32_16x16x32_bf16 v[8:11], v[44:47], v[108:111], v[8:11]
  ds_read_b128 v[104:107], v14 offset:768
  s_waitcnt lgkmcnt(10)
  v_mfma_f32_16x16x32_bf16 v[8:11], v[48:51], v[112:115], v[8:11]
  ds_read_b128 v[108:111], v14 offset:832
  s_waitcnt lgkmcnt(10)
  v_mfma_f32_16x16x32_bf16 v[8:11], v[52:55], v[116:119], v[8:11]
  ds_read_b128 v[112:115], v14 offset:896
  s_waitcnt lgkmcnt(10)
  v_mfma_f32_16x16x32_bf16 v[8:11], v[56:59], v[120:123], v[8:11]
  ds_read_b128 v[116:119], v14 offset:960
  s_waitcnt lgkmcnt(10)
  v_mfma_f32_16x16x32_bf16 v[8:11], v[60:63], v[124:127], v[8:11]
  s_waitcnt lgkmcnt(9)
  v_mfma_f32_16x16x32_bf16 v[8:11], v[64:67], v[128:131], v[8:11]
  s_waitcnt lgkmcnt(8)
  v_mfma_f32_16x16x32_bf16 v[8:11], v[68:71], v[132:135], v[8:11]
  s_waitcnt lgkmcnt(7)
  v_mfma_f32_16x16x32_bf16 v[8:11], v[72:75], v[136:139], v[8:11]
  s_waitcnt lgkmcnt(6)
  v_mfma_f32_16x16x32_bf16 v[8:11], v[76:79], v[140:143], v[8:11]
  s_waitcnt lgkmcnt(5)
  v_mfma_f32_16x16x32_bf16 v[8:11], v[80:83], v[144:147], v[8:11]
  s_waitcnt lgkmcnt(4)
  v_mfma_f32_16x16x32_bf16 v[8:11], v[84:87], v[148:151], v[8:11]
  s_waitcnt lgkmcnt(3)
  v_mfma_f32_16x16x32_bf16 v[8:11], v[88:91], v[104:107], v[8:11]
  s_waitcnt lgkmcnt(2)
  v_mfma_f32_16x16x32_bf16 v[8:11], v[92:95], v[108:111], v[8:11]
  s_waitcnt lgkmcnt(1)
  v_mfma_f32_16x16x32_bf16 v[8:11], v[96:99], v[112:115], v[8:11]
  s_waitcnt lgkmcnt(0)
  v_mfma_f32_16x16x32_bf16 v[8:11], v[100:103], v[116:119], v[8:11]
  s_nop 7
  v_bfi_b32 v8, v36, s32, v8
  v_bfi_b32 v9, v36, s33, v9
  v_bfi_b32 v10, v36, s34, v10
  v_bfi_b32 v11, v36, s35, v11
  s_mov_b32 exec_lo, 0x000f000f
  s_mov_b32 exec_hi, exec_lo
  global_store_dwordx4 v13, v[8:11], s[42:43] sc1
  v_mov_b32 v3, 1
  s_mov_b64 exec, 1
  ds_add_u32 v38, v3 offset:264
  s_mov_b64 exec, -1
  s_branch L_fin
L_r_mod:
  global_load_dwordx2 v[14:15], v37, s[34:35]
  s_mov_b32 s44, s36
  s_mov_b32 s45, s37
  s_mov_b32 s46, 3145728
  s_mov_b32 s47, 0x20000
  s_cmp_ge_u32 s60, 2
  s_cbranch_scc1 L_mod2
  s_lshl1_add_u32 s61, s8, s60
  s_lshl_b32 s48, s61, 7
  s_lshl_b32 s58, s61, 9
  s_add_u32 s58, s58, 917504
  v_lshrrev_b32 v2, 3, v1
  v_and_b32 v3, 6, v2
  v_xor_b32 v3, v3, v1
  v_mul_u32_u24 v2, 6144, v2
  v_and_b32 v3, 7, v3
  v_lshl_add_u32 v2, v3, 4, v2
  s_mul_i32 s49, s5, 786432
  s_lshl_b32 s50, s5, 14
  s_add_u32 s49, s49, s48
  s_add_u32 s50, s50, 77824
  s_add_u32 s51, s50, 16384
L_dma_53:
  s_mov_b32 m0, s50
  s_add_u32 s50, s50, 1024
  buffer_load_dwordx4 v2, s[44:47], s49 offen nt lds
  s_add_u32 s49, s49, 49152
  s_cmp_lt_u32 s50, s51
  s_cbranch_scc1 L_dma_53
L_dmae_54:
  v_mov_b32 v3, 1
  s_mov_b64 exec, 1
  ds_add_u32 v38, v3 offset:268
  s_mov_b64 exec, -1
  s_getpc_b64 s[56:57]
L_pc_55:
  s_lshr_b32 s3, s2, 5
  s_lshl3_add_u32 s3, s3, s8
  s_lshl_b32 s3, s3, 2
  s_add_u32 s3, s3, L_table-L_pc_55
  s_load_dword s14, s[56:57], s3
  s_waitcnt lgkmcnt(0)
  s_mul_i32 s74, s74, 0x9e3779b1
  s_add_u32 s74, s74, 0x7f4a7c15
  s_waitcnt vmcnt(16)
  v_lshlrev_b32 v16, 16, v14
  v_and_b32 v17, s73, v14
  v_lshlrev_b32 v18, 16, v15
  v_and_b32 v19, s73, v15
  v_mul_f32 v20, 0xbfb8aa3b, v16
  v_mul_f32 v21, 0xbfb8aa3b, v17
  v_mul_f32 v22, 0xbfb8aa3b, v18
  v_mul_f32 v23, 0xbfb8aa3b, v19
  v_exp_f32 v20, v20
  v_exp_f32 v21, v21
  v_exp_f32 v22, v22
  v_exp_f32 v23, v23
  s_nop 0
  v_add_f32 v20, 1.0, v20
  v_add_f32 v21, 1.0, v21
  v_add_f32 v22, 1.0, v22
  v_add_f32 v23, 1.0, v23
  v_rcp_f32 v20, v20
  v_rcp_f32 v21, v21
  v_rcp_f32 v22, v22
  v_rcp_f32 v23, v23
  s_nop 0
  v_mul_f32 v16, v16, v20
  v_mul_f32 v17, v17, v21
  v_mul_f32 v18, v18, v22
  v_mul_f32 v19, v19, v23
  v_cvt_pk_bf16_f32 v14, v16, v17
  v_cvt_pk_bf16_f32 v15, v18, v19
  ds_write_b64 v12, v[14:15] offset:3200
  v_and_b32 v13, 1, v1
  v_lshlrev_b32 v13, 6, v13
  v_lshrrev_b32 v3, 4, v1
  v_lshl_add_u32 v13, v3, 4, v13
  s_lshl_b32 s49, s5, 7
  s_add_u32 s49, s49, s58
  v_add_u32 v13, s49, v13
  v_bfe_u32 v3, v1, 1, 3
  v_lshl_add_u32 v13, v3, 13, v13
  v_and_b32 v14, 1, v1
  v_mul_u32_u24 v14, 1056, v14
  v_lshrrev_b32 v3, 4, v1
  v_lshl_add_u32 v14, v3, 4, v14
  v_add_u32 v14, 3200, v14
  v_lshrrev_b32 v2, 2, v1
  v_bfe_u32 v3, v1, 1, 1
  s_lshl_b32 s49, s5, 1
  v_or_b32 v3, s49, v3
  v_and_b32 v10, 6, v2
  v_xor_b32 v3, v3, v10
  v_lshlrev_b32 v2, 7, v2
  v_lshl_add_u32 v2, v3, 4, v2
  v_and_b32 v3, 1, v1
  v_lshl_add_u32 v2, v3, 3, v2
  v_add_u32 v2, 77824, v2
  s_waitcnt vmcnt(0) lgkmcnt(0)
  s_add_u32 s77, s77, 4
  v_mov_b32 v9, 1
  s_mov_b64 exec, 1
  ds_add_u32 v38, v9 offset:316
  s_mov_b64 exec, -1
  s_mov_b32 s70, 0
L_hy_56:
  ds_read_b32 v9, v38 offset:316
  s_waitcnt lgkmcnt(0)
  v_cmp_gt_u32 vcc, s77, v9
  s_cmp_eq_u64 vcc, 0
  s_cbranch_scc1 L_hyd_57
  s_add_u32 s70, s70, 1
  s_cmp_lt_u32 s70, 2097152
  s_cbranch_scc1 L_hy_56
L_hyd_57:
  ds_read_b64_tr_b16 v[40:41], v2 offset:0
  ds_read_b64_tr_b16 v[42:43], v2 offset:2048
  ds_read_b128 v[104:107], v14 offset:0
  ds_read_b64_tr_b16 v[44:45], v2 offset:4096
  ds_read_b64_tr_b16 v[46:47], v2 offset:6144
  ds_read_b128 v[108:111], v14 offset:64
  ds_read_b64_tr_b16 v[48:49], v2 offset:8192
  ds_read_b64_tr_b16 v[50:51], v2 offset:10240
  ds_read_b128 v[112:115], v14 offset:128
  ds_read_b64_tr_b16 v[52:53], v2 offset:12288
  ds_read_b64_tr_b16 v[54:55], v2 offset:14336
  ds_read_b128 v[116:119], v14 offset:192
  ds_read_b64_tr_b16 v[56:57], v2 offset:16384
  ds_read_b64_tr_b16 v[58:59], v2 offset:18432
  ds_read_b128 v[120:123], v14 offset:256
  s_waitcnt lgkmcnt(12)
  v_mfma_f32_16x16x32_bf16 v[8:11], v[40:43], v[104:107], 0
  ds_read_b64_tr_b16 v[60:61], v2 offset:20480
  ds_read_b64_tr_b16 v[62:63], v2 offset:22528
  ds_read_b128 v[124:127], v14 offset:320
  s_waitcnt lgkmcnt(12)
  v_mfma_f32_16x16x32_bf16 v[8:11], v[44:47], v[108:111], v[8:11]
  ds_read_b64_tr_b16 v[64:65], v2 offset:24576
  ds_read_b64_tr_b16 v[66:67], v2 offset:26624
  ds_read_b128 v[128:131], v14 offset:384
  s_waitcnt lgkmcnt(12)
  v_mfma_f32_16x16x32_bf16 v[8:11], v[48:51], v[112:115], v[8:11]
  ds_read_b64_tr_b16 v[68:69], v2 offset:28672
  ds_read_b64_tr_b16 v[70:71], v2 offset:30720
  ds_read_b128 v[132:135], v14 offset:448
  s_waitcnt lgkmcnt(12)
  v_mfma_f32_16x16x32_bf16 v[8:11], v[52:55], v[116:119], v[8:11]
  ds_read_b64_tr_b16 v[72:73], v2 offset:32768
  ds_read_b64_tr_b16 v[74:75], v2 offset:34816
  ds_read_b128 v[136:139], v14 offset:512
  s_waitcnt lgkmcnt(12)
  v_mfma_f32_16x16x32_bf16 v[8:11], v[56:59], v[120:123], v[8:11]
  ds_read_b64_tr_b16 v[76:77], v2 offset:36864
  ds_read_b64_tr_b16 v[78:79], v2 offset:38912
  ds_read_b128 v[140:143], v14 offset:576
  s_waitcnt lgkmcnt(12)
  v_mfma_f32_16x16x32_bf16 v[8:11], v[60:63], v[124:127], v[8:11]
  ds_read_b64_tr_b16 v[80:81], v2 offset:40960
  ds_read_b64_tr_b16 v[82:83], v2 offset:43008
  ds_read_b128 v[144:147], v14 offset:640
  s_waitcnt lgkmcnt(12)
  v_mfma_f32_16x16x32_bf16 v[8:11], v[64:67], v[128:131], v[8:11]
  ds_read_b64_tr_b16 v[84:85], v2 offset:45056
  ds_read_b64_tr_b16 v[86:87], v2 offset:47104
  ds_read_b128 v[148:151], v14 offset:704
  s_waitcnt lgkmcnt(12)
  v_mfma_f32_16x16x32_bf16 v[8:11], v[68:71], v[132:135], v[8:11]
  ds_read_b64_tr_b16 v[88:89], v2 offset:49152
  ds_read_b64_tr_b16 v[90:91], v2 offset:51200
  ds_read_b128 v[152:155], v14 offset:768
  s_waitcnt lgkmcnt(12)
  v_mfma_f32_16x16x32_bf16 v[8:11], v[72:75], v[136:139], v[8:11]
  ds_read_b64_tr_b16 v[92:93], v2 offset:53248
  ds_read_b64_tr_b16 v[94:95], v2 offset:55296
  ds_read_b128 v[156:159], v14 offset:832
  s_waitcnt lgkmcnt(12)
  v_mfma_f32_16x16x32_bf16 v[8:11], v[76:79], v[140:143], v[8:11]
  ds_read_b64_tr_b16 v[96:97], v2 offset:57344
  ds_read_b64_tr_b16 v[98:99], v2 offset:59392
  ds_read_b128 v[160:163], v14 offset:896
  s_waitcnt lgkmcnt(12)
  v_mfma_f32_16x16x32_bf16 v[8:11], v[80:83], v[144:147], v[8:11]
  ds_read_b64_tr_b16 v[100:101], v2 offset:61440
  ds_read_b64_tr_b16 v[102:103], v2 offset:63488
  ds_read_b128 v[164:167], v14 offset:960
  s_waitcnt lgkmcnt(12)
  v_mfma_f32_16x16x32_bf16 v[8:11], v[84:87], v[148:151], v[8:11]
  s_waitcnt lgkmcnt(9)
  v_mfma_f32_16x16x32_bf16 v[8:11], v[88:91], v[152:155], v[8:11]
  s_waitcnt lgkmcnt(6)
  v_mfma_f32_16x16x32_bf16 v[8:11], v[92:95], v[156:159], v[8:11]
  s_waitcnt lgkmcnt(3)
  v_mfma_f32_16x16x32_bf16 v[8:11], v[96:99], v[160:163], v[8:11]
  s_waitcnt lgkmcnt(0)
  v_mfma_f32_16x16x32_bf16 v[8:11], v[100:103], v[164:167], v[8:11]
  s_nop 7
  v_cvt_pk_bf16_f32 v8, v8, v9
  v_cvt_pk_bf16_f32 v10, v10, v11
  v_mov_b32 v9, s74
  v_mov_b32 v11, s74
  global_store_dwordx4 v13, v[8:11], s[42:43] sc1
  s_mov_b64 exec, -1
  s_add_u32 s77, s77, 4
  v_mov_b32 v9, 1
  s_mov_b64 exec, 1
  ds_add_u32 v38, v9 offset:316
  s_mov_b64 exec, -1
  s_mov_b32 s70, 0
L_hy_58:
  ds_read_b32 v9, v38 offset:316
  s_waitcnt lgkmcnt(0)
  v_cmp_gt_u32 vcc, s77, v9
  s_cmp_eq_u64 vcc, 0
  s_cbranch_scc1 L_hyd_59
  s_add_u32 s70, s70, 1
  s_cmp_lt_u32 s70, 2097152
  s_cbranch_scc1 L_hy_58
L_hyd_59:
  s_branch L_mod3
L_mod2:
  s_getpc_b64 s[56:57]
L_pc_60:
  s_lshr_b32 s3, s2, 5
  s_lshl3_add_u32 s3, s3, s8
  s_lshl_b32 s3, s3, 2
  s_add_u32 s3, s3, L_table-L_pc_60
  s_load_dword s14, s[56:57], s3
  s_waitcnt lgkmcnt(0)
  s_mul_i32 s74, s74, 0x9e3779b1
  s_add_u32 s74, s74, 0x7f4a7c15
  s_waitcnt vmcnt(0)
  v_lshlrev_b32 v16, 16, v14
  v_and_b32 v17, s73, v14
  v_lshlrev_b32 v18, 16, v15
  v_and_b32 v19, s73, v15
  v_mul_f32 v20, 0xbfb8aa3b, v16
  v_mul_f32 v21, 0xbfb8aa3b, v17
  v_mul_f32 v22, 0xbfb8aa3b, v18
  v_mul_f32 v23, 0xbfb8aa3b, v19
  v_exp_f32 v20, v20
  v_exp_f32 v21, v21
  v_exp_f32 v22, v22
  v_exp_f32 v23, v23
  s_nop 0
  v_add_f32 v20, 1.0, v20
  v_add_f32 v21, 1.0, v21
  v_add_f32 v22, 1.0, v22
  v_add_f32 v23, 1.0, v23
  v_rcp_f32 v20, v20
  v_rcp_f32 v21, v21
  v_rcp_f32 v22, v22
  v_rcp_f32 v23, v23
  s_nop 0
  v_mul_f32 v16, v16, v20
  v_mul_f32 v17, v17, v21
  v_mul_f32 v18, v18, v22
  v_mul_f32 v19, v19, v23
  v_cvt_pk_bf16_f32 v14, v16, v17
  v_cvt_pk_bf16_f32 v15, v18, v19
  ds_write_b64 v12, v[14:15] offset:3200
L_mod3:
  s_mov_b32 s70, 0
L_sn_61:
  ds_read_b32 v8, v38 offset:264
  s_waitcnt lgkmcnt(0)
  v_cmp_gt_u32 vcc, 0x4, v8
  s_cmp_eq_u64 vcc, 0
  s_cbranch_scc1 L_snd_62
  s_sleep 4
  s_add_u32 s70, s70, 1
  s_cmp_lt_u32 s70, 2097152
  s_cbranch_scc1 L_sn_61
L_snd_62:
  s_and_b32 s61, s14, 0xff
  s_cmp_ge_u32 s61, 48
  s_cbranch_scc1 L_r_f1
  s_mov_b32 s70, 0
L_sn_63:
  ds_read_b32 v8, v38 offset:312
  s_waitcnt lgkmcnt(0)
  v_cmp_gt_u32 vcc, 0x8, v8
  s_cmp_eq_u64 vcc, 0
  s_cbranch_scc1 L_snd_64
  s_sleep 4
  s_add_u32 s70, s70, 1
  s_cmp_lt_u32 s70, 2097152
  s_cbranch_scc1 L_sn_63
L_snd_64:
  s_and_b32 s61, s14, 0xff
L_mod4:
  s_cmp_ge_u32 s61, 48
  s_cbranch_scc1 L_r_f1
  s_lshl_b32 s48, s61, 7
  s_lshl_b32 s58, s61, 9
  s_add_u32 s58, s58, 4096
  v_lshrrev_b32 v2, 3, v1
  v_and_b32 v3, 6, v2
  v_xor_b32 v3, v3, v1
  v_mul_u32_u24 v2, 6144, v2
  v_and_b32 v3, 7, v3
  v_lshl_add_u32 v2, v3, 4, v2
  s_mul_i32 s49, s5, 786432
  s_lshl_b32 s50, s5, 14
  s_add_u32 s49, s49, s48
  s_add_u32 s50, s50, 77824
  s_add_u32 s51, s50, 16384
L_dma_65:
  s_mov_b32 m0, s50
  s_add_u32 s50, s50, 1024
  buffer_load_dwordx4 v2, s[44:47], s49 offen nt lds
  s_add_u32 s49, s49, 49152
  s_waitcnt vmcnt(5)
  s_cmp_lt_u32 s50, s51
  s_cbranch_scc1 L_dma_65
L_dmae_66:
  v_and_b32 v13, 1, v1
  v_lshlrev_b32 v13, 6, v13
  v_lshrrev_b32 v3, 4, v1
  v_lshl_add_u32 v13, v3, 4, v13
  s_lshl_b32 s49, s5, 7
  s_add_u32 s49, s49, s58
  v_add_u32 v13, s49, v13
  v_and_b32 v14, 1, v1
  v_mul_u32_u24 v14, 1056, v14
  v_lshrrev_b32 v3, 4, v1
  v_lshl_add_u32 v14, v3, 4, v14
  v_add_u32 v14, 3200, v14
  v_lshrrev_b32 v2, 2, v1
  v_bfe_u32 v3, v1, 1, 1
  s_lshl_b32 s49, s5, 1
  v_or_b32 v3, s49, v3
  v_and_b32 v10, 6, v2
  v_xor_b32 v3, v3, v10
  v_lshlrev_b32 v2, 7, v2
  v_lshl_add_u32 v2, v3, 4, v2
  v_and_b32 v3, 1, v1
  v_lshl_add_u32 v2, v3, 3, v2
  v_add_u32 v2, 77824, v2
  s_waitcnt vmcnt(0) lgkmcnt(0)
  s_add_u32 s77, s77, 4
  v_mov_b32 v9, 1
  s_mov_b64 exec, 1
  ds_add_u32 v38, v9 offset:316
  s_mov_b64 exec, -1
  s_mov_b32 s70, 0
L_hy_67:
  ds_read_b32 v9, v38 offset:316
  s_waitcnt lgkmcnt(0)
  v_cmp_gt_u32 vcc, s77, v9
  s_cmp_eq_u64 vcc, 0
  s_cbranch_scc1 L_hyd_68
  s_sleep 4
  s_add_u32 s70, s70, 1
  s_cmp_lt_u32 s70, 2097152
  s_cbranch_scc1 L_hy_67
L_hyd_68:
  ds_read_b64_tr_b16 v[40:41], v2 offset:0
  ds_read_b64_tr_b16 v[42:43], v2 offset:2048
  ds_read_b128 v[104:107], v14 offset:0
  ds_read_b64_tr_b16 v[44:45], v2 offset:4096
  ds_read_b64_tr_b16 v[46:47], v2 offset:6144
  ds_read_b128 v[108:111], v14 offset:64
  ds_read_b64_tr_b16 v[48:49], v2 offset:8192
  ds_read_b64_tr_b16 v[50:51], v2 offset:10240
  ds_read_b128 v[112:115], v14 offset:128
  ds_read_b64_tr_b16 v[52:53], v2 offset:12288
  ds_read_b64_tr_b16 v[54:55], v2 offset:14336
  ds_read_b128 v[116:119], v14 offset:192
  ds_read_b64_tr_b16 v[56:57], v2 offset:16384
  ds_read_b64_tr_b16 v[58:59], v2 offset:18432
  ds_read_b128 v[120:123], v14 offset:256
  s_waitcnt lgkmcnt(12)
  v_mfma_f32_16x16x32_bf16 v[8:11], v[40:43], v[104:107], 0
  ds_read_b64_tr_b16 v[60:61], v2 offset:20480
  ds_read_b64_tr_b16 v[62:63], v2 offset:22528
  ds_read_b128 v[124:127], v14 offset:320
  s_waitcnt lgkmcnt(12)
  v_mfma_f32_16x16x32_bf16 v[8:11], v[44:47], v[108:111], v[8:11]
  ds_read_b64_tr_b16 v[64:65], v2 offset:24576
  ds_read_b64_tr_b16 v[66:67], v2 offset:26624
  ds_read_b128 v[128:131], v14 offset:384
  s_waitcnt lgkmcnt(12)
  v_mfma_f32_16x16x32_bf16 v[8:11], v[48:51], v[112:115], v[8:11]
  ds_read_b64_tr_b16 v[68:69], v2 offset:28672
  ds_read_b64_tr_b16 v[70:71], v2 offset:30720
  ds_read_b128 v[132:135], v14 offset:448
  s_waitcnt lgkmcnt(12)
  v_mfma_f32_16x16x32_bf16 v[8:11], v[52:55], v[116:119], v[8:11]
  ds_read_b64_tr_b16 v[72:73], v2 offset:32768
  ds_read_b64_tr_b16 v[74:75], v2 offset:34816
  ds_read_b128 v[136:139], v14 offset:512
  s_waitcnt lgkmcnt(12)
  v_mfma_f32_16x16x32_bf16 v[8:11], v[56:59], v[120:123], v[8:11]
  ds_read_b64_tr_b16 v[76:77], v2 offset:36864
  ds_read_b64_tr_b16 v[78:79], v2 offset:38912
  ds_read_b128 v[140:143], v14 offset:576
  s_waitcnt lgkmcnt(12)
  v_mfma_f32_16x16x32_bf16 v[8:11], v[60:63], v[124:127], v[8:11]
  ds_read_b64_tr_b16 v[80:81], v2 offset:40960
  ds_read_b64_tr_b16 v[82:83], v2 offset:43008
  ds_read_b128 v[144:147], v14 offset:640
  s_waitcnt lgkmcnt(12)
  v_mfma_f32_16x16x32_bf16 v[8:11], v[64:67], v[128:131], v[8:11]
  ds_read_b64_tr_b16 v[84:85], v2 offset:45056
  ds_read_b64_tr_b16 v[86:87], v2 offset:47104
  ds_read_b128 v[148:151], v14 offset:704
  s_waitcnt lgkmcnt(12)
  v_mfma_f32_16x16x32_bf16 v[8:11], v[68:71], v[132:135], v[8:11]
  ds_read_b64_tr_b16 v[88:89], v2 offset:49152
  ds_read_b64_tr_b16 v[90:91], v2 offset:51200
  ds_read_b128 v[152:155], v14 offset:768
  s_waitcnt lgkmcnt(12)
  v_mfma_f32_16x16x32_bf16 v[8:11], v[72:75], v[136:139], v[8:11]
  ds_read_b64_tr_b16 v[92:93], v2 offset:53248
  ds_read_b64_tr_b16 v[94:95], v2 offset:55296
  ds_read_b128 v[156:159], v14 offset:832
  s_waitcnt lgkmcnt(12)
  v_mfma_f32_16x16x32_bf16 v[8:11], v[76:79], v[140:143], v[8:11]
  ds_read_b64_tr_b16 v[96:97], v2 offset:57344
  ds_read_b64_tr_b16 v[98:99], v2 offset:59392
  ds_read_b128 v[160:163], v14 offset:896
  s_waitcnt lgkmcnt(12)
  v_mfma_f32_16x16x32_bf16 v[8:11], v[80:83], v[144:147], v[8:11]
  ds_read_b64_tr_b16 v[100:101], v2 offset:61440
  ds_read_b64_tr_b16 v[102:103], v2 offset:63488
  ds_read_b128 v[164:167], v14 offset:960
  s_waitcnt lgkmcnt(12)
  v_mfma_f32_16x16x32_bf16 v[8:11], v[84:87], v[148:151], v[8:11]
  s_waitcnt lgkmcnt(9)
  v_mfma_f32_16x16x32_bf16 v[8:11], v[88:91], v[152:155], v[8:11]
  s_waitcnt lgkmcnt(6)
  v_mfma_f32_16x16x32_bf16 v[8:11], v[92:95], v[156:159], v[8:11]
  s_waitcnt lgkmcnt(3)
  v_mfma_f32_16x16x32_bf16 v[8:11], v[96:99], v[160:163], v[8:11]
  s_waitcnt lgkmcnt(0)
  v_mfma_f32_16x16x32_bf16 v[8:11], v[100:103], v[164:167], v[8:11]
  s_nop 7
  v_cvt_pk_bf16_f32 v8, v8, v9
  v_cvt_pk_bf16_f32 v10, v10, v11
  v_mov_b32 v9, s74
  v_mov_b32 v11, s74
  s_mov_b32 exec_lo, 0x00030003
  s_mov_b32 exec_hi, 0x00030003
  global_store_dwordx4 v13, v[8:11], s[42:43] sc1
  s_mov_b64 exec, -1
  s_add_u32 s77, s77, 4
  v_mov_b32 v9, 1
  s_mov_b64 exec, 1
  ds_add_u32 v38, v9 offset:316
  s_mov_b64 exec, -1
  s_mov_b32 s70, 0
L_hy_69:
  ds_read_b32 v9, v38 offset:316
  s_waitcnt lgkmcnt(0)
  v_cmp_gt_u32 vcc, s77, v9
  s_cmp_eq_u64 vcc, 0
  s_cbranch_scc1 L_hyd_70
  s_add_u32 s70, s70, 1
  s_cmp_lt_u32 s70, 2097152
  s_cbranch_scc1 L_hy_69
L_hyd_70:
  s_lshr_b32 s61, s14, 24
  s_or_b32 s14, s14, 0xff000000
  s_branch L_mod4
L_r_f1:
  s_bfe_u32 s61, s14, 0x80008
  s_cmp_ge_u32 s61, 43
  s_cbranch_scc1 L_fin
  s_lshl_b32 s48, s61, 6
  s_lshl_b32 s58, s61, 7
  s_add_u32 s58, s58, 1572864
  s_cmp_lt_u32 s5, 2
  s_cselect_b32 s44, s28, s30
  s_cselect_b32 s45, s29, s31
  s_mov_b32 s46, 1409024
  s_and_b32 s54, s61, 1
  v_lshrrev_b32 v2, 2, v1
  v_mul_u32_u24 v2, 5504, v2
  s_and_b32 s49, s5, 2
  s_or_b32 s49, s49, s54
  v_xor_b32 v3, s49, v1
  v_and_b32 v3, 3, v3
  v_lshl_add_u32 v2, v3, 4, v2
  s_and_b32 s55, s5, 1
  s_mul_i32 s49, s55, 704512
  s_add_u32 s49, s49, s48
  s_mul_i32 s50, s54, 2752
  s_add_u32 s49, s49, s50
  s_lshr_b32 s50, s5, 1
  s_lshl_b32 s50, s50, 15
  s_lshl_b32 s54, s54, 14
  s_add_u32 s50, s50, s54
  s_lshl_b32 s55, s55, 13
  s_add_u32 s50, s50, s55
  s_add_u32 s50, s50, 77824
  s_mov_b32 s70, 0
L_sn_71:
  ds_read_b32 v8, v38 offset:260
  s_waitcnt lgkmcnt(0)
  v_cmp_gt_u32 vcc, 0x1, v8
  s_cmp_eq_u64 vcc, 0
  s_cbranch_scc1 L_snd_72
  s_sleep 8
  s_add_u32 s70, s70, 1
  s_cmp_lt_u32 s70, 2097152
  s_cbranch_scc1 L_sn_71
L_snd_72:
  s_add_u32 s51, s50, 8192
L_dma_73:
  s_mov_b32 m0, s50
  s_add_u32 s50, s50, 1024
  buffer_load_dwordx4 v2, s[44:47], s49 offen  lds
  s_add_u32 s49, s49, 88064
  s_waitcnt vmcnt(3)
  s_cmp_lt_u32 s50, s51
  s_cbranch_scc1 L_dma_73
L_dmae_74:
  s_andn2_b32 s54, 1, s61
  v_lshrrev_b32 v2, 2, v1
  v_mul_u32_u24 v2, 5504, v2
  s_and_b32 s49, s5, 2
  s_or_b32 s49, s49, s54
  v_xor_b32 v3, s49, v1
  v_and_b32 v3, 3, v3
  v_lshl_add_u32 v2, v3, 4, v2
  s_and_b32 s55, s5, 1
  s_mul_i32 s49, s55, 704512
  s_add_u32 s49, s49, s48
  s_mul_i32 s50, s54, 2752
  s_add_u32 s49, s49, s50
  s_lshr_b32 s50, s5, 1
  s_lshl_b32 s50, s50, 15
  s_lshl_b32 s54, s54, 14
  s_add_u32 s50, s50, s54
  s_lshl_b32 s55, s55, 13
  s_add_u32 s50, s50, s55
  s_add_u32 s50, s50, 77824
  s_add_u32 s51, s50, 8192
L_dma_75:
  s_mov_b32 m0, s50
  s_add_u32 s50, s50, 1024
  buffer_load_dwordx4 v2, s[44:47], s49 offen nt lds
  s_add_u32 s49, s49, 88064
  s_waitcnt vmcnt(3)
  s_cmp_lt_u32 s50, s51
  s_cbranch_scc1 L_dma_75
L_dmae_76:
  v_lshlrev_b32 v15, 4, v0
  v_add_u32 v39, 16384, v15
  s_and_b32 s59, s2, 1
  s_lshl_b32 s59, s59, 16
  s_add_u32 s59, s59, 2101248
  v_add_u32 v15, s59, v15
  v_lshrrev_b32 v5, 2, v0
  v_lshlrev_b32 v5, 3, v5
  v_add_u32 v5, 9536, v5
  v_lshlrev_b32 v7, 3, v1
  v_add_u32 v7, 9536, v7
  v_and_b32 v14, 7, v1
  v_mul_u32_u24 v14, 1056, v14
  v_lshrrev_b32 v3, 4, v1
  v_lshl_add_u32 v14, v3, 4, v14
  v_bfe_u32 v6, v1, 2, 2
  v_lshl_add_u32 v6, v3, 3, v6
  v_mul_u32_u24 v6, 1056, v6
  v_and_b32 v8, 3, v1
  v_lshl_add_u32 v6, v8, 3, v6
  s_lshl_b32 s49, s5, 8
  s_add_u32 s49, s49, 77824
  v_add_u32 v6, s49, v6
  v_lshlrev_b32 v10, 3, v0
  v_add_u32 v10, 10048, v10
  v_mov_b32 v8, 0
  v_mov_b32 v9, 0
  ds_write_b64 v10, v[8:9]
  v_and_b32 v13, 1, v1
  v_lshlrev_b32 v13, 6, v13
  v_lshrrev_b32 v3, 4, v1
  v_lshl_add_u32 v13, v3, 4, v13
  s_lshl_b32 s49, s5, 17
  s_add_u32 s49, s49, s58
  v_add_u32 v13, s49, v13
  v_bfe_u32 v3, v1, 1, 3
  v_lshl_add_u32 v13, v3, 14, v13
  v_lshrrev_b32 v2, 3, v1
  v_lshlrev_b32 v2, 6, v2
  v_bfe_u32 v3, v1, 2, 1
  v_lshl_add_u32 v2, v3, 14, v2
  v_and_b32 v8, 2, v1
  v_or_b32 v3, v3, v8
  v_xor_b32 v3, s5, v3
  v_lshl_add_u32 v2, v3, 4, v2
  v_lshl_add_u32 v2, v8, 14, v2
  v_and_b32 v3, 1, v1
  v_lshl_add_u32 v2, v3, 3, v2
  v_add_u32 v2, 77824, v2
  s_waitcnt vmcnt(0)
  s_add_u32 s77, s77, 4
  v_mov_b32 v9, 1
  s_mov_b64 exec, 1
  ds_add_u32 v38, v9 offset:316
  s_mov_b64 exec, -1
  s_mov_b32 s70, 0
L_hy_77:
  ds_read_b32 v9, v38 offset:316
  s_waitcnt lgkmcnt(0)
  v_cmp_gt_u32 vcc, s77, v9
  s_cmp_eq_u64 vcc, 0
  s_cbranch_scc1 L_hyd_78
  s_sleep 4
  s_add_u32 s70, s70, 1
  s_cmp_lt_u32 s70, 2097152
  s_cbranch_scc1 L_hy_77
L_hyd_78:
  ds_read_b64_tr_b16 v[40:41], v2 offset:0
  ds_read_b64_tr_b16 v[42:43], v2 offset:512
  ds_read_b64_tr_b16 v[44:45], v2 offset:1024
  ds_read_b64_tr_b16 v[46:47], v2 offset:1536
  ds_read_b64_tr_b16 v[48:49], v2 offset:2048
  ds_read_b64_tr_b16 v[50:51], v2 offset:2560
  ds_read_b64_tr_b16 v[52:53], v2 offset:3072
  ds_read_b64_tr_b16 v[54:55], v2 offset:3584
  ds_read_b64_tr_b16 v[56:57], v2 offset:4096
  ds_read_b64_tr_b16 v[58:59], v2 offset:4608
  ds_read_b64_tr_b16 v[60:61], v2 offset:5120
  ds_read_b64_tr_b16 v[62:63], v2 offset:5632
  s_waitcnt lgkmcnt(10)
  ds_read_b64_tr_b16 v[64:65], v2 offset:6144
  ds_read_b64_tr_b16 v[66:67], v2 offset:6656
  s_waitcnt lgkmcnt(10)
  ds_read_b64_tr_b16 v[68:69], v2 offset:7168
  ds_read_b64_tr_b16 v[70:71], v2 offset:7680
  s_waitcnt lgkmcnt(10)
  ds_read_b64_tr_b16 v[72:73], v2 offset:8192
  ds_read_b64_tr_b16 v[74:75], v2 offset:8704
  s_waitcnt lgkmcnt(10)
  ds_read_b64_tr_b16 v[76:77], v2 offset:9216
  ds_read_b64_tr_b16 v[78:79], v2 offset:9728
  s_waitcnt lgkmcnt(10)
  ds_read_b64_tr_b16 v[80:81], v2 offset:10240
  ds_read_b64_tr_b16 v[82:83], v2 offset:10752
  s_waitcnt lgkmcnt(10)
  ds_read_b64_tr_b16 v[84:85], v2 offset:11264
  ds_read_b64_tr_b16 v[86:87], v2 offset:11776
  s_waitcnt lgkmcnt(10)
  ds_read_b64_tr_b16 v[88:89], v2 offset:12288
  ds_read_b64_tr_b16 v[90:91], v2 offset:12800
  s_waitcnt lgkmcnt(10)
  ds_read_b64_tr_b16 v[92:93], v2 offset:13312
  ds_read_b64_tr_b16 v[94:95], v2 offset:13824
  s_waitcnt lgkmcnt(10)
  ds_read_b64_tr_b16 v[96:97], v2 offset:14336
  ds_read_b64_tr_b16 v[98:99], v2 offset:14848
  s_waitcnt lgkmcnt(10)
  ds_read_b64_tr_b16 v[100:101], v2 offset:15360
  ds_read_b64_tr_b16 v[102:103], v2 offset:15872
  s_waitcnt lgkmcnt(10)
  s_waitcnt lgkmcnt(0)
  s_add_u32 s77, s77, 4
  v_mov_b32 v9, 1
  s_mov_b64 exec, 1
  ds_add_u32 v38, v9 offset:316
  s_mov_b64 exec, -1
  s_mov_b32 s70, 0
L_hy_79:
  ds_read_b32 v9, v38 offset:316
  s_waitcnt lgkmcnt(0)
  v_cmp_gt_u32 vcc, s77, v9
  s_cmp_eq_u64 vcc, 0
  s_cbranch_scc1 L_hyd_80
  s_add_u32 s70, s70, 1
  s_cmp_lt_u32 s70, 2097152
  s_cbranch_scc1 L_hy_79
L_hyd_80:
  s_mov_b32 s44, s32
  s_mov_b32 s45, s33
  s_mov_b32 s46, 1409024
  s_mov_b32 s47, 0x20000
  v_lshlrev_b32 v2, 4, v1
  s_lshl2_add_u32 s49, s61, s5
  s_lshl_b32 s49, s49, 13
  s_mul_i32 s50, s5, 8448
  s_add_u32 s50, s50, 77824
  s_add_u32 s51, s50, 8448
L_dma_81:
  s_mov_b32 m0, s50
  s_add_u32 s50, s50, 1056
  buffer_load_dwordx4 v2, s[44:47], s49 offen nt lds
  s_add_u32 s49, s49, 1024
  s_waitcnt vmcnt(3)
  s_cmp_lt_u32 s50, s51
  s_cbranch_scc1 L_dma_81
L_dmae_82:
  s_bfe_u32 s32, s74, 0x80000
  s_bfe_u32 s33, s74, 0x80008
  s_bfe_u32 s34, s74, 0x80010
  s_bfe_u32 s35, s74, 0x80018
  v_add_u32 v4, 16384, v15
  v_add_u32 v0, 32768, v15
  v_add_u32 v36, 49152, v15
  global_load_dwordx2 v[8:9], v37, s[16:17]
  s_mov_b32 s70, 0
L_pg_83:
  global_load_dwordx4 v[136:139], v39, s[42:43] offset:-4096 sc1
  global_load_dwordx4 v[140:143], v39, s[42:43] offset:0 sc1
  v_add_u32 v3, 4096, v39
  global_load_dwordx4 v[144:147], v3, s[42:43] sc1
  s_waitcnt vmcnt(0)
  s_mov_b64 vcc, 0
  v_cmp_ne_u32 s[68:69], s74, v137
  s_or_b64 vcc, vcc, s[68:69]
  v_cmp_ne_u32 s[68:69], s74, v139
  s_or_b64 vcc, vcc, s[68:69]
  v_cmp_ne_u32 s[68:69], s74, v141
  s_or_b64 vcc, vcc, s[68:69]
  v_cmp_ne_u32 s[68:69], s74, v143
  s_or_b64 vcc, vcc, s[68:69]
  v_cmp_ne_u32 s[68:69], s74, v145
  s_or_b64 vcc, vcc, s[68:69]
  v_cmp_ne_u32 s[68:69], s74, v147
  s_or_b64 vcc, vcc, s[68:69]
  s_cmp_eq_u64 vcc, 0
  s_cbranch_scc1 L_pge_84
  s_sleep 8
  s_add_u32 s70, s70, 1
  s_cmp_lt_u32 s70, 262144
  s_cbranch_scc1 L_pg_83
L_pge_84:
  v_and_b32 v39, 1, v1
  v_lshlrev_b32 v39, 6, v39
  v_add_u32 v39, 10944, v39
  v_lshrrev_b32 v3, 4, v1
  v_lshl_add_u32 v37, v3, 4, v39
  v_bfe_u32 v3, v1, 1, 3
  v_lshlrev_b32 v3, 7, v3
  v_sub_u32 v37, v37, v3
  v_bfe_u32 v3, v1, 4, 1
  v_lshl_add_u32 v39, v3, 3, v39
  v_lshrrev_b32 v3, 5, v1
  v_lshl_add_u32 v39, v3, 2, v39
  s_lshl_b32 s49, s5, 4
  v_add_u32 v39, s49, v39
  v_lshlrev_b32 v16, 16, v8
  v_and_b32 v17, s73, v8
  v_lshlrev_b32 v18, 16, v9
  v_and_b32 v19, s73, v9
  v_lshlrev_b32 v20, 16, v136
  v_and_b32 v21, s73, v136
  v_lshlrev_b32 v22, 16, v138
  v_and_b32 v23, s73, v138
  v_lshlrev_b32 v28, 16, v144
  v_and_b32 v29, s73, v144
  v_lshlrev_b32 v30, 16, v146
  v_and_b32 v31, s73, v146
  v_add_f32 v28, 1.0, v28
  v_add_f32 v29, 1.0, v29
  v_add_f32 v30, 1.0, v30
  v_add_f32 v31, 1.0, v31
  v_cvt_pk_bf16_f32 v8, v28, v29
  v_cvt_pk_bf16_f32 v9, v30, v31
  v_mov_b32 v141, v142
  ds_write_b64 v12, v[8:9] offset:5312
  ds_write_b64 v12, v[140:141] offset:7424
  v_cvt_pk_bf16_f32 v28, 0, v28
  v_cvt_pk_bf16_f32 v29, 0, v29
  v_cvt_pk_bf16_f32 v30, 0, v30
  v_cvt_pk_bf16_f32 v31, 0, v31
  v_mul_f32 v24, v20, v28
  v_mul_f32 v25, v21, v29
  v_mul_f32 v26, v22, v30
  v_mul_f32 v27, v23, v31
  v_mul_f32 v28, v16, v28
  v_mul_f32 v29, v17, v29
  v_mul_f32 v30, v18, v30
  v_mul_f32 v31, v19, v31
  s_waitcnt lgkmcnt(0)
  s_waitcnt vmcnt(0)
  s_mov_b32 s70, 0
L_sn_85:
  ds_read_b32 v8, v38 offset:264
  s_waitcnt lgkmcnt(0)
  v_cmp_gt_u32 vcc, 0x8, v8
  s_cmp_eq_u64 vcc, 0
  s_cbranch_scc1 L_snd_86
  s_sleep 2
  s_add_u32 s70, s70, 1
  s_cmp_lt_u32 s70, 2097152
  s_cbranch_scc1 L_sn_85
L_snd_86:
  s_mov_b32 s70, 0
  s_movk_i32 s71, 0xff
  s_mov_b32 s63, s71
  s_branch L_f1_l
L_f1_p:
  s_add_u32 s70, s70, 1
  s_cmp_ge_u32 s70, 262144
  s_cbranch_scc1 L_f1_ok
  s_mov_b32 s63, s71
L_f1_l:
  s_bitcmp1_b32 s63, 0
  s_cbranch_scc0 L_fl_87
  global_load_dwordx4 v[104:107], v15, s[42:43] offset:-4096 sc1
L_fl_87:
  s_bitcmp1_b32 s63, 1
  s_cbranch_scc0 L_fl_88
  global_load_dwordx4 v[108:111], v15, s[42:43] offset:0 sc1
L_fl_88:
  s_bitcmp1_b32 s63, 2
  s_cbranch_scc0 L_fl_89
  global_load_dwordx4 v[112:115], v4, s[42:43] offset:-4096 sc1
L_fl_89:
  s_bitcmp1_b32 s63, 3
  s_cbranch_scc0 L_fl_90
  global_load_dwordx4 v[116:119], v4, s[42:43] offset:0 sc1
L_fl_90:
  s_bitcmp1_b32 s63, 4
  s_cbranch_scc0 L_fl_91
  global_load_dwordx4 v[120:123], v0, s[42:43] offset:-4096 sc1
L_fl_91:
  s_bitcmp1_b32 s63, 5
  s_cbranch_scc0 L_fl_92
  global_load_dwordx4 v[124:127], v0, s[42:43] offset:0 sc1
L_fl_92:
  s_bitcmp1_b32 s63, 6
  s_cbranch_scc0 L_fl_93
  global_load_dwordx4 v[128:131], v36, s[42:43] offset:-4096 sc1
L_fl_93:
  s_bitcmp1_b32 s63, 7
  s_cbranch_scc0 L_fl_94
  global_load_dwordx4 v[132:135], v36, s[42:43] offset:0 sc1
L_fl_94:
  s_waitcnt vmcnt(0)
  s_bitcmp1_b32 s63, 0
  s_cbranch_scc0 L_fc_95
  v_xor_b32 v104, s32, v104
  v_xor_b32 v105, s33, v105
  v_xor_b32 v106, s34, v106
  v_xor_b32 v107, s35, v107
  v_or3_b32 v8, v104, v105, v106
  v_or_b32 v8, v8, v107
  v_cmp_ne_u32_sdwa vcc, v8, v38 src0_sel:BYTE_0 src1_sel:DWORD
  s_cmp_lg_u64 vcc, 0
  s_cbranch_scc1 L_fc_95
  s_bitset0_b32 s71, 0
L_fc_95:
  s_bitcmp1_b32 s63, 1
  s_cbranch_scc0 L_fc_96
  v_xor_b32 v108, s32, v108
  v_xor_b32 v109, s33, v109
  v_xor_b32 v110, s34, v110
  v_xor_b32 v111, s35, v111
  v_or3_b32 v8, v108, v109, v110
  v_or_b32 v8, v8, v111
  v_cmp_ne_u32_sdwa vcc, v8, v38 src0_sel:BYTE_0 src1_sel:DWORD
  s_cmp_lg_u64 vcc, 0
  s_cbranch_scc1 L_fc_96
  s_bitset0_b32 s71, 1
L_fc_96:
  s_bitcmp1_b32 s63, 2
  s_cbranch_scc0 L_fc_97
  v_xor_b32 v112, s32, v112
  v_xor_b32 v113, s33, v113
  v_xor_b32 v114, s34, v114
  v_xor_b32 v115, s35, v115
  v_or3_b32 v8, v112, v113, v114
  v_or_b32 v8, v8, v115
  v_cmp_ne_u32_sdwa vcc, v8, v38 src0_sel:BYTE_0 src1_sel:DWORD
  s_cmp_lg_u64 vcc, 0
  s_cbranch_scc1 L_fc_97
  s_bitset0_b32 s71, 2
L_fc_97:
  s_bitcmp1_b32 s63, 3
  s_cbranch_scc0 L_fc_98
  v_xor_b32 v116, s32, v116
  v_xor_b32 v117, s33, v117
  v_xor_b32 v118, s34, v118
  v_xor_b32 v119, s35, v119
  v_or3_b32 v8, v116, v117, v118
  v_or_b32 v8, v8, v119
  v_cmp_ne_u32_sdwa vcc, v8, v38 src0_sel:BYTE_0 src1_sel:DWORD
  s_cmp_lg_u64 vcc, 0
  s_cbranch_scc1 L_fc_98
  s_bitset0_b32 s71, 3
L_fc_98:
  s_bitcmp1_b32 s63, 4
  s_cbranch_scc0 L_fc_99
  v_xor_b32 v120, s32, v120
  v_xor_b32 v121, s33, v121
  v_xor_b32 v122, s34, v122
  v_xor_b32 v123, s35, v123
  v_or3_b32 v8, v120, v121, v122
  v_or_b32 v8, v8, v123
  v_cmp_ne_u32_sdwa vcc, v8, v38 src0_sel:BYTE_0 src1_sel:DWORD
  s_cmp_lg_u64 vcc, 0
  s_cbranch_scc1 L_fc_99
  s_bitset0_b32 s71, 4
L_fc_99:
  s_bitcmp1_b32 s63, 5
  s_cbranch_scc0 L_fc_100
  v_xor_b32 v124, s32, v124
  v_xor_b32 v125, s33, v125
  v_xor_b32 v126, s34, v126
  v_xor_b32 v127, s35, v127
  v_or3_b32 v8, v124, v125, v126
  v_or_b32 v8, v8, v127
  v_cmp_ne_u32_sdwa vcc, v8, v38 src0_sel:BYTE_0 src1_sel:DWORD
  s_cmp_lg_u64 vcc, 0
  s_cbranch_scc1 L_fc_100
  s_bitset0_b32 s71, 5
L_fc_100:
  s_bitcmp1_b32 s63, 6
  s_cbranch_scc0 L_fc_101
  v_xor_b32 v128, s32, v128
  v_xor_b32 v129, s33, v129
  v_xor_b32 v130, s34, v130
  v_xor_b32 v131, s35, v131
  v_or3_b32 v8, v128, v129, v130
  v_or_b32 v8, v8, v131
  v_cmp_ne_u32_sdwa vcc, v8, v38 src0_sel:BYTE_0 src1_sel:DWORD
  s_cmp_lg_u64 vcc, 0
  s_cbranch_scc1 L_fc_101
  s_bitset0_b32 s71, 6
L_fc_101:
  s_bitcmp1_b32 s63, 7
  s_cbranch_scc0 L_fc_102
  v_xor_b32 v132, s32, v132
  v_xor_b32 v133, s33, v133
  v_xor_b32 v134, s34, v134
  v_xor_b32 v135, s35, v135
  v_or3_b32 v8, v132, v133, v134
  v_or_b32 v8, v8, v135
  v_cmp_ne_u32_sdwa vcc, v8, v38 src0_sel:BYTE_0 src1_sel:DWORD
  s_cmp_lg_u64 vcc, 0
  s_cbranch_scc1 L_fc_102
  s_bitset0_b32 s71, 7
L_fc_102:
  s_cmp_lg_u32 s71, 0
  s_cbranch_scc1 L_f1_p
L_f1_ok:
  v_pk_add_f32 v[136:137], v[104:105], v[108:109]
  v_pk_add_f32 v[138:139], v[106:107], v[110:111]
  v_pk_add_f32 v[144:145], v[112:113], v[116:117]
  v_pk_add_f32 v[146:147], v[114:115], v[118:119]
  v_pk_add_f32 v[152:153], v[120:121], v[124:125]
  v_pk_add_f32 v[154:155], v[122:123], v[126:127]
  v_pk_add_f32 v[160:161], v[128:129], v[132:133]
  v_pk_add_f32 v[162:163], v[130:131], v[134:135]
  v_pk_add_f32 v[136:137], v[136:137], v[144:145]
  v_pk_add_f32 v[138:139], v[138:139], v[146:147]
  v_pk_add_f32 v[152:153], v[152:153], v[160:161]
  v_pk_add_f32 v[154:155], v[154:155], v[162:163]
  v_pk_add_f32 v[136:137], v[136:137], v[152:153]
  v_pk_add_f32 v[138:139], v[138:139], v[154:155]
  v_pk_fma_f32 v[8:9], v[136:137], v[24:25], v[28:29]
  v_pk_fma_f32 v[10:11], v[138:139], v[26:27], v[30:31]
  v_cvt_pk_bf16_f32 v8, v8, v9
  v_cvt_pk_bf16_f32 v9, v10, v11
  ds_write_b64 v12, v[8:9] offset:3200
  v_pk_fma_f32 v[16:17], v[136:137], v[20:21], v[16:17]
  v_pk_fma_f32 v[18:19], v[138:139], v[22:23], v[18:19]
  v_add_f32 v24, v16, v17
  v_mul_f32 v25, v16, v16
  v_add_f32 v26, v18, v19
  v_mul_f32 v27, v18, v18
  v_fmac_f32 v25, v17, v17
  v_fmac_f32 v27, v19, v19
  v_pk_add_f32 v[24:25], v[24:25], v[26:27]
  s_nop 1
  v_add_f32_dpp v24, v24, v24 quad_perm:[1,0,3,2] row_mask:0xf bank_mask:0xf
  v_add_f32_dpp v25, v25, v25 quad_perm:[1,0,3,2] row_mask:0xf bank_mask:0xf
  s_nop 0
  v_add_f32_dpp v24, v24, v24 quad_perm:[2,3,0,1] row_mask:0xf bank_mask:0xf
  v_add_f32_dpp v25, v25, v25 quad_perm:[2,3,0,1] row_mask:0xf bank_mask:0xf
  ds_write_b64 v5, v[24:25]
  s_add_u32 s77, s77, 4
  v_mov_b32 v10, 1
  s_mov_b64 exec, 1
  ds_add_u32 v38, v10 offset:316
  s_mov_b64 exec, -1
  s_mov_b32 s70, 0
L_hy_103:
  ds_read_b32 v10, v38 offset:316
  ds_read_b128 v[136:139], v14 offset:3200
  ds_read_b128 v[140:143], v14 offset:3264
  ds_read_b128 v[144:147], v14 offset:3328
  ds_read_b128 v[148:151], v14 offset:3392
  s_waitcnt lgkmcnt(4)
  v_cmp_gt_u32 vcc, s77, v10
  s_cmp_eq_u64 vcc, 0
  s_cbranch_scc1 L_hyd_104
  s_waitcnt lgkmcnt(0)
  s_add_u32 s70, s70, 1
  s_cmp_lt_u32 s70, 2097152
  s_cbranch_scc1 L_hy_103
L_hyd_104:
  ds_read_b64 v[20:21], v7
  ds_read_b128 v[152:155], v14 offset:3456
  ds_read_b128 v[156:159], v14 offset:3520
  ds_read_b128 v[160:163], v14 offset:3584
  ds_read_b128 v[164:167], v14 offset:3648
  s_waitcnt lgkmcnt(8)
  v_mfma_f32_16x16x32_bf16 v[32:35], v[40:43], v[136:139], 0
  s_waitcnt lgkmcnt(7)
  v_mfma_f32_16x16x32_bf16 v[32:35], v[44:47], v[140:143], v[32:35]
  ds_read_b128 v[136:139], v14 offset:3712
  s_waitcnt lgkmcnt(7)
  v_mfma_f32_16x16x32_bf16 v[32:35], v[48:51], v[144:147], v[32:35]
  ds_read_b128 v[140:143], v14 offset:3776
  s_waitcnt lgkmcnt(7)
  v_mfma_f32_16x16x32_bf16 v[32:35], v[52:55], v[148:151], v[32:35]
  ds_read_b128 v[144:147], v14 offset:3840
  s_waitcnt lgkmcnt(6)
  v_mfma_f32_16x16x32_bf16 v[32:35], v[56:59], v[152:155], v[32:35]
  ds_read_b128 v[148:151], v14 offset:3904
  v_add_f32_dpp v20, v20, v20 quad_perm:[2,3,0,1] row_mask:0xf bank_mask:0xf
  v_add_f32_dpp v21, v21, v21 quad_perm:[2,3,0,1] row_mask:0xf bank_mask:0xf
  s_waitcnt lgkmcnt(6)
  v_mfma_f32_16x16x32_bf16 v[32:35], v[60:63], v[156:159], v[32:35]
  ds_read_b128 v[152:155], v14 offset:3968
  v_add_f32_dpp v20, v20, v20 row_ror:4 row_mask:0xf bank_mask:0xf
  v_add_f32_dpp v21, v21, v21 row_ror:4 row_mask:0xf bank_mask:0xf
  s_waitcnt lgkmcnt(6)
  v_mfma_f32_16x16x32_bf16 v[32:35], v[64:67], v[160:163], v[32:35]
  ds_read_b128 v[156:159], v14 offset:4032
  v_add_f32_dpp v20, v20, v20 row_ror:8 row_mask:0xf bank_mask:0xf
  v_add_f32_dpp v21, v21, v21 row_ror:8 row_mask:0xf bank_mask:0xf
  s_waitcnt lgkmcnt(6)
  v_mfma_f32_16x16x32_bf16 v[32:35], v[68:71], v[164:167], v[32:35]
  ds_read_b128 v[160:163], v14 offset:4096
  v_mov_b32 v22, v20
  v_mov_b32 v23, v21
  s_waitcnt lgkmcnt(6)
  v_mfma_f32_16x16x32_bf16 v[32:35], v[72:75], v[136:139], v[32:35]
  ds_read_b128 v[164:167], v14 offset:4160
  v_permlane16_swap_b32 v22, v20
  v_permlane16_swap_b32 v23, v21
  s_waitcnt lgkmcnt(6)
  v_mfma_f32_16x16x32_bf16 v[32:35], v[76:79], v[140:143], v[32:35]
  v_pk_add_f32 v[20:21], v[20:21], v[22:23]
  v_mov_b32 v22, v20
  v_mov_b32 v23, v21
  s_waitcnt lgkmcnt(5)
  v_mfma_f32_16x16x32_bf16 v[32:35], v[80:83], v[144:147], v[32:35]
  v_permlane32_swap_b32 v22, v20
  v_permlane32_swap_b32 v23, v21
  s_waitcnt lgkmcnt(4)
  v_mfma_f32_16x16x32_bf16 v[32:35], v[84:87], v[148:151], v[32:35]
  v_pk_add_f32 v[20:21], v[20:21], v[22:23]
  v_mul_f32 v20, 0xbb000000, v20
  s_waitcnt lgkmcnt(3)
  v_mfma_f32_16x16x32_bf16 v[32:35], v[88:91], v[152:155], v[32:35]
  v_mul_f32 v21, 0x3b000000, v21
  v_fma_f32 v21, -v20, v20, v21
  s_waitcnt lgkmcnt(2)
  v_mfma_f32_16x16x32_bf16 v[32:35], v[92:95], v[156:159], v[32:35]
  v_max_f32 v21, 0, v21
  v_add_f32 v21, 0x3727c5ac, v21
  s_waitcnt lgkmcnt(1)
  v_mfma_f32_16x16x32_bf16 v[32:35], v[96:99], v[160:163], v[32:35]
  v_rsq_f32 v21, v21
  s_waitcnt lgkmcnt(0)
  v_mfma_f32_16x16x32_bf16 v[32:35], v[100:103], v[164:167], v[32:35]
  ds_read_b64_tr_b16 v[40:41], v6 offset:0
  ds_read_b64_tr_b16 v[42:43], v6 offset:4224
  ds_read_b64_tr_b16 v[44:45], v6 offset:32
  ds_read_b64_tr_b16 v[46:47], v6 offset:4256
  ds_read_b64_tr_b16 v[48:49], v6 offset:64
  ds_read_b64_tr_b16 v[50:51], v6 offset:4288
  ds_read_b64_tr_b16 v[52:53], v6 offset:96
  ds_read_b64_tr_b16 v[54:55], v6 offset:4320
  v_fmac_f32_dpp v32, v32, v20 row_shl:2 row_mask:0xf bank_mask:0x1
  v_fmac_f32_dpp v33, v33, v20 row_shl:2 row_mask:0xf bank_mask:0x1
  v_fmac_f32_dpp v34, v34, v20 row_shl:2 row_mask:0xf bank_mask:0x1
  v_fmac_f32_dpp v35, v35, v20 row_shl:2 row_mask:0xf bank_mask:0x1
  v_mul_f32 v8, v32, v21
  v_mul_f32 v9, v33, v21
  v_mul_f32 v10, v34, v21
  v_mul_f32 v11, v35, v21
  v_add_f32_dpp v8, v32, v8 row_shl:4 row_mask:0xf bank_mask:0xf
  v_add_f32_dpp v9, v33, v9 row_shl:4 row_mask:0xf bank_mask:0xf
  v_add_f32_dpp v10, v34, v10 row_shl:4 row_mask:0xf bank_mask:0xf
  v_add_f32_dpp v11, v35, v11 row_shl:4 row_mask:0xf bank_mask:0xf
  s_waitcnt lgkmcnt(4)
  ds_read_b64_tr_b16 v[56:57], v6 offset:128
  ds_read_b64_tr_b16 v[58:59], v6 offset:4352
  ds_read_b64_tr_b16 v[60:61], v6 offset:160
  ds_read_b64_tr_b16 v[62:63], v6 offset:4384
  ds_read_b64_tr_b16 v[64:65], v6 offset:192
  ds_read_b64_tr_b16 v[66:67], v6 offset:4416
  ds_read_b64_tr_b16 v[68:69], v6 offset:224
  ds_read_b64_tr_b16 v[70:71], v6 offset:4448
  v_permlane32_swap_b32 v8, v10
  v_permlane32_swap_b32 v9, v11
  v_mul_f32 v20, 0xbfb8aa3b, v8
  v_mul_f32 v21, 0xbfb8aa3b, v9
  v_exp_f32 v20, v20
  v_exp_f32 v21, v21
  v_mul_f32 v8, v8, v10
  v_mul_f32 v9, v9, v11
  v_add_f32 v20, 1.0, v20
  v_add_f32 v21, 1.0, v21
  v_rcp_f32 v20, v20
  v_rcp_f32 v21, v21
  s_mov_b32 exec_lo, 0x00030003
  s_mov_b32 exec_hi, 0x00030003
  v_mul_f32 v8, v8, v20
  v_mul_f32 v9, v9, v21
  v_cvt_pk_bf16_f32 v8, v8, v9
  ds_write_b32 v39, v8
  s_mov_b64 exec, -1
  s_waitcnt lgkmcnt(4)
  s_add_u32 s77, s77, 4
  v_mov_b32 v10, 1
  s_mov_b64 exec, 1
  ds_add_u32 v38, v10 offset:316
  s_mov_b64 exec, -1
  s_mov_b32 s70, 0
L_hy_105:
  ds_read_b32 v10, v38 offset:316
  ds_read_b128 v[136:139], v37 offset:0
  ds_read_b128 v[140:143], v37 offset:128
  ds_read_b128 v[144:147], v37 offset:256
  ds_read_b128 v[148:151], v37 offset:384
  s_waitcnt lgkmcnt(4)
  v_cmp_gt_u32 vcc, s77, v10
  s_cmp_eq_u64 vcc, 0
  s_cbranch_scc1 L_hyd_106
  s_waitcnt lgkmcnt(0)
  s_add_u32 s70, s70, 1
  s_cmp_lt_u32 s70, 2097152
  s_cbranch_scc1 L_hy_105
L_hyd_106:
  ds_read_b128 v[152:155], v37 offset:512
  ds_read_b128 v[156:159], v37 offset:640
  ds_read_b128 v[160:163], v37 offset:768
  ds_read_b128 v[164:167], v37 offset:896
  v_mov_b32 v3, 0xff
  s_waitcnt lgkmcnt(7)
  v_mfma_f32_16x16x32_bf16 v[8:11], v[40:43], v[136:139], 0
  s_waitcnt lgkmcnt(6)
  v_mfma_f32_16x16x32_bf16 v[8:11], v[44:47], v[140:143], v[8:11]
  s_waitcnt lgkmcnt(5)
  v_mfma_f32_16x16x32_bf16 v[8:11], v[48:51], v[144:147], v[8:11]
  s_waitcnt lgkmcnt(4)
  v_mfma_f32_16x16x32_bf16 v[8:11], v[52:55], v[148:151], v[8:11]
  s_waitcnt lgkmcnt(3)
  v_mfma_f32_16x16x32_bf16 v[8:11], v[56:59], v[152:155], v[8:11]
  s_waitcnt lgkmcnt(2)
  v_mfma_f32_16x16x32_bf16 v[8:11], v[60:63], v[156:159], v[8:11]
  s_waitcnt lgkmcnt(1)
  v_mfma_f32_16x16x32_bf16 v[8:11], v[64:67], v[160:163], v[8:11]
  s_waitcnt lgkmcnt(0)
  v_mfma_f32_16x16x32_bf16 v[8:11], v[68:71], v[164:167], v[8:11]
  s_nop 7
  v_bfi_b32 v8, v3, s32, v8
  v_bfi_b32 v9, v3, s33, v9
  v_bfi_b32 v10, v3, s34, v10
  v_bfi_b32 v11, v3, s35, v11
  global_store_dwordx4 v13, v[8:11], s[42:43] sc1
  s_branch L_fin
L_r_f2:
  v_bfe_u32 v12, v1, 2, 1
  v_and_b32 v14, 3, v1
  s_lshl_b32 s49, s61, 5
  v_lshl_add_u32 v3, v14, 3, s49
  v_lshl_add_u32 v37, v12, 10, v3
  v_and_b32 v15, 7, v1
  s_lshl_b32 s49, s61, 7
  v_lshl_add_u32 v15, v15, 4, s49
  v_add_u32 v39, 16384, v15
  v_bfe_u32 v3, v1, 3, 1
  v_lshl_add_u32 v15, v3, 12, v15
  v_lshrrev_b32 v3, 4, v1
  v_lshl_add_u32 v15, v3, 14, v15
  s_and_b32 s59, s2, 1
  s_lshl_b32 s59, s59, 16
  s_add_u32 s59, s59, 2097152
  v_add_u32 v15, s59, v15
  s_lshl_b32 s49, s61, 14
  s_add_u32 s49, s49, 1574912
  v_lshl_add_u32 v36, v1, 4, s49
  global_load_dword v11, v37, s[38:39]
  s_lshl_b32 s49, s61, 14
  s_add_u32 s49, s49, 1572864
  v_min_u32 v10, 42, v1
  v_lshl_add_u32 v10, v10, 7, s49
  global_load_dword v11, v10, s[42:43] sc1
  s_lshl_b32 s49, s61, 7
  s_add_u32 s49, s49, 28672
  v_mov_b32 v10, s49
  global_load_dword v11, v10, s[42:43] sc1
  global_load_dwordx2 v[8:9], v37, s[16:17]
  s_mov_b32 s70, 0
L_pg_107:
  global_load_dwordx4 v[136:139], v39, s[42:43] offset:-4096 sc1
  v_add_u32 v3, 8192, v39
  global_load_dwordx4 v[140:143], v3, s[42:43] sc1
  s_waitcnt vmcnt(0)
  s_mov_b64 vcc, 0
  v_cmp_ne_u32 s[68:69], s74, v137
  s_or_b64 vcc, vcc, s[68:69]
  v_cmp_ne_u32 s[68:69], s74, v139
  s_or_b64 vcc, vcc, s[68:69]
  v_cmp_ne_u32 s[68:69], s74, v141
  s_or_b64 vcc, vcc, s[68:69]
  v_cmp_ne_u32 s[68:69], s74, v143
  s_or_b64 vcc, vcc, s[68:69]
  s_cmp_eq_u64 vcc, 0
  s_cbranch_scc1 L_pge_108
  s_sleep 8
  s_add_u32 s70, s70, 1
  s_cmp_lt_u32 s70, 262144
  s_cbranch_scc1 L_pg_107
L_pge_108:
  v_lshlrev_b32 v16, 16, v8
  v_and_b32 v17, s73, v8
  v_lshlrev_b32 v18, 16, v9
  v_and_b32 v19, s73, v9
  v_lshlrev_b32 v20, 16, v136
  v_and_b32 v21, s73, v136
  v_lshlrev_b32 v22, 16, v138
  v_and_b32 v23, s73, v138
  v_lshlrev_b32 v24, 16, v140
  v_and_b32 v25, s73, v140
  v_lshlrev_b32 v26, 16, v142
  v_and_b32 v27, s73, v142
  s_mov_b32 s70, 0
L_sn_109:
  ds_read_b32 v8, v38 offset:264
  s_waitcnt lgkmcnt(0)
  v_cmp_gt_u32 vcc, 0x8, v8
  s_cmp_eq_u64 vcc, 0
  s_cbranch_scc1 L_snd_110
  s_sleep 2
  s_add_u32 s70, s70, 1
  s_cmp_lt_u32 s70, 2097152
  s_cbranch_scc1 L_sn_109
L_snd_110:
  s_mov_b32 s70, 0
L_f2_a:
  global_load_dwordx4 v[136:139], v15, s[42:43] sc1
  s_waitcnt vmcnt(0)
  v_xor_b32 v136, s32, v136
  v_xor_b32 v137, s33, v137
  v_xor_b32 v138, s34, v138
  v_xor_b32 v139, s35, v139
  v_or3_b32 v3, v136, v137, v138
  v_or_b32 v3, v3, v139
  v_lshlrev_b32 v3, 24, v3
  v_cmp_ne_u32 vcc, 0, v3
  s_cmp_eq_u64 vcc, 0
  s_cbranch_scc1 L_f2_ad
  s_sleep 4
  s_add_u32 s70, s70, 1
  s_cmp_lt_u32 s70, 262144
  s_cbranch_scc1 L_f2_a
L_f2_ad:
  s_cmp_lg_u32 s61, 0
  s_cbranch_scc1 L_f2_e
  v_mov_b32 v10, s74
  s_mov_b64 exec, 1
  global_store_dword v38, v10, s[42:43] offset:0 sc1
  s_mov_b64 exec, -1
L_f2_e:
  s_nop 1
  v_add_f32_dpp v136, v136, v136 row_ror:8 row_mask:0xf bank_mask:0xf
  v_add_f32_dpp v137, v137, v137 row_ror:8 row_mask:0xf bank_mask:0xf
  v_add_f32_dpp v138, v138, v138 row_ror:8 row_mask:0xf bank_mask:0xf
  v_add_f32_dpp v139, v139, v139 row_ror:8 row_mask:0xf bank_mask:0xf
  v_mov_b32 v140, v136
  v_mov_b32 v141, v137
  v_mov_b32 v142, v138
  v_mov_b32 v143, v139
  v_permlane16_swap_b32 v140, v136
  v_permlane16_swap_b32 v141, v137
  v_permlane16_swap_b32 v142, v138
  v_permlane16_swap_b32 v143, v139
  v_add_f32 v136, v136, v140
  v_add_f32 v137, v137, v141
  v_add_f32 v138, v138, v142
  v_add_f32 v139, v139, v143
  v_mov_b32 v140, v136
  v_mov_b32 v141, v137
  v_mov_b32 v142, v138
  v_mov_b32 v143, v139
  v_permlane32_swap_b32 v140, v136
  v_permlane32_swap_b32 v141, v137
  v_permlane32_swap_b32 v142, v138
  v_permlane32_swap_b32 v143, v139
  v_add_f32 v136, v136, v140
  v_add_f32 v137, v137, v141
  v_add_f32 v138, v138, v142
  v_add_f32 v139, v139, v143
  v_cvt_pk_bf16_f32 v136, 0, v136
  v_cvt_pk_bf16_f32 v137, 0, v137
  v_cvt_pk_bf16_f32 v138, 0, v138
  v_cvt_pk_bf16_f32 v139, 0, v139
  v_mul_f32 v136, v136, v20
  v_mul_f32 v137, v137, v21
  v_mul_f32 v138, v138, v22
  v_mul_f32 v139, v139, v23
  v_cvt_pk_bf16_f32 v136, 0, v136
  v_cvt_pk_bf16_f32 v137, 0, v137
  v_cvt_pk_bf16_f32 v138, 0, v138
  v_cvt_pk_bf16_f32 v139, 0, v139
  v_add_f32 v16, v16, v136
  v_add_f32 v17, v17, v137
  v_add_f32 v18, v18, v138
  v_add_f32 v19, v19, v139
  v_cvt_pk_bf16_f32 v16, 0, v16
  v_cvt_pk_bf16_f32 v17, 0, v17
  v_cvt_pk_bf16_f32 v18, 0, v18
  v_cvt_pk_bf16_f32 v19, 0, v19
  v_mov_b32 v156, s32
  v_mov_b32 v157, s33
  v_mov_b32 v158, s34
  v_mov_b32 v159, s35
  s_mov_b64 s[20:21], -1
  s_mov_b64 s[22:23], -1
  s_mov_b64 s[24:25], -1
  s_mov_b64 s[26:27], -1
  s_mov_b64 s[28:29], -1
  s_mov_b64 s[30:31], 0xffffff
  s_mov_b64 exec, s[20:21]
  global_load_dwordx4 v[136:139], v36, s[42:43] offset:-2048 sc1
  s_mov_b64 exec, s[22:23]
  global_load_dwordx4 v[140:143], v36, s[42:43] offset:-1024 sc1
  s_mov_b64 exec, s[24:25]
  global_load_dwordx4 v[144:147], v36, s[42:43] offset:0 sc1
  s_mov_b64 exec, s[26:27]
  global_load_dwordx4 v[148:151], v36, s[42:43] offset:1024 sc1
  s_mov_b64 exec, s[28:29]
  global_load_dwordx4 v[152:155], v36, s[42:43] offset:2048 sc1
  s_mov_b64 exec, s[30:31]
  global_load_dwordx4 v[156:159], v36, s[42:43] offset:3072 sc1
  s_mov_b64 exec, -1
  s_waitcnt vmcnt(0)
  s_mov_b32 s70, 0
  s_branch L_f2_pc
L_f2_p:
  s_mov_b64 exec, s[20:21]
  global_load_dwordx4 v[136:139], v36, s[42:43] offset:-2048 sc1
  s_mov_b64 exec, s[22:23]
  global_load_dwordx4 v[140:143], v36, s[42:43] offset:-1024 sc1
  s_mov_b64 exec, s[24:25]
  global_load_dwordx4 v[144:147], v36, s[42:43] offset:0 sc1
  s_mov_b64 exec, s[26:27]
  global_load_dwordx4 v[148:151], v36, s[42:43] offset:1024 sc1
  s_mov_b64 exec, s[28:29]
  global_load_dwordx4 v[152:155], v36, s[42:43] offset:2048 sc1
  s_mov_b64 exec, s[30:31]
  global_load_dwordx4 v[156:159], v36, s[42:43] offset:3072 sc1
  s_mov_b64 exec, -1
  s_waitcnt vmcnt(0)
L_f2_pc:
  v_xor_b32 v104, s32, v136
  v_xor_b32 v105, s33, v137
  v_xor_b32 v106, s34, v138
  v_xor_b32 v107, s35, v139
  v_xor_b32 v108, s32, v140
  v_xor_b32 v109, s33, v141
  v_xor_b32 v110, s34, v142
  v_xor_b32 v111, s35, v143
  v_xor_b32 v112, s32, v144
  v_xor_b32 v113, s33, v145
  v_xor_b32 v114, s34, v146
  v_xor_b32 v115, s35, v147
  v_xor_b32 v116, s32, v148
  v_xor_b32 v117, s33, v149
  v_xor_b32 v118, s34, v150
  v_xor_b32 v119, s35, v151
  v_xor_b32 v120, s32, v152
  v_xor_b32 v121, s33, v153
  v_xor_b32 v122, s34, v154
  v_xor_b32 v123, s35, v155
  v_xor_b32 v124, s32, v156
  v_xor_b32 v125, s33, v157
  v_xor_b32 v126, s34, v158
  v_xor_b32 v127, s35, v159
  v_or3_b32 v28, v104, v105, v106
  v_or3_b32 v29, v108, v109, v110
  v_or3_b32 v30, v112, v113, v114
  v_or3_b32 v31, v116, v117, v118
  v_or3_b32 v32, v120, v121, v122
  v_or3_b32 v33, v124, v125, v126
  v_or_b32 v28, v28, v107
  v_or_b32 v29, v29, v111
  v_or_b32 v30, v30, v115
  v_or_b32 v31, v31, v119
  v_or_b32 v32, v32, v123
  v_or_b32 v33, v33, v127
  v_cmp_ne_u32_sdwa s[20:21], v28, v38 src0_sel:BYTE_0 src1_sel:DWORD
  v_cmp_ne_u32_sdwa s[22:23], v29, v38 src0_sel:BYTE_0 src1_sel:DWORD
  v_cmp_ne_u32_sdwa s[24:25], v30, v38 src0_sel:BYTE_0 src1_sel:DWORD
  v_cmp_ne_u32_sdwa s[26:27], v31, v38 src0_sel:BYTE_0 src1_sel:DWORD
  v_cmp_ne_u32_sdwa s[28:29], v32, v38 src0_sel:BYTE_0 src1_sel:DWORD
  v_cmp_ne_u32_sdwa s[30:31], v33, v38 src0_sel:BYTE_0 src1_sel:DWORD
  v_pk_add_f32 v[104:105], v[104:105], v[108:109]
  v_pk_add_f32 v[106:107], v[106:107], v[110:111]
  v_pk_add_f32 v[112:113], v[112:113], v[116:117]
  v_pk_add_f32 v[114:115], v[114:115], v[118:119]
  v_pk_add_f32 v[120:121], v[120:121], v[124:125]
  v_pk_add_f32 v[122:123], v[122:123], v[126:127]
  v_pk_add_f32 v[104:105], v[104:105], v[112:113]
  v_pk_add_f32 v[106:107], v[106:107], v[114:115]
  v_pk_add_f32 v[104:105], v[104:105], v[120:121]
  v_pk_add_f32 v[106:107], v[106:107], v[122:123]
  s_mov_b64 vcc, s[20:21]
  s_or_b64 vcc, vcc, s[22:23]
  s_or_b64 vcc, vcc, s[24:25]
  s_or_b64 vcc, vcc, s[26:27]
  s_or_b64 vcc, vcc, s[28:29]
  s_or_b64 vcc, vcc, s[30:31]
  s_or_b32 s20, s20, 1
  s_or_b32 s22, s22, 1
  s_or_b32 s24, s24, 1
  s_or_b32 s26, s26, 1
  s_or_b32 s28, s28, 1
  s_or_b32 s30, s30, 1
  s_cmp_eq_u64 vcc, 0
  s_cbranch_scc1 L_f2_pok
  s_add_u32 s70, s70, 1
  s_cmp_lt_u32 s70, 262144
  s_cbranch_scc1 L_f2_p
L_f2_pok:
  s_nop 1
  v_add_f32_dpp v104, v104, v104 row_ror:8 row_mask:0xf bank_mask:0xf
  v_add_f32_dpp v105, v105, v105 row_ror:8 row_mask:0xf bank_mask:0xf
  v_add_f32_dpp v106, v106, v106 row_ror:8 row_mask:0xf bank_mask:0xf
  v_add_f32_dpp v107, v107, v107 row_ror:8 row_mask:0xf bank_mask:0xf
  v_mov_b32 v108, v104
  v_mov_b32 v109, v105
  v_mov_b32 v110, v106
  v_mov_b32 v111, v107
  v_permlane16_swap_b32 v108, v104
  v_permlane16_swap_b32 v109, v105
  v_permlane16_swap_b32 v110, v106
  v_permlane16_swap_b32 v111, v107
  v_add_f32 v104, v104, v108
  v_add_f32 v105, v105, v109
  v_add_f32 v106, v106, v110
  v_add_f32 v107, v107, v111
  v_mov_b32 v108, v104
  v_mov_b32 v109, v105
  v_mov_b32 v110, v106
  v_mov_b32 v111, v107
  v_permlane32_swap_b32 v108, v104
  v_permlane32_swap_b32 v109, v105
  v_permlane32_swap_b32 v110, v106
  v_permlane32_swap_b32 v111, v107
  v_add_f32 v104, v104, v108
  v_add_f32 v105, v105, v109
  v_add_f32 v106, v106, v110
  v_add_f32 v107, v107, v111
  v_cvt_pk_bf16_f32 v104, 0, v104
  v_cvt_pk_bf16_f32 v105, 0, v105
  v_cvt_pk_bf16_f32 v106, 0, v106
  v_cvt_pk_bf16_f32 v107, 0, v107
  v_mul_f32 v104, v104, v24
  v_mul_f32 v105, v105, v25
  v_mul_f32 v106, v106, v26
  v_mul_f32 v107, v107, v27
  v_cvt_pk_bf16_f32 v104, 0, v104
  v_cvt_pk_bf16_f32 v105, 0, v105
  v_cvt_pk_bf16_f32 v106, 0, v106
  v_cvt_pk_bf16_f32 v107, 0, v107
  v_add_f32 v8, v104, v16
  v_add_f32 v9, v105, v17
  v_add_f32 v10, v106, v18
  v_add_f32 v11, v107, v19
  v_cvt_pk_bf16_f32 v8, v8, v9
  v_cvt_pk_bf16_f32 v9, v10, v11
  s_mov_b64 exec, 0xff
  global_store_dwordx2 v37, v[8:9], s[38:39] sc1
  s_mov_b64 exec, 1
  v_mov_b32 v10, s74
  s_lshl_b32 s49, s61, 7
  s_add_u32 s49, s49, 28672
  v_mov_b32 v11, s49
  global_store_dword v11, v10, s[42:43] sc1
L_fin:
L_end:
  s_endpgm
.p2align 7
L_table:
  .long 0xff00ff13, 0x1504ff14, 0xff08ff1b, 0x1d0cff1c, 0xff10ff23, 0xff14ff24, 0xff18ff2b, 0x2d1cff2c
  .long 0xff01ff10, 0x1705ff16, 0xff09ff18, 0x1f0dff1e, 0xff11ff20, 0xff15ff25, 0xff19ff28, 0x2f1dff2e
  .long 0x1202ff11, 0xff0605ff, 0x1a0aff19, 0xff0e10ff, 0x2212ff21, 0x2716ff26, 0x2a1aff29, 0xff1e25ff
  .long 0xffff00ff, 0xffff06ff, 0xffff0bff, 0xffff11ff, 0xffff16ff, 0xffff1bff, 0xffff20ff, 0xffff26ff
  .long 0xffff01ff, 0xffff07ff, 0xffff0cff, 0xffff12ff, 0xffff17ff, 0xffff1cff, 0xffff21ff, 0xffff27ff
  .long 0xffff02ff, 0xffff08ff, 0xffff0dff, 0xffff13ff, 0xffff18ff, 0xffff1dff, 0xffff22ff, 0xffff28ff
  .long 0xffff03ff, 0xffff09ff, 0xffff0eff, 0xffff14ff, 0xffff19ff, 0xffff1eff, 0xffff23ff, 0xffff29ff
  .long 0xff0304ff, 0xff070aff, 0xff0b0fff, 0xff0f15ff, 0xff131aff, 0xff171fff, 0xff1b24ff, 0xff1f2aff
L_touch:
  .long 0x80804101, 0x80804909, 0x80804303, 0x80808080, 0x80804b0b, 0x80804505, 0x80804d0d, 0x80808080
  .long 0x80804707, 0x80804f0f, 0x80805900, 0x80808080, 0x80805b08, 0x80805d02, 0x80805f0a, 0x80808080
  .long 0x80805804, 0x80805a0c, 0x80805c06, 0x80808080, 0x80805e0e, 0x80805140, 0x80806148, 0x80808080
  .long 0x80806942, 0x8080714a, 0x80807944, 0x80808080, 0x8080534c, 0x80806346, 0x80806b4e, 0x80808080
.section .rodata,"a"
.p2align 6
.amdhsa_kernel adaLN_cond__sliding_block_cached__glu_gated_swiglu__decode_kernel
  .amdhsa_next_free_vgpr 168
  .amdhsa_next_free_sgpr 102
  .amdhsa_accum_offset 168
  .amdhsa_group_segment_fixed_size 0
  .amdhsa_kernarg_size 112
  .amdhsa_user_sgpr_count 2
  .amdhsa_user_sgpr_kernarg_segment_ptr 1
  .amdhsa_system_sgpr_workgroup_id_x 1
.end_amdhsa_kernel
```

```asm
; @launch grid=(256,1,1) block=(768,1,1) lds=143360
.amdgcn_target "amdgcn-amd-amdhsa--gfx950"
.text
.globl adaLN_cond__sliding_block_cached__glu_gated_swiglu__decode_kernel
.p2align 8
.type adaLN_cond__sliding_block_cached__glu_gated_swiglu__decode_kernel,@function
adaLN_cond__sliding_block_cached__glu_gated_swiglu__decode_kernel:
  s_load_dwordx8 s[16:23], s[0:1], 0
  s_cmp_ge_u32 s2, 256
  s_cbranch_scc1 L_end
  v_lshrrev_b32 v2, 6, v0
  v_and_b32 v1, 63, v0
  v_readfirstlane_b32 s13, v2
  s_bfe_u32 s7, s2, 0x20003
  s_bfe_u32 s6, s2, 0x20005
  s_and_b32 s8, s2, 7
  s_lshl2_add_u32 s6, s8, s6
  s_and_b32 s9, s2, 0x80
  s_lshr_b32 s9, s9, 2
  s_add_u32 s6, s6, s9
  s_cmp_eq_u32 s7, 3
  s_cbranch_scc1 L_serv
  s_cmp_eq_u32 s13, 0
  s_cbranch_scc1 L_pub
L_stream:
  s_sub_u32 s9, s13, 1
  s_lshl_b32 s11, s9, 10
  s_mul_i32 s4, s7, 11264
  s_lshl_b32 s10, s6, 22
  s_add_u32 s10, s10, s4
  s_add_u32 s10, s10, 0x300000
  v_and_b32 v0, 15, v1
  v_lshl_add_u32 v0, v0, 6, s11
  v_and_b32 v3, 48, v1
  v_add_u32 v0, v3, v0
  s_lshr_b32 s15, s2, 3
  s_mul_i32 s12, s15, 33792
  s_sub_u32 s46, 0x100000, s4
  s_mov_b32 s47, 0x20000
  s_mov_b32 s14, 1047552
  s_waitcnt lgkmcnt(0)
  s_add_u32 s44, s18, s10
  s_addc_u32 s45, s19, 0
  buffer_load_dwordx4 v[44:47], v0, s[44:47], s12 offen nt
  s_add_u32 s12, s12, 33792
  s_cmp_eq_u32 s12, s14
  s_cselect_b32 s12, 0, s12
  buffer_load_dwordx4 v[48:51], v0, s[44:47], s12 offen nt
  s_add_u32 s12, s12, 33792
  s_cmp_eq_u32 s12, s14
  s_cselect_b32 s12, 0, s12
  buffer_load_dwordx4 v[52:55], v0, s[44:47], s12 offen nt
  s_add_u32 s12, s12, 33792
  s_cmp_eq_u32 s12, s14
  s_cselect_b32 s12, 0, s12
  buffer_load_dwordx4 v[40:43], v0, s[44:47], s14 offen nt
  s_add_u32 s48, s20, s10
  s_addc_u32 s49, s21, 0
  s_mov_b32 s50, s46
  s_mov_b32 s51, 0x20000
  s_mov_b32 s52, 0xcccccccc
  s_mov_b32 s53, 0xcccccccc
  s_mov_b32 s54, 0xaaaaaaaa
  s_mov_b32 s55, 0xaaaaaaaa
  v_and_b32 v38, 15, v1
  v_lshlrev_b32 v38, 4, v38
  s_lshl_b32 s10, s9, 11
  s_add_u32 s10, s10, 12288
  v_lshl_add_u32 v3, v1, 3, s10
  v_mov_b32 v4, 0x7fff0000
  v_mov_b32 v5, 0xff800000
  ds_write_b64 v3, v[4:5] offset:0
  ds_write_b64 v3, v[4:5] offset:512
  ds_write_b64 v3, v[4:5] offset:1024
  v_lshrrev_b32 v3, 4, v1
  v_lshl_add_u32 v39, v38, 1, s10
  v_lshl_add_u32 v39, v3, 3, v39
  s_sub_u32 s68, s15, 1
  v_and_b32 v4, 3, v1
  v_lshl_add_u32 v4, v3, 2, v4
  v_bfe_u32 v3, v1, 2, 2
  v_lshl_add_u32 v3, v3, 8, s11
  v_cmp_eq_u32 s[70:71], 0, v4
  v_add_u32 v24, s68, v4
  v_subrev_u32 v5, 31, v24
  v_min_u32 v24, v5, v24
  v_cndmask_b32 v24, v24, 31, s[70:71]
  v_mul_u32_u24 v24, 33792, v24
  v_add_u32 v24, v3, v24
  v_add_u32 v26, s68, v4
  v_add_u32 v26, 16, v26
  v_subrev_u32 v5, 31, v26
  v_min_u32 v26, v5, v26
  v_mul_u32_u24 v26, 33792, v26
  v_add_u32 v26, v3, v26
  s_lshl_b32 s11, s9, 9
  s_sub_u32 s11, s11, s10
  s_mov_b32 s32, 4
  s_mul_i32 s33, s9, 0x60000000
  s_add_u32 s33, s33, 0x10000000
  s_mov_b64 s[64:65], 0
  s_mov_b64 s[66:67], 0
  s_mov_b32 s38, 0
  s_mov_b32 s39, 2
  s_mov_b32 s75, 0
  s_mov_b32 s61, 0
  v_and_b32 v3, 1, v1
  v_lshlrev_b32 v3, 4, v3
  v_mov_b32 v20, 0xffff
  v_lshlrev_b32 v3, v3, v20
  v_bfe_u32 v20, v1, 1, 3
  v_cmp_eq_u32 vcc, 0, v20
  s_nop 1
  v_cndmask_b32 v34, 0, v3, vcc
  v_cmp_eq_u32 vcc, 1, v20
  s_nop 1
  v_cndmask_b32 v35, 0, v3, vcc
  v_cmp_eq_u32 vcc, 2, v20
  s_nop 1
  v_cndmask_b32 v36, 0, v3, vcc
  s_barrier
  s_waitcnt lgkmcnt(0)
  s_mov_b32 s56, s10
  s_mov_b32 s41, 5
  s_mov_b32 s57, 0
  s_mov_b32 s76, 20480
  s_mov_b32 s34, 175104
  s_mov_b32 s77, 0
  s_mov_b32 s35, 28
  s_mov_b32 s59, 0
  v_mov_b32 v22, 1332
  v_mov_b32 v23, 0
  v_mov_b32 v2, 0
  s_call_b64 s[62:63], L_kq
  buffer_load_dwordx4 v[56:59], v0, s[44:47], s12 offen nt
  s_add_u32 s12, s12, 33792
  s_cmp_eq_u32 s12, s14
  s_cselect_b32 s12, 0, s12
  s_call_b64 s[62:63], L_kq
  buffer_load_dwordx4 v[60:63], v0, s[44:47], s12 offen nt
  s_add_u32 s12, s12, 33792
  s_cmp_eq_u32 s12, s14
  s_cselect_b32 s12, 0, s12
  s_call_b64 s[62:63], L_kq
  buffer_load_dwordx4 v[64:67], v0, s[44:47], s12 offen nt
  s_add_u32 s12, s12, 33792
  s_cmp_eq_u32 s12, s14
  s_cselect_b32 s12, 0, s12
  s_call_b64 s[62:63], L_kq
  buffer_load_dwordx4 v[68:71], v0, s[44:47], s12 offen nt
  s_add_u32 s12, s12, 33792
  s_cmp_eq_u32 s12, s14
  s_cselect_b32 s12, 0, s12
  s_call_b64 s[62:63], L_kq
  buffer_load_dwordx4 v[72:75], v0, s[44:47], s12 offen nt
  s_add_u32 s12, s12, 33792
  s_cmp_eq_u32 s12, s14
  s_cselect_b32 s12, 0, s12
  s_call_b64 s[62:63], L_kq
  buffer_load_dwordx4 v[76:79], v0, s[44:47], s12 offen nt
  s_add_u32 s12, s12, 33792
  s_cmp_eq_u32 s12, s14
  s_cselect_b32 s12, 0, s12
  s_call_b64 s[62:63], L_kq
  buffer_load_dwordx4 v[80:83], v0, s[44:47], s12 offen nt
  s_add_u32 s12, s12, 33792
  s_cmp_eq_u32 s12, s14
  s_cselect_b32 s12, 0, s12
  s_call_b64 s[62:63], L_kq
  buffer_load_dwordx4 v[84:87], v0, s[44:47], s12 offen nt
  s_add_u32 s12, s12, 33792
  s_cmp_eq_u32 s12, s14
  s_cselect_b32 s12, 0, s12
  s_call_b64 s[62:63], L_kq
  buffer_load_dwordx4 v[88:91], v0, s[44:47], s12 offen nt
  s_add_u32 s12, s12, 33792
  s_cmp_eq_u32 s12, s14
  s_cselect_b32 s12, 0, s12
  s_call_b64 s[62:63], L_kq
  buffer_load_dwordx4 v[92:95], v0, s[44:47], s12 offen nt
  s_add_u32 s12, s12, 33792
  s_cmp_eq_u32 s12, s14
  s_cselect_b32 s12, 0, s12
  s_call_b64 s[62:63], L_kq
  buffer_load_dwordx4 v[96:99], v0, s[44:47], s12 offen nt
  s_add_u32 s12, s12, 33792
  s_cmp_eq_u32 s12, s14
  s_cselect_b32 s12, 0, s12
  s_call_b64 s[62:63], L_ks
  buffer_load_dwordx4 v[100:103], v0, s[44:47], s12 offen nt
  s_add_u32 s12, s12, 33792
  s_cmp_eq_u32 s12, s14
  s_cselect_b32 s12, 0, s12
  s_call_b64 s[62:63], L_ks
  buffer_load_dwordx4 v[104:107], v0, s[44:47], s12 offen nt
  s_add_u32 s12, s12, 33792
  s_cmp_eq_u32 s12, s14
  s_cselect_b32 s12, 0, s12
  s_call_b64 s[62:63], L_ks
  buffer_load_dwordx4 v[108:111], v0, s[44:47], s12 offen nt
  s_add_u32 s12, s12, 33792
  s_cmp_eq_u32 s12, s14
  s_cselect_b32 s12, 0, s12
  s_call_b64 s[62:63], L_ks
  buffer_load_dwordx4 v[112:115], v0, s[44:47], s12 offen nt
  s_add_u32 s12, s12, 33792
  s_cmp_eq_u32 s12, s14
  s_cselect_b32 s12, 0, s12
  s_call_b64 s[62:63], L_ks
  buffer_load_dwordx4 v[116:119], v0, s[44:47], s12 offen nt
  s_add_u32 s12, s12, 33792
  s_cmp_eq_u32 s12, s14
  s_cselect_b32 s12, 0, s12
  s_call_b64 s[62:63], L_ks
  buffer_load_dwordx4 v[120:123], v0, s[44:47], s12 offen nt
  s_add_u32 s12, s12, 33792
  s_cmp_eq_u32 s12, s14
  s_cselect_b32 s12, 0, s12
  s_call_b64 s[62:63], L_ks
  buffer_load_dwordx4 v[124:127], v0, s[44:47], s12 offen nt
  s_add_u32 s12, s12, 33792
  s_cmp_eq_u32 s12, s14
  s_cselect_b32 s12, 0, s12
  s_call_b64 s[62:63], L_ks
  buffer_load_dwordx4 v[128:131], v0, s[44:47], s12 offen nt
  s_add_u32 s12, s12, 33792
  s_cmp_eq_u32 s12, s14
  s_cselect_b32 s12, 0, s12
  s_call_b64 s[62:63], L_ks
  buffer_load_dwordx4 v[132:135], v0, s[44:47], s12 offen nt
  s_add_u32 s12, s12, 33792
  s_cmp_eq_u32 s12, s14
  s_cselect_b32 s12, 0, s12
  s_call_b64 s[62:63], L_ks
  buffer_load_dwordx4 v[136:139], v0, s[44:47], s12 offen nt
  s_add_u32 s12, s12, 33792
  s_cmp_eq_u32 s12, s14
  s_cselect_b32 s12, 0, s12
  s_call_b64 s[62:63], L_ks
  buffer_load_dwordx4 v[140:143], v0, s[44:47], s12 offen nt
  s_add_u32 s12, s12, 33792
  s_cmp_eq_u32 s12, s14
  s_cselect_b32 s12, 0, s12
  s_call_b64 s[62:63], L_ks
  buffer_load_dwordx4 v[144:147], v0, s[44:47], s12 offen nt
  s_add_u32 s12, s12, 33792
  s_cmp_eq_u32 s12, s14
  s_cselect_b32 s12, 0, s12
  s_call_b64 s[62:63], L_ks
  buffer_load_dwordx4 v[148:151], v0, s[44:47], s12 offen nt
  s_add_u32 s12, s12, 33792
  s_cmp_eq_u32 s12, s14
  s_cselect_b32 s12, 0, s12
  s_call_b64 s[62:63], L_ks
  buffer_load_dwordx4 v[152:155], v0, s[44:47], s12 offen nt
  s_add_u32 s12, s12, 33792
  s_cmp_eq_u32 s12, s14
  s_cselect_b32 s12, 0, s12
  s_call_b64 s[62:63], L_ks
  buffer_load_dwordx4 v[156:159], v0, s[44:47], s12 offen nt
  s_add_u32 s12, s12, 33792
  s_cmp_eq_u32 s12, s14
  s_cselect_b32 s12, 0, s12
  s_call_b64 s[62:63], L_ks
  buffer_load_dwordx4 v[160:163], v0, s[44:47], s12 offen nt
  s_add_u32 s12, s12, 33792
  s_cmp_eq_u32 s12, s14
  s_cselect_b32 s12, 0, s12
  s_call_b64 s[62:63], L_ks
  buffer_load_dwordx4 v[164:167], v0, s[44:47], s12 offen nt
  s_add_u32 s12, s12, 33792
  s_cmp_eq_u32 s12, s14
  s_cselect_b32 s12, 0, s12
  s_mov_b32 s10, 0
L_kw:
  s_cmp_ge_u32 s39, 6
  s_cbranch_scc1 L_v0
  s_call_b64 s[100:101], L_work
  s_sleep 1
  s_add_u32 s10, s10, 1
  s_cmp_lt_u32 s10, 262144
  s_cbranch_scc1 L_kw
L_v0:
  s_mov_b32 s32, 0
  v_mov_b32 v2, 8
  s_mov_b32 s35, s59
  ds_read_b64 v[22:23], v2 offset:288
  v_mov_b32_dpp v0, v36 row_shr:2 row_mask:0xf bank_mask:0xf bound_ctrl:0
  s_mov_b32 s77, 62
  s_mov_b32 s76, 12288
  s_mov_b32 s34, 164659
  s_waitcnt lgkmcnt(0)
  s_call_b64 s[62:63], L_vs
  v_add_u32_dpp v3, v28, v38 row_newbcast:0 row_mask:0xf bank_mask:0xf
  buffer_load_dwordx4 v[40:43], v3, s[48:51], 0 offen nt
  s_mov_b64 vcc, s[52:53]
  v_mfma_f32_16x16x32_bf16 v[8:11], v[4:7], v[136:139], 0
  v_mfma_f32_16x16x32_bf16 v[136:139], v[4:7], v[140:143], 0
  v_mfma_f32_16x16x32_bf16 v[140:143], v[4:7], v[144:147], 0
  v_mfma_f32_16x16x32_bf16 v[144:147], v[4:7], v[148:151], 0
  s_nop 4
  v_cndmask_b32 v8, v8, v9, s[54:55]
  v_cndmask_b32 v10, v10, v11, s[54:55]
  v_cndmask_b32 v136, v136, v137, s[54:55]
  v_cndmask_b32 v138, v138, v139, s[54:55]
  v_cndmask_b32 v140, v140, v141, s[54:55]
  v_cndmask_b32 v142, v142, v143, s[54:55]
  v_cndmask_b32 v144, v144, v145, s[54:55]
  v_cndmask_b32 v146, v146, v147, s[54:55]
  v_cndmask_b32_dpp v16, v8, v10, vcc quad_perm:[0,1,2,3] row_mask:0x4 bank_mask:0xf
  v_cndmask_b32_dpp v18, v136, v138, vcc quad_perm:[0,1,2,3] row_mask:0x4 bank_mask:0xf
  v_cndmask_b32_dpp v17, v140, v142, vcc quad_perm:[0,1,2,3] row_mask:0x4 bank_mask:0xf
  v_cndmask_b32_dpp v19, v144, v146, vcc quad_perm:[0,1,2,3] row_mask:0x4 bank_mask:0xf
  s_call_b64 s[62:63], L_vs
  s_cbranch_scc0 L_dr5
  v_add_u32_dpp v3, v28, v38 row_newbcast:1 row_mask:0xf bank_mask:0xf
  buffer_load_dwordx4 v[44:47], v3, s[48:51], 0 offen nt
  s_call_b64 s[62:63], L_vs
  s_cbranch_scc0 L_dr5
  v_add_u32_dpp v3, v28, v38 row_newbcast:2 row_mask:0xf bank_mask:0xf
  buffer_load_dwordx4 v[48:51], v3, s[48:51], 0 offen nt
  s_call_b64 s[62:63], L_vs
  s_cbranch_scc0 L_dr5
  v_add_u32_dpp v3, v28, v38 row_newbcast:3 row_mask:0xf bank_mask:0xf
  buffer_load_dwordx4 v[52:55], v3, s[48:51], 0 offen nt
  s_call_b64 s[62:63], L_vs
  s_cbranch_scc0 L_dr5
  v_add_u32_dpp v3, v28, v38 row_newbcast:4 row_mask:0xf bank_mask:0xf
  buffer_load_dwordx4 v[56:59], v3, s[48:51], 0 offen nt
  s_call_b64 s[62:63], L_vs
  s_cbranch_scc0 L_dr5
  v_add_u32_dpp v3, v28, v38 row_newbcast:5 row_mask:0xf bank_mask:0xf
  buffer_load_dwordx4 v[60:63], v3, s[48:51], 0 offen nt
  v_and_b32_dpp v12, v29, v34 row_newbcast:0 row_mask:0xf bank_mask:0xf
  v_and_b32_dpp v13, v29, v35 row_newbcast:0 row_mask:0xf bank_mask:0xf
  v_and_b32_dpp v14, v29, v36 row_newbcast:0 row_mask:0xf bank_mask:0xf
  v_and_b32_dpp v15, v29, v0 row_newbcast:0 row_mask:0xf bank_mask:0xf
  s_nop 1
  v_mfma_f32_16x16x32_bf16 v[8:11], v[12:15], v[40:43], v[8:11]
  s_call_b64 s[62:63], L_vs
  s_cbranch_scc0 L_dr6
  v_add_u32_dpp v3, v28, v38 row_newbcast:6 row_mask:0xf bank_mask:0xf
  buffer_load_dwordx4 v[64:67], v3, s[48:51], 0 offen nt
  v_and_b32_dpp v12, v29, v34 row_newbcast:1 row_mask:0xf bank_mask:0xf
  v_and_b32_dpp v13, v29, v35 row_newbcast:1 row_mask:0xf bank_mask:0xf
  v_and_b32_dpp v14, v29, v36 row_newbcast:1 row_mask:0xf bank_mask:0xf
  v_and_b32_dpp v15, v29, v0 row_newbcast:1 row_mask:0xf bank_mask:0xf
  s_nop 1
  v_mfma_f32_16x16x32_bf16 v[8:11], v[12:15], v[44:47], v[8:11]
  s_call_b64 s[62:63], L_vs
  s_cbranch_scc0 L_dr7
  v_add_u32_dpp v3, v28, v38 row_newbcast:7 row_mask:0xf bank_mask:0xf
  buffer_load_dwordx4 v[68:71], v3, s[48:51], 0 offen nt
  v_and_b32_dpp v12, v29, v34 row_newbcast:2 row_mask:0xf bank_mask:0xf
  v_and_b32_dpp v13, v29, v35 row_newbcast:2 row_mask:0xf bank_mask:0xf
  v_and_b32_dpp v14, v29, v36 row_newbcast:2 row_mask:0xf bank_mask:0xf
  v_and_b32_dpp v15, v29, v0 row_newbcast:2 row_mask:0xf bank_mask:0xf
  s_nop 1
  v_mfma_f32_16x16x32_bf16 v[8:11], v[12:15], v[48:51], v[8:11]
  s_call_b64 s[62:63], L_vs
  s_cbranch_scc0 L_dr8
  v_add_u32_dpp v3, v28, v38 row_newbcast:8 row_mask:0xf bank_mask:0xf
  buffer_load_dwordx4 v[72:75], v3, s[48:51], 0 offen nt
  v_and_b32_dpp v12, v29, v34 row_newbcast:3 row_mask:0xf bank_mask:0xf
  v_and_b32_dpp v13, v29, v35 row_newbcast:3 row_mask:0xf bank_mask:0xf
  v_and_b32_dpp v14, v29, v36 row_newbcast:3 row_mask:0xf bank_mask:0xf
  v_and_b32_dpp v15, v29, v0 row_newbcast:3 row_mask:0xf bank_mask:0xf
  s_nop 1
  v_mfma_f32_16x16x32_bf16 v[8:11], v[12:15], v[52:55], v[8:11]
  s_call_b64 s[62:63], L_vs
  s_cbranch_scc0 L_dr9
  v_add_u32_dpp v3, v28, v38 row_newbcast:9 row_mask:0xf bank_mask:0xf
  buffer_load_dwordx4 v[76:79], v3, s[48:51], 0 offen nt
  v_and_b32_dpp v12, v29, v34 row_newbcast:4 row_mask:0xf bank_mask:0xf
  v_and_b32_dpp v13, v29, v35 row_newbcast:4 row_mask:0xf bank_mask:0xf
  v_and_b32_dpp v14, v29, v36 row_newbcast:4 row_mask:0xf bank_mask:0xf
  v_and_b32_dpp v15, v29, v0 row_newbcast:4 row_mask:0xf bank_mask:0xf
  s_nop 1
  v_mfma_f32_16x16x32_bf16 v[8:11], v[12:15], v[56:59], v[8:11]
  s_call_b64 s[62:63], L_vs
  s_cbranch_scc0 L_dr10
  v_add_u32_dpp v3, v28, v38 row_newbcast:10 row_mask:0xf bank_mask:0xf
  buffer_load_dwordx4 v[80:83], v3, s[48:51], 0 offen nt
  v_and_b32_dpp v12, v29, v34 row_newbcast:5 row_mask:0xf bank_mask:0xf
  v_and_b32_dpp v13, v29, v35 row_newbcast:5 row_mask:0xf bank_mask:0xf
  v_and_b32_dpp v14, v29, v36 row_newbcast:5 row_mask:0xf bank_mask:0xf
  v_and_b32_dpp v15, v29, v0 row_newbcast:5 row_mask:0xf bank_mask:0xf
  s_nop 1
  v_mfma_f32_16x16x32_bf16 v[8:11], v[12:15], v[60:63], v[8:11]
  s_call_b64 s[62:63], L_vq
  s_cbranch_scc0 L_dr11
  v_add_u32_dpp v3, v28, v38 row_newbcast:11 row_mask:0xf bank_mask:0xf
  buffer_load_dwordx4 v[84:87], v3, s[48:51], 0 offen nt
  v_and_b32_dpp v12, v29, v34 row_newbcast:6 row_mask:0xf bank_mask:0xf
  v_and_b32_dpp v13, v29, v35 row_newbcast:6 row_mask:0xf bank_mask:0xf
  v_and_b32_dpp v14, v29, v36 row_newbcast:6 row_mask:0xf bank_mask:0xf
  v_and_b32_dpp v15, v29, v0 row_newbcast:6 row_mask:0xf bank_mask:0xf
  s_nop 1
  v_mfma_f32_16x16x32_bf16 v[8:11], v[12:15], v[64:67], v[8:11]
  s_call_b64 s[62:63], L_vq
  s_cbranch_scc0 L_dr12
  v_add_u32_dpp v3, v28, v38 row_newbcast:12 row_mask:0xf bank_mask:0xf
  buffer_load_dwordx4 v[88:91], v3, s[48:51], 0 offen nt
  v_and_b32_dpp v12, v29, v34 row_newbcast:7 row_mask:0xf bank_mask:0xf
  v_and_b32_dpp v13, v29, v35 row_newbcast:7 row_mask:0xf bank_mask:0xf
  v_and_b32_dpp v14, v29, v36 row_newbcast:7 row_mask:0xf bank_mask:0xf
  v_and_b32_dpp v15, v29, v0 row_newbcast:7 row_mask:0xf bank_mask:0xf
  s_nop 1
  v_mfma_f32_16x16x32_bf16 v[8:11], v[12:15], v[68:71], v[8:11]
  s_call_b64 s[62:63], L_vq
  s_cbranch_scc0 L_dr13
  v_add_u32_dpp v3, v28, v38 row_newbcast:13 row_mask:0xf bank_mask:0xf
  buffer_load_dwordx4 v[92:95], v3, s[48:51], 0 offen nt
  v_and_b32_dpp v12, v29, v34 row_newbcast:8 row_mask:0xf bank_mask:0xf
  v_and_b32_dpp v13, v29, v35 row_newbcast:8 row_mask:0xf bank_mask:0xf
  v_and_b32_dpp v14, v29, v36 row_newbcast:8 row_mask:0xf bank_mask:0xf
  v_and_b32_dpp v15, v29, v0 row_newbcast:8 row_mask:0xf bank_mask:0xf
  s_nop 1
  v_mfma_f32_16x16x32_bf16 v[8:11], v[12:15], v[72:75], v[8:11]
  s_call_b64 s[62:63], L_vq
  s_cbranch_scc0 L_dr14
  v_add_u32_dpp v3, v28, v38 row_newbcast:14 row_mask:0xf bank_mask:0xf
  buffer_load_dwordx4 v[96:99], v3, s[48:51], 0 offen nt
  v_and_b32_dpp v12, v29, v34 row_newbcast:9 row_mask:0xf bank_mask:0xf
  v_and_b32_dpp v13, v29, v35 row_newbcast:9 row_mask:0xf bank_mask:0xf
  v_and_b32_dpp v14, v29, v36 row_newbcast:9 row_mask:0xf bank_mask:0xf
  v_and_b32_dpp v15, v29, v0 row_newbcast:9 row_mask:0xf bank_mask:0xf
  s_nop 1
  v_mfma_f32_16x16x32_bf16 v[8:11], v[12:15], v[76:79], v[8:11]
  s_call_b64 s[62:63], L_vq
  s_cbranch_scc0 L_dr15
  v_add_u32_dpp v3, v28, v38 row_newbcast:15 row_mask:0xf bank_mask:0xf
  buffer_load_dwordx4 v[100:103], v3, s[48:51], 0 offen nt
  v_and_b32_dpp v12, v29, v34 row_newbcast:10 row_mask:0xf bank_mask:0xf
  v_and_b32_dpp v13, v29, v35 row_newbcast:10 row_mask:0xf bank_mask:0xf
  v_and_b32_dpp v14, v29, v36 row_newbcast:10 row_mask:0xf bank_mask:0xf
  v_and_b32_dpp v15, v29, v0 row_newbcast:10 row_mask:0xf bank_mask:0xf
  s_nop 1
  v_mfma_f32_16x16x32_bf16 v[8:11], v[12:15], v[80:83], v[8:11]
  s_call_b64 s[62:63], L_vq
  s_cbranch_scc0 L_dr16
  v_add_u32_dpp v3, v30, v38 row_newbcast:0 row_mask:0xf bank_mask:0xf
  buffer_load_dwordx4 v[104:107], v3, s[48:51], 0 offen nt
  v_and_b32_dpp v12, v29, v34 row_newbcast:11 row_mask:0xf bank_mask:0xf
  v_and_b32_dpp v13, v29, v35 row_newbcast:11 row_mask:0xf bank_mask:0xf
  v_and_b32_dpp v14, v29, v36 row_newbcast:11 row_mask:0xf bank_mask:0xf
  v_and_b32_dpp v15, v29, v0 row_newbcast:11 row_mask:0xf bank_mask:0xf
  s_nop 1
  v_mfma_f32_16x16x32_bf16 v[8:11], v[12:15], v[84:87], v[8:11]
  s_call_b64 s[62:63], L_vq
  s_cbranch_scc0 L_dr17
  v_add_u32_dpp v3, v30, v38 row_newbcast:1 row_mask:0xf bank_mask:0xf
  buffer_load_dwordx4 v[108:111], v3, s[48:51], 0 offen nt
  v_and_b32_dpp v12, v29, v34 row_newbcast:12 row_mask:0xf bank_mask:0xf
  v_and_b32_dpp v13, v29, v35 row_newbcast:12 row_mask:0xf bank_mask:0xf
  v_and_b32_dpp v14, v29, v36 row_newbcast:12 row_mask:0xf bank_mask:0xf
  v_and_b32_dpp v15, v29, v0 row_newbcast:12 row_mask:0xf bank_mask:0xf
  s_nop 1
  v_mfma_f32_16x16x32_bf16 v[8:11], v[12:15], v[88:91], v[8:11]
  s_call_b64 s[62:63], L_vq
  s_cbranch_scc0 L_dr18
  v_add_u32_dpp v3, v30, v38 row_newbcast:2 row_mask:0xf bank_mask:0xf
  buffer_load_dwordx4 v[112:115], v3, s[48:51], 0 offen nt
  v_and_b32_dpp v12, v29, v34 row_newbcast:13 row_mask:0xf bank_mask:0xf
  v_and_b32_dpp v13, v29, v35 row_newbcast:13 row_mask:0xf bank_mask:0xf
  v_and_b32_dpp v14, v29, v36 row_newbcast:13 row_mask:0xf bank_mask:0xf
  v_and_b32_dpp v15, v29, v0 row_newbcast:13 row_mask:0xf bank_mask:0xf
  s_nop 1
  v_mfma_f32_16x16x32_bf16 v[8:11], v[12:15], v[92:95], v[8:11]
  s_call_b64 s[62:63], L_vq
  s_cbranch_scc0 L_dr19
  v_add_u32_dpp v3, v30, v38 row_newbcast:3 row_mask:0xf bank_mask:0xf
  buffer_load_dwordx4 v[116:119], v3, s[48:51], 0 offen nt
  v_and_b32_dpp v12, v29, v34 row_newbcast:14 row_mask:0xf bank_mask:0xf
  v_and_b32_dpp v13, v29, v35 row_newbcast:14 row_mask:0xf bank_mask:0xf
  v_and_b32_dpp v14, v29, v36 row_newbcast:14 row_mask:0xf bank_mask:0xf
  v_and_b32_dpp v15, v29, v0 row_newbcast:14 row_mask:0xf bank_mask:0xf
  s_nop 1
  v_mfma_f32_16x16x32_bf16 v[8:11], v[12:15], v[96:99], v[8:11]
  s_call_b64 s[62:63], L_vq
  s_cbranch_scc0 L_dr20
  v_add_u32_dpp v3, v30, v38 row_newbcast:4 row_mask:0xf bank_mask:0xf
  buffer_load_dwordx4 v[120:123], v3, s[48:51], 0 offen nt
  v_and_b32_dpp v12, v29, v34 row_newbcast:15 row_mask:0xf bank_mask:0xf
  v_and_b32_dpp v13, v29, v35 row_newbcast:15 row_mask:0xf bank_mask:0xf
  v_and_b32_dpp v14, v29, v36 row_newbcast:15 row_mask:0xf bank_mask:0xf
  v_and_b32_dpp v15, v29, v0 row_newbcast:15 row_mask:0xf bank_mask:0xf
  s_nop 1
  v_mfma_f32_16x16x32_bf16 v[8:11], v[12:15], v[100:103], v[8:11]
  s_call_b64 s[62:63], L_vq
  s_cbranch_scc0 L_dr21
  v_add_u32_dpp v3, v30, v38 row_newbcast:5 row_mask:0xf bank_mask:0xf
  buffer_load_dwordx4 v[124:127], v3, s[48:51], 0 offen nt
  v_and_b32_dpp v12, v31, v34 row_newbcast:0 row_mask:0xf bank_mask:0xf
  v_and_b32_dpp v13, v31, v35 row_newbcast:0 row_mask:0xf bank_mask:0xf
  v_and_b32_dpp v14, v31, v36 row_newbcast:0 row_mask:0xf bank_mask:0xf
  v_and_b32_dpp v15, v31, v0 row_newbcast:0 row_mask:0xf bank_mask:0xf
  s_nop 1
  v_mfma_f32_16x16x32_bf16 v[8:11], v[12:15], v[104:107], v[8:11]
  s_call_b64 s[62:63], L_vq
  s_cbranch_scc0 L_dr22
  v_add_u32_dpp v3, v30, v38 row_newbcast:6 row_mask:0xf bank_mask:0xf
  buffer_load_dwordx4 v[128:131], v3, s[48:51], 0 offen nt
  v_and_b32_dpp v12, v31, v34 row_newbcast:1 row_mask:0xf bank_mask:0xf
  v_and_b32_dpp v13, v31, v35 row_newbcast:1 row_mask:0xf bank_mask:0xf
  v_and_b32_dpp v14, v31, v36 row_newbcast:1 row_mask:0xf bank_mask:0xf
  v_and_b32_dpp v15, v31, v0 row_newbcast:1 row_mask:0xf bank_mask:0xf
  s_nop 1
  v_mfma_f32_16x16x32_bf16 v[8:11], v[12:15], v[108:111], v[8:11]
  s_call_b64 s[62:63], L_vq
  s_cbranch_scc0 L_dr23
  v_add_u32_dpp v3, v30, v38 row_newbcast:7 row_mask:0xf bank_mask:0xf
  buffer_load_dwordx4 v[132:135], v3, s[48:51], 0 offen nt
  v_and_b32_dpp v12, v31, v34 row_newbcast:2 row_mask:0xf bank_mask:0xf
  v_and_b32_dpp v13, v31, v35 row_newbcast:2 row_mask:0xf bank_mask:0xf
  v_and_b32_dpp v14, v31, v36 row_newbcast:2 row_mask:0xf bank_mask:0xf
  v_and_b32_dpp v15, v31, v0 row_newbcast:2 row_mask:0xf bank_mask:0xf
  s_nop 1
  v_mfma_f32_16x16x32_bf16 v[8:11], v[12:15], v[112:115], v[8:11]
  s_call_b64 s[62:63], L_vq
  s_cbranch_scc0 L_dr24
  v_add_u32_dpp v3, v30, v38 row_newbcast:8 row_mask:0xf bank_mask:0xf
  buffer_load_dwordx4 v[136:139], v3, s[48:51], 0 offen nt
  v_and_b32_dpp v12, v31, v34 row_newbcast:3 row_mask:0xf bank_mask:0xf
  v_and_b32_dpp v13, v31, v35 row_newbcast:3 row_mask:0xf bank_mask:0xf
  v_and_b32_dpp v14, v31, v36 row_newbcast:3 row_mask:0xf bank_mask:0xf
  v_and_b32_dpp v15, v31, v0 row_newbcast:3 row_mask:0xf bank_mask:0xf
  s_nop 1
  v_mfma_f32_16x16x32_bf16 v[8:11], v[12:15], v[116:119], v[8:11]
  s_call_b64 s[62:63], L_vq
  s_cbranch_scc0 L_dr25
  v_add_u32_dpp v3, v30, v38 row_newbcast:9 row_mask:0xf bank_mask:0xf
  buffer_load_dwordx4 v[140:143], v3, s[48:51], 0 offen nt
  v_and_b32_dpp v12, v31, v34 row_newbcast:4 row_mask:0xf bank_mask:0xf
  v_and_b32_dpp v13, v31, v35 row_newbcast:4 row_mask:0xf bank_mask:0xf
  v_and_b32_dpp v14, v31, v36 row_newbcast:4 row_mask:0xf bank_mask:0xf
  v_and_b32_dpp v15, v31, v0 row_newbcast:4 row_mask:0xf bank_mask:0xf
  s_nop 1
  v_mfma_f32_16x16x32_bf16 v[8:11], v[12:15], v[120:123], v[8:11]
  s_call_b64 s[62:63], L_vq
  s_cbranch_scc0 L_dr26
  v_add_u32_dpp v3, v30, v38 row_newbcast:10 row_mask:0xf bank_mask:0xf
  buffer_load_dwordx4 v[144:147], v3, s[48:51], 0 offen nt
  v_and_b32_dpp v12, v31, v34 row_newbcast:5 row_mask:0xf bank_mask:0xf
  v_and_b32_dpp v13, v31, v35 row_newbcast:5 row_mask:0xf bank_mask:0xf
  v_and_b32_dpp v14, v31, v36 row_newbcast:5 row_mask:0xf bank_mask:0xf
  v_and_b32_dpp v15, v31, v0 row_newbcast:5 row_mask:0xf bank_mask:0xf
  s_nop 1
  v_mfma_f32_16x16x32_bf16 v[8:11], v[12:15], v[124:127], v[8:11]
  s_call_b64 s[62:63], L_vq
  s_cbranch_scc0 L_dr27
  v_add_u32_dpp v3, v30, v38 row_newbcast:11 row_mask:0xf bank_mask:0xf
  buffer_load_dwordx4 v[148:151], v3, s[48:51], 0 offen nt
  v_and_b32_dpp v12, v31, v34 row_newbcast:6 row_mask:0xf bank_mask:0xf
  v_and_b32_dpp v13, v31, v35 row_newbcast:6 row_mask:0xf bank_mask:0xf
  v_and_b32_dpp v14, v31, v36 row_newbcast:6 row_mask:0xf bank_mask:0xf
  v_and_b32_dpp v15, v31, v0 row_newbcast:6 row_mask:0xf bank_mask:0xf
  s_nop 1
  v_mfma_f32_16x16x32_bf16 v[8:11], v[12:15], v[128:131], v[8:11]
  s_call_b64 s[62:63], L_vq
  s_cbranch_scc0 L_dr28
  v_add_u32_dpp v3, v30, v38 row_newbcast:12 row_mask:0xf bank_mask:0xf
  buffer_load_dwordx4 v[152:155], v3, s[48:51], 0 offen nt
  v_and_b32_dpp v12, v31, v34 row_newbcast:7 row_mask:0xf bank_mask:0xf
  v_and_b32_dpp v13, v31, v35 row_newbcast:7 row_mask:0xf bank_mask:0xf
  v_and_b32_dpp v14, v31, v36 row_newbcast:7 row_mask:0xf bank_mask:0xf
  v_and_b32_dpp v15, v31, v0 row_newbcast:7 row_mask:0xf bank_mask:0xf
  s_nop 1
  v_mfma_f32_16x16x32_bf16 v[8:11], v[12:15], v[132:135], v[8:11]
  s_call_b64 s[62:63], L_vq
  s_cbranch_scc0 L_dr29
  v_add_u32_dpp v3, v30, v38 row_newbcast:13 row_mask:0xf bank_mask:0xf
  buffer_load_dwordx4 v[156:159], v3, s[48:51], 0 offen nt
  v_and_b32_dpp v12, v31, v34 row_newbcast:8 row_mask:0xf bank_mask:0xf
  v_and_b32_dpp v13, v31, v35 row_newbcast:8 row_mask:0xf bank_mask:0xf
  v_and_b32_dpp v14, v31, v36 row_newbcast:8 row_mask:0xf bank_mask:0xf
  v_and_b32_dpp v15, v31, v0 row_newbcast:8 row_mask:0xf bank_mask:0xf
  s_nop 1
  v_mfma_f32_16x16x32_bf16 v[8:11], v[12:15], v[136:139], v[8:11]
  s_call_b64 s[62:63], L_vq
  s_cbranch_scc0 L_dr30
  v_add_u32_dpp v3, v30, v38 row_newbcast:14 row_mask:0xf bank_mask:0xf
  buffer_load_dwordx4 v[160:163], v3, s[48:51], 0 offen nt
  v_and_b32_dpp v12, v31, v34 row_newbcast:9 row_mask:0xf bank_mask:0xf
  v_and_b32_dpp v13, v31, v35 row_newbcast:9 row_mask:0xf bank_mask:0xf
  v_and_b32_dpp v14, v31, v36 row_newbcast:9 row_mask:0xf bank_mask:0xf
  v_and_b32_dpp v15, v31, v0 row_newbcast:9 row_mask:0xf bank_mask:0xf
  s_nop 1
  v_mfma_f32_16x16x32_bf16 v[8:11], v[12:15], v[140:143], v[8:11]
  s_call_b64 s[62:63], L_vq
  s_cbranch_scc0 L_dr31
  v_add_u32_dpp v3, v30, v38 row_newbcast:15 row_mask:0xf bank_mask:0xf
  buffer_load_dwordx4 v[164:167], v3, s[48:51], 0 offen nt
  v_and_b32_dpp v12, v31, v34 row_newbcast:10 row_mask:0xf bank_mask:0xf
  v_and_b32_dpp v13, v31, v35 row_newbcast:10 row_mask:0xf bank_mask:0xf
  v_and_b32_dpp v14, v31, v36 row_newbcast:10 row_mask:0xf bank_mask:0xf
  v_and_b32_dpp v15, v31, v0 row_newbcast:10 row_mask:0xf bank_mask:0xf
  s_nop 1
  v_mfma_f32_16x16x32_bf16 v[8:11], v[12:15], v[144:147], v[8:11]
  s_call_b64 s[62:63], L_vq
  s_cbranch_scc0 L_dr32
  v_add_u32_dpp v3, v32, v38 row_newbcast:0 row_mask:0xf bank_mask:0xf
  buffer_load_dwordx4 v[40:43], v3, s[48:51], 0 offen nt
  v_and_b32_dpp v12, v31, v34 row_newbcast:11 row_mask:0xf bank_mask:0xf
  v_and_b32_dpp v13, v31, v35 row_newbcast:11 row_mask:0xf bank_mask:0xf
  v_and_b32_dpp v14, v31, v36 row_newbcast:11 row_mask:0xf bank_mask:0xf
  v_and_b32_dpp v15, v31, v0 row_newbcast:11 row_mask:0xf bank_mask:0xf
  s_nop 1
  v_mfma_f32_16x16x32_bf16 v[8:11], v[12:15], v[148:151], v[8:11]
  s_call_b64 s[62:63], L_vq
  s_cbranch_scc0 L_dr33
  v_add_u32_dpp v3, v32, v38 row_newbcast:1 row_mask:0xf bank_mask:0xf
  buffer_load_dwordx4 v[44:47], v3, s[48:51], 0 offen nt
  v_and_b32_dpp v12, v31, v34 row_newbcast:12 row_mask:0xf bank_mask:0xf
  v_and_b32_dpp v13, v31, v35 row_newbcast:12 row_mask:0xf bank_mask:0xf
  v_and_b32_dpp v14, v31, v36 row_newbcast:12 row_mask:0xf bank_mask:0xf
  v_and_b32_dpp v15, v31, v0 row_newbcast:12 row_mask:0xf bank_mask:0xf
  s_nop 1
  v_mfma_f32_16x16x32_bf16 v[8:11], v[12:15], v[152:155], v[8:11]
  s_call_b64 s[62:63], L_vq
  s_cbranch_scc0 L_dr34
  v_add_u32_dpp v3, v32, v38 row_newbcast:2 row_mask:0xf bank_mask:0xf
  buffer_load_dwordx4 v[48:51], v3, s[48:51], 0 offen nt
  v_and_b32_dpp v12, v31, v34 row_newbcast:13 row_mask:0xf bank_mask:0xf
  v_and_b32_dpp v13, v31, v35 row_newbcast:13 row_mask:0xf bank_mask:0xf
  v_and_b32_dpp v14, v31, v36 row_newbcast:13 row_mask:0xf bank_mask:0xf
  v_and_b32_dpp v15, v31, v0 row_newbcast:13 row_mask:0xf bank_mask:0xf
  s_nop 1
  v_mfma_f32_16x16x32_bf16 v[8:11], v[12:15], v[156:159], v[8:11]
  s_call_b64 s[62:63], L_vq
  s_cbranch_scc0 L_dr35
  v_add_u32_dpp v3, v32, v38 row_newbcast:3 row_mask:0xf bank_mask:0xf
  buffer_load_dwordx4 v[52:55], v3, s[48:51], 0 offen nt
  v_and_b32_dpp v12, v31, v34 row_newbcast:14 row_mask:0xf bank_mask:0xf
  v_and_b32_dpp v13, v31, v35 row_newbcast:14 row_mask:0xf bank_mask:0xf
  v_and_b32_dpp v14, v31, v36 row_newbcast:14 row_mask:0xf bank_mask:0xf
  v_and_b32_dpp v15, v31, v0 row_newbcast:14 row_mask:0xf bank_mask:0xf
  s_nop 1
  v_mfma_f32_16x16x32_bf16 v[8:11], v[12:15], v[160:163], v[8:11]
  s_call_b64 s[62:63], L_vq
  s_cbranch_scc0 L_dr36
  v_add_u32_dpp v3, v32, v38 row_newbcast:4 row_mask:0xf bank_mask:0xf
  buffer_load_dwordx4 v[56:59], v3, s[48:51], 0 offen nt
  v_and_b32_dpp v12, v31, v34 row_newbcast:15 row_mask:0xf bank_mask:0xf
  v_and_b32_dpp v13, v31, v35 row_newbcast:15 row_mask:0xf bank_mask:0xf
  v_and_b32_dpp v14, v31, v36 row_newbcast:15 row_mask:0xf bank_mask:0xf
  v_and_b32_dpp v15, v31, v0 row_newbcast:15 row_mask:0xf bank_mask:0xf
  s_nop 1
  v_mfma_f32_16x16x32_bf16 v[8:11], v[12:15], v[164:167], v[8:11]
  s_call_b64 s[62:63], L_vq
  s_cbranch_scc0 L_dr37
  v_add_u32_dpp v3, v32, v38 row_newbcast:5 row_mask:0xf bank_mask:0xf
  buffer_load_dwordx4 v[60:63], v3, s[48:51], 0 offen nt
  v_and_b32_dpp v12, v33, v34 row_newbcast:0 row_mask:0xf bank_mask:0xf
  v_and_b32_dpp v13, v33, v35 row_newbcast:0 row_mask:0xf bank_mask:0xf
  v_and_b32_dpp v14, v33, v36 row_newbcast:0 row_mask:0xf bank_mask:0xf
  v_and_b32_dpp v15, v33, v0 row_newbcast:0 row_mask:0xf bank_mask:0xf
  s_nop 1
  v_mfma_f32_16x16x32_bf16 v[8:11], v[12:15], v[40:43], v[8:11]
  s_call_b64 s[62:63], L_vq
  s_branch L_dr38
L_dr5:
  v_and_b32_dpp v12, v29, v34 row_newbcast:0 row_mask:0xf bank_mask:0xf
  v_and_b32_dpp v13, v29, v35 row_newbcast:0 row_mask:0xf bank_mask:0xf
  v_and_b32_dpp v14, v29, v36 row_newbcast:0 row_mask:0xf bank_mask:0xf
  v_and_b32_dpp v15, v29, v0 row_newbcast:0 row_mask:0xf bank_mask:0xf
  s_nop 1
  v_mfma_f32_16x16x32_bf16 v[8:11], v[12:15], v[40:43], v[8:11]
  s_cmp_eq_u32 s75, 6
  s_cbranch_scc1 L_epi
L_dr6:
  v_and_b32_dpp v12, v29, v34 row_newbcast:1 row_mask:0xf bank_mask:0xf
  v_and_b32_dpp v13, v29, v35 row_newbcast:1 row_mask:0xf bank_mask:0xf
  v_and_b32_dpp v14, v29, v36 row_newbcast:1 row_mask:0xf bank_mask:0xf
  v_and_b32_dpp v15, v29, v0 row_newbcast:1 row_mask:0xf bank_mask:0xf
  s_nop 1
  v_mfma_f32_16x16x32_bf16 v[8:11], v[12:15], v[44:47], v[8:11]
  s_cmp_eq_u32 s75, 7
  s_cbranch_scc1 L_epi
L_dr7:
  v_and_b32_dpp v12, v29, v34 row_newbcast:2 row_mask:0xf bank_mask:0xf
  v_and_b32_dpp v13, v29, v35 row_newbcast:2 row_mask:0xf bank_mask:0xf
  v_and_b32_dpp v14, v29, v36 row_newbcast:2 row_mask:0xf bank_mask:0xf
  v_and_b32_dpp v15, v29, v0 row_newbcast:2 row_mask:0xf bank_mask:0xf
  s_nop 1
  v_mfma_f32_16x16x32_bf16 v[8:11], v[12:15], v[48:51], v[8:11]
  s_cmp_eq_u32 s75, 8
  s_cbranch_scc1 L_epi
L_dr8:
  v_and_b32_dpp v12, v29, v34 row_newbcast:3 row_mask:0xf bank_mask:0xf
  v_and_b32_dpp v13, v29, v35 row_newbcast:3 row_mask:0xf bank_mask:0xf
  v_and_b32_dpp v14, v29, v36 row_newbcast:3 row_mask:0xf bank_mask:0xf
  v_and_b32_dpp v15, v29, v0 row_newbcast:3 row_mask:0xf bank_mask:0xf
  s_nop 1
  v_mfma_f32_16x16x32_bf16 v[8:11], v[12:15], v[52:55], v[8:11]
  s_cmp_eq_u32 s75, 9
  s_cbranch_scc1 L_epi
L_dr9:
  v_and_b32_dpp v12, v29, v34 row_newbcast:4 row_mask:0xf bank_mask:0xf
  v_and_b32_dpp v13, v29, v35 row_newbcast:4 row_mask:0xf bank_mask:0xf
  v_and_b32_dpp v14, v29, v36 row_newbcast:4 row_mask:0xf bank_mask:0xf
  v_and_b32_dpp v15, v29, v0 row_newbcast:4 row_mask:0xf bank_mask:0xf
  s_nop 1
  v_mfma_f32_16x16x32_bf16 v[8:11], v[12:15], v[56:59], v[8:11]
  s_cmp_eq_u32 s75, 10
  s_cbranch_scc1 L_epi
L_dr10:
  v_and_b32_dpp v12, v29, v34 row_newbcast:5 row_mask:0xf bank_mask:0xf
  v_and_b32_dpp v13, v29, v35 row_newbcast:5 row_mask:0xf bank_mask:0xf
  v_and_b32_dpp v14, v29, v36 row_newbcast:5 row_mask:0xf bank_mask:0xf
  v_and_b32_dpp v15, v29, v0 row_newbcast:5 row_mask:0xf bank_mask:0xf
  s_nop 1
  v_mfma_f32_16x16x32_bf16 v[8:11], v[12:15], v[60:63], v[8:11]
  s_cmp_eq_u32 s75, 11
  s_cbranch_scc1 L_epi
L_dr11:
  v_and_b32_dpp v12, v29, v34 row_newbcast:6 row_mask:0xf bank_mask:0xf
  v_and_b32_dpp v13, v29, v35 row_newbcast:6 row_mask:0xf bank_mask:0xf
  v_and_b32_dpp v14, v29, v36 row_newbcast:6 row_mask:0xf bank_mask:0xf
  v_and_b32_dpp v15, v29, v0 row_newbcast:6 row_mask:0xf bank_mask:0xf
  s_nop 1
  v_mfma_f32_16x16x32_bf16 v[8:11], v[12:15], v[64:67], v[8:11]
  s_cmp_eq_u32 s75, 12
  s_cbranch_scc1 L_epi
L_dr12:
  v_and_b32_dpp v12, v29, v34 row_newbcast:7 row_mask:0xf bank_mask:0xf
  v_and_b32_dpp v13, v29, v35 row_newbcast:7 row_mask:0xf bank_mask:0xf
  v_and_b32_dpp v14, v29, v36 row_newbcast:7 row_mask:0xf bank_mask:0xf
  v_and_b32_dpp v15, v29, v0 row_newbcast:7 row_mask:0xf bank_mask:0xf
  s_nop 1
  v_mfma_f32_16x16x32_bf16 v[8:11], v[12:15], v[68:71], v[8:11]
  s_cmp_eq_u32 s75, 13
  s_cbranch_scc1 L_epi
L_dr13:
  v_and_b32_dpp v12, v29, v34 row_newbcast:8 row_mask:0xf bank_mask:0xf
  v_and_b32_dpp v13, v29, v35 row_newbcast:8 row_mask:0xf bank_mask:0xf
  v_and_b32_dpp v14, v29, v36 row_newbcast:8 row_mask:0xf bank_mask:0xf
  v_and_b32_dpp v15, v29, v0 row_newbcast:8 row_mask:0xf bank_mask:0xf
  s_nop 1
  v_mfma_f32_16x16x32_bf16 v[8:11], v[12:15], v[72:75], v[8:11]
  s_cmp_eq_u32 s75, 14
  s_cbranch_scc1 L_epi
L_dr14:
  v_and_b32_dpp v12, v29, v34 row_newbcast:9 row_mask:0xf bank_mask:0xf
  v_and_b32_dpp v13, v29, v35 row_newbcast:9 row_mask:0xf bank_mask:0xf
  v_and_b32_dpp v14, v29, v36 row_newbcast:9 row_mask:0xf bank_mask:0xf
  v_and_b32_dpp v15, v29, v0 row_newbcast:9 row_mask:0xf bank_mask:0xf
  s_nop 1
  v_mfma_f32_16x16x32_bf16 v[8:11], v[12:15], v[76:79], v[8:11]
  s_cmp_eq_u32 s75, 15
  s_cbranch_scc1 L_epi
L_dr15:
  v_and_b32_dpp v12, v29, v34 row_newbcast:10 row_mask:0xf bank_mask:0xf
  v_and_b32_dpp v13, v29, v35 row_newbcast:10 row_mask:0xf bank_mask:0xf
  v_and_b32_dpp v14, v29, v36 row_newbcast:10 row_mask:0xf bank_mask:0xf
  v_and_b32_dpp v15, v29, v0 row_newbcast:10 row_mask:0xf bank_mask:0xf
  s_nop 1
  v_mfma_f32_16x16x32_bf16 v[8:11], v[12:15], v[80:83], v[8:11]
  s_cmp_eq_u32 s75, 16
  s_cbranch_scc1 L_epi
L_dr16:
  v_and_b32_dpp v12, v29, v34 row_newbcast:11 row_mask:0xf bank_mask:0xf
  v_and_b32_dpp v13, v29, v35 row_newbcast:11 row_mask:0xf bank_mask:0xf
  v_and_b32_dpp v14, v29, v36 row_newbcast:11 row_mask:0xf bank_mask:0xf
  v_and_b32_dpp v15, v29, v0 row_newbcast:11 row_mask:0xf bank_mask:0xf
  s_nop 1
  v_mfma_f32_16x16x32_bf16 v[8:11], v[12:15], v[84:87], v[8:11]
  s_cmp_eq_u32 s75, 17
  s_cbranch_scc1 L_epi
L_dr17:
  v_and_b32_dpp v12, v29, v34 row_newbcast:12 row_mask:0xf bank_mask:0xf
  v_and_b32_dpp v13, v29, v35 row_newbcast:12 row_mask:0xf bank_mask:0xf
  v_and_b32_dpp v14, v29, v36 row_newbcast:12 row_mask:0xf bank_mask:0xf
  v_and_b32_dpp v15, v29, v0 row_newbcast:12 row_mask:0xf bank_mask:0xf
  s_nop 1
  v_mfma_f32_16x16x32_bf16 v[8:11], v[12:15], v[88:91], v[8:11]
  s_cmp_eq_u32 s75, 18
  s_cbranch_scc1 L_epi
L_dr18:
  v_and_b32_dpp v12, v29, v34 row_newbcast:13 row_mask:0xf bank_mask:0xf
  v_and_b32_dpp v13, v29, v35 row_newbcast:13 row_mask:0xf bank_mask:0xf
  v_and_b32_dpp v14, v29, v36 row_newbcast:13 row_mask:0xf bank_mask:0xf
  v_and_b32_dpp v15, v29, v0 row_newbcast:13 row_mask:0xf bank_mask:0xf
  s_nop 1
  v_mfma_f32_16x16x32_bf16 v[8:11], v[12:15], v[92:95], v[8:11]
  s_cmp_eq_u32 s75, 19
  s_cbranch_scc1 L_epi
L_dr19:
  v_and_b32_dpp v12, v29, v34 row_newbcast:14 row_mask:0xf bank_mask:0xf
  v_and_b32_dpp v13, v29, v35 row_newbcast:14 row_mask:0xf bank_mask:0xf
  v_and_b32_dpp v14, v29, v36 row_newbcast:14 row_mask:0xf bank_mask:0xf
  v_and_b32_dpp v15, v29, v0 row_newbcast:14 row_mask:0xf bank_mask:0xf
  s_nop 1
  v_mfma_f32_16x16x32_bf16 v[8:11], v[12:15], v[96:99], v[8:11]
  s_cmp_eq_u32 s75, 20
  s_cbranch_scc1 L_epi
L_dr20:
  v_and_b32_dpp v12, v29, v34 row_newbcast:15 row_mask:0xf bank_mask:0xf
  v_and_b32_dpp v13, v29, v35 row_newbcast:15 row_mask:0xf bank_mask:0xf
  v_and_b32_dpp v14, v29, v36 row_newbcast:15 row_mask:0xf bank_mask:0xf
  v_and_b32_dpp v15, v29, v0 row_newbcast:15 row_mask:0xf bank_mask:0xf
  s_nop 1
  v_mfma_f32_16x16x32_bf16 v[8:11], v[12:15], v[100:103], v[8:11]
  s_cmp_eq_u32 s75, 21
  s_cbranch_scc1 L_epi
L_dr21:
  v_and_b32_dpp v12, v31, v34 row_newbcast:0 row_mask:0xf bank_mask:0xf
  v_and_b32_dpp v13, v31, v35 row_newbcast:0 row_mask:0xf bank_mask:0xf
  v_and_b32_dpp v14, v31, v36 row_newbcast:0 row_mask:0xf bank_mask:0xf
  v_and_b32_dpp v15, v31, v0 row_newbcast:0 row_mask:0xf bank_mask:0xf
  s_nop 1
  v_mfma_f32_16x16x32_bf16 v[8:11], v[12:15], v[104:107], v[8:11]
  s_cmp_eq_u32 s75, 22
  s_cbranch_scc1 L_epi
L_dr22:
  v_and_b32_dpp v12, v31, v34 row_newbcast:1 row_mask:0xf bank_mask:0xf
  v_and_b32_dpp v13, v31, v35 row_newbcast:1 row_mask:0xf bank_mask:0xf
  v_and_b32_dpp v14, v31, v36 row_newbcast:1 row_mask:0xf bank_mask:0xf
  v_and_b32_dpp v15, v31, v0 row_newbcast:1 row_mask:0xf bank_mask:0xf
  s_nop 1
  v_mfma_f32_16x16x32_bf16 v[8:11], v[12:15], v[108:111], v[8:11]
  s_cmp_eq_u32 s75, 23
  s_cbranch_scc1 L_epi
L_dr23:
  v_and_b32_dpp v12, v31, v34 row_newbcast:2 row_mask:0xf bank_mask:0xf
  v_and_b32_dpp v13, v31, v35 row_newbcast:2 row_mask:0xf bank_mask:0xf
  v_and_b32_dpp v14, v31, v36 row_newbcast:2 row_mask:0xf bank_mask:0xf
  v_and_b32_dpp v15, v31, v0 row_newbcast:2 row_mask:0xf bank_mask:0xf
  s_nop 1
  v_mfma_f32_16x16x32_bf16 v[8:11], v[12:15], v[112:115], v[8:11]
  s_cmp_eq_u32 s75, 24
  s_cbranch_scc1 L_epi
L_dr24:
  v_and_b32_dpp v12, v31, v34 row_newbcast:3 row_mask:0xf bank_mask:0xf
  v_and_b32_dpp v13, v31, v35 row_newbcast:3 row_mask:0xf bank_mask:0xf
  v_and_b32_dpp v14, v31, v36 row_newbcast:3 row_mask:0xf bank_mask:0xf
  v_and_b32_dpp v15, v31, v0 row_newbcast:3 row_mask:0xf bank_mask:0xf
  s_nop 1
  v_mfma_f32_16x16x32_bf16 v[8:11], v[12:15], v[116:119], v[8:11]
  s_cmp_eq_u32 s75, 25
  s_cbranch_scc1 L_epi
L_dr25:
  v_and_b32_dpp v12, v31, v34 row_newbcast:4 row_mask:0xf bank_mask:0xf
  v_and_b32_dpp v13, v31, v35 row_newbcast:4 row_mask:0xf bank_mask:0xf
  v_and_b32_dpp v14, v31, v36 row_newbcast:4 row_mask:0xf bank_mask:0xf
  v_and_b32_dpp v15, v31, v0 row_newbcast:4 row_mask:0xf bank_mask:0xf
  s_nop 1
  v_mfma_f32_16x16x32_bf16 v[8:11], v[12:15], v[120:123], v[8:11]
  s_cmp_eq_u32 s75, 26
  s_cbranch_scc1 L_epi
L_dr26:
  v_and_b32_dpp v12, v31, v34 row_newbcast:5 row_mask:0xf bank_mask:0xf
  v_and_b32_dpp v13, v31, v35 row_newbcast:5 row_mask:0xf bank_mask:0xf
  v_and_b32_dpp v14, v31, v36 row_newbcast:5 row_mask:0xf bank_mask:0xf
  v_and_b32_dpp v15, v31, v0 row_newbcast:5 row_mask:0xf bank_mask:0xf
  s_nop 1
  v_mfma_f32_16x16x32_bf16 v[8:11], v[12:15], v[124:127], v[8:11]
  s_cmp_eq_u32 s75, 27
  s_cbranch_scc1 L_epi
L_dr27:
  v_and_b32_dpp v12, v31, v34 row_newbcast:6 row_mask:0xf bank_mask:0xf
  v_and_b32_dpp v13, v31, v35 row_newbcast:6 row_mask:0xf bank_mask:0xf
  v_and_b32_dpp v14, v31, v36 row_newbcast:6 row_mask:0xf bank_mask:0xf
  v_and_b32_dpp v15, v31, v0 row_newbcast:6 row_mask:0xf bank_mask:0xf
  s_nop 1
  v_mfma_f32_16x16x32_bf16 v[8:11], v[12:15], v[128:131], v[8:11]
  s_cmp_eq_u32 s75, 28
  s_cbranch_scc1 L_epi
L_dr28:
  v_and_b32_dpp v12, v31, v34 row_newbcast:7 row_mask:0xf bank_mask:0xf
  v_and_b32_dpp v13, v31, v35 row_newbcast:7 row_mask:0xf bank_mask:0xf
  v_and_b32_dpp v14, v31, v36 row_newbcast:7 row_mask:0xf bank_mask:0xf
  v_and_b32_dpp v15, v31, v0 row_newbcast:7 row_mask:0xf bank_mask:0xf
  s_nop 1
  v_mfma_f32_16x16x32_bf16 v[8:11], v[12:15], v[132:135], v[8:11]
  s_cmp_eq_u32 s75, 29
  s_cbranch_scc1 L_epi
L_dr29:
  v_and_b32_dpp v12, v31, v34 row_newbcast:8 row_mask:0xf bank_mask:0xf
  v_and_b32_dpp v13, v31, v35 row_newbcast:8 row_mask:0xf bank_mask:0xf
  v_and_b32_dpp v14, v31, v36 row_newbcast:8 row_mask:0xf bank_mask:0xf
  v_and_b32_dpp v15, v31, v0 row_newbcast:8 row_mask:0xf bank_mask:0xf
  s_nop 1
  v_mfma_f32_16x16x32_bf16 v[8:11], v[12:15], v[136:139], v[8:11]
  s_cmp_eq_u32 s75, 30
  s_cbranch_scc1 L_epi
L_dr30:
  v_and_b32_dpp v12, v31, v34 row_newbcast:9 row_mask:0xf bank_mask:0xf
  v_and_b32_dpp v13, v31, v35 row_newbcast:9 row_mask:0xf bank_mask:0xf
  v_and_b32_dpp v14, v31, v36 row_newbcast:9 row_mask:0xf bank_mask:0xf
  v_and_b32_dpp v15, v31, v0 row_newbcast:9 row_mask:0xf bank_mask:0xf
  s_nop 1
  v_mfma_f32_16x16x32_bf16 v[8:11], v[12:15], v[140:143], v[8:11]
  s_cmp_eq_u32 s75, 31
  s_cbranch_scc1 L_epi
L_dr31:
  v_and_b32_dpp v12, v31, v34 row_newbcast:10 row_mask:0xf bank_mask:0xf
  v_and_b32_dpp v13, v31, v35 row_newbcast:10 row_mask:0xf bank_mask:0xf
  v_and_b32_dpp v14, v31, v36 row_newbcast:10 row_mask:0xf bank_mask:0xf
  v_and_b32_dpp v15, v31, v0 row_newbcast:10 row_mask:0xf bank_mask:0xf
  s_nop 1
  v_mfma_f32_16x16x32_bf16 v[8:11], v[12:15], v[144:147], v[8:11]
  s_cmp_eq_u32 s75, 32
  s_cbranch_scc1 L_epi
L_dr32:
  v_and_b32_dpp v12, v31, v34 row_newbcast:11 row_mask:0xf bank_mask:0xf
  v_and_b32_dpp v13, v31, v35 row_newbcast:11 row_mask:0xf bank_mask:0xf
  v_and_b32_dpp v14, v31, v36 row_newbcast:11 row_mask:0xf bank_mask:0xf
  v_and_b32_dpp v15, v31, v0 row_newbcast:11 row_mask:0xf bank_mask:0xf
  s_nop 1
  v_mfma_f32_16x16x32_bf16 v[8:11], v[12:15], v[148:151], v[8:11]
  s_cmp_eq_u32 s75, 33
  s_cbranch_scc1 L_epi
L_dr33:
  v_and_b32_dpp v12, v31, v34 row_newbcast:12 row_mask:0xf bank_mask:0xf
  v_and_b32_dpp v13, v31, v35 row_newbcast:12 row_mask:0xf bank_mask:0xf
  v_and_b32_dpp v14, v31, v36 row_newbcast:12 row_mask:0xf bank_mask:0xf
  v_and_b32_dpp v15, v31, v0 row_newbcast:12 row_mask:0xf bank_mask:0xf
  s_nop 1
  v_mfma_f32_16x16x32_bf16 v[8:11], v[12:15], v[152:155], v[8:11]
  s_cmp_eq_u32 s75, 34
  s_cbranch_scc1 L_epi
L_dr34:
  v_and_b32_dpp v12, v31, v34 row_newbcast:13 row_mask:0xf bank_mask:0xf
  v_and_b32_dpp v13, v31, v35 row_newbcast:13 row_mask:0xf bank_mask:0xf
  v_and_b32_dpp v14, v31, v36 row_newbcast:13 row_mask:0xf bank_mask:0xf
  v_and_b32_dpp v15, v31, v0 row_newbcast:13 row_mask:0xf bank_mask:0xf
  s_nop 1
  v_mfma_f32_16x16x32_bf16 v[8:11], v[12:15], v[156:159], v[8:11]
  s_cmp_eq_u32 s75, 35
  s_cbranch_scc1 L_epi
L_dr35:
  v_and_b32_dpp v12, v31, v34 row_newbcast:14 row_mask:0xf bank_mask:0xf
  v_and_b32_dpp v13, v31, v35 row_newbcast:14 row_mask:0xf bank_mask:0xf
  v_and_b32_dpp v14, v31, v36 row_newbcast:14 row_mask:0xf bank_mask:0xf
  v_and_b32_dpp v15, v31, v0 row_newbcast:14 row_mask:0xf bank_mask:0xf
  s_nop 1
  v_mfma_f32_16x16x32_bf16 v[8:11], v[12:15], v[160:163], v[8:11]
  s_cmp_eq_u32 s75, 36
  s_cbranch_scc1 L_epi
L_dr36:
  v_and_b32_dpp v12, v31, v34 row_newbcast:15 row_mask:0xf bank_mask:0xf
  v_and_b32_dpp v13, v31, v35 row_newbcast:15 row_mask:0xf bank_mask:0xf
  v_and_b32_dpp v14, v31, v36 row_newbcast:15 row_mask:0xf bank_mask:0xf
  v_and_b32_dpp v15, v31, v0 row_newbcast:15 row_mask:0xf bank_mask:0xf
  s_nop 1
  v_mfma_f32_16x16x32_bf16 v[8:11], v[12:15], v[164:167], v[8:11]
  s_cmp_eq_u32 s75, 37
  s_cbranch_scc1 L_epi
L_dr37:
  v_and_b32_dpp v12, v33, v34 row_newbcast:0 row_mask:0xf bank_mask:0xf
  v_and_b32_dpp v13, v33, v35 row_newbcast:0 row_mask:0xf bank_mask:0xf
  v_and_b32_dpp v14, v33, v36 row_newbcast:0 row_mask:0xf bank_mask:0xf
  v_and_b32_dpp v15, v33, v0 row_newbcast:0 row_mask:0xf bank_mask:0xf
  s_nop 1
  v_mfma_f32_16x16x32_bf16 v[8:11], v[12:15], v[40:43], v[8:11]
  s_cmp_eq_u32 s75, 38
  s_cbranch_scc1 L_epi
L_dr38:
  v_and_b32_dpp v12, v33, v34 row_newbcast:1 row_mask:0xf bank_mask:0xf
  v_and_b32_dpp v13, v33, v35 row_newbcast:1 row_mask:0xf bank_mask:0xf
  v_and_b32_dpp v14, v33, v36 row_newbcast:1 row_mask:0xf bank_mask:0xf
  v_and_b32_dpp v15, v33, v0 row_newbcast:1 row_mask:0xf bank_mask:0xf
  s_nop 1
  v_mfma_f32_16x16x32_bf16 v[8:11], v[12:15], v[44:47], v[8:11]
  s_cmp_eq_u32 s75, 39
  s_cbranch_scc1 L_epi
L_dr39:
  v_and_b32_dpp v12, v33, v34 row_newbcast:2 row_mask:0xf bank_mask:0xf
  v_and_b32_dpp v13, v33, v35 row_newbcast:2 row_mask:0xf bank_mask:0xf
  v_and_b32_dpp v14, v33, v36 row_newbcast:2 row_mask:0xf bank_mask:0xf
  v_and_b32_dpp v15, v33, v0 row_newbcast:2 row_mask:0xf bank_mask:0xf
  s_nop 1
  v_mfma_f32_16x16x32_bf16 v[8:11], v[12:15], v[48:51], v[8:11]
  s_cmp_eq_u32 s75, 40
  s_cbranch_scc1 L_epi
L_dr40:
  v_and_b32_dpp v12, v33, v34 row_newbcast:3 row_mask:0xf bank_mask:0xf
  v_and_b32_dpp v13, v33, v35 row_newbcast:3 row_mask:0xf bank_mask:0xf
  v_and_b32_dpp v14, v33, v36 row_newbcast:3 row_mask:0xf bank_mask:0xf
  v_and_b32_dpp v15, v33, v0 row_newbcast:3 row_mask:0xf bank_mask:0xf
  s_nop 1
  v_mfma_f32_16x16x32_bf16 v[8:11], v[12:15], v[52:55], v[8:11]
  s_cmp_eq_u32 s75, 41
  s_cbranch_scc1 L_epi
L_dr41:
  v_and_b32_dpp v12, v33, v34 row_newbcast:4 row_mask:0xf bank_mask:0xf
  v_and_b32_dpp v13, v33, v35 row_newbcast:4 row_mask:0xf bank_mask:0xf
  v_and_b32_dpp v14, v33, v36 row_newbcast:4 row_mask:0xf bank_mask:0xf
  v_and_b32_dpp v15, v33, v0 row_newbcast:4 row_mask:0xf bank_mask:0xf
  s_nop 1
  v_mfma_f32_16x16x32_bf16 v[8:11], v[12:15], v[56:59], v[8:11]
  s_cmp_eq_u32 s75, 42
  s_cbranch_scc1 L_epi
L_dr42:
  v_and_b32_dpp v12, v33, v34 row_newbcast:5 row_mask:0xf bank_mask:0xf
  v_and_b32_dpp v13, v33, v35 row_newbcast:5 row_mask:0xf bank_mask:0xf
  v_and_b32_dpp v14, v33, v36 row_newbcast:5 row_mask:0xf bank_mask:0xf
  v_and_b32_dpp v15, v33, v0 row_newbcast:5 row_mask:0xf bank_mask:0xf
  s_nop 1
  v_mfma_f32_16x16x32_bf16 v[8:11], v[12:15], v[60:63], v[8:11]
  s_cmp_eq_u32 s75, 43
  s_cbranch_scc1 L_epi
L_epi:
  v_lshrrev_b32 v3, 4, v1
  v_lshl_add_u32 v21, v3, 3, v39
  v_add_u32 v21, s11, v21
  v_mov_b32 v3, 1
  s_nop 3
  v_pk_add_f32 v[8:9], v[8:9], v[4:5]
  v_pk_add_f32 v[10:11], v[10:11], v[6:7]
  s_mov_b32 exec_hi, 0
  ds_write_b128 v21, v[8:11] offset:1024
  s_cmp_eq_u32 s21, 0
  s_cbranch_scc1 L_ep2
  s_mov_b32 exec_hi, 0
  ds_write_b128 v21, v[8:11] offset:6656
  s_mov_b64 exec, 1
  ds_add_u32 v1, v3 offset:304
  s_mov_b64 exec, -1
L_ep2:
  s_mov_b64 exec, 1
  ds_add_u32 v1, v3 offset:308
L_send:
  s_endpgm
L_ks:
  s_cmp_lt_u32 s32, s57
  s_cbranch_scc1 L_kq
  s_call_b64 s[100:101], L_work
L_kq:
  v_readfirstlane_b32 s78, v22
  v_readfirstlane_b32 s79, v23
L_ks2:
  s_mov_b64 exec, 1
  ds_dec_u32 v2, v39 offset:288
  ds_read_b64 v[22:23], v2 offset:288
  s_mov_b64 exec, -1
  s_mul_i32 s68, s35, 11
  s_and_b32 s69, s79, 0xffff
  s_sub_i32 s68, s68, s78
  s_mul_i32 s69, s69, s77
  s_mul_i32 s68, s68, 160
  s_sub_u32 s35, s35, 1
  s_add_i32 s68, s68, s69
  s_add_i32 s68, s68, s34
  s_max_i32 s68, s68, 4915
  s_min_i32 s68, s68, s76
  s_lshr_b32 s37, s68, 12
  s_lshl_b32 s58, s68, 20
L_kl:
  s_add_u32 s32, s32, 1
  s_add_u32 s33, s33, 0x20000000
  s_add_u32 s68, s33, s58
  s_addc_u32 s41, s37, 0
  s_cmp_eq_u32 s41, 3
  s_cbranch_scc1 L_wt3
  s_cmp_eq_u32 s41, 2
  s_cbranch_scc1 L_wt2
  s_cmp_eq_u32 s41, 4
  s_cbranch_scc1 L_wt4
  s_cmp_eq_u32 s41, 1
  s_cbranch_scc1 L_wt1
L_wtx:
  s_cmp_eq_u32 s32, s32
L_wt5:
  s_waitcnt vmcnt(4)
  s_setpc_b64 s[62:63]
L_wt3:
  s_waitcnt vmcnt(2)
  s_setpc_b64 s[62:63]
L_wt2:
  s_waitcnt vmcnt(1)
  s_setpc_b64 s[62:63]
L_wt4:
  s_waitcnt vmcnt(3)
  s_setpc_b64 s[62:63]
L_wt1:
  s_waitcnt vmcnt(0)
  s_setpc_b64 s[62:63]
L_kq2:
  v_readfirstlane_b32 s78, v22
  v_readfirstlane_b32 s79, v23
L_ks3:
  s_mov_b64 exec, 1
  ds_dec_u32 v2, v39 offset:288
  ds_dec_u32 v2, v39 offset:288
  ds_read_b64 v[22:23], v2 offset:288
  s_mov_b64 exec, -1
  s_mul_i32 s68, s35, 11
  s_and_b32 s69, s79, 0xffff
  s_sub_i32 s68, s68, s78
  s_mul_i32 s69, s69, s77
  s_mul_i32 s68, s68, 160
  s_sub_u32 s35, s35, 2
  s_add_i32 s68, s68, s69
  s_add_i32 s68, s68, s34
  s_max_i32 s68, s68, 4915
  s_min_i32 s68, s68, s76
  s_lshr_b32 s37, s68, 12
  s_lshl_b32 s58, s68, 20
  s_branch L_kl
L_vl:
  s_cmp_lt_u32 s32, s36
  s_cbranch_scc1 L_kl
  s_branch L_ev
L_vq2:
  v_readfirstlane_b32 s78, v22
  v_readfirstlane_b32 s79, v23
  s_cmp_lt_u32 s32, s36
  s_cbranch_scc1 L_ks3
  s_branch L_ev
L_vs:
  v_readfirstlane_b32 s78, v22
  v_readfirstlane_b32 s79, v23
  s_cmp_eq_u32 s61, 2
  s_cbranch_scc1 L_vs1
  s_cmp_eq_u32 s61, 1
  s_cbranch_scc1 L_x3
  s_cmp_gt_u32 s41, s32
  s_cbranch_scc1 L_ks2
L_x1:
  s_mov_b64 vcc, s[52:53]
  v_mfma_f32_16x16x32_bf16 v[8:11], v[4:7], v[152:155], 0
  v_mfma_f32_16x16x32_bf16 v[152:155], v[4:7], v[156:159], 0
  v_mfma_f32_16x16x32_bf16 v[156:159], v[4:7], v[160:163], 0
  v_mfma_f32_16x16x32_bf16 v[160:163], v[4:7], v[164:167], 0
  s_nop 4
  v_cndmask_b32 v8, v8, v9, s[54:55]
  v_cndmask_b32 v10, v10, v11, s[54:55]
  v_cndmask_b32 v152, v152, v153, s[54:55]
  v_cndmask_b32 v154, v154, v155, s[54:55]
  v_cndmask_b32 v156, v156, v157, s[54:55]
  v_cndmask_b32 v158, v158, v159, s[54:55]
  v_cndmask_b32 v160, v160, v161, s[54:55]
  v_cndmask_b32 v162, v162, v163, s[54:55]
  v_cndmask_b32_dpp v16, v8, v10, vcc quad_perm:[0,1,2,3] row_mask:0x8 bank_mask:0xf
  v_cndmask_b32_dpp v18, v152, v154, vcc quad_perm:[0,1,2,3] row_mask:0x8 bank_mask:0xf
  v_cndmask_b32_dpp v17, v156, v158, vcc quad_perm:[0,1,2,3] row_mask:0x8 bank_mask:0xf
  v_cndmask_b32_dpp v19, v160, v162, vcc quad_perm:[0,1,2,3] row_mask:0x8 bank_mask:0xf
  s_lshl_b32 s68, s20, 3
  s_add_u32 s68, s68, s56
  v_add_f32_dpp v16, v16, v16 quad_perm:[2,3,0,1] row_mask:0xf bank_mask:0xf
  v_add_f32_dpp v17, v17, v17 quad_perm:[2,3,0,1] row_mask:0xf bank_mask:0xf
  v_add_f32_dpp v18, v18, v18 quad_perm:[2,3,0,1] row_mask:0xf bank_mask:0xf
  v_add_f32_dpp v19, v19, v19 quad_perm:[2,3,0,1] row_mask:0xf bank_mask:0xf
  v_cndmask_b32 v8, v16, v17, s[52:53]
  v_cndmask_b32 v9, v18, v19, s[52:53]
  v_mov_b32 v20, 64
  v_lshlrev_b32 v21, 3, s9
  v_add_f32_dpp v8, v8, v8 quad_perm:[1,0,3,2] row_mask:0xf bank_mask:0xf
  v_add_f32_dpp v9, v9, v9 quad_perm:[1,0,3,2] row_mask:0xf bank_mask:0xf
  v_cndmask_b32 v27, v8, v9, s[54:55]
  v_cvt_pk_bf16_f32 v27, 0, v27
  v_mul_f32 v27, 0x3db504f3, v27
  v_cvt_pk_bf16_f32 v27, 0, v27
  v_max_f32 v37, v37, v27
  v_cmp_ngt_f32 vcc, s22, v27
  v_mov_b32 v4, 0
  v_max_f32_dpp v37, v37, v37 row_ror:8 row_mask:0xf bank_mask:0xf
  s_bcnt1_i32_b64 s69, vcc
  s_add_u32 s69, s69, s20
  v_max_f32_dpp v37, v37, v37 row_ror:4 row_mask:0xf bank_mask:0xf
  s_cmp_gt_u32 s69, 32
  s_cselect_b32 s21, 1, s21
  v_max_f32_dpp v37, v37, v37 row_ror:2 row_mask:0xf bank_mask:0xf
  s_cmp_eq_u32 s21, 0
  s_cselect_b64 s[66:67], vcc, 0
  s_cselect_b32 s20, s69, s20
  v_max_f32_dpp v37, v37, v37 row_ror:1 row_mask:0xf bank_mask:0xf
  v_mbcnt_lo_u32_b32 v3, s66, 0
  v_mov_b32 v8, v37
  v_mbcnt_hi_u32_b32 v3, s67, v3
  v_lshl_add_u32 v3, v3, 3, s68
  v_permlane16_swap_b32 v8, v37
  s_mov_b64 exec, s[66:67]
  ds_write_b64 v3, v[26:27] offset:1280
  s_mov_b64 exec, -1
  ds_read_b32 v32, v39 offset:1024
  v_max_f32 v37, v37, v8
  v_mov_b32 v8, v37
  v_mov_b32 v5, 0
  s_mov_b32 s18, s32
  v_permlane32_swap_b32 v8, v37
  v_max_f32 v37, v37, v8
  v_sub_f32 v17, v25, v37
  v_sub_f32 v18, v27, v37
  v_mul_f32 v17, 0x3fb8aa3b, v17
  v_mul_f32 v18, 0x3fb8aa3b, v18
  v_exp_f32 v17, v17
  v_exp_f32 v18, v18
  s_lshl_b32 s68, s9, 9
  v_lshl_add_u32 v16, v1, 2, s68
  v_add_f32 v17, v17, v18
  s_waitcnt lgkmcnt(0)
  s_cmp_le_u32 s20, 0
  s_cbranch_scc1 L_x2
  v_add_u32_dpp v3, v32, v38 row_newbcast:8 row_mask:0xf bank_mask:0xf
  buffer_load_dwordx4 v[136:139], v3, s[48:51], 0 offen nt
  s_cmp_le_u32 s20, 4
  s_cbranch_scc1 L_x2
  v_add_u32_dpp v3, v32, v38 row_newbcast:9 row_mask:0xf bank_mask:0xf
  buffer_load_dwordx4 v[140:143], v3, s[48:51], 0 offen nt
  s_cmp_le_u32 s20, 8
  s_cbranch_scc1 L_x2
  v_add_u32_dpp v3, v32, v38 row_newbcast:10 row_mask:0xf bank_mask:0xf
  buffer_load_dwordx4 v[144:147], v3, s[48:51], 0 offen nt
  s_cmp_le_u32 s20, 12
  s_cbranch_scc1 L_x2
  v_add_u32_dpp v3, v32, v38 row_newbcast:11 row_mask:0xf bank_mask:0xf
  buffer_load_dwordx4 v[148:151], v3, s[48:51], 0 offen nt
  s_cmp_le_u32 s20, 16
  s_cbranch_scc1 L_x2
  v_add_u32_dpp v3, v32, v38 row_newbcast:12 row_mask:0xf bank_mask:0xf
  buffer_load_dwordx4 v[152:155], v3, s[48:51], 0 offen nt
  s_cmp_le_u32 s20, 20
  s_cbranch_scc1 L_x2
  v_add_u32_dpp v3, v32, v38 row_newbcast:13 row_mask:0xf bank_mask:0xf
  buffer_load_dwordx4 v[156:159], v3, s[48:51], 0 offen nt
  s_cmp_le_u32 s20, 24
  s_cbranch_scc1 L_x2
  v_add_u32_dpp v3, v32, v38 row_newbcast:14 row_mask:0xf bank_mask:0xf
  buffer_load_dwordx4 v[160:163], v3, s[48:51], 0 offen nt
  s_cmp_le_u32 s20, 28
  s_cbranch_scc1 L_x2
  v_add_u32_dpp v3, v32, v38 row_newbcast:15 row_mask:0xf bank_mask:0xf
  buffer_load_dwordx4 v[164:167], v3, s[48:51], 0 offen nt
L_x2:
  ds_write_b32 v16, v17 offset:1024
  s_mov_b64 exec, 1
  ds_write_b32 v21, v37 offset:512
  ds_add_u32 v1, v20 offset:272
  s_mov_b64 exec, -1
  s_mov_b32 s61, 1
  s_mov_b32 s19, 1
  s_add_i32 s34, s34, 820
  s_cmp_lt_u32 s32, 5
  s_cbranch_scc1 L_ks2
L_x3:
  v_max_f32 v21, s23, v37
  s_add_u32 s38, s38, 3
  s_lshr_b32 s38, s38, 2
  v_add_f32 v21, 0xc2a5e666, v21
  s_max_u32 s38, s38, s32
  s_lshl_b32 s38, s38, 2
  v_cmp_nlt_f32 vcc, v27, v21
  s_lshl_b32 s68, s38, 3
  s_add_u32 s68, s68, s56
  s_andn2_b64 s[70:71], vcc, s[66:67]
  v_mbcnt_lo_u32_b32 v3, s70, 0
  v_mbcnt_hi_u32_b32 v3, s71, v3
  s_bcnt1_i32_b64 s69, s[70:71]
  v_lshl_add_u32 v3, v3, 3, s68
  s_mov_b64 exec, s[70:71]
  ds_write_b64 v3, v[26:27]
  s_mov_b64 exec, -1
  s_or_b64 s[66:67], s[66:67], s[70:71]
  s_add_u32 s38, s38, s69
  ds_read_b64 v[28:29], v39 offset:0
  ds_read_b64 v[30:31], v39 offset:512
  ds_read_b64 v[32:33], v39 offset:1024
  v_mov_b32 v8, 0
  v_mov_b32 v9, 0
  v_mov_b32 v10, 0
  v_mov_b32 v11, 0
  v_mov_b32 v6, 0
  v_mov_b32 v7, 0
  s_lshr_b32 s36, s38, 2
  s_mov_b32 s61, 2
  s_add_u32 s68, s38, 13
  s_lshr_b32 s68, s68, 2
  s_sub_u32 s69, s68, s59
  s_mov_b32 s59, s68
  s_add_u32 s35, s35, s69
  s_add_u32 s78, s78, s69
  v_mov_b32 v3, s69
  s_mov_b64 exec, 1
  ds_add_u32 v1, v3 offset:296
  ds_add_u32 v1, v3 offset:300
  s_mov_b64 exec, -1
  s_waitcnt lgkmcnt(0)
  v_sub_f32 v29, v29, v37
  v_sub_f32 v31, v31, v37
  v_sub_f32 v33, v33, v37
  v_mul_f32 v29, 0x3fb8aa3b, v29
  v_mul_f32 v31, 0x3fb8aa3b, v31
  v_mul_f32 v33, 0x3fb8aa3b, v33
  v_exp_f32 v29, v29
  v_exp_f32 v31, v31
  v_exp_f32 v33, v33
  s_nop 0
  v_cvt_pk_bf16_f32 v29, v29, v29
  v_cvt_pk_bf16_f32 v31, v31, v31
  v_cvt_pk_bf16_f32 v33, v33, v33
  s_cmp_eq_u32 s20, 0
  s_cselect_b32 s41, 0, s41
L_vs1:
  s_cmp_eq_u32 s19, 0
  s_cbranch_scc1 L_vs1b
  s_sub_u32 s68, s32, s18
  s_cmp_le_u32 s41, s68
  s_cbranch_scc1 L_snap
  s_cmp_lt_u32 s32, s36
  s_cbranch_scc1 L_ks2
  s_waitcnt vmcnt(0)
L_snap:
  s_cmp_le_u32 s20, 0
  s_cbranch_scc1 L_snp2
  v_and_b32_dpp v12, v33, v34 row_newbcast:8 row_mask:0xf bank_mask:0xf
  v_and_b32_dpp v13, v33, v35 row_newbcast:8 row_mask:0xf bank_mask:0xf
  v_and_b32_dpp v14, v33, v36 row_newbcast:8 row_mask:0xf bank_mask:0xf
  v_and_b32_dpp v15, v33, v0 row_newbcast:8 row_mask:0xf bank_mask:0xf
  s_nop 1
  v_mfma_f32_16x16x32_bf16 v[4:7], v[12:15], v[136:139], v[4:7]
  s_cmp_le_u32 s20, 4
  s_cbranch_scc1 L_snp2
  v_and_b32_dpp v12, v33, v34 row_newbcast:9 row_mask:0xf bank_mask:0xf
  v_and_b32_dpp v13, v33, v35 row_newbcast:9 row_mask:0xf bank_mask:0xf
  v_and_b32_dpp v14, v33, v36 row_newbcast:9 row_mask:0xf bank_mask:0xf
  v_and_b32_dpp v15, v33, v0 row_newbcast:9 row_mask:0xf bank_mask:0xf
  s_nop 1
  v_mfma_f32_16x16x32_bf16 v[4:7], v[12:15], v[140:143], v[4:7]
  s_cmp_le_u32 s20, 8
  s_cbranch_scc1 L_snp2
  v_and_b32_dpp v12, v33, v34 row_newbcast:10 row_mask:0xf bank_mask:0xf
  v_and_b32_dpp v13, v33, v35 row_newbcast:10 row_mask:0xf bank_mask:0xf
  v_and_b32_dpp v14, v33, v36 row_newbcast:10 row_mask:0xf bank_mask:0xf
  v_and_b32_dpp v15, v33, v0 row_newbcast:10 row_mask:0xf bank_mask:0xf
  s_nop 1
  v_mfma_f32_16x16x32_bf16 v[4:7], v[12:15], v[144:147], v[4:7]
  s_cmp_le_u32 s20, 12
  s_cbranch_scc1 L_snp2
  v_and_b32_dpp v12, v33, v34 row_newbcast:11 row_mask:0xf bank_mask:0xf
  v_and_b32_dpp v13, v33, v35 row_newbcast:11 row_mask:0xf bank_mask:0xf
  v_and_b32_dpp v14, v33, v36 row_newbcast:11 row_mask:0xf bank_mask:0xf
  v_and_b32_dpp v15, v33, v0 row_newbcast:11 row_mask:0xf bank_mask:0xf
  s_nop 1
  v_mfma_f32_16x16x32_bf16 v[4:7], v[12:15], v[148:151], v[4:7]
  s_cmp_le_u32 s20, 16
  s_cbranch_scc1 L_snp2
  v_and_b32_dpp v12, v33, v34 row_newbcast:12 row_mask:0xf bank_mask:0xf
  v_and_b32_dpp v13, v33, v35 row_newbcast:12 row_mask:0xf bank_mask:0xf
  v_and_b32_dpp v14, v33, v36 row_newbcast:12 row_mask:0xf bank_mask:0xf
  v_and_b32_dpp v15, v33, v0 row_newbcast:12 row_mask:0xf bank_mask:0xf
  s_nop 1
  v_mfma_f32_16x16x32_bf16 v[4:7], v[12:15], v[152:155], v[4:7]
  s_cmp_le_u32 s20, 20
  s_cbranch_scc1 L_snp2
  v_and_b32_dpp v12, v33, v34 row_newbcast:13 row_mask:0xf bank_mask:0xf
  v_and_b32_dpp v13, v33, v35 row_newbcast:13 row_mask:0xf bank_mask:0xf
  v_and_b32_dpp v14, v33, v36 row_newbcast:13 row_mask:0xf bank_mask:0xf
  v_and_b32_dpp v15, v33, v0 row_newbcast:13 row_mask:0xf bank_mask:0xf
  s_nop 1
  v_mfma_f32_16x16x32_bf16 v[4:7], v[12:15], v[156:159], v[4:7]
  s_cmp_le_u32 s20, 24
  s_cbranch_scc1 L_snp2
  v_and_b32_dpp v12, v33, v34 row_newbcast:14 row_mask:0xf bank_mask:0xf
  v_and_b32_dpp v13, v33, v35 row_newbcast:14 row_mask:0xf bank_mask:0xf
  v_and_b32_dpp v14, v33, v36 row_newbcast:14 row_mask:0xf bank_mask:0xf
  v_and_b32_dpp v15, v33, v0 row_newbcast:14 row_mask:0xf bank_mask:0xf
  s_nop 1
  v_mfma_f32_16x16x32_bf16 v[4:7], v[12:15], v[160:163], v[4:7]
  s_cmp_le_u32 s20, 28
  s_cbranch_scc1 L_snp2
  v_and_b32_dpp v12, v33, v34 row_newbcast:15 row_mask:0xf bank_mask:0xf
  v_and_b32_dpp v13, v33, v35 row_newbcast:15 row_mask:0xf bank_mask:0xf
  v_and_b32_dpp v14, v33, v36 row_newbcast:15 row_mask:0xf bank_mask:0xf
  v_and_b32_dpp v15, v33, v0 row_newbcast:15 row_mask:0xf bank_mask:0xf
  s_nop 1
  v_mfma_f32_16x16x32_bf16 v[4:7], v[12:15], v[164:167], v[4:7]
L_snp2:
  v_lshrrev_b32 v3, 4, v1
  v_lshl_add_u32 v21, v3, 3, v39
  v_add_u32 v21, s11, v21
  v_mov_b32 v3, 1
  s_nop 0
  s_mov_b32 s19, 0
  s_sub_i32 s34, s34, 2458
  s_mov_b32 s76, 20480
  s_cmp_lg_u32 s21, 0
  s_cbranch_scc1 L_vs1b
  s_mov_b32 exec_hi, 0
  ds_write_b128 v21, v[4:7] offset:6656
  s_mov_b64 exec, 1
  ds_add_u32 v1, v3 offset:304
  s_mov_b64 exec, -1
  s_branch L_vs1b
L_vq:
  v_readfirstlane_b32 s78, v22
  v_readfirstlane_b32 s79, v23
L_vs1b:
L_vs2:
  s_cmp_lt_u32 s32, s36
  s_cbranch_scc1 L_ks2
L_ev:
  s_cmp_eq_u32 s75, 0
  s_cbranch_scc1 L_hand
  s_add_u32 s68, s32, 5
  s_cmp_lt_u32 s68, s75
  s_cbranch_scc0 L_wt1
  s_add_u32 s32, s32, 1
  s_mov_b64 exec, 1
  ds_dec_u32 v2, v39 offset:288
  s_mov_b64 exec, -1
  s_branch L_wtx
L_hand:
  v_mov_b32 v3, 0
  s_mov_b32 s70, 0
L_sn_1:
  ds_read_b64 v[18:19], v3 offset:272
  s_waitcnt lgkmcnt(0)
  v_cmp_gt_u32 vcc, 0x102c0, v18
  s_cmp_eq_u64 vcc, 0
  s_cbranch_scc1 L_snd_2
  s_sleep 1
  s_add_u32 s70, s70, 1
  s_cmp_lt_u32 s70, 2097152
  s_cbranch_scc1 L_sn_1
L_snd_2:
  v_cmp_nlt_f32 vcc, v25, v19
  s_lshl_b32 s68, s38, 3
  s_add_u32 s68, s68, s56
  s_andn2_b64 s[70:71], vcc, s[64:65]
  v_mbcnt_lo_u32_b32 v3, s70, 0
  v_mbcnt_hi_u32_b32 v3, s71, v3
  s_bcnt1_i32_b64 s69, s[70:71]
  v_lshl_add_u32 v3, v3, 3, s68
  s_mov_b64 exec, s[70:71]
  ds_write_b64 v3, v[24:25]
  s_mov_b64 exec, -1
  s_or_b64 s[64:65], s[64:65], s[70:71]
  s_add_u32 s38, s38, s69
  v_cmp_nlt_f32 vcc, v27, v19
  s_lshl_b32 s68, s38, 3
  s_add_u32 s68, s68, s56
  s_andn2_b64 s[70:71], vcc, s[66:67]
  v_mbcnt_lo_u32_b32 v3, s70, 0
  v_mbcnt_hi_u32_b32 v3, s71, v3
  s_bcnt1_i32_b64 s69, s[70:71]
  v_lshl_add_u32 v3, v3, 3, s68
  s_mov_b64 exec, s[70:71]
  ds_write_b64 v3, v[26:27]
  s_mov_b64 exec, -1
  s_or_b64 s[66:67], s[66:67], s[70:71]
  s_add_u32 s38, s38, s69
  ds_read_b64 v[28:29], v39 offset:0
  ds_read_b64 v[30:31], v39 offset:512
  ds_read_b64 v[32:33], v39 offset:1024
  s_add_u32 s75, s38, 23
  s_lshr_b32 s75, s75, 2
  s_sub_u32 s36, s75, 8
  s_max_i32 s36, s36, 0
  s_add_u32 s68, s38, 3
  s_lshr_b32 s68, s68, 2
  s_sub_u32 s69, s68, s59
  s_mov_b32 s59, s68
  s_add_u32 s35, s35, s69
  s_add_u32 s78, s78, s69
  v_mov_b32 v3, s69
  s_mov_b64 exec, 1
  ds_add_u32 v1, v3 offset:296
  ds_add_u32 v1, v3 offset:300
  s_mov_b64 exec, -1
  s_waitcnt lgkmcnt(0)
  v_sub_f32 v29, v29, v37
  v_sub_f32 v31, v31, v37
  v_sub_f32 v33, v33, v37
  v_mul_f32 v29, 0x3fb8aa3b, v29
  v_mul_f32 v31, 0x3fb8aa3b, v31
  v_mul_f32 v33, 0x3fb8aa3b, v33
  v_exp_f32 v29, v29
  v_exp_f32 v31, v31
  v_exp_f32 v33, v33
  s_nop 0
  v_cvt_pk_bf16_f32 v29, v29, v29
  v_cvt_pk_bf16_f32 v31, v31, v31
  v_cvt_pk_bf16_f32 v33, v33, v33
  s_branch L_vs2
L_work:
  s_cmp_eq_u32 s39, 4
  s_cbranch_scc1 L_w3
  s_cmp_eq_u32 s39, 3
  s_cbranch_scc1 L_w2b
  s_cmp_eq_u32 s39, 5
  s_cbranch_scc1 L_w5
L_w2:
  v_and_b32 v3, 0xf0, v0
  ds_read_b128 v[4:7], v3 offset:0
  s_waitcnt lgkmcnt(0)
  v_max3_u32 v8, v4, v5, v6
  v_max_u32 v8, v8, v7
  v_cmp_eq_u32 vcc, -1, v8
  s_cmp_lg_u64 vcc, 0
  s_cbranch_scc1 L_wr
  s_mov_b64 vcc, s[52:53]
  v_mfma_f32_16x16x32_bf16 v[8:11], v[4:7], v[40:43], 0
  v_mfma_f32_16x16x32_bf16 v[40:43], v[4:7], v[44:47], 0
  v_mfma_f32_16x16x32_bf16 v[44:47], v[4:7], v[48:51], 0
  v_mfma_f32_16x16x32_bf16 v[48:51], v[4:7], v[52:55], 0
  v_mfma_f32_16x16x32_bf16 v[52:55], v[4:7], v[56:59], 0
  v_mfma_f32_16x16x32_bf16 v[56:59], v[4:7], v[60:63], 0
  v_mfma_f32_16x16x32_bf16 v[60:63], v[4:7], v[64:67], 0
  v_mfma_f32_16x16x32_bf16 v[64:67], v[4:7], v[68:71], 0
  s_nop 0
  v_cndmask_b32 v8, v8, v9, s[54:55]
  v_cndmask_b32 v10, v10, v11, s[54:55]
  v_cndmask_b32 v40, v40, v41, s[54:55]
  v_cndmask_b32 v42, v42, v43, s[54:55]
  v_cndmask_b32 v44, v44, v45, s[54:55]
  v_cndmask_b32 v46, v46, v47, s[54:55]
  v_cndmask_b32 v48, v48, v49, s[54:55]
  v_cndmask_b32 v50, v50, v51, s[54:55]
  v_cndmask_b32 v52, v52, v53, s[54:55]
  v_cndmask_b32 v54, v54, v55, s[54:55]
  v_cndmask_b32 v56, v56, v57, s[54:55]
  v_cndmask_b32 v58, v58, v59, s[54:55]
  v_cndmask_b32 v60, v60, v61, s[54:55]
  v_cndmask_b32 v62, v62, v63, s[54:55]
  v_cndmask_b32 v64, v64, v65, s[54:55]
  v_cndmask_b32 v66, v66, v67, s[54:55]
  v_cndmask_b32_dpp v16, v8, v10, vcc quad_perm:[0,1,2,3] row_mask:0x1 bank_mask:0xf
  v_cndmask_b32_dpp v18, v40, v42, vcc quad_perm:[0,1,2,3] row_mask:0x1 bank_mask:0xf
  v_cndmask_b32_dpp v17, v44, v46, vcc quad_perm:[0,1,2,3] row_mask:0x1 bank_mask:0xf
  v_cndmask_b32_dpp v19, v48, v50, vcc quad_perm:[0,1,2,3] row_mask:0x1 bank_mask:0xf
  v_cndmask_b32_dpp v16, v52, v54, vcc quad_perm:[0,1,2,3] row_mask:0x2 bank_mask:0xf
  v_cndmask_b32_dpp v18, v56, v58, vcc quad_perm:[0,1,2,3] row_mask:0x2 bank_mask:0xf
  v_cndmask_b32_dpp v17, v60, v62, vcc quad_perm:[0,1,2,3] row_mask:0x2 bank_mask:0xf
  v_cndmask_b32_dpp v19, v64, v66, vcc quad_perm:[0,1,2,3] row_mask:0x2 bank_mask:0xf
  s_mov_b32 s39, 3
  s_mov_b32 s57, 17
L_wr:
  s_setpc_b64 s[100:101]
L_w2b:
  s_add_u32 s68, s41, 16
  s_cmp_lt_u32 s32, s68
  s_cbranch_scc1 L_wr
  s_mov_b64 vcc, s[52:53]
  v_mfma_f32_16x16x32_bf16 v[8:11], v[4:7], v[72:75], 0
  v_mfma_f32_16x16x32_bf16 v[72:75], v[4:7], v[76:79], 0
  v_mfma_f32_16x16x32_bf16 v[76:79], v[4:7], v[80:83], 0
  v_mfma_f32_16x16x32_bf16 v[80:83], v[4:7], v[84:87], 0
  v_mfma_f32_16x16x32_bf16 v[84:87], v[4:7], v[88:91], 0
  v_mfma_f32_16x16x32_bf16 v[88:91], v[4:7], v[92:95], 0
  v_mfma_f32_16x16x32_bf16 v[92:95], v[4:7], v[96:99], 0
  v_mfma_f32_16x16x32_bf16 v[96:99], v[4:7], v[100:103], 0
  s_nop 0
  v_cndmask_b32 v8, v8, v9, s[54:55]
  v_cndmask_b32 v10, v10, v11, s[54:55]
  v_cndmask_b32 v72, v72, v73, s[54:55]
  v_cndmask_b32 v74, v74, v75, s[54:55]
  v_cndmask_b32 v76, v76, v77, s[54:55]
  v_cndmask_b32 v78, v78, v79, s[54:55]
  v_cndmask_b32 v80, v80, v81, s[54:55]
  v_cndmask_b32 v82, v82, v83, s[54:55]
  v_cndmask_b32 v84, v84, v85, s[54:55]
  v_cndmask_b32 v86, v86, v87, s[54:55]
  v_cndmask_b32 v88, v88, v89, s[54:55]
  v_cndmask_b32 v90, v90, v91, s[54:55]
  v_cndmask_b32 v92, v92, v93, s[54:55]
  v_cndmask_b32 v94, v94, v95, s[54:55]
  v_cndmask_b32 v96, v96, v97, s[54:55]
  v_cndmask_b32 v98, v98, v99, s[54:55]
  v_cndmask_b32_dpp v16, v8, v10, vcc quad_perm:[0,1,2,3] row_mask:0x4 bank_mask:0xf
  v_cndmask_b32_dpp v18, v72, v74, vcc quad_perm:[0,1,2,3] row_mask:0x4 bank_mask:0xf
  v_cndmask_b32_dpp v17, v76, v78, vcc quad_perm:[0,1,2,3] row_mask:0x4 bank_mask:0xf
  v_cndmask_b32_dpp v19, v80, v82, vcc quad_perm:[0,1,2,3] row_mask:0x4 bank_mask:0xf
  v_cndmask_b32_dpp v16, v84, v86, vcc quad_perm:[0,1,2,3] row_mask:0x8 bank_mask:0xf
  v_cndmask_b32_dpp v18, v88, v90, vcc quad_perm:[0,1,2,3] row_mask:0x8 bank_mask:0xf
  v_cndmask_b32_dpp v17, v92, v94, vcc quad_perm:[0,1,2,3] row_mask:0x8 bank_mask:0xf
  v_cndmask_b32_dpp v19, v96, v98, vcc quad_perm:[0,1,2,3] row_mask:0x8 bank_mask:0xf
  v_mov_b32 v3, 0
  v_mov_b32 v20, 64
  v_add_f32_dpp v16, v16, v16 quad_perm:[2,3,0,1] row_mask:0xf bank_mask:0xf
  v_add_f32_dpp v17, v17, v17 quad_perm:[2,3,0,1] row_mask:0xf bank_mask:0xf
  v_add_f32_dpp v18, v18, v18 quad_perm:[2,3,0,1] row_mask:0xf bank_mask:0xf
  v_add_f32_dpp v19, v19, v19 quad_perm:[2,3,0,1] row_mask:0xf bank_mask:0xf
  v_cndmask_b32 v8, v16, v17, s[52:53]
  v_cndmask_b32 v9, v18, v19, s[52:53]
  s_nop 0
  v_lshlrev_b32 v21, 3, s9
  v_add_f32_dpp v8, v8, v8 quad_perm:[1,0,3,2] row_mask:0xf bank_mask:0xf
  v_add_f32_dpp v9, v9, v9 quad_perm:[1,0,3,2] row_mask:0xf bank_mask:0xf
  v_cndmask_b32 v25, v8, v9, s[54:55]
  v_cvt_pk_bf16_f32 v25, 0, v25
  v_mul_f32 v25, 0x3db504f3, v25
  v_cvt_pk_bf16_f32 v25, 0, v25
  v_cmp_gt_u32 vcc, s46, v24
  v_mov_b32 v37, 0xff800000
  s_nop 0
  v_cndmask_b32 v25, v37, v25, vcc
  v_mov_b32 v37, v25
  s_nop 1
  v_max_f32_dpp v37, v37, v37 row_ror:8 row_mask:0xf bank_mask:0xf
  s_nop 1
  v_max_f32_dpp v37, v37, v37 row_ror:4 row_mask:0xf bank_mask:0xf
  s_nop 1
  v_max_f32_dpp v37, v37, v37 row_ror:2 row_mask:0xf bank_mask:0xf
  s_nop 1
  v_max_f32_dpp v37, v37, v37 row_ror:1 row_mask:0xf bank_mask:0xf
  v_mov_b32 v8, v37
  s_nop 1
  v_permlane16_swap_b32 v8, v37
  v_max_f32 v37, v37, v8
  v_mov_b32 v8, v37
  s_nop 1
  v_permlane32_swap_b32 v8, v37
  v_max_f32 v37, v37, v8
  s_mov_b64 exec, 1
  ds_max_f32 v3, v37 offset:284
  ds_add_u32 v3, v20 offset:280
  s_mov_b64 exec, -1
  s_mov_b32 s39, 4
  s_mov_b32 s19, 0
  s_setpc_b64 s[100:101]
L_w5:
  s_add_u32 s68, s41, 24
  s_cmp_lt_u32 s32, s68
  s_cbranch_scc1 L_wr
  s_mov_b64 vcc, s[52:53]
  v_mfma_f32_16x16x32_bf16 v[8:11], v[4:7], v[104:107], 0
  v_mfma_f32_16x16x32_bf16 v[104:107], v[4:7], v[108:111], 0
  v_mfma_f32_16x16x32_bf16 v[108:111], v[4:7], v[112:115], 0
  v_mfma_f32_16x16x32_bf16 v[112:115], v[4:7], v[116:119], 0
  v_mfma_f32_16x16x32_bf16 v[116:119], v[4:7], v[120:123], 0
  v_mfma_f32_16x16x32_bf16 v[120:123], v[4:7], v[124:127], 0
  v_mfma_f32_16x16x32_bf16 v[124:127], v[4:7], v[128:131], 0
  v_mfma_f32_16x16x32_bf16 v[128:131], v[4:7], v[132:135], 0
  s_nop 0
  v_cndmask_b32 v8, v8, v9, s[54:55]
  v_cndmask_b32 v10, v10, v11, s[54:55]
  v_cndmask_b32 v104, v104, v105, s[54:55]
  v_cndmask_b32 v106, v106, v107, s[54:55]
  v_cndmask_b32 v108, v108, v109, s[54:55]
  v_cndmask_b32 v110, v110, v111, s[54:55]
  v_cndmask_b32 v112, v112, v113, s[54:55]
  v_cndmask_b32 v114, v114, v115, s[54:55]
  v_cndmask_b32 v116, v116, v117, s[54:55]
  v_cndmask_b32 v118, v118, v119, s[54:55]
  v_cndmask_b32 v120, v120, v121, s[54:55]
  v_cndmask_b32 v122, v122, v123, s[54:55]
  v_cndmask_b32 v124, v124, v125, s[54:55]
  v_cndmask_b32 v126, v126, v127, s[54:55]
  v_cndmask_b32 v128, v128, v129, s[54:55]
  v_cndmask_b32 v130, v130, v131, s[54:55]
  v_cndmask_b32_dpp v16, v8, v10, vcc quad_perm:[0,1,2,3] row_mask:0x1 bank_mask:0xf
  v_cndmask_b32_dpp v18, v104, v106, vcc quad_perm:[0,1,2,3] row_mask:0x1 bank_mask:0xf
  v_cndmask_b32_dpp v17, v108, v110, vcc quad_perm:[0,1,2,3] row_mask:0x1 bank_mask:0xf
  v_cndmask_b32_dpp v19, v112, v114, vcc quad_perm:[0,1,2,3] row_mask:0x1 bank_mask:0xf
  v_cndmask_b32_dpp v16, v116, v118, vcc quad_perm:[0,1,2,3] row_mask:0x2 bank_mask:0xf
  v_cndmask_b32_dpp v18, v120, v122, vcc quad_perm:[0,1,2,3] row_mask:0x2 bank_mask:0xf
  v_cndmask_b32_dpp v17, v124, v126, vcc quad_perm:[0,1,2,3] row_mask:0x2 bank_mask:0xf
  v_cndmask_b32_dpp v19, v128, v130, vcc quad_perm:[0,1,2,3] row_mask:0x2 bank_mask:0xf
  s_mov_b32 s39, 6
  s_mov_b32 s57, 99
  s_setpc_b64 s[100:101]
L_w3:
  v_mov_b32 v3, 0
  ds_read_b64 v[18:19], v3 offset:280
  s_waitcnt lgkmcnt(0)
  v_cmp_gt_u32 vcc, 0x102c0, v18
  s_cmp_lg_u64 vcc, 0
  s_cbranch_scc1 L_wr
  ds_read_b64 v[20:21], v3 offset:320
  s_waitcnt lgkmcnt(0)
  v_add_f32 v21, 0xc1c00000, v21
  v_cmp_nlt_f32 vcc, v25, v21
  v_readfirstlane_b32 s22, v21
  v_readfirstlane_b32 s23, v20
  s_mov_b32 s20, 0
  s_bcnt1_i32_b64 s68, vcc
  s_cmp_gt_u32 s68, 32
  s_cselect_b32 s21, 1, 0
  s_cbranch_scc1 L_w4
  s_mov_b32 s38, 160
  v_cmp_nlt_f32 vcc, v25, v21
  s_lshl_b32 s68, s38, 3
  s_add_u32 s68, s68, s56
  s_andn2_b64 s[70:71], vcc, s[64:65]
  v_mbcnt_lo_u32_b32 v3, s70, 0
  v_mbcnt_hi_u32_b32 v3, s71, v3
  s_bcnt1_i32_b64 s69, s[70:71]
  v_lshl_add_u32 v3, v3, 3, s68
  s_mov_b64 exec, s[70:71]
  ds_write_b64 v3, v[24:25]
  s_mov_b64 exec, -1
  s_or_b64 s[64:65], s[64:65], s[70:71]
  s_add_u32 s38, s38, s69
  s_mov_b32 s20, s69
  s_mov_b32 s38, 0
L_w4:
  v_add_f32 v21, 0xc2a5e666, v20
  v_cmp_nlt_f32 vcc, v25, v21
  s_lshl_b32 s68, s38, 3
  s_add_u32 s68, s68, s56
  s_andn2_b64 s[70:71], vcc, s[64:65]
  v_mbcnt_lo_u32_b32 v3, s70, 0
  v_mbcnt_hi_u32_b32 v3, s71, v3
  s_bcnt1_i32_b64 s69, s[70:71]
  v_lshl_add_u32 v3, v3, 3, s68
  s_mov_b64 exec, s[70:71]
  ds_write_b64 v3, v[24:25]
  s_mov_b64 exec, -1
  s_or_b64 s[64:65], s[64:65], s[70:71]
  s_add_u32 s38, s38, s69
  s_add_u32 s68, s38, 6
  s_lshr_b32 s68, s68, 1
  s_sub_u32 s69, s68, s59
  s_mov_b32 s59, s68
  v_mov_b32 v3, s69
  s_mov_b64 exec, 1
  ds_add_u32 v1, v3 offset:296
  ds_add_u32 v1, v3 offset:300
  s_mov_b64 exec, -1
  s_sub_i32 s68, s59, 20
  s_max_i32 s68, s68, -4
  s_mul_i32 s68, s68, 245
  s_add_i32 s34, s34, s68
  s_mov_b32 s39, 5
  s_mov_b32 s57, 25
  ds_read_b64 v[28:29], v39 offset:0
  s_waitcnt lgkmcnt(0)
  s_setpc_b64 s[100:101]
L_pub:
  s_load_dwordx8 s[24:31], s[0:1], 32
  s_load_dwordx8 s[32:39], s[0:1], 64
  s_load_dwordx4 s[40:43], s[0:1], 96
  s_mov_b32 s72, 0xfffffffe
  s_mov_b32 s73, 0xffff0000
  s_getpc_b64 s[56:57]
L_pct:
  s_lshr_b32 s3, s2, 3
  s_lshl_b32 s3, s3, 2
  s_add_u32 s3, s3, L_touch-L_pct
  s_load_dword s14, s[56:57], s3
  s_waitcnt lgkmcnt(0)
  s_bfe_u32 s48, s14, 0x30000
  s_lshl_b32 s48, s48, 6
  v_add_u32 v2, s48, v1
  s_bfe_u32 s48, s14, 0x30003
  s_bitcmp1_b32 s14, 7
  s_cbranch_scc1 L_te_4
  s_bitcmp1_b32 s14, 6
  s_cbranch_scc1 L_tq_3
  s_lshl1_add_u32 s48, s8, s48
  s_lshl_b32 s48, s48, 7
  v_mul_u32_u24 v2, 6144, v2
  v_add_u32 v2, s48, v2
  global_load_dword v167, v2, s[36:37]
  s_branch L_te_4
L_tq_3:
  s_lshl3_add_u32 s48, s8, s48
  s_lshl_b32 s48, s48, 7
  v_lshl_add_u32 v2, v2, 13, s48
  global_load_dword v167, v2, s[22:23]
L_te_4:
  s_bfe_u32 s48, s14, 0x30008
  s_lshl_b32 s48, s48, 6
  v_add_u32 v2, s48, v1
  s_bfe_u32 s48, s14, 0x3000b
  s_bitcmp1_b32 s14, 15
  s_cbranch_scc1 L_te_6
  s_bitcmp1_b32 s14, 14
  s_cbranch_scc1 L_tq_5
  s_lshl1_add_u32 s48, s8, s48
  s_lshl_b32 s48, s48, 7
  v_mul_u32_u24 v2, 6144, v2
  v_add_u32 v2, s48, v2
  global_load_dword v167, v2, s[36:37]
  s_branch L_te_6
L_tq_5:
  s_lshl3_add_u32 s48, s8, s48
  s_lshl_b32 s48, s48, 7
  v_lshl_add_u32 v2, v2, 13, s48
  global_load_dword v167, v2, s[22:23]
L_te_6:
  v_mov_b32 v38, 0
  v_mov_b32 v4, -1
  v_mov_b32 v8, 0xff800000
  v_mov_b32 v9, 0
  v_lshlrev_b32 v2, 3, v1
  ds_write_b64 v2, v[8:9] offset:448
  v_mov_b32 v5, 0
  v_mov_b32 v6, 0
  v_mov_b32 v7, 0
  v_lshlrev_b32 v2, 2, v1
  ds_write_b32 v2, v4 offset:0
  ds_write_b128 v38, v[4:7] offset:256
  v_mov_b32 v10, 0
  v_mov_b32 v11, v8
  v_mov_b32 v12, 0
  v_mov_b32 v13, v8
  ds_write_b128 v38, v[10:13] offset:272
  v_mov_b32 v10, 1332
  v_mov_b32 v11, 0
  v_mov_b32 v12, 1024
  v_mov_b32 v13, 0
  ds_write_b128 v38, v[10:13] offset:288
  v_mov_b32 v4, 0
  ds_write_b128 v38, v[4:7] offset:304
  s_getreg_b32 s76, hwreg(HW_REG_XCC_ID, 0, 4)
  s_waitcnt lgkmcnt(0)
  s_load_dword s74, s[42:43], 0
  s_barrier
  s_waitcnt lgkmcnt(0)
  s_mul_i32 s74, s74, 0x9e3779b1
  s_add_u32 s74, s74, 0x7f4a7c15
  s_add_u32 s76, s76, s74
  s_lshl2_add_u32 s64, s6, s7
  s_lshl_b32 s64, s64, 7
  s_add_u32 s64, s64, 65536
  v_mov_b32 v18, s64
  v_add_u32 v19, 32768, v18
  v_mov_b32 v17, 0x10000
  s_lshl2_add_u32 s49, s6, s7
  s_lshl_b32 s49, s49, 9
  s_add_u32 s49, s49, 131072
  v_and_b32 v10, 3, v1
  v_lshl_add_u32 v10, v10, 7, s49
  v_bfe_u32 v11, v1, 2, 1
  v_mul_u32_u24 v11, 393216, v11
  v_add_u32 v10, v10, v11
  s_mov_b64 exec, 0xff
  global_load_dword v166, v10, s[42:43] sc1
  s_mov_b64 exec, 1
  global_load_dword v166, v18, s[42:43] sc1
  global_load_dword v166, v19, s[42:43] sc1
  s_mov_b64 exec, -1
  s_mov_b32 s70, 0
L_qw_7:
  ds_read_b32 v8, v38 offset:288
  s_waitcnt lgkmcnt(0)
  v_cmp_lt_u32 vcc, 1233, v8
  s_cmp_eq_u64 vcc, 0
  s_cbranch_scc1 L_qw_7d
  s_sleep 4
  s_add_u32 s70, s70, 1
  s_cmp_lt_u32 s70, 2097152
  s_cbranch_scc1 L_qw_7
L_qw_7d:
  s_lshl_b32 s3, s6, 9
  s_mov_b64 exec, 1
  s_mov_b32 s70, 0
L_qp0:
  s_load_dwordx16 s[8:23], s[42:43], s3 offset:32768 glc
  s_load_dwordx16 s[24:39], s[42:43], s3 offset:32832 glc
  s_load_dwordx16 s[44:59], s[42:43], s3 offset:32896 glc
  s_load_dwordx16 s[84:99], s[42:43], s3 offset:32960 glc
  s_mov_b32 s62, -1
  s_mov_b32 s63, 0
  s_waitcnt lgkmcnt(0)
  s_and_b32 s62, s62, s9
  s_or_b32 s63, s63, s9
  s_and_b32 s62, s62, s11
  s_or_b32 s63, s63, s11
  s_and_b32 s62, s62, s13
  s_or_b32 s63, s63, s13
  s_and_b32 s62, s62, s15
  s_or_b32 s63, s63, s15
  s_and_b32 s62, s62, s17
  s_or_b32 s63, s63, s17
  s_and_b32 s62, s62, s19
  s_or_b32 s63, s63, s19
  s_and_b32 s62, s62, s21
  s_or_b32 s63, s63, s21
  s_and_b32 s62, s62, s23
  s_or_b32 s63, s63, s23
  s_and_b32 s62, s62, s25
  s_or_b32 s63, s63, s25
  s_and_b32 s62, s62, s27
  s_or_b32 s63, s63, s27
  s_and_b32 s62, s62, s29
  s_or_b32 s63, s63, s29
  s_and_b32 s62, s62, s31
  s_or_b32 s63, s63, s31
  s_and_b32 s62, s62, s33
  s_or_b32 s63, s63, s33
  s_and_b32 s62, s62, s35
  s_or_b32 s63, s63, s35
  s_and_b32 s62, s62, s37
  s_or_b32 s63, s63, s37
  s_and_b32 s62, s62, s39
  s_or_b32 s63, s63, s39
  s_and_b32 s62, s62, s45
  s_or_b32 s63, s63, s45
  s_and_b32 s62, s62, s47
  s_or_b32 s63, s63, s47
  s_and_b32 s62, s62, s49
  s_or_b32 s63, s63, s49
  s_and_b32 s62, s62, s51
  s_or_b32 s63, s63, s51
  s_and_b32 s62, s62, s53
  s_or_b32 s63, s63, s53
  s_and_b32 s62, s62, s55
  s_or_b32 s63, s63, s55
  s_and_b32 s62, s62, s57
  s_or_b32 s63, s63, s57
  s_and_b32 s62, s62, s59
  s_or_b32 s63, s63, s59
  s_and_b32 s62, s62, s85
  s_or_b32 s63, s63, s85
  s_and_b32 s62, s62, s87
  s_or_b32 s63, s63, s87
  s_and_b32 s62, s62, s89
  s_or_b32 s63, s63, s89
  s_and_b32 s62, s62, s91
  s_or_b32 s63, s63, s91
  s_and_b32 s62, s62, s93
  s_or_b32 s63, s63, s93
  s_and_b32 s62, s62, s95
  s_or_b32 s63, s63, s95
  s_and_b32 s62, s62, s97
  s_or_b32 s63, s63, s97
  s_and_b32 s62, s62, s99
  s_or_b32 s63, s63, s99
  s_xor_b32 s62, s62, s74
  s_xor_b32 s63, s63, s74
  s_or_b32 s62, s62, s63
  s_cbranch_scc0 L_qp0d
  s_sleep 2
  s_add_u32 s70, s70, 1
  s_cmp_lt_u32 s70, 262144
  s_cbranch_scc1 L_qp0
L_qp0d:
  v_mov_b32 v40, s8
  v_mov_b32 v41, s10
  v_mov_b32 v42, s12
  v_mov_b32 v43, s14
  v_mov_b32 v44, s16
  v_mov_b32 v45, s18
  v_mov_b32 v46, s20
  v_mov_b32 v47, s22
  v_mov_b32 v48, s24
  v_mov_b32 v49, s26
  v_mov_b32 v50, s28
  v_mov_b32 v51, s30
  v_mov_b32 v52, s32
  v_mov_b32 v53, s34
  v_mov_b32 v54, s36
  v_mov_b32 v55, s38
  v_mov_b32 v56, s44
  v_mov_b32 v57, s46
  v_mov_b32 v58, s48
  v_mov_b32 v59, s50
  v_mov_b32 v60, s52
  v_mov_b32 v61, s54
  v_mov_b32 v62, s56
  v_mov_b32 v63, s58
  v_mov_b32 v64, s84
  v_mov_b32 v65, s86
  v_mov_b32 v66, s88
  v_mov_b32 v67, s90
  v_mov_b32 v68, s92
  v_mov_b32 v69, s94
  v_mov_b32 v70, s96
  v_mov_b32 v71, s98
  s_mov_b32 s70, 0
L_qp1:
  s_load_dwordx16 s[8:23], s[42:43], s3 offset:33024 glc
  s_load_dwordx16 s[24:39], s[42:43], s3 offset:33088 glc
  s_load_dwordx16 s[44:59], s[42:43], s3 offset:33152 glc
  s_load_dwordx16 s[84:99], s[42:43], s3 offset:33216 glc
  s_mov_b32 s62, -1
  s_mov_b32 s63, 0
  s_waitcnt lgkmcnt(0)
  s_and_b32 s62, s62, s9
  s_or_b32 s63, s63, s9
  s_and_b32 s62, s62, s11
  s_or_b32 s63, s63, s11
  s_and_b32 s62, s62, s13
  s_or_b32 s63, s63, s13
  s_and_b32 s62, s62, s15
  s_or_b32 s63, s63, s15
  s_and_b32 s62, s62, s17
  s_or_b32 s63, s63, s17
  s_and_b32 s62, s62, s19
  s_or_b32 s63, s63, s19
  s_and_b32 s62, s62, s21
  s_or_b32 s63, s63, s21
  s_and_b32 s62, s62, s23
  s_or_b32 s63, s63, s23
  s_and_b32 s62, s62, s25
  s_or_b32 s63, s63, s25
  s_and_b32 s62, s62, s27
  s_or_b32 s63, s63, s27
  s_and_b32 s62, s62, s29
  s_or_b32 s63, s63, s29
  s_and_b32 s62, s62, s31
  s_or_b32 s63, s63, s31
  s_and_b32 s62, s62, s33
  s_or_b32 s63, s63, s33
  s_and_b32 s62, s62, s35
  s_or_b32 s63, s63, s35
  s_and_b32 s62, s62, s37
  s_or_b32 s63, s63, s37
  s_and_b32 s62, s62, s39
  s_or_b32 s63, s63, s39
  s_and_b32 s62, s62, s45
  s_or_b32 s63, s63, s45
  s_and_b32 s62, s62, s47
  s_or_b32 s63, s63, s47
  s_and_b32 s62, s62, s49
  s_or_b32 s63, s63, s49
  s_and_b32 s62, s62, s51
  s_or_b32 s63, s63, s51
  s_and_b32 s62, s62, s53
  s_or_b32 s63, s63, s53
  s_and_b32 s62, s62, s55
  s_or_b32 s63, s63, s55
  s_and_b32 s62, s62, s57
  s_or_b32 s63, s63, s57
  s_and_b32 s62, s62, s59
  s_or_b32 s63, s63, s59
  s_and_b32 s62, s62, s85
  s_or_b32 s63, s63, s85
  s_and_b32 s62, s62, s87
  s_or_b32 s63, s63, s87
  s_and_b32 s62, s62, s89
  s_or_b32 s63, s63, s89
  s_and_b32 s62, s62, s91
  s_or_b32 s63, s63, s91
  s_and_b32 s62, s62, s93
  s_or_b32 s63, s63, s93
  s_and_b32 s62, s62, s95
  s_or_b32 s63, s63, s95
  s_and_b32 s62, s62, s97
  s_or_b32 s63, s63, s97
  s_and_b32 s62, s62, s99
  s_or_b32 s63, s63, s99
  s_xor_b32 s62, s62, s74
  s_xor_b32 s63, s63, s74
  s_or_b32 s62, s62, s63
  s_cbranch_scc0 L_qp1d
  s_sleep 2
  s_add_u32 s70, s70, 1
  s_cmp_lt_u32 s70, 262144
  s_cbranch_scc1 L_qp1
L_qp1d:
  v_mov_b32 v72, s8
  v_mov_b32 v73, s10
  v_mov_b32 v74, s12
  v_mov_b32 v75, s14
  v_mov_b32 v76, s16
  v_mov_b32 v77, s18
  v_mov_b32 v78, s20
  v_mov_b32 v79, s22
  v_mov_b32 v80, s24
  v_mov_b32 v81, s26
  v_mov_b32 v82, s28
  v_mov_b32 v83, s30
  v_mov_b32 v84, s32
  v_mov_b32 v85, s34
  v_mov_b32 v86, s36
  v_mov_b32 v87, s38
  v_mov_b32 v88, s44
  v_mov_b32 v89, s46
  v_mov_b32 v90, s48
  v_mov_b32 v91, s50
  v_mov_b32 v92, s52
  v_mov_b32 v93, s54
  v_mov_b32 v94, s56
  v_mov_b32 v95, s58
  v_mov_b32 v96, s84
  v_mov_b32 v97, s86
  v_mov_b32 v98, s88
  v_mov_b32 v99, s90
  v_mov_b32 v100, s92
  v_mov_b32 v101, s94
  v_mov_b32 v102, s96
  v_mov_b32 v103, s98
  ds_write_b128 v38, v[40:43] offset:0
  ds_write_b128 v38, v[44:47] offset:16
  ds_write_b128 v38, v[48:51] offset:32
  ds_write_b128 v38, v[52:55] offset:48
  ds_write_b128 v38, v[56:59] offset:64
  ds_write_b128 v38, v[60:63] offset:80
  ds_write_b128 v38, v[64:67] offset:96
  ds_write_b128 v38, v[68:71] offset:112
  ds_write_b128 v38, v[72:75] offset:128
  ds_write_b128 v38, v[76:79] offset:144
  ds_write_b128 v38, v[80:83] offset:160
  ds_write_b128 v38, v[84:87] offset:176
  ds_write_b128 v38, v[88:91] offset:192
  ds_write_b128 v38, v[92:95] offset:208
  ds_write_b128 v38, v[96:99] offset:224
  ds_write_b128 v38, v[100:103] offset:240
  s_mov_b64 exec, -1
  s_and_b32 s8, s2, 7
  s_mov_b32 s13, 0
  s_add_u32 s52, s7, 1
  s_cmp_eq_u32 s52, 3
  s_cselect_b32 s52, 0, s52
  s_add_u32 s53, s52, s7
  s_sub_u32 s53, 3, s53
  s_lshl2_add_u32 s54, s6, s52
  s_lshl_b32 s54, s54, 7
  s_lshl2_add_u32 s55, s6, s53
  s_lshl_b32 s55, s55, 7
  s_mov_b32 s70, 0
L_sn_8:
  ds_read_b64 v[8:9], v38 offset:280
  s_waitcnt lgkmcnt(0)
  v_cmp_gt_u32 vcc, 0x2c0, v8
  s_cmp_eq_u64 vcc, 0
  s_cbranch_scc1 L_snd_9
  s_sleep 2
  s_add_u32 s70, s70, 1
  s_cmp_lt_u32 s70, 2097152
  s_cbranch_scc1 L_sn_8
L_snd_9:
  s_load_dwordx2 s[20:21], s[42:43], s54 offset:65536 glc
  s_load_dwordx2 s[24:25], s[42:43], s55 offset:65536 glc
  v_mov_b32 v8, v9
  v_mov_b32 v9, s74
  s_mov_b64 exec, 1
  global_store_dwordx2 v18, v[8:9], s[42:43] sc1
  s_mov_b32 s70, 0
  s_branch L_s3ec
L_s3e:
  s_load_dwordx2 s[20:21], s[42:43], s54 offset:65536 glc
  s_load_dwordx2 s[24:25], s[42:43], s55 offset:65536 glc
L_s3ec:
  s_waitcnt lgkmcnt(0)
  s_xor_b32 s68, s21, s74
  s_xor_b32 s69, s25, s74
  s_or_b32 s68, s68, s69
  s_cbranch_scc0 L_s3ed
  s_sleep 2
  s_add_u32 s70, s70, 1
  s_cmp_lt_u32 s70, 262144
  s_cbranch_scc1 L_s3e
L_s3ed:
  v_mov_b32 v12, s20
  v_max3_f32 v10, v8, v12, s24
  v_min3_f32 v11, v8, v12, s24
  ds_write_b64 v38, v[10:11] offset:320
  ds_add_u32 v38, v17 offset:280
  s_mov_b64 exec, -1
  s_lshl_b32 s64, s8, 7
  s_load_dwordx8 s[20:27], s[42:43], s64 offset:1024 glc
  s_waitcnt lgkmcnt(0)
  s_xor_b32 s68, s20, s76
  s_xor_b32 s69, s21, s76
  s_or_b32 s68, s68, s69
  s_xor_b32 s69, s22, s76
  s_or_b32 s68, s68, s69
  s_xor_b32 s69, s23, s76
  s_or_b32 s68, s68, s69
  s_xor_b32 s69, s24, s76
  s_or_b32 s68, s68, s69
  s_xor_b32 s69, s25, s76
  s_or_b32 s68, s68, s69
  s_xor_b32 s69, s26, s76
  s_or_b32 s68, s68, s69
  s_xor_b32 s69, s27, s76
  s_or_b32 s68, s68, s69
  s_cselect_b32 s75, 0, 1
  v_lshlrev_b32 v20, 3, s7
  v_lshlrev_b32 v21, 3, s52
  v_lshlrev_b32 v22, 3, s53
  v_and_b32 v9, 15, v1
  v_lshlrev_b32 v9, 3, v9
  v_lshlrev_b32 v11, 2, v1
  s_mov_b32 s70, 0
L_sn_10:
  ds_read_b32 v8, v38 offset:272
  s_waitcnt lgkmcnt(0)
  v_cmp_gt_u32 vcc, 0x280, v8
  s_cmp_eq_u64 vcc, 0
  s_cbranch_scc1 L_snd_11
  s_sleep 1
  s_add_u32 s70, s70, 1
  s_cmp_lt_u32 s70, 2097152
  s_cbranch_scc1 L_sn_10
L_snd_11:
  s_mov_b32 s70, 0
L_wt_12:
  ds_read_b32 v8, v38 offset:272
  ds_read_b32 v16, v9 offset:512
  ds_read_b32 v40, v11 offset:1024
  ds_read_b32 v41, v11 offset:1536
  ds_read_b32 v42, v11 offset:2048
  ds_read_b32 v43, v11 offset:2560
  ds_read_b32 v44, v11 offset:3072
  ds_read_b32 v45, v11 offset:3584
  ds_read_b32 v46, v11 offset:4096
  ds_read_b32 v47, v11 offset:4608
  ds_read_b32 v48, v11 offset:5120
  ds_read_b32 v49, v11 offset:5632
  ds_read_b32 v50, v11 offset:6144
  s_waitcnt lgkmcnt(12)
  v_cmp_gt_u32 vcc, 0x2c0, v8
  s_cmp_eq_u64 vcc, 0
  s_cbranch_scc1 L_wtd_13
  s_waitcnt lgkmcnt(0)
  s_add_u32 s70, s70, 1
  s_cmp_lt_u32 s70, 2097152
  s_cbranch_scc1 L_wt_12
L_wtd_13:
  s_waitcnt lgkmcnt(11)
  v_max_f32_dpp v8, v16, v16 quad_perm:[1,0,3,2] row_mask:0xf bank_mask:0xf
  s_nop 1
  v_max_f32_dpp v8, v8, v8 quad_perm:[2,3,0,1] row_mask:0xf bank_mask:0xf
  s_nop 1
  v_max_f32_dpp v8, v8, v8 row_half_mirror row_mask:0xf bank_mask:0xf
  s_nop 1
  v_max_f32_dpp v8, v8, v8 row_mirror row_mask:0xf bank_mask:0xf
  v_sub_f32 v9, v16, v8
  v_mul_f32 v9, 0x3fb8aa3b, v9
  v_exp_f32 v9, v9
  s_waitcnt lgkmcnt(0)
  s_nop 0
  v_mul_f32_dpp v10, v9, v40 row_newbcast:0 row_mask:0xf bank_mask:0xf
  v_mul_f32_dpp v12, v9, v41 row_newbcast:1 row_mask:0xf bank_mask:0xf
  v_fmac_f32_dpp v10, v9, v42 row_newbcast:2 row_mask:0xf bank_mask:0xf
  v_fmac_f32_dpp v12, v9, v43 row_newbcast:3 row_mask:0xf bank_mask:0xf
  v_fmac_f32_dpp v10, v9, v44 row_newbcast:4 row_mask:0xf bank_mask:0xf
  v_fmac_f32_dpp v12, v9, v45 row_newbcast:5 row_mask:0xf bank_mask:0xf
  v_fmac_f32_dpp v10, v9, v46 row_newbcast:6 row_mask:0xf bank_mask:0xf
  v_fmac_f32_dpp v12, v9, v47 row_newbcast:7 row_mask:0xf bank_mask:0xf
  v_fmac_f32_dpp v10, v9, v48 row_newbcast:8 row_mask:0xf bank_mask:0xf
  v_fmac_f32_dpp v12, v9, v49 row_newbcast:9 row_mask:0xf bank_mask:0xf
  v_fmac_f32_dpp v10, v9, v50 row_newbcast:10 row_mask:0xf bank_mask:0xf
  v_add_f32 v10, v10, v12
  s_nop 1
  v_add_f32_dpp v10, v10, v10 row_ror:8 row_mask:0xf bank_mask:0xf
  s_nop 1
  v_add_f32_dpp v10, v10, v10 row_ror:4 row_mask:0xf bank_mask:0xf
  s_nop 1
  v_add_f32_dpp v10, v10, v10 row_ror:2 row_mask:0xf bank_mask:0xf
  s_nop 1
  v_add_f32_dpp v10, v10, v10 row_ror:1 row_mask:0xf bank_mask:0xf
  v_mov_b32 v12, v10
  s_nop 1
  v_permlane16_swap_b32 v12, v10
  v_add_f32 v10, v10, v12
  v_mov_b32 v12, v10
  s_nop 1
  v_permlane32_swap_b32 v12, v10
  v_add_f32 v10, v10, v12
  s_load_dwordx4 s[20:23], s[42:43], s54 offset:98304 glc
  s_load_dwordx4 s[24:27], s[42:43], s55 offset:98304 glc
  v_mov_b32 v9, s74
  v_mov_b32 v11, s74
  s_mov_b64 exec, 1
  global_store_dwordx4 v19, v[8:11], s[42:43] sc1
  ds_write_b32 v20, v8 offset:448
  ds_write_b32 v20, v10 offset:452
  s_mov_b32 s70, 0
  s_branch L_s3pc
L_s3p:
  s_load_dwordx4 s[20:23], s[42:43], s54 offset:98304 glc
  s_load_dwordx4 s[24:27], s[42:43], s55 offset:98304 glc
L_s3pc:
  s_waitcnt lgkmcnt(0)
  s_xor_b32 s68, s21, s74
  s_xor_b32 s69, s23, s74
  s_or_b32 s68, s68, s69
  s_xor_b32 s69, s25, s74
  s_or_b32 s68, s68, s69
  s_xor_b32 s69, s27, s74
  s_or_b32 s68, s68, s69
  s_cbranch_scc0 L_s3pd
  s_sleep 2
  s_add_u32 s70, s70, 1
  s_cmp_lt_u32 s70, 262144
  s_cbranch_scc1 L_s3p
L_s3pd:
  v_mov_b32 v12, s20
  v_mov_b32 v13, s22
  v_mov_b32 v14, s24
  v_mov_b32 v15, s26
  ds_write_b64 v21, v[12:13] offset:448
  ds_write_b64 v22, v[14:15] offset:448
  s_mov_b64 exec, -1
  v_and_b32 v9, 3, v1
  v_lshlrev_b32 v9, 3, v9
  ds_read_b64 v[10:11], v9 offset:448
  s_waitcnt lgkmcnt(0)
  v_max_f32_dpp v8, v10, v10 quad_perm:[1,0,3,2] row_mask:0xf bank_mask:0xf
  s_nop 1
  v_max_f32_dpp v8, v8, v8 quad_perm:[2,3,0,1] row_mask:0xf bank_mask:0xf
  v_sub_f32 v9, v10, v8
  v_mul_f32 v9, 0x3fb8aa3b, v9
  v_exp_f32 v9, v9
  s_nop 0
  v_mul_f32 v10, v9, v11
  s_nop 1
  v_add_f32_dpp v10, v10, v10 quad_perm:[1,0,3,2] row_mask:0xf bank_mask:0xf
  s_nop 1
  v_add_f32_dpp v10, v10, v10 quad_perm:[2,3,0,1] row_mask:0xf bank_mask:0xf
  v_log_f32 v12, v10
  v_sub_f32 v9, v16, v8
  v_rcp_f32 v10, v10
  v_mul_f32 v9, 0x3fb8aa3b, v9
  v_exp_f32 v9, v9
  v_add_f32 v8, 0xc2b9e666, v8
  v_fmac_f32 v8, 0x3f317218, v12
  v_lshlrev_b32 v13, 2, v1
  v_mul_f32 v9, v9, v10
  s_mov_b64 exec, 0xffff
  ds_write_b32 v13, v9 offset:384
  s_mov_b64 exec, 1
  ds_write_b32 v38, v8 offset:276
  ds_add_u32 v38, v17 offset:272
  ds_add_u32 v38, v17 offset:300
  s_mov_b64 exec, -1
  ds_write_b32 v38, v38 offset:256
  ds_read_b128 v[62:65], v38 offset:384
  ds_read_b128 v[66:69], v38 offset:400
  ds_read_b128 v[70:73], v38 offset:416
  v_lshlrev_b32 v77, 3, v1
  s_lshl2_add_u32 s68, s6, s7
  s_lshl_b32 s68, s68, 9
  s_add_u32 s68, s68, 131072
  v_add_u32 v74, s68, v77
  v_and_b32 v75, 1, v1
  v_lshlrev_b32 v75, 4, v75
  v_lshrrev_b32 v75, v75, s74
  v_lshrrev_b32 v76, 8, v75
  s_mov_b32 s70, 0
L_sn_14:
  ds_read_b32 v8, v38 offset:304
  s_waitcnt lgkmcnt(0)
  v_cmp_gt_u32 vcc, 0xa, v8
  s_cmp_eq_u64 vcc, 0
  s_cbranch_scc1 L_snd_15
  s_sleep 1
  s_add_u32 s70, s70, 1
  s_cmp_lt_u32 s70, 2097152
  s_cbranch_scc1 L_sn_14
L_snd_15:
  s_mov_b32 s70, 0
L_wt_16:
  ds_read_b32 v8, v38 offset:304
  ds_read_b64 v[40:41], v77 offset:6656
  ds_read_b64 v[42:43], v77 offset:7168
  ds_read_b64 v[44:45], v77 offset:7680
  ds_read_b64 v[46:47], v77 offset:8192
  ds_read_b64 v[48:49], v77 offset:8704
  ds_read_b64 v[50:51], v77 offset:9216
  ds_read_b64 v[52:53], v77 offset:9728
  ds_read_b64 v[54:55], v77 offset:10240
  ds_read_b64 v[56:57], v77 offset:10752
  ds_read_b64 v[58:59], v77 offset:11264
  ds_read_b64 v[60:61], v77 offset:11776
  s_waitcnt lgkmcnt(11)
  v_cmp_gt_u32 vcc, 0xb, v8
  s_cmp_eq_u64 vcc, 0
  s_cbranch_scc1 L_wtd_17
  s_waitcnt lgkmcnt(0)
  s_add_u32 s70, s70, 1
  s_cmp_lt_u32 s70, 2097152
  s_cbranch_scc1 L_wt_16
L_wtd_17:
  s_movk_i32 s69, 0xff
  s_waitcnt lgkmcnt(10)
  v_pk_mul_f32 v[40:41], v[40:41], v[62:63] op_sel:[0,0] op_sel_hi:[1,0]
  s_waitcnt lgkmcnt(9)
  v_pk_mul_f32 v[42:43], v[42:43], v[62:63] op_sel:[0,1] op_sel_hi:[1,1]
  s_waitcnt lgkmcnt(8)
  v_pk_fma_f32 v[40:41], v[44:45], v[64:65], v[40:41] op_sel:[0,0,0] op_sel_hi:[1,0,1]
  s_waitcnt lgkmcnt(7)
  v_pk_fma_f32 v[42:43], v[46:47], v[64:65], v[42:43] op_sel:[0,1,0] op_sel_hi:[1,1,1]
  s_waitcnt lgkmcnt(6)
  v_pk_fma_f32 v[40:41], v[48:49], v[66:67], v[40:41] op_sel:[0,0,0] op_sel_hi:[1,0,1]
  s_waitcnt lgkmcnt(5)
  v_pk_fma_f32 v[42:43], v[50:51], v[66:67], v[42:43] op_sel:[0,1,0] op_sel_hi:[1,1,1]
  s_waitcnt lgkmcnt(4)
  v_pk_fma_f32 v[40:41], v[52:53], v[68:69], v[40:41] op_sel:[0,0,0] op_sel_hi:[1,0,1]
  s_waitcnt lgkmcnt(3)
  v_pk_fma_f32 v[42:43], v[54:55], v[68:69], v[42:43] op_sel:[0,1,0] op_sel_hi:[1,1,1]
  s_waitcnt lgkmcnt(2)
  v_pk_fma_f32 v[40:41], v[56:57], v[70:71], v[40:41] op_sel:[0,0,0] op_sel_hi:[1,0,1]
  s_waitcnt lgkmcnt(1)
  v_pk_fma_f32 v[42:43], v[58:59], v[70:71], v[42:43] op_sel:[0,1,0] op_sel_hi:[1,1,1]
  s_waitcnt lgkmcnt(0)
  v_pk_fma_f32 v[40:41], v[60:61], v[72:73], v[40:41] op_sel:[0,0,0] op_sel_hi:[1,0,1]
  v_pk_add_f32 v[40:41], v[40:41], v[42:43]
  v_bfi_b32 v40, s69, v75, v40
  v_bfi_b32 v41, s69, v76, v41
  s_cmp_eq_u32 s75, 1
  s_cbranch_scc0 L_pf_18
  global_store_dwordx2 v74, v[40:41], s[42:43]
  s_branch L_pe_19
L_pf_18:
  global_store_dwordx2 v74, v[40:41], s[42:43] sc1
L_pe_19:
  ds_read_b128 v[102:105], v38 offset:384
  ds_read_b128 v[106:109], v38 offset:400
  ds_read_b128 v[110:113], v38 offset:416
  v_lshlrev_b32 v117, 3, v1
  s_lshl2_add_u32 s68, s6, s7
  s_lshl_b32 s68, s68, 9
  s_add_u32 s68, s68, 524288
  v_add_u32 v114, s68, v117
  v_and_b32 v115, 1, v1
  v_lshlrev_b32 v115, 4, v115
  v_lshrrev_b32 v115, v115, s74
  v_lshrrev_b32 v116, 8, v115
  s_waitcnt vmcnt(0)
  s_mov_b32 s70, 0
L_sn_20:
  ds_read_b32 v8, v38 offset:308
  s_waitcnt lgkmcnt(0)
  v_cmp_gt_u32 vcc, 0x1, v8
  s_cmp_eq_u64 vcc, 0
  s_cbranch_scc1 L_snd_21
  s_sleep 4
  s_add_u32 s70, s70, 1
  s_cmp_lt_u32 s70, 2097152
  s_cbranch_scc1 L_sn_20
L_snd_21:
  global_store_dwordx2 v74, v[40:41], s[42:43] sc1
  s_cmp_eq_u32 s7, 2
  s_cbranch_scc1 L_chk
  s_mov_b32 s70, 0
L_sn_22:
  ds_read_b32 v8, v38 offset:308
  s_waitcnt lgkmcnt(0)
  v_cmp_gt_u32 vcc, 0xa, v8
  s_cmp_eq_u64 vcc, 0
  s_cbranch_scc1 L_snd_23
  s_sleep 1
  s_add_u32 s70, s70, 1
  s_cmp_lt_u32 s70, 2097152
  s_cbranch_scc1 L_sn_22
L_snd_23:
  s_mov_b32 s70, 0
L_wt_24:
  ds_read_b32 v8, v38 offset:308
  ds_read_b64 v[80:81], v117 offset:1024
  ds_read_b64 v[82:83], v117 offset:1536
  ds_read_b64 v[84:85], v117 offset:2048
  ds_read_b64 v[86:87], v117 offset:2560
  ds_read_b64 v[88:89], v117 offset:3072
  ds_read_b64 v[90:91], v117 offset:3584
  ds_read_b64 v[92:93], v117 offset:4096
  ds_read_b64 v[94:95], v117 offset:4608
  ds_read_b64 v[96:97], v117 offset:5120
  ds_read_b64 v[98:99], v117 offset:5632
  ds_read_b64 v[100:101], v117 offset:6144
  s_waitcnt lgkmcnt(11)
  v_cmp_gt_u32 vcc, 0xb, v8
  s_cmp_eq_u64 vcc, 0
  s_cbranch_scc1 L_wtd_25
  s_waitcnt lgkmcnt(0)
  s_add_u32 s70, s70, 1
  s_cmp_lt_u32 s70, 2097152
  s_cbranch_scc1 L_wt_24
L_wtd_25:
  s_movk_i32 s69, 0xff
  s_waitcnt lgkmcnt(10)
  v_pk_mul_f32 v[80:81], v[80:81], v[102:103] op_sel:[0,0] op_sel_hi:[1,0]
  s_waitcnt lgkmcnt(9)
  v_pk_mul_f32 v[82:83], v[82:83], v[102:103] op_sel:[0,1] op_sel_hi:[1,1]
  s_waitcnt lgkmcnt(8)
  v_pk_fma_f32 v[80:81], v[84:85], v[104:105], v[80:81] op_sel:[0,0,0] op_sel_hi:[1,0,1]
  s_waitcnt lgkmcnt(7)
  v_pk_fma_f32 v[82:83], v[86:87], v[104:105], v[82:83] op_sel:[0,1,0] op_sel_hi:[1,1,1]
  s_waitcnt lgkmcnt(6)
  v_pk_fma_f32 v[80:81], v[88:89], v[106:107], v[80:81] op_sel:[0,0,0] op_sel_hi:[1,0,1]
  s_waitcnt lgkmcnt(5)
  v_pk_fma_f32 v[82:83], v[90:91], v[106:107], v[82:83] op_sel:[0,1,0] op_sel_hi:[1,1,1]
  s_waitcnt lgkmcnt(4)
  v_pk_fma_f32 v[80:81], v[92:93], v[108:109], v[80:81] op_sel:[0,0,0] op_sel_hi:[1,0,1]
  s_waitcnt lgkmcnt(3)
  v_pk_fma_f32 v[82:83], v[94:95], v[108:109], v[82:83] op_sel:[0,1,0] op_sel_hi:[1,1,1]
  s_waitcnt lgkmcnt(2)
  v_pk_fma_f32 v[80:81], v[96:97], v[110:111], v[80:81] op_sel:[0,0,0] op_sel_hi:[1,0,1]
  s_waitcnt lgkmcnt(1)
  v_pk_fma_f32 v[82:83], v[98:99], v[110:111], v[82:83] op_sel:[0,1,0] op_sel_hi:[1,1,1]
  s_waitcnt lgkmcnt(0)
  v_pk_fma_f32 v[80:81], v[100:101], v[112:113], v[80:81] op_sel:[0,0,0] op_sel_hi:[1,0,1]
  v_pk_add_f32 v[80:81], v[80:81], v[82:83]
  v_bfi_b32 v80, s69, v115, v80
  v_bfi_b32 v81, s69, v116, v81
  global_store_dwordx2 v114, v[80:81], s[42:43] sc1
  s_branch L_fin
L_chk:
  v_and_b32 v160, 0xff, v75
  v_and_b32 v161, 0xff, v76
  s_lshl_b32 s10, s6, 11
  s_add_u32 s10, s10, 131072
  v_lshl_add_u32 v2, v1, 3, s10
  global_load_dwordx2 v[154:155], v2, s[42:43] offset:0 sc1
  global_load_dwordx2 v[156:157], v2, s[42:43] offset:512 sc1
  v_add_u32 v3, 393216, v2
  s_mov_b32 s70, 0
L_sn_26:
  ds_read_b32 v8, v38 offset:308
  s_waitcnt lgkmcnt(0)
  v_cmp_gt_u32 vcc, 0xa, v8
  s_cmp_eq_u64 vcc, 0
  s_cbranch_scc1 L_snd_27
  s_sleep 1
  s_add_u32 s70, s70, 1
  s_cmp_lt_u32 s70, 2097152
  s_cbranch_scc1 L_sn_26
L_snd_27:
  s_mov_b32 s70, 0
L_wt_28:
  ds_read_b32 v8, v38 offset:308
  ds_read_b64 v[80:81], v117 offset:1024
  ds_read_b64 v[82:83], v117 offset:1536
  ds_read_b64 v[84:85], v117 offset:2048
  ds_read_b64 v[86:87], v117 offset:2560
  ds_read_b64 v[88:89], v117 offset:3072
  ds_read_b64 v[90:91], v117 offset:3584
  ds_read_b64 v[92:93], v117 offset:4096
  ds_read_b64 v[94:95], v117 offset:4608
  ds_read_b64 v[96:97], v117 offset:5120
  ds_read_b64 v[98:99], v117 offset:5632
  ds_read_b64 v[100:101], v117 offset:6144
  s_waitcnt lgkmcnt(11)
  v_cmp_gt_u32 vcc, 0xb, v8
  s_cmp_eq_u64 vcc, 0
  s_cbranch_scc1 L_wtd_29
  s_waitcnt lgkmcnt(0)
  s_add_u32 s70, s70, 1
  s_cmp_lt_u32 s70, 2097152
  s_cbranch_scc1 L_wt_28
L_wtd_29:
  global_load_dwordx2 v[130:131], v3, s[42:43] offset:0 sc1
  global_load_dwordx2 v[132:133], v3, s[42:43] offset:512 sc1
  s_movk_i32 s69, 0xff
  s_waitcnt lgkmcnt(10)
  v_pk_mul_f32 v[80:81], v[80:81], v[102:103] op_sel:[0,0] op_sel_hi:[1,0]
  s_waitcnt lgkmcnt(9)
  v_pk_mul_f32 v[82:83], v[82:83], v[102:103] op_sel:[0,1] op_sel_hi:[1,1]
  s_waitcnt lgkmcnt(8)
  v_pk_fma_f32 v[80:81], v[84:85], v[104:105], v[80:81] op_sel:[0,0,0] op_sel_hi:[1,0,1]
  s_waitcnt lgkmcnt(7)
  v_pk_fma_f32 v[82:83], v[86:87], v[104:105], v[82:83] op_sel:[0,1,0] op_sel_hi:[1,1,1]
  s_waitcnt lgkmcnt(6)
  v_pk_fma_f32 v[80:81], v[88:89], v[106:107], v[80:81] op_sel:[0,0,0] op_sel_hi:[1,0,1]
  s_waitcnt lgkmcnt(5)
  v_pk_fma_f32 v[82:83], v[90:91], v[106:107], v[82:83] op_sel:[0,1,0] op_sel_hi:[1,1,1]
  s_waitcnt lgkmcnt(4)
  v_pk_fma_f32 v[80:81], v[92:93], v[108:109], v[80:81] op_sel:[0,0,0] op_sel_hi:[1,0,1]
  s_waitcnt lgkmcnt(3)
  v_pk_fma_f32 v[82:83], v[94:95], v[108:109], v[82:83] op_sel:[0,1,0] op_sel_hi:[1,1,1]
  s_waitcnt lgkmcnt(2)
  v_pk_fma_f32 v[80:81], v[96:97], v[110:111], v[80:81] op_sel:[0,0,0] op_sel_hi:[1,0,1]
  s_waitcnt lgkmcnt(1)
  v_pk_fma_f32 v[82:83], v[98:99], v[110:111], v[82:83] op_sel:[0,1,0] op_sel_hi:[1,1,1]
  s_waitcnt lgkmcnt(0)
  v_pk_fma_f32 v[80:81], v[100:101], v[112:113], v[80:81] op_sel:[0,0,0] op_sel_hi:[1,0,1]
  v_pk_add_f32 v[80:81], v[80:81], v[82:83]
  v_bfi_b32 v80, s69, v115, v80
  v_bfi_b32 v81, s69, v116, v81
  global_store_dwordx2 v114, v[80:81], s[42:43] sc1
  s_waitcnt vmcnt(1)
  s_mov_b32 s70, 0
  s_branch L_cp0c
L_cp0:
  global_load_dwordx2 v[154:155], v2, s[42:43] offset:0 sc1
  global_load_dwordx2 v[156:157], v2, s[42:43] offset:512 sc1
  s_sleep 4
  s_waitcnt vmcnt(0)
L_cp0c:
  v_xor_b32 v136, v154, v160
  v_xor_b32 v137, v155, v161
  v_xor_b32 v138, v156, v160
  v_xor_b32 v139, v157, v161
  v_xor_b32 v140, v40, v160
  v_xor_b32 v141, v41, v161
  v_or3_b32 v152, v136, v137, v138
  v_or3_b32 v153, v139, v140, v141
  v_or_b32 v136, 0x80, v136
  v_or_b32 v137, 0x80, v137
  v_or_b32 v138, 0x80, v138
  v_or_b32 v139, 0x80, v139
  v_or_b32 v140, 0x80, v140
  v_or_b32 v141, 0x80, v141
  v_or_b32 v152, v152, v153
  v_pk_add_f32 v[136:137], v[136:137], v[138:139]
  v_lshlrev_b32 v152, 24, v152
  v_pk_add_f32 v[136:137], v[136:137], v[140:141]
  v_cmp_ne_u32 vcc, 0, v152
  v_cvt_pk_bf16_f32 v136, v136, v137
  s_cmp_eq_u64 vcc, 0
  s_cbranch_scc1 L_cp0d
  s_add_u32 s70, s70, 1
  s_cmp_lt_u32 s70, 262144
  s_cbranch_scc1 L_cp0
L_cp0d:
  v_add_u32 v2, 393216, v2
  s_mov_b32 s70, 0
  s_branch L_cp1c
L_cp1:
  global_load_dwordx2 v[130:131], v2, s[42:43] offset:0 sc1
  global_load_dwordx2 v[132:133], v2, s[42:43] offset:512 sc1
  s_waitcnt vmcnt(0)
L_cp1c:
  v_xor_b32 v144, v130, v160
  v_xor_b32 v145, v131, v161
  v_xor_b32 v146, v132, v160
  v_xor_b32 v147, v133, v161
  v_xor_b32 v148, v80, v160
  v_xor_b32 v149, v81, v161
  v_or3_b32 v152, v144, v145, v146
  v_or3_b32 v153, v147, v148, v149
  v_or_b32 v144, 0x80, v144
  v_or_b32 v145, 0x80, v145
  v_or_b32 v146, 0x80, v146
  v_or_b32 v147, 0x80, v147
  v_or_b32 v148, 0x80, v148
  v_or_b32 v149, 0x80, v149
  v_or_b32 v152, v152, v153
  v_pk_add_f32 v[144:145], v[144:145], v[146:147]
  v_lshlrev_b32 v152, 24, v152
  v_pk_add_f32 v[144:145], v[144:145], v[148:149]
  v_cmp_ne_u32 vcc, 0, v152
  v_cvt_pk_bf16_f32 v144, v144, v145
  s_cmp_eq_u64 vcc, 0
  s_cbranch_scc1 L_cp1d
  s_add_u32 s70, s70, 1
  s_cmp_lt_u32 s70, 262144
  s_cbranch_scc1 L_cp1
L_cp1d:
  v_cmp_ne_u32 vcc, v136, v144
  s_cmp_eq_u64 vcc, 0
  s_cbranch_scc1 L_fin
  s_waitcnt vmcnt(0)
L_slow:
  s_mov_b32 s47, 0x20000
  s_load_dwordx16 s[16:31], s[0:1], 0
  s_load_dwordx8 s[32:39], s[0:1], 64
  v_and_b32 v2, 31, v1
  v_lshlrev_b32 v2, 7, v2
  v_add_u32 v2, 28672, v2
  s_mov_b32 s70, 0
L_sl_d:
  global_load_dword v3, v2, s[42:43] sc1
  s_waitcnt vmcnt(0) lgkmcnt(0)
  v_cmp_ne_u32 vcc, s74, v3
  s_cmp_eq_u64 vcc, 0
  s_cbranch_scc1 L_sl_dd
  s_sleep 8
  s_add_u32 s70, s70, 1
  s_cmp_lt_u32 s70, 262144
  s_cbranch_scc1 L_sl_d
L_sl_dd:
  v_lshlrev_b32 v2, 3, v1
  v_add_u32 v2, 524288, v2
  v_lshlrev_b32 v0, 2, v1
  v_add_u32 v0, 12288, v0
  s_mov_b32 s10, 0
L_sl_h:
  s_mov_b32 s70, 0
L_sl_hp:
  global_load_dwordx2 v[40:41], v2, s[42:43] offset:0 sc1
  global_load_dwordx2 v[42:43], v2, s[42:43] offset:512 sc1
  global_load_dwordx2 v[44:45], v2, s[42:43] offset:1024 sc1
  s_waitcnt vmcnt(0)
  v_xor_b32 v40, v40, v160
  v_xor_b32 v41, v41, v161
  v_xor_b32 v42, v42, v160
  v_xor_b32 v43, v43, v161
  v_xor_b32 v44, v44, v160
  v_xor_b32 v45, v45, v161
  v_or3_b32 v48, v40, v41, v42
  v_or3_b32 v49, v43, v44, v45
  v_or_b32 v40, 0x80, v40
  v_or_b32 v41, 0x80, v41
  v_or_b32 v42, 0x80, v42
  v_or_b32 v43, 0x80, v43
  v_or_b32 v44, 0x80, v44
  v_or_b32 v45, 0x80, v45
  v_or_b32 v48, v48, v49
  v_pk_add_f32 v[40:41], v[40:41], v[42:43]
  v_lshlrev_b32 v48, 24, v48
  v_pk_add_f32 v[40:41], v[40:41], v[44:45]
  v_cmp_ne_u32 vcc, 0, v48
  v_cvt_pk_bf16_f32 v40, v40, v41
  s_cmp_eq_u64 vcc, 0
  s_cbranch_scc1 L_sl_hd
  s_sleep 8
  s_add_u32 s70, s70, 1
  s_cmp_lt_u32 s70, 262144
  s_cbranch_scc1 L_sl_hp
L_sl_hd:
  ds_write_b32 v0, v40
  v_add_u32 v2, 2048, v2
  v_add_u32 v0, 256, v0
  s_add_u32 s10, s10, 1
  s_cmp_lt_u32 s10, 64
  s_cbranch_scc1 L_sl_h
  s_mov_b32 s44, s24
  s_mov_b32 s45, s25
  s_mov_b32 s46, 4194304
  s_mov_b32 s11, 1024
  s_mov_b32 s12, 4194304
  v_mov_b32 v4, 12288
  v_mov_b32 v5, 20480
  v_lshlrev_b32 v2, 4, v1
  s_call_b64 s[62:63], L_gv
  v_lshlrev_b32 v0, 4, v1
  global_load_dwordx4 v[40:43], v0, s[16:17] offset:0
  global_load_dwordx4 v[44:47], v0, s[16:17] offset:1024
  s_waitcnt vmcnt(0)
  v_lshlrev_b32 v104, 16, v40
  v_and_b32 v105, s73, v40
  v_lshlrev_b32 v106, 16, v41
  v_and_b32 v107, s73, v41
  v_lshlrev_b32 v108, 16, v42
  v_and_b32 v109, s73, v42
  v_lshlrev_b32 v110, 16, v43
  v_and_b32 v111, s73, v43
  v_lshlrev_b32 v112, 16, v44
  v_and_b32 v113, s73, v44
  v_lshlrev_b32 v114, 16, v45
  v_and_b32 v115, s73, v45
  v_lshlrev_b32 v116, 16, v46
  v_and_b32 v117, s73, v46
  v_lshlrev_b32 v118, 16, v47
  v_and_b32 v119, s73, v47
  v_lshrrev_b32 v2, 1, v1
  v_lshlrev_b32 v2, 7, v2
  v_and_b32 v3, 1, v1
  v_lshl_add_u32 v2, v3, 5, v2
  v_add_u32 v2, 12288, v2
  global_load_dwordx4 v[40:43], v2, s[42:43] offset:0 sc1
  global_load_dwordx4 v[44:47], v2, s[42:43] offset:16 sc1
  global_load_dwordx4 v[48:51], v2, s[42:43] offset:64 sc1
  global_load_dwordx4 v[52:55], v2, s[42:43] offset:80 sc1
  s_waitcnt vmcnt(0)
  v_lshlrev_b32 v88, 16, v40
  v_and_b32 v89, s73, v40
  v_lshlrev_b32 v90, 16, v42
  v_and_b32 v91, s73, v42
  v_lshlrev_b32 v92, 16, v44
  v_and_b32 v93, s73, v44
  v_lshlrev_b32 v94, 16, v46
  v_and_b32 v95, s73, v46
  v_lshlrev_b32 v96, 16, v48
  v_and_b32 v97, s73, v48
  v_lshlrev_b32 v98, 16, v50
  v_and_b32 v99, s73, v50
  v_lshlrev_b32 v100, 16, v52
  v_and_b32 v101, s73, v52
  v_lshlrev_b32 v102, 16, v54
  v_and_b32 v103, s73, v54
  v_cvt_pk_bf16_f32 v72, 0, v72
  v_cvt_pk_bf16_f32 v73, 0, v73
  v_cvt_pk_bf16_f32 v74, 0, v74
  v_cvt_pk_bf16_f32 v75, 0, v75
  v_cvt_pk_bf16_f32 v76, 0, v76
  v_cvt_pk_bf16_f32 v77, 0, v77
  v_cvt_pk_bf16_f32 v78, 0, v78
  v_cvt_pk_bf16_f32 v79, 0, v79
  v_cvt_pk_bf16_f32 v80, 0, v80
  v_cvt_pk_bf16_f32 v81, 0, v81
  v_cvt_pk_bf16_f32 v82, 0, v82
  v_cvt_pk_bf16_f32 v83, 0, v83
  v_cvt_pk_bf16_f32 v84, 0, v84
  v_cvt_pk_bf16_f32 v85, 0, v85
  v_cvt_pk_bf16_f32 v86, 0, v86
  v_cvt_pk_bf16_f32 v87, 0, v87
  v_mul_f32 v72, v72, v88
  v_mul_f32 v73, v73, v89
  v_mul_f32 v74, v74, v90
  v_mul_f32 v75, v75, v91
  v_mul_f32 v76, v76, v92
  v_mul_f32 v77, v77, v93
  v_mul_f32 v78, v78, v94
  v_mul_f32 v79, v79, v95
  v_mul_f32 v80, v80, v96
  v_mul_f32 v81, v81, v97
  v_mul_f32 v82, v82, v98
  v_mul_f32 v83, v83, v99
  v_mul_f32 v84, v84, v100
  v_mul_f32 v85, v85, v101
  v_mul_f32 v86, v86, v102
  v_mul_f32 v87, v87, v103
  v_cvt_pk_bf16_f32 v72, 0, v72
  v_cvt_pk_bf16_f32 v73, 0, v73
  v_cvt_pk_bf16_f32 v74, 0, v74
  v_cvt_pk_bf16_f32 v75, 0, v75
  v_cvt_pk_bf16_f32 v76, 0, v76
  v_cvt_pk_bf16_f32 v77, 0, v77
  v_cvt_pk_bf16_f32 v78, 0, v78
  v_cvt_pk_bf16_f32 v79, 0, v79
  v_cvt_pk_bf16_f32 v80, 0, v80
  v_cvt_pk_bf16_f32 v81, 0, v81
  v_cvt_pk_bf16_f32 v82, 0, v82
  v_cvt_pk_bf16_f32 v83, 0, v83
  v_cvt_pk_bf16_f32 v84, 0, v84
  v_cvt_pk_bf16_f32 v85, 0, v85
  v_cvt_pk_bf16_f32 v86, 0, v86
  v_cvt_pk_bf16_f32 v87, 0, v87
  v_add_f32 v104, v104, v72
  v_add_f32 v105, v105, v73
  v_add_f32 v106, v106, v74
  v_add_f32 v107, v107, v75
  v_add_f32 v108, v108, v76
  v_add_f32 v109, v109, v77
  v_add_f32 v110, v110, v78
  v_add_f32 v111, v111, v79
  v_add_f32 v112, v112, v80
  v_add_f32 v113, v113, v81
  v_add_f32 v114, v114, v82
  v_add_f32 v115, v115, v83
  v_add_f32 v116, v116, v84
  v_add_f32 v117, v117, v85
  v_add_f32 v118, v118, v86
  v_add_f32 v119, v119, v87
  v_cvt_pk_bf16_f32 v104, 0, v104
  v_cvt_pk_bf16_f32 v105, 0, v105
  v_cvt_pk_bf16_f32 v106, 0, v106
  v_cvt_pk_bf16_f32 v107, 0, v107
  v_cvt_pk_bf16_f32 v108, 0, v108
  v_cvt_pk_bf16_f32 v109, 0, v109
  v_cvt_pk_bf16_f32 v110, 0, v110
  v_cvt_pk_bf16_f32 v111, 0, v111
  v_cvt_pk_bf16_f32 v112, 0, v112
  v_cvt_pk_bf16_f32 v113, 0, v113
  v_cvt_pk_bf16_f32 v114, 0, v114
  v_cvt_pk_bf16_f32 v115, 0, v115
  v_cvt_pk_bf16_f32 v116, 0, v116
  v_cvt_pk_bf16_f32 v117, 0, v117
  v_cvt_pk_bf16_f32 v118, 0, v118
  v_cvt_pk_bf16_f32 v119, 0, v119
  v_add_f32 v8, v104, v105
  v_add_f32 v8, v8, v106
  v_add_f32 v8, v8, v107
  v_add_f32 v8, v8, v108
  v_add_f32 v8, v8, v109
  v_add_f32 v8, v8, v110
  v_add_f32 v8, v8, v111
  s_nop 1
  v_add_f32_dpp v8, v8, v8 row_ror:8 row_mask:0xf bank_mask:0xf
  s_nop 1
  v_add_f32_dpp v8, v8, v8 row_ror:4 row_mask:0xf bank_mask:0xf
  s_nop 1
  v_add_f32_dpp v8, v8, v8 row_ror:2 row_mask:0xf bank_mask:0xf
  s_nop 1
  v_add_f32_dpp v8, v8, v8 row_ror:1 row_mask:0xf bank_mask:0xf
  v_mov_b32 v9, v8
  s_nop 1
  v_permlane16_swap_b32 v9, v8
  v_add_f32 v8, v8, v9
  v_mov_b32 v9, v8
  s_nop 1
  v_permlane32_swap_b32 v9, v8
  v_add_f32 v8, v8, v9
  v_mul_f32 v8, 0x3b000000, v8
  v_sub_f32 v72, v104, v8
  v_sub_f32 v73, v105, v8
  v_sub_f32 v74, v106, v8
  v_sub_f32 v75, v107, v8
  v_sub_f32 v76, v108, v8
  v_sub_f32 v77, v109, v8
  v_sub_f32 v78, v110, v8
  v_sub_f32 v79, v111, v8
  v_mul_f32 v10, v72, v72
  v_fmac_f32 v10, v73, v73
  v_fmac_f32 v10, v74, v74
  v_fmac_f32 v10, v75, v75
  v_fmac_f32 v10, v76, v76
  v_fmac_f32 v10, v77, v77
  v_fmac_f32 v10, v78, v78
  v_fmac_f32 v10, v79, v79
  s_nop 1
  v_add_f32_dpp v10, v10, v10 row_ror:8 row_mask:0xf bank_mask:0xf
  s_nop 1
  v_add_f32_dpp v10, v10, v10 row_ror:4 row_mask:0xf bank_mask:0xf
  s_nop 1
  v_add_f32_dpp v10, v10, v10 row_ror:2 row_mask:0xf bank_mask:0xf
  s_nop 1
  v_add_f32_dpp v10, v10, v10 row_ror:1 row_mask:0xf bank_mask:0xf
  v_mov_b32 v9, v10
  s_nop 1
  v_permlane16_swap_b32 v9, v10
  v_add_f32 v10, v10, v9
  v_mov_b32 v9, v10
  s_nop 1
  v_permlane32_swap_b32 v9, v10
  v_add_f32 v10, v10, v9
  v_mul_f32 v10, 0x3b000000, v10
  v_cvt_pk_bf16_f32 v8, 0, v8
  v_cvt_pk_bf16_f32 v10, 0, v10
  v_add_f32 v10, 0x3727c5ac, v10
  v_cvt_pk_bf16_f32 v10, 0, v10
  v_sqrt_f32 v10, v10
  v_sub_f32 v72, v104, v8
  v_sub_f32 v73, v105, v8
  v_sub_f32 v74, v106, v8
  v_sub_f32 v75, v107, v8
  v_sub_f32 v76, v108, v8
  v_sub_f32 v77, v109, v8
  v_sub_f32 v78, v110, v8
  v_sub_f32 v79, v111, v8
  v_cvt_pk_bf16_f32 v10, 0, v10
  v_cvt_pk_bf16_f32 v72, 0, v72
  v_cvt_pk_bf16_f32 v73, 0, v73
  v_cvt_pk_bf16_f32 v74, 0, v74
  v_cvt_pk_bf16_f32 v75, 0, v75
  v_cvt_pk_bf16_f32 v76, 0, v76
  v_cvt_pk_bf16_f32 v77, 0, v77
  v_cvt_pk_bf16_f32 v78, 0, v78
  v_cvt_pk_bf16_f32 v79, 0, v79
  v_rcp_f32 v10, v10
  s_nop 0
  v_mul_f32 v72, v72, v10
  v_mul_f32 v73, v73, v10
  v_mul_f32 v74, v74, v10
  v_mul_f32 v75, v75, v10
  v_mul_f32 v76, v76, v10
  v_mul_f32 v77, v77, v10
  v_mul_f32 v78, v78, v10
  v_mul_f32 v79, v79, v10
  v_cvt_pk_bf16_f32 v72, 0, v72
  v_cvt_pk_bf16_f32 v73, 0, v73
  v_cvt_pk_bf16_f32 v74, 0, v74
  v_cvt_pk_bf16_f32 v75, 0, v75
  v_cvt_pk_bf16_f32 v76, 0, v76
  v_cvt_pk_bf16_f32 v77, 0, v77
  v_cvt_pk_bf16_f32 v78, 0, v78
  v_cvt_pk_bf16_f32 v79, 0, v79
  v_add_f32 v8, v112, v113
  v_add_f32 v8, v8, v114
  v_add_f32 v8, v8, v115
  v_add_f32 v8, v8, v116
  v_add_f32 v8, v8, v117
  v_add_f32 v8, v8, v118
  v_add_f32 v8, v8, v119
  s_nop 1
  v_add_f32_dpp v8, v8, v8 row_ror:8 row_mask:0xf bank_mask:0xf
  s_nop 1
  v_add_f32_dpp v8, v8, v8 row_ror:4 row_mask:0xf bank_mask:0xf
  s_nop 1
  v_add_f32_dpp v8, v8, v8 row_ror:2 row_mask:0xf bank_mask:0xf
  s_nop 1
  v_add_f32_dpp v8, v8, v8 row_ror:1 row_mask:0xf bank_mask:0xf
  v_mov_b32 v9, v8
  s_nop 1
  v_permlane16_swap_b32 v9, v8
  v_add_f32 v8, v8, v9
  v_mov_b32 v9, v8
  s_nop 1
  v_permlane32_swap_b32 v9, v8
  v_add_f32 v8, v8, v9
  v_mul_f32 v8, 0x3b000000, v8
  v_sub_f32 v80, v112, v8
  v_sub_f32 v81, v113, v8
  v_sub_f32 v82, v114, v8
  v_sub_f32 v83, v115, v8
  v_sub_f32 v84, v116, v8
  v_sub_f32 v85, v117, v8
  v_sub_f32 v86, v118, v8
  v_sub_f32 v87, v119, v8
  v_mul_f32 v10, v80, v80
  v_fmac_f32 v10, v81, v81
  v_fmac_f32 v10, v82, v82
  v_fmac_f32 v10, v83, v83
  v_fmac_f32 v10, v84, v84
  v_fmac_f32 v10, v85, v85
  v_fmac_f32 v10, v86, v86
  v_fmac_f32 v10, v87, v87
  s_nop 1
  v_add_f32_dpp v10, v10, v10 row_ror:8 row_mask:0xf bank_mask:0xf
  s_nop 1
  v_add_f32_dpp v10, v10, v10 row_ror:4 row_mask:0xf bank_mask:0xf
  s_nop 1
  v_add_f32_dpp v10, v10, v10 row_ror:2 row_mask:0xf bank_mask:0xf
  s_nop 1
  v_add_f32_dpp v10, v10, v10 row_ror:1 row_mask:0xf bank_mask:0xf
  v_mov_b32 v9, v10
  s_nop 1
  v_permlane16_swap_b32 v9, v10
  v_add_f32 v10, v10, v9
  v_mov_b32 v9, v10
  s_nop 1
  v_permlane32_swap_b32 v9, v10
  v_add_f32 v10, v10, v9
  v_mul_f32 v10, 0x3b000000, v10
  v_cvt_pk_bf16_f32 v8, 0, v8
  v_cvt_pk_bf16_f32 v10, 0, v10
  v_add_f32 v10, 0x3727c5ac, v10
  v_cvt_pk_bf16_f32 v10, 0, v10
  v_sqrt_f32 v10, v10
  v_sub_f32 v80, v112, v8
  v_sub_f32 v81, v113, v8
  v_sub_f32 v82, v114, v8
  v_sub_f32 v83, v115, v8
  v_sub_f32 v84, v116, v8
  v_sub_f32 v85, v117, v8
  v_sub_f32 v86, v118, v8
  v_sub_f32 v87, v119, v8
  v_cvt_pk_bf16_f32 v10, 0, v10
  v_cvt_pk_bf16_f32 v80, 0, v80
  v_cvt_pk_bf16_f32 v81, 0, v81
  v_cvt_pk_bf16_f32 v82, 0, v82
  v_cvt_pk_bf16_f32 v83, 0, v83
  v_cvt_pk_bf16_f32 v84, 0, v84
  v_cvt_pk_bf16_f32 v85, 0, v85
  v_cvt_pk_bf16_f32 v86, 0, v86
  v_cvt_pk_bf16_f32 v87, 0, v87
  v_rcp_f32 v10, v10
  s_nop 0
  v_mul_f32 v80, v80, v10
  v_mul_f32 v81, v81, v10
  v_mul_f32 v82, v82, v10
  v_mul_f32 v83, v83, v10
  v_mul_f32 v84, v84, v10
  v_mul_f32 v85, v85, v10
  v_mul_f32 v86, v86, v10
  v_mul_f32 v87, v87, v10
  v_cvt_pk_bf16_f32 v80, 0, v80
  v_cvt_pk_bf16_f32 v81, 0, v81
  v_cvt_pk_bf16_f32 v82, 0, v82
  v_cvt_pk_bf16_f32 v83, 0, v83
  v_cvt_pk_bf16_f32 v84, 0, v84
  v_cvt_pk_bf16_f32 v85, 0, v85
  v_cvt_pk_bf16_f32 v86, 0, v86
  v_cvt_pk_bf16_f32 v87, 0, v87
  v_lshrrev_b32 v2, 1, v1
  v_lshlrev_b32 v2, 7, v2
  v_and_b32 v3, 1, v1
  v_lshl_add_u32 v2, v3, 5, v2
  v_add_u32 v2, 20480, v2
  global_load_dwordx4 v[40:43], v2, s[42:43] offset:0 sc1
  global_load_dwordx4 v[44:47], v2, s[42:43] offset:16 sc1
  global_load_dwordx4 v[48:51], v2, s[42:43] offset:64 sc1
  global_load_dwordx4 v[52:55], v2, s[42:43] offset:80 sc1
  s_waitcnt vmcnt(0)
  v_lshlrev_b32 v88, 16, v40
  v_and_b32 v89, s73, v40
  v_lshlrev_b32 v90, 16, v42
  v_and_b32 v91, s73, v42
  v_lshlrev_b32 v92, 16, v44
  v_and_b32 v93, s73, v44
  v_lshlrev_b32 v94, 16, v46
  v_and_b32 v95, s73, v46
  v_lshlrev_b32 v96, 16, v48
  v_and_b32 v97, s73, v48
  v_lshlrev_b32 v98, 16, v50
  v_and_b32 v99, s73, v50
  v_lshlrev_b32 v100, 16, v52
  v_and_b32 v101, s73, v52
  v_lshlrev_b32 v102, 16, v54
  v_and_b32 v103, s73, v54
  v_add_f32 v88, 1.0, v88
  v_add_f32 v89, 1.0, v89
  v_add_f32 v90, 1.0, v90
  v_add_f32 v91, 1.0, v91
  v_add_f32 v92, 1.0, v92
  v_add_f32 v93, 1.0, v93
  v_add_f32 v94, 1.0, v94
  v_add_f32 v95, 1.0, v95
  v_add_f32 v96, 1.0, v96
  v_add_f32 v97, 1.0, v97
  v_add_f32 v98, 1.0, v98
  v_add_f32 v99, 1.0, v99
  v_add_f32 v100, 1.0, v100
  v_add_f32 v101, 1.0, v101
  v_add_f32 v102, 1.0, v102
  v_add_f32 v103, 1.0, v103
  v_cvt_pk_bf16_f32 v88, 0, v88
  v_cvt_pk_bf16_f32 v89, 0, v89
  v_cvt_pk_bf16_f32 v90, 0, v90
  v_cvt_pk_bf16_f32 v91, 0, v91
  v_cvt_pk_bf16_f32 v92, 0, v92
  v_cvt_pk_bf16_f32 v93, 0, v93
  v_cvt_pk_bf16_f32 v94, 0, v94
  v_cvt_pk_bf16_f32 v95, 0, v95
  v_cvt_pk_bf16_f32 v96, 0, v96
  v_cvt_pk_bf16_f32 v97, 0, v97
  v_cvt_pk_bf16_f32 v98, 0, v98
  v_cvt_pk_bf16_f32 v99, 0, v99
  v_cvt_pk_bf16_f32 v100, 0, v100
  v_cvt_pk_bf16_f32 v101, 0, v101
  v_cvt_pk_bf16_f32 v102, 0, v102
  v_cvt_pk_bf16_f32 v103, 0, v103
  v_mul_f32 v72, v72, v88
  v_mul_f32 v73, v73, v89
  v_mul_f32 v74, v74, v90
  v_mul_f32 v75, v75, v91
  v_mul_f32 v76, v76, v92
  v_mul_f32 v77, v77, v93
  v_mul_f32 v78, v78, v94
  v_mul_f32 v79, v79, v95
  v_mul_f32 v80, v80, v96
  v_mul_f32 v81, v81, v97
  v_mul_f32 v82, v82, v98
  v_mul_f32 v83, v83, v99
  v_mul_f32 v84, v84, v100
  v_mul_f32 v85, v85, v101
  v_mul_f32 v86, v86, v102
  v_mul_f32 v87, v87, v103
  v_cvt_pk_bf16_f32 v72, 0, v72
  v_cvt_pk_bf16_f32 v73, 0, v73
  v_cvt_pk_bf16_f32 v74, 0, v74
  v_cvt_pk_bf16_f32 v75, 0, v75
  v_cvt_pk_bf16_f32 v76, 0, v76
  v_cvt_pk_bf16_f32 v77, 0, v77
  v_cvt_pk_bf16_f32 v78, 0, v78
  v_cvt_pk_bf16_f32 v79, 0, v79
  v_cvt_pk_bf16_f32 v80, 0, v80
  v_cvt_pk_bf16_f32 v81, 0, v81
  v_cvt_pk_bf16_f32 v82, 0, v82
  v_cvt_pk_bf16_f32 v83, 0, v83
  v_cvt_pk_bf16_f32 v84, 0, v84
  v_cvt_pk_bf16_f32 v85, 0, v85
  v_cvt_pk_bf16_f32 v86, 0, v86
  v_cvt_pk_bf16_f32 v87, 0, v87
  v_lshrrev_b32 v2, 1, v1
  v_lshlrev_b32 v2, 7, v2
  v_and_b32 v3, 1, v1
  v_lshl_add_u32 v2, v3, 5, v2
  v_add_u32 v2, 16384, v2
  global_load_dwordx4 v[40:43], v2, s[42:43] offset:0 sc1
  global_load_dwordx4 v[44:47], v2, s[42:43] offset:16 sc1
  global_load_dwordx4 v[48:51], v2, s[42:43] offset:64 sc1
  global_load_dwordx4 v[52:55], v2, s[42:43] offset:80 sc1
  s_waitcnt vmcnt(0)
  v_lshlrev_b32 v88, 16, v40
  v_and_b32 v89, s73, v40
  v_lshlrev_b32 v90, 16, v42
  v_and_b32 v91, s73, v42
  v_lshlrev_b32 v92, 16, v44
  v_and_b32 v93, s73, v44
  v_lshlrev_b32 v94, 16, v46
  v_and_b32 v95, s73, v46
  v_lshlrev_b32 v96, 16, v48
  v_and_b32 v97, s73, v48
  v_lshlrev_b32 v98, 16, v50
  v_and_b32 v99, s73, v50
  v_lshlrev_b32 v100, 16, v52
  v_and_b32 v101, s73, v52
  v_lshlrev_b32 v102, 16, v54
  v_and_b32 v103, s73, v54
  v_add_f32 v72, v72, v88
  v_add_f32 v73, v73, v89
  v_add_f32 v74, v74, v90
  v_add_f32 v75, v75, v91
  v_add_f32 v76, v76, v92
  v_add_f32 v77, v77, v93
  v_add_f32 v78, v78, v94
  v_add_f32 v79, v79, v95
  v_add_f32 v80, v80, v96
  v_add_f32 v81, v81, v97
  v_add_f32 v82, v82, v98
  v_add_f32 v83, v83, v99
  v_add_f32 v84, v84, v100
  v_add_f32 v85, v85, v101
  v_add_f32 v86, v86, v102
  v_add_f32 v87, v87, v103
  v_cvt_pk_bf16_f32 v40, v72, v73
  v_cvt_pk_bf16_f32 v41, v74, v75
  v_cvt_pk_bf16_f32 v42, v76, v77
  v_cvt_pk_bf16_f32 v43, v78, v79
  v_cvt_pk_bf16_f32 v44, v80, v81
  v_cvt_pk_bf16_f32 v45, v82, v83
  v_cvt_pk_bf16_f32 v46, v84, v85
  v_cvt_pk_bf16_f32 v47, v86, v87
  v_add_u32 v3, 12288, v0
  ds_write_b128 v3, v[40:43] offset:0
  ds_write_b128 v3, v[44:47] offset:1024
  s_mov_b32 s44, s28
  s_mov_b32 s45, s29
  s_mov_b32 s46, 1409024
  s_mov_b32 s11, 2752
  s_mov_b32 s12, 1409024
  v_mov_b32 v4, 12288
  v_mov_b32 v5, 13312
  v_lshlrev_b32 v2, 4, v1
  s_call_b64 s[62:63], L_gv
  v_cvt_pk_bf16_f32 v120, 0, v72
  v_cvt_pk_bf16_f32 v121, 0, v73
  v_cvt_pk_bf16_f32 v122, 0, v74
  v_cvt_pk_bf16_f32 v123, 0, v75
  v_cvt_pk_bf16_f32 v124, 0, v76
  v_cvt_pk_bf16_f32 v125, 0, v77
  v_cvt_pk_bf16_f32 v126, 0, v78
  v_cvt_pk_bf16_f32 v127, 0, v79
  v_cvt_pk_bf16_f32 v128, 0, v80
  v_cvt_pk_bf16_f32 v129, 0, v81
  v_cvt_pk_bf16_f32 v130, 0, v82
  v_cvt_pk_bf16_f32 v131, 0, v83
  v_cvt_pk_bf16_f32 v132, 0, v84
  v_cvt_pk_bf16_f32 v133, 0, v85
  v_cvt_pk_bf16_f32 v134, 0, v86
  v_cvt_pk_bf16_f32 v135, 0, v87
  s_mov_b32 s44, s30
  s_mov_b32 s45, s31
  s_mov_b32 s46, 1409024
  s_mov_b32 s11, 2752
  s_mov_b32 s12, 1409024
  v_mov_b32 v4, 12288
  v_mov_b32 v5, 13312
  v_lshlrev_b32 v2, 4, v1
  s_call_b64 s[62:63], L_gv
  v_mul_f32 v88, 0xbfb8aa3b, v120
  v_mul_f32 v89, 0xbfb8aa3b, v121
  v_mul_f32 v90, 0xbfb8aa3b, v122
  v_mul_f32 v91, 0xbfb8aa3b, v123
  v_exp_f32 v88, v88
  v_exp_f32 v89, v89
  v_exp_f32 v90, v90
  v_exp_f32 v91, v91
  s_nop 0
  v_add_f32 v88, 1.0, v88
  v_add_f32 v89, 1.0, v89
  v_add_f32 v90, 1.0, v90
  v_add_f32 v91, 1.0, v91
  v_rcp_f32 v88, v88
  v_rcp_f32 v89, v89
  v_rcp_f32 v90, v90
  v_rcp_f32 v91, v91
  s_nop 0
  v_mul_f32 v120, v120, v88
  v_mul_f32 v121, v121, v89
  v_mul_f32 v122, v122, v90
  v_mul_f32 v123, v123, v91
  v_mul_f32 v88, 0xbfb8aa3b, v124
  v_mul_f32 v89, 0xbfb8aa3b, v125
  v_mul_f32 v90, 0xbfb8aa3b, v126
  v_mul_f32 v91, 0xbfb8aa3b, v127
  v_exp_f32 v88, v88
  v_exp_f32 v89, v89
  v_exp_f32 v90, v90
  v_exp_f32 v91, v91
  s_nop 0
  v_add_f32 v88, 1.0, v88
  v_add_f32 v89, 1.0, v89
  v_add_f32 v90, 1.0, v90
  v_add_f32 v91, 1.0, v91
  v_rcp_f32 v88, v88
  v_rcp_f32 v89, v89
  v_rcp_f32 v90, v90
  v_rcp_f32 v91, v91
  s_nop 0
  v_mul_f32 v124, v124, v88
  v_mul_f32 v125, v125, v89
  v_mul_f32 v126, v126, v90
  v_mul_f32 v127, v127, v91
  v_mul_f32 v88, 0xbfb8aa3b, v128
  v_mul_f32 v89, 0xbfb8aa3b, v129
  v_mul_f32 v90, 0xbfb8aa3b, v130
  v_mul_f32 v91, 0xbfb8aa3b, v131
  v_exp_f32 v88, v88
  v_exp_f32 v89, v89
  v_exp_f32 v90, v90
  v_exp_f32 v91, v91
  s_nop 0
  v_add_f32 v88, 1.0, v88
  v_add_f32 v89, 1.0, v89
  v_add_f32 v90, 1.0, v90
  v_add_f32 v91, 1.0, v91
  v_rcp_f32 v88, v88
  v_rcp_f32 v89, v89
  v_rcp_f32 v90, v90
  v_rcp_f32 v91, v91
  s_nop 0
  v_mul_f32 v128, v128, v88
  v_mul_f32 v129, v129, v89
  v_mul_f32 v130, v130, v90
  v_mul_f32 v131, v131, v91
  v_mul_f32 v88, 0xbfb8aa3b, v132
  v_mul_f32 v89, 0xbfb8aa3b, v133
  v_mul_f32 v90, 0xbfb8aa3b, v134
  v_mul_f32 v91, 0xbfb8aa3b, v135
  v_exp_f32 v88, v88
  v_exp_f32 v89, v89
  v_exp_f32 v90, v90
  v_exp_f32 v91, v91
  s_nop 0
  v_add_f32 v88, 1.0, v88
  v_add_f32 v89, 1.0, v89
  v_add_f32 v90, 1.0, v90
  v_add_f32 v91, 1.0, v91
  v_rcp_f32 v88, v88
  v_rcp_f32 v89, v89
  v_rcp_f32 v90, v90
  v_rcp_f32 v91, v91
  s_nop 0
  v_mul_f32 v132, v132, v88
  v_mul_f32 v133, v133, v89
  v_mul_f32 v134, v134, v90
  v_mul_f32 v135, v135, v91
  v_cvt_pk_bf16_f32 v120, 0, v120
  v_cvt_pk_bf16_f32 v121, 0, v121
  v_cvt_pk_bf16_f32 v122, 0, v122
  v_cvt_pk_bf16_f32 v123, 0, v123
  v_cvt_pk_bf16_f32 v124, 0, v124
  v_cvt_pk_bf16_f32 v125, 0, v125
  v_cvt_pk_bf16_f32 v126, 0, v126
  v_cvt_pk_bf16_f32 v127, 0, v127
  v_cvt_pk_bf16_f32 v128, 0, v128
  v_cvt_pk_bf16_f32 v129, 0, v129
  v_cvt_pk_bf16_f32 v130, 0, v130
  v_cvt_pk_bf16_f32 v131, 0, v131
  v_cvt_pk_bf16_f32 v132, 0, v132
  v_cvt_pk_bf16_f32 v133, 0, v133
  v_cvt_pk_bf16_f32 v134, 0, v134
  v_cvt_pk_bf16_f32 v135, 0, v135
  v_cvt_pk_bf16_f32 v72, 0, v72
  v_cvt_pk_bf16_f32 v73, 0, v73
  v_cvt_pk_bf16_f32 v74, 0, v74
  v_cvt_pk_bf16_f32 v75, 0, v75
  v_cvt_pk_bf16_f32 v76, 0, v76
  v_cvt_pk_bf16_f32 v77, 0, v77
  v_cvt_pk_bf16_f32 v78, 0, v78
  v_cvt_pk_bf16_f32 v79, 0, v79
  v_cvt_pk_bf16_f32 v80, 0, v80
  v_cvt_pk_bf16_f32 v81, 0, v81
  v_cvt_pk_bf16_f32 v82, 0, v82
  v_cvt_pk_bf16_f32 v83, 0, v83
  v_cvt_pk_bf16_f32 v84, 0, v84
  v_cvt_pk_bf16_f32 v85, 0, v85
  v_cvt_pk_bf16_f32 v86, 0, v86
  v_cvt_pk_bf16_f32 v87, 0, v87
  v_mul_f32 v72, v72, v120
  v_mul_f32 v73, v73, v121
  v_mul_f32 v74, v74, v122
  v_mul_f32 v75, v75, v123
  v_mul_f32 v76, v76, v124
  v_mul_f32 v77, v77, v125
  v_mul_f32 v78, v78, v126
  v_mul_f32 v79, v79, v127
  v_mul_f32 v80, v80, v128
  v_mul_f32 v81, v81, v129
  v_mul_f32 v82, v82, v130
  v_mul_f32 v83, v83, v131
  v_mul_f32 v84, v84, v132
  v_mul_f32 v85, v85, v133
  v_mul_f32 v86, v86, v134
  v_mul_f32 v87, v87, v135
  v_cvt_pk_bf16_f32 v40, v72, v73
  v_cvt_pk_bf16_f32 v41, v74, v75
  v_cvt_pk_bf16_f32 v42, v76, v77
  v_cvt_pk_bf16_f32 v43, v78, v79
  v_cvt_pk_bf16_f32 v44, v80, v81
  v_cvt_pk_bf16_f32 v45, v82, v83
  v_cvt_pk_bf16_f32 v46, v84, v85
  v_cvt_pk_bf16_f32 v47, v86, v87
  v_add_u32 v3, 14336, v0
  ds_write_b128 v3, v[40:43] offset:0
  ds_write_b128 v3, v[44:47] offset:3072
  s_mov_b32 s44, s28
  s_mov_b32 s45, s29
  s_mov_b32 s46, 1409024
  s_mov_b32 s11, 2752
  s_mov_b32 s12, 1409024
  v_mov_b32 v4, 12288
  v_mov_b32 v5, 13312
  v_lshlrev_b32 v2, 4, v1
  v_add_u32 v2, 1024, v2
  s_call_b64 s[62:63], L_gv
  v_cvt_pk_bf16_f32 v120, 0, v72
  v_cvt_pk_bf16_f32 v121, 0, v73
  v_cvt_pk_bf16_f32 v122, 0, v74
  v_cvt_pk_bf16_f32 v123, 0, v75
  v_cvt_pk_bf16_f32 v124, 0, v76
  v_cvt_pk_bf16_f32 v125, 0, v77
  v_cvt_pk_bf16_f32 v126, 0, v78
  v_cvt_pk_bf16_f32 v127, 0, v79
  v_cvt_pk_bf16_f32 v128, 0, v80
  v_cvt_pk_bf16_f32 v129, 0, v81
  v_cvt_pk_bf16_f32 v130, 0, v82
  v_cvt_pk_bf16_f32 v131, 0, v83
  v_cvt_pk_bf16_f32 v132, 0, v84
  v_cvt_pk_bf16_f32 v133, 0, v85
  v_cvt_pk_bf16_f32 v134, 0, v86
  v_cvt_pk_bf16_f32 v135, 0, v87
  s_mov_b32 s44, s30
  s_mov_b32 s45, s31
  s_mov_b32 s46, 1409024
  s_mov_b32 s11, 2752
  s_mov_b32 s12, 1409024
  v_mov_b32 v4, 12288
  v_mov_b32 v5, 13312
  v_lshlrev_b32 v2, 4, v1
  v_add_u32 v2, 1024, v2
  s_call_b64 s[62:63], L_gv
  v_mul_f32 v88, 0xbfb8aa3b, v120
  v_mul_f32 v89, 0xbfb8aa3b, v121
  v_mul_f32 v90, 0xbfb8aa3b, v122
  v_mul_f32 v91, 0xbfb8aa3b, v123
  v_exp_f32 v88, v88
  v_exp_f32 v89, v89
  v_exp_f32 v90, v90
  v_exp_f32 v91, v91
  s_nop 0
  v_add_f32 v88, 1.0, v88
  v_add_f32 v89, 1.0, v89
  v_add_f32 v90, 1.0, v90
  v_add_f32 v91, 1.0, v91
  v_rcp_f32 v88, v88
  v_rcp_f32 v89, v89
  v_rcp_f32 v90, v90
  v_rcp_f32 v91, v91
  s_nop 0
  v_mul_f32 v120, v120, v88
  v_mul_f32 v121, v121, v89
  v_mul_f32 v122, v122, v90
  v_mul_f32 v123, v123, v91
  v_mul_f32 v88, 0xbfb8aa3b, v124
  v_mul_f32 v89, 0xbfb8aa3b, v125
  v_mul_f32 v90, 0xbfb8aa3b, v126
  v_mul_f32 v91, 0xbfb8aa3b, v127
  v_exp_f32 v88, v88
  v_exp_f32 v89, v89
  v_exp_f32 v90, v90
  v_exp_f32 v91, v91
  s_nop 0
  v_add_f32 v88, 1.0, v88
  v_add_f32 v89, 1.0, v89
  v_add_f32 v90, 1.0, v90
  v_add_f32 v91, 1.0, v91
  v_rcp_f32 v88, v88
  v_rcp_f32 v89, v89
  v_rcp_f32 v90, v90
  v_rcp_f32 v91, v91
  s_nop 0
  v_mul_f32 v124, v124, v88
  v_mul_f32 v125, v125, v89
  v_mul_f32 v126, v126, v90
  v_mul_f32 v127, v127, v91
  v_mul_f32 v88, 0xbfb8aa3b, v128
  v_mul_f32 v89, 0xbfb8aa3b, v129
  v_mul_f32 v90, 0xbfb8aa3b, v130
  v_mul_f32 v91, 0xbfb8aa3b, v131
  v_exp_f32 v88, v88
  v_exp_f32 v89, v89
  v_exp_f32 v90, v90
  v_exp_f32 v91, v91
  s_nop 0
  v_add_f32 v88, 1.0, v88
  v_add_f32 v89, 1.0, v89
  v_add_f32 v90, 1.0, v90
  v_add_f32 v91, 1.0, v91
  v_rcp_f32 v88, v88
  v_rcp_f32 v89, v89
  v_rcp_f32 v90, v90
  v_rcp_f32 v91, v91
  s_nop 0
  v_mul_f32 v128, v128, v88
  v_mul_f32 v129, v129, v89
  v_mul_f32 v130, v130, v90
  v_mul_f32 v131, v131, v91
  v_mul_f32 v88, 0xbfb8aa3b, v132
  v_mul_f32 v89, 0xbfb8aa3b, v133
  v_mul_f32 v90, 0xbfb8aa3b, v134
  v_mul_f32 v91, 0xbfb8aa3b, v135
  v_exp_f32 v88, v88
  v_exp_f32 v89, v89
  v_exp_f32 v90, v90
  v_exp_f32 v91, v91
  s_nop 0
  v_add_f32 v88, 1.0, v88
  v_add_f32 v89, 1.0, v89
  v_add_f32 v90, 1.0, v90
  v_add_f32 v91, 1.0, v91
  v_rcp_f32 v88, v88
  v_rcp_f32 v89, v89
  v_rcp_f32 v90, v90
  v_rcp_f32 v91, v91
  s_nop 0
  v_mul_f32 v132, v132, v88
  v_mul_f32 v133, v133, v89
  v_mul_f32 v134, v134, v90
  v_mul_f32 v135, v135, v91
  v_cvt_pk_bf16_f32 v120, 0, v120
  v_cvt_pk_bf16_f32 v121, 0, v121
  v_cvt_pk_bf16_f32 v122, 0, v122
  v_cvt_pk_bf16_f32 v123, 0, v123
  v_cvt_pk_bf16_f32 v124, 0, v124
  v_cvt_pk_bf16_f32 v125, 0, v125
  v_cvt_pk_bf16_f32 v126, 0, v126
  v_cvt_pk_bf16_f32 v127, 0, v127
  v_cvt_pk_bf16_f32 v128, 0, v128
  v_cvt_pk_bf16_f32 v129, 0, v129
  v_cvt_pk_bf16_f32 v130, 0, v130
  v_cvt_pk_bf16_f32 v131, 0, v131
  v_cvt_pk_bf16_f32 v132, 0, v132
  v_cvt_pk_bf16_f32 v133, 0, v133
  v_cvt_pk_bf16_f32 v134, 0, v134
  v_cvt_pk_bf16_f32 v135, 0, v135
  v_cvt_pk_bf16_f32 v72, 0, v72
  v_cvt_pk_bf16_f32 v73, 0, v73
  v_cvt_pk_bf16_f32 v74, 0, v74
  v_cvt_pk_bf16_f32 v75, 0, v75
  v_cvt_pk_bf16_f32 v76, 0, v76
  v_cvt_pk_bf16_f32 v77, 0, v77
  v_cvt_pk_bf16_f32 v78, 0, v78
  v_cvt_pk_bf16_f32 v79, 0, v79
  v_cvt_pk_bf16_f32 v80, 0, v80
  v_cvt_pk_bf16_f32 v81, 0, v81
  v_cvt_pk_bf16_f32 v82, 0, v82
  v_cvt_pk_bf16_f32 v83, 0, v83
  v_cvt_pk_bf16_f32 v84, 0, v84
  v_cvt_pk_bf16_f32 v85, 0, v85
  v_cvt_pk_bf16_f32 v86, 0, v86
  v_cvt_pk_bf16_f32 v87, 0, v87
  v_mul_f32 v72, v72, v120
  v_mul_f32 v73, v73, v121
  v_mul_f32 v74, v74, v122
  v_mul_f32 v75, v75, v123
  v_mul_f32 v76, v76, v124
  v_mul_f32 v77, v77, v125
  v_mul_f32 v78, v78, v126
  v_mul_f32 v79, v79, v127
  v_mul_f32 v80, v80, v128
  v_mul_f32 v81, v81, v129
  v_mul_f32 v82, v82, v130
  v_mul_f32 v83, v83, v131
  v_mul_f32 v84, v84, v132
  v_mul_f32 v85, v85, v133
  v_mul_f32 v86, v86, v134
  v_mul_f32 v87, v87, v135
  v_cvt_pk_bf16_f32 v40, v72, v73
  v_cvt_pk_bf16_f32 v41, v74, v75
  v_cvt_pk_bf16_f32 v42, v76, v77
  v_cvt_pk_bf16_f32 v43, v78, v79
  v_cvt_pk_bf16_f32 v44, v80, v81
  v_cvt_pk_bf16_f32 v45, v82, v83
  v_cvt_pk_bf16_f32 v46, v84, v85
  v_cvt_pk_bf16_f32 v47, v86, v87
  v_add_u32 v3, 15360, v0
  ds_write_b128 v3, v[40:43] offset:0
  ds_write_b128 v3, v[44:47] offset:3072
  s_mov_b32 s44, s28
  s_mov_b32 s45, s29
  s_mov_b32 s46, 1409024
  s_mov_b32 s11, 2752
  s_mov_b32 s12, 1409024
  v_mov_b32 v4, 12288
  v_mov_b32 v5, 13312
  v_lshlrev_b32 v2, 4, v1
  v_add_u32 v2, 2048, v2
  s_call_b64 s[62:63], L_gv
  v_cvt_pk_bf16_f32 v120, 0, v72
  v_cvt_pk_bf16_f32 v121, 0, v73
  v_cvt_pk_bf16_f32 v122, 0, v74
  v_cvt_pk_bf16_f32 v123, 0, v75
  v_cvt_pk_bf16_f32 v124, 0, v76
  v_cvt_pk_bf16_f32 v125, 0, v77
  v_cvt_pk_bf16_f32 v126, 0, v78
  v_cvt_pk_bf16_f32 v127, 0, v79
  v_cvt_pk_bf16_f32 v128, 0, v80
  v_cvt_pk_bf16_f32 v129, 0, v81
  v_cvt_pk_bf16_f32 v130, 0, v82
  v_cvt_pk_bf16_f32 v131, 0, v83
  v_cvt_pk_bf16_f32 v132, 0, v84
  v_cvt_pk_bf16_f32 v133, 0, v85
  v_cvt_pk_bf16_f32 v134, 0, v86
  v_cvt_pk_bf16_f32 v135, 0, v87
  s_mov_b32 s44, s30
  s_mov_b32 s45, s31
  s_mov_b32 s46, 1409024
  s_mov_b32 s11, 2752
  s_mov_b32 s12, 1409024
  v_mov_b32 v4, 12288
  v_mov_b32 v5, 13312
  v_lshlrev_b32 v2, 4, v1
  v_add_u32 v2, 2048, v2
  s_call_b64 s[62:63], L_gv
  v_mul_f32 v88, 0xbfb8aa3b, v120
  v_mul_f32 v89, 0xbfb8aa3b, v121
  v_mul_f32 v90, 0xbfb8aa3b, v122
  v_mul_f32 v91, 0xbfb8aa3b, v123
  v_exp_f32 v88, v88
  v_exp_f32 v89, v89
  v_exp_f32 v90, v90
  v_exp_f32 v91, v91
  s_nop 0
  v_add_f32 v88, 1.0, v88
  v_add_f32 v89, 1.0, v89
  v_add_f32 v90, 1.0, v90
  v_add_f32 v91, 1.0, v91
  v_rcp_f32 v88, v88
  v_rcp_f32 v89, v89
  v_rcp_f32 v90, v90
  v_rcp_f32 v91, v91
  s_nop 0
  v_mul_f32 v120, v120, v88
  v_mul_f32 v121, v121, v89
  v_mul_f32 v122, v122, v90
  v_mul_f32 v123, v123, v91
  v_mul_f32 v88, 0xbfb8aa3b, v124
  v_mul_f32 v89, 0xbfb8aa3b, v125
  v_mul_f32 v90, 0xbfb8aa3b, v126
  v_mul_f32 v91, 0xbfb8aa3b, v127
  v_exp_f32 v88, v88
  v_exp_f32 v89, v89
  v_exp_f32 v90, v90
  v_exp_f32 v91, v91
  s_nop 0
  v_add_f32 v88, 1.0, v88
  v_add_f32 v89, 1.0, v89
  v_add_f32 v90, 1.0, v90
  v_add_f32 v91, 1.0, v91
  v_rcp_f32 v88, v88
  v_rcp_f32 v89, v89
  v_rcp_f32 v90, v90
  v_rcp_f32 v91, v91
  s_nop 0
  v_mul_f32 v124, v124, v88
  v_mul_f32 v125, v125, v89
  v_mul_f32 v126, v126, v90
  v_mul_f32 v127, v127, v91
  v_mul_f32 v88, 0xbfb8aa3b, v128
  v_mul_f32 v89, 0xbfb8aa3b, v129
  v_mul_f32 v90, 0xbfb8aa3b, v130
  v_mul_f32 v91, 0xbfb8aa3b, v131
  v_exp_f32 v88, v88
  v_exp_f32 v89, v89
  v_exp_f32 v90, v90
  v_exp_f32 v91, v91
  s_nop 0
  v_add_f32 v88, 1.0, v88
  v_add_f32 v89, 1.0, v89
  v_add_f32 v90, 1.0, v90
  v_add_f32 v91, 1.0, v91
  v_rcp_f32 v88, v88
  v_rcp_f32 v89, v89
  v_rcp_f32 v90, v90
  v_rcp_f32 v91, v91
  s_nop 0
  v_mul_f32 v128, v128, v88
  v_mul_f32 v129, v129, v89
  v_mul_f32 v130, v130, v90
  v_mul_f32 v131, v131, v91
  v_mul_f32 v88, 0xbfb8aa3b, v132
  v_mul_f32 v89, 0xbfb8aa3b, v133
  v_mul_f32 v90, 0xbfb8aa3b, v134
  v_mul_f32 v91, 0xbfb8aa3b, v135
  v_exp_f32 v88, v88
  v_exp_f32 v89, v89
  v_exp_f32 v90, v90
  v_exp_f32 v91, v91
  s_nop 0
  v_add_f32 v88, 1.0, v88
  v_add_f32 v89, 1.0, v89
  v_add_f32 v90, 1.0, v90
  v_add_f32 v91, 1.0, v91
  v_rcp_f32 v88, v88
  v_rcp_f32 v89, v89
  v_rcp_f32 v90, v90
  v_rcp_f32 v91, v91
  s_nop 0
  v_mul_f32 v132, v132, v88
  v_mul_f32 v133, v133, v89
  v_mul_f32 v134, v134, v90
  v_mul_f32 v135, v135, v91
  v_cvt_pk_bf16_f32 v120, 0, v120
  v_cvt_pk_bf16_f32 v121, 0, v121
  v_cvt_pk_bf16_f32 v122, 0, v122
  v_cvt_pk_bf16_f32 v123, 0, v123
  v_cvt_pk_bf16_f32 v124, 0, v124
  v_cvt_pk_bf16_f32 v125, 0, v125
  v_cvt_pk_bf16_f32 v126, 0, v126
  v_cvt_pk_bf16_f32 v127, 0, v127
  v_cvt_pk_bf16_f32 v128, 0, v128
  v_cvt_pk_bf16_f32 v129, 0, v129
  v_cvt_pk_bf16_f32 v130, 0, v130
  v_cvt_pk_bf16_f32 v131, 0, v131
  v_cvt_pk_bf16_f32 v132, 0, v132
  v_cvt_pk_bf16_f32 v133, 0, v133
  v_cvt_pk_bf16_f32 v134, 0, v134
  v_cvt_pk_bf16_f32 v135, 0, v135
  v_cvt_pk_bf16_f32 v72, 0, v72
  v_cvt_pk_bf16_f32 v73, 0, v73
  v_cvt_pk_bf16_f32 v74, 0, v74
  v_cvt_pk_bf16_f32 v75, 0, v75
  v_cvt_pk_bf16_f32 v76, 0, v76
  v_cvt_pk_bf16_f32 v77, 0, v77
  v_cvt_pk_bf16_f32 v78, 0, v78
  v_cvt_pk_bf16_f32 v79, 0, v79
  v_cvt_pk_bf16_f32 v80, 0, v80
  v_cvt_pk_bf16_f32 v81, 0, v81
  v_cvt_pk_bf16_f32 v82, 0, v82
  v_cvt_pk_bf16_f32 v83, 0, v83
  v_cvt_pk_bf16_f32 v84, 0, v84
  v_cvt_pk_bf16_f32 v85, 0, v85
  v_cvt_pk_bf16_f32 v86, 0, v86
  v_cvt_pk_bf16_f32 v87, 0, v87
  v_mul_f32 v72, v72, v120
  v_mul_f32 v73, v73, v121
  v_mul_f32 v74, v74, v122
  v_mul_f32 v75, v75, v123
  v_mul_f32 v76, v76, v124
  v_mul_f32 v77, v77, v125
  v_mul_f32 v78, v78, v126
  v_mul_f32 v79, v79, v127
  v_mul_f32 v80, v80, v128
  v_mul_f32 v81, v81, v129
  v_mul_f32 v82, v82, v130
  v_mul_f32 v83, v83, v131
  v_mul_f32 v84, v84, v132
  v_mul_f32 v85, v85, v133
  v_mul_f32 v86, v86, v134
  v_mul_f32 v87, v87, v135
  v_cvt_pk_bf16_f32 v40, v72, v73
  v_cvt_pk_bf16_f32 v41, v74, v75
  v_cvt_pk_bf16_f32 v42, v76, v77
  v_cvt_pk_bf16_f32 v43, v78, v79
  v_cvt_pk_bf16_f32 v44, v80, v81
  v_cvt_pk_bf16_f32 v45, v82, v83
  v_cvt_pk_bf16_f32 v46, v84, v85
  v_cvt_pk_bf16_f32 v47, v86, v87
  v_add_u32 v3, 16384, v0
  ds_write_b128 v3, v[40:43] offset:0
  ds_write_b128 v3, v[44:47] offset:3072
  s_mov_b32 s44, s32
  s_mov_b32 s45, s33
  s_mov_b32 s46, 1409024
  s_mov_b32 s11, 1024
  s_mov_b32 s12, 1409024
  v_mov_b32 v4, 14336
  v_mov_b32 v5, 17408
  v_lshlrev_b32 v2, 4, v1
  s_call_b64 s[62:63], L_gv
  v_lshrrev_b32 v2, 1, v1
  v_lshlrev_b32 v2, 7, v2
  v_and_b32 v3, 1, v1
  v_lshl_add_u32 v2, v3, 5, v2
  v_add_u32 v2, 24576, v2
  global_load_dwordx4 v[40:43], v2, s[42:43] offset:0 sc1
  global_load_dwordx4 v[44:47], v2, s[42:43] offset:16 sc1
  global_load_dwordx4 v[48:51], v2, s[42:43] offset:64 sc1
  global_load_dwordx4 v[52:55], v2, s[42:43] offset:80 sc1
  s_waitcnt vmcnt(0)
  v_lshlrev_b32 v88, 16, v40
  v_and_b32 v89, s73, v40
  v_lshlrev_b32 v90, 16, v42
  v_and_b32 v91, s73, v42
  v_lshlrev_b32 v92, 16, v44
  v_and_b32 v93, s73, v44
  v_lshlrev_b32 v94, 16, v46
  v_and_b32 v95, s73, v46
  v_lshlrev_b32 v96, 16, v48
  v_and_b32 v97, s73, v48
  v_lshlrev_b32 v98, 16, v50
  v_and_b32 v99, s73, v50
  v_lshlrev_b32 v100, 16, v52
  v_and_b32 v101, s73, v52
  v_lshlrev_b32 v102, 16, v54
  v_and_b32 v103, s73, v54
  v_cvt_pk_bf16_f32 v72, 0, v72
  v_cvt_pk_bf16_f32 v73, 0, v73
  v_cvt_pk_bf16_f32 v74, 0, v74
  v_cvt_pk_bf16_f32 v75, 0, v75
  v_cvt_pk_bf16_f32 v76, 0, v76
  v_cvt_pk_bf16_f32 v77, 0, v77
  v_cvt_pk_bf16_f32 v78, 0, v78
  v_cvt_pk_bf16_f32 v79, 0, v79
  v_cvt_pk_bf16_f32 v80, 0, v80
  v_cvt_pk_bf16_f32 v81, 0, v81
  v_cvt_pk_bf16_f32 v82, 0, v82
  v_cvt_pk_bf16_f32 v83, 0, v83
  v_cvt_pk_bf16_f32 v84, 0, v84
  v_cvt_pk_bf16_f32 v85, 0, v85
  v_cvt_pk_bf16_f32 v86, 0, v86
  v_cvt_pk_bf16_f32 v87, 0, v87
  v_mul_f32 v72, v72, v88
  v_mul_f32 v73, v73, v89
  v_mul_f32 v74, v74, v90
  v_mul_f32 v75, v75, v91
  v_mul_f32 v76, v76, v92
  v_mul_f32 v77, v77, v93
  v_mul_f32 v78, v78, v94
  v_mul_f32 v79, v79, v95
  v_mul_f32 v80, v80, v96
  v_mul_f32 v81, v81, v97
  v_mul_f32 v82, v82, v98
  v_mul_f32 v83, v83, v99
  v_mul_f32 v84, v84, v100
  v_mul_f32 v85, v85, v101
  v_mul_f32 v86, v86, v102
  v_mul_f32 v87, v87, v103
  v_cvt_pk_bf16_f32 v72, 0, v72
  v_cvt_pk_bf16_f32 v73, 0, v73
  v_cvt_pk_bf16_f32 v74, 0, v74
  v_cvt_pk_bf16_f32 v75, 0, v75
  v_cvt_pk_bf16_f32 v76, 0, v76
  v_cvt_pk_bf16_f32 v77, 0, v77
  v_cvt_pk_bf16_f32 v78, 0, v78
  v_cvt_pk_bf16_f32 v79, 0, v79
  v_cvt_pk_bf16_f32 v80, 0, v80
  v_cvt_pk_bf16_f32 v81, 0, v81
  v_cvt_pk_bf16_f32 v82, 0, v82
  v_cvt_pk_bf16_f32 v83, 0, v83
  v_cvt_pk_bf16_f32 v84, 0, v84
  v_cvt_pk_bf16_f32 v85, 0, v85
  v_cvt_pk_bf16_f32 v86, 0, v86
  v_cvt_pk_bf16_f32 v87, 0, v87
  v_add_f32 v104, v104, v72
  v_add_f32 v105, v105, v73
  v_add_f32 v106, v106, v74
  v_add_f32 v107, v107, v75
  v_add_f32 v108, v108, v76
  v_add_f32 v109, v109, v77
  v_add_f32 v110, v110, v78
  v_add_f32 v111, v111, v79
  v_add_f32 v112, v112, v80
  v_add_f32 v113, v113, v81
  v_add_f32 v114, v114, v82
  v_add_f32 v115, v115, v83
  v_add_f32 v116, v116, v84
  v_add_f32 v117, v117, v85
  v_add_f32 v118, v118, v86
  v_add_f32 v119, v119, v87
  v_cvt_pk_bf16_f32 v104, 0, v104
  v_cvt_pk_bf16_f32 v105, 0, v105
  v_cvt_pk_bf16_f32 v106, 0, v106
  v_cvt_pk_bf16_f32 v107, 0, v107
  v_cvt_pk_bf16_f32 v108, 0, v108
  v_cvt_pk_bf16_f32 v109, 0, v109
  v_cvt_pk_bf16_f32 v110, 0, v110
  v_cvt_pk_bf16_f32 v111, 0, v111
  v_cvt_pk_bf16_f32 v112, 0, v112
  v_cvt_pk_bf16_f32 v113, 0, v113
  v_cvt_pk_bf16_f32 v114, 0, v114
  v_cvt_pk_bf16_f32 v115, 0, v115
  v_cvt_pk_bf16_f32 v116, 0, v116
  v_cvt_pk_bf16_f32 v117, 0, v117
  v_cvt_pk_bf16_f32 v118, 0, v118
  v_cvt_pk_bf16_f32 v119, 0, v119
  v_cvt_pk_bf16_f32 v40, v104, v105
  v_cvt_pk_bf16_f32 v41, v106, v107
  v_cvt_pk_bf16_f32 v42, v108, v109
  v_cvt_pk_bf16_f32 v43, v110, v111
  v_cvt_pk_bf16_f32 v44, v112, v113
  v_cvt_pk_bf16_f32 v45, v114, v115
  v_cvt_pk_bf16_f32 v46, v116, v117
  v_cvt_pk_bf16_f32 v47, v118, v119
  global_store_dwordx4 v0, v[40:43], s[38:39] offset:0 sc1
  global_store_dwordx4 v0, v[44:47], s[38:39] offset:1024 sc1
  s_endpgm
L_gv:
  v_mov_b32 v72, 0
  v_mov_b32 v73, 0
  v_mov_b32 v74, 0
  v_mov_b32 v75, 0
  v_mov_b32 v76, 0
  v_mov_b32 v77, 0
  v_mov_b32 v78, 0
  v_mov_b32 v79, 0
  v_mov_b32 v80, 0
  v_mov_b32 v81, 0
  v_mov_b32 v82, 0
  v_mov_b32 v83, 0
  v_mov_b32 v84, 0
  v_mov_b32 v85, 0
  v_mov_b32 v86, 0
  v_mov_b32 v87, 0
  s_mov_b32 s10, 0
L_gvl:
  buffer_load_dwordx4 v[40:43], v2, s[44:47], s10 offen
  s_add_u32 s10, s10, s11
  buffer_load_dwordx4 v[44:47], v2, s[44:47], s10 offen
  s_add_u32 s10, s10, s11
  buffer_load_dwordx4 v[48:51], v2, s[44:47], s10 offen
  s_add_u32 s10, s10, s11
  buffer_load_dwordx4 v[52:55], v2, s[44:47], s10 offen
  s_add_u32 s10, s10, s11
  buffer_load_dwordx4 v[56:59], v2, s[44:47], s10 offen
  s_add_u32 s10, s10, s11
  buffer_load_dwordx4 v[60:63], v2, s[44:47], s10 offen
  s_add_u32 s10, s10, s11
  buffer_load_dwordx4 v[64:67], v2, s[44:47], s10 offen
  s_add_u32 s10, s10, s11
  buffer_load_dwordx4 v[68:71], v2, s[44:47], s10 offen
  s_add_u32 s10, s10, s11
  ds_read_b128 v[88:91], v4
  ds_read_b128 v[92:95], v5
  v_add_u32 v4, 16, v4
  v_add_u32 v5, 16, v5
  s_waitcnt lgkmcnt(0)
  v_and_b32 v8, 0xffff, v88
  v_lshlrev_b32 v9, 16, v88
  v_and_b32 v10, 0xffff, v92
  v_lshlrev_b32 v11, 16, v92
  s_waitcnt vmcnt(7)
  v_dot2c_f32_bf16 v72, v8, v40
  v_dot2c_f32_bf16 v73, v9, v40
  v_dot2c_f32_bf16 v74, v8, v41
  v_dot2c_f32_bf16 v75, v9, v41
  v_dot2c_f32_bf16 v76, v8, v42
  v_dot2c_f32_bf16 v77, v9, v42
  v_dot2c_f32_bf16 v78, v8, v43
  v_dot2c_f32_bf16 v79, v9, v43
  v_dot2c_f32_bf16 v80, v10, v40
  v_dot2c_f32_bf16 v81, v11, v40
  v_dot2c_f32_bf16 v82, v10, v41
  v_dot2c_f32_bf16 v83, v11, v41
  v_dot2c_f32_bf16 v84, v10, v42
  v_dot2c_f32_bf16 v85, v11, v42
  v_dot2c_f32_bf16 v86, v10, v43
  v_dot2c_f32_bf16 v87, v11, v43
  v_lshrrev_b32 v8, 16, v88
  v_and_b32 v9, s73, v88
  v_lshrrev_b32 v10, 16, v92
  v_and_b32 v11, s73, v92
  s_waitcnt vmcnt(6)
  v_dot2c_f32_bf16 v72, v8, v44
  v_dot2c_f32_bf16 v73, v9, v44
  v_dot2c_f32_bf16 v74, v8, v45
  v_dot2c_f32_bf16 v75, v9, v45
  v_dot2c_f32_bf16 v76, v8, v46
  v_dot2c_f32_bf16 v77, v9, v46
  v_dot2c_f32_bf16 v78, v8, v47
  v_dot2c_f32_bf16 v79, v9, v47
  v_dot2c_f32_bf16 v80, v10, v44
  v_dot2c_f32_bf16 v81, v11, v44
  v_dot2c_f32_bf16 v82, v10, v45
  v_dot2c_f32_bf16 v83, v11, v45
  v_dot2c_f32_bf16 v84, v10, v46
  v_dot2c_f32_bf16 v85, v11, v46
  v_dot2c_f32_bf16 v86, v10, v47
  v_dot2c_f32_bf16 v87, v11, v47
  v_and_b32 v8, 0xffff, v89
  v_lshlrev_b32 v9, 16, v89
  v_and_b32 v10, 0xffff, v93
  v_lshlrev_b32 v11, 16, v93
  s_waitcnt vmcnt(5)
  v_dot2c_f32_bf16 v72, v8, v48
  v_dot2c_f32_bf16 v73, v9, v48
  v_dot2c_f32_bf16 v74, v8, v49
  v_dot2c_f32_bf16 v75, v9, v49
  v_dot2c_f32_bf16 v76, v8, v50
  v_dot2c_f32_bf16 v77, v9, v50
  v_dot2c_f32_bf16 v78, v8, v51
  v_dot2c_f32_bf16 v79, v9, v51
  v_dot2c_f32_bf16 v80, v10, v48
  v_dot2c_f32_bf16 v81, v11, v48
  v_dot2c_f32_bf16 v82, v10, v49
  v_dot2c_f32_bf16 v83, v11, v49
  v_dot2c_f32_bf16 v84, v10, v50
  v_dot2c_f32_bf16 v85, v11, v50
  v_dot2c_f32_bf16 v86, v10, v51
  v_dot2c_f32_bf16 v87, v11, v51
  v_lshrrev_b32 v8, 16, v89
  v_and_b32 v9, s73, v89
  v_lshrrev_b32 v10, 16, v93
  v_and_b32 v11, s73, v93
  s_waitcnt vmcnt(4)
  v_dot2c_f32_bf16 v72, v8, v52
  v_dot2c_f32_bf16 v73, v9, v52
  v_dot2c_f32_bf16 v74, v8, v53
  v_dot2c_f32_bf16 v75, v9, v53
  v_dot2c_f32_bf16 v76, v8, v54
  v_dot2c_f32_bf16 v77, v9, v54
  v_dot2c_f32_bf16 v78, v8, v55
  v_dot2c_f32_bf16 v79, v9, v55
  v_dot2c_f32_bf16 v80, v10, v52
  v_dot2c_f32_bf16 v81, v11, v52
  v_dot2c_f32_bf16 v82, v10, v53
  v_dot2c_f32_bf16 v83, v11, v53
  v_dot2c_f32_bf16 v84, v10, v54
  v_dot2c_f32_bf16 v85, v11, v54
  v_dot2c_f32_bf16 v86, v10, v55
  v_dot2c_f32_bf16 v87, v11, v55
  v_and_b32 v8, 0xffff, v90
  v_lshlrev_b32 v9, 16, v90
  v_and_b32 v10, 0xffff, v94
  v_lshlrev_b32 v11, 16, v94
  s_waitcnt vmcnt(3)
  v_dot2c_f32_bf16 v72, v8, v56
  v_dot2c_f32_bf16 v73, v9, v56
  v_dot2c_f32_bf16 v74, v8, v57
  v_dot2c_f32_bf16 v75, v9, v57
  v_dot2c_f32_bf16 v76, v8, v58
  v_dot2c_f32_bf16 v77, v9, v58
  v_dot2c_f32_bf16 v78, v8, v59
  v_dot2c_f32_bf16 v79, v9, v59
  v_dot2c_f32_bf16 v80, v10, v56
  v_dot2c_f32_bf16 v81, v11, v56
  v_dot2c_f32_bf16 v82, v10, v57
  v_dot2c_f32_bf16 v83, v11, v57
  v_dot2c_f32_bf16 v84, v10, v58
  v_dot2c_f32_bf16 v85, v11, v58
  v_dot2c_f32_bf16 v86, v10, v59
  v_dot2c_f32_bf16 v87, v11, v59
  v_lshrrev_b32 v8, 16, v90
  v_and_b32 v9, s73, v90
  v_lshrrev_b32 v10, 16, v94
  v_and_b32 v11, s73, v94
  s_waitcnt vmcnt(2)
  v_dot2c_f32_bf16 v72, v8, v60
  v_dot2c_f32_bf16 v73, v9, v60
  v_dot2c_f32_bf16 v74, v8, v61
  v_dot2c_f32_bf16 v75, v9, v61
  v_dot2c_f32_bf16 v76, v8, v62
  v_dot2c_f32_bf16 v77, v9, v62
  v_dot2c_f32_bf16 v78, v8, v63
  v_dot2c_f32_bf16 v79, v9, v63
  v_dot2c_f32_bf16 v80, v10, v60
  v_dot2c_f32_bf16 v81, v11, v60
  v_dot2c_f32_bf16 v82, v10, v61
  v_dot2c_f32_bf16 v83, v11, v61
  v_dot2c_f32_bf16 v84, v10, v62
  v_dot2c_f32_bf16 v85, v11, v62
  v_dot2c_f32_bf16 v86, v10, v63
  v_dot2c_f32_bf16 v87, v11, v63
  v_and_b32 v8, 0xffff, v91
  v_lshlrev_b32 v9, 16, v91
  v_and_b32 v10, 0xffff, v95
  v_lshlrev_b32 v11, 16, v95
  s_waitcnt vmcnt(1)
  v_dot2c_f32_bf16 v72, v8, v64
  v_dot2c_f32_bf16 v73, v9, v64
  v_dot2c_f32_bf16 v74, v8, v65
  v_dot2c_f32_bf16 v75, v9, v65
  v_dot2c_f32_bf16 v76, v8, v66
  v_dot2c_f32_bf16 v77, v9, v66
  v_dot2c_f32_bf16 v78, v8, v67
  v_dot2c_f32_bf16 v79, v9, v67
  v_dot2c_f32_bf16 v80, v10, v64
  v_dot2c_f32_bf16 v81, v11, v64
  v_dot2c_f32_bf16 v82, v10, v65
  v_dot2c_f32_bf16 v83, v11, v65
  v_dot2c_f32_bf16 v84, v10, v66
  v_dot2c_f32_bf16 v85, v11, v66
  v_dot2c_f32_bf16 v86, v10, v67
  v_dot2c_f32_bf16 v87, v11, v67
  v_lshrrev_b32 v8, 16, v91
  v_and_b32 v9, s73, v91
  v_lshrrev_b32 v10, 16, v95
  v_and_b32 v11, s73, v95
  s_waitcnt vmcnt(0)
  v_dot2c_f32_bf16 v72, v8, v68
  v_dot2c_f32_bf16 v73, v9, v68
  v_dot2c_f32_bf16 v74, v8, v69
  v_dot2c_f32_bf16 v75, v9, v69
  v_dot2c_f32_bf16 v76, v8, v70
  v_dot2c_f32_bf16 v77, v9, v70
  v_dot2c_f32_bf16 v78, v8, v71
  v_dot2c_f32_bf16 v79, v9, v71
  v_dot2c_f32_bf16 v80, v10, v68
  v_dot2c_f32_bf16 v81, v11, v68
  v_dot2c_f32_bf16 v82, v10, v69
  v_dot2c_f32_bf16 v83, v11, v69
  v_dot2c_f32_bf16 v84, v10, v70
  v_dot2c_f32_bf16 v85, v11, v70
  v_dot2c_f32_bf16 v86, v10, v71
  v_dot2c_f32_bf16 v87, v11, v71
  s_cmp_lt_u32 s10, s12
  s_cbranch_scc1 L_gvl
  s_nop 1
  s_setpc_b64 s[62:63]
L_serv:
  s_load_dwordx8 s[24:31], s[0:1], 32
  s_load_dwordx8 s[32:39], s[0:1], 64
  s_load_dwordx4 s[40:43], s[0:1], 96
  s_mov_b32 s72, 0xfffffffe
  s_mov_b32 s73, 0xffff0000
  s_cmp_ge_u32 s13, 4
  s_cbranch_scc1 L_team
  s_cmp_lt_u32 s13, 2
  s_cbranch_scc1 L_sv1
  s_getpc_b64 s[56:57]
L_pcc:
  s_sub_u32 s56, s56, L_pcc-adaLN_cond__sliding_block_cached__glu_gated_swiglu__decode_kernel
  s_subb_u32 s57, s57, 0
  s_lshr_b32 s3, s2, 5
  s_lshl1_add_u32 s3, s3, s13
  s_sub_u32 s3, s3, 2
  s_lshl_b32 s3, s3, 12
  v_lshl_add_u32 v2, v1, 6, s3
  v_min_u32 v2, L_end-adaLN_cond__sliding_block_cached__glu_gated_swiglu__decode_kernel, v2
  global_load_dword v3, v2, s[56:57]
  s_endpgm
L_sv1:
  v_mov_b32 v38, 0
  v_mov_b32 v4, -1
  v_mov_b32 v5, 0
  v_mov_b32 v6, 0
  v_mov_b32 v7, 0
  ds_write_b128 v38, v[4:7] offset:256
  ds_write_b64 v38, v[6:7] offset:312
  s_getreg_b32 s76, hwreg(HW_REG_XCC_ID, 0, 4)
  s_waitcnt lgkmcnt(0)
  s_load_dword s74, s[42:43], 0
  s_getpc_b64 s[56:57]
L_pc_30:
  s_lshr_b32 s3, s2, 5
  s_lshl3_add_u32 s3, s3, s8
  s_lshl_b32 s3, s3, 2
  s_add_u32 s3, s3, L_table-L_pc_30
  s_load_dword s14, s[56:57], s3
  s_barrier
  s_waitcnt lgkmcnt(0)
  s_mul_i32 s74, s74, 0x9e3779b1
  s_add_u32 s74, s74, 0x7f4a7c15
  s_bfe_u32 s32, s74, 0x80000
  s_bfe_u32 s33, s74, 0x80008
  s_bfe_u32 s34, s74, 0x80010
  s_bfe_u32 s35, s74, 0x80018
  s_cmp_eq_u32 s13, 0
  s_cbranch_scc1 L_sv0
  s_bfe_u32 s61, s14, 0x80010
  s_cmp_ge_u32 s61, 32
  s_cbranch_scc1 L_fin
  s_mov_b32 s70, 0
L_pl_31:
  ds_read_b32 v8, v38 offset:256
  s_waitcnt lgkmcnt(0)
  v_cmp_eq_u32 vcc, -1, v8
  s_cmp_eq_u64 vcc, 0
  s_cbranch_scc1 L_pld_32
  s_sleep 16
  s_add_u32 s70, s70, 1
  s_cmp_lt_u32 s70, 1048576
  s_cbranch_scc1 L_pl_31
L_pld_32:
  s_branch L_r_f2
L_sv0:
  s_add_u32 s76, s76, s74
  s_lshr_b32 s49, s2, 5
  s_lshl_b32 s50, s8, 5
  s_add_u32 s49, s49, s50
  s_lshl_b32 s49, s49, 2
  v_mov_b32 v8, s49
  v_mov_b32 v9, s76
  s_mov_b64 exec, 1
  global_store_dword v8, v9, s[42:43] offset:1024 sc1
  s_mov_b64 exec, -1
  s_lshl_b32 s54, s6, 9
  s_add_u32 s54, s54, 0
  s_lshl_b32 s55, s6, 9
  s_add_u32 s55, s55, 128
  s_lshl_b32 s56, s6, 9
  s_add_u32 s56, s56, 256
  s_mov_b32 s70, 0
L_sn_33:
  ds_read_b32 v8, v38 offset:312
  s_waitcnt lgkmcnt(0)
  v_cmp_gt_u32 vcc, 0x8, v8
  s_cmp_eq_u64 vcc, 0
  s_cbranch_scc1 L_snd_34
  s_sleep 16
  s_add_u32 s70, s70, 1
  s_cmp_lt_u32 s70, 2097152
  s_cbranch_scc1 L_sn_33
L_snd_34:
  s_load_dwordx2 s[20:21], s[42:43], s54 offset:65536 glc
  s_mov_b32 s70, 0
  s_branch L_s3wc
L_s3w:
  s_load_dwordx2 s[20:21], s[42:43], s54 offset:65536 glc
L_s3wc:
  s_waitcnt lgkmcnt(0)
  s_xor_b32 s68, s21, s74
  s_cbranch_scc0 L_s3wd
  s_sleep 8
  s_add_u32 s70, s70, 1
  s_cmp_lt_u32 s70, 262144
  s_cbranch_scc1 L_s3w
L_s3wd:
  v_mov_b32 v8, 1
  ds_write_b32 v38, v8 offset:260
  s_mov_b32 s70, 0
L_sn_35:
  ds_read_b32 v8, v38 offset:312
  s_waitcnt lgkmcnt(0)
  v_cmp_gt_u32 vcc, 0xc, v8
  s_cmp_eq_u64 vcc, 0
  s_cbranch_scc1 L_snd_36
  s_sleep 16
  s_add_u32 s70, s70, 1
  s_cmp_lt_u32 s70, 2097152
  s_cbranch_scc1 L_sn_35
L_snd_36:
  s_load_dwordx2 s[20:21], s[42:43], s54 offset:98304 glc
  s_load_dwordx2 s[24:25], s[42:43], s55 offset:98304 glc
  s_load_dwordx2 s[28:29], s[42:43], s56 offset:98304 glc
  s_mov_b32 s70, 0
  s_branch L_s3sc
L_s3s:
  s_load_dwordx2 s[20:21], s[42:43], s54 offset:98304 glc
  s_load_dwordx2 s[24:25], s[42:43], s55 offset:98304 glc
  s_load_dwordx2 s[28:29], s[42:43], s56 offset:98304 glc
L_s3sc:
  s_waitcnt lgkmcnt(0)
  s_xor_b32 s68, s21, s74
  s_xor_b32 s69, s25, s74
  s_or_b32 s68, s68, s69
  s_xor_b32 s69, s29, s74
  s_or_b32 s68, s68, s69
  s_cbranch_scc0 L_s3sd
  s_sleep 8
  s_add_u32 s70, s70, 1
  s_cmp_lt_u32 s70, 262144
  s_cbranch_scc1 L_s3s
L_s3sd:
  ds_write_b32 v38, v38 offset:256
  s_branch L_fin
L_team:
  s_and_b32 s5, s13, 3
  v_and_b32 v0, 0xff, v0
  v_mov_b32 v38, 0
  s_mov_b32 s77, 0
  s_lshr_b32 s60, s2, 5
  v_lshrrev_b32 v12, 3, v0
  v_lshlrev_b32 v12, 5, v12
  v_bfe_u32 v3, v1, 2, 1
  v_lshl_add_u32 v12, v3, 10, v12
  v_and_b32 v8, 3, v1
  v_lshl_add_u32 v37, v8, 3, v12
  v_and_b32 v12, 0xffffffdf, v12
  v_lshl_add_u32 v12, v8, 4, v12
  v_bfe_u32 v8, v1, 3, 1
  v_lshl_add_u32 v12, v8, 3, v12
  v_lshl_add_u32 v12, v3, 5, v12
  s_waitcnt lgkmcnt(0)
  s_load_dword s74, s[42:43], 0
  s_barrier
  s_cmp_ge_u32 s13, 8
  s_cbranch_scc1 L_r_mod
L_r_q:
  s_lshl3_add_u32 s61, s8, s60
  s_lshl_b32 s48, s61, 7
  s_lshl_b32 s58, s61, 8
  s_add_u32 s58, s58, 32768
  global_load_dwordx2 v[14:15], v37, s[16:17]
  s_mov_b32 s44, s22
  s_mov_b32 s45, s23
  s_mov_b32 s46, 4194304
  s_mov_b32 s47, 0x20000
  s_cmp_ge_u32 s60, 2
  s_cbranch_scc1 L_q_go
  s_mov_b32 s70, 0
L_sn_37:
  ds_read_b32 v8, v38 offset:268
  s_waitcnt lgkmcnt(0)
  v_cmp_gt_u32 vcc, 0x4, v8
  s_cmp_eq_u64 vcc, 0
  s_cbranch_scc1 L_snd_38
  s_sleep 1
  s_add_u32 s70, s70, 1
  s_cmp_lt_u32 s70, 2097152
  s_cbranch_scc1 L_sn_37
L_snd_38:
L_q_go:
  v_lshrrev_b32 v2, 3, v1
  v_and_b32 v3, 6, v2
  v_xor_b32 v3, v3, v1
  v_mul_u32_u24 v2, 8192, v2
  v_and_b32 v3, 7, v3
  v_lshl_add_u32 v2, v3, 4, v2
  s_mul_i32 s49, s5, 1048576
  s_lshl_b32 s50, s5, 14
  s_add_u32 s49, s49, s48
  s_add_u32 s50, s50, 12288
  s_add_u32 s51, s50, 16384
L_dma_39:
  s_mov_b32 m0, s50
  s_add_u32 s50, s50, 1024
  buffer_load_dwordx4 v2, s[44:47], s49 offen nt lds
  s_add_u32 s49, s49, 65536
  s_cmp_lt_u32 s50, s51
  s_cbranch_scc1 L_dma_39
L_dmae_40:
  v_mov_b32 v3, 1
  s_mov_b64 exec, 1
  ds_add_u32 v38, v3 offset:264
  s_mov_b64 exec, -1
  s_waitcnt lgkmcnt(0)
  s_mul_i32 s74, s74, 0x9e3779b1
  s_add_u32 s74, s74, 0x7f4a7c15
  v_bfe_u32 v6, v1, 2, 1
  v_lshlrev_b32 v6, 5, v6
  v_add_u32 v6, 3136, v6
  s_lshl_b32 s49, s5, 3
  v_add_u32 v5, s49, v6
  s_waitcnt vmcnt(16)
  v_lshlrev_b32 v20, 16, v14
  v_and_b32 v21, s73, v14
  v_lshlrev_b32 v22, 16, v15
  v_and_b32 v23, s73, v15
  v_add_f32 v8, v20, v21
  v_mul_f32 v9, v20, v20
  v_add_f32 v10, v22, v23
  v_mul_f32 v11, v22, v22
  v_fmac_f32 v9, v21, v21
  v_fmac_f32 v11, v23, v23
  v_add_f32 v8, v8, v10
  v_add_f32 v9, v9, v11
  s_nop 0
  v_add_f32_dpp v8, v8, v8 quad_perm:[1,0,3,2] row_mask:0xf bank_mask:0xf
  v_add_f32_dpp v9, v9, v9 quad_perm:[1,0,3,2] row_mask:0xf bank_mask:0xf
  s_nop 0
  v_add_f32_dpp v8, v8, v8 quad_perm:[2,3,0,1] row_mask:0xf bank_mask:0xf
  v_add_f32_dpp v9, v9, v9 quad_perm:[2,3,0,1] row_mask:0xf bank_mask:0xf
  s_nop 0
  v_add_f32_dpp v8, v8, v8 row_ror:8 row_mask:0xf bank_mask:0xf
  v_add_f32_dpp v9, v9, v9 row_ror:8 row_mask:0xf bank_mask:0xf
  s_nop 0
  v_mov_b32 v10, v8
  v_mov_b32 v11, v9
  s_nop 0
  v_permlane16_swap_b32 v10, v8
  v_permlane16_swap_b32 v11, v9
  v_add_f32 v8, v8, v10
  v_add_f32 v9, v9, v11
  v_mov_b32 v10, v8
  v_mov_b32 v11, v9
  s_nop 0
  v_permlane32_swap_b32 v10, v8
  v_permlane32_swap_b32 v11, v9
  v_add_f32 v8, v8, v10
  v_add_f32 v9, v9, v11
  ds_write_b64 v5, v[8:9]
  s_waitcnt vmcnt(0) lgkmcnt(0)
  s_add_u32 s77, s77, 4
  v_mov_b32 v9, 1
  s_mov_b64 exec, 1
  ds_add_u32 v38, v9 offset:312
  s_mov_b64 exec, -1
  s_mov_b32 s70, 0
L_hy_41:
  ds_read_b32 v9, v38 offset:312
  s_waitcnt lgkmcnt(0)
  v_cmp_gt_u32 vcc, s77, v9
  s_cmp_eq_u64 vcc, 0
  s_cbranch_scc1 L_hyd_42
  s_add_u32 s70, s70, 1
  s_cmp_lt_u32 s70, 2097152
  s_cbranch_scc1 L_hy_41
L_hyd_42:
  ds_read_b128 v[24:27], v6
  ds_read_b128 v[28:31], v6 offset:16
  s_waitcnt lgkmcnt(0)
  v_pk_add_f32 v[24:25], v[24:25], v[26:27]
  v_pk_add_f32 v[28:29], v[28:29], v[30:31]
  v_pk_add_f32 v[24:25], v[24:25], v[28:29]
  v_mul_f32 v8, 0x3b000000, v24
  v_mul_f32 v9, 0x3b000000, v25
  v_fma_f32 v9, -v8, v8, v9
  v_cvt_pk_bf16_f32 v8, 0, v8
  v_max_f32 v9, 0, v9
  v_cvt_pk_bf16_f32 v9, 0, v9
  v_sub_f32 v20, v20, v8
  v_sub_f32 v21, v21, v8
  v_add_f32 v9, 0x3727c5ac, v9
  v_sub_f32 v22, v22, v8
  v_sub_f32 v23, v23, v8
  v_cvt_pk_bf16_f32 v9, 0, v9
  v_cvt_pk_bf16_f32 v20, 0, v20
  v_sqrt_f32 v9, v9
  v_cvt_pk_bf16_f32 v21, 0, v21
  v_cvt_pk_bf16_f32 v9, 0, v9
  v_cvt_pk_bf16_f32 v22, 0, v22
  v_rcp_f32 v9, v9
  v_cvt_pk_bf16_f32 v23, 0, v23
  v_mul_f32 v20, v20, v9
  v_mul_f32 v21, v21, v9
  v_mul_f32 v22, v22, v9
  v_mul_f32 v23, v23, v9
  v_cvt_pk_bf16_f32 v20, 0, v20
  v_cvt_pk_bf16_f32 v21, 0, v21
  v_cvt_pk_bf16_f32 v22, 0, v22
  v_cvt_pk_bf16_f32 v23, 0, v23
  s_lshl_b32 s49, s8, 13
  s_add_u32 s49, s49, 917504
  v_lshl_add_u32 v15, v0, 4, s49
  v_add_u32 v36, 0x1000, v15
  s_mov_b64 s[64:65], -1
  s_mov_b64 s[66:67], -1
  s_mov_b64 exec, s[64:65]
  global_load_dwordx4 v[16:19], v15, s[42:43] sc1
  s_mov_b64 exec, s[66:67]
  global_load_dwordx4 v[32:35], v36, s[42:43] sc1
  s_mov_b64 exec, -1
  v_lshrrev_b32 v2, 2, v1
  v_bfe_u32 v3, v1, 1, 1
  s_lshl_b32 s49, s5, 1
  v_or_b32 v3, s49, v3
  v_and_b32 v10, 6, v2
  v_xor_b32 v3, v3, v10
  v_lshlrev_b32 v2, 7, v2
  v_lshl_add_u32 v2, v3, 4, v2
  v_and_b32 v3, 1, v1
  v_lshl_add_u32 v2, v3, 3, v2
  v_add_u32 v2, 12288, v2
  ds_read_b64_tr_b16 v[40:41], v2 offset:0
  ds_read_b64_tr_b16 v[42:43], v2 offset:2048
  ds_read_b64_tr_b16 v[44:45], v2 offset:4096
  ds_read_b64_tr_b16 v[46:47], v2 offset:6144
  ds_read_b64_tr_b16 v[48:49], v2 offset:8192
  ds_read_b64_tr_b16 v[50:51], v2 offset:10240
  ds_read_b64_tr_b16 v[52:53], v2 offset:12288
  ds_read_b64_tr_b16 v[54:55], v2 offset:14336
  ds_read_b64_tr_b16 v[56:57], v2 offset:16384
  ds_read_b64_tr_b16 v[58:59], v2 offset:18432
  ds_read_b64_tr_b16 v[60:61], v2 offset:20480
  ds_read_b64_tr_b16 v[62:63], v2 offset:22528
  s_waitcnt lgkmcnt(10)
  ds_read_b64_tr_b16 v[64:65], v2 offset:24576
  ds_read_b64_tr_b16 v[66:67], v2 offset:26624
  s_waitcnt lgkmcnt(10)
  ds_read_b64_tr_b16 v[68:69], v2 offset:28672
  ds_read_b64_tr_b16 v[70:71], v2 offset:30720
  s_waitcnt lgkmcnt(10)
  ds_read_b64_tr_b16 v[72:73], v2 offset:32768
  ds_read_b64_tr_b16 v[74:75], v2 offset:34816
  s_waitcnt lgkmcnt(10)
  ds_read_b64_tr_b16 v[76:77], v2 offset:36864
  ds_read_b64_tr_b16 v[78:79], v2 offset:38912
  s_waitcnt lgkmcnt(10)
  ds_read_b64_tr_b16 v[80:81], v2 offset:40960
  ds_read_b64_tr_b16 v[82:83], v2 offset:43008
  s_waitcnt lgkmcnt(10)
  ds_read_b64_tr_b16 v[84:85], v2 offset:45056
  ds_read_b64_tr_b16 v[86:87], v2 offset:47104
  s_waitcnt lgkmcnt(10)
  ds_read_b64_tr_b16 v[88:89], v2 offset:49152
  ds_read_b64_tr_b16 v[90:91], v2 offset:51200
  s_waitcnt lgkmcnt(10)
  ds_read_b64_tr_b16 v[92:93], v2 offset:53248
  ds_read_b64_tr_b16 v[94:95], v2 offset:55296
  s_waitcnt lgkmcnt(10)
  ds_read_b64_tr_b16 v[96:97], v2 offset:57344
  ds_read_b64_tr_b16 v[98:99], v2 offset:59392
  s_waitcnt lgkmcnt(10)
  ds_read_b64_tr_b16 v[100:101], v2 offset:61440
  ds_read_b64_tr_b16 v[102:103], v2 offset:63488
  s_waitcnt lgkmcnt(10)
  s_waitcnt lgkmcnt(0)
  v_and_b32 v13, 1, v1
  v_lshlrev_b32 v13, 14, v13
  v_lshrrev_b32 v3, 4, v1
  v_lshl_add_u32 v13, v3, 4, v13
  s_lshl_b32 s49, s5, 6
  s_add_u32 s49, s49, s58
  v_add_u32 v13, s49, v13
  v_and_b32 v14, 1, v1
  v_mul_u32_u24 v14, 1056, v14
  v_lshrrev_b32 v3, 4, v1
  v_lshl_add_u32 v14, v3, 4, v14
  v_add_u32 v14, 1024, v14
  s_mov_b32 s70, 0
  s_branch L_q_c
L_q_p:
  s_mov_b64 exec, s[64:65]
  global_load_dwordx4 v[16:19], v15, s[42:43] sc1
  s_mov_b64 exec, s[66:67]
  global_load_dwordx4 v[32:35], v36, s[42:43] sc1
  s_mov_b64 exec, -1
L_q_c:
  s_waitcnt vmcnt(0)
  v_cmp_ne_u32 s[64:65], s74, v17
  v_cmp_ne_u32 s[68:69], s74, v19
  s_or_b64 s[64:65], s[64:65], s[68:69]
  v_cmp_ne_u32 s[66:67], s74, v33
  v_cmp_ne_u32 s[68:69], s74, v35
  s_or_b64 s[66:67], s[66:67], s[68:69]
  s_or_b64 vcc, s[64:65], s[66:67]
  s_or_b32 s64, s64, 1
  s_or_b32 s66, s66, 1
  s_cmp_eq_u64 vcc, 0
  s_cbranch_scc1 L_q_ok
  s_sleep 2
  s_add_u32 s70, s70, 1
  s_cmp_lt_u32 s70, 262144
  s_cbranch_scc1 L_q_p
L_q_ok:
  v_lshlrev_b32 v28, 16, v32
  v_and_b32 v29, s73, v32
  v_lshlrev_b32 v30, 16, v34
  v_and_b32 v31, s73, v34
  v_lshlrev_b32 v24, 16, v16
  v_and_b32 v25, s73, v16
  v_lshlrev_b32 v26, 16, v18
  v_and_b32 v27, s73, v18
  v_add_f32 v28, 1.0, v28
  v_add_f32 v29, 1.0, v29
  v_add_f32 v30, 1.0, v30
  v_add_f32 v31, 1.0, v31
  v_cvt_pk_bf16_f32 v28, 0, v28
  v_cvt_pk_bf16_f32 v29, 0, v29
  v_cvt_pk_bf16_f32 v30, 0, v30
  v_cvt_pk_bf16_f32 v31, 0, v31
  v_mul_f32 v20, v20, v28
  v_mul_f32 v21, v21, v29
  v_mul_f32 v22, v22, v30
  v_mul_f32 v23, v23, v31
  v_cvt_pk_bf16_f32 v20, 0, v20
  v_cvt_pk_bf16_f32 v21, 0, v21
  v_cvt_pk_bf16_f32 v22, 0, v22
  v_cvt_pk_bf16_f32 v23, 0, v23
  v_add_f32 v20, v20, v24
  v_add_f32 v21, v21, v25
  v_add_f32 v22, v22, v26
  v_add_f32 v23, v23, v27
  v_cvt_pk_bf16_f32 v16, v20, v21
  v_cvt_pk_bf16_f32 v17, v22, v23
  ds_write_b64 v12, v[16:17] offset:1024
  s_add_u32 s77, s77, 4
  v_mov_b32 v9, 1
  s_mov_b64 exec, 1
  ds_add_u32 v38, v9 offset:312
  s_mov_b64 exec, -1
  s_mov_b32 s70, 0
L_hy_43:
  ds_read_b32 v9, v38 offset:312
  s_waitcnt lgkmcnt(0)
  v_cmp_gt_u32 vcc, s77, v9
  s_cmp_eq_u64 vcc, 0
  s_cbranch_scc1 L_hyd_44
  s_add_u32 s70, s70, 1
  s_cmp_lt_u32 s70, 2097152
  s_cbranch_scc1 L_hy_43
L_hyd_44:
  ds_read_b128 v[104:107], v14 offset:0
  ds_read_b128 v[108:111], v14 offset:64
  ds_read_b128 v[112:115], v14 offset:128
  ds_read_b128 v[116:119], v14 offset:192
  ds_read_b128 v[120:123], v14 offset:256
  ds_read_b128 v[124:127], v14 offset:320
  ds_read_b128 v[128:131], v14 offset:384
  ds_read_b128 v[132:135], v14 offset:448
  ds_read_b128 v[136:139], v14 offset:512
  ds_read_b128 v[140:143], v14 offset:576
  ds_read_b128 v[144:147], v14 offset:640
  ds_read_b128 v[148:151], v14 offset:704
  s_waitcnt lgkmcnt(11)
  v_mfma_f32_16x16x32_bf16 v[8:11], v[40:43], v[104:107], 0
  ds_read_b128 v[152:155], v14 offset:768
  s_waitcnt lgkmcnt(11)
  v_mfma_f32_16x16x32_bf16 v[8:11], v[44:47], v[108:111], v[8:11]
  ds_read_b128 v[156:159], v14 offset:832
  s_waitcnt lgkmcnt(11)
  v_mfma_f32_16x16x32_bf16 v[8:11], v[48:51], v[112:115], v[8:11]
  ds_read_b128 v[160:163], v14 offset:896
  s_waitcnt lgkmcnt(11)
  v_mfma_f32_16x16x32_bf16 v[8:11], v[52:55], v[116:119], v[8:11]
  ds_read_b128 v[164:167], v14 offset:960
  s_waitcnt lgkmcnt(11)
  v_mfma_f32_16x16x32_bf16 v[8:11], v[56:59], v[120:123], v[8:11]
  s_waitcnt lgkmcnt(10)
  v_mfma_f32_16x16x32_bf16 v[8:11], v[60:63], v[124:127], v[8:11]
  s_waitcnt lgkmcnt(9)
  v_mfma_f32_16x16x32_bf16 v[8:11], v[64:67], v[128:131], v[8:11]
  s_waitcnt lgkmcnt(8)
  v_mfma_f32_16x16x32_bf16 v[8:11], v[68:71], v[132:135], v[8:11]
  s_waitcnt lgkmcnt(7)
  v_mfma_f32_16x16x32_bf16 v[8:11], v[72:75], v[136:139], v[8:11]
  s_waitcnt lgkmcnt(6)
  v_mfma_f32_16x16x32_bf16 v[8:11], v[76:79], v[140:143], v[8:11]
  s_waitcnt lgkmcnt(5)
  v_mfma_f32_16x16x32_bf16 v[8:11], v[80:83], v[144:147], v[8:11]
  s_waitcnt lgkmcnt(4)
  v_mfma_f32_16x16x32_bf16 v[8:11], v[84:87], v[148:151], v[8:11]
  s_waitcnt lgkmcnt(3)
  v_mfma_f32_16x16x32_bf16 v[8:11], v[88:91], v[152:155], v[8:11]
  s_waitcnt lgkmcnt(2)
  v_mfma_f32_16x16x32_bf16 v[8:11], v[92:95], v[156:159], v[8:11]
  s_waitcnt lgkmcnt(1)
  v_mfma_f32_16x16x32_bf16 v[8:11], v[96:99], v[160:163], v[8:11]
  s_waitcnt lgkmcnt(0)
  v_mfma_f32_16x16x32_bf16 v[8:11], v[100:103], v[164:167], v[8:11]
  s_nop 7
  v_cvt_pk_bf16_f32 v8, v8, v9
  v_cvt_pk_bf16_f32 v10, v10, v11
  v_mov_b32 v9, s74
  v_mov_b32 v11, s74
  v_min_u32 v8, s72, v8
  v_min_u32 v10, s72, v10
  s_mov_b32 exec_lo, 0x00030003
  s_mov_b32 exec_hi, 0x00030003
  global_store_dwordx4 v13, v[8:11], s[42:43] sc1
  s_mov_b64 exec, -1
L_r_wo:
  s_xor_b32 s61, s60, 1
  s_lshl_b32 s48, s8, 19
  s_lshl_b32 s49, s61, 7
  s_add_u32 s48, s48, s49
  s_lshr_b32 s58, s8, 1
  s_lshl_b32 s58, s58, 14
  s_and_b32 s49, s8, 1
  s_lshl_b32 s49, s49, 12
  s_add_u32 s58, s58, s49
  s_lshl_b32 s49, s61, 9
  s_add_u32 s58, s58, s49
  s_add_u32 s58, s58, 2097152
  s_mov_b32 s44, s24
  s_mov_b32 s45, s25
  s_mov_b32 s46, 4194304
  s_mov_b32 s47, 0x20000
  v_lshrrev_b32 v2, 3, v1
  v_and_b32 v3, 6, v2
  v_xor_b32 v3, v3, v1
  v_mul_u32_u24 v2, 1024, v2
  v_and_b32 v3, 7, v3
  v_lshl_add_u32 v2, v3, 4, v2
  s_mul_i32 s49, s5, 131072
  s_lshl_b32 s50, s5, 14
  s_add_u32 s49, s49, s48
  s_add_u32 s50, s50, 12288
  s_add_u32 s51, s50, 16384
L_dma_45:
  s_mov_b32 m0, s50
  s_add_u32 s50, s50, 1024
  buffer_load_dwordx4 v2, s[44:47], s49 offen nt lds
  s_add_u32 s49, s49, 8192
  s_waitcnt vmcnt(2)
  s_cmp_lt_u32 s50, s51
  s_cbranch_scc1 L_dma_45
L_dmae_46:
  s_bfe_u32 s32, s74, 0x80000
  s_bfe_u32 s33, s74, 0x80008
  s_bfe_u32 s34, s74, 0x80010
  s_bfe_u32 s35, s74, 0x80018
  s_lshl2_add_u32 s49, s8, s5
  s_lshl_b32 s49, s49, 11
  s_add_u32 s49, s49, 131072
  v_lshrrev_b32 v12, 5, v1
  v_and_b32 v16, 31, v1
  v_lshlrev_b32 v15, 16, v12
  v_lshl_add_u32 v15, v16, 4, v15
  v_add_u32 v15, s49, v15
  v_mul_u32_u24 v12, 1056, v12
  v_bfe_u32 v16, v1, 3, 2
  v_lshl_add_u32 v12, v16, 6, v12
  v_and_b32 v16, 3, v1
  v_lshl_add_u32 v12, v16, 4, v12
  v_bfe_u32 v16, v1, 2, 1
  v_lshl_add_u32 v12, v16, 3, v12
  s_lshl_b32 s49, s5, 8
  v_add_u32 v12, s49, v12
  v_and_b32 v13, 1, v1
  v_lshlrev_b32 v13, 6, v13
  v_lshrrev_b32 v3, 4, v1
  v_lshl_add_u32 v13, v3, 4, v13
  s_lshl_b32 s49, s5, 7
  s_add_u32 s49, s49, s58
  v_add_u32 v13, s49, v13
  v_bfe_u32 v3, v1, 1, 1
  v_lshl_add_u32 v13, v3, 16, v13
  v_mov_b32 v36, 0xff
  global_load_dword v11, v13, s[42:43] sc1
  s_waitcnt vmcnt(0)
  s_add_u32 s77, s77, 4
  v_mov_b32 v9, 1
  s_mov_b64 exec, 1
  ds_add_u32 v38, v9 offset:312
  s_mov_b64 exec, -1
  s_mov_b32 s70, 0
L_hy_47:
  ds_read_b32 v9, v38 offset:312
  s_waitcnt lgkmcnt(0)
  v_cmp_gt_u32 vcc, s77, v9
  s_cmp_eq_u64 vcc, 0
  s_cbranch_scc1 L_hyd_48
  s_sleep 4
  s_add_u32 s70, s70, 1
  s_cmp_lt_u32 s70, 2097152
  s_cbranch_scc1 L_hy_47
L_hyd_48:
  v_lshrrev_b32 v2, 2, v1
  v_bfe_u32 v3, v1, 1, 1
  s_lshl_b32 s49, s5, 1
  v_or_b32 v3, s49, v3
  v_and_b32 v10, 6, v2
  v_xor_b32 v3, v3, v10
  v_lshlrev_b32 v2, 7, v2
  v_lshl_add_u32 v2, v3, 4, v2
  v_and_b32 v3, 1, v1
  v_lshl_add_u32 v2, v3, 3, v2
  v_add_u32 v2, 12288, v2
  ds_read_b64_tr_b16 v[40:41], v2 offset:0
  ds_read_b64_tr_b16 v[42:43], v2 offset:2048
  ds_read_b64_tr_b16 v[44:45], v2 offset:4096
  ds_read_b64_tr_b16 v[46:47], v2 offset:6144
  ds_read_b64_tr_b16 v[48:49], v2 offset:8192
  ds_read_b64_tr_b16 v[50:51], v2 offset:10240
  ds_read_b64_tr_b16 v[52:53], v2 offset:12288
  ds_read_b64_tr_b16 v[54:55], v2 offset:14336
  ds_read_b64_tr_b16 v[56:57], v2 offset:16384
  ds_read_b64_tr_b16 v[58:59], v2 offset:18432
  ds_read_b64_tr_b16 v[60:61], v2 offset:20480
  ds_read_b64_tr_b16 v[62:63], v2 offset:22528
  s_waitcnt lgkmcnt(10)
  ds_read_b64_tr_b16 v[64:65], v2 offset:24576
  ds_read_b64_tr_b16 v[66:67], v2 offset:26624
  s_waitcnt lgkmcnt(10)
  ds_read_b64_tr_b16 v[68:69], v2 offset:28672
  ds_read_b64_tr_b16 v[70:71], v2 offset:30720
  s_waitcnt lgkmcnt(10)
  ds_read_b64_tr_b16 v[72:73], v2 offset:32768
  ds_read_b64_tr_b16 v[74:75], v2 offset:34816
  s_waitcnt lgkmcnt(10)
  ds_read_b64_tr_b16 v[76:77], v2 offset:36864
  ds_read_b64_tr_b16 v[78:79], v2 offset:38912
  s_waitcnt lgkmcnt(10)
  ds_read_b64_tr_b16 v[80:81], v2 offset:40960
  ds_read_b64_tr_b16 v[82:83], v2 offset:43008
  s_waitcnt lgkmcnt(10)
  ds_read_b64_tr_b16 v[84:85], v2 offset:45056
  ds_read_b64_tr_b16 v[86:87], v2 offset:47104
  s_waitcnt lgkmcnt(10)
  ds_read_b64_tr_b16 v[88:89], v2 offset:49152
  ds_read_b64_tr_b16 v[90:91], v2 offset:51200
  s_waitcnt lgkmcnt(10)
  ds_read_b64_tr_b16 v[92:93], v2 offset:53248
  ds_read_b64_tr_b16 v[94:95], v2 offset:55296
  s_waitcnt lgkmcnt(10)
  ds_read_b64_tr_b16 v[96:97], v2 offset:57344
  ds_read_b64_tr_b16 v[98:99], v2 offset:59392
  s_waitcnt lgkmcnt(10)
  ds_read_b64_tr_b16 v[100:101], v2 offset:61440
  ds_read_b64_tr_b16 v[102:103], v2 offset:63488
  s_waitcnt lgkmcnt(10)
  s_waitcnt lgkmcnt(0)
  s_mov_b32 s70, 0
L_pl_49:
  ds_read_b32 v8, v38 offset:256
  s_waitcnt lgkmcnt(0)
  v_cmp_eq_u32 vcc, -1, v8
  s_cmp_eq_u64 vcc, 0
  s_cbranch_scc1 L_pld_50
  s_sleep 8
  s_add_u32 s70, s70, 1
  s_cmp_lt_u32 s70, 1048576
  s_cbranch_scc1 L_pl_49
L_pld_50:
  s_mov_b64 s[20:21], -1
  s_mov_b64 s[22:23], -1
  s_mov_b64 s[24:25], -1
  s_mov_b64 exec, s[20:21]
  global_load_dwordx4 v[152:155], v15, s[42:43] offset:0 sc1
  s_mov_b64 exec, s[22:23]
  global_load_dwordx4 v[156:159], v15, s[42:43] offset:512 sc1
  s_mov_b64 exec, s[24:25]
  global_load_dwordx4 v[160:163], v15, s[42:43] offset:1024 sc1
  s_mov_b64 exec, -1
  s_waitcnt vmcnt(0)
  s_mov_b32 s70, 0
  s_branch L_wo_c
L_wo_:
  s_mov_b64 exec, s[20:21]
  global_load_dwordx4 v[152:155], v15, s[42:43] offset:0 sc1
  s_mov_b64 exec, s[22:23]
  global_load_dwordx4 v[156:159], v15, s[42:43] offset:512 sc1
  s_mov_b64 exec, s[24:25]
  global_load_dwordx4 v[160:163], v15, s[42:43] offset:1024 sc1
  s_mov_b64 exec, -1
  s_waitcnt vmcnt(0)
L_wo_c:
  v_xor_b32 v136, s32, v152
  v_xor_b32 v137, s33, v153
  v_xor_b32 v138, s34, v154
  v_xor_b32 v139, s35, v155
  v_xor_b32 v140, s32, v156
  v_xor_b32 v141, s33, v157
  v_xor_b32 v142, s34, v158
  v_xor_b32 v143, s35, v159
  v_xor_b32 v144, s32, v160
  v_xor_b32 v145, s33, v161
  v_xor_b32 v146, s34, v162
  v_xor_b32 v147, s35, v163
  v_or3_b32 v28, v136, v137, v138
  v_or3_b32 v29, v140, v141, v142
  v_or3_b32 v30, v144, v145, v146
  v_or_b32 v28, v28, v139
  v_or_b32 v29, v29, v143
  v_or_b32 v30, v30, v147
  v_cmp_ne_u32_sdwa s[20:21], v28, v38 src0_sel:BYTE_0 src1_sel:DWORD
  v_cmp_ne_u32_sdwa s[22:23], v29, v38 src0_sel:BYTE_0 src1_sel:DWORD
  v_cmp_ne_u32_sdwa s[24:25], v30, v38 src0_sel:BYTE_0 src1_sel:DWORD
  v_or_b32 v136, 0x80, v136
  v_or_b32 v137, 0x80, v137
  v_or_b32 v138, 0x80, v138
  v_or_b32 v139, 0x80, v139
  v_or_b32 v140, 0x80, v140
  v_or_b32 v141, 0x80, v141
  v_or_b32 v142, 0x80, v142
  v_or_b32 v143, 0x80, v143
  v_or_b32 v144, 0x80, v144
  v_or_b32 v145, 0x80, v145
  v_or_b32 v146, 0x80, v146
  v_or_b32 v147, 0x80, v147
  v_pk_add_f32 v[16:17], v[136:137], v[140:141]
  v_pk_add_f32 v[18:19], v[138:139], v[142:143]
  v_pk_add_f32 v[16:17], v[16:17], v[144:145]
  v_pk_add_f32 v[18:19], v[18:19], v[146:147]
  s_mov_b64 vcc, s[20:21]
  s_or_b64 vcc, vcc, s[22:23]
  s_or_b64 vcc, vcc, s[24:25]
  s_or_b32 s20, s20, 1
  s_or_b32 s22, s22, 1
  s_or_b32 s24, s24, 1
  s_cmp_eq_u64 vcc, 0
  s_cbranch_scc1 L_wo_ok
  s_add_u32 s70, s70, 1
  s_cmp_lt_u32 s70, 262144
  s_cbranch_scc1 L_wo_
L_wo_ok:
  v_cvt_pk_bf16_f32 v8, v16, v17
  v_cvt_pk_bf16_f32 v9, v18, v19
  ds_write_b64 v12, v[8:9] offset:1024
  s_add_u32 s77, s77, 4
  v_mov_b32 v3, 1
  s_mov_b64 exec, 1
  ds_add_u32 v38, v3 offset:312
  s_mov_b64 exec, -1
  s_mov_b32 s70, 0
L_hy_51:
  ds_read_b32 v3, v38 offset:312
  ds_read_b128 v[104:107], v14 offset:0
  ds_read_b128 v[108:111], v14 offset:64
  ds_read_b128 v[112:115], v14 offset:128
  ds_read_b128 v[116:119], v14 offset:192
  s_waitcnt lgkmcnt(4)
  v_cmp_gt_u32 vcc, s77, v3
  s_cmp_eq_u64 vcc, 0
  s_cbranch_scc1 L_hyd_52
  s_waitcnt lgkmcnt(0)
  s_add_u32 s70, s70, 1
  s_cmp_lt_u32 s70, 2097152
  s_cbranch_scc1 L_hy_51
L_hyd_52:
  ds_read_b128 v[120:123], v14 offset:256
  ds_read_b128 v[124:127], v14 offset:320
  ds_read_b128 v[128:131], v14 offset:384
  ds_read_b128 v[132:135], v14 offset:448
  ds_read_b128 v[136:139], v14 offset:512
  ds_read_b128 v[140:143], v14 offset:576
  ds_read_b128 v[144:147], v14 offset:640
  ds_read_b128 v[148:151], v14 offset:704
  s_waitcnt lgkmcnt(11)
  v_mfma_f32_16x16x32_bf16 v[8:11], v[40:43], v[104:107], 0
  s_waitcnt lgkmcnt(10)
  v_mfma_f32_16x16x32_bf16 v[8:11], v[44:47], v[108:111], v[8:11]
  ds_read_b128 v[104:107], v14 offset:768
  s_waitcnt lgkmcnt(10)
  v_mfma_f32_16x16x32_bf16 v[8:11], v[48:51], v[112:115], v[8:11]
  ds_read_b128 v[108:111], v14 offset:832
  s_waitcnt lgkmcnt(10)
  v_mfma_f32_16x16x32_bf16 v[8:11], v[52:55], v[116:119], v[8:11]
  ds_read_b128 v[112:115], v14 offset:896
  s_waitcnt lgkmcnt(10)
  v_mfma_f32_16x16x32_bf16 v[8:11], v[56:59], v[120:123], v[8:11]
  ds_read_b128 v[116:119], v14 offset:960
  s_waitcnt lgkmcnt(10)
  v_mfma_f32_16x16x32_bf16 v[8:11], v[60:63], v[124:127], v[8:11]
  s_waitcnt lgkmcnt(9)
  v_mfma_f32_16x16x32_bf16 v[8:11], v[64:67], v[128:131], v[8:11]
  s_waitcnt lgkmcnt(8)
  v_mfma_f32_16x16x32_bf16 v[8:11], v[68:71], v[132:135], v[8:11]
  s_waitcnt lgkmcnt(7)
  v_mfma_f32_16x16x32_bf16 v[8:11], v[72:75], v[136:139], v[8:11]
  s_waitcnt lgkmcnt(6)
  v_mfma_f32_16x16x32_bf16 v[8:11], v[76:79], v[140:143], v[8:11]
  s_waitcnt lgkmcnt(5)
  v_mfma_f32_16x16x32_bf16 v[8:11], v[80:83], v[144:147], v[8:11]
  s_waitcnt lgkmcnt(4)
  v_mfma_f32_16x16x32_bf16 v[8:11], v[84:87], v[148:151], v[8:11]
  s_waitcnt lgkmcnt(3)
  v_mfma_f32_16x16x32_bf16 v[8:11], v[88:91], v[104:107], v[8:11]
  s_waitcnt lgkmcnt(2)
  v_mfma_f32_16x16x32_bf16 v[8:11], v[92:95], v[108:111], v[8:11]
  s_waitcnt lgkmcnt(1)
  v_mfma_f32_16x16x32_bf16 v[8:11], v[96:99], v[112:115], v[8:11]
  s_waitcnt lgkmcnt(0)
  v_mfma_f32_16x16x32_bf16 v[8:11], v[100:103], v[116:119], v[8:11]
  s_nop 7
  v_bfi_b32 v8, v36, s32, v8
  v_bfi_b32 v9, v36, s33, v9
  v_bfi_b32 v10, v36, s34, v10
  v_bfi_b32 v11, v36, s35, v11
  s_mov_b32 exec_lo, 0x000f000f
  s_mov_b32 exec_hi, exec_lo
  global_store_dwordx4 v13, v[8:11], s[42:43] sc1
  v_mov_b32 v3, 1
  s_mov_b64 exec, 1
  ds_add_u32 v38, v3 offset:264
  s_mov_b64 exec, -1
  s_branch L_fin
L_r_mod:
  global_load_dwordx2 v[14:15], v37, s[34:35]
  s_mov_b32 s44, s36
  s_mov_b32 s45, s37
  s_mov_b32 s46, 3145728
  s_mov_b32 s47, 0x20000
  s_cmp_ge_u32 s60, 2
  s_cbranch_scc1 L_mod2
  s_lshl1_add_u32 s61, s8, s60
  s_lshl_b32 s48, s61, 7
  s_lshl_b32 s58, s61, 9
  s_add_u32 s58, s58, 917504
  v_lshrrev_b32 v2, 3, v1
  v_and_b32 v3, 6, v2
  v_xor_b32 v3, v3, v1
  v_mul_u32_u24 v2, 6144, v2
  v_and_b32 v3, 7, v3
  v_lshl_add_u32 v2, v3, 4, v2
  s_mul_i32 s49, s5, 786432
  s_lshl_b32 s50, s5, 14
  s_add_u32 s49, s49, s48
  s_add_u32 s50, s50, 77824
  s_add_u32 s51, s50, 16384
L_dma_53:
  s_mov_b32 m0, s50
  s_add_u32 s50, s50, 1024
  buffer_load_dwordx4 v2, s[44:47], s49 offen nt lds
  s_add_u32 s49, s49, 49152
  s_cmp_lt_u32 s50, s51
  s_cbranch_scc1 L_dma_53
L_dmae_54:
  v_mov_b32 v3, 1
  s_mov_b64 exec, 1
  ds_add_u32 v38, v3 offset:268
  s_mov_b64 exec, -1
  s_getpc_b64 s[56:57]
L_pc_55:
  s_lshr_b32 s3, s2, 5
  s_lshl3_add_u32 s3, s3, s8
  s_lshl_b32 s3, s3, 2
  s_add_u32 s3, s3, L_table-L_pc_55
  s_load_dword s14, s[56:57], s3
  s_waitcnt lgkmcnt(0)
  s_mul_i32 s74, s74, 0x9e3779b1
  s_add_u32 s74, s74, 0x7f4a7c15
  s_waitcnt vmcnt(16)
  v_lshlrev_b32 v16, 16, v14
  v_and_b32 v17, s73, v14
  v_lshlrev_b32 v18, 16, v15
  v_and_b32 v19, s73, v15
  v_mul_f32 v20, 0xbfb8aa3b, v16
  v_mul_f32 v21, 0xbfb8aa3b, v17
  v_mul_f32 v22, 0xbfb8aa3b, v18
  v_mul_f32 v23, 0xbfb8aa3b, v19
  v_exp_f32 v20, v20
  v_exp_f32 v21, v21
  v_exp_f32 v22, v22
  v_exp_f32 v23, v23
  s_nop 0
  v_add_f32 v20, 1.0, v20
  v_add_f32 v21, 1.0, v21
  v_add_f32 v22, 1.0, v22
  v_add_f32 v23, 1.0, v23
  v_rcp_f32 v20, v20
  v_rcp_f32 v21, v21
  v_rcp_f32 v22, v22
  v_rcp_f32 v23, v23
  s_nop 0
  v_mul_f32 v16, v16, v20
  v_mul_f32 v17, v17, v21
  v_mul_f32 v18, v18, v22
  v_mul_f32 v19, v19, v23
  v_cvt_pk_bf16_f32 v14, v16, v17
  v_cvt_pk_bf16_f32 v15, v18, v19
  ds_write_b64 v12, v[14:15] offset:3200
  v_and_b32 v13, 1, v1
  v_lshlrev_b32 v13, 6, v13
  v_lshrrev_b32 v3, 4, v1
  v_lshl_add_u32 v13, v3, 4, v13
  s_lshl_b32 s49, s5, 7
  s_add_u32 s49, s49, s58
  v_add_u32 v13, s49, v13
  v_bfe_u32 v3, v1, 1, 3
  v_lshl_add_u32 v13, v3, 13, v13
  v_and_b32 v14, 1, v1
  v_mul_u32_u24 v14, 1056, v14
  v_lshrrev_b32 v3, 4, v1
  v_lshl_add_u32 v14, v3, 4, v14
  v_add_u32 v14, 3200, v14
  v_lshrrev_b32 v2, 2, v1
  v_bfe_u32 v3, v1, 1, 1
  s_lshl_b32 s49, s5, 1
  v_or_b32 v3, s49, v3
  v_and_b32 v10, 6, v2
  v_xor_b32 v3, v3, v10
  v_lshlrev_b32 v2, 7, v2
  v_lshl_add_u32 v2, v3, 4, v2
  v_and_b32 v3, 1, v1
  v_lshl_add_u32 v2, v3, 3, v2
  v_add_u32 v2, 77824, v2
  s_waitcnt vmcnt(0) lgkmcnt(0)
  s_add_u32 s77, s77, 4
  v_mov_b32 v9, 1
  s_mov_b64 exec, 1
  ds_add_u32 v38, v9 offset:316
  s_mov_b64 exec, -1
  s_mov_b32 s70, 0
L_hy_56:
  ds_read_b32 v9, v38 offset:316
  s_waitcnt lgkmcnt(0)
  v_cmp_gt_u32 vcc, s77, v9
  s_cmp_eq_u64 vcc, 0
  s_cbranch_scc1 L_hyd_57
  s_add_u32 s70, s70, 1
  s_cmp_lt_u32 s70, 2097152
  s_cbranch_scc1 L_hy_56
L_hyd_57:
  ds_read_b64_tr_b16 v[40:41], v2 offset:0
  ds_read_b64_tr_b16 v[42:43], v2 offset:2048
  ds_read_b128 v[104:107], v14 offset:0
  ds_read_b64_tr_b16 v[44:45], v2 offset:4096
  ds_read_b64_tr_b16 v[46:47], v2 offset:6144
  ds_read_b128 v[108:111], v14 offset:64
  ds_read_b64_tr_b16 v[48:49], v2 offset:8192
  ds_read_b64_tr_b16 v[50:51], v2 offset:10240
  ds_read_b128 v[112:115], v14 offset:128
  ds_read_b64_tr_b16 v[52:53], v2 offset:12288
  ds_read_b64_tr_b16 v[54:55], v2 offset:14336
  ds_read_b128 v[116:119], v14 offset:192
  ds_read_b64_tr_b16 v[56:57], v2 offset:16384
  ds_read_b64_tr_b16 v[58:59], v2 offset:18432
  ds_read_b128 v[120:123], v14 offset:256
  s_waitcnt lgkmcnt(12)
  v_mfma_f32_16x16x32_bf16 v[8:11], v[40:43], v[104:107], 0
  ds_read_b64_tr_b16 v[60:61], v2 offset:20480
  ds_read_b64_tr_b16 v[62:63], v2 offset:22528
  ds_read_b128 v[124:127], v14 offset:320
  s_waitcnt lgkmcnt(12)
  v_mfma_f32_16x16x32_bf16 v[8:11], v[44:47], v[108:111], v[8:11]
  ds_read_b64_tr_b16 v[64:65], v2 offset:24576
  ds_read_b64_tr_b16 v[66:67], v2 offset:26624
  ds_read_b128 v[128:131], v14 offset:384
  s_waitcnt lgkmcnt(12)
  v_mfma_f32_16x16x32_bf16 v[8:11], v[48:51], v[112:115], v[8:11]
  ds_read_b64_tr_b16 v[68:69], v2 offset:28672
  ds_read_b64_tr_b16 v[70:71], v2 offset:30720
  ds_read_b128 v[132:135], v14 offset:448
  s_waitcnt lgkmcnt(12)
  v_mfma_f32_16x16x32_bf16 v[8:11], v[52:55], v[116:119], v[8:11]
  ds_read_b64_tr_b16 v[72:73], v2 offset:32768
  ds_read_b64_tr_b16 v[74:75], v2 offset:34816
  ds_read_b128 v[136:139], v14 offset:512
  s_waitcnt lgkmcnt(12)
  v_mfma_f32_16x16x32_bf16 v[8:11], v[56:59], v[120:123], v[8:11]
  ds_read_b64_tr_b16 v[76:77], v2 offset:36864
  ds_read_b64_tr_b16 v[78:79], v2 offset:38912
  ds_read_b128 v[140:143], v14 offset:576
  s_waitcnt lgkmcnt(12)
  v_mfma_f32_16x16x32_bf16 v[8:11], v[60:63], v[124:127], v[8:11]
  ds_read_b64_tr_b16 v[80:81], v2 offset:40960
  ds_read_b64_tr_b16 v[82:83], v2 offset:43008
  ds_read_b128 v[144:147], v14 offset:640
  s_waitcnt lgkmcnt(12)
  v_mfma_f32_16x16x32_bf16 v[8:11], v[64:67], v[128:131], v[8:11]
  ds_read_b64_tr_b16 v[84:85], v2 offset:45056
  ds_read_b64_tr_b16 v[86:87], v2 offset:47104
  ds_read_b128 v[148:151], v14 offset:704
  s_waitcnt lgkmcnt(12)
  v_mfma_f32_16x16x32_bf16 v[8:11], v[68:71], v[132:135], v[8:11]
  ds_read_b64_tr_b16 v[88:89], v2 offset:49152
  ds_read_b64_tr_b16 v[90:91], v2 offset:51200
  ds_read_b128 v[152:155], v14 offset:768
  s_waitcnt lgkmcnt(12)
  v_mfma_f32_16x16x32_bf16 v[8:11], v[72:75], v[136:139], v[8:11]
  ds_read_b64_tr_b16 v[92:93], v2 offset:53248
  ds_read_b64_tr_b16 v[94:95], v2 offset:55296
  ds_read_b128 v[156:159], v14 offset:832
  s_waitcnt lgkmcnt(12)
  v_mfma_f32_16x16x32_bf16 v[8:11], v[76:79], v[140:143], v[8:11]
  ds_read_b64_tr_b16 v[96:97], v2 offset:57344
  ds_read_b64_tr_b16 v[98:99], v2 offset:59392
  ds_read_b128 v[160:163], v14 offset:896
  s_waitcnt lgkmcnt(12)
  v_mfma_f32_16x16x32_bf16 v[8:11], v[80:83], v[144:147], v[8:11]
  ds_read_b64_tr_b16 v[100:101], v2 offset:61440
  ds_read_b64_tr_b16 v[102:103], v2 offset:63488
  ds_read_b128 v[164:167], v14 offset:960
  s_waitcnt lgkmcnt(12)
  v_mfma_f32_16x16x32_bf16 v[8:11], v[84:87], v[148:151], v[8:11]
  s_waitcnt lgkmcnt(9)
  v_mfma_f32_16x16x32_bf16 v[8:11], v[88:91], v[152:155], v[8:11]
  s_waitcnt lgkmcnt(6)
  v_mfma_f32_16x16x32_bf16 v[8:11], v[92:95], v[156:159], v[8:11]
  s_waitcnt lgkmcnt(3)
  v_mfma_f32_16x16x32_bf16 v[8:11], v[96:99], v[160:163], v[8:11]
  s_waitcnt lgkmcnt(0)
  v_mfma_f32_16x16x32_bf16 v[8:11], v[100:103], v[164:167], v[8:11]
  s_nop 7
  v_cvt_pk_bf16_f32 v8, v8, v9
  v_cvt_pk_bf16_f32 v10, v10, v11
  v_mov_b32 v9, s74
  v_mov_b32 v11, s74
  global_store_dwordx4 v13, v[8:11], s[42:43] sc1
  s_mov_b64 exec, -1
  s_add_u32 s77, s77, 4
  v_mov_b32 v9, 1
  s_mov_b64 exec, 1
  ds_add_u32 v38, v9 offset:316
  s_mov_b64 exec, -1
  s_mov_b32 s70, 0
L_hy_58:
  ds_read_b32 v9, v38 offset:316
  s_waitcnt lgkmcnt(0)
  v_cmp_gt_u32 vcc, s77, v9
  s_cmp_eq_u64 vcc, 0
  s_cbranch_scc1 L_hyd_59
  s_add_u32 s70, s70, 1
  s_cmp_lt_u32 s70, 2097152
  s_cbranch_scc1 L_hy_58
L_hyd_59:
  s_branch L_mod3
L_mod2:
  s_getpc_b64 s[56:57]
L_pc_60:
  s_lshr_b32 s3, s2, 5
  s_lshl3_add_u32 s3, s3, s8
  s_lshl_b32 s3, s3, 2
  s_add_u32 s3, s3, L_table-L_pc_60
  s_load_dword s14, s[56:57], s3
  s_waitcnt lgkmcnt(0)
  s_mul_i32 s74, s74, 0x9e3779b1
  s_add_u32 s74, s74, 0x7f4a7c15
  s_waitcnt vmcnt(0)
  v_lshlrev_b32 v16, 16, v14
  v_and_b32 v17, s73, v14
  v_lshlrev_b32 v18, 16, v15
  v_and_b32 v19, s73, v15
  v_mul_f32 v20, 0xbfb8aa3b, v16
  v_mul_f32 v21, 0xbfb8aa3b, v17
  v_mul_f32 v22, 0xbfb8aa3b, v18
  v_mul_f32 v23, 0xbfb8aa3b, v19
  v_exp_f32 v20, v20
  v_exp_f32 v21, v21
  v_exp_f32 v22, v22
  v_exp_f32 v23, v23
  s_nop 0
  v_add_f32 v20, 1.0, v20
  v_add_f32 v21, 1.0, v21
  v_add_f32 v22, 1.0, v22
  v_add_f32 v23, 1.0, v23
  v_rcp_f32 v20, v20
  v_rcp_f32 v21, v21
  v_rcp_f32 v22, v22
  v_rcp_f32 v23, v23
  s_nop 0
  v_mul_f32 v16, v16, v20
  v_mul_f32 v17, v17, v21
  v_mul_f32 v18, v18, v22
  v_mul_f32 v19, v19, v23
  v_cvt_pk_bf16_f32 v14, v16, v17
  v_cvt_pk_bf16_f32 v15, v18, v19
  ds_write_b64 v12, v[14:15] offset:3200
L_mod3:
  s_mov_b32 s70, 0
L_sn_61:
  ds_read_b32 v8, v38 offset:264
  s_waitcnt lgkmcnt(0)
  v_cmp_gt_u32 vcc, 0x4, v8
  s_cmp_eq_u64 vcc, 0
  s_cbranch_scc1 L_snd_62
  s_sleep 4
  s_add_u32 s70, s70, 1
  s_cmp_lt_u32 s70, 2097152
  s_cbranch_scc1 L_sn_61
L_snd_62:
  s_and_b32 s61, s14, 0xff
  s_cmp_ge_u32 s61, 48
  s_cbranch_scc1 L_r_f1
  s_mov_b32 s70, 0
L_sn_63:
  ds_read_b32 v8, v38 offset:312
  s_waitcnt lgkmcnt(0)
  v_cmp_gt_u32 vcc, 0x8, v8
  s_cmp_eq_u64 vcc, 0
  s_cbranch_scc1 L_snd_64
  s_sleep 4
  s_add_u32 s70, s70, 1
  s_cmp_lt_u32 s70, 2097152
  s_cbranch_scc1 L_sn_63
L_snd_64:
  s_and_b32 s61, s14, 0xff
L_mod4:
  s_cmp_ge_u32 s61, 48
  s_cbranch_scc1 L_r_f1
  s_lshl_b32 s48, s61, 7
  s_lshl_b32 s58, s61, 9
  s_add_u32 s58, s58, 4096
  v_lshrrev_b32 v2, 3, v1
  v_and_b32 v3, 6, v2
  v_xor_b32 v3, v3, v1
  v_mul_u32_u24 v2, 6144, v2
  v_and_b32 v3, 7, v3
  v_lshl_add_u32 v2, v3, 4, v2
  s_mul_i32 s49, s5, 786432
  s_lshl_b32 s50, s5, 14
  s_add_u32 s49, s49, s48
  s_add_u32 s50, s50, 77824
  s_add_u32 s51, s50, 16384
L_dma_65:
  s_mov_b32 m0, s50
  s_add_u32 s50, s50, 1024
  buffer_load_dwordx4 v2, s[44:47], s49 offen nt lds
  s_add_u32 s49, s49, 49152
  s_waitcnt vmcnt(5)
  s_cmp_lt_u32 s50, s51
  s_cbranch_scc1 L_dma_65
L_dmae_66:
  v_and_b32 v13, 1, v1
  v_lshlrev_b32 v13, 6, v13
  v_lshrrev_b32 v3, 4, v1
  v_lshl_add_u32 v13, v3, 4, v13
  s_lshl_b32 s49, s5, 7
  s_add_u32 s49, s49, s58
  v_add_u32 v13, s49, v13
  v_and_b32 v14, 1, v1
  v_mul_u32_u24 v14, 1056, v14
  v_lshrrev_b32 v3, 4, v1
  v_lshl_add_u32 v14, v3, 4, v14
  v_add_u32 v14, 3200, v14
  v_lshrrev_b32 v2, 2, v1
  v_bfe_u32 v3, v1, 1, 1
  s_lshl_b32 s49, s5, 1
  v_or_b32 v3, s49, v3
  v_and_b32 v10, 6, v2
  v_xor_b32 v3, v3, v10
  v_lshlrev_b32 v2, 7, v2
  v_lshl_add_u32 v2, v3, 4, v2
  v_and_b32 v3, 1, v1
  v_lshl_add_u32 v2, v3, 3, v2
  v_add_u32 v2, 77824, v2
  s_waitcnt vmcnt(0) lgkmcnt(0)
  s_add_u32 s77, s77, 4
  v_mov_b32 v9, 1
  s_mov_b64 exec, 1
  ds_add_u32 v38, v9 offset:316
  s_mov_b64 exec, -1
  s_mov_b32 s70, 0
L_hy_67:
  ds_read_b32 v9, v38 offset:316
  s_waitcnt lgkmcnt(0)
  v_cmp_gt_u32 vcc, s77, v9
  s_cmp_eq_u64 vcc, 0
  s_cbranch_scc1 L_hyd_68
  s_sleep 4
  s_add_u32 s70, s70, 1
  s_cmp_lt_u32 s70, 2097152
  s_cbranch_scc1 L_hy_67
L_hyd_68:
  ds_read_b64_tr_b16 v[40:41], v2 offset:0
  ds_read_b64_tr_b16 v[42:43], v2 offset:2048
  ds_read_b128 v[104:107], v14 offset:0
  ds_read_b64_tr_b16 v[44:45], v2 offset:4096
  ds_read_b64_tr_b16 v[46:47], v2 offset:6144
  ds_read_b128 v[108:111], v14 offset:64
  ds_read_b64_tr_b16 v[48:49], v2 offset:8192
  ds_read_b64_tr_b16 v[50:51], v2 offset:10240
  ds_read_b128 v[112:115], v14 offset:128
  ds_read_b64_tr_b16 v[52:53], v2 offset:12288
  ds_read_b64_tr_b16 v[54:55], v2 offset:14336
  ds_read_b128 v[116:119], v14 offset:192
  ds_read_b64_tr_b16 v[56:57], v2 offset:16384
  ds_read_b64_tr_b16 v[58:59], v2 offset:18432
  ds_read_b128 v[120:123], v14 offset:256
  s_waitcnt lgkmcnt(12)
  v_mfma_f32_16x16x32_bf16 v[8:11], v[40:43], v[104:107], 0
  ds_read_b64_tr_b16 v[60:61], v2 offset:20480
  ds_read_b64_tr_b16 v[62:63], v2 offset:22528
  ds_read_b128 v[124:127], v14 offset:320
  s_waitcnt lgkmcnt(12)
  v_mfma_f32_16x16x32_bf16 v[8:11], v[44:47], v[108:111], v[8:11]
  ds_read_b64_tr_b16 v[64:65], v2 offset:24576
  ds_read_b64_tr_b16 v[66:67], v2 offset:26624
  ds_read_b128 v[128:131], v14 offset:384
  s_waitcnt lgkmcnt(12)
  v_mfma_f32_16x16x32_bf16 v[8:11], v[48:51], v[112:115], v[8:11]
  ds_read_b64_tr_b16 v[68:69], v2 offset:28672
  ds_read_b64_tr_b16 v[70:71], v2 offset:30720
  ds_read_b128 v[132:135], v14 offset:448
  s_waitcnt lgkmcnt(12)
  v_mfma_f32_16x16x32_bf16 v[8:11], v[52:55], v[116:119], v[8:11]
  ds_read_b64_tr_b16 v[72:73], v2 offset:32768
  ds_read_b64_tr_b16 v[74:75], v2 offset:34816
  ds_read_b128 v[136:139], v14 offset:512
  s_waitcnt lgkmcnt(12)
  v_mfma_f32_16x16x32_bf16 v[8:11], v[56:59], v[120:123], v[8:11]
  ds_read_b64_tr_b16 v[76:77], v2 offset:36864
  ds_read_b64_tr_b16 v[78:79], v2 offset:38912
  ds_read_b128 v[140:143], v14 offset:576
  s_waitcnt lgkmcnt(12)
  v_mfma_f32_16x16x32_bf16 v[8:11], v[60:63], v[124:127], v[8:11]
  ds_read_b64_tr_b16 v[80:81], v2 offset:40960
  ds_read_b64_tr_b16 v[82:83], v2 offset:43008
  ds_read_b128 v[144:147], v14 offset:640
  s_waitcnt lgkmcnt(12)
  v_mfma_f32_16x16x32_bf16 v[8:11], v[64:67], v[128:131], v[8:11]
  ds_read_b64_tr_b16 v[84:85], v2 offset:45056
  ds_read_b64_tr_b16 v[86:87], v2 offset:47104
  ds_read_b128 v[148:151], v14 offset:704
  s_waitcnt lgkmcnt(12)
  v_mfma_f32_16x16x32_bf16 v[8:11], v[68:71], v[132:135], v[8:11]
  ds_read_b64_tr_b16 v[88:89], v2 offset:49152
  ds_read_b64_tr_b16 v[90:91], v2 offset:51200
  ds_read_b128 v[152:155], v14 offset:768
  s_waitcnt lgkmcnt(12)
  v_mfma_f32_16x16x32_bf16 v[8:11], v[72:75], v[136:139], v[8:11]
  ds_read_b64_tr_b16 v[92:93], v2 offset:53248
  ds_read_b64_tr_b16 v[94:95], v2 offset:55296
  ds_read_b128 v[156:159], v14 offset:832
  s_waitcnt lgkmcnt(12)
  v_mfma_f32_16x16x32_bf16 v[8:11], v[76:79], v[140:143], v[8:11]
  ds_read_b64_tr_b16 v[96:97], v2 offset:57344
  ds_read_b64_tr_b16 v[98:99], v2 offset:59392
  ds_read_b128 v[160:163], v14 offset:896
  s_waitcnt lgkmcnt(12)
  v_mfma_f32_16x16x32_bf16 v[8:11], v[80:83], v[144:147], v[8:11]
  ds_read_b64_tr_b16 v[100:101], v2 offset:61440
  ds_read_b64_tr_b16 v[102:103], v2 offset:63488
  ds_read_b128 v[164:167], v14 offset:960
  s_waitcnt lgkmcnt(12)
  v_mfma_f32_16x16x32_bf16 v[8:11], v[84:87], v[148:151], v[8:11]
  s_waitcnt lgkmcnt(9)
  v_mfma_f32_16x16x32_bf16 v[8:11], v[88:91], v[152:155], v[8:11]
  s_waitcnt lgkmcnt(6)
  v_mfma_f32_16x16x32_bf16 v[8:11], v[92:95], v[156:159], v[8:11]
  s_waitcnt lgkmcnt(3)
  v_mfma_f32_16x16x32_bf16 v[8:11], v[96:99], v[160:163], v[8:11]
  s_waitcnt lgkmcnt(0)
  v_mfma_f32_16x16x32_bf16 v[8:11], v[100:103], v[164:167], v[8:11]
  s_nop 7
  v_cvt_pk_bf16_f32 v8, v8, v9
  v_cvt_pk_bf16_f32 v10, v10, v11
  v_mov_b32 v9, s74
  v_mov_b32 v11, s74
  s_mov_b32 exec_lo, 0x00030003
  s_mov_b32 exec_hi, 0x00030003
  global_store_dwordx4 v13, v[8:11], s[42:43] sc1
  s_mov_b64 exec, -1
  s_add_u32 s77, s77, 4
  v_mov_b32 v9, 1
  s_mov_b64 exec, 1
  ds_add_u32 v38, v9 offset:316
  s_mov_b64 exec, -1
  s_mov_b32 s70, 0
L_hy_69:
  ds_read_b32 v9, v38 offset:316
  s_waitcnt lgkmcnt(0)
  v_cmp_gt_u32 vcc, s77, v9
  s_cmp_eq_u64 vcc, 0
  s_cbranch_scc1 L_hyd_70
  s_add_u32 s70, s70, 1
  s_cmp_lt_u32 s70, 2097152
  s_cbranch_scc1 L_hy_69
L_hyd_70:
  s_lshr_b32 s61, s14, 24
  s_or_b32 s14, s14, 0xff000000
  s_branch L_mod4
L_r_f1:
  s_bfe_u32 s61, s14, 0x80008
  s_cmp_ge_u32 s61, 43
  s_cbranch_scc1 L_fin
  s_lshl_b32 s48, s61, 6
  s_lshl_b32 s58, s61, 7
  s_add_u32 s58, s58, 1572864
  s_cmp_lt_u32 s5, 2
  s_cselect_b32 s44, s28, s30
  s_cselect_b32 s45, s29, s31
  s_mov_b32 s46, 1409024
  s_and_b32 s54, s61, 1
  v_lshrrev_b32 v2, 2, v1
  v_mul_u32_u24 v2, 5504, v2
  s_and_b32 s49, s5, 2
  s_or_b32 s49, s49, s54
  v_xor_b32 v3, s49, v1
  v_and_b32 v3, 3, v3
  v_lshl_add_u32 v2, v3, 4, v2
  s_and_b32 s55, s5, 1
  s_mul_i32 s49, s55, 704512
  s_add_u32 s49, s49, s48
  s_mul_i32 s50, s54, 2752
  s_add_u32 s49, s49, s50
  s_lshr_b32 s50, s5, 1
  s_lshl_b32 s50, s50, 15
  s_lshl_b32 s54, s54, 14
  s_add_u32 s50, s50, s54
  s_lshl_b32 s55, s55, 13
  s_add_u32 s50, s50, s55
  s_add_u32 s50, s50, 77824
  s_mov_b32 s70, 0
L_sn_71:
  ds_read_b32 v8, v38 offset:260
  s_waitcnt lgkmcnt(0)
  v_cmp_gt_u32 vcc, 0x1, v8
  s_cmp_eq_u64 vcc, 0
  s_cbranch_scc1 L_snd_72
  s_sleep 8
  s_add_u32 s70, s70, 1
  s_cmp_lt_u32 s70, 2097152
  s_cbranch_scc1 L_sn_71
L_snd_72:
  s_add_u32 s51, s50, 8192
L_dma_73:
  s_mov_b32 m0, s50
  s_add_u32 s50, s50, 1024
  buffer_load_dwordx4 v2, s[44:47], s49 offen  lds
  s_add_u32 s49, s49, 88064
  s_waitcnt vmcnt(3)
  s_cmp_lt_u32 s50, s51
  s_cbranch_scc1 L_dma_73
L_dmae_74:
  s_andn2_b32 s54, 1, s61
  v_lshrrev_b32 v2, 2, v1
  v_mul_u32_u24 v2, 5504, v2
  s_and_b32 s49, s5, 2
  s_or_b32 s49, s49, s54
  v_xor_b32 v3, s49, v1
  v_and_b32 v3, 3, v3
  v_lshl_add_u32 v2, v3, 4, v2
  s_and_b32 s55, s5, 1
  s_mul_i32 s49, s55, 704512
  s_add_u32 s49, s49, s48
  s_mul_i32 s50, s54, 2752
  s_add_u32 s49, s49, s50
  s_lshr_b32 s50, s5, 1
  s_lshl_b32 s50, s50, 15
  s_lshl_b32 s54, s54, 14
  s_add_u32 s50, s50, s54
  s_lshl_b32 s55, s55, 13
  s_add_u32 s50, s50, s55
  s_add_u32 s50, s50, 77824
  s_add_u32 s51, s50, 8192
L_dma_75:
  s_mov_b32 m0, s50
  s_add_u32 s50, s50, 1024
  buffer_load_dwordx4 v2, s[44:47], s49 offen nt lds
  s_add_u32 s49, s49, 88064
  s_waitcnt vmcnt(3)
  s_cmp_lt_u32 s50, s51
  s_cbranch_scc1 L_dma_75
L_dmae_76:
  v_lshlrev_b32 v15, 4, v0
  v_add_u32 v39, 16384, v15
  s_and_b32 s59, s2, 1
  s_lshl_b32 s59, s59, 16
  s_add_u32 s59, s59, 2101248
  v_add_u32 v15, s59, v15
  v_lshrrev_b32 v5, 2, v0
  v_lshlrev_b32 v5, 3, v5
  v_add_u32 v5, 9536, v5
  v_lshlrev_b32 v7, 3, v1
  v_add_u32 v7, 9536, v7
  v_and_b32 v14, 7, v1
  v_mul_u32_u24 v14, 1056, v14
  v_lshrrev_b32 v3, 4, v1
  v_lshl_add_u32 v14, v3, 4, v14
  v_bfe_u32 v6, v1, 2, 2
  v_lshl_add_u32 v6, v3, 3, v6
  v_mul_u32_u24 v6, 1056, v6
  v_and_b32 v8, 3, v1
  v_lshl_add_u32 v6, v8, 3, v6
  s_lshl_b32 s49, s5, 8
  s_add_u32 s49, s49, 77824
  v_add_u32 v6, s49, v6
  v_lshlrev_b32 v10, 3, v0
  v_add_u32 v10, 10048, v10
  v_mov_b32 v8, 0
  v_mov_b32 v9, 0
  ds_write_b64 v10, v[8:9]
  v_and_b32 v13, 1, v1
  v_lshlrev_b32 v13, 6, v13
  v_lshrrev_b32 v3, 4, v1
  v_lshl_add_u32 v13, v3, 4, v13
  s_lshl_b32 s49, s5, 17
  s_add_u32 s49, s49, s58
  v_add_u32 v13, s49, v13
  v_bfe_u32 v3, v1, 1, 3
  v_lshl_add_u32 v13, v3, 14, v13
  v_lshrrev_b32 v2, 3, v1
  v_lshlrev_b32 v2, 6, v2
  v_bfe_u32 v3, v1, 2, 1
  v_lshl_add_u32 v2, v3, 14, v2
  v_and_b32 v8, 2, v1
  v_or_b32 v3, v3, v8
  v_xor_b32 v3, s5, v3
  v_lshl_add_u32 v2, v3, 4, v2
  v_lshl_add_u32 v2, v8, 14, v2
  v_and_b32 v3, 1, v1
  v_lshl_add_u32 v2, v3, 3, v2
  v_add_u32 v2, 77824, v2
  s_waitcnt vmcnt(0)
  s_add_u32 s77, s77, 4
  v_mov_b32 v9, 1
  s_mov_b64 exec, 1
  ds_add_u32 v38, v9 offset:316
  s_mov_b64 exec, -1
  s_mov_b32 s70, 0
L_hy_77:
  ds_read_b32 v9, v38 offset:316
  s_waitcnt lgkmcnt(0)
  v_cmp_gt_u32 vcc, s77, v9
  s_cmp_eq_u64 vcc, 0
  s_cbranch_scc1 L_hyd_78
  s_sleep 4
  s_add_u32 s70, s70, 1
  s_cmp_lt_u32 s70, 2097152
  s_cbranch_scc1 L_hy_77
L_hyd_78:
  ds_read_b64_tr_b16 v[40:41], v2 offset:0
  ds_read_b64_tr_b16 v[42:43], v2 offset:512
  ds_read_b64_tr_b16 v[44:45], v2 offset:1024
  ds_read_b64_tr_b16 v[46:47], v2 offset:1536
  ds_read_b64_tr_b16 v[48:49], v2 offset:2048
  ds_read_b64_tr_b16 v[50:51], v2 offset:2560
  ds_read_b64_tr_b16 v[52:53], v2 offset:3072
  ds_read_b64_tr_b16 v[54:55], v2 offset:3584
  ds_read_b64_tr_b16 v[56:57], v2 offset:4096
  ds_read_b64_tr_b16 v[58:59], v2 offset:4608
  ds_read_b64_tr_b16 v[60:61], v2 offset:5120
  ds_read_b64_tr_b16 v[62:63], v2 offset:5632
  s_waitcnt lgkmcnt(10)
  ds_read_b64_tr_b16 v[64:65], v2 offset:6144
  ds_read_b64_tr_b16 v[66:67], v2 offset:6656
  s_waitcnt lgkmcnt(10)
  ds_read_b64_tr_b16 v[68:69], v2 offset:7168
  ds_read_b64_tr_b16 v[70:71], v2 offset:7680
  s_waitcnt lgkmcnt(10)
  ds_read_b64_tr_b16 v[72:73], v2 offset:8192
  ds_read_b64_tr_b16 v[74:75], v2 offset:8704
  s_waitcnt lgkmcnt(10)
  ds_read_b64_tr_b16 v[76:77], v2 offset:9216
  ds_read_b64_tr_b16 v[78:79], v2 offset:9728
  s_waitcnt lgkmcnt(10)
  ds_read_b64_tr_b16 v[80:81], v2 offset:10240
  ds_read_b64_tr_b16 v[82:83], v2 offset:10752
  s_waitcnt lgkmcnt(10)
  ds_read_b64_tr_b16 v[84:85], v2 offset:11264
  ds_read_b64_tr_b16 v[86:87], v2 offset:11776
  s_waitcnt lgkmcnt(10)
  ds_read_b64_tr_b16 v[88:89], v2 offset:12288
  ds_read_b64_tr_b16 v[90:91], v2 offset:12800
  s_waitcnt lgkmcnt(10)
  ds_read_b64_tr_b16 v[92:93], v2 offset:13312
  ds_read_b64_tr_b16 v[94:95], v2 offset:13824
  s_waitcnt lgkmcnt(10)
  ds_read_b64_tr_b16 v[96:97], v2 offset:14336
  ds_read_b64_tr_b16 v[98:99], v2 offset:14848
  s_waitcnt lgkmcnt(10)
  ds_read_b64_tr_b16 v[100:101], v2 offset:15360
  ds_read_b64_tr_b16 v[102:103], v2 offset:15872
  s_waitcnt lgkmcnt(10)
  s_waitcnt lgkmcnt(0)
  s_add_u32 s77, s77, 4
  v_mov_b32 v9, 1
  s_mov_b64 exec, 1
  ds_add_u32 v38, v9 offset:316
  s_mov_b64 exec, -1
  s_mov_b32 s70, 0
L_hy_79:
  ds_read_b32 v9, v38 offset:316
  s_waitcnt lgkmcnt(0)
  v_cmp_gt_u32 vcc, s77, v9
  s_cmp_eq_u64 vcc, 0
  s_cbranch_scc1 L_hyd_80
  s_add_u32 s70, s70, 1
  s_cmp_lt_u32 s70, 2097152
  s_cbranch_scc1 L_hy_79
L_hyd_80:
  s_mov_b32 s44, s32
  s_mov_b32 s45, s33
  s_mov_b32 s46, 1409024
  s_mov_b32 s47, 0x20000
  v_lshlrev_b32 v2, 4, v1
  s_lshl2_add_u32 s49, s61, s5
  s_lshl_b32 s49, s49, 13
  s_mul_i32 s50, s5, 8448
  s_add_u32 s50, s50, 77824
  s_add_u32 s51, s50, 8448
L_dma_81:
  s_mov_b32 m0, s50
  s_add_u32 s50, s50, 1056
  buffer_load_dwordx4 v2, s[44:47], s49 offen nt lds
  s_add_u32 s49, s49, 1024
  s_waitcnt vmcnt(3)
  s_cmp_lt_u32 s50, s51
  s_cbranch_scc1 L_dma_81
L_dmae_82:
  s_bfe_u32 s32, s74, 0x80000
  s_bfe_u32 s33, s74, 0x80008
  s_bfe_u32 s34, s74, 0x80010
  s_bfe_u32 s35, s74, 0x80018
  v_add_u32 v4, 16384, v15
  v_add_u32 v0, 32768, v15
  v_add_u32 v36, 49152, v15
  global_load_dwordx2 v[8:9], v37, s[16:17]
  s_mov_b32 s70, 0
L_pg_83:
  global_load_dwordx4 v[136:139], v39, s[42:43] offset:-4096 sc1
  global_load_dwordx4 v[140:143], v39, s[42:43] offset:0 sc1
  v_add_u32 v3, 4096, v39
  global_load_dwordx4 v[144:147], v3, s[42:43] sc1
  s_waitcnt vmcnt(0)
  s_mov_b64 vcc, 0
  v_cmp_ne_u32 s[68:69], s74, v137
  s_or_b64 vcc, vcc, s[68:69]
  v_cmp_ne_u32 s[68:69], s74, v139
  s_or_b64 vcc, vcc, s[68:69]
  v_cmp_ne_u32 s[68:69], s74, v141
  s_or_b64 vcc, vcc, s[68:69]
  v_cmp_ne_u32 s[68:69], s74, v143
  s_or_b64 vcc, vcc, s[68:69]
  v_cmp_ne_u32 s[68:69], s74, v145
  s_or_b64 vcc, vcc, s[68:69]
  v_cmp_ne_u32 s[68:69], s74, v147
  s_or_b64 vcc, vcc, s[68:69]
  s_cmp_eq_u64 vcc, 0
  s_cbranch_scc1 L_pge_84
  s_sleep 8
  s_add_u32 s70, s70, 1
  s_cmp_lt_u32 s70, 262144
  s_cbranch_scc1 L_pg_83
L_pge_84:
  v_and_b32 v39, 1, v1
  v_lshlrev_b32 v39, 6, v39
  v_add_u32 v39, 10944, v39
  v_lshrrev_b32 v3, 4, v1
  v_lshl_add_u32 v37, v3, 4, v39
  v_bfe_u32 v3, v1, 1, 3
  v_lshlrev_b32 v3, 7, v3
  v_sub_u32 v37, v37, v3
  v_bfe_u32 v3, v1, 4, 1
  v_lshl_add_u32 v39, v3, 3, v39
  v_lshrrev_b32 v3, 5, v1
  v_lshl_add_u32 v39, v3, 2, v39
  s_lshl_b32 s49, s5, 4
  v_add_u32 v39, s49, v39
  v_lshlrev_b32 v16, 16, v8
  v_and_b32 v17, s73, v8
  v_lshlrev_b32 v18, 16, v9
  v_and_b32 v19, s73, v9
  v_lshlrev_b32 v20, 16, v136
  v_and_b32 v21, s73, v136
  v_lshlrev_b32 v22, 16, v138
  v_and_b32 v23, s73, v138
  v_lshlrev_b32 v28, 16, v144
  v_and_b32 v29, s73, v144
  v_lshlrev_b32 v30, 16, v146
  v_and_b32 v31, s73, v146
  v_add_f32 v28, 1.0, v28
  v_add_f32 v29, 1.0, v29
  v_add_f32 v30, 1.0, v30
  v_add_f32 v31, 1.0, v31
  v_cvt_pk_bf16_f32 v8, v28, v29
  v_cvt_pk_bf16_f32 v9, v30, v31
  v_mov_b32 v141, v142
  ds_write_b64 v12, v[8:9] offset:5312
  ds_write_b64 v12, v[140:141] offset:7424
  v_cvt_pk_bf16_f32 v28, 0, v28
  v_cvt_pk_bf16_f32 v29, 0, v29
  v_cvt_pk_bf16_f32 v30, 0, v30
  v_cvt_pk_bf16_f32 v31, 0, v31
  v_mul_f32 v24, v20, v28
  v_mul_f32 v25, v21, v29
  v_mul_f32 v26, v22, v30
  v_mul_f32 v27, v23, v31
  v_mul_f32 v28, v16, v28
  v_mul_f32 v29, v17, v29
  v_mul_f32 v30, v18, v30
  v_mul_f32 v31, v19, v31
  s_waitcnt lgkmcnt(0)
  s_waitcnt vmcnt(0)
  s_mov_b32 s70, 0
L_sn_85:
  ds_read_b32 v8, v38 offset:264
  s_waitcnt lgkmcnt(0)
  v_cmp_gt_u32 vcc, 0x8, v8
  s_cmp_eq_u64 vcc, 0
  s_cbranch_scc1 L_snd_86
  s_sleep 2
  s_add_u32 s70, s70, 1
  s_cmp_lt_u32 s70, 2097152
  s_cbranch_scc1 L_sn_85
L_snd_86:
  s_mov_b32 s70, 0
  s_movk_i32 s71, 0xff
  s_mov_b32 s63, s71
  s_branch L_f1_l
L_f1_p:
  s_add_u32 s70, s70, 1
  s_cmp_ge_u32 s70, 262144
  s_cbranch_scc1 L_f1_ok
  s_mov_b32 s63, s71
L_f1_l:
  s_bitcmp1_b32 s63, 0
  s_cbranch_scc0 L_fl_87
  global_load_dwordx4 v[104:107], v15, s[42:43] offset:-4096 sc1
L_fl_87:
  s_bitcmp1_b32 s63, 1
  s_cbranch_scc0 L_fl_88
  global_load_dwordx4 v[108:111], v15, s[42:43] offset:0 sc1
L_fl_88:
  s_bitcmp1_b32 s63, 2
  s_cbranch_scc0 L_fl_89
  global_load_dwordx4 v[112:115], v4, s[42:43] offset:-4096 sc1
L_fl_89:
  s_bitcmp1_b32 s63, 3
  s_cbranch_scc0 L_fl_90
  global_load_dwordx4 v[116:119], v4, s[42:43] offset:0 sc1
L_fl_90:
  s_bitcmp1_b32 s63, 4
  s_cbranch_scc0 L_fl_91
  global_load_dwordx4 v[120:123], v0, s[42:43] offset:-4096 sc1
L_fl_91:
  s_bitcmp1_b32 s63, 5
  s_cbranch_scc0 L_fl_92
  global_load_dwordx4 v[124:127], v0, s[42:43] offset:0 sc1
L_fl_92:
  s_bitcmp1_b32 s63, 6
  s_cbranch_scc0 L_fl_93
  global_load_dwordx4 v[128:131], v36, s[42:43] offset:-4096 sc1
L_fl_93:
  s_bitcmp1_b32 s63, 7
  s_cbranch_scc0 L_fl_94
  global_load_dwordx4 v[132:135], v36, s[42:43] offset:0 sc1
L_fl_94:
  s_waitcnt vmcnt(0)
  s_bitcmp1_b32 s63, 0
  s_cbranch_scc0 L_fc_95
  v_xor_b32 v104, s32, v104
  v_xor_b32 v105, s33, v105
  v_xor_b32 v106, s34, v106
  v_xor_b32 v107, s35, v107
  v_or3_b32 v8, v104, v105, v106
  v_or_b32 v8, v8, v107
  v_cmp_ne_u32_sdwa vcc, v8, v38 src0_sel:BYTE_0 src1_sel:DWORD
  s_cmp_lg_u64 vcc, 0
  s_cbranch_scc1 L_fc_95
  s_bitset0_b32 s71, 0
L_fc_95:
  s_bitcmp1_b32 s63, 1
  s_cbranch_scc0 L_fc_96
  v_xor_b32 v108, s32, v108
  v_xor_b32 v109, s33, v109
  v_xor_b32 v110, s34, v110
  v_xor_b32 v111, s35, v111
  v_or3_b32 v8, v108, v109, v110
  v_or_b32 v8, v8, v111
  v_cmp_ne_u32_sdwa vcc, v8, v38 src0_sel:BYTE_0 src1_sel:DWORD
  s_cmp_lg_u64 vcc, 0
  s_cbranch_scc1 L_fc_96
  s_bitset0_b32 s71, 1
L_fc_96:
  s_bitcmp1_b32 s63, 2
  s_cbranch_scc0 L_fc_97
  v_xor_b32 v112, s32, v112
  v_xor_b32 v113, s33, v113
  v_xor_b32 v114, s34, v114
  v_xor_b32 v115, s35, v115
  v_or3_b32 v8, v112, v113, v114
  v_or_b32 v8, v8, v115
  v_cmp_ne_u32_sdwa vcc, v8, v38 src0_sel:BYTE_0 src1_sel:DWORD
  s_cmp_lg_u64 vcc, 0
  s_cbranch_scc1 L_fc_97
  s_bitset0_b32 s71, 2
L_fc_97:
  s_bitcmp1_b32 s63, 3
  s_cbranch_scc0 L_fc_98
  v_xor_b32 v116, s32, v116
  v_xor_b32 v117, s33, v117
  v_xor_b32 v118, s34, v118
  v_xor_b32 v119, s35, v119
  v_or3_b32 v8, v116, v117, v118
  v_or_b32 v8, v8, v119
  v_cmp_ne_u32_sdwa vcc, v8, v38 src0_sel:BYTE_0 src1_sel:DWORD
  s_cmp_lg_u64 vcc, 0
  s_cbranch_scc1 L_fc_98
  s_bitset0_b32 s71, 3
L_fc_98:
  s_bitcmp1_b32 s63, 4
  s_cbranch_scc0 L_fc_99
  v_xor_b32 v120, s32, v120
  v_xor_b32 v121, s33, v121
  v_xor_b32 v122, s34, v122
  v_xor_b32 v123, s35, v123
  v_or3_b32 v8, v120, v121, v122
  v_or_b32 v8, v8, v123
  v_cmp_ne_u32_sdwa vcc, v8, v38 src0_sel:BYTE_0 src1_sel:DWORD
  s_cmp_lg_u64 vcc, 0
  s_cbranch_scc1 L_fc_99
  s_bitset0_b32 s71, 4
L_fc_99:
  s_bitcmp1_b32 s63, 5
  s_cbranch_scc0 L_fc_100
  v_xor_b32 v124, s32, v124
  v_xor_b32 v125, s33, v125
  v_xor_b32 v126, s34, v126
  v_xor_b32 v127, s35, v127
  v_or3_b32 v8, v124, v125, v126
  v_or_b32 v8, v8, v127
  v_cmp_ne_u32_sdwa vcc, v8, v38 src0_sel:BYTE_0 src1_sel:DWORD
  s_cmp_lg_u64 vcc, 0
  s_cbranch_scc1 L_fc_100
  s_bitset0_b32 s71, 5
L_fc_100:
  s_bitcmp1_b32 s63, 6
  s_cbranch_scc0 L_fc_101
  v_xor_b32 v128, s32, v128
  v_xor_b32 v129, s33, v129
  v_xor_b32 v130, s34, v130
  v_xor_b32 v131, s35, v131
  v_or3_b32 v8, v128, v129, v130
  v_or_b32 v8, v8, v131
  v_cmp_ne_u32_sdwa vcc, v8, v38 src0_sel:BYTE_0 src1_sel:DWORD
  s_cmp_lg_u64 vcc, 0
  s_cbranch_scc1 L_fc_101
  s_bitset0_b32 s71, 6
L_fc_101:
  s_bitcmp1_b32 s63, 7
  s_cbranch_scc0 L_fc_102
  v_xor_b32 v132, s32, v132
  v_xor_b32 v133, s33, v133
  v_xor_b32 v134, s34, v134
  v_xor_b32 v135, s35, v135
  v_or3_b32 v8, v132, v133, v134
  v_or_b32 v8, v8, v135
  v_cmp_ne_u32_sdwa vcc, v8, v38 src0_sel:BYTE_0 src1_sel:DWORD
  s_cmp_lg_u64 vcc, 0
  s_cbranch_scc1 L_fc_102
  s_bitset0_b32 s71, 7
L_fc_102:
  s_cmp_lg_u32 s71, 0
  s_cbranch_scc1 L_f1_p
L_f1_ok:
  v_pk_add_f32 v[136:137], v[104:105], v[108:109]
  v_pk_add_f32 v[138:139], v[106:107], v[110:111]
  v_pk_add_f32 v[144:145], v[112:113], v[116:117]
  v_pk_add_f32 v[146:147], v[114:115], v[118:119]
  v_pk_add_f32 v[152:153], v[120:121], v[124:125]
  v_pk_add_f32 v[154:155], v[122:123], v[126:127]
  v_pk_add_f32 v[160:161], v[128:129], v[132:133]
  v_pk_add_f32 v[162:163], v[130:131], v[134:135]
  v_pk_add_f32 v[136:137], v[136:137], v[144:145]
  v_pk_add_f32 v[138:139], v[138:139], v[146:147]
  v_pk_add_f32 v[152:153], v[152:153], v[160:161]
  v_pk_add_f32 v[154:155], v[154:155], v[162:163]
  v_pk_add_f32 v[136:137], v[136:137], v[152:153]
  v_pk_add_f32 v[138:139], v[138:139], v[154:155]
  v_pk_fma_f32 v[8:9], v[136:137], v[24:25], v[28:29]
  v_pk_fma_f32 v[10:11], v[138:139], v[26:27], v[30:31]
  v_cvt_pk_bf16_f32 v8, v8, v9
  v_cvt_pk_bf16_f32 v9, v10, v11
  ds_write_b64 v12, v[8:9] offset:3200
  v_pk_fma_f32 v[16:17], v[136:137], v[20:21], v[16:17]
  v_pk_fma_f32 v[18:19], v[138:139], v[22:23], v[18:19]
  v_add_f32 v24, v16, v17
  v_mul_f32 v25, v16, v16
  v_add_f32 v26, v18, v19
  v_mul_f32 v27, v18, v18
  v_fmac_f32 v25, v17, v17
  v_fmac_f32 v27, v19, v19
  v_pk_add_f32 v[24:25], v[24:25], v[26:27]
  s_nop 1
  v_add_f32_dpp v24, v24, v24 quad_perm:[1,0,3,2] row_mask:0xf bank_mask:0xf
  v_add_f32_dpp v25, v25, v25 quad_perm:[1,0,3,2] row_mask:0xf bank_mask:0xf
  s_nop 0
  v_add_f32_dpp v24, v24, v24 quad_perm:[2,3,0,1] row_mask:0xf bank_mask:0xf
  v_add_f32_dpp v25, v25, v25 quad_perm:[2,3,0,1] row_mask:0xf bank_mask:0xf
  ds_write_b64 v5, v[24:25]
  s_add_u32 s77, s77, 4
  v_mov_b32 v10, 1
  s_mov_b64 exec, 1
  ds_add_u32 v38, v10 offset:316
  s_mov_b64 exec, -1
  s_mov_b32 s70, 0
L_hy_103:
  ds_read_b32 v10, v38 offset:316
  ds_read_b128 v[136:139], v14 offset:3200
  ds_read_b128 v[140:143], v14 offset:3264
  ds_read_b128 v[144:147], v14 offset:3328
  ds_read_b128 v[148:151], v14 offset:3392
  s_waitcnt lgkmcnt(4)
  v_cmp_gt_u32 vcc, s77, v10
  s_cmp_eq_u64 vcc, 0
  s_cbranch_scc1 L_hyd_104
  s_waitcnt lgkmcnt(0)
  s_add_u32 s70, s70, 1
  s_cmp_lt_u32 s70, 2097152
  s_cbranch_scc1 L_hy_103
L_hyd_104:
  ds_read_b64 v[20:21], v7
  ds_read_b128 v[152:155], v14 offset:3456
  ds_read_b128 v[156:159], v14 offset:3520
  ds_read_b128 v[160:163], v14 offset:3584
  ds_read_b128 v[164:167], v14 offset:3648
  s_waitcnt lgkmcnt(8)
  v_mfma_f32_16x16x32_bf16 v[32:35], v[40:43], v[136:139], 0
  s_waitcnt lgkmcnt(7)
  v_mfma_f32_16x16x32_bf16 v[32:35], v[44:47], v[140:143], v[32:35]
  ds_read_b128 v[136:139], v14 offset:3712
  s_waitcnt lgkmcnt(7)
  v_mfma_f32_16x16x32_bf16 v[32:35], v[48:51], v[144:147], v[32:35]
  ds_read_b128 v[140:143], v14 offset:3776
  s_waitcnt lgkmcnt(7)
  v_mfma_f32_16x16x32_bf16 v[32:35], v[52:55], v[148:151], v[32:35]
  ds_read_b128 v[144:147], v14 offset:3840
  s_waitcnt lgkmcnt(6)
  v_mfma_f32_16x16x32_bf16 v[32:35], v[56:59], v[152:155], v[32:35]
  ds_read_b128 v[148:151], v14 offset:3904
  v_add_f32_dpp v20, v20, v20 quad_perm:[2,3,0,1] row_mask:0xf bank_mask:0xf
  v_add_f32_dpp v21, v21, v21 quad_perm:[2,3,0,1] row_mask:0xf bank_mask:0xf
  s_waitcnt lgkmcnt(6)
  v_mfma_f32_16x16x32_bf16 v[32:35], v[60:63], v[156:159], v[32:35]
  ds_read_b128 v[152:155], v14 offset:3968
  v_add_f32_dpp v20, v20, v20 row_ror:4 row_mask:0xf bank_mask:0xf
  v_add_f32_dpp v21, v21, v21 row_ror:4 row_mask:0xf bank_mask:0xf
  s_waitcnt lgkmcnt(6)
  v_mfma_f32_16x16x32_bf16 v[32:35], v[64:67], v[160:163], v[32:35]
  ds_read_b128 v[156:159], v14 offset:4032
  v_add_f32_dpp v20, v20, v20 row_ror:8 row_mask:0xf bank_mask:0xf
  v_add_f32_dpp v21, v21, v21 row_ror:8 row_mask:0xf bank_mask:0xf
  s_waitcnt lgkmcnt(6)
  v_mfma_f32_16x16x32_bf16 v[32:35], v[68:71], v[164:167], v[32:35]
  ds_read_b128 v[160:163], v14 offset:4096
  v_mov_b32 v22, v20
  v_mov_b32 v23, v21
  s_waitcnt lgkmcnt(6)
  v_mfma_f32_16x16x32_bf16 v[32:35], v[72:75], v[136:139], v[32:35]
  ds_read_b128 v[164:167], v14 offset:4160
  v_permlane16_swap_b32 v22, v20
  v_permlane16_swap_b32 v23, v21
  s_waitcnt lgkmcnt(6)
  v_mfma_f32_16x16x32_bf16 v[32:35], v[76:79], v[140:143], v[32:35]
  v_pk_add_f32 v[20:21], v[20:21], v[22:23]
  v_mov_b32 v22, v20
  v_mov_b32 v23, v21
  s_waitcnt lgkmcnt(5)
  v_mfma_f32_16x16x32_bf16 v[32:35], v[80:83], v[144:147], v[32:35]
  v_permlane32_swap_b32 v22, v20
  v_permlane32_swap_b32 v23, v21
  s_waitcnt lgkmcnt(4)
  v_mfma_f32_16x16x32_bf16 v[32:35], v[84:87], v[148:151], v[32:35]
  v_pk_add_f32 v[20:21], v[20:21], v[22:23]
  v_mul_f32 v20, 0xbb000000, v20
  s_waitcnt lgkmcnt(3)
  v_mfma_f32_16x16x32_bf16 v[32:35], v[88:91], v[152:155], v[32:35]
  v_mul_f32 v21, 0x3b000000, v21
  v_fma_f32 v21, -v20, v20, v21
  s_waitcnt lgkmcnt(2)
  v_mfma_f32_16x16x32_bf16 v[32:35], v[92:95], v[156:159], v[32:35]
  v_max_f32 v21, 0, v21
  v_add_f32 v21, 0x3727c5ac, v21
  s_waitcnt lgkmcnt(1)
  v_mfma_f32_16x16x32_bf16 v[32:35], v[96:99], v[160:163], v[32:35]
  v_rsq_f32 v21, v21
  s_waitcnt lgkmcnt(0)
  v_mfma_f32_16x16x32_bf16 v[32:35], v[100:103], v[164:167], v[32:35]
  ds_read_b64_tr_b16 v[40:41], v6 offset:0
  ds_read_b64_tr_b16 v[42:43], v6 offset:4224
  ds_read_b64_tr_b16 v[44:45], v6 offset:32
  ds_read_b64_tr_b16 v[46:47], v6 offset:4256
  ds_read_b64_tr_b16 v[48:49], v6 offset:64
  ds_read_b64_tr_b16 v[50:51], v6 offset:4288
  ds_read_b64_tr_b16 v[52:53], v6 offset:96
  ds_read_b64_tr_b16 v[54:55], v6 offset:4320
  v_fmac_f32_dpp v32, v32, v20 row_shl:2 row_mask:0xf bank_mask:0x1
  v_fmac_f32_dpp v33, v33, v20 row_shl:2 row_mask:0xf bank_mask:0x1
  v_fmac_f32_dpp v34, v34, v20 row_shl:2 row_mask:0xf bank_mask:0x1
  v_fmac_f32_dpp v35, v35, v20 row_shl:2 row_mask:0xf bank_mask:0x1
  v_mul_f32 v8, v32, v21
  v_mul_f32 v9, v33, v21
  v_mul_f32 v10, v34, v21
  v_mul_f32 v11, v35, v21
  v_add_f32_dpp v8, v32, v8 row_shl:4 row_mask:0xf bank_mask:0xf
  v_add_f32_dpp v9, v33, v9 row_shl:4 row_mask:0xf bank_mask:0xf
  v_add_f32_dpp v10, v34, v10 row_shl:4 row_mask:0xf bank_mask:0xf
  v_add_f32_dpp v11, v35, v11 row_shl:4 row_mask:0xf bank_mask:0xf
  s_waitcnt lgkmcnt(4)
  ds_read_b64_tr_b16 v[56:57], v6 offset:128
  ds_read_b64_tr_b16 v[58:59], v6 offset:4352
  ds_read_b64_tr_b16 v[60:61], v6 offset:160
  ds_read_b64_tr_b16 v[62:63], v6 offset:4384
  ds_read_b64_tr_b16 v[64:65], v6 offset:192
  ds_read_b64_tr_b16 v[66:67], v6 offset:4416
  ds_read_b64_tr_b16 v[68:69], v6 offset:224
  ds_read_b64_tr_b16 v[70:71], v6 offset:4448
  v_permlane32_swap_b32 v8, v10
  v_permlane32_swap_b32 v9, v11
  v_mul_f32 v20, 0xbfb8aa3b, v8
  v_mul_f32 v21, 0xbfb8aa3b, v9
  v_exp_f32 v20, v20
  v_exp_f32 v21, v21
  v_mul_f32 v8, v8, v10
  v_mul_f32 v9, v9, v11
  v_add_f32 v20, 1.0, v20
  v_add_f32 v21, 1.0, v21
  v_rcp_f32 v20, v20
  v_rcp_f32 v21, v21
  s_mov_b32 exec_lo, 0x00030003
  s_mov_b32 exec_hi, 0x00030003
  v_mul_f32 v8, v8, v20
  v_mul_f32 v9, v9, v21
  v_cvt_pk_bf16_f32 v8, v8, v9
  ds_write_b32 v39, v8
  s_mov_b64 exec, -1
  s_waitcnt lgkmcnt(4)
  s_add_u32 s77, s77, 4
  v_mov_b32 v10, 1
  s_mov_b64 exec, 1
  ds_add_u32 v38, v10 offset:316
  s_mov_b64 exec, -1
  s_mov_b32 s70, 0
L_hy_105:
  ds_read_b32 v10, v38 offset:316
  ds_read_b128 v[136:139], v37 offset:0
  ds_read_b128 v[140:143], v37 offset:128
  ds_read_b128 v[144:147], v37 offset:256
  ds_read_b128 v[148:151], v37 offset:384
  s_waitcnt lgkmcnt(4)
  v_cmp_gt_u32 vcc, s77, v10
  s_cmp_eq_u64 vcc, 0
  s_cbranch_scc1 L_hyd_106
  s_waitcnt lgkmcnt(0)
  s_add_u32 s70, s70, 1
  s_cmp_lt_u32 s70, 2097152
  s_cbranch_scc1 L_hy_105
L_hyd_106:
  ds_read_b128 v[152:155], v37 offset:512
  ds_read_b128 v[156:159], v37 offset:640
  ds_read_b128 v[160:163], v37 offset:768
  ds_read_b128 v[164:167], v37 offset:896
  v_mov_b32 v3, 0xff
  s_waitcnt lgkmcnt(7)
  v_mfma_f32_16x16x32_bf16 v[8:11], v[40:43], v[136:139], 0
  s_waitcnt lgkmcnt(6)
  v_mfma_f32_16x16x32_bf16 v[8:11], v[44:47], v[140:143], v[8:11]
  s_waitcnt lgkmcnt(5)
  v_mfma_f32_16x16x32_bf16 v[8:11], v[48:51], v[144:147], v[8:11]
  s_waitcnt lgkmcnt(4)
  v_mfma_f32_16x16x32_bf16 v[8:11], v[52:55], v[148:151], v[8:11]
  s_waitcnt lgkmcnt(3)
  v_mfma_f32_16x16x32_bf16 v[8:11], v[56:59], v[152:155], v[8:11]
  s_waitcnt lgkmcnt(2)
  v_mfma_f32_16x16x32_bf16 v[8:11], v[60:63], v[156:159], v[8:11]
  s_waitcnt lgkmcnt(1)
  v_mfma_f32_16x16x32_bf16 v[8:11], v[64:67], v[160:163], v[8:11]
  s_waitcnt lgkmcnt(0)
  v_mfma_f32_16x16x32_bf16 v[8:11], v[68:71], v[164:167], v[8:11]
  s_nop 7
  v_bfi_b32 v8, v3, s32, v8
  v_bfi_b32 v9, v3, s33, v9
  v_bfi_b32 v10, v3, s34, v10
  v_bfi_b32 v11, v3, s35, v11
  global_store_dwordx4 v13, v[8:11], s[42:43] sc1
  s_branch L_fin
L_r_f2:
  v_bfe_u32 v12, v1, 2, 1
  v_and_b32 v14, 3, v1
  s_lshl_b32 s49, s61, 5
  v_lshl_add_u32 v3, v14, 3, s49
  v_lshl_add_u32 v37, v12, 10, v3
  v_and_b32 v15, 7, v1
  s_lshl_b32 s49, s61, 7
  v_lshl_add_u32 v15, v15, 4, s49
  v_add_u32 v39, 16384, v15
  v_bfe_u32 v3, v1, 3, 1
  v_lshl_add_u32 v15, v3, 12, v15
  v_lshrrev_b32 v3, 4, v1
  v_lshl_add_u32 v15, v3, 14, v15
  s_and_b32 s59, s2, 1
  s_lshl_b32 s59, s59, 16
  s_add_u32 s59, s59, 2097152
  v_add_u32 v15, s59, v15
  s_lshl_b32 s49, s61, 14
  s_add_u32 s49, s49, 1574912
  v_lshl_add_u32 v36, v1, 4, s49
  global_load_dword v11, v37, s[38:39]
  s_lshl_b32 s49, s61, 14
  s_add_u32 s49, s49, 1572864
  v_min_u32 v10, 42, v1
  v_lshl_add_u32 v10, v10, 7, s49
  global_load_dword v11, v10, s[42:43] sc1
  s_lshl_b32 s49, s61, 7
  s_add_u32 s49, s49, 28672
  v_mov_b32 v10, s49
  global_load_dword v11, v10, s[42:43] sc1
  global_load_dwordx2 v[8:9], v37, s[16:17]
  s_mov_b32 s70, 0
L_pg_107:
  global_load_dwordx4 v[136:139], v39, s[42:43] offset:-4096 sc1
  v_add_u32 v3, 8192, v39
  global_load_dwordx4 v[140:143], v3, s[42:43] sc1
  s_waitcnt vmcnt(0)
  s_mov_b64 vcc, 0
  v_cmp_ne_u32 s[68:69], s74, v137
  s_or_b64 vcc, vcc, s[68:69]
  v_cmp_ne_u32 s[68:69], s74, v139
  s_or_b64 vcc, vcc, s[68:69]
  v_cmp_ne_u32 s[68:69], s74, v141
  s_or_b64 vcc, vcc, s[68:69]
  v_cmp_ne_u32 s[68:69], s74, v143
  s_or_b64 vcc, vcc, s[68:69]
  s_cmp_eq_u64 vcc, 0
  s_cbranch_scc1 L_pge_108
  s_sleep 8
  s_add_u32 s70, s70, 1
  s_cmp_lt_u32 s70, 262144
  s_cbranch_scc1 L_pg_107
L_pge_108:
  v_lshlrev_b32 v16, 16, v8
  v_and_b32 v17, s73, v8
  v_lshlrev_b32 v18, 16, v9
  v_and_b32 v19, s73, v9
  v_lshlrev_b32 v20, 16, v136
  v_and_b32 v21, s73, v136
  v_lshlrev_b32 v22, 16, v138
  v_and_b32 v23, s73, v138
  v_lshlrev_b32 v24, 16, v140
  v_and_b32 v25, s73, v140
  v_lshlrev_b32 v26, 16, v142
  v_and_b32 v27, s73, v142
  s_mov_b32 s70, 0
L_sn_109:
  ds_read_b32 v8, v38 offset:264
  s_waitcnt lgkmcnt(0)
  v_cmp_gt_u32 vcc, 0x8, v8
  s_cmp_eq_u64 vcc, 0
  s_cbranch_scc1 L_snd_110
  s_sleep 2
  s_add_u32 s70, s70, 1
  s_cmp_lt_u32 s70, 2097152
  s_cbranch_scc1 L_sn_109
L_snd_110:
  s_mov_b32 s70, 0
L_f2_a:
  global_load_dwordx4 v[136:139], v15, s[42:43] sc1
  s_waitcnt vmcnt(0)
  v_xor_b32 v136, s32, v136
  v_xor_b32 v137, s33, v137
  v_xor_b32 v138, s34, v138
  v_xor_b32 v139, s35, v139
  v_or3_b32 v3, v136, v137, v138
  v_or_b32 v3, v3, v139
  v_lshlrev_b32 v3, 24, v3
  v_cmp_ne_u32 vcc, 0, v3
  s_cmp_eq_u64 vcc, 0
  s_cbranch_scc1 L_f2_ad
  s_sleep 4
  s_add_u32 s70, s70, 1
  s_cmp_lt_u32 s70, 262144
  s_cbranch_scc1 L_f2_a
L_f2_ad:
  s_cmp_lg_u32 s61, 0
  s_cbranch_scc1 L_f2_e
  v_mov_b32 v10, s74
  s_mov_b64 exec, 1
  global_store_dword v38, v10, s[42:43] offset:0 sc1
  s_mov_b64 exec, -1
L_f2_e:
  s_nop 1
  v_add_f32_dpp v136, v136, v136 row_ror:8 row_mask:0xf bank_mask:0xf
  v_add_f32_dpp v137, v137, v137 row_ror:8 row_mask:0xf bank_mask:0xf
  v_add_f32_dpp v138, v138, v138 row_ror:8 row_mask:0xf bank_mask:0xf
  v_add_f32_dpp v139, v139, v139 row_ror:8 row_mask:0xf bank_mask:0xf
  v_mov_b32 v140, v136
  v_mov_b32 v141, v137
  v_mov_b32 v142, v138
  v_mov_b32 v143, v139
  v_permlane16_swap_b32 v140, v136
  v_permlane16_swap_b32 v141, v137
  v_permlane16_swap_b32 v142, v138
  v_permlane16_swap_b32 v143, v139
  v_add_f32 v136, v136, v140
  v_add_f32 v137, v137, v141
  v_add_f32 v138, v138, v142
  v_add_f32 v139, v139, v143
  v_mov_b32 v140, v136
  v_mov_b32 v141, v137
  v_mov_b32 v142, v138
  v_mov_b32 v143, v139
  v_permlane32_swap_b32 v140, v136
  v_permlane32_swap_b32 v141, v137
  v_permlane32_swap_b32 v142, v138
  v_permlane32_swap_b32 v143, v139
  v_add_f32 v136, v136, v140
  v_add_f32 v137, v137, v141
  v_add_f32 v138, v138, v142
  v_add_f32 v139, v139, v143
  v_cvt_pk_bf16_f32 v136, 0, v136
  v_cvt_pk_bf16_f32 v137, 0, v137
  v_cvt_pk_bf16_f32 v138, 0, v138
  v_cvt_pk_bf16_f32 v139, 0, v139
  v_mul_f32 v136, v136, v20
  v_mul_f32 v137, v137, v21
  v_mul_f32 v138, v138, v22
  v_mul_f32 v139, v139, v23
  v_cvt_pk_bf16_f32 v136, 0, v136
  v_cvt_pk_bf16_f32 v137, 0, v137
  v_cvt_pk_bf16_f32 v138, 0, v138
  v_cvt_pk_bf16_f32 v139, 0, v139
  v_add_f32 v16, v16, v136
  v_add_f32 v17, v17, v137
  v_add_f32 v18, v18, v138
  v_add_f32 v19, v19, v139
  v_cvt_pk_bf16_f32 v16, 0, v16
  v_cvt_pk_bf16_f32 v17, 0, v17
  v_cvt_pk_bf16_f32 v18, 0, v18
  v_cvt_pk_bf16_f32 v19, 0, v19
  v_mov_b32 v156, s32
  v_mov_b32 v157, s33
  v_mov_b32 v158, s34
  v_mov_b32 v159, s35
  s_mov_b64 s[20:21], -1
  s_mov_b64 s[22:23], -1
  s_mov_b64 s[24:25], -1
  s_mov_b64 s[26:27], -1
  s_mov_b64 s[28:29], -1
  s_mov_b64 s[30:31], 0xffffff
  s_mov_b64 exec, s[20:21]
  global_load_dwordx4 v[136:139], v36, s[42:43] offset:-2048 sc1
  s_mov_b64 exec, s[22:23]
  global_load_dwordx4 v[140:143], v36, s[42:43] offset:-1024 sc1
  s_mov_b64 exec, s[24:25]
  global_load_dwordx4 v[144:147], v36, s[42:43] offset:0 sc1
  s_mov_b64 exec, s[26:27]
  global_load_dwordx4 v[148:151], v36, s[42:43] offset:1024 sc1
  s_mov_b64 exec, s[28:29]
  global_load_dwordx4 v[152:155], v36, s[42:43] offset:2048 sc1
  s_mov_b64 exec, s[30:31]
  global_load_dwordx4 v[156:159], v36, s[42:43] offset:3072 sc1
  s_mov_b64 exec, -1
  s_waitcnt vmcnt(0)
  s_mov_b32 s70, 0
  s_branch L_f2_pc
L_f2_p:
  s_mov_b64 exec, s[20:21]
  global_load_dwordx4 v[136:139], v36, s[42:43] offset:-2048 sc1
  s_mov_b64 exec, s[22:23]
  global_load_dwordx4 v[140:143], v36, s[42:43] offset:-1024 sc1
  s_mov_b64 exec, s[24:25]
  global_load_dwordx4 v[144:147], v36, s[42:43] offset:0 sc1
  s_mov_b64 exec, s[26:27]
  global_load_dwordx4 v[148:151], v36, s[42:43] offset:1024 sc1
  s_mov_b64 exec, s[28:29]
  global_load_dwordx4 v[152:155], v36, s[42:43] offset:2048 sc1
  s_mov_b64 exec, s[30:31]
  global_load_dwordx4 v[156:159], v36, s[42:43] offset:3072 sc1
  s_mov_b64 exec, -1
  s_waitcnt vmcnt(0)
L_f2_pc:
  v_xor_b32 v104, s32, v136
  v_xor_b32 v105, s33, v137
  v_xor_b32 v106, s34, v138
  v_xor_b32 v107, s35, v139
  v_xor_b32 v108, s32, v140
  v_xor_b32 v109, s33, v141
  v_xor_b32 v110, s34, v142
  v_xor_b32 v111, s35, v143
  v_xor_b32 v112, s32, v144
  v_xor_b32 v113, s33, v145
  v_xor_b32 v114, s34, v146
  v_xor_b32 v115, s35, v147
  v_xor_b32 v116, s32, v148
  v_xor_b32 v117, s33, v149
  v_xor_b32 v118, s34, v150
  v_xor_b32 v119, s35, v151
  v_xor_b32 v120, s32, v152
  v_xor_b32 v121, s33, v153
  v_xor_b32 v122, s34, v154
  v_xor_b32 v123, s35, v155
  v_xor_b32 v124, s32, v156
  v_xor_b32 v125, s33, v157
  v_xor_b32 v126, s34, v158
  v_xor_b32 v127, s35, v159
  v_or3_b32 v28, v104, v105, v106
  v_or3_b32 v29, v108, v109, v110
  v_or3_b32 v30, v112, v113, v114
  v_or3_b32 v31, v116, v117, v118
  v_or3_b32 v32, v120, v121, v122
  v_or3_b32 v33, v124, v125, v126
  v_or_b32 v28, v28, v107
  v_or_b32 v29, v29, v111
  v_or_b32 v30, v30, v115
  v_or_b32 v31, v31, v119
  v_or_b32 v32, v32, v123
  v_or_b32 v33, v33, v127
  v_cmp_ne_u32_sdwa s[20:21], v28, v38 src0_sel:BYTE_0 src1_sel:DWORD
  v_cmp_ne_u32_sdwa s[22:23], v29, v38 src0_sel:BYTE_0 src1_sel:DWORD
  v_cmp_ne_u32_sdwa s[24:25], v30, v38 src0_sel:BYTE_0 src1_sel:DWORD
  v_cmp_ne_u32_sdwa s[26:27], v31, v38 src0_sel:BYTE_0 src1_sel:DWORD
  v_cmp_ne_u32_sdwa s[28:29], v32, v38 src0_sel:BYTE_0 src1_sel:DWORD
  v_cmp_ne_u32_sdwa s[30:31], v33, v38 src0_sel:BYTE_0 src1_sel:DWORD
  v_pk_add_f32 v[104:105], v[104:105], v[108:109]
  v_pk_add_f32 v[106:107], v[106:107], v[110:111]
  v_pk_add_f32 v[112:113], v[112:113], v[116:117]
  v_pk_add_f32 v[114:115], v[114:115], v[118:119]
  v_pk_add_f32 v[120:121], v[120:121], v[124:125]
  v_pk_add_f32 v[122:123], v[122:123], v[126:127]
  v_pk_add_f32 v[104:105], v[104:105], v[112:113]
  v_pk_add_f32 v[106:107], v[106:107], v[114:115]
  v_pk_add_f32 v[104:105], v[104:105], v[120:121]
  v_pk_add_f32 v[106:107], v[106:107], v[122:123]
  s_mov_b64 vcc, s[20:21]
  s_or_b64 vcc, vcc, s[22:23]
  s_or_b64 vcc, vcc, s[24:25]
  s_or_b64 vcc, vcc, s[26:27]
  s_or_b64 vcc, vcc, s[28:29]
  s_or_b64 vcc, vcc, s[30:31]
  s_or_b32 s20, s20, 1
  s_or_b32 s22, s22, 1
  s_or_b32 s24, s24, 1
  s_or_b32 s26, s26, 1
  s_or_b32 s28, s28, 1
  s_or_b32 s30, s30, 1
  s_cmp_eq_u64 vcc, 0
  s_cbranch_scc1 L_f2_pok
  s_add_u32 s70, s70, 1
  s_cmp_lt_u32 s70, 262144
  s_cbranch_scc1 L_f2_p
L_f2_pok:
  s_nop 1
  v_add_f32_dpp v104, v104, v104 row_ror:8 row_mask:0xf bank_mask:0xf
  v_add_f32_dpp v105, v105, v105 row_ror:8 row_mask:0xf bank_mask:0xf
  v_add_f32_dpp v106, v106, v106 row_ror:8 row_mask:0xf bank_mask:0xf
  v_add_f32_dpp v107, v107, v107 row_ror:8 row_mask:0xf bank_mask:0xf
  v_mov_b32 v108, v104
  v_mov_b32 v109, v105
  v_mov_b32 v110, v106
  v_mov_b32 v111, v107
  v_permlane16_swap_b32 v108, v104
  v_permlane16_swap_b32 v109, v105
  v_permlane16_swap_b32 v110, v106
  v_permlane16_swap_b32 v111, v107
  v_add_f32 v104, v104, v108
  v_add_f32 v105, v105, v109
  v_add_f32 v106, v106, v110
  v_add_f32 v107, v107, v111
  v_mov_b32 v108, v104
  v_mov_b32 v109, v105
  v_mov_b32 v110, v106
  v_mov_b32 v111, v107
  v_permlane32_swap_b32 v108, v104
  v_permlane32_swap_b32 v109, v105
  v_permlane32_swap_b32 v110, v106
  v_permlane32_swap_b32 v111, v107
  v_add_f32 v104, v104, v108
  v_add_f32 v105, v105, v109
  v_add_f32 v106, v106, v110
  v_add_f32 v107, v107, v111
  v_cvt_pk_bf16_f32 v104, 0, v104
  v_cvt_pk_bf16_f32 v105, 0, v105
  v_cvt_pk_bf16_f32 v106, 0, v106
  v_cvt_pk_bf16_f32 v107, 0, v107
  v_mul_f32 v104, v104, v24
  v_mul_f32 v105, v105, v25
  v_mul_f32 v106, v106, v26
  v_mul_f32 v107, v107, v27
  v_cvt_pk_bf16_f32 v104, 0, v104
  v_cvt_pk_bf16_f32 v105, 0, v105
  v_cvt_pk_bf16_f32 v106, 0, v106
  v_cvt_pk_bf16_f32 v107, 0, v107
  v_add_f32 v8, v104, v16
  v_add_f32 v9, v105, v17
  v_add_f32 v10, v106, v18
  v_add_f32 v11, v107, v19
  v_cvt_pk_bf16_f32 v8, v8, v9
  v_cvt_pk_bf16_f32 v9, v10, v11
  s_mov_b64 exec, 0xff
  global_store_dwordx2 v37, v[8:9], s[38:39] sc1
  s_mov_b64 exec, 1
  v_mov_b32 v10, s74
  s_lshl_b32 s49, s61, 7
  s_add_u32 s49, s49, 28672
  v_mov_b32 v11, s49
  global_store_dword v11, v10, s[42:43] sc1
L_fin:
L_end:
  s_endpgm
.p2align 7
L_table:
  .long 0xff00ff13, 0x1504ff14, 0xff08ff1b, 0x1d0cff1c, 0xff10ff23, 0xff14ff24, 0xff18ff2b, 0x2d1cff2c
  .long 0xff01ff10, 0x1705ff16, 0xff09ff18, 0x1f0dff1e, 0xff11ff20, 0xff15ff25, 0xff19ff28, 0x2f1dff2e
  .long 0x1202ff11, 0xff0605ff, 0x1a0aff19, 0xff0e10ff, 0x2212ff21, 0x2716ff26, 0x2a1aff29, 0xff1e25ff
  .long 0xffff00ff, 0xffff06ff, 0xffff0bff, 0xffff11ff, 0xffff16ff, 0xffff1bff, 0xffff20ff, 0xffff26ff
  .long 0xffff01ff, 0xffff07ff, 0xffff0cff, 0xffff12ff, 0xffff17ff, 0xffff1cff, 0xffff21ff, 0xffff27ff
  .long 0xffff02ff, 0xffff08ff, 0xffff0dff, 0xffff13ff, 0xffff18ff, 0xffff1dff, 0xffff22ff, 0xffff28ff
  .long 0xffff03ff, 0xffff09ff, 0xffff0eff, 0xffff14ff, 0xffff19ff, 0xffff1eff, 0xffff23ff, 0xffff29ff
  .long 0xff0304ff, 0xff070aff, 0xff0b0fff, 0xff0f15ff, 0xff131aff, 0xff171fff, 0xff1b24ff, 0xff1f2aff
L_touch:
  .long 0x80804101, 0x80804909, 0x80804303, 0x80808080, 0x80804b0b, 0x80804505, 0x80804d0d, 0x80808080
  .long 0x80804707, 0x80804f0f, 0x80805900, 0x80808080, 0x80805b08, 0x80805d02, 0x80805f0a, 0x80808080
  .long 0x80805804, 0x80805a0c, 0x80805c06, 0x80808080, 0x80805e0e, 0x80805140, 0x80806148, 0x80808080
  .long 0x80806942, 0x8080714a, 0x80807944, 0x80808080, 0x8080534c, 0x80806346, 0x80806b4e, 0x80808080
.section .rodata,"a"
.p2align 6
.amdhsa_kernel adaLN_cond__sliding_block_cached__glu_gated_swiglu__decode_kernel
  .amdhsa_next_free_vgpr 168
  .amdhsa_next_free_sgpr 102
  .amdhsa_accum_offset 168
  .amdhsa_group_segment_fixed_size 0
  .amdhsa_kernarg_size 112
  .amdhsa_user_sgpr_count 2
  .amdhsa_user_sgpr_kernarg_segment_ptr 1
  .amdhsa_system_sgpr_workgroup_id_x 1
.end_amdhsa_kernel
```

```asm
; @launch grid=(256,1,1) block=(768,1,1) lds=143360
.amdgcn_target "amdgcn-amd-amdhsa--gfx950"
.text
.globl adaLN_cond__sliding_block_cached__glu_gated_swiglu__decode_kernel
.p2align 8
.type adaLN_cond__sliding_block_cached__glu_gated_swiglu__decode_kernel,@function
adaLN_cond__sliding_block_cached__glu_gated_swiglu__decode_kernel:
  s_load_dwordx8 s[16:23], s[0:1], 0
  s_cmp_ge_u32 s2, 256
  s_cbranch_scc1 L_end
  v_lshrrev_b32 v2, 6, v0
  v_and_b32 v1, 63, v0
  v_readfirstlane_b32 s13, v2
  s_bfe_u32 s7, s2, 0x20003
  s_bfe_u32 s6, s2, 0x20005
  s_and_b32 s8, s2, 7
  s_lshl2_add_u32 s6, s8, s6
  s_and_b32 s9, s2, 0x80
  s_lshr_b32 s9, s9, 2
  s_add_u32 s6, s6, s9
  s_cmp_eq_u32 s7, 3
  s_cbranch_scc1 L_serv
  s_cmp_eq_u32 s13, 0
  s_cbranch_scc1 L_pub
L_stream:
  s_sub_u32 s9, s13, 1
  s_lshl_b32 s11, s9, 10
  s_mul_i32 s4, s7, 11264
  s_lshl_b32 s10, s6, 22
  s_add_u32 s10, s10, s4
  s_add_u32 s10, s10, 0x300000
  v_and_b32 v0, 15, v1
  v_lshl_add_u32 v0, v0, 6, s11
  v_and_b32 v3, 48, v1
  v_add_u32 v0, v3, v0
  s_lshr_b32 s15, s2, 3
  s_mul_i32 s12, s15, 33792
  s_sub_u32 s46, 0x100000, s4
  s_mov_b32 s47, 0x20000
  s_mov_b32 s14, 1047552
  s_waitcnt lgkmcnt(0)
  s_add_u32 s44, s18, s10
  s_addc_u32 s45, s19, 0
  buffer_load_dwordx4 v[44:47], v0, s[44:47], s12 offen nt
  s_add_u32 s12, s12, 33792
  s_cmp_eq_u32 s12, s14
  s_cselect_b32 s12, 0, s12
  buffer_load_dwordx4 v[48:51], v0, s[44:47], s12 offen nt
  s_add_u32 s12, s12, 33792
  s_cmp_eq_u32 s12, s14
  s_cselect_b32 s12, 0, s12
  buffer_load_dwordx4 v[52:55], v0, s[44:47], s12 offen nt
  s_add_u32 s12, s12, 33792
  s_cmp_eq_u32 s12, s14
  s_cselect_b32 s12, 0, s12
  buffer_load_dwordx4 v[40:43], v0, s[44:47], s14 offen nt
  s_add_u32 s48, s20, s10
  s_addc_u32 s49, s21, 0
  s_mov_b32 s50, s46
  s_mov_b32 s51, 0x20000
  s_mov_b32 s52, 0xcccccccc
  s_mov_b32 s53, 0xcccccccc
  s_mov_b32 s54, 0xaaaaaaaa
  s_mov_b32 s55, 0xaaaaaaaa
  v_and_b32 v38, 15, v1
  v_lshlrev_b32 v38, 4, v38
  s_lshl_b32 s10, s9, 11
  s_add_u32 s10, s10, 12288
  v_lshl_add_u32 v3, v1, 3, s10
  v_mov_b32 v4, 0x7fff0000
  v_mov_b32 v5, 0xff800000
  ds_write_b64 v3, v[4:5] offset:0
  ds_write_b64 v3, v[4:5] offset:512
  ds_write_b64 v3, v[4:5] offset:1024
  v_lshrrev_b32 v3, 4, v1
  v_lshl_add_u32 v39, v38, 1, s10
  v_lshl_add_u32 v39, v3, 3, v39
  s_sub_u32 s68, s15, 1
  v_and_b32 v4, 3, v1
  v_lshl_add_u32 v4, v3, 2, v4
  v_bfe_u32 v3, v1, 2, 2
  v_lshl_add_u32 v3, v3, 8, s11
  v_cmp_eq_u32 s[70:71], 0, v4
  v_add_u32 v24, s68, v4
  v_subrev_u32 v5, 31, v24
  v_min_u32 v24, v5, v24
  v_cndmask_b32 v24, v24, 31, s[70:71]
  v_mul_u32_u24 v24, 33792, v24
  v_add_u32 v24, v3, v24
  v_add_u32 v26, s68, v4
  v_add_u32 v26, 16, v26
  v_subrev_u32 v5, 31, v26
  v_min_u32 v26, v5, v26
  v_mul_u32_u24 v26, 33792, v26
  v_add_u32 v26, v3, v26
  s_lshl_b32 s11, s9, 9
  s_sub_u32 s11, s11, s10
  s_mov_b32 s32, 4
  s_mul_i32 s33, s9, 0x60000000
  s_add_u32 s33, s33, 0x10000000
  s_mov_b64 s[64:65], 0
  s_mov_b64 s[66:67], 0
  s_mov_b32 s38, 0
  s_mov_b32 s39, 2
  s_mov_b32 s75, 0
  s_mov_b32 s61, 0
  v_and_b32 v3, 1, v1
  v_lshlrev_b32 v3, 4, v3
  v_mov_b32 v20, 0xffff
  v_lshlrev_b32 v3, v3, v20
  v_bfe_u32 v20, v1, 1, 3
  v_cmp_eq_u32 vcc, 0, v20
  s_nop 1
  v_cndmask_b32 v34, 0, v3, vcc
  v_cmp_eq_u32 vcc, 1, v20
  s_nop 1
  v_cndmask_b32 v35, 0, v3, vcc
  v_cmp_eq_u32 vcc, 2, v20
  s_nop 1
  v_cndmask_b32 v36, 0, v3, vcc
  s_barrier
  s_waitcnt lgkmcnt(0)
  s_mov_b32 s56, s10
  s_mov_b32 s41, 5
  s_mov_b32 s57, 0
  s_mov_b32 s76, 20480
  s_mov_b32 s34, 175104
  s_mov_b32 s77, 0
  s_mov_b32 s35, 28
  s_mov_b32 s59, 0
  v_mov_b32 v22, 1332
  v_mov_b32 v23, 0
  v_mov_b32 v2, 0
  s_call_b64 s[62:63], L_kq
  buffer_load_dwordx4 v[56:59], v0, s[44:47], s12 offen nt
  s_add_u32 s12, s12, 33792
  s_cmp_eq_u32 s12, s14
  s_cselect_b32 s12, 0, s12
  s_call_b64 s[62:63], L_kq
  buffer_load_dwordx4 v[60:63], v0, s[44:47], s12 offen nt
  s_add_u32 s12, s12, 33792
  s_cmp_eq_u32 s12, s14
  s_cselect_b32 s12, 0, s12
  s_call_b64 s[62:63], L_kq
  buffer_load_dwordx4 v[64:67], v0, s[44:47], s12 offen nt
  s_add_u32 s12, s12, 33792
  s_cmp_eq_u32 s12, s14
  s_cselect_b32 s12, 0, s12
  s_call_b64 s[62:63], L_kq
  buffer_load_dwordx4 v[68:71], v0, s[44:47], s12 offen nt
  s_add_u32 s12, s12, 33792
  s_cmp_eq_u32 s12, s14
  s_cselect_b32 s12, 0, s12
  s_call_b64 s[62:63], L_kq
  buffer_load_dwordx4 v[72:75], v0, s[44:47], s12 offen nt
  s_add_u32 s12, s12, 33792
  s_cmp_eq_u32 s12, s14
  s_cselect_b32 s12, 0, s12
  s_call_b64 s[62:63], L_kq
  buffer_load_dwordx4 v[76:79], v0, s[44:47], s12 offen nt
  s_add_u32 s12, s12, 33792
  s_cmp_eq_u32 s12, s14
  s_cselect_b32 s12, 0, s12
  s_call_b64 s[62:63], L_kq
  buffer_load_dwordx4 v[80:83], v0, s[44:47], s12 offen nt
  s_add_u32 s12, s12, 33792
  s_cmp_eq_u32 s12, s14
  s_cselect_b32 s12, 0, s12
  s_call_b64 s[62:63], L_kq
  buffer_load_dwordx4 v[84:87], v0, s[44:47], s12 offen nt
  s_add_u32 s12, s12, 33792
  s_cmp_eq_u32 s12, s14
  s_cselect_b32 s12, 0, s12
  s_call_b64 s[62:63], L_kq
  buffer_load_dwordx4 v[88:91], v0, s[44:47], s12 offen nt
  s_add_u32 s12, s12, 33792
  s_cmp_eq_u32 s12, s14
  s_cselect_b32 s12, 0, s12
  s_call_b64 s[62:63], L_kq
  buffer_load_dwordx4 v[92:95], v0, s[44:47], s12 offen nt
  s_add_u32 s12, s12, 33792
  s_cmp_eq_u32 s12, s14
  s_cselect_b32 s12, 0, s12
  s_call_b64 s[62:63], L_kq
  buffer_load_dwordx4 v[96:99], v0, s[44:47], s12 offen nt
  s_add_u32 s12, s12, 33792
  s_cmp_eq_u32 s12, s14
  s_cselect_b32 s12, 0, s12
  s_call_b64 s[62:63], L_ks
  buffer_load_dwordx4 v[100:103], v0, s[44:47], s12 offen nt
  s_add_u32 s12, s12, 33792
  s_cmp_eq_u32 s12, s14
  s_cselect_b32 s12, 0, s12
  s_call_b64 s[62:63], L_ks
  buffer_load_dwordx4 v[104:107], v0, s[44:47], s12 offen nt
  s_add_u32 s12, s12, 33792
  s_cmp_eq_u32 s12, s14
  s_cselect_b32 s12, 0, s12
  s_call_b64 s[62:63], L_ks
  buffer_load_dwordx4 v[108:111], v0, s[44:47], s12 offen nt
  s_add_u32 s12, s12, 33792
  s_cmp_eq_u32 s12, s14
  s_cselect_b32 s12, 0, s12
  s_call_b64 s[62:63], L_ks
  buffer_load_dwordx4 v[112:115], v0, s[44:47], s12 offen nt
  s_add_u32 s12, s12, 33792
  s_cmp_eq_u32 s12, s14
  s_cselect_b32 s12, 0, s12
  s_call_b64 s[62:63], L_ks
  buffer_load_dwordx4 v[116:119], v0, s[44:47], s12 offen nt
  s_add_u32 s12, s12, 33792
  s_cmp_eq_u32 s12, s14
  s_cselect_b32 s12, 0, s12
  s_call_b64 s[62:63], L_ks
  buffer_load_dwordx4 v[120:123], v0, s[44:47], s12 offen nt
  s_add_u32 s12, s12, 33792
  s_cmp_eq_u32 s12, s14
  s_cselect_b32 s12, 0, s12
  s_call_b64 s[62:63], L_ks
  buffer_load_dwordx4 v[124:127], v0, s[44:47], s12 offen nt
  s_add_u32 s12, s12, 33792
  s_cmp_eq_u32 s12, s14
  s_cselect_b32 s12, 0, s12
  s_call_b64 s[62:63], L_ks
  buffer_load_dwordx4 v[128:131], v0, s[44:47], s12 offen nt
  s_add_u32 s12, s12, 33792
  s_cmp_eq_u32 s12, s14
  s_cselect_b32 s12, 0, s12
  s_call_b64 s[62:63], L_ks
  buffer_load_dwordx4 v[132:135], v0, s[44:47], s12 offen nt
  s_add_u32 s12, s12, 33792
  s_cmp_eq_u32 s12, s14
  s_cselect_b32 s12, 0, s12
  s_call_b64 s[62:63], L_ks
  buffer_load_dwordx4 v[136:139], v0, s[44:47], s12 offen nt
  s_add_u32 s12, s12, 33792
  s_cmp_eq_u32 s12, s14
  s_cselect_b32 s12, 0, s12
  s_call_b64 s[62:63], L_ks
  buffer_load_dwordx4 v[140:143], v0, s[44:47], s12 offen nt
  s_add_u32 s12, s12, 33792
  s_cmp_eq_u32 s12, s14
  s_cselect_b32 s12, 0, s12
  s_call_b64 s[62:63], L_ks
  buffer_load_dwordx4 v[144:147], v0, s[44:47], s12 offen nt
  s_add_u32 s12, s12, 33792
  s_cmp_eq_u32 s12, s14
  s_cselect_b32 s12, 0, s12
  s_call_b64 s[62:63], L_ks
  buffer_load_dwordx4 v[148:151], v0, s[44:47], s12 offen nt
  s_add_u32 s12, s12, 33792
  s_cmp_eq_u32 s12, s14
  s_cselect_b32 s12, 0, s12
  s_call_b64 s[62:63], L_ks
  buffer_load_dwordx4 v[152:155], v0, s[44:47], s12 offen nt
  s_add_u32 s12, s12, 33792
  s_cmp_eq_u32 s12, s14
  s_cselect_b32 s12, 0, s12
  s_add_u32 s34, s34, 4096
  s_call_b64 s[62:63], L_ks
  buffer_load_dwordx4 v[156:159], v0, s[44:47], s12 offen nt
  s_add_u32 s12, s12, 33792
  s_cmp_eq_u32 s12, s14
  s_cselect_b32 s12, 0, s12
  s_call_b64 s[62:63], L_ks
  buffer_load_dwordx4 v[160:163], v0, s[44:47], s12 offen nt
  s_add_u32 s12, s12, 33792
  s_cmp_eq_u32 s12, s14
  s_cselect_b32 s12, 0, s12
  s_call_b64 s[62:63], L_ks
  buffer_load_dwordx4 v[164:167], v0, s[44:47], s12 offen nt
  s_add_u32 s12, s12, 33792
  s_cmp_eq_u32 s12, s14
  s_cselect_b32 s12, 0, s12
  s_mov_b32 s10, 0
L_kw:
  s_cmp_ge_u32 s39, 6
  s_cbranch_scc1 L_v0
  s_call_b64 s[100:101], L_work
  s_sleep 1
  s_add_u32 s10, s10, 1
  s_cmp_lt_u32 s10, 262144
  s_cbranch_scc1 L_kw
L_v0:
  s_mov_b32 s32, 0
  v_mov_b32 v2, 8
  s_mov_b32 s35, s59
  ds_read_b64 v[22:23], v2 offset:288
  v_mov_b32_dpp v0, v36 row_shr:2 row_mask:0xf bank_mask:0xf bound_ctrl:0
  s_mov_b32 s77, 62
  s_mov_b32 s76, 12288
  s_mov_b32 s34, 163021
  s_waitcnt lgkmcnt(0)
  s_call_b64 s[62:63], L_vs
  v_add_u32_dpp v3, v28, v38 row_newbcast:0 row_mask:0xf bank_mask:0xf
  buffer_load_dwordx4 v[40:43], v3, s[48:51], 0 offen nt
  s_mov_b64 vcc, s[52:53]
  v_mfma_f32_16x16x32_bf16 v[8:11], v[4:7], v[136:139], 0
  v_mfma_f32_16x16x32_bf16 v[136:139], v[4:7], v[140:143], 0
  v_mfma_f32_16x16x32_bf16 v[140:143], v[4:7], v[144:147], 0
  v_mfma_f32_16x16x32_bf16 v[144:147], v[4:7], v[148:151], 0
  s_nop 4
  v_cndmask_b32 v8, v8, v9, s[54:55]
  v_cndmask_b32 v10, v10, v11, s[54:55]
  v_cndmask_b32 v136, v136, v137, s[54:55]
  v_cndmask_b32 v138, v138, v139, s[54:55]
  v_cndmask_b32 v140, v140, v141, s[54:55]
  v_cndmask_b32 v142, v142, v143, s[54:55]
  v_cndmask_b32 v144, v144, v145, s[54:55]
  v_cndmask_b32 v146, v146, v147, s[54:55]
  v_cndmask_b32_dpp v16, v8, v10, vcc quad_perm:[0,1,2,3] row_mask:0x4 bank_mask:0xf
  v_cndmask_b32_dpp v18, v136, v138, vcc quad_perm:[0,1,2,3] row_mask:0x4 bank_mask:0xf
  v_cndmask_b32_dpp v17, v140, v142, vcc quad_perm:[0,1,2,3] row_mask:0x4 bank_mask:0xf
  v_cndmask_b32_dpp v19, v144, v146, vcc quad_perm:[0,1,2,3] row_mask:0x4 bank_mask:0xf
  s_call_b64 s[62:63], L_vs
  s_cbranch_scc0 L_dr5
  v_add_u32_dpp v3, v28, v38 row_newbcast:1 row_mask:0xf bank_mask:0xf
  buffer_load_dwordx4 v[44:47], v3, s[48:51], 0 offen nt
  s_call_b64 s[62:63], L_vs
  s_cbranch_scc0 L_dr5
  v_add_u32_dpp v3, v28, v38 row_newbcast:2 row_mask:0xf bank_mask:0xf
  buffer_load_dwordx4 v[48:51], v3, s[48:51], 0 offen nt
  s_call_b64 s[62:63], L_vs
  s_cbranch_scc0 L_dr5
  v_add_u32_dpp v3, v28, v38 row_newbcast:3 row_mask:0xf bank_mask:0xf
  buffer_load_dwordx4 v[52:55], v3, s[48:51], 0 offen nt
  s_call_b64 s[62:63], L_vs
  s_cbranch_scc0 L_dr5
  v_add_u32_dpp v3, v28, v38 row_newbcast:4 row_mask:0xf bank_mask:0xf
  buffer_load_dwordx4 v[56:59], v3, s[48:51], 0 offen nt
  s_call_b64 s[62:63], L_vs
  s_cbranch_scc0 L_dr5
  v_add_u32_dpp v3, v28, v38 row_newbcast:5 row_mask:0xf bank_mask:0xf
  buffer_load_dwordx4 v[60:63], v3, s[48:51], 0 offen nt
  v_and_b32_dpp v12, v29, v34 row_newbcast:0 row_mask:0xf bank_mask:0xf
  v_and_b32_dpp v13, v29, v35 row_newbcast:0 row_mask:0xf bank_mask:0xf
  v_and_b32_dpp v14, v29, v36 row_newbcast:0 row_mask:0xf bank_mask:0xf
  v_and_b32_dpp v15, v29, v0 row_newbcast:0 row_mask:0xf bank_mask:0xf
  s_nop 1
  v_mfma_f32_16x16x32_bf16 v[8:11], v[12:15], v[40:43], v[8:11]
  s_call_b64 s[62:63], L_vs
  s_cbranch_scc0 L_dr6
  v_add_u32_dpp v3, v28, v38 row_newbcast:6 row_mask:0xf bank_mask:0xf
  buffer_load_dwordx4 v[64:67], v3, s[48:51], 0 offen nt
  v_and_b32_dpp v12, v29, v34 row_newbcast:1 row_mask:0xf bank_mask:0xf
  v_and_b32_dpp v13, v29, v35 row_newbcast:1 row_mask:0xf bank_mask:0xf
  v_and_b32_dpp v14, v29, v36 row_newbcast:1 row_mask:0xf bank_mask:0xf
  v_and_b32_dpp v15, v29, v0 row_newbcast:1 row_mask:0xf bank_mask:0xf
  s_nop 1
  v_mfma_f32_16x16x32_bf16 v[8:11], v[12:15], v[44:47], v[8:11]
  s_call_b64 s[62:63], L_vs
  s_cbranch_scc0 L_dr7
  v_add_u32_dpp v3, v28, v38 row_newbcast:7 row_mask:0xf bank_mask:0xf
  buffer_load_dwordx4 v[68:71], v3, s[48:51], 0 offen nt
  v_and_b32_dpp v12, v29, v34 row_newbcast:2 row_mask:0xf bank_mask:0xf
  v_and_b32_dpp v13, v29, v35 row_newbcast:2 row_mask:0xf bank_mask:0xf
  v_and_b32_dpp v14, v29, v36 row_newbcast:2 row_mask:0xf bank_mask:0xf
  v_and_b32_dpp v15, v29, v0 row_newbcast:2 row_mask:0xf bank_mask:0xf
  s_nop 1
  v_mfma_f32_16x16x32_bf16 v[8:11], v[12:15], v[48:51], v[8:11]
  s_call_b64 s[62:63], L_vs
  s_cbranch_scc0 L_dr8
  v_add_u32_dpp v3, v28, v38 row_newbcast:8 row_mask:0xf bank_mask:0xf
  buffer_load_dwordx4 v[72:75], v3, s[48:51], 0 offen nt
  v_and_b32_dpp v12, v29, v34 row_newbcast:3 row_mask:0xf bank_mask:0xf
  v_and_b32_dpp v13, v29, v35 row_newbcast:3 row_mask:0xf bank_mask:0xf
  v_and_b32_dpp v14, v29, v36 row_newbcast:3 row_mask:0xf bank_mask:0xf
  v_and_b32_dpp v15, v29, v0 row_newbcast:3 row_mask:0xf bank_mask:0xf
  s_nop 1
  v_mfma_f32_16x16x32_bf16 v[8:11], v[12:15], v[52:55], v[8:11]
  s_call_b64 s[62:63], L_vs
  s_cbranch_scc0 L_dr9
  v_add_u32_dpp v3, v28, v38 row_newbcast:9 row_mask:0xf bank_mask:0xf
  buffer_load_dwordx4 v[76:79], v3, s[48:51], 0 offen nt
  v_and_b32_dpp v12, v29, v34 row_newbcast:4 row_mask:0xf bank_mask:0xf
  v_and_b32_dpp v13, v29, v35 row_newbcast:4 row_mask:0xf bank_mask:0xf
  v_and_b32_dpp v14, v29, v36 row_newbcast:4 row_mask:0xf bank_mask:0xf
  v_and_b32_dpp v15, v29, v0 row_newbcast:4 row_mask:0xf bank_mask:0xf
  s_nop 1
  v_mfma_f32_16x16x32_bf16 v[8:11], v[12:15], v[56:59], v[8:11]
  s_call_b64 s[62:63], L_vs
  s_cbranch_scc0 L_dr10
  v_add_u32_dpp v3, v28, v38 row_newbcast:10 row_mask:0xf bank_mask:0xf
  buffer_load_dwordx4 v[80:83], v3, s[48:51], 0 offen nt
  v_and_b32_dpp v12, v29, v34 row_newbcast:5 row_mask:0xf bank_mask:0xf
  v_and_b32_dpp v13, v29, v35 row_newbcast:5 row_mask:0xf bank_mask:0xf
  v_and_b32_dpp v14, v29, v36 row_newbcast:5 row_mask:0xf bank_mask:0xf
  v_and_b32_dpp v15, v29, v0 row_newbcast:5 row_mask:0xf bank_mask:0xf
  s_nop 1
  v_mfma_f32_16x16x32_bf16 v[8:11], v[12:15], v[60:63], v[8:11]
  s_call_b64 s[62:63], L_vq
  s_cbranch_scc0 L_dr11
  v_add_u32_dpp v3, v28, v38 row_newbcast:11 row_mask:0xf bank_mask:0xf
  buffer_load_dwordx4 v[84:87], v3, s[48:51], 0 offen nt
  v_and_b32_dpp v12, v29, v34 row_newbcast:6 row_mask:0xf bank_mask:0xf
  v_and_b32_dpp v13, v29, v35 row_newbcast:6 row_mask:0xf bank_mask:0xf
  v_and_b32_dpp v14, v29, v36 row_newbcast:6 row_mask:0xf bank_mask:0xf
  v_and_b32_dpp v15, v29, v0 row_newbcast:6 row_mask:0xf bank_mask:0xf
  s_nop 1
  v_mfma_f32_16x16x32_bf16 v[8:11], v[12:15], v[64:67], v[8:11]
  s_call_b64 s[62:63], L_vq
  s_cbranch_scc0 L_dr12
  v_add_u32_dpp v3, v28, v38 row_newbcast:12 row_mask:0xf bank_mask:0xf
  buffer_load_dwordx4 v[88:91], v3, s[48:51], 0 offen nt
  v_and_b32_dpp v12, v29, v34 row_newbcast:7 row_mask:0xf bank_mask:0xf
  v_and_b32_dpp v13, v29, v35 row_newbcast:7 row_mask:0xf bank_mask:0xf
  v_and_b32_dpp v14, v29, v36 row_newbcast:7 row_mask:0xf bank_mask:0xf
  v_and_b32_dpp v15, v29, v0 row_newbcast:7 row_mask:0xf bank_mask:0xf
  s_nop 1
  v_mfma_f32_16x16x32_bf16 v[8:11], v[12:15], v[68:71], v[8:11]
  s_call_b64 s[62:63], L_vq
  s_cbranch_scc0 L_dr13
  v_add_u32_dpp v3, v28, v38 row_newbcast:13 row_mask:0xf bank_mask:0xf
  buffer_load_dwordx4 v[92:95], v3, s[48:51], 0 offen nt
  v_and_b32_dpp v12, v29, v34 row_newbcast:8 row_mask:0xf bank_mask:0xf
  v_and_b32_dpp v13, v29, v35 row_newbcast:8 row_mask:0xf bank_mask:0xf
  v_and_b32_dpp v14, v29, v36 row_newbcast:8 row_mask:0xf bank_mask:0xf
  v_and_b32_dpp v15, v29, v0 row_newbcast:8 row_mask:0xf bank_mask:0xf
  s_nop 1
  v_mfma_f32_16x16x32_bf16 v[8:11], v[12:15], v[72:75], v[8:11]
  s_call_b64 s[62:63], L_vq
  s_cbranch_scc0 L_dr14
  v_add_u32_dpp v3, v28, v38 row_newbcast:14 row_mask:0xf bank_mask:0xf
  buffer_load_dwordx4 v[96:99], v3, s[48:51], 0 offen nt
  v_and_b32_dpp v12, v29, v34 row_newbcast:9 row_mask:0xf bank_mask:0xf
  v_and_b32_dpp v13, v29, v35 row_newbcast:9 row_mask:0xf bank_mask:0xf
  v_and_b32_dpp v14, v29, v36 row_newbcast:9 row_mask:0xf bank_mask:0xf
  v_and_b32_dpp v15, v29, v0 row_newbcast:9 row_mask:0xf bank_mask:0xf
  s_nop 1
  v_mfma_f32_16x16x32_bf16 v[8:11], v[12:15], v[76:79], v[8:11]
  s_call_b64 s[62:63], L_vq
  s_cbranch_scc0 L_dr15
  v_add_u32_dpp v3, v28, v38 row_newbcast:15 row_mask:0xf bank_mask:0xf
  buffer_load_dwordx4 v[100:103], v3, s[48:51], 0 offen nt
  v_and_b32_dpp v12, v29, v34 row_newbcast:10 row_mask:0xf bank_mask:0xf
  v_and_b32_dpp v13, v29, v35 row_newbcast:10 row_mask:0xf bank_mask:0xf
  v_and_b32_dpp v14, v29, v36 row_newbcast:10 row_mask:0xf bank_mask:0xf
  v_and_b32_dpp v15, v29, v0 row_newbcast:10 row_mask:0xf bank_mask:0xf
  s_nop 1
  v_mfma_f32_16x16x32_bf16 v[8:11], v[12:15], v[80:83], v[8:11]
  s_call_b64 s[62:63], L_vq
  s_cbranch_scc0 L_dr16
  v_add_u32_dpp v3, v30, v38 row_newbcast:0 row_mask:0xf bank_mask:0xf
  buffer_load_dwordx4 v[104:107], v3, s[48:51], 0 offen nt
  v_and_b32_dpp v12, v29, v34 row_newbcast:11 row_mask:0xf bank_mask:0xf
  v_and_b32_dpp v13, v29, v35 row_newbcast:11 row_mask:0xf bank_mask:0xf
  v_and_b32_dpp v14, v29, v36 row_newbcast:11 row_mask:0xf bank_mask:0xf
  v_and_b32_dpp v15, v29, v0 row_newbcast:11 row_mask:0xf bank_mask:0xf
  s_nop 1
  v_mfma_f32_16x16x32_bf16 v[8:11], v[12:15], v[84:87], v[8:11]
  s_call_b64 s[62:63], L_vq
  s_cbranch_scc0 L_dr17
  v_add_u32_dpp v3, v30, v38 row_newbcast:1 row_mask:0xf bank_mask:0xf
  buffer_load_dwordx4 v[108:111], v3, s[48:51], 0 offen nt
  v_and_b32_dpp v12, v29, v34 row_newbcast:12 row_mask:0xf bank_mask:0xf
  v_and_b32_dpp v13, v29, v35 row_newbcast:12 row_mask:0xf bank_mask:0xf
  v_and_b32_dpp v14, v29, v36 row_newbcast:12 row_mask:0xf bank_mask:0xf
  v_and_b32_dpp v15, v29, v0 row_newbcast:12 row_mask:0xf bank_mask:0xf
  s_nop 1
  v_mfma_f32_16x16x32_bf16 v[8:11], v[12:15], v[88:91], v[8:11]
  s_call_b64 s[62:63], L_vq
  s_cbranch_scc0 L_dr18
  v_add_u32_dpp v3, v30, v38 row_newbcast:2 row_mask:0xf bank_mask:0xf
  buffer_load_dwordx4 v[112:115], v3, s[48:51], 0 offen nt
  v_and_b32_dpp v12, v29, v34 row_newbcast:13 row_mask:0xf bank_mask:0xf
  v_and_b32_dpp v13, v29, v35 row_newbcast:13 row_mask:0xf bank_mask:0xf
  v_and_b32_dpp v14, v29, v36 row_newbcast:13 row_mask:0xf bank_mask:0xf
  v_and_b32_dpp v15, v29, v0 row_newbcast:13 row_mask:0xf bank_mask:0xf
  s_nop 1
  v_mfma_f32_16x16x32_bf16 v[8:11], v[12:15], v[92:95], v[8:11]
  s_call_b64 s[62:63], L_vq
  s_cbranch_scc0 L_dr19
  v_add_u32_dpp v3, v30, v38 row_newbcast:3 row_mask:0xf bank_mask:0xf
  buffer_load_dwordx4 v[116:119], v3, s[48:51], 0 offen nt
  v_and_b32_dpp v12, v29, v34 row_newbcast:14 row_mask:0xf bank_mask:0xf
  v_and_b32_dpp v13, v29, v35 row_newbcast:14 row_mask:0xf bank_mask:0xf
  v_and_b32_dpp v14, v29, v36 row_newbcast:14 row_mask:0xf bank_mask:0xf
  v_and_b32_dpp v15, v29, v0 row_newbcast:14 row_mask:0xf bank_mask:0xf
  s_nop 1
  v_mfma_f32_16x16x32_bf16 v[8:11], v[12:15], v[96:99], v[8:11]
  s_call_b64 s[62:63], L_vq
  s_cbranch_scc0 L_dr20
  v_add_u32_dpp v3, v30, v38 row_newbcast:4 row_mask:0xf bank_mask:0xf
  buffer_load_dwordx4 v[120:123], v3, s[48:51], 0 offen nt
  v_and_b32_dpp v12, v29, v34 row_newbcast:15 row_mask:0xf bank_mask:0xf
  v_and_b32_dpp v13, v29, v35 row_newbcast:15 row_mask:0xf bank_mask:0xf
  v_and_b32_dpp v14, v29, v36 row_newbcast:15 row_mask:0xf bank_mask:0xf
  v_and_b32_dpp v15, v29, v0 row_newbcast:15 row_mask:0xf bank_mask:0xf
  s_nop 1
  v_mfma_f32_16x16x32_bf16 v[8:11], v[12:15], v[100:103], v[8:11]
  s_call_b64 s[62:63], L_vq
  s_cbranch_scc0 L_dr21
  v_add_u32_dpp v3, v30, v38 row_newbcast:5 row_mask:0xf bank_mask:0xf
  buffer_load_dwordx4 v[124:127], v3, s[48:51], 0 offen nt
  v_and_b32_dpp v12, v31, v34 row_newbcast:0 row_mask:0xf bank_mask:0xf
  v_and_b32_dpp v13, v31, v35 row_newbcast:0 row_mask:0xf bank_mask:0xf
  v_and_b32_dpp v14, v31, v36 row_newbcast:0 row_mask:0xf bank_mask:0xf
  v_and_b32_dpp v15, v31, v0 row_newbcast:0 row_mask:0xf bank_mask:0xf
  s_nop 1
  v_mfma_f32_16x16x32_bf16 v[8:11], v[12:15], v[104:107], v[8:11]
  s_call_b64 s[62:63], L_vq
  s_cbranch_scc0 L_dr22
  v_add_u32_dpp v3, v30, v38 row_newbcast:6 row_mask:0xf bank_mask:0xf
  buffer_load_dwordx4 v[128:131], v3, s[48:51], 0 offen nt
  v_and_b32_dpp v12, v31, v34 row_newbcast:1 row_mask:0xf bank_mask:0xf
  v_and_b32_dpp v13, v31, v35 row_newbcast:1 row_mask:0xf bank_mask:0xf
  v_and_b32_dpp v14, v31, v36 row_newbcast:1 row_mask:0xf bank_mask:0xf
  v_and_b32_dpp v15, v31, v0 row_newbcast:1 row_mask:0xf bank_mask:0xf
  s_nop 1
  v_mfma_f32_16x16x32_bf16 v[8:11], v[12:15], v[108:111], v[8:11]
  s_call_b64 s[62:63], L_vq
  s_cbranch_scc0 L_dr23
  v_add_u32_dpp v3, v30, v38 row_newbcast:7 row_mask:0xf bank_mask:0xf
  buffer_load_dwordx4 v[132:135], v3, s[48:51], 0 offen nt
  v_and_b32_dpp v12, v31, v34 row_newbcast:2 row_mask:0xf bank_mask:0xf
  v_and_b32_dpp v13, v31, v35 row_newbcast:2 row_mask:0xf bank_mask:0xf
  v_and_b32_dpp v14, v31, v36 row_newbcast:2 row_mask:0xf bank_mask:0xf
  v_and_b32_dpp v15, v31, v0 row_newbcast:2 row_mask:0xf bank_mask:0xf
  s_nop 1
  v_mfma_f32_16x16x32_bf16 v[8:11], v[12:15], v[112:115], v[8:11]
  s_call_b64 s[62:63], L_vq
  s_cbranch_scc0 L_dr24
  v_add_u32_dpp v3, v30, v38 row_newbcast:8 row_mask:0xf bank_mask:0xf
  buffer_load_dwordx4 v[136:139], v3, s[48:51], 0 offen nt
  v_and_b32_dpp v12, v31, v34 row_newbcast:3 row_mask:0xf bank_mask:0xf
  v_and_b32_dpp v13, v31, v35 row_newbcast:3 row_mask:0xf bank_mask:0xf
  v_and_b32_dpp v14, v31, v36 row_newbcast:3 row_mask:0xf bank_mask:0xf
  v_and_b32_dpp v15, v31, v0 row_newbcast:3 row_mask:0xf bank_mask:0xf
  s_nop 1
  v_mfma_f32_16x16x32_bf16 v[8:11], v[12:15], v[116:119], v[8:11]
  s_call_b64 s[62:63], L_vq
  s_cbranch_scc0 L_dr25
  v_add_u32_dpp v3, v30, v38 row_newbcast:9 row_mask:0xf bank_mask:0xf
  buffer_load_dwordx4 v[140:143], v3, s[48:51], 0 offen nt
  v_and_b32_dpp v12, v31, v34 row_newbcast:4 row_mask:0xf bank_mask:0xf
  v_and_b32_dpp v13, v31, v35 row_newbcast:4 row_mask:0xf bank_mask:0xf
  v_and_b32_dpp v14, v31, v36 row_newbcast:4 row_mask:0xf bank_mask:0xf
  v_and_b32_dpp v15, v31, v0 row_newbcast:4 row_mask:0xf bank_mask:0xf
  s_nop 1
  v_mfma_f32_16x16x32_bf16 v[8:11], v[12:15], v[120:123], v[8:11]
  s_call_b64 s[62:63], L_vq
  s_cbranch_scc0 L_dr26
  v_add_u32_dpp v3, v30, v38 row_newbcast:10 row_mask:0xf bank_mask:0xf
  buffer_load_dwordx4 v[144:147], v3, s[48:51], 0 offen nt
  v_and_b32_dpp v12, v31, v34 row_newbcast:5 row_mask:0xf bank_mask:0xf
  v_and_b32_dpp v13, v31, v35 row_newbcast:5 row_mask:0xf bank_mask:0xf
  v_and_b32_dpp v14, v31, v36 row_newbcast:5 row_mask:0xf bank_mask:0xf
  v_and_b32_dpp v15, v31, v0 row_newbcast:5 row_mask:0xf bank_mask:0xf
  s_nop 1
  v_mfma_f32_16x16x32_bf16 v[8:11], v[12:15], v[124:127], v[8:11]
  s_call_b64 s[62:63], L_vq
  s_cbranch_scc0 L_dr27
  v_add_u32_dpp v3, v30, v38 row_newbcast:11 row_mask:0xf bank_mask:0xf
  buffer_load_dwordx4 v[148:151], v3, s[48:51], 0 offen nt
  v_and_b32_dpp v12, v31, v34 row_newbcast:6 row_mask:0xf bank_mask:0xf
  v_and_b32_dpp v13, v31, v35 row_newbcast:6 row_mask:0xf bank_mask:0xf
  v_and_b32_dpp v14, v31, v36 row_newbcast:6 row_mask:0xf bank_mask:0xf
  v_and_b32_dpp v15, v31, v0 row_newbcast:6 row_mask:0xf bank_mask:0xf
  s_nop 1
  v_mfma_f32_16x16x32_bf16 v[8:11], v[12:15], v[128:131], v[8:11]
  s_call_b64 s[62:63], L_vq
  s_cbranch_scc0 L_dr28
  v_add_u32_dpp v3, v30, v38 row_newbcast:12 row_mask:0xf bank_mask:0xf
  buffer_load_dwordx4 v[152:155], v3, s[48:51], 0 offen nt
  v_and_b32_dpp v12, v31, v34 row_newbcast:7 row_mask:0xf bank_mask:0xf
  v_and_b32_dpp v13, v31, v35 row_newbcast:7 row_mask:0xf bank_mask:0xf
  v_and_b32_dpp v14, v31, v36 row_newbcast:7 row_mask:0xf bank_mask:0xf
  v_and_b32_dpp v15, v31, v0 row_newbcast:7 row_mask:0xf bank_mask:0xf
  s_nop 1
  v_mfma_f32_16x16x32_bf16 v[8:11], v[12:15], v[132:135], v[8:11]
  s_call_b64 s[62:63], L_vq
  s_cbranch_scc0 L_dr29
  v_add_u32_dpp v3, v30, v38 row_newbcast:13 row_mask:0xf bank_mask:0xf
  buffer_load_dwordx4 v[156:159], v3, s[48:51], 0 offen nt
  v_and_b32_dpp v12, v31, v34 row_newbcast:8 row_mask:0xf bank_mask:0xf
  v_and_b32_dpp v13, v31, v35 row_newbcast:8 row_mask:0xf bank_mask:0xf
  v_and_b32_dpp v14, v31, v36 row_newbcast:8 row_mask:0xf bank_mask:0xf
  v_and_b32_dpp v15, v31, v0 row_newbcast:8 row_mask:0xf bank_mask:0xf
  s_nop 1
  v_mfma_f32_16x16x32_bf16 v[8:11], v[12:15], v[136:139], v[8:11]
  s_call_b64 s[62:63], L_vq
  s_cbranch_scc0 L_dr30
  v_add_u32_dpp v3, v30, v38 row_newbcast:14 row_mask:0xf bank_mask:0xf
  buffer_load_dwordx4 v[160:163], v3, s[48:51], 0 offen nt
  v_and_b32_dpp v12, v31, v34 row_newbcast:9 row_mask:0xf bank_mask:0xf
  v_and_b32_dpp v13, v31, v35 row_newbcast:9 row_mask:0xf bank_mask:0xf
  v_and_b32_dpp v14, v31, v36 row_newbcast:9 row_mask:0xf bank_mask:0xf
  v_and_b32_dpp v15, v31, v0 row_newbcast:9 row_mask:0xf bank_mask:0xf
  s_nop 1
  v_mfma_f32_16x16x32_bf16 v[8:11], v[12:15], v[140:143], v[8:11]
  s_call_b64 s[62:63], L_vq
  s_cbranch_scc0 L_dr31
  v_add_u32_dpp v3, v30, v38 row_newbcast:15 row_mask:0xf bank_mask:0xf
  buffer_load_dwordx4 v[164:167], v3, s[48:51], 0 offen nt
  v_and_b32_dpp v12, v31, v34 row_newbcast:10 row_mask:0xf bank_mask:0xf
  v_and_b32_dpp v13, v31, v35 row_newbcast:10 row_mask:0xf bank_mask:0xf
  v_and_b32_dpp v14, v31, v36 row_newbcast:10 row_mask:0xf bank_mask:0xf
  v_and_b32_dpp v15, v31, v0 row_newbcast:10 row_mask:0xf bank_mask:0xf
  s_nop 1
  v_mfma_f32_16x16x32_bf16 v[8:11], v[12:15], v[144:147], v[8:11]
  s_call_b64 s[62:63], L_vq
  s_cbranch_scc0 L_dr32
  v_add_u32_dpp v3, v32, v38 row_newbcast:0 row_mask:0xf bank_mask:0xf
  buffer_load_dwordx4 v[40:43], v3, s[48:51], 0 offen nt
  v_and_b32_dpp v12, v31, v34 row_newbcast:11 row_mask:0xf bank_mask:0xf
  v_and_b32_dpp v13, v31, v35 row_newbcast:11 row_mask:0xf bank_mask:0xf
  v_and_b32_dpp v14, v31, v36 row_newbcast:11 row_mask:0xf bank_mask:0xf
  v_and_b32_dpp v15, v31, v0 row_newbcast:11 row_mask:0xf bank_mask:0xf
  s_nop 1
  v_mfma_f32_16x16x32_bf16 v[8:11], v[12:15], v[148:151], v[8:11]
  s_call_b64 s[62:63], L_vq
  s_cbranch_scc0 L_dr33
  v_add_u32_dpp v3, v32, v38 row_newbcast:1 row_mask:0xf bank_mask:0xf
  buffer_load_dwordx4 v[44:47], v3, s[48:51], 0 offen nt
  v_and_b32_dpp v12, v31, v34 row_newbcast:12 row_mask:0xf bank_mask:0xf
  v_and_b32_dpp v13, v31, v35 row_newbcast:12 row_mask:0xf bank_mask:0xf
  v_and_b32_dpp v14, v31, v36 row_newbcast:12 row_mask:0xf bank_mask:0xf
  v_and_b32_dpp v15, v31, v0 row_newbcast:12 row_mask:0xf bank_mask:0xf
  s_nop 1
  v_mfma_f32_16x16x32_bf16 v[8:11], v[12:15], v[152:155], v[8:11]
  s_call_b64 s[62:63], L_vq
  s_cbranch_scc0 L_dr34
  v_add_u32_dpp v3, v32, v38 row_newbcast:2 row_mask:0xf bank_mask:0xf
  buffer_load_dwordx4 v[48:51], v3, s[48:51], 0 offen nt
  v_and_b32_dpp v12, v31, v34 row_newbcast:13 row_mask:0xf bank_mask:0xf
  v_and_b32_dpp v13, v31, v35 row_newbcast:13 row_mask:0xf bank_mask:0xf
  v_and_b32_dpp v14, v31, v36 row_newbcast:13 row_mask:0xf bank_mask:0xf
  v_and_b32_dpp v15, v31, v0 row_newbcast:13 row_mask:0xf bank_mask:0xf
  s_nop 1
  v_mfma_f32_16x16x32_bf16 v[8:11], v[12:15], v[156:159], v[8:11]
  s_call_b64 s[62:63], L_vq
  s_cbranch_scc0 L_dr35
  v_add_u32_dpp v3, v32, v38 row_newbcast:3 row_mask:0xf bank_mask:0xf
  buffer_load_dwordx4 v[52:55], v3, s[48:51], 0 offen nt
  v_and_b32_dpp v12, v31, v34 row_newbcast:14 row_mask:0xf bank_mask:0xf
  v_and_b32_dpp v13, v31, v35 row_newbcast:14 row_mask:0xf bank_mask:0xf
  v_and_b32_dpp v14, v31, v36 row_newbcast:14 row_mask:0xf bank_mask:0xf
  v_and_b32_dpp v15, v31, v0 row_newbcast:14 row_mask:0xf bank_mask:0xf
  s_nop 1
  v_mfma_f32_16x16x32_bf16 v[8:11], v[12:15], v[160:163], v[8:11]
  s_call_b64 s[62:63], L_vq
  s_cbranch_scc0 L_dr36
  v_add_u32_dpp v3, v32, v38 row_newbcast:4 row_mask:0xf bank_mask:0xf
  buffer_load_dwordx4 v[56:59], v3, s[48:51], 0 offen nt
  v_and_b32_dpp v12, v31, v34 row_newbcast:15 row_mask:0xf bank_mask:0xf
  v_and_b32_dpp v13, v31, v35 row_newbcast:15 row_mask:0xf bank_mask:0xf
  v_and_b32_dpp v14, v31, v36 row_newbcast:15 row_mask:0xf bank_mask:0xf
  v_and_b32_dpp v15, v31, v0 row_newbcast:15 row_mask:0xf bank_mask:0xf
  s_nop 1
  v_mfma_f32_16x16x32_bf16 v[8:11], v[12:15], v[164:167], v[8:11]
  s_call_b64 s[62:63], L_vq
  s_cbranch_scc0 L_dr37
  v_add_u32_dpp v3, v32, v38 row_newbcast:5 row_mask:0xf bank_mask:0xf
  buffer_load_dwordx4 v[60:63], v3, s[48:51], 0 offen nt
  v_and_b32_dpp v12, v33, v34 row_newbcast:0 row_mask:0xf bank_mask:0xf
  v_and_b32_dpp v13, v33, v35 row_newbcast:0 row_mask:0xf bank_mask:0xf
  v_and_b32_dpp v14, v33, v36 row_newbcast:0 row_mask:0xf bank_mask:0xf
  v_and_b32_dpp v15, v33, v0 row_newbcast:0 row_mask:0xf bank_mask:0xf
  s_nop 1
  v_mfma_f32_16x16x32_bf16 v[8:11], v[12:15], v[40:43], v[8:11]
  s_call_b64 s[62:63], L_vq
  s_branch L_dr38
L_dr5:
  v_and_b32_dpp v12, v29, v34 row_newbcast:0 row_mask:0xf bank_mask:0xf
  v_and_b32_dpp v13, v29, v35 row_newbcast:0 row_mask:0xf bank_mask:0xf
  v_and_b32_dpp v14, v29, v36 row_newbcast:0 row_mask:0xf bank_mask:0xf
  v_and_b32_dpp v15, v29, v0 row_newbcast:0 row_mask:0xf bank_mask:0xf
  s_nop 1
  v_mfma_f32_16x16x32_bf16 v[8:11], v[12:15], v[40:43], v[8:11]
  s_cmp_eq_u32 s75, 6
  s_cbranch_scc1 L_epi
L_dr6:
  v_and_b32_dpp v12, v29, v34 row_newbcast:1 row_mask:0xf bank_mask:0xf
  v_and_b32_dpp v13, v29, v35 row_newbcast:1 row_mask:0xf bank_mask:0xf
  v_and_b32_dpp v14, v29, v36 row_newbcast:1 row_mask:0xf bank_mask:0xf
  v_and_b32_dpp v15, v29, v0 row_newbcast:1 row_mask:0xf bank_mask:0xf
  s_nop 1
  v_mfma_f32_16x16x32_bf16 v[8:11], v[12:15], v[44:47], v[8:11]
  s_cmp_eq_u32 s75, 7
  s_cbranch_scc1 L_epi
L_dr7:
  v_and_b32_dpp v12, v29, v34 row_newbcast:2 row_mask:0xf bank_mask:0xf
  v_and_b32_dpp v13, v29, v35 row_newbcast:2 row_mask:0xf bank_mask:0xf
  v_and_b32_dpp v14, v29, v36 row_newbcast:2 row_mask:0xf bank_mask:0xf
  v_and_b32_dpp v15, v29, v0 row_newbcast:2 row_mask:0xf bank_mask:0xf
  s_nop 1
  v_mfma_f32_16x16x32_bf16 v[8:11], v[12:15], v[48:51], v[8:11]
  s_cmp_eq_u32 s75, 8
  s_cbranch_scc1 L_epi
L_dr8:
  v_and_b32_dpp v12, v29, v34 row_newbcast:3 row_mask:0xf bank_mask:0xf
  v_and_b32_dpp v13, v29, v35 row_newbcast:3 row_mask:0xf bank_mask:0xf
  v_and_b32_dpp v14, v29, v36 row_newbcast:3 row_mask:0xf bank_mask:0xf
  v_and_b32_dpp v15, v29, v0 row_newbcast:3 row_mask:0xf bank_mask:0xf
  s_nop 1
  v_mfma_f32_16x16x32_bf16 v[8:11], v[12:15], v[52:55], v[8:11]
  s_cmp_eq_u32 s75, 9
  s_cbranch_scc1 L_epi
L_dr9:
  v_and_b32_dpp v12, v29, v34 row_newbcast:4 row_mask:0xf bank_mask:0xf
  v_and_b32_dpp v13, v29, v35 row_newbcast:4 row_mask:0xf bank_mask:0xf
  v_and_b32_dpp v14, v29, v36 row_newbcast:4 row_mask:0xf bank_mask:0xf
  v_and_b32_dpp v15, v29, v0 row_newbcast:4 row_mask:0xf bank_mask:0xf
  s_nop 1
  v_mfma_f32_16x16x32_bf16 v[8:11], v[12:15], v[56:59], v[8:11]
  s_cmp_eq_u32 s75, 10
  s_cbranch_scc1 L_epi
L_dr10:
  v_and_b32_dpp v12, v29, v34 row_newbcast:5 row_mask:0xf bank_mask:0xf
  v_and_b32_dpp v13, v29, v35 row_newbcast:5 row_mask:0xf bank_mask:0xf
  v_and_b32_dpp v14, v29, v36 row_newbcast:5 row_mask:0xf bank_mask:0xf
  v_and_b32_dpp v15, v29, v0 row_newbcast:5 row_mask:0xf bank_mask:0xf
  s_nop 1
  v_mfma_f32_16x16x32_bf16 v[8:11], v[12:15], v[60:63], v[8:11]
  s_cmp_eq_u32 s75, 11
  s_cbranch_scc1 L_epi
L_dr11:
  v_and_b32_dpp v12, v29, v34 row_newbcast:6 row_mask:0xf bank_mask:0xf
  v_and_b32_dpp v13, v29, v35 row_newbcast:6 row_mask:0xf bank_mask:0xf
  v_and_b32_dpp v14, v29, v36 row_newbcast:6 row_mask:0xf bank_mask:0xf
  v_and_b32_dpp v15, v29, v0 row_newbcast:6 row_mask:0xf bank_mask:0xf
  s_nop 1
  v_mfma_f32_16x16x32_bf16 v[8:11], v[12:15], v[64:67], v[8:11]
  s_cmp_eq_u32 s75, 12
  s_cbranch_scc1 L_epi
L_dr12:
  v_and_b32_dpp v12, v29, v34 row_newbcast:7 row_mask:0xf bank_mask:0xf
  v_and_b32_dpp v13, v29, v35 row_newbcast:7 row_mask:0xf bank_mask:0xf
  v_and_b32_dpp v14, v29, v36 row_newbcast:7 row_mask:0xf bank_mask:0xf
  v_and_b32_dpp v15, v29, v0 row_newbcast:7 row_mask:0xf bank_mask:0xf
  s_nop 1
  v_mfma_f32_16x16x32_bf16 v[8:11], v[12:15], v[68:71], v[8:11]
  s_cmp_eq_u32 s75, 13
  s_cbranch_scc1 L_epi
L_dr13:
  v_and_b32_dpp v12, v29, v34 row_newbcast:8 row_mask:0xf bank_mask:0xf
  v_and_b32_dpp v13, v29, v35 row_newbcast:8 row_mask:0xf bank_mask:0xf
  v_and_b32_dpp v14, v29, v36 row_newbcast:8 row_mask:0xf bank_mask:0xf
  v_and_b32_dpp v15, v29, v0 row_newbcast:8 row_mask:0xf bank_mask:0xf
  s_nop 1
  v_mfma_f32_16x16x32_bf16 v[8:11], v[12:15], v[72:75], v[8:11]
  s_cmp_eq_u32 s75, 14
  s_cbranch_scc1 L_epi
L_dr14:
  v_and_b32_dpp v12, v29, v34 row_newbcast:9 row_mask:0xf bank_mask:0xf
  v_and_b32_dpp v13, v29, v35 row_newbcast:9 row_mask:0xf bank_mask:0xf
  v_and_b32_dpp v14, v29, v36 row_newbcast:9 row_mask:0xf bank_mask:0xf
  v_and_b32_dpp v15, v29, v0 row_newbcast:9 row_mask:0xf bank_mask:0xf
  s_nop 1
  v_mfma_f32_16x16x32_bf16 v[8:11], v[12:15], v[76:79], v[8:11]
  s_cmp_eq_u32 s75, 15
  s_cbranch_scc1 L_epi
L_dr15:
  v_and_b32_dpp v12, v29, v34 row_newbcast:10 row_mask:0xf bank_mask:0xf
  v_and_b32_dpp v13, v29, v35 row_newbcast:10 row_mask:0xf bank_mask:0xf
  v_and_b32_dpp v14, v29, v36 row_newbcast:10 row_mask:0xf bank_mask:0xf
  v_and_b32_dpp v15, v29, v0 row_newbcast:10 row_mask:0xf bank_mask:0xf
  s_nop 1
  v_mfma_f32_16x16x32_bf16 v[8:11], v[12:15], v[80:83], v[8:11]
  s_cmp_eq_u32 s75, 16
  s_cbranch_scc1 L_epi
L_dr16:
  v_and_b32_dpp v12, v29, v34 row_newbcast:11 row_mask:0xf bank_mask:0xf
  v_and_b32_dpp v13, v29, v35 row_newbcast:11 row_mask:0xf bank_mask:0xf
  v_and_b32_dpp v14, v29, v36 row_newbcast:11 row_mask:0xf bank_mask:0xf
  v_and_b32_dpp v15, v29, v0 row_newbcast:11 row_mask:0xf bank_mask:0xf
  s_nop 1
  v_mfma_f32_16x16x32_bf16 v[8:11], v[12:15], v[84:87], v[8:11]
  s_cmp_eq_u32 s75, 17
  s_cbranch_scc1 L_epi
L_dr17:
  v_and_b32_dpp v12, v29, v34 row_newbcast:12 row_mask:0xf bank_mask:0xf
  v_and_b32_dpp v13, v29, v35 row_newbcast:12 row_mask:0xf bank_mask:0xf
  v_and_b32_dpp v14, v29, v36 row_newbcast:12 row_mask:0xf bank_mask:0xf
  v_and_b32_dpp v15, v29, v0 row_newbcast:12 row_mask:0xf bank_mask:0xf
  s_nop 1
  v_mfma_f32_16x16x32_bf16 v[8:11], v[12:15], v[88:91], v[8:11]
  s_cmp_eq_u32 s75, 18
  s_cbranch_scc1 L_epi
L_dr18:
  v_and_b32_dpp v12, v29, v34 row_newbcast:13 row_mask:0xf bank_mask:0xf
  v_and_b32_dpp v13, v29, v35 row_newbcast:13 row_mask:0xf bank_mask:0xf
  v_and_b32_dpp v14, v29, v36 row_newbcast:13 row_mask:0xf bank_mask:0xf
  v_and_b32_dpp v15, v29, v0 row_newbcast:13 row_mask:0xf bank_mask:0xf
  s_nop 1
  v_mfma_f32_16x16x32_bf16 v[8:11], v[12:15], v[92:95], v[8:11]
  s_cmp_eq_u32 s75, 19
  s_cbranch_scc1 L_epi
L_dr19:
  v_and_b32_dpp v12, v29, v34 row_newbcast:14 row_mask:0xf bank_mask:0xf
  v_and_b32_dpp v13, v29, v35 row_newbcast:14 row_mask:0xf bank_mask:0xf
  v_and_b32_dpp v14, v29, v36 row_newbcast:14 row_mask:0xf bank_mask:0xf
  v_and_b32_dpp v15, v29, v0 row_newbcast:14 row_mask:0xf bank_mask:0xf
  s_nop 1
  v_mfma_f32_16x16x32_bf16 v[8:11], v[12:15], v[96:99], v[8:11]
  s_cmp_eq_u32 s75, 20
  s_cbranch_scc1 L_epi
L_dr20:
  v_and_b32_dpp v12, v29, v34 row_newbcast:15 row_mask:0xf bank_mask:0xf
  v_and_b32_dpp v13, v29, v35 row_newbcast:15 row_mask:0xf bank_mask:0xf
  v_and_b32_dpp v14, v29, v36 row_newbcast:15 row_mask:0xf bank_mask:0xf
  v_and_b32_dpp v15, v29, v0 row_newbcast:15 row_mask:0xf bank_mask:0xf
  s_nop 1
  v_mfma_f32_16x16x32_bf16 v[8:11], v[12:15], v[100:103], v[8:11]
  s_cmp_eq_u32 s75, 21
  s_cbranch_scc1 L_epi
L_dr21:
  v_and_b32_dpp v12, v31, v34 row_newbcast:0 row_mask:0xf bank_mask:0xf
  v_and_b32_dpp v13, v31, v35 row_newbcast:0 row_mask:0xf bank_mask:0xf
  v_and_b32_dpp v14, v31, v36 row_newbcast:0 row_mask:0xf bank_mask:0xf
  v_and_b32_dpp v15, v31, v0 row_newbcast:0 row_mask:0xf bank_mask:0xf
  s_nop 1
  v_mfma_f32_16x16x32_bf16 v[8:11], v[12:15], v[104:107], v[8:11]
  s_cmp_eq_u32 s75, 22
  s_cbranch_scc1 L_epi
L_dr22:
  v_and_b32_dpp v12, v31, v34 row_newbcast:1 row_mask:0xf bank_mask:0xf
  v_and_b32_dpp v13, v31, v35 row_newbcast:1 row_mask:0xf bank_mask:0xf
  v_and_b32_dpp v14, v31, v36 row_newbcast:1 row_mask:0xf bank_mask:0xf
  v_and_b32_dpp v15, v31, v0 row_newbcast:1 row_mask:0xf bank_mask:0xf
  s_nop 1
  v_mfma_f32_16x16x32_bf16 v[8:11], v[12:15], v[108:111], v[8:11]
  s_cmp_eq_u32 s75, 23
  s_cbranch_scc1 L_epi
L_dr23:
  v_and_b32_dpp v12, v31, v34 row_newbcast:2 row_mask:0xf bank_mask:0xf
  v_and_b32_dpp v13, v31, v35 row_newbcast:2 row_mask:0xf bank_mask:0xf
  v_and_b32_dpp v14, v31, v36 row_newbcast:2 row_mask:0xf bank_mask:0xf
  v_and_b32_dpp v15, v31, v0 row_newbcast:2 row_mask:0xf bank_mask:0xf
  s_nop 1
  v_mfma_f32_16x16x32_bf16 v[8:11], v[12:15], v[112:115], v[8:11]
  s_cmp_eq_u32 s75, 24
  s_cbranch_scc1 L_epi
L_dr24:
  v_and_b32_dpp v12, v31, v34 row_newbcast:3 row_mask:0xf bank_mask:0xf
  v_and_b32_dpp v13, v31, v35 row_newbcast:3 row_mask:0xf bank_mask:0xf
  v_and_b32_dpp v14, v31, v36 row_newbcast:3 row_mask:0xf bank_mask:0xf
  v_and_b32_dpp v15, v31, v0 row_newbcast:3 row_mask:0xf bank_mask:0xf
  s_nop 1
  v_mfma_f32_16x16x32_bf16 v[8:11], v[12:15], v[116:119], v[8:11]
  s_cmp_eq_u32 s75, 25
  s_cbranch_scc1 L_epi
L_dr25:
  v_and_b32_dpp v12, v31, v34 row_newbcast:4 row_mask:0xf bank_mask:0xf
  v_and_b32_dpp v13, v31, v35 row_newbcast:4 row_mask:0xf bank_mask:0xf
  v_and_b32_dpp v14, v31, v36 row_newbcast:4 row_mask:0xf bank_mask:0xf
  v_and_b32_dpp v15, v31, v0 row_newbcast:4 row_mask:0xf bank_mask:0xf
  s_nop 1
  v_mfma_f32_16x16x32_bf16 v[8:11], v[12:15], v[120:123], v[8:11]
  s_cmp_eq_u32 s75, 26
  s_cbranch_scc1 L_epi
L_dr26:
  v_and_b32_dpp v12, v31, v34 row_newbcast:5 row_mask:0xf bank_mask:0xf
  v_and_b32_dpp v13, v31, v35 row_newbcast:5 row_mask:0xf bank_mask:0xf
  v_and_b32_dpp v14, v31, v36 row_newbcast:5 row_mask:0xf bank_mask:0xf
  v_and_b32_dpp v15, v31, v0 row_newbcast:5 row_mask:0xf bank_mask:0xf
  s_nop 1
  v_mfma_f32_16x16x32_bf16 v[8:11], v[12:15], v[124:127], v[8:11]
  s_cmp_eq_u32 s75, 27
  s_cbranch_scc1 L_epi
L_dr27:
  v_and_b32_dpp v12, v31, v34 row_newbcast:6 row_mask:0xf bank_mask:0xf
  v_and_b32_dpp v13, v31, v35 row_newbcast:6 row_mask:0xf bank_mask:0xf
  v_and_b32_dpp v14, v31, v36 row_newbcast:6 row_mask:0xf bank_mask:0xf
  v_and_b32_dpp v15, v31, v0 row_newbcast:6 row_mask:0xf bank_mask:0xf
  s_nop 1
  v_mfma_f32_16x16x32_bf16 v[8:11], v[12:15], v[128:131], v[8:11]
  s_cmp_eq_u32 s75, 28
  s_cbranch_scc1 L_epi
L_dr28:
  v_and_b32_dpp v12, v31, v34 row_newbcast:7 row_mask:0xf bank_mask:0xf
  v_and_b32_dpp v13, v31, v35 row_newbcast:7 row_mask:0xf bank_mask:0xf
  v_and_b32_dpp v14, v31, v36 row_newbcast:7 row_mask:0xf bank_mask:0xf
  v_and_b32_dpp v15, v31, v0 row_newbcast:7 row_mask:0xf bank_mask:0xf
  s_nop 1
  v_mfma_f32_16x16x32_bf16 v[8:11], v[12:15], v[132:135], v[8:11]
  s_cmp_eq_u32 s75, 29
  s_cbranch_scc1 L_epi
L_dr29:
  v_and_b32_dpp v12, v31, v34 row_newbcast:8 row_mask:0xf bank_mask:0xf
  v_and_b32_dpp v13, v31, v35 row_newbcast:8 row_mask:0xf bank_mask:0xf
  v_and_b32_dpp v14, v31, v36 row_newbcast:8 row_mask:0xf bank_mask:0xf
  v_and_b32_dpp v15, v31, v0 row_newbcast:8 row_mask:0xf bank_mask:0xf
  s_nop 1
  v_mfma_f32_16x16x32_bf16 v[8:11], v[12:15], v[136:139], v[8:11]
  s_cmp_eq_u32 s75, 30
  s_cbranch_scc1 L_epi
L_dr30:
  v_and_b32_dpp v12, v31, v34 row_newbcast:9 row_mask:0xf bank_mask:0xf
  v_and_b32_dpp v13, v31, v35 row_newbcast:9 row_mask:0xf bank_mask:0xf
  v_and_b32_dpp v14, v31, v36 row_newbcast:9 row_mask:0xf bank_mask:0xf
  v_and_b32_dpp v15, v31, v0 row_newbcast:9 row_mask:0xf bank_mask:0xf
  s_nop 1
  v_mfma_f32_16x16x32_bf16 v[8:11], v[12:15], v[140:143], v[8:11]
  s_cmp_eq_u32 s75, 31
  s_cbranch_scc1 L_epi
L_dr31:
  v_and_b32_dpp v12, v31, v34 row_newbcast:10 row_mask:0xf bank_mask:0xf
  v_and_b32_dpp v13, v31, v35 row_newbcast:10 row_mask:0xf bank_mask:0xf
  v_and_b32_dpp v14, v31, v36 row_newbcast:10 row_mask:0xf bank_mask:0xf
  v_and_b32_dpp v15, v31, v0 row_newbcast:10 row_mask:0xf bank_mask:0xf
  s_nop 1
  v_mfma_f32_16x16x32_bf16 v[8:11], v[12:15], v[144:147], v[8:11]
  s_cmp_eq_u32 s75, 32
  s_cbranch_scc1 L_epi
L_dr32:
  v_and_b32_dpp v12, v31, v34 row_newbcast:11 row_mask:0xf bank_mask:0xf
  v_and_b32_dpp v13, v31, v35 row_newbcast:11 row_mask:0xf bank_mask:0xf
  v_and_b32_dpp v14, v31, v36 row_newbcast:11 row_mask:0xf bank_mask:0xf
  v_and_b32_dpp v15, v31, v0 row_newbcast:11 row_mask:0xf bank_mask:0xf
  s_nop 1
  v_mfma_f32_16x16x32_bf16 v[8:11], v[12:15], v[148:151], v[8:11]
  s_cmp_eq_u32 s75, 33
  s_cbranch_scc1 L_epi
L_dr33:
  v_and_b32_dpp v12, v31, v34 row_newbcast:12 row_mask:0xf bank_mask:0xf
  v_and_b32_dpp v13, v31, v35 row_newbcast:12 row_mask:0xf bank_mask:0xf
  v_and_b32_dpp v14, v31, v36 row_newbcast:12 row_mask:0xf bank_mask:0xf
  v_and_b32_dpp v15, v31, v0 row_newbcast:12 row_mask:0xf bank_mask:0xf
  s_nop 1
  v_mfma_f32_16x16x32_bf16 v[8:11], v[12:15], v[152:155], v[8:11]
  s_cmp_eq_u32 s75, 34
  s_cbranch_scc1 L_epi
L_dr34:
  v_and_b32_dpp v12, v31, v34 row_newbcast:13 row_mask:0xf bank_mask:0xf
  v_and_b32_dpp v13, v31, v35 row_newbcast:13 row_mask:0xf bank_mask:0xf
  v_and_b32_dpp v14, v31, v36 row_newbcast:13 row_mask:0xf bank_mask:0xf
  v_and_b32_dpp v15, v31, v0 row_newbcast:13 row_mask:0xf bank_mask:0xf
  s_nop 1
  v_mfma_f32_16x16x32_bf16 v[8:11], v[12:15], v[156:159], v[8:11]
  s_cmp_eq_u32 s75, 35
  s_cbranch_scc1 L_epi
L_dr35:
  v_and_b32_dpp v12, v31, v34 row_newbcast:14 row_mask:0xf bank_mask:0xf
  v_and_b32_dpp v13, v31, v35 row_newbcast:14 row_mask:0xf bank_mask:0xf
  v_and_b32_dpp v14, v31, v36 row_newbcast:14 row_mask:0xf bank_mask:0xf
  v_and_b32_dpp v15, v31, v0 row_newbcast:14 row_mask:0xf bank_mask:0xf
  s_nop 1
  v_mfma_f32_16x16x32_bf16 v[8:11], v[12:15], v[160:163], v[8:11]
  s_cmp_eq_u32 s75, 36
  s_cbranch_scc1 L_epi
L_dr36:
  v_and_b32_dpp v12, v31, v34 row_newbcast:15 row_mask:0xf bank_mask:0xf
  v_and_b32_dpp v13, v31, v35 row_newbcast:15 row_mask:0xf bank_mask:0xf
  v_and_b32_dpp v14, v31, v36 row_newbcast:15 row_mask:0xf bank_mask:0xf
  v_and_b32_dpp v15, v31, v0 row_newbcast:15 row_mask:0xf bank_mask:0xf
  s_nop 1
  v_mfma_f32_16x16x32_bf16 v[8:11], v[12:15], v[164:167], v[8:11]
  s_cmp_eq_u32 s75, 37
  s_cbranch_scc1 L_epi
L_dr37:
  v_and_b32_dpp v12, v33, v34 row_newbcast:0 row_mask:0xf bank_mask:0xf
  v_and_b32_dpp v13, v33, v35 row_newbcast:0 row_mask:0xf bank_mask:0xf
  v_and_b32_dpp v14, v33, v36 row_newbcast:0 row_mask:0xf bank_mask:0xf
  v_and_b32_dpp v15, v33, v0 row_newbcast:0 row_mask:0xf bank_mask:0xf
  s_nop 1
  v_mfma_f32_16x16x32_bf16 v[8:11], v[12:15], v[40:43], v[8:11]
  s_cmp_eq_u32 s75, 38
  s_cbranch_scc1 L_epi
L_dr38:
  v_and_b32_dpp v12, v33, v34 row_newbcast:1 row_mask:0xf bank_mask:0xf
  v_and_b32_dpp v13, v33, v35 row_newbcast:1 row_mask:0xf bank_mask:0xf
  v_and_b32_dpp v14, v33, v36 row_newbcast:1 row_mask:0xf bank_mask:0xf
  v_and_b32_dpp v15, v33, v0 row_newbcast:1 row_mask:0xf bank_mask:0xf
  s_nop 1
  v_mfma_f32_16x16x32_bf16 v[8:11], v[12:15], v[44:47], v[8:11]
  s_cmp_eq_u32 s75, 39
  s_cbranch_scc1 L_epi
L_dr39:
  v_and_b32_dpp v12, v33, v34 row_newbcast:2 row_mask:0xf bank_mask:0xf
  v_and_b32_dpp v13, v33, v35 row_newbcast:2 row_mask:0xf bank_mask:0xf
  v_and_b32_dpp v14, v33, v36 row_newbcast:2 row_mask:0xf bank_mask:0xf
  v_and_b32_dpp v15, v33, v0 row_newbcast:2 row_mask:0xf bank_mask:0xf
  s_nop 1
  v_mfma_f32_16x16x32_bf16 v[8:11], v[12:15], v[48:51], v[8:11]
  s_cmp_eq_u32 s75, 40
  s_cbranch_scc1 L_epi
L_dr40:
  v_and_b32_dpp v12, v33, v34 row_newbcast:3 row_mask:0xf bank_mask:0xf
  v_and_b32_dpp v13, v33, v35 row_newbcast:3 row_mask:0xf bank_mask:0xf
  v_and_b32_dpp v14, v33, v36 row_newbcast:3 row_mask:0xf bank_mask:0xf
  v_and_b32_dpp v15, v33, v0 row_newbcast:3 row_mask:0xf bank_mask:0xf
  s_nop 1
  v_mfma_f32_16x16x32_bf16 v[8:11], v[12:15], v[52:55], v[8:11]
  s_cmp_eq_u32 s75, 41
  s_cbranch_scc1 L_epi
L_dr41:
  v_and_b32_dpp v12, v33, v34 row_newbcast:4 row_mask:0xf bank_mask:0xf
  v_and_b32_dpp v13, v33, v35 row_newbcast:4 row_mask:0xf bank_mask:0xf
  v_and_b32_dpp v14, v33, v36 row_newbcast:4 row_mask:0xf bank_mask:0xf
  v_and_b32_dpp v15, v33, v0 row_newbcast:4 row_mask:0xf bank_mask:0xf
  s_nop 1
  v_mfma_f32_16x16x32_bf16 v[8:11], v[12:15], v[56:59], v[8:11]
  s_cmp_eq_u32 s75, 42
  s_cbranch_scc1 L_epi
L_dr42:
  v_and_b32_dpp v12, v33, v34 row_newbcast:5 row_mask:0xf bank_mask:0xf
  v_and_b32_dpp v13, v33, v35 row_newbcast:5 row_mask:0xf bank_mask:0xf
  v_and_b32_dpp v14, v33, v36 row_newbcast:5 row_mask:0xf bank_mask:0xf
  v_and_b32_dpp v15, v33, v0 row_newbcast:5 row_mask:0xf bank_mask:0xf
  s_nop 1
  v_mfma_f32_16x16x32_bf16 v[8:11], v[12:15], v[60:63], v[8:11]
  s_cmp_eq_u32 s75, 43
  s_cbranch_scc1 L_epi
L_epi:
  v_lshrrev_b32 v3, 4, v1
  v_lshl_add_u32 v21, v3, 3, v39
  v_add_u32 v21, s11, v21
  v_mov_b32 v3, 1
  s_nop 3
  v_pk_add_f32 v[8:9], v[8:9], v[4:5]
  v_pk_add_f32 v[10:11], v[10:11], v[6:7]
  s_mov_b32 exec_hi, 0
  ds_write_b128 v21, v[8:11] offset:1024
  s_cmp_eq_u32 s21, 0
  s_cbranch_scc1 L_ep2
  s_mov_b32 exec_hi, 0
  ds_write_b128 v21, v[8:11] offset:6656
  s_mov_b64 exec, 1
  ds_add_u32 v1, v3 offset:304
  s_mov_b64 exec, -1
L_ep2:
  s_mov_b64 exec, 1
  ds_add_u32 v1, v3 offset:308
L_send:
  s_endpgm
L_ks:
  s_cmp_lt_u32 s32, s57
  s_cbranch_scc1 L_kq
  s_call_b64 s[100:101], L_work
L_kq:
  v_readfirstlane_b32 s78, v22
  v_readfirstlane_b32 s79, v23
L_ks2:
  s_mov_b64 exec, 1
  ds_dec_u32 v2, v39 offset:288
  ds_read_b64 v[22:23], v2 offset:288
  s_mov_b64 exec, -1
  s_mul_i32 s68, s35, 11
  s_mul_i32 s69, s79, s77
  s_sub_i32 s68, s68, s78
  s_mul_i32 s68, s68, 160
  s_sub_u32 s35, s35, 1
  s_add_i32 s68, s68, s69
  s_add_i32 s68, s68, s34
  s_max_i32 s68, s68, 4915
  s_min_i32 s68, s68, s76
  s_lshr_b32 s37, s68, 12
  s_lshl_b32 s58, s68, 20
  s_add_u32 s32, s32, 1
  s_add_u32 s33, s33, 0x20000000
  s_add_u32 s68, s33, s58
  s_addc_u32 s41, s37, 0
  s_cmp_eq_u32 s41, 3
  s_cbranch_scc1 L_wt3
  s_cmp_eq_u32 s41, 2
  s_cbranch_scc1 L_wt2
  s_cmp_eq_u32 s41, 4
  s_cbranch_scc1 L_wt4
  s_cmp_eq_u32 s41, 1
  s_cbranch_scc1 L_wt1
L_wtx:
  s_cmp_eq_u32 s32, s32
L_wt5:
  s_waitcnt vmcnt(4)
  s_setpc_b64 s[62:63]
L_wt3:
  s_waitcnt vmcnt(2)
  s_setpc_b64 s[62:63]
L_wt2:
  s_waitcnt vmcnt(1)
  s_setpc_b64 s[62:63]
L_wt4:
  s_waitcnt vmcnt(3)
  s_setpc_b64 s[62:63]
L_wt1:
  s_waitcnt vmcnt(0)
  s_setpc_b64 s[62:63]
L_vs:
  v_readfirstlane_b32 s78, v22
  v_readfirstlane_b32 s79, v23
  s_cmp_eq_u32 s61, 2
  s_cbranch_scc1 L_vs1
  s_cmp_eq_u32 s61, 1
  s_cbranch_scc1 L_x3
  s_cmp_gt_u32 s41, s32
  s_cbranch_scc1 L_ks2
L_x1:
  s_mov_b64 vcc, s[52:53]
  v_mfma_f32_16x16x32_bf16 v[8:11], v[4:7], v[152:155], 0
  v_mfma_f32_16x16x32_bf16 v[152:155], v[4:7], v[156:159], 0
  v_mfma_f32_16x16x32_bf16 v[156:159], v[4:7], v[160:163], 0
  v_mfma_f32_16x16x32_bf16 v[160:163], v[4:7], v[164:167], 0
  s_nop 4
  v_cndmask_b32 v8, v8, v9, s[54:55]
  v_cndmask_b32 v10, v10, v11, s[54:55]
  v_cndmask_b32 v152, v152, v153, s[54:55]
  v_cndmask_b32 v154, v154, v155, s[54:55]
  v_cndmask_b32 v156, v156, v157, s[54:55]
  v_cndmask_b32 v158, v158, v159, s[54:55]
  v_cndmask_b32 v160, v160, v161, s[54:55]
  v_cndmask_b32 v162, v162, v163, s[54:55]
  v_cndmask_b32_dpp v16, v8, v10, vcc quad_perm:[0,1,2,3] row_mask:0x8 bank_mask:0xf
  v_cndmask_b32_dpp v18, v152, v154, vcc quad_perm:[0,1,2,3] row_mask:0x8 bank_mask:0xf
  v_cndmask_b32_dpp v17, v156, v158, vcc quad_perm:[0,1,2,3] row_mask:0x8 bank_mask:0xf
  v_cndmask_b32_dpp v19, v160, v162, vcc quad_perm:[0,1,2,3] row_mask:0x8 bank_mask:0xf
  s_lshl_b32 s68, s20, 3
  s_add_u32 s68, s68, s56
  v_add_f32_dpp v16, v16, v16 quad_perm:[2,3,0,1] row_mask:0xf bank_mask:0xf
  v_add_f32_dpp v17, v17, v17 quad_perm:[2,3,0,1] row_mask:0xf bank_mask:0xf
  v_add_f32_dpp v18, v18, v18 quad_perm:[2,3,0,1] row_mask:0xf bank_mask:0xf
  v_add_f32_dpp v19, v19, v19 quad_perm:[2,3,0,1] row_mask:0xf bank_mask:0xf
  v_cndmask_b32 v8, v16, v17, s[52:53]
  v_cndmask_b32 v9, v18, v19, s[52:53]
  v_mov_b32 v20, 64
  v_lshlrev_b32 v21, 3, s9
  v_add_f32_dpp v8, v8, v8 quad_perm:[1,0,3,2] row_mask:0xf bank_mask:0xf
  v_add_f32_dpp v9, v9, v9 quad_perm:[1,0,3,2] row_mask:0xf bank_mask:0xf
  v_cndmask_b32 v27, v8, v9, s[54:55]
  v_cvt_pk_bf16_f32 v27, 0, v27
  v_mul_f32 v27, 0x3db504f3, v27
  v_cvt_pk_bf16_f32 v27, 0, v27
  v_max_f32 v37, v37, v27
  v_cmp_ngt_f32 vcc, s22, v27
  v_mov_b32 v4, 0
  v_max_f32_dpp v37, v37, v37 row_ror:8 row_mask:0xf bank_mask:0xf
  s_bcnt1_i32_b64 s69, vcc
  s_add_u32 s69, s69, s20
  v_max_f32_dpp v37, v37, v37 row_ror:4 row_mask:0xf bank_mask:0xf
  s_cmp_gt_u32 s69, 32
  s_cselect_b32 s21, 1, s21
  v_max_f32_dpp v37, v37, v37 row_ror:2 row_mask:0xf bank_mask:0xf
  s_cmp_eq_u32 s21, 0
  s_cselect_b64 s[66:67], vcc, 0
  s_cselect_b32 s20, s69, s20
  v_max_f32_dpp v37, v37, v37 row_ror:1 row_mask:0xf bank_mask:0xf
  v_mbcnt_lo_u32_b32 v3, s66, 0
  v_mov_b32 v8, v37
  v_mbcnt_hi_u32_b32 v3, s67, v3
  v_lshl_add_u32 v3, v3, 3, s68
  v_permlane16_swap_b32 v8, v37
  s_mov_b64 exec, s[66:67]
  ds_write_b64 v3, v[26:27] offset:1280
  s_mov_b64 exec, -1
  ds_read_b32 v32, v39 offset:1024
  v_max_f32 v37, v37, v8
  v_mov_b32 v8, v37
  v_mov_b32 v5, 0
  s_mov_b32 s18, s32
  v_permlane32_swap_b32 v8, v37
  v_max_f32 v37, v37, v8
  v_sub_f32 v17, v25, v37
  v_sub_f32 v18, v27, v37
  v_mul_f32 v17, 0x3fb8aa3b, v17
  v_mul_f32 v18, 0x3fb8aa3b, v18
  v_exp_f32 v17, v17
  v_exp_f32 v18, v18
  s_lshl_b32 s68, s9, 9
  v_lshl_add_u32 v16, v1, 2, s68
  v_add_f32 v17, v17, v18
  s_waitcnt lgkmcnt(0)
  s_cmp_le_u32 s20, 0
  s_cbranch_scc1 L_x2
  v_add_u32_dpp v3, v32, v38 row_newbcast:8 row_mask:0xf bank_mask:0xf
  buffer_load_dwordx4 v[136:139], v3, s[48:51], 0 offen nt
  s_cmp_le_u32 s20, 4
  s_cbranch_scc1 L_x2
  v_add_u32_dpp v3, v32, v38 row_newbcast:9 row_mask:0xf bank_mask:0xf
  buffer_load_dwordx4 v[140:143], v3, s[48:51], 0 offen nt
  s_cmp_le_u32 s20, 8
  s_cbranch_scc1 L_x2
  v_add_u32_dpp v3, v32, v38 row_newbcast:10 row_mask:0xf bank_mask:0xf
  buffer_load_dwordx4 v[144:147], v3, s[48:51], 0 offen nt
  s_cmp_le_u32 s20, 12
  s_cbranch_scc1 L_x2
  v_add_u32_dpp v3, v32, v38 row_newbcast:11 row_mask:0xf bank_mask:0xf
  buffer_load_dwordx4 v[148:151], v3, s[48:51], 0 offen nt
  s_cmp_le_u32 s20, 16
  s_cbranch_scc1 L_x2
  v_add_u32_dpp v3, v32, v38 row_newbcast:12 row_mask:0xf bank_mask:0xf
  buffer_load_dwordx4 v[152:155], v3, s[48:51], 0 offen nt
  s_cmp_le_u32 s20, 20
  s_cbranch_scc1 L_x2
  v_add_u32_dpp v3, v32, v38 row_newbcast:13 row_mask:0xf bank_mask:0xf
  buffer_load_dwordx4 v[156:159], v3, s[48:51], 0 offen nt
  s_cmp_le_u32 s20, 24
  s_cbranch_scc1 L_x2
  v_add_u32_dpp v3, v32, v38 row_newbcast:14 row_mask:0xf bank_mask:0xf
  buffer_load_dwordx4 v[160:163], v3, s[48:51], 0 offen nt
  s_cmp_le_u32 s20, 28
  s_cbranch_scc1 L_x2
  v_add_u32_dpp v3, v32, v38 row_newbcast:15 row_mask:0xf bank_mask:0xf
  buffer_load_dwordx4 v[164:167], v3, s[48:51], 0 offen nt
L_x2:
  ds_write_b32 v16, v17 offset:1024
  s_mov_b64 exec, 1
  ds_write_b32 v21, v37 offset:512
  ds_add_u32 v1, v20 offset:272
  s_mov_b64 exec, -1
  s_mov_b32 s61, 1
  s_mov_b32 s19, 1
  s_add_i32 s34, s34, 2458
  s_cmp_lt_u32 s32, 5
  s_cbranch_scc1 L_ks2
L_x3:
  v_max_f32 v21, s23, v37
  s_add_u32 s38, s38, 3
  s_lshr_b32 s38, s38, 2
  v_add_f32 v21, 0xc2a5e666, v21
  s_max_u32 s38, s38, s32
  s_lshl_b32 s38, s38, 2
  v_cmp_nlt_f32 vcc, v27, v21
  s_lshl_b32 s68, s38, 3
  s_add_u32 s68, s68, s56
  s_andn2_b64 s[70:71], vcc, s[66:67]
  v_mbcnt_lo_u32_b32 v3, s70, 0
  v_mbcnt_hi_u32_b32 v3, s71, v3
  s_bcnt1_i32_b64 s69, s[70:71]
  v_lshl_add_u32 v3, v3, 3, s68
  s_mov_b64 exec, s[70:71]
  ds_write_b64 v3, v[26:27]
  s_mov_b64 exec, -1
  s_or_b64 s[66:67], s[66:67], s[70:71]
  s_add_u32 s38, s38, s69
  ds_read_b64 v[28:29], v39 offset:0
  ds_read_b64 v[30:31], v39 offset:512
  ds_read_b64 v[32:33], v39 offset:1024
  v_mov_b32 v8, 0
  v_mov_b32 v9, 0
  v_mov_b32 v10, 0
  v_mov_b32 v11, 0
  v_mov_b32 v6, 0
  v_mov_b32 v7, 0
  s_lshr_b32 s36, s38, 2
  s_mov_b32 s61, 2
  s_add_u32 s68, s38, 13
  s_lshr_b32 s68, s68, 2
  s_sub_u32 s69, s68, s59
  s_mov_b32 s59, s68
  s_add_u32 s35, s35, s69
  s_add_u32 s78, s78, s69
  v_mov_b32 v3, s69
  s_mov_b64 exec, 1
  ds_add_u32 v1, v3 offset:296
  ds_add_u32 v1, v3 offset:300
  s_mov_b64 exec, -1
  s_waitcnt lgkmcnt(0)
  v_sub_f32 v29, v29, v37
  v_sub_f32 v31, v31, v37
  v_sub_f32 v33, v33, v37
  v_mul_f32 v29, 0x3fb8aa3b, v29
  v_mul_f32 v31, 0x3fb8aa3b, v31
  v_mul_f32 v33, 0x3fb8aa3b, v33
  v_exp_f32 v29, v29
  v_exp_f32 v31, v31
  v_exp_f32 v33, v33
  s_nop 0
  v_cvt_pk_bf16_f32 v29, v29, v29
  v_cvt_pk_bf16_f32 v31, v31, v31
  v_cvt_pk_bf16_f32 v33, v33, v33
  s_cmp_eq_u32 s20, 0
  s_cselect_b32 s41, 0, s41
L_vs1:
  s_cmp_eq_u32 s19, 0
  s_cbranch_scc1 L_vs1b
  s_sub_u32 s68, s32, s18
  s_cmp_le_u32 s41, s68
  s_cbranch_scc1 L_snap
  s_cmp_lt_u32 s32, s36
  s_cbranch_scc1 L_ks2
  s_waitcnt vmcnt(0)
L_snap:
  s_cmp_le_u32 s20, 0
  s_cbranch_scc1 L_snp2
  v_and_b32_dpp v12, v33, v34 row_newbcast:8 row_mask:0xf bank_mask:0xf
  v_and_b32_dpp v13, v33, v35 row_newbcast:8 row_mask:0xf bank_mask:0xf
  v_and_b32_dpp v14, v33, v36 row_newbcast:8 row_mask:0xf bank_mask:0xf
  v_and_b32_dpp v15, v33, v0 row_newbcast:8 row_mask:0xf bank_mask:0xf
  s_nop 1
  v_mfma_f32_16x16x32_bf16 v[4:7], v[12:15], v[136:139], v[4:7]
  s_cmp_le_u32 s20, 4
  s_cbranch_scc1 L_snp2
  v_and_b32_dpp v12, v33, v34 row_newbcast:9 row_mask:0xf bank_mask:0xf
  v_and_b32_dpp v13, v33, v35 row_newbcast:9 row_mask:0xf bank_mask:0xf
  v_and_b32_dpp v14, v33, v36 row_newbcast:9 row_mask:0xf bank_mask:0xf
  v_and_b32_dpp v15, v33, v0 row_newbcast:9 row_mask:0xf bank_mask:0xf
  s_nop 1
  v_mfma_f32_16x16x32_bf16 v[4:7], v[12:15], v[140:143], v[4:7]
  s_cmp_le_u32 s20, 8
  s_cbranch_scc1 L_snp2
  v_and_b32_dpp v12, v33, v34 row_newbcast:10 row_mask:0xf bank_mask:0xf
  v_and_b32_dpp v13, v33, v35 row_newbcast:10 row_mask:0xf bank_mask:0xf
  v_and_b32_dpp v14, v33, v36 row_newbcast:10 row_mask:0xf bank_mask:0xf
  v_and_b32_dpp v15, v33, v0 row_newbcast:10 row_mask:0xf bank_mask:0xf
  s_nop 1
  v_mfma_f32_16x16x32_bf16 v[4:7], v[12:15], v[144:147], v[4:7]
  s_cmp_le_u32 s20, 12
  s_cbranch_scc1 L_snp2
  v_and_b32_dpp v12, v33, v34 row_newbcast:11 row_mask:0xf bank_mask:0xf
  v_and_b32_dpp v13, v33, v35 row_newbcast:11 row_mask:0xf bank_mask:0xf
  v_and_b32_dpp v14, v33, v36 row_newbcast:11 row_mask:0xf bank_mask:0xf
  v_and_b32_dpp v15, v33, v0 row_newbcast:11 row_mask:0xf bank_mask:0xf
  s_nop 1
  v_mfma_f32_16x16x32_bf16 v[4:7], v[12:15], v[148:151], v[4:7]
  s_cmp_le_u32 s20, 16
  s_cbranch_scc1 L_snp2
  v_and_b32_dpp v12, v33, v34 row_newbcast:12 row_mask:0xf bank_mask:0xf
  v_and_b32_dpp v13, v33, v35 row_newbcast:12 row_mask:0xf bank_mask:0xf
  v_and_b32_dpp v14, v33, v36 row_newbcast:12 row_mask:0xf bank_mask:0xf
  v_and_b32_dpp v15, v33, v0 row_newbcast:12 row_mask:0xf bank_mask:0xf
  s_nop 1
  v_mfma_f32_16x16x32_bf16 v[4:7], v[12:15], v[152:155], v[4:7]
  s_cmp_le_u32 s20, 20
  s_cbranch_scc1 L_snp2
  v_and_b32_dpp v12, v33, v34 row_newbcast:13 row_mask:0xf bank_mask:0xf
  v_and_b32_dpp v13, v33, v35 row_newbcast:13 row_mask:0xf bank_mask:0xf
  v_and_b32_dpp v14, v33, v36 row_newbcast:13 row_mask:0xf bank_mask:0xf
  v_and_b32_dpp v15, v33, v0 row_newbcast:13 row_mask:0xf bank_mask:0xf
  s_nop 1
  v_mfma_f32_16x16x32_bf16 v[4:7], v[12:15], v[156:159], v[4:7]
  s_cmp_le_u32 s20, 24
  s_cbranch_scc1 L_snp2
  v_and_b32_dpp v12, v33, v34 row_newbcast:14 row_mask:0xf bank_mask:0xf
  v_and_b32_dpp v13, v33, v35 row_newbcast:14 row_mask:0xf bank_mask:0xf
  v_and_b32_dpp v14, v33, v36 row_newbcast:14 row_mask:0xf bank_mask:0xf
  v_and_b32_dpp v15, v33, v0 row_newbcast:14 row_mask:0xf bank_mask:0xf
  s_nop 1
  v_mfma_f32_16x16x32_bf16 v[4:7], v[12:15], v[160:163], v[4:7]
  s_cmp_le_u32 s20, 28
  s_cbranch_scc1 L_snp2
  v_and_b32_dpp v12, v33, v34 row_newbcast:15 row_mask:0xf bank_mask:0xf
  v_and_b32_dpp v13, v33, v35 row_newbcast:15 row_mask:0xf bank_mask:0xf
  v_and_b32_dpp v14, v33, v36 row_newbcast:15 row_mask:0xf bank_mask:0xf
  v_and_b32_dpp v15, v33, v0 row_newbcast:15 row_mask:0xf bank_mask:0xf
  s_nop 1
  v_mfma_f32_16x16x32_bf16 v[4:7], v[12:15], v[164:167], v[4:7]
L_snp2:
  v_lshrrev_b32 v3, 4, v1
  v_lshl_add_u32 v21, v3, 3, v39
  v_add_u32 v21, s11, v21
  v_mov_b32 v3, 1
  s_nop 0
  s_mov_b32 s19, 0
  s_sub_i32 s34, s34, 2458
  s_mov_b32 s76, 20480
  s_cmp_lg_u32 s21, 0
  s_cbranch_scc1 L_vs1b
  s_mov_b32 exec_hi, 0
  ds_write_b128 v21, v[4:7] offset:6656
  s_mov_b64 exec, 1
  ds_add_u32 v1, v3 offset:304
  s_mov_b64 exec, -1
  s_branch L_vs1b
L_vq:
  v_readfirstlane_b32 s78, v22
  v_readfirstlane_b32 s79, v23
L_vs1b:
L_vs2:
  s_cmp_lt_u32 s32, s36
  s_cbranch_scc1 L_ks2
L_ev:
  s_cmp_eq_u32 s75, 0
  s_cbranch_scc1 L_hand
  s_add_u32 s68, s32, 5
  s_cmp_lt_u32 s68, s75
  s_cbranch_scc0 L_wt1
  s_add_u32 s32, s32, 1
  s_mov_b64 exec, 1
  ds_dec_u32 v2, v39 offset:288
  s_mov_b64 exec, -1
  s_branch L_wtx
L_hand:
  v_mov_b32 v3, 0
  s_mov_b32 s70, 0
L_sn_1:
  ds_read_b64 v[18:19], v3 offset:272
  s_waitcnt lgkmcnt(0)
  v_cmp_gt_u32 vcc, 0x102c0, v18
  s_cmp_eq_u64 vcc, 0
  s_cbranch_scc1 L_snd_2
  s_sleep 1
  s_add_u32 s70, s70, 1
  s_cmp_lt_u32 s70, 2097152
  s_cbranch_scc1 L_sn_1
L_snd_2:
  v_cmp_nlt_f32 vcc, v25, v19
  s_lshl_b32 s68, s38, 3
  s_add_u32 s68, s68, s56
  s_andn2_b64 s[70:71], vcc, s[64:65]
  v_mbcnt_lo_u32_b32 v3, s70, 0
  v_mbcnt_hi_u32_b32 v3, s71, v3
  s_bcnt1_i32_b64 s69, s[70:71]
  v_lshl_add_u32 v3, v3, 3, s68
  s_mov_b64 exec, s[70:71]
  ds_write_b64 v3, v[24:25]
  s_mov_b64 exec, -1
  s_or_b64 s[64:65], s[64:65], s[70:71]
  s_add_u32 s38, s38, s69
  v_cmp_nlt_f32 vcc, v27, v19
  s_lshl_b32 s68, s38, 3
  s_add_u32 s68, s68, s56
  s_andn2_b64 s[70:71], vcc, s[66:67]
  v_mbcnt_lo_u32_b32 v3, s70, 0
  v_mbcnt_hi_u32_b32 v3, s71, v3
  s_bcnt1_i32_b64 s69, s[70:71]
  v_lshl_add_u32 v3, v3, 3, s68
  s_mov_b64 exec, s[70:71]
  ds_write_b64 v3, v[26:27]
  s_mov_b64 exec, -1
  s_or_b64 s[66:67], s[66:67], s[70:71]
  s_add_u32 s38, s38, s69
  ds_read_b64 v[28:29], v39 offset:0
  ds_read_b64 v[30:31], v39 offset:512
  ds_read_b64 v[32:33], v39 offset:1024
  s_add_u32 s75, s38, 23
  s_lshr_b32 s75, s75, 2
  s_sub_u32 s36, s75, 8
  s_max_i32 s36, s36, 0
  s_add_u32 s68, s38, 3
  s_lshr_b32 s68, s68, 2
  s_sub_u32 s69, s68, s59
  s_mov_b32 s59, s68
  s_add_u32 s35, s35, s69
  s_add_u32 s78, s78, s69
  v_mov_b32 v3, s69
  s_mov_b64 exec, 1
  ds_add_u32 v1, v3 offset:296
  ds_add_u32 v1, v3 offset:300
  s_mov_b64 exec, -1
  s_waitcnt lgkmcnt(0)
  v_sub_f32 v29, v29, v37
  v_sub_f32 v31, v31, v37
  v_sub_f32 v33, v33, v37
  v_mul_f32 v29, 0x3fb8aa3b, v29
  v_mul_f32 v31, 0x3fb8aa3b, v31
  v_mul_f32 v33, 0x3fb8aa3b, v33
  v_exp_f32 v29, v29
  v_exp_f32 v31, v31
  v_exp_f32 v33, v33
  s_nop 0
  v_cvt_pk_bf16_f32 v29, v29, v29
  v_cvt_pk_bf16_f32 v31, v31, v31
  v_cvt_pk_bf16_f32 v33, v33, v33
  s_branch L_vs2
L_work:
  s_cmp_eq_u32 s39, 4
  s_cbranch_scc1 L_w3
  s_cmp_eq_u32 s39, 3
  s_cbranch_scc1 L_w2b
  s_cmp_eq_u32 s39, 5
  s_cbranch_scc1 L_w5
L_w2:
  v_and_b32 v3, 0xf0, v0
  ds_read_b128 v[4:7], v3 offset:0
  s_waitcnt lgkmcnt(0)
  v_max3_u32 v8, v4, v5, v6
  v_max_u32 v8, v8, v7
  v_cmp_eq_u32 vcc, -1, v8
  s_cmp_lg_u64 vcc, 0
  s_cbranch_scc1 L_wr
  s_mov_b64 vcc, s[52:53]
  v_mfma_f32_16x16x32_bf16 v[8:11], v[4:7], v[40:43], 0
  v_mfma_f32_16x16x32_bf16 v[40:43], v[4:7], v[44:47], 0
  v_mfma_f32_16x16x32_bf16 v[44:47], v[4:7], v[48:51], 0
  v_mfma_f32_16x16x32_bf16 v[48:51], v[4:7], v[52:55], 0
  v_mfma_f32_16x16x32_bf16 v[52:55], v[4:7], v[56:59], 0
  v_mfma_f32_16x16x32_bf16 v[56:59], v[4:7], v[60:63], 0
  v_mfma_f32_16x16x32_bf16 v[60:63], v[4:7], v[64:67], 0
  v_mfma_f32_16x16x32_bf16 v[64:67], v[4:7], v[68:71], 0
  s_nop 0
  v_cndmask_b32 v8, v8, v9, s[54:55]
  v_cndmask_b32 v10, v10, v11, s[54:55]
  v_cndmask_b32 v40, v40, v41, s[54:55]
  v_cndmask_b32 v42, v42, v43, s[54:55]
  v_cndmask_b32 v44, v44, v45, s[54:55]
  v_cndmask_b32 v46, v46, v47, s[54:55]
  v_cndmask_b32 v48, v48, v49, s[54:55]
  v_cndmask_b32 v50, v50, v51, s[54:55]
  v_cndmask_b32 v52, v52, v53, s[54:55]
  v_cndmask_b32 v54, v54, v55, s[54:55]
  v_cndmask_b32 v56, v56, v57, s[54:55]
  v_cndmask_b32 v58, v58, v59, s[54:55]
  v_cndmask_b32 v60, v60, v61, s[54:55]
  v_cndmask_b32 v62, v62, v63, s[54:55]
  v_cndmask_b32 v64, v64, v65, s[54:55]
  v_cndmask_b32 v66, v66, v67, s[54:55]
  v_cndmask_b32_dpp v16, v8, v10, vcc quad_perm:[0,1,2,3] row_mask:0x1 bank_mask:0xf
  v_cndmask_b32_dpp v18, v40, v42, vcc quad_perm:[0,1,2,3] row_mask:0x1 bank_mask:0xf
  v_cndmask_b32_dpp v17, v44, v46, vcc quad_perm:[0,1,2,3] row_mask:0x1 bank_mask:0xf
  v_cndmask_b32_dpp v19, v48, v50, vcc quad_perm:[0,1,2,3] row_mask:0x1 bank_mask:0xf
  v_cndmask_b32_dpp v16, v52, v54, vcc quad_perm:[0,1,2,3] row_mask:0x2 bank_mask:0xf
  v_cndmask_b32_dpp v18, v56, v58, vcc quad_perm:[0,1,2,3] row_mask:0x2 bank_mask:0xf
  v_cndmask_b32_dpp v17, v60, v62, vcc quad_perm:[0,1,2,3] row_mask:0x2 bank_mask:0xf
  v_cndmask_b32_dpp v19, v64, v66, vcc quad_perm:[0,1,2,3] row_mask:0x2 bank_mask:0xf
  s_mov_b32 s39, 3
  s_mov_b32 s57, 17
L_wr:
  s_setpc_b64 s[100:101]
L_w2b:
  s_add_u32 s68, s41, 16
  s_cmp_lt_u32 s32, s68
  s_cbranch_scc1 L_wr
  s_mov_b64 vcc, s[52:53]
  v_mfma_f32_16x16x32_bf16 v[8:11], v[4:7], v[72:75], 0
  v_mfma_f32_16x16x32_bf16 v[72:75], v[4:7], v[76:79], 0
  v_mfma_f32_16x16x32_bf16 v[76:79], v[4:7], v[80:83], 0
  v_mfma_f32_16x16x32_bf16 v[80:83], v[4:7], v[84:87], 0
  v_mfma_f32_16x16x32_bf16 v[84:87], v[4:7], v[88:91], 0
  v_mfma_f32_16x16x32_bf16 v[88:91], v[4:7], v[92:95], 0
  v_mfma_f32_16x16x32_bf16 v[92:95], v[4:7], v[96:99], 0
  v_mfma_f32_16x16x32_bf16 v[96:99], v[4:7], v[100:103], 0
  s_nop 0
  v_cndmask_b32 v8, v8, v9, s[54:55]
  v_cndmask_b32 v10, v10, v11, s[54:55]
  v_cndmask_b32 v72, v72, v73, s[54:55]
  v_cndmask_b32 v74, v74, v75, s[54:55]
  v_cndmask_b32 v76, v76, v77, s[54:55]
  v_cndmask_b32 v78, v78, v79, s[54:55]
  v_cndmask_b32 v80, v80, v81, s[54:55]
  v_cndmask_b32 v82, v82, v83, s[54:55]
  v_cndmask_b32 v84, v84, v85, s[54:55]
  v_cndmask_b32 v86, v86, v87, s[54:55]
  v_cndmask_b32 v88, v88, v89, s[54:55]
  v_cndmask_b32 v90, v90, v91, s[54:55]
  v_cndmask_b32 v92, v92, v93, s[54:55]
  v_cndmask_b32 v94, v94, v95, s[54:55]
  v_cndmask_b32 v96, v96, v97, s[54:55]
  v_cndmask_b32 v98, v98, v99, s[54:55]
  v_cndmask_b32_dpp v16, v8, v10, vcc quad_perm:[0,1,2,3] row_mask:0x4 bank_mask:0xf
  v_cndmask_b32_dpp v18, v72, v74, vcc quad_perm:[0,1,2,3] row_mask:0x4 bank_mask:0xf
  v_cndmask_b32_dpp v17, v76, v78, vcc quad_perm:[0,1,2,3] row_mask:0x4 bank_mask:0xf
  v_cndmask_b32_dpp v19, v80, v82, vcc quad_perm:[0,1,2,3] row_mask:0x4 bank_mask:0xf
  v_cndmask_b32_dpp v16, v84, v86, vcc quad_perm:[0,1,2,3] row_mask:0x8 bank_mask:0xf
  v_cndmask_b32_dpp v18, v88, v90, vcc quad_perm:[0,1,2,3] row_mask:0x8 bank_mask:0xf
  v_cndmask_b32_dpp v17, v92, v94, vcc quad_perm:[0,1,2,3] row_mask:0x8 bank_mask:0xf
  v_cndmask_b32_dpp v19, v96, v98, vcc quad_perm:[0,1,2,3] row_mask:0x8 bank_mask:0xf
  v_mov_b32 v3, 0
  v_mov_b32 v20, 64
  v_add_f32_dpp v16, v16, v16 quad_perm:[2,3,0,1] row_mask:0xf bank_mask:0xf
  v_add_f32_dpp v17, v17, v17 quad_perm:[2,3,0,1] row_mask:0xf bank_mask:0xf
  v_add_f32_dpp v18, v18, v18 quad_perm:[2,3,0,1] row_mask:0xf bank_mask:0xf
  v_add_f32_dpp v19, v19, v19 quad_perm:[2,3,0,1] row_mask:0xf bank_mask:0xf
  v_cndmask_b32 v8, v16, v17, s[52:53]
  v_cndmask_b32 v9, v18, v19, s[52:53]
  s_nop 0
  v_lshlrev_b32 v21, 3, s9
  v_add_f32_dpp v8, v8, v8 quad_perm:[1,0,3,2] row_mask:0xf bank_mask:0xf
  v_add_f32_dpp v9, v9, v9 quad_perm:[1,0,3,2] row_mask:0xf bank_mask:0xf
  v_cndmask_b32 v25, v8, v9, s[54:55]
  v_cvt_pk_bf16_f32 v25, 0, v25
  v_mul_f32 v25, 0x3db504f3, v25
  v_cvt_pk_bf16_f32 v25, 0, v25
  v_cmp_gt_u32 vcc, s46, v24
  v_mov_b32 v37, 0xff800000
  s_nop 0
  v_cndmask_b32 v25, v37, v25, vcc
  v_mov_b32 v37, v25
  s_nop 1
  v_max_f32_dpp v37, v37, v37 row_ror:8 row_mask:0xf bank_mask:0xf
  s_nop 1
  v_max_f32_dpp v37, v37, v37 row_ror:4 row_mask:0xf bank_mask:0xf
  s_nop 1
  v_max_f32_dpp v37, v37, v37 row_ror:2 row_mask:0xf bank_mask:0xf
  s_nop 1
  v_max_f32_dpp v37, v37, v37 row_ror:1 row_mask:0xf bank_mask:0xf
  v_mov_b32 v8, v37
  s_nop 1
  v_permlane16_swap_b32 v8, v37
  v_max_f32 v37, v37, v8
  v_mov_b32 v8, v37
  s_nop 1
  v_permlane32_swap_b32 v8, v37
  v_max_f32 v37, v37, v8
  s_mov_b64 exec, 1
  ds_max_f32 v3, v37 offset:284
  ds_add_u32 v3, v20 offset:280
  s_mov_b64 exec, -1
  s_mov_b32 s39, 4
  s_mov_b32 s19, 0
  s_setpc_b64 s[100:101]
L_w5:
  s_add_u32 s68, s41, 24
  s_cmp_lt_u32 s32, s68
  s_cbranch_scc1 L_wr
  s_mov_b64 vcc, s[52:53]
  v_mfma_f32_16x16x32_bf16 v[8:11], v[4:7], v[104:107], 0
  v_mfma_f32_16x16x32_bf16 v[104:107], v[4:7], v[108:111], 0
  v_mfma_f32_16x16x32_bf16 v[108:111], v[4:7], v[112:115], 0
  v_mfma_f32_16x16x32_bf16 v[112:115], v[4:7], v[116:119], 0
  v_mfma_f32_16x16x32_bf16 v[116:119], v[4:7], v[120:123], 0
  v_mfma_f32_16x16x32_bf16 v[120:123], v[4:7], v[124:127], 0
  v_mfma_f32_16x16x32_bf16 v[124:127], v[4:7], v[128:131], 0
  v_mfma_f32_16x16x32_bf16 v[128:131], v[4:7], v[132:135], 0
  s_nop 0
  v_cndmask_b32 v8, v8, v9, s[54:55]
  v_cndmask_b32 v10, v10, v11, s[54:55]
  v_cndmask_b32 v104, v104, v105, s[54:55]
  v_cndmask_b32 v106, v106, v107, s[54:55]
  v_cndmask_b32 v108, v108, v109, s[54:55]
  v_cndmask_b32 v110, v110, v111, s[54:55]
  v_cndmask_b32 v112, v112, v113, s[54:55]
  v_cndmask_b32 v114, v114, v115, s[54:55]
  v_cndmask_b32 v116, v116, v117, s[54:55]
  v_cndmask_b32 v118, v118, v119, s[54:55]
  v_cndmask_b32 v120, v120, v121, s[54:55]
  v_cndmask_b32 v122, v122, v123, s[54:55]
  v_cndmask_b32 v124, v124, v125, s[54:55]
  v_cndmask_b32 v126, v126, v127, s[54:55]
  v_cndmask_b32 v128, v128, v129, s[54:55]
  v_cndmask_b32 v130, v130, v131, s[54:55]
  v_cndmask_b32_dpp v16, v8, v10, vcc quad_perm:[0,1,2,3] row_mask:0x1 bank_mask:0xf
  v_cndmask_b32_dpp v18, v104, v106, vcc quad_perm:[0,1,2,3] row_mask:0x1 bank_mask:0xf
  v_cndmask_b32_dpp v17, v108, v110, vcc quad_perm:[0,1,2,3] row_mask:0x1 bank_mask:0xf
  v_cndmask_b32_dpp v19, v112, v114, vcc quad_perm:[0,1,2,3] row_mask:0x1 bank_mask:0xf
  v_cndmask_b32_dpp v16, v116, v118, vcc quad_perm:[0,1,2,3] row_mask:0x2 bank_mask:0xf
  v_cndmask_b32_dpp v18, v120, v122, vcc quad_perm:[0,1,2,3] row_mask:0x2 bank_mask:0xf
  v_cndmask_b32_dpp v17, v124, v126, vcc quad_perm:[0,1,2,3] row_mask:0x2 bank_mask:0xf
  v_cndmask_b32_dpp v19, v128, v130, vcc quad_perm:[0,1,2,3] row_mask:0x2 bank_mask:0xf
  s_mov_b32 s39, 6
  s_mov_b32 s57, 99
  s_setpc_b64 s[100:101]
L_w3:
  v_mov_b32 v3, 0
  ds_read_b64 v[18:19], v3 offset:280
  s_waitcnt lgkmcnt(0)
  v_cmp_gt_u32 vcc, 0x102c0, v18
  s_cmp_lg_u64 vcc, 0
  s_cbranch_scc1 L_wr
  ds_read_b64 v[20:21], v3 offset:320
  s_waitcnt lgkmcnt(0)
  v_add_f32 v21, 0xc1c00000, v21
  v_cmp_nlt_f32 vcc, v25, v21
  v_readfirstlane_b32 s22, v21
  v_readfirstlane_b32 s23, v20
  s_mov_b32 s20, 0
  s_bcnt1_i32_b64 s68, vcc
  s_cmp_gt_u32 s68, 32
  s_cselect_b32 s21, 1, 0
  s_cbranch_scc1 L_w4
  s_mov_b32 s38, 160
  v_cmp_nlt_f32 vcc, v25, v21
  s_lshl_b32 s68, s38, 3
  s_add_u32 s68, s68, s56
  s_andn2_b64 s[70:71], vcc, s[64:65]
  v_mbcnt_lo_u32_b32 v3, s70, 0
  v_mbcnt_hi_u32_b32 v3, s71, v3
  s_bcnt1_i32_b64 s69, s[70:71]
  v_lshl_add_u32 v3, v3, 3, s68
  s_mov_b64 exec, s[70:71]
  ds_write_b64 v3, v[24:25]
  s_mov_b64 exec, -1
  s_or_b64 s[64:65], s[64:65], s[70:71]
  s_add_u32 s38, s38, s69
  s_mov_b32 s20, s69
  s_mov_b32 s38, 0
L_w4:
  v_add_f32 v21, 0xc2a5e666, v20
  v_cmp_nlt_f32 vcc, v25, v21
  s_lshl_b32 s68, s38, 3
  s_add_u32 s68, s68, s56
  s_andn2_b64 s[70:71], vcc, s[64:65]
  v_mbcnt_lo_u32_b32 v3, s70, 0
  v_mbcnt_hi_u32_b32 v3, s71, v3
  s_bcnt1_i32_b64 s69, s[70:71]
  v_lshl_add_u32 v3, v3, 3, s68
  s_mov_b64 exec, s[70:71]
  ds_write_b64 v3, v[24:25]
  s_mov_b64 exec, -1
  s_or_b64 s[64:65], s[64:65], s[70:71]
  s_add_u32 s38, s38, s69
  s_add_u32 s68, s38, 6
  s_lshr_b32 s68, s68, 1
  s_sub_u32 s69, s68, s59
  s_mov_b32 s59, s68
  v_mov_b32 v3, s69
  s_mov_b64 exec, 1
  ds_add_u32 v1, v3 offset:296
  ds_add_u32 v1, v3 offset:300
  s_mov_b64 exec, -1
  s_sub_i32 s68, s59, 20
  s_max_i32 s68, s68, -4
  s_mul_i32 s68, s68, 245
  s_add_i32 s34, s34, s68
  s_mov_b32 s39, 5
  s_mov_b32 s57, 25
  ds_read_b64 v[28:29], v39 offset:0
  s_waitcnt lgkmcnt(0)
  s_setpc_b64 s[100:101]
L_pub:
  s_load_dwordx8 s[24:31], s[0:1], 32
  s_load_dwordx8 s[32:39], s[0:1], 64
  s_load_dwordx4 s[40:43], s[0:1], 96
  s_mov_b32 s72, 0xfffffffe
  s_mov_b32 s73, 0xffff0000
  s_getpc_b64 s[56:57]
L_pct:
  s_lshr_b32 s3, s2, 3
  s_lshl_b32 s3, s3, 2
  s_add_u32 s3, s3, L_touch-L_pct
  s_load_dword s14, s[56:57], s3
  s_waitcnt lgkmcnt(0)
  s_bfe_u32 s48, s14, 0x30000
  s_lshl_b32 s48, s48, 6
  v_add_u32 v2, s48, v1
  s_bfe_u32 s48, s14, 0x30003
  s_bitcmp1_b32 s14, 7
  s_cbranch_scc1 L_te_4
  s_bitcmp1_b32 s14, 6
  s_cbranch_scc1 L_tq_3
  s_lshl1_add_u32 s48, s8, s48
  s_lshl_b32 s48, s48, 7
  v_mul_u32_u24 v2, 6144, v2
  v_add_u32 v2, s48, v2
  global_load_dword v167, v2, s[36:37]
  s_branch L_te_4
L_tq_3:
  s_lshl3_add_u32 s48, s8, s48
  s_lshl_b32 s48, s48, 7
  v_lshl_add_u32 v2, v2, 13, s48
  global_load_dword v167, v2, s[22:23]
L_te_4:
  s_bfe_u32 s48, s14, 0x30008
  s_lshl_b32 s48, s48, 6
  v_add_u32 v2, s48, v1
  s_bfe_u32 s48, s14, 0x3000b
  s_bitcmp1_b32 s14, 15
  s_cbranch_scc1 L_te_6
  s_bitcmp1_b32 s14, 14
  s_cbranch_scc1 L_tq_5
  s_lshl1_add_u32 s48, s8, s48
  s_lshl_b32 s48, s48, 7
  v_mul_u32_u24 v2, 6144, v2
  v_add_u32 v2, s48, v2
  global_load_dword v167, v2, s[36:37]
  s_branch L_te_6
L_tq_5:
  s_lshl3_add_u32 s48, s8, s48
  s_lshl_b32 s48, s48, 7
  v_lshl_add_u32 v2, v2, 13, s48
  global_load_dword v167, v2, s[22:23]
L_te_6:
  v_mov_b32 v38, 0
  v_mov_b32 v4, -1
  v_mov_b32 v8, 0xff800000
  v_mov_b32 v9, 0
  v_lshlrev_b32 v2, 3, v1
  ds_write_b64 v2, v[8:9] offset:448
  v_mov_b32 v5, 0
  v_mov_b32 v6, 0
  v_mov_b32 v7, 0
  v_lshlrev_b32 v2, 2, v1
  ds_write_b32 v2, v4 offset:0
  ds_write_b128 v38, v[4:7] offset:256
  v_mov_b32 v10, 0
  v_mov_b32 v11, v8
  v_mov_b32 v12, 0
  v_mov_b32 v13, v8
  ds_write_b128 v38, v[10:13] offset:272
  v_mov_b32 v10, 1332
  v_mov_b32 v11, 0
  v_mov_b32 v12, 1024
  v_mov_b32 v13, 0
  ds_write_b128 v38, v[10:13] offset:288
  v_mov_b32 v4, 0
  ds_write_b128 v38, v[4:7] offset:304
  s_getreg_b32 s76, hwreg(HW_REG_XCC_ID, 0, 4)
  s_waitcnt lgkmcnt(0)
  s_load_dword s74, s[42:43], 0
  s_barrier
  s_waitcnt lgkmcnt(0)
  s_mul_i32 s74, s74, 0x9e3779b1
  s_add_u32 s74, s74, 0x7f4a7c15
  s_add_u32 s76, s76, s74
  s_lshl2_add_u32 s64, s6, s7
  s_lshl_b32 s64, s64, 7
  s_add_u32 s64, s64, 65536
  v_mov_b32 v18, s64
  v_add_u32 v19, 32768, v18
  v_mov_b32 v17, 0x10000
  s_lshl2_add_u32 s49, s6, s7
  s_lshl_b32 s49, s49, 9
  s_add_u32 s49, s49, 131072
  v_and_b32 v10, 3, v1
  v_lshl_add_u32 v10, v10, 7, s49
  v_bfe_u32 v11, v1, 2, 1
  v_mul_u32_u24 v11, 393216, v11
  v_add_u32 v10, v10, v11
  s_mov_b64 exec, 0xff
  global_load_dword v166, v10, s[42:43] sc1
  s_mov_b64 exec, 1
  global_load_dword v166, v18, s[42:43] sc1
  global_load_dword v166, v19, s[42:43] sc1
  s_mov_b64 exec, -1
  s_mov_b32 s70, 0
L_qw_7:
  ds_read_b32 v8, v38 offset:288
  s_waitcnt lgkmcnt(0)
  v_cmp_lt_u32 vcc, 1222, v8
  s_cmp_eq_u64 vcc, 0
  s_cbranch_scc1 L_qw_7d
  s_sleep 4
  s_add_u32 s70, s70, 1
  s_cmp_lt_u32 s70, 2097152
  s_cbranch_scc1 L_qw_7
L_qw_7d:
  s_lshl_b32 s3, s6, 9
  s_add_u32 s3, s3, 32768
  v_lshl_add_u32 v10, v1, 4, s3
  v_lshlrev_b32 v11, 3, v1
  s_mov_b32 exec_hi, 0
  s_mov_b32 s70, 0
L_qp:
  s_load_dword s20, s[42:43], s3 offset:252 glc
  s_load_dword s21, s[42:43], s3 offset:508 glc
  s_add_u32 s70, s70, 1
  s_cmp_ge_u32 s70, 262144
  s_cbranch_scc1 L_qpd
  s_waitcnt lgkmcnt(0)
  s_xor_b32 s68, s20, s74
  s_xor_b32 s69, s21, s74
  s_or_b32 s68, s68, s69
  s_cbranch_scc1 L_qp
  global_load_dwordx4 v[12:15], v10, s[42:43] sc1
  s_waitcnt vmcnt(0)
  v_cmp_ne_u32 vcc, s74, v13
  v_cmp_ne_u32 s[68:69], s74, v15
  s_or_b64 vcc, vcc, s[68:69]
  s_cbranch_scc1 L_qp
L_qpd:
  s_waitcnt lgkmcnt(0)
  v_mov_b32 v13, v14
  ds_write_b64 v11, v[12:13] offset:0
  s_mov_b64 exec, -1
  s_add_u32 s52, s7, 1
  s_cmp_eq_u32 s52, 3
  s_cselect_b32 s52, 0, s52
  s_add_u32 s53, s52, s7
  s_sub_u32 s53, 3, s53
  s_lshl2_add_u32 s54, s6, s52
  s_lshl_b32 s54, s54, 7
  s_lshl2_add_u32 s55, s6, s53
  s_lshl_b32 s55, s55, 7
  s_mov_b32 s70, 0
L_sn_8:
  ds_read_b64 v[8:9], v38 offset:280
  s_waitcnt lgkmcnt(0)
  v_cmp_gt_u32 vcc, 0x2c0, v8
  s_cmp_eq_u64 vcc, 0
  s_cbranch_scc1 L_snd_9
  s_sleep 2
  s_add_u32 s70, s70, 1
  s_cmp_lt_u32 s70, 2097152
  s_cbranch_scc1 L_sn_8
L_snd_9:
  s_load_dwordx2 s[20:21], s[42:43], s54 offset:65536 glc
  s_load_dwordx2 s[24:25], s[42:43], s55 offset:65536 glc
  v_mov_b32 v8, v9
  v_mov_b32 v9, s74
  s_mov_b64 exec, 1
  global_store_dwordx2 v18, v[8:9], s[42:43] sc1
  s_mov_b32 s70, 0
  s_branch L_s3ec
L_s3e:
  s_load_dwordx2 s[20:21], s[42:43], s54 offset:65536 glc
  s_load_dwordx2 s[24:25], s[42:43], s55 offset:65536 glc
L_s3ec:
  s_waitcnt lgkmcnt(0)
  s_xor_b32 s68, s21, s74
  s_xor_b32 s69, s25, s74
  s_or_b32 s68, s68, s69
  s_cbranch_scc0 L_s3ed
  s_sleep 2
  s_add_u32 s70, s70, 1
  s_cmp_lt_u32 s70, 262144
  s_cbranch_scc1 L_s3e
L_s3ed:
  v_mov_b32 v12, s20
  v_max3_f32 v10, v8, v12, s24
  v_min3_f32 v11, v8, v12, s24
  ds_write_b64 v38, v[10:11] offset:320
  ds_add_u32 v38, v17 offset:280
  s_mov_b64 exec, -1
  s_lshl_b32 s64, s8, 7
  s_load_dwordx8 s[20:27], s[42:43], s64 offset:1024 glc
  s_waitcnt lgkmcnt(0)
  s_xor_b32 s68, s20, s76
  s_xor_b32 s69, s21, s76
  s_or_b32 s68, s68, s69
  s_xor_b32 s69, s22, s76
  s_or_b32 s68, s68, s69
  s_xor_b32 s69, s23, s76
  s_or_b32 s68, s68, s69
  s_xor_b32 s69, s24, s76
  s_or_b32 s68, s68, s69
  s_xor_b32 s69, s25, s76
  s_or_b32 s68, s68, s69
  s_xor_b32 s69, s26, s76
  s_or_b32 s68, s68, s69
  s_xor_b32 s69, s27, s76
  s_or_b32 s68, s68, s69
  s_cselect_b32 s75, 0, 1
  v_lshlrev_b32 v20, 3, s7
  v_lshlrev_b32 v21, 3, s52
  v_lshlrev_b32 v22, 3, s53
  v_and_b32 v9, 15, v1
  v_lshlrev_b32 v9, 3, v9
  v_lshlrev_b32 v11, 2, v1
  s_mov_b32 s70, 0
L_sn_10:
  ds_read_b32 v8, v38 offset:272
  s_waitcnt lgkmcnt(0)
  v_cmp_gt_u32 vcc, 0x280, v8
  s_cmp_eq_u64 vcc, 0
  s_cbranch_scc1 L_snd_11
  s_sleep 1
  s_add_u32 s70, s70, 1
  s_cmp_lt_u32 s70, 2097152
  s_cbranch_scc1 L_sn_10
L_snd_11:
  s_mov_b32 s70, 0
L_wt_12:
  ds_read_b32 v8, v38 offset:272
  ds_read_b32 v16, v9 offset:512
  ds_read_b32 v40, v11 offset:1024
  ds_read_b32 v41, v11 offset:1536
  ds_read_b32 v42, v11 offset:2048
  ds_read_b32 v43, v11 offset:2560
  ds_read_b32 v44, v11 offset:3072
  ds_read_b32 v45, v11 offset:3584
  ds_read_b32 v46, v11 offset:4096
  ds_read_b32 v47, v11 offset:4608
  ds_read_b32 v48, v11 offset:5120
  ds_read_b32 v49, v11 offset:5632
  ds_read_b32 v50, v11 offset:6144
  s_waitcnt lgkmcnt(12)
  v_cmp_gt_u32 vcc, 0x2c0, v8
  s_cmp_eq_u64 vcc, 0
  s_cbranch_scc1 L_wtd_13
  s_waitcnt lgkmcnt(0)
  s_add_u32 s70, s70, 1
  s_cmp_lt_u32 s70, 2097152
  s_cbranch_scc1 L_wt_12
L_wtd_13:
  s_waitcnt lgkmcnt(11)
  v_max_f32_dpp v8, v16, v16 quad_perm:[1,0,3,2] row_mask:0xf bank_mask:0xf
  s_nop 1
  v_max_f32_dpp v8, v8, v8 quad_perm:[2,3,0,1] row_mask:0xf bank_mask:0xf
  s_nop 1
  v_max_f32_dpp v8, v8, v8 row_half_mirror row_mask:0xf bank_mask:0xf
  s_nop 1
  v_max_f32_dpp v8, v8, v8 row_mirror row_mask:0xf bank_mask:0xf
  v_sub_f32 v9, v16, v8
  v_mul_f32 v9, 0x3fb8aa3b, v9
  v_exp_f32 v9, v9
  s_waitcnt lgkmcnt(0)
  s_nop 0
  v_mul_f32_dpp v10, v9, v40 row_newbcast:0 row_mask:0xf bank_mask:0xf
  v_mul_f32_dpp v12, v9, v41 row_newbcast:1 row_mask:0xf bank_mask:0xf
  v_fmac_f32_dpp v10, v9, v42 row_newbcast:2 row_mask:0xf bank_mask:0xf
  v_fmac_f32_dpp v12, v9, v43 row_newbcast:3 row_mask:0xf bank_mask:0xf
  v_fmac_f32_dpp v10, v9, v44 row_newbcast:4 row_mask:0xf bank_mask:0xf
  v_fmac_f32_dpp v12, v9, v45 row_newbcast:5 row_mask:0xf bank_mask:0xf
  v_fmac_f32_dpp v10, v9, v46 row_newbcast:6 row_mask:0xf bank_mask:0xf
  v_fmac_f32_dpp v12, v9, v47 row_newbcast:7 row_mask:0xf bank_mask:0xf
  v_fmac_f32_dpp v10, v9, v48 row_newbcast:8 row_mask:0xf bank_mask:0xf
  v_fmac_f32_dpp v12, v9, v49 row_newbcast:9 row_mask:0xf bank_mask:0xf
  v_fmac_f32_dpp v10, v9, v50 row_newbcast:10 row_mask:0xf bank_mask:0xf
  v_add_f32 v10, v10, v12
  s_nop 1
  v_add_f32_dpp v10, v10, v10 row_ror:8 row_mask:0xf bank_mask:0xf
  s_nop 1
  v_add_f32_dpp v10, v10, v10 row_ror:4 row_mask:0xf bank_mask:0xf
  s_nop 1
  v_add_f32_dpp v10, v10, v10 row_ror:2 row_mask:0xf bank_mask:0xf
  s_nop 1
  v_add_f32_dpp v10, v10, v10 row_ror:1 row_mask:0xf bank_mask:0xf
  v_mov_b32 v12, v10
  s_nop 1
  v_permlane16_swap_b32 v12, v10
  v_add_f32 v10, v10, v12
  v_mov_b32 v12, v10
  s_nop 1
  v_permlane32_swap_b32 v12, v10
  v_add_f32 v10, v10, v12
  s_load_dwordx4 s[20:23], s[42:43], s54 offset:98304 glc
  s_load_dwordx4 s[24:27], s[42:43], s55 offset:98304 glc
  v_mov_b32 v9, s74
  v_mov_b32 v11, s74
  s_mov_b64 exec, 1
  global_store_dwordx4 v19, v[8:11], s[42:43] sc1
  ds_write_b32 v20, v8 offset:448
  ds_write_b32 v20, v10 offset:452
  s_mov_b32 s70, 0
  s_branch L_s3pc
L_s3p:
  s_load_dwordx4 s[20:23], s[42:43], s54 offset:98304 glc
  s_load_dwordx4 s[24:27], s[42:43], s55 offset:98304 glc
L_s3pc:
  s_waitcnt lgkmcnt(0)
  s_xor_b32 s68, s21, s74
  s_xor_b32 s69, s23, s74
  s_or_b32 s68, s68, s69
  s_xor_b32 s69, s25, s74
  s_or_b32 s68, s68, s69
  s_xor_b32 s69, s27, s74
  s_or_b32 s68, s68, s69
  s_cbranch_scc0 L_s3pd
  s_sleep 2
  s_add_u32 s70, s70, 1
  s_cmp_lt_u32 s70, 262144
  s_cbranch_scc1 L_s3p
L_s3pd:
  v_mov_b32 v12, s20
  v_mov_b32 v13, s22
  v_mov_b32 v14, s24
  v_mov_b32 v15, s26
  ds_write_b64 v21, v[12:13] offset:448
  ds_write_b64 v22, v[14:15] offset:448
  s_mov_b64 exec, -1
  v_and_b32 v9, 3, v1
  v_lshlrev_b32 v9, 3, v9
  ds_read_b64 v[10:11], v9 offset:448
  s_waitcnt lgkmcnt(0)
  v_max_f32_dpp v8, v10, v10 quad_perm:[1,0,3,2] row_mask:0xf bank_mask:0xf
  s_nop 1
  v_max_f32_dpp v8, v8, v8 quad_perm:[2,3,0,1] row_mask:0xf bank_mask:0xf
  v_sub_f32 v9, v10, v8
  v_mul_f32 v9, 0x3fb8aa3b, v9
  v_exp_f32 v9, v9
  s_nop 0
  v_mul_f32 v10, v9, v11
  s_nop 1
  v_add_f32_dpp v10, v10, v10 quad_perm:[1,0,3,2] row_mask:0xf bank_mask:0xf
  s_nop 1
  v_add_f32_dpp v10, v10, v10 quad_perm:[2,3,0,1] row_mask:0xf bank_mask:0xf
  v_log_f32 v12, v10
  v_sub_f32 v9, v16, v8
  v_rcp_f32 v10, v10
  v_mul_f32 v9, 0x3fb8aa3b, v9
  v_exp_f32 v9, v9
  v_add_f32 v8, 0xc2b9e666, v8
  v_fmac_f32 v8, 0x3f317218, v12
  v_lshlrev_b32 v13, 2, v1
  v_mul_f32 v9, v9, v10
  s_mov_b64 exec, 0xffff
  ds_write_b32 v13, v9 offset:384
  s_mov_b64 exec, 1
  ds_write_b32 v38, v8 offset:276
  ds_add_u32 v38, v17 offset:272
  s_mov_b64 exec, -1
  ds_read_b128 v[62:65], v38 offset:384
  ds_read_b128 v[66:69], v38 offset:400
  ds_read_b128 v[70:73], v38 offset:416
  v_lshlrev_b32 v77, 3, v1
  s_lshl2_add_u32 s68, s6, s7
  s_lshl_b32 s68, s68, 9
  s_add_u32 s68, s68, 131072
  v_add_u32 v74, s68, v77
  v_and_b32 v75, 1, v1
  v_lshlrev_b32 v75, 4, v75
  v_lshrrev_b32 v75, v75, s74
  v_lshrrev_b32 v76, 8, v75
  s_mov_b32 s70, 0
L_sn_14:
  ds_read_b32 v8, v38 offset:304
  s_waitcnt lgkmcnt(0)
  v_cmp_gt_u32 vcc, 0xa, v8
  s_cmp_eq_u64 vcc, 0
  s_cbranch_scc1 L_snd_15
  s_sleep 1
  s_add_u32 s70, s70, 1
  s_cmp_lt_u32 s70, 2097152
  s_cbranch_scc1 L_sn_14
L_snd_15:
  s_mov_b32 s70, 0
L_wt_16:
  ds_read_b32 v8, v38 offset:304
  ds_read_b64 v[40:41], v77 offset:6656
  ds_read_b64 v[42:43], v77 offset:7168
  ds_read_b64 v[44:45], v77 offset:7680
  ds_read_b64 v[46:47], v77 offset:8192
  ds_read_b64 v[48:49], v77 offset:8704
  ds_read_b64 v[50:51], v77 offset:9216
  ds_read_b64 v[52:53], v77 offset:9728
  ds_read_b64 v[54:55], v77 offset:10240
  ds_read_b64 v[56:57], v77 offset:10752
  ds_read_b64 v[58:59], v77 offset:11264
  ds_read_b64 v[60:61], v77 offset:11776
  s_waitcnt lgkmcnt(11)
  v_cmp_gt_u32 vcc, 0xb, v8
  s_cmp_eq_u64 vcc, 0
  s_cbranch_scc1 L_wtd_17
  s_waitcnt lgkmcnt(0)
  s_add_u32 s70, s70, 1
  s_cmp_lt_u32 s70, 2097152
  s_cbranch_scc1 L_wt_16
L_wtd_17:
  s_movk_i32 s69, 0xff
  s_waitcnt lgkmcnt(10)
  v_pk_mul_f32 v[40:41], v[40:41], v[62:63] op_sel:[0,0] op_sel_hi:[1,0]
  s_waitcnt lgkmcnt(9)
  v_pk_mul_f32 v[42:43], v[42:43], v[62:63] op_sel:[0,1] op_sel_hi:[1,1]
  s_waitcnt lgkmcnt(8)
  v_pk_fma_f32 v[40:41], v[44:45], v[64:65], v[40:41] op_sel:[0,0,0] op_sel_hi:[1,0,1]
  s_waitcnt lgkmcnt(7)
  v_pk_fma_f32 v[42:43], v[46:47], v[64:65], v[42:43] op_sel:[0,1,0] op_sel_hi:[1,1,1]
  s_waitcnt lgkmcnt(6)
  v_pk_fma_f32 v[40:41], v[48:49], v[66:67], v[40:41] op_sel:[0,0,0] op_sel_hi:[1,0,1]
  s_waitcnt lgkmcnt(5)
  v_pk_fma_f32 v[42:43], v[50:51], v[66:67], v[42:43] op_sel:[0,1,0] op_sel_hi:[1,1,1]
  s_waitcnt lgkmcnt(4)
  v_pk_fma_f32 v[40:41], v[52:53], v[68:69], v[40:41] op_sel:[0,0,0] op_sel_hi:[1,0,1]
  s_waitcnt lgkmcnt(3)
  v_pk_fma_f32 v[42:43], v[54:55], v[68:69], v[42:43] op_sel:[0,1,0] op_sel_hi:[1,1,1]
  s_waitcnt lgkmcnt(2)
  v_pk_fma_f32 v[40:41], v[56:57], v[70:71], v[40:41] op_sel:[0,0,0] op_sel_hi:[1,0,1]
  s_waitcnt lgkmcnt(1)
  v_pk_fma_f32 v[42:43], v[58:59], v[70:71], v[42:43] op_sel:[0,1,0] op_sel_hi:[1,1,1]
  s_waitcnt lgkmcnt(0)
  v_pk_fma_f32 v[40:41], v[60:61], v[72:73], v[40:41] op_sel:[0,0,0] op_sel_hi:[1,0,1]
  v_pk_add_f32 v[40:41], v[40:41], v[42:43]
  v_bfi_b32 v40, s69, v75, v40
  v_bfi_b32 v41, s69, v76, v41
  s_cmp_eq_u32 s75, 1
  s_cbranch_scc0 L_pf_18
  global_store_dwordx2 v74, v[40:41], s[42:43]
  s_branch L_pe_19
L_pf_18:
  global_store_dwordx2 v74, v[40:41], s[42:43] sc1
L_pe_19:
  ds_read_b128 v[102:105], v38 offset:384
  ds_read_b128 v[106:109], v38 offset:400
  ds_read_b128 v[110:113], v38 offset:416
  v_lshlrev_b32 v117, 3, v1
  s_lshl2_add_u32 s68, s6, s7
  s_lshl_b32 s68, s68, 9
  s_add_u32 s68, s68, 524288
  v_add_u32 v114, s68, v117
  v_and_b32 v115, 1, v1
  v_lshlrev_b32 v115, 4, v115
  v_lshrrev_b32 v115, v115, s74
  v_lshrrev_b32 v116, 8, v115
  s_waitcnt vmcnt(0)
  s_mov_b32 s70, 0
L_sn_20:
  ds_read_b32 v8, v38 offset:308
  s_waitcnt lgkmcnt(0)
  v_cmp_gt_u32 vcc, 0x1, v8
  s_cmp_eq_u64 vcc, 0
  s_cbranch_scc1 L_snd_21
  s_sleep 4
  s_add_u32 s70, s70, 1
  s_cmp_lt_u32 s70, 2097152
  s_cbranch_scc1 L_sn_20
L_snd_21:
  global_store_dwordx2 v74, v[40:41], s[42:43] sc1
  s_cmp_eq_u32 s7, 2
  s_cbranch_scc1 L_chk
  s_mov_b32 s70, 0
L_sn_22:
  ds_read_b32 v8, v38 offset:308
  s_waitcnt lgkmcnt(0)
  v_cmp_gt_u32 vcc, 0xa, v8
  s_cmp_eq_u64 vcc, 0
  s_cbranch_scc1 L_snd_23
  s_sleep 1
  s_add_u32 s70, s70, 1
  s_cmp_lt_u32 s70, 2097152
  s_cbranch_scc1 L_sn_22
L_snd_23:
  s_mov_b32 s70, 0
L_wt_24:
  ds_read_b32 v8, v38 offset:308
  ds_read_b64 v[80:81], v117 offset:1024
  ds_read_b64 v[82:83], v117 offset:1536
  ds_read_b64 v[84:85], v117 offset:2048
  ds_read_b64 v[86:87], v117 offset:2560
  ds_read_b64 v[88:89], v117 offset:3072
  ds_read_b64 v[90:91], v117 offset:3584
  ds_read_b64 v[92:93], v117 offset:4096
  ds_read_b64 v[94:95], v117 offset:4608
  ds_read_b64 v[96:97], v117 offset:5120
  ds_read_b64 v[98:99], v117 offset:5632
  ds_read_b64 v[100:101], v117 offset:6144
  s_waitcnt lgkmcnt(11)
  v_cmp_gt_u32 vcc, 0xb, v8
  s_cmp_eq_u64 vcc, 0
  s_cbranch_scc1 L_wtd_25
  s_waitcnt lgkmcnt(0)
  s_add_u32 s70, s70, 1
  s_cmp_lt_u32 s70, 2097152
  s_cbranch_scc1 L_wt_24
L_wtd_25:
  s_movk_i32 s69, 0xff
  s_waitcnt lgkmcnt(10)
  v_pk_mul_f32 v[80:81], v[80:81], v[102:103] op_sel:[0,0] op_sel_hi:[1,0]
  s_waitcnt lgkmcnt(9)
  v_pk_mul_f32 v[82:83], v[82:83], v[102:103] op_sel:[0,1] op_sel_hi:[1,1]
  s_waitcnt lgkmcnt(8)
  v_pk_fma_f32 v[80:81], v[84:85], v[104:105], v[80:81] op_sel:[0,0,0] op_sel_hi:[1,0,1]
  s_waitcnt lgkmcnt(7)
  v_pk_fma_f32 v[82:83], v[86:87], v[104:105], v[82:83] op_sel:[0,1,0] op_sel_hi:[1,1,1]
  s_waitcnt lgkmcnt(6)
  v_pk_fma_f32 v[80:81], v[88:89], v[106:107], v[80:81] op_sel:[0,0,0] op_sel_hi:[1,0,1]
  s_waitcnt lgkmcnt(5)
  v_pk_fma_f32 v[82:83], v[90:91], v[106:107], v[82:83] op_sel:[0,1,0] op_sel_hi:[1,1,1]
  s_waitcnt lgkmcnt(4)
  v_pk_fma_f32 v[80:81], v[92:93], v[108:109], v[80:81] op_sel:[0,0,0] op_sel_hi:[1,0,1]
  s_waitcnt lgkmcnt(3)
  v_pk_fma_f32 v[82:83], v[94:95], v[108:109], v[82:83] op_sel:[0,1,0] op_sel_hi:[1,1,1]
  s_waitcnt lgkmcnt(2)
  v_pk_fma_f32 v[80:81], v[96:97], v[110:111], v[80:81] op_sel:[0,0,0] op_sel_hi:[1,0,1]
  s_waitcnt lgkmcnt(1)
  v_pk_fma_f32 v[82:83], v[98:99], v[110:111], v[82:83] op_sel:[0,1,0] op_sel_hi:[1,1,1]
  s_waitcnt lgkmcnt(0)
  v_pk_fma_f32 v[80:81], v[100:101], v[112:113], v[80:81] op_sel:[0,0,0] op_sel_hi:[1,0,1]
  v_pk_add_f32 v[80:81], v[80:81], v[82:83]
  v_bfi_b32 v80, s69, v115, v80
  v_bfi_b32 v81, s69, v116, v81
  global_store_dwordx2 v114, v[80:81], s[42:43] sc1
  s_branch L_fin
L_chk:
  v_and_b32 v160, 0xff, v75
  v_and_b32 v161, 0xff, v76
  s_lshl_b32 s10, s6, 11
  s_add_u32 s10, s10, 131072
  v_lshl_add_u32 v2, v1, 3, s10
  global_load_dwordx2 v[154:155], v2, s[42:43] offset:0 sc1
  global_load_dwordx2 v[156:157], v2, s[42:43] offset:512 sc1
  v_add_u32 v3, 393216, v2
  s_mov_b32 s70, 0
L_sn_26:
  ds_read_b32 v8, v38 offset:308
  s_waitcnt lgkmcnt(0)
  v_cmp_gt_u32 vcc, 0xa, v8
  s_cmp_eq_u64 vcc, 0
  s_cbranch_scc1 L_snd_27
  s_sleep 1
  s_add_u32 s70, s70, 1
  s_cmp_lt_u32 s70, 2097152
  s_cbranch_scc1 L_sn_26
L_snd_27:
  s_mov_b32 s70, 0
L_wt_28:
  ds_read_b32 v8, v38 offset:308
  ds_read_b64 v[80:81], v117 offset:1024
  ds_read_b64 v[82:83], v117 offset:1536
  ds_read_b64 v[84:85], v117 offset:2048
  ds_read_b64 v[86:87], v117 offset:2560
  ds_read_b64 v[88:89], v117 offset:3072
  ds_read_b64 v[90:91], v117 offset:3584
  ds_read_b64 v[92:93], v117 offset:4096
  ds_read_b64 v[94:95], v117 offset:4608
  ds_read_b64 v[96:97], v117 offset:5120
  ds_read_b64 v[98:99], v117 offset:5632
  ds_read_b64 v[100:101], v117 offset:6144
  s_waitcnt lgkmcnt(11)
  v_cmp_gt_u32 vcc, 0xb, v8
  s_cmp_eq_u64 vcc, 0
  s_cbranch_scc1 L_wtd_29
  s_waitcnt lgkmcnt(0)
  s_add_u32 s70, s70, 1
  s_cmp_lt_u32 s70, 2097152
  s_cbranch_scc1 L_wt_28
L_wtd_29:
  global_load_dwordx2 v[130:131], v3, s[42:43] offset:0 sc1
  global_load_dwordx2 v[132:133], v3, s[42:43] offset:512 sc1
  s_movk_i32 s69, 0xff
  s_waitcnt lgkmcnt(10)
  v_pk_mul_f32 v[80:81], v[80:81], v[102:103] op_sel:[0,0] op_sel_hi:[1,0]
  s_waitcnt lgkmcnt(9)
  v_pk_mul_f32 v[82:83], v[82:83], v[102:103] op_sel:[0,1] op_sel_hi:[1,1]
  s_waitcnt lgkmcnt(8)
  v_pk_fma_f32 v[80:81], v[84:85], v[104:105], v[80:81] op_sel:[0,0,0] op_sel_hi:[1,0,1]
  s_waitcnt lgkmcnt(7)
  v_pk_fma_f32 v[82:83], v[86:87], v[104:105], v[82:83] op_sel:[0,1,0] op_sel_hi:[1,1,1]
  s_waitcnt lgkmcnt(6)
  v_pk_fma_f32 v[80:81], v[88:89], v[106:107], v[80:81] op_sel:[0,0,0] op_sel_hi:[1,0,1]
  s_waitcnt lgkmcnt(5)
  v_pk_fma_f32 v[82:83], v[90:91], v[106:107], v[82:83] op_sel:[0,1,0] op_sel_hi:[1,1,1]
  s_waitcnt lgkmcnt(4)
  v_pk_fma_f32 v[80:81], v[92:93], v[108:109], v[80:81] op_sel:[0,0,0] op_sel_hi:[1,0,1]
  s_waitcnt lgkmcnt(3)
  v_pk_fma_f32 v[82:83], v[94:95], v[108:109], v[82:83] op_sel:[0,1,0] op_sel_hi:[1,1,1]
  s_waitcnt lgkmcnt(2)
  v_pk_fma_f32 v[80:81], v[96:97], v[110:111], v[80:81] op_sel:[0,0,0] op_sel_hi:[1,0,1]
  s_waitcnt lgkmcnt(1)
  v_pk_fma_f32 v[82:83], v[98:99], v[110:111], v[82:83] op_sel:[0,1,0] op_sel_hi:[1,1,1]
  s_waitcnt lgkmcnt(0)
  v_pk_fma_f32 v[80:81], v[100:101], v[112:113], v[80:81] op_sel:[0,0,0] op_sel_hi:[1,0,1]
  v_pk_add_f32 v[80:81], v[80:81], v[82:83]
  v_bfi_b32 v80, s69, v115, v80
  v_bfi_b32 v81, s69, v116, v81
  global_store_dwordx2 v114, v[80:81], s[42:43] sc1
  s_waitcnt vmcnt(1)
  s_mov_b32 s70, 0
  s_branch L_cp0c
L_cp0:
  global_load_dwordx2 v[154:155], v2, s[42:43] offset:0 sc1
  global_load_dwordx2 v[156:157], v2, s[42:43] offset:512 sc1
  s_sleep 4
  s_waitcnt vmcnt(0)
L_cp0c:
  v_xor_b32 v136, v154, v160
  v_xor_b32 v137, v155, v161
  v_xor_b32 v138, v156, v160
  v_xor_b32 v139, v157, v161
  v_xor_b32 v140, v40, v160
  v_xor_b32 v141, v41, v161
  v_or3_b32 v152, v136, v137, v138
  v_or3_b32 v153, v139, v140, v141
  v_or_b32 v136, 0x80, v136
  v_or_b32 v137, 0x80, v137
  v_or_b32 v138, 0x80, v138
  v_or_b32 v139, 0x80, v139
  v_or_b32 v140, 0x80, v140
  v_or_b32 v141, 0x80, v141
  v_or_b32 v152, v152, v153
  v_pk_add_f32 v[136:137], v[136:137], v[138:139]
  v_lshlrev_b32 v152, 24, v152
  v_pk_add_f32 v[136:137], v[136:137], v[140:141]
  v_cmp_ne_u32 vcc, 0, v152
  v_cvt_pk_bf16_f32 v136, v136, v137
  s_cmp_eq_u64 vcc, 0
  s_cbranch_scc1 L_cp0d
  s_add_u32 s70, s70, 1
  s_cmp_lt_u32 s70, 262144
  s_cbranch_scc1 L_cp0
L_cp0d:
  v_add_u32 v2, 393216, v2
  s_mov_b32 s70, 0
  s_branch L_cp1c
L_cp1:
  global_load_dwordx2 v[130:131], v2, s[42:43] offset:0 sc1
  global_load_dwordx2 v[132:133], v2, s[42:43] offset:512 sc1
  s_waitcnt vmcnt(0)
L_cp1c:
  v_xor_b32 v144, v130, v160
  v_xor_b32 v145, v131, v161
  v_xor_b32 v146, v132, v160
  v_xor_b32 v147, v133, v161
  v_xor_b32 v148, v80, v160
  v_xor_b32 v149, v81, v161
  v_or3_b32 v152, v144, v145, v146
  v_or3_b32 v153, v147, v148, v149
  v_or_b32 v144, 0x80, v144
  v_or_b32 v145, 0x80, v145
  v_or_b32 v146, 0x80, v146
  v_or_b32 v147, 0x80, v147
  v_or_b32 v148, 0x80, v148
  v_or_b32 v149, 0x80, v149
  v_or_b32 v152, v152, v153
  v_pk_add_f32 v[144:145], v[144:145], v[146:147]
  v_lshlrev_b32 v152, 24, v152
  v_pk_add_f32 v[144:145], v[144:145], v[148:149]
  v_cmp_ne_u32 vcc, 0, v152
  v_cvt_pk_bf16_f32 v144, v144, v145
  s_cmp_eq_u64 vcc, 0
  s_cbranch_scc1 L_cp1d
  s_add_u32 s70, s70, 1
  s_cmp_lt_u32 s70, 262144
  s_cbranch_scc1 L_cp1
L_cp1d:
  v_cmp_ne_u32 vcc, v136, v144
  s_cmp_eq_u64 vcc, 0
  s_cbranch_scc1 L_fin
  s_waitcnt vmcnt(0)
L_slow:
  s_mov_b32 s47, 0x20000
  s_load_dwordx16 s[16:31], s[0:1], 0
  s_load_dwordx8 s[32:39], s[0:1], 64
  v_and_b32 v2, 31, v1
  v_lshlrev_b32 v2, 7, v2
  v_add_u32 v2, 28672, v2
  s_mov_b32 s70, 0
L_sl_d:
  global_load_dword v3, v2, s[42:43] sc1
  s_waitcnt vmcnt(0) lgkmcnt(0)
  v_cmp_ne_u32 vcc, s74, v3
  s_cmp_eq_u64 vcc, 0
  s_cbranch_scc1 L_sl_dd
  s_sleep 8
  s_add_u32 s70, s70, 1
  s_cmp_lt_u32 s70, 262144
  s_cbranch_scc1 L_sl_d
L_sl_dd:
  v_lshlrev_b32 v2, 3, v1
  v_add_u32 v2, 524288, v2
  v_lshlrev_b32 v0, 2, v1
  v_add_u32 v0, 12288, v0
  s_mov_b32 s10, 0
L_sl_h:
  s_mov_b32 s70, 0
L_sl_hp:
  global_load_dwordx2 v[40:41], v2, s[42:43] offset:0 sc1
  global_load_dwordx2 v[42:43], v2, s[42:43] offset:512 sc1
  global_load_dwordx2 v[44:45], v2, s[42:43] offset:1024 sc1
  s_waitcnt vmcnt(0)
  v_xor_b32 v40, v40, v160
  v_xor_b32 v41, v41, v161
  v_xor_b32 v42, v42, v160
  v_xor_b32 v43, v43, v161
  v_xor_b32 v44, v44, v160
  v_xor_b32 v45, v45, v161
  v_or3_b32 v48, v40, v41, v42
  v_or3_b32 v49, v43, v44, v45
  v_or_b32 v40, 0x80, v40
  v_or_b32 v41, 0x80, v41
  v_or_b32 v42, 0x80, v42
  v_or_b32 v43, 0x80, v43
  v_or_b32 v44, 0x80, v44
  v_or_b32 v45, 0x80, v45
  v_or_b32 v48, v48, v49
  v_pk_add_f32 v[40:41], v[40:41], v[42:43]
  v_lshlrev_b32 v48, 24, v48
  v_pk_add_f32 v[40:41], v[40:41], v[44:45]
  v_cmp_ne_u32 vcc, 0, v48
  v_cvt_pk_bf16_f32 v40, v40, v41
  s_cmp_eq_u64 vcc, 0
  s_cbranch_scc1 L_sl_hd
  s_sleep 8
  s_add_u32 s70, s70, 1
  s_cmp_lt_u32 s70, 262144
  s_cbranch_scc1 L_sl_hp
L_sl_hd:
  ds_write_b32 v0, v40
  v_add_u32 v2, 2048, v2
  v_add_u32 v0, 256, v0
  s_add_u32 s10, s10, 1
  s_cmp_lt_u32 s10, 64
  s_cbranch_scc1 L_sl_h
  s_mov_b32 s44, s24
  s_mov_b32 s45, s25
  s_mov_b32 s46, 4194304
  s_mov_b32 s11, 1024
  s_mov_b32 s12, 4194304
  v_mov_b32 v4, 12288
  v_mov_b32 v5, 20480
  v_lshlrev_b32 v2, 4, v1
  s_call_b64 s[62:63], L_gv
  v_lshlrev_b32 v0, 4, v1
  global_load_dwordx4 v[40:43], v0, s[16:17] offset:0
  global_load_dwordx4 v[44:47], v0, s[16:17] offset:1024
  s_waitcnt vmcnt(0)
  v_lshlrev_b32 v104, 16, v40
  v_and_b32 v105, s73, v40
  v_lshlrev_b32 v106, 16, v41
  v_and_b32 v107, s73, v41
  v_lshlrev_b32 v108, 16, v42
  v_and_b32 v109, s73, v42
  v_lshlrev_b32 v110, 16, v43
  v_and_b32 v111, s73, v43
  v_lshlrev_b32 v112, 16, v44
  v_and_b32 v113, s73, v44
  v_lshlrev_b32 v114, 16, v45
  v_and_b32 v115, s73, v45
  v_lshlrev_b32 v116, 16, v46
  v_and_b32 v117, s73, v46
  v_lshlrev_b32 v118, 16, v47
  v_and_b32 v119, s73, v47
  v_lshrrev_b32 v2, 1, v1
  v_lshlrev_b32 v2, 7, v2
  v_and_b32 v3, 1, v1
  v_lshl_add_u32 v2, v3, 5, v2
  v_add_u32 v2, 12288, v2
  global_load_dwordx4 v[40:43], v2, s[42:43] offset:0 sc1
  global_load_dwordx4 v[44:47], v2, s[42:43] offset:16 sc1
  global_load_dwordx4 v[48:51], v2, s[42:43] offset:64 sc1
  global_load_dwordx4 v[52:55], v2, s[42:43] offset:80 sc1
  s_waitcnt vmcnt(0)
  v_lshlrev_b32 v88, 16, v40
  v_and_b32 v89, s73, v40
  v_lshlrev_b32 v90, 16, v42
  v_and_b32 v91, s73, v42
  v_lshlrev_b32 v92, 16, v44
  v_and_b32 v93, s73, v44
  v_lshlrev_b32 v94, 16, v46
  v_and_b32 v95, s73, v46
  v_lshlrev_b32 v96, 16, v48
  v_and_b32 v97, s73, v48
  v_lshlrev_b32 v98, 16, v50
  v_and_b32 v99, s73, v50
  v_lshlrev_b32 v100, 16, v52
  v_and_b32 v101, s73, v52
  v_lshlrev_b32 v102, 16, v54
  v_and_b32 v103, s73, v54
  v_cvt_pk_bf16_f32 v72, 0, v72
  v_cvt_pk_bf16_f32 v73, 0, v73
  v_cvt_pk_bf16_f32 v74, 0, v74
  v_cvt_pk_bf16_f32 v75, 0, v75
  v_cvt_pk_bf16_f32 v76, 0, v76
  v_cvt_pk_bf16_f32 v77, 0, v77
  v_cvt_pk_bf16_f32 v78, 0, v78
  v_cvt_pk_bf16_f32 v79, 0, v79
  v_cvt_pk_bf16_f32 v80, 0, v80
  v_cvt_pk_bf16_f32 v81, 0, v81
  v_cvt_pk_bf16_f32 v82, 0, v82
  v_cvt_pk_bf16_f32 v83, 0, v83
  v_cvt_pk_bf16_f32 v84, 0, v84
  v_cvt_pk_bf16_f32 v85, 0, v85
  v_cvt_pk_bf16_f32 v86, 0, v86
  v_cvt_pk_bf16_f32 v87, 0, v87
  v_mul_f32 v72, v72, v88
  v_mul_f32 v73, v73, v89
  v_mul_f32 v74, v74, v90
  v_mul_f32 v75, v75, v91
  v_mul_f32 v76, v76, v92
  v_mul_f32 v77, v77, v93
  v_mul_f32 v78, v78, v94
  v_mul_f32 v79, v79, v95
  v_mul_f32 v80, v80, v96
  v_mul_f32 v81, v81, v97
  v_mul_f32 v82, v82, v98
  v_mul_f32 v83, v83, v99
  v_mul_f32 v84, v84, v100
  v_mul_f32 v85, v85, v101
  v_mul_f32 v86, v86, v102
  v_mul_f32 v87, v87, v103
  v_cvt_pk_bf16_f32 v72, 0, v72
  v_cvt_pk_bf16_f32 v73, 0, v73
  v_cvt_pk_bf16_f32 v74, 0, v74
  v_cvt_pk_bf16_f32 v75, 0, v75
  v_cvt_pk_bf16_f32 v76, 0, v76
  v_cvt_pk_bf16_f32 v77, 0, v77
  v_cvt_pk_bf16_f32 v78, 0, v78
  v_cvt_pk_bf16_f32 v79, 0, v79
  v_cvt_pk_bf16_f32 v80, 0, v80
  v_cvt_pk_bf16_f32 v81, 0, v81
  v_cvt_pk_bf16_f32 v82, 0, v82
  v_cvt_pk_bf16_f32 v83, 0, v83
  v_cvt_pk_bf16_f32 v84, 0, v84
  v_cvt_pk_bf16_f32 v85, 0, v85
  v_cvt_pk_bf16_f32 v86, 0, v86
  v_cvt_pk_bf16_f32 v87, 0, v87
  v_add_f32 v104, v104, v72
  v_add_f32 v105, v105, v73
  v_add_f32 v106, v106, v74
  v_add_f32 v107, v107, v75
  v_add_f32 v108, v108, v76
  v_add_f32 v109, v109, v77
  v_add_f32 v110, v110, v78
  v_add_f32 v111, v111, v79
  v_add_f32 v112, v112, v80
  v_add_f32 v113, v113, v81
  v_add_f32 v114, v114, v82
  v_add_f32 v115, v115, v83
  v_add_f32 v116, v116, v84
  v_add_f32 v117, v117, v85
  v_add_f32 v118, v118, v86
  v_add_f32 v119, v119, v87
  v_cvt_pk_bf16_f32 v104, 0, v104
  v_cvt_pk_bf16_f32 v105, 0, v105
  v_cvt_pk_bf16_f32 v106, 0, v106
  v_cvt_pk_bf16_f32 v107, 0, v107
  v_cvt_pk_bf16_f32 v108, 0, v108
  v_cvt_pk_bf16_f32 v109, 0, v109
  v_cvt_pk_bf16_f32 v110, 0, v110
  v_cvt_pk_bf16_f32 v111, 0, v111
  v_cvt_pk_bf16_f32 v112, 0, v112
  v_cvt_pk_bf16_f32 v113, 0, v113
  v_cvt_pk_bf16_f32 v114, 0, v114
  v_cvt_pk_bf16_f32 v115, 0, v115
  v_cvt_pk_bf16_f32 v116, 0, v116
  v_cvt_pk_bf16_f32 v117, 0, v117
  v_cvt_pk_bf16_f32 v118, 0, v118
  v_cvt_pk_bf16_f32 v119, 0, v119
  v_add_f32 v8, v104, v105
  v_add_f32 v8, v8, v106
  v_add_f32 v8, v8, v107
  v_add_f32 v8, v8, v108
  v_add_f32 v8, v8, v109
  v_add_f32 v8, v8, v110
  v_add_f32 v8, v8, v111
  s_nop 1
  v_add_f32_dpp v8, v8, v8 row_ror:8 row_mask:0xf bank_mask:0xf
  s_nop 1
  v_add_f32_dpp v8, v8, v8 row_ror:4 row_mask:0xf bank_mask:0xf
  s_nop 1
  v_add_f32_dpp v8, v8, v8 row_ror:2 row_mask:0xf bank_mask:0xf
  s_nop 1
  v_add_f32_dpp v8, v8, v8 row_ror:1 row_mask:0xf bank_mask:0xf
  v_mov_b32 v9, v8
  s_nop 1
  v_permlane16_swap_b32 v9, v8
  v_add_f32 v8, v8, v9
  v_mov_b32 v9, v8
  s_nop 1
  v_permlane32_swap_b32 v9, v8
  v_add_f32 v8, v8, v9
  v_mul_f32 v8, 0x3b000000, v8
  v_sub_f32 v72, v104, v8
  v_sub_f32 v73, v105, v8
  v_sub_f32 v74, v106, v8
  v_sub_f32 v75, v107, v8
  v_sub_f32 v76, v108, v8
  v_sub_f32 v77, v109, v8
  v_sub_f32 v78, v110, v8
  v_sub_f32 v79, v111, v8
  v_mul_f32 v10, v72, v72
  v_fmac_f32 v10, v73, v73
  v_fmac_f32 v10, v74, v74
  v_fmac_f32 v10, v75, v75
  v_fmac_f32 v10, v76, v76
  v_fmac_f32 v10, v77, v77
  v_fmac_f32 v10, v78, v78
  v_fmac_f32 v10, v79, v79
  s_nop 1
  v_add_f32_dpp v10, v10, v10 row_ror:8 row_mask:0xf bank_mask:0xf
  s_nop 1
  v_add_f32_dpp v10, v10, v10 row_ror:4 row_mask:0xf bank_mask:0xf
  s_nop 1
  v_add_f32_dpp v10, v10, v10 row_ror:2 row_mask:0xf bank_mask:0xf
  s_nop 1
  v_add_f32_dpp v10, v10, v10 row_ror:1 row_mask:0xf bank_mask:0xf
  v_mov_b32 v9, v10
  s_nop 1
  v_permlane16_swap_b32 v9, v10
  v_add_f32 v10, v10, v9
  v_mov_b32 v9, v10
  s_nop 1
  v_permlane32_swap_b32 v9, v10
  v_add_f32 v10, v10, v9
  v_mul_f32 v10, 0x3b000000, v10
  v_cvt_pk_bf16_f32 v8, 0, v8
  v_cvt_pk_bf16_f32 v10, 0, v10
  v_add_f32 v10, 0x3727c5ac, v10
  v_cvt_pk_bf16_f32 v10, 0, v10
  v_sqrt_f32 v10, v10
  v_sub_f32 v72, v104, v8
  v_sub_f32 v73, v105, v8
  v_sub_f32 v74, v106, v8
  v_sub_f32 v75, v107, v8
  v_sub_f32 v76, v108, v8
  v_sub_f32 v77, v109, v8
  v_sub_f32 v78, v110, v8
  v_sub_f32 v79, v111, v8
  v_cvt_pk_bf16_f32 v10, 0, v10
  v_cvt_pk_bf16_f32 v72, 0, v72
  v_cvt_pk_bf16_f32 v73, 0, v73
  v_cvt_pk_bf16_f32 v74, 0, v74
  v_cvt_pk_bf16_f32 v75, 0, v75
  v_cvt_pk_bf16_f32 v76, 0, v76
  v_cvt_pk_bf16_f32 v77, 0, v77
  v_cvt_pk_bf16_f32 v78, 0, v78
  v_cvt_pk_bf16_f32 v79, 0, v79
  v_rcp_f32 v10, v10
  s_nop 0
  v_mul_f32 v72, v72, v10
  v_mul_f32 v73, v73, v10
  v_mul_f32 v74, v74, v10
  v_mul_f32 v75, v75, v10
  v_mul_f32 v76, v76, v10
  v_mul_f32 v77, v77, v10
  v_mul_f32 v78, v78, v10
  v_mul_f32 v79, v79, v10
  v_cvt_pk_bf16_f32 v72, 0, v72
  v_cvt_pk_bf16_f32 v73, 0, v73
  v_cvt_pk_bf16_f32 v74, 0, v74
  v_cvt_pk_bf16_f32 v75, 0, v75
  v_cvt_pk_bf16_f32 v76, 0, v76
  v_cvt_pk_bf16_f32 v77, 0, v77
  v_cvt_pk_bf16_f32 v78, 0, v78
  v_cvt_pk_bf16_f32 v79, 0, v79
  v_add_f32 v8, v112, v113
  v_add_f32 v8, v8, v114
  v_add_f32 v8, v8, v115
  v_add_f32 v8, v8, v116
  v_add_f32 v8, v8, v117
  v_add_f32 v8, v8, v118
  v_add_f32 v8, v8, v119
  s_nop 1
  v_add_f32_dpp v8, v8, v8 row_ror:8 row_mask:0xf bank_mask:0xf
  s_nop 1
  v_add_f32_dpp v8, v8, v8 row_ror:4 row_mask:0xf bank_mask:0xf
  s_nop 1
  v_add_f32_dpp v8, v8, v8 row_ror:2 row_mask:0xf bank_mask:0xf
  s_nop 1
  v_add_f32_dpp v8, v8, v8 row_ror:1 row_mask:0xf bank_mask:0xf
  v_mov_b32 v9, v8
  s_nop 1
  v_permlane16_swap_b32 v9, v8
  v_add_f32 v8, v8, v9
  v_mov_b32 v9, v8
  s_nop 1
  v_permlane32_swap_b32 v9, v8
  v_add_f32 v8, v8, v9
  v_mul_f32 v8, 0x3b000000, v8
  v_sub_f32 v80, v112, v8
  v_sub_f32 v81, v113, v8
  v_sub_f32 v82, v114, v8
  v_sub_f32 v83, v115, v8
  v_sub_f32 v84, v116, v8
  v_sub_f32 v85, v117, v8
  v_sub_f32 v86, v118, v8
  v_sub_f32 v87, v119, v8
  v_mul_f32 v10, v80, v80
  v_fmac_f32 v10, v81, v81
  v_fmac_f32 v10, v82, v82
  v_fmac_f32 v10, v83, v83
  v_fmac_f32 v10, v84, v84
  v_fmac_f32 v10, v85, v85
  v_fmac_f32 v10, v86, v86
  v_fmac_f32 v10, v87, v87
  s_nop 1
  v_add_f32_dpp v10, v10, v10 row_ror:8 row_mask:0xf bank_mask:0xf
  s_nop 1
  v_add_f32_dpp v10, v10, v10 row_ror:4 row_mask:0xf bank_mask:0xf
  s_nop 1
  v_add_f32_dpp v10, v10, v10 row_ror:2 row_mask:0xf bank_mask:0xf
  s_nop 1
  v_add_f32_dpp v10, v10, v10 row_ror:1 row_mask:0xf bank_mask:0xf
  v_mov_b32 v9, v10
  s_nop 1
  v_permlane16_swap_b32 v9, v10
  v_add_f32 v10, v10, v9
  v_mov_b32 v9, v10
  s_nop 1
  v_permlane32_swap_b32 v9, v10
  v_add_f32 v10, v10, v9
  v_mul_f32 v10, 0x3b000000, v10
  v_cvt_pk_bf16_f32 v8, 0, v8
  v_cvt_pk_bf16_f32 v10, 0, v10
  v_add_f32 v10, 0x3727c5ac, v10
  v_cvt_pk_bf16_f32 v10, 0, v10
  v_sqrt_f32 v10, v10
  v_sub_f32 v80, v112, v8
  v_sub_f32 v81, v113, v8
  v_sub_f32 v82, v114, v8
  v_sub_f32 v83, v115, v8
  v_sub_f32 v84, v116, v8
  v_sub_f32 v85, v117, v8
  v_sub_f32 v86, v118, v8
  v_sub_f32 v87, v119, v8
  v_cvt_pk_bf16_f32 v10, 0, v10
  v_cvt_pk_bf16_f32 v80, 0, v80
  v_cvt_pk_bf16_f32 v81, 0, v81
  v_cvt_pk_bf16_f32 v82, 0, v82
  v_cvt_pk_bf16_f32 v83, 0, v83
  v_cvt_pk_bf16_f32 v84, 0, v84
  v_cvt_pk_bf16_f32 v85, 0, v85
  v_cvt_pk_bf16_f32 v86, 0, v86
  v_cvt_pk_bf16_f32 v87, 0, v87
  v_rcp_f32 v10, v10
  s_nop 0
  v_mul_f32 v80, v80, v10
  v_mul_f32 v81, v81, v10
  v_mul_f32 v82, v82, v10
  v_mul_f32 v83, v83, v10
  v_mul_f32 v84, v84, v10
  v_mul_f32 v85, v85, v10
  v_mul_f32 v86, v86, v10
  v_mul_f32 v87, v87, v10
  v_cvt_pk_bf16_f32 v80, 0, v80
  v_cvt_pk_bf16_f32 v81, 0, v81
  v_cvt_pk_bf16_f32 v82, 0, v82
  v_cvt_pk_bf16_f32 v83, 0, v83
  v_cvt_pk_bf16_f32 v84, 0, v84
  v_cvt_pk_bf16_f32 v85, 0, v85
  v_cvt_pk_bf16_f32 v86, 0, v86
  v_cvt_pk_bf16_f32 v87, 0, v87
  v_lshrrev_b32 v2, 1, v1
  v_lshlrev_b32 v2, 7, v2
  v_and_b32 v3, 1, v1
  v_lshl_add_u32 v2, v3, 5, v2
  v_add_u32 v2, 20480, v2
  global_load_dwordx4 v[40:43], v2, s[42:43] offset:0 sc1
  global_load_dwordx4 v[44:47], v2, s[42:43] offset:16 sc1
  global_load_dwordx4 v[48:51], v2, s[42:43] offset:64 sc1
  global_load_dwordx4 v[52:55], v2, s[42:43] offset:80 sc1
  s_waitcnt vmcnt(0)
  v_lshlrev_b32 v88, 16, v40
  v_and_b32 v89, s73, v40
  v_lshlrev_b32 v90, 16, v42
  v_and_b32 v91, s73, v42
  v_lshlrev_b32 v92, 16, v44
  v_and_b32 v93, s73, v44
  v_lshlrev_b32 v94, 16, v46
  v_and_b32 v95, s73, v46
  v_lshlrev_b32 v96, 16, v48
  v_and_b32 v97, s73, v48
  v_lshlrev_b32 v98, 16, v50
  v_and_b32 v99, s73, v50
  v_lshlrev_b32 v100, 16, v52
  v_and_b32 v101, s73, v52
  v_lshlrev_b32 v102, 16, v54
  v_and_b32 v103, s73, v54
  v_add_f32 v88, 1.0, v88
  v_add_f32 v89, 1.0, v89
  v_add_f32 v90, 1.0, v90
  v_add_f32 v91, 1.0, v91
  v_add_f32 v92, 1.0, v92
  v_add_f32 v93, 1.0, v93
  v_add_f32 v94, 1.0, v94
  v_add_f32 v95, 1.0, v95
  v_add_f32 v96, 1.0, v96
  v_add_f32 v97, 1.0, v97
  v_add_f32 v98, 1.0, v98
  v_add_f32 v99, 1.0, v99
  v_add_f32 v100, 1.0, v100
  v_add_f32 v101, 1.0, v101
  v_add_f32 v102, 1.0, v102
  v_add_f32 v103, 1.0, v103
  v_cvt_pk_bf16_f32 v88, 0, v88
  v_cvt_pk_bf16_f32 v89, 0, v89
  v_cvt_pk_bf16_f32 v90, 0, v90
  v_cvt_pk_bf16_f32 v91, 0, v91
  v_cvt_pk_bf16_f32 v92, 0, v92
  v_cvt_pk_bf16_f32 v93, 0, v93
  v_cvt_pk_bf16_f32 v94, 0, v94
  v_cvt_pk_bf16_f32 v95, 0, v95
  v_cvt_pk_bf16_f32 v96, 0, v96
  v_cvt_pk_bf16_f32 v97, 0, v97
  v_cvt_pk_bf16_f32 v98, 0, v98
  v_cvt_pk_bf16_f32 v99, 0, v99
  v_cvt_pk_bf16_f32 v100, 0, v100
  v_cvt_pk_bf16_f32 v101, 0, v101
  v_cvt_pk_bf16_f32 v102, 0, v102
  v_cvt_pk_bf16_f32 v103, 0, v103
  v_mul_f32 v72, v72, v88
  v_mul_f32 v73, v73, v89
  v_mul_f32 v74, v74, v90
  v_mul_f32 v75, v75, v91
  v_mul_f32 v76, v76, v92
  v_mul_f32 v77, v77, v93
  v_mul_f32 v78, v78, v94
  v_mul_f32 v79, v79, v95
  v_mul_f32 v80, v80, v96
  v_mul_f32 v81, v81, v97
  v_mul_f32 v82, v82, v98
  v_mul_f32 v83, v83, v99
  v_mul_f32 v84, v84, v100
  v_mul_f32 v85, v85, v101
  v_mul_f32 v86, v86, v102
  v_mul_f32 v87, v87, v103
  v_cvt_pk_bf16_f32 v72, 0, v72
  v_cvt_pk_bf16_f32 v73, 0, v73
  v_cvt_pk_bf16_f32 v74, 0, v74
  v_cvt_pk_bf16_f32 v75, 0, v75
  v_cvt_pk_bf16_f32 v76, 0, v76
  v_cvt_pk_bf16_f32 v77, 0, v77
  v_cvt_pk_bf16_f32 v78, 0, v78
  v_cvt_pk_bf16_f32 v79, 0, v79
  v_cvt_pk_bf16_f32 v80, 0, v80
  v_cvt_pk_bf16_f32 v81, 0, v81
  v_cvt_pk_bf16_f32 v82, 0, v82
  v_cvt_pk_bf16_f32 v83, 0, v83
  v_cvt_pk_bf16_f32 v84, 0, v84
  v_cvt_pk_bf16_f32 v85, 0, v85
  v_cvt_pk_bf16_f32 v86, 0, v86
  v_cvt_pk_bf16_f32 v87, 0, v87
  v_lshrrev_b32 v2, 1, v1
  v_lshlrev_b32 v2, 7, v2
  v_and_b32 v3, 1, v1
  v_lshl_add_u32 v2, v3, 5, v2
  v_add_u32 v2, 16384, v2
  global_load_dwordx4 v[40:43], v2, s[42:43] offset:0 sc1
  global_load_dwordx4 v[44:47], v2, s[42:43] offset:16 sc1
  global_load_dwordx4 v[48:51], v2, s[42:43] offset:64 sc1
  global_load_dwordx4 v[52:55], v2, s[42:43] offset:80 sc1
  s_waitcnt vmcnt(0)
  v_lshlrev_b32 v88, 16, v40
  v_and_b32 v89, s73, v40
  v_lshlrev_b32 v90, 16, v42
  v_and_b32 v91, s73, v42
  v_lshlrev_b32 v92, 16, v44
  v_and_b32 v93, s73, v44
  v_lshlrev_b32 v94, 16, v46
  v_and_b32 v95, s73, v46
  v_lshlrev_b32 v96, 16, v48
  v_and_b32 v97, s73, v48
  v_lshlrev_b32 v98, 16, v50
  v_and_b32 v99, s73, v50
  v_lshlrev_b32 v100, 16, v52
  v_and_b32 v101, s73, v52
  v_lshlrev_b32 v102, 16, v54
  v_and_b32 v103, s73, v54
  v_add_f32 v72, v72, v88
  v_add_f32 v73, v73, v89
  v_add_f32 v74, v74, v90
  v_add_f32 v75, v75, v91
  v_add_f32 v76, v76, v92
  v_add_f32 v77, v77, v93
  v_add_f32 v78, v78, v94
  v_add_f32 v79, v79, v95
  v_add_f32 v80, v80, v96
  v_add_f32 v81, v81, v97
  v_add_f32 v82, v82, v98
  v_add_f32 v83, v83, v99
  v_add_f32 v84, v84, v100
  v_add_f32 v85, v85, v101
  v_add_f32 v86, v86, v102
  v_add_f32 v87, v87, v103
  v_cvt_pk_bf16_f32 v40, v72, v73
  v_cvt_pk_bf16_f32 v41, v74, v75
  v_cvt_pk_bf16_f32 v42, v76, v77
  v_cvt_pk_bf16_f32 v43, v78, v79
  v_cvt_pk_bf16_f32 v44, v80, v81
  v_cvt_pk_bf16_f32 v45, v82, v83
  v_cvt_pk_bf16_f32 v46, v84, v85
  v_cvt_pk_bf16_f32 v47, v86, v87
  v_add_u32 v3, 12288, v0
  ds_write_b128 v3, v[40:43] offset:0
  ds_write_b128 v3, v[44:47] offset:1024
  s_mov_b32 s44, s28
  s_mov_b32 s45, s29
  s_mov_b32 s46, 1409024
  s_mov_b32 s11, 2752
  s_mov_b32 s12, 1409024
  v_mov_b32 v4, 12288
  v_mov_b32 v5, 13312
  v_lshlrev_b32 v2, 4, v1
  s_call_b64 s[62:63], L_gv
  v_cvt_pk_bf16_f32 v120, 0, v72
  v_cvt_pk_bf16_f32 v121, 0, v73
  v_cvt_pk_bf16_f32 v122, 0, v74
  v_cvt_pk_bf16_f32 v123, 0, v75
  v_cvt_pk_bf16_f32 v124, 0, v76
  v_cvt_pk_bf16_f32 v125, 0, v77
  v_cvt_pk_bf16_f32 v126, 0, v78
  v_cvt_pk_bf16_f32 v127, 0, v79
  v_cvt_pk_bf16_f32 v128, 0, v80
  v_cvt_pk_bf16_f32 v129, 0, v81
  v_cvt_pk_bf16_f32 v130, 0, v82
  v_cvt_pk_bf16_f32 v131, 0, v83
  v_cvt_pk_bf16_f32 v132, 0, v84
  v_cvt_pk_bf16_f32 v133, 0, v85
  v_cvt_pk_bf16_f32 v134, 0, v86
  v_cvt_pk_bf16_f32 v135, 0, v87
  s_mov_b32 s44, s30
  s_mov_b32 s45, s31
  s_mov_b32 s46, 1409024
  s_mov_b32 s11, 2752
  s_mov_b32 s12, 1409024
  v_mov_b32 v4, 12288
  v_mov_b32 v5, 13312
  v_lshlrev_b32 v2, 4, v1
  s_call_b64 s[62:63], L_gv
  v_mul_f32 v88, 0xbfb8aa3b, v120
  v_mul_f32 v89, 0xbfb8aa3b, v121
  v_mul_f32 v90, 0xbfb8aa3b, v122
  v_mul_f32 v91, 0xbfb8aa3b, v123
  v_exp_f32 v88, v88
  v_exp_f32 v89, v89
  v_exp_f32 v90, v90
  v_exp_f32 v91, v91
  s_nop 0
  v_add_f32 v88, 1.0, v88
  v_add_f32 v89, 1.0, v89
  v_add_f32 v90, 1.0, v90
  v_add_f32 v91, 1.0, v91
  v_rcp_f32 v88, v88
  v_rcp_f32 v89, v89
  v_rcp_f32 v90, v90
  v_rcp_f32 v91, v91
  s_nop 0
  v_mul_f32 v120, v120, v88
  v_mul_f32 v121, v121, v89
  v_mul_f32 v122, v122, v90
  v_mul_f32 v123, v123, v91
  v_mul_f32 v88, 0xbfb8aa3b, v124
  v_mul_f32 v89, 0xbfb8aa3b, v125
  v_mul_f32 v90, 0xbfb8aa3b, v126
  v_mul_f32 v91, 0xbfb8aa3b, v127
  v_exp_f32 v88, v88
  v_exp_f32 v89, v89
  v_exp_f32 v90, v90
  v_exp_f32 v91, v91
  s_nop 0
  v_add_f32 v88, 1.0, v88
  v_add_f32 v89, 1.0, v89
  v_add_f32 v90, 1.0, v90
  v_add_f32 v91, 1.0, v91
  v_rcp_f32 v88, v88
  v_rcp_f32 v89, v89
  v_rcp_f32 v90, v90
  v_rcp_f32 v91, v91
  s_nop 0
  v_mul_f32 v124, v124, v88
  v_mul_f32 v125, v125, v89
  v_mul_f32 v126, v126, v90
  v_mul_f32 v127, v127, v91
  v_mul_f32 v88, 0xbfb8aa3b, v128
  v_mul_f32 v89, 0xbfb8aa3b, v129
  v_mul_f32 v90, 0xbfb8aa3b, v130
  v_mul_f32 v91, 0xbfb8aa3b, v131
  v_exp_f32 v88, v88
  v_exp_f32 v89, v89
  v_exp_f32 v90, v90
  v_exp_f32 v91, v91
  s_nop 0
  v_add_f32 v88, 1.0, v88
  v_add_f32 v89, 1.0, v89
  v_add_f32 v90, 1.0, v90
  v_add_f32 v91, 1.0, v91
  v_rcp_f32 v88, v88
  v_rcp_f32 v89, v89
  v_rcp_f32 v90, v90
  v_rcp_f32 v91, v91
  s_nop 0
  v_mul_f32 v128, v128, v88
  v_mul_f32 v129, v129, v89
  v_mul_f32 v130, v130, v90
  v_mul_f32 v131, v131, v91
  v_mul_f32 v88, 0xbfb8aa3b, v132
  v_mul_f32 v89, 0xbfb8aa3b, v133
  v_mul_f32 v90, 0xbfb8aa3b, v134
  v_mul_f32 v91, 0xbfb8aa3b, v135
  v_exp_f32 v88, v88
  v_exp_f32 v89, v89
  v_exp_f32 v90, v90
  v_exp_f32 v91, v91
  s_nop 0
  v_add_f32 v88, 1.0, v88
  v_add_f32 v89, 1.0, v89
  v_add_f32 v90, 1.0, v90
  v_add_f32 v91, 1.0, v91
  v_rcp_f32 v88, v88
  v_rcp_f32 v89, v89
  v_rcp_f32 v90, v90
  v_rcp_f32 v91, v91
  s_nop 0
  v_mul_f32 v132, v132, v88
  v_mul_f32 v133, v133, v89
  v_mul_f32 v134, v134, v90
  v_mul_f32 v135, v135, v91
  v_cvt_pk_bf16_f32 v120, 0, v120
  v_cvt_pk_bf16_f32 v121, 0, v121
  v_cvt_pk_bf16_f32 v122, 0, v122
  v_cvt_pk_bf16_f32 v123, 0, v123
  v_cvt_pk_bf16_f32 v124, 0, v124
  v_cvt_pk_bf16_f32 v125, 0, v125
  v_cvt_pk_bf16_f32 v126, 0, v126
  v_cvt_pk_bf16_f32 v127, 0, v127
  v_cvt_pk_bf16_f32 v128, 0, v128
  v_cvt_pk_bf16_f32 v129, 0, v129
  v_cvt_pk_bf16_f32 v130, 0, v130
  v_cvt_pk_bf16_f32 v131, 0, v131
  v_cvt_pk_bf16_f32 v132, 0, v132
  v_cvt_pk_bf16_f32 v133, 0, v133
  v_cvt_pk_bf16_f32 v134, 0, v134
  v_cvt_pk_bf16_f32 v135, 0, v135
  v_cvt_pk_bf16_f32 v72, 0, v72
  v_cvt_pk_bf16_f32 v73, 0, v73
  v_cvt_pk_bf16_f32 v74, 0, v74
  v_cvt_pk_bf16_f32 v75, 0, v75
  v_cvt_pk_bf16_f32 v76, 0, v76
  v_cvt_pk_bf16_f32 v77, 0, v77
  v_cvt_pk_bf16_f32 v78, 0, v78
  v_cvt_pk_bf16_f32 v79, 0, v79
  v_cvt_pk_bf16_f32 v80, 0, v80
  v_cvt_pk_bf16_f32 v81, 0, v81
  v_cvt_pk_bf16_f32 v82, 0, v82
  v_cvt_pk_bf16_f32 v83, 0, v83
  v_cvt_pk_bf16_f32 v84, 0, v84
  v_cvt_pk_bf16_f32 v85, 0, v85
  v_cvt_pk_bf16_f32 v86, 0, v86
  v_cvt_pk_bf16_f32 v87, 0, v87
  v_mul_f32 v72, v72, v120
  v_mul_f32 v73, v73, v121
  v_mul_f32 v74, v74, v122
  v_mul_f32 v75, v75, v123
  v_mul_f32 v76, v76, v124
  v_mul_f32 v77, v77, v125
  v_mul_f32 v78, v78, v126
  v_mul_f32 v79, v79, v127
  v_mul_f32 v80, v80, v128
  v_mul_f32 v81, v81, v129
  v_mul_f32 v82, v82, v130
  v_mul_f32 v83, v83, v131
  v_mul_f32 v84, v84, v132
  v_mul_f32 v85, v85, v133
  v_mul_f32 v86, v86, v134
  v_mul_f32 v87, v87, v135
  v_cvt_pk_bf16_f32 v40, v72, v73
  v_cvt_pk_bf16_f32 v41, v74, v75
  v_cvt_pk_bf16_f32 v42, v76, v77
  v_cvt_pk_bf16_f32 v43, v78, v79
  v_cvt_pk_bf16_f32 v44, v80, v81
  v_cvt_pk_bf16_f32 v45, v82, v83
  v_cvt_pk_bf16_f32 v46, v84, v85
  v_cvt_pk_bf16_f32 v47, v86, v87
  v_add_u32 v3, 14336, v0
  ds_write_b128 v3, v[40:43] offset:0
  ds_write_b128 v3, v[44:47] offset:3072
  s_mov_b32 s44, s28
  s_mov_b32 s45, s29
  s_mov_b32 s46, 1409024
  s_mov_b32 s11, 2752
  s_mov_b32 s12, 1409024
  v_mov_b32 v4, 12288
  v_mov_b32 v5, 13312
  v_lshlrev_b32 v2, 4, v1
  v_add_u32 v2, 1024, v2
  s_call_b64 s[62:63], L_gv
  v_cvt_pk_bf16_f32 v120, 0, v72
  v_cvt_pk_bf16_f32 v121, 0, v73
  v_cvt_pk_bf16_f32 v122, 0, v74
  v_cvt_pk_bf16_f32 v123, 0, v75
  v_cvt_pk_bf16_f32 v124, 0, v76
  v_cvt_pk_bf16_f32 v125, 0, v77
  v_cvt_pk_bf16_f32 v126, 0, v78
  v_cvt_pk_bf16_f32 v127, 0, v79
  v_cvt_pk_bf16_f32 v128, 0, v80
  v_cvt_pk_bf16_f32 v129, 0, v81
  v_cvt_pk_bf16_f32 v130, 0, v82
  v_cvt_pk_bf16_f32 v131, 0, v83
  v_cvt_pk_bf16_f32 v132, 0, v84
  v_cvt_pk_bf16_f32 v133, 0, v85
  v_cvt_pk_bf16_f32 v134, 0, v86
  v_cvt_pk_bf16_f32 v135, 0, v87
  s_mov_b32 s44, s30
  s_mov_b32 s45, s31
  s_mov_b32 s46, 1409024
  s_mov_b32 s11, 2752
  s_mov_b32 s12, 1409024
  v_mov_b32 v4, 12288
  v_mov_b32 v5, 13312
  v_lshlrev_b32 v2, 4, v1
  v_add_u32 v2, 1024, v2
  s_call_b64 s[62:63], L_gv
  v_mul_f32 v88, 0xbfb8aa3b, v120
  v_mul_f32 v89, 0xbfb8aa3b, v121
  v_mul_f32 v90, 0xbfb8aa3b, v122
  v_mul_f32 v91, 0xbfb8aa3b, v123
  v_exp_f32 v88, v88
  v_exp_f32 v89, v89
  v_exp_f32 v90, v90
  v_exp_f32 v91, v91
  s_nop 0
  v_add_f32 v88, 1.0, v88
  v_add_f32 v89, 1.0, v89
  v_add_f32 v90, 1.0, v90
  v_add_f32 v91, 1.0, v91
  v_rcp_f32 v88, v88
  v_rcp_f32 v89, v89
  v_rcp_f32 v90, v90
  v_rcp_f32 v91, v91
  s_nop 0
  v_mul_f32 v120, v120, v88
  v_mul_f32 v121, v121, v89
  v_mul_f32 v122, v122, v90
  v_mul_f32 v123, v123, v91
  v_mul_f32 v88, 0xbfb8aa3b, v124
  v_mul_f32 v89, 0xbfb8aa3b, v125
  v_mul_f32 v90, 0xbfb8aa3b, v126
  v_mul_f32 v91, 0xbfb8aa3b, v127
  v_exp_f32 v88, v88
  v_exp_f32 v89, v89
  v_exp_f32 v90, v90
  v_exp_f32 v91, v91
  s_nop 0
  v_add_f32 v88, 1.0, v88
  v_add_f32 v89, 1.0, v89
  v_add_f32 v90, 1.0, v90
  v_add_f32 v91, 1.0, v91
  v_rcp_f32 v88, v88
  v_rcp_f32 v89, v89
  v_rcp_f32 v90, v90
  v_rcp_f32 v91, v91
  s_nop 0
  v_mul_f32 v124, v124, v88
  v_mul_f32 v125, v125, v89
  v_mul_f32 v126, v126, v90
  v_mul_f32 v127, v127, v91
  v_mul_f32 v88, 0xbfb8aa3b, v128
  v_mul_f32 v89, 0xbfb8aa3b, v129
  v_mul_f32 v90, 0xbfb8aa3b, v130
  v_mul_f32 v91, 0xbfb8aa3b, v131
  v_exp_f32 v88, v88
  v_exp_f32 v89, v89
  v_exp_f32 v90, v90
  v_exp_f32 v91, v91
  s_nop 0
  v_add_f32 v88, 1.0, v88
  v_add_f32 v89, 1.0, v89
  v_add_f32 v90, 1.0, v90
  v_add_f32 v91, 1.0, v91
  v_rcp_f32 v88, v88
  v_rcp_f32 v89, v89
  v_rcp_f32 v90, v90
  v_rcp_f32 v91, v91
  s_nop 0
  v_mul_f32 v128, v128, v88
  v_mul_f32 v129, v129, v89
  v_mul_f32 v130, v130, v90
  v_mul_f32 v131, v131, v91
  v_mul_f32 v88, 0xbfb8aa3b, v132
  v_mul_f32 v89, 0xbfb8aa3b, v133
  v_mul_f32 v90, 0xbfb8aa3b, v134
  v_mul_f32 v91, 0xbfb8aa3b, v135
  v_exp_f32 v88, v88
  v_exp_f32 v89, v89
  v_exp_f32 v90, v90
  v_exp_f32 v91, v91
  s_nop 0
  v_add_f32 v88, 1.0, v88
  v_add_f32 v89, 1.0, v89
  v_add_f32 v90, 1.0, v90
  v_add_f32 v91, 1.0, v91
  v_rcp_f32 v88, v88
  v_rcp_f32 v89, v89
  v_rcp_f32 v90, v90
  v_rcp_f32 v91, v91
  s_nop 0
  v_mul_f32 v132, v132, v88
  v_mul_f32 v133, v133, v89
  v_mul_f32 v134, v134, v90
  v_mul_f32 v135, v135, v91
  v_cvt_pk_bf16_f32 v120, 0, v120
  v_cvt_pk_bf16_f32 v121, 0, v121
  v_cvt_pk_bf16_f32 v122, 0, v122
  v_cvt_pk_bf16_f32 v123, 0, v123
  v_cvt_pk_bf16_f32 v124, 0, v124
  v_cvt_pk_bf16_f32 v125, 0, v125
  v_cvt_pk_bf16_f32 v126, 0, v126
  v_cvt_pk_bf16_f32 v127, 0, v127
  v_cvt_pk_bf16_f32 v128, 0, v128
  v_cvt_pk_bf16_f32 v129, 0, v129
  v_cvt_pk_bf16_f32 v130, 0, v130
  v_cvt_pk_bf16_f32 v131, 0, v131
  v_cvt_pk_bf16_f32 v132, 0, v132
  v_cvt_pk_bf16_f32 v133, 0, v133
  v_cvt_pk_bf16_f32 v134, 0, v134
  v_cvt_pk_bf16_f32 v135, 0, v135
  v_cvt_pk_bf16_f32 v72, 0, v72
  v_cvt_pk_bf16_f32 v73, 0, v73
  v_cvt_pk_bf16_f32 v74, 0, v74
  v_cvt_pk_bf16_f32 v75, 0, v75
  v_cvt_pk_bf16_f32 v76, 0, v76
  v_cvt_pk_bf16_f32 v77, 0, v77
  v_cvt_pk_bf16_f32 v78, 0, v78
  v_cvt_pk_bf16_f32 v79, 0, v79
  v_cvt_pk_bf16_f32 v80, 0, v80
  v_cvt_pk_bf16_f32 v81, 0, v81
  v_cvt_pk_bf16_f32 v82, 0, v82
  v_cvt_pk_bf16_f32 v83, 0, v83
  v_cvt_pk_bf16_f32 v84, 0, v84
  v_cvt_pk_bf16_f32 v85, 0, v85
  v_cvt_pk_bf16_f32 v86, 0, v86
  v_cvt_pk_bf16_f32 v87, 0, v87
  v_mul_f32 v72, v72, v120
  v_mul_f32 v73, v73, v121
  v_mul_f32 v74, v74, v122
  v_mul_f32 v75, v75, v123
  v_mul_f32 v76, v76, v124
  v_mul_f32 v77, v77, v125
  v_mul_f32 v78, v78, v126
  v_mul_f32 v79, v79, v127
  v_mul_f32 v80, v80, v128
  v_mul_f32 v81, v81, v129
  v_mul_f32 v82, v82, v130
  v_mul_f32 v83, v83, v131
  v_mul_f32 v84, v84, v132
  v_mul_f32 v85, v85, v133
  v_mul_f32 v86, v86, v134
  v_mul_f32 v87, v87, v135
  v_cvt_pk_bf16_f32 v40, v72, v73
  v_cvt_pk_bf16_f32 v41, v74, v75
  v_cvt_pk_bf16_f32 v42, v76, v77
  v_cvt_pk_bf16_f32 v43, v78, v79
  v_cvt_pk_bf16_f32 v44, v80, v81
  v_cvt_pk_bf16_f32 v45, v82, v83
  v_cvt_pk_bf16_f32 v46, v84, v85
  v_cvt_pk_bf16_f32 v47, v86, v87
  v_add_u32 v3, 15360, v0
  ds_write_b128 v3, v[40:43] offset:0
  ds_write_b128 v3, v[44:47] offset:3072
  s_mov_b32 s44, s28
  s_mov_b32 s45, s29
  s_mov_b32 s46, 1409024
  s_mov_b32 s11, 2752
  s_mov_b32 s12, 1409024
  v_mov_b32 v4, 12288
  v_mov_b32 v5, 13312
  v_lshlrev_b32 v2, 4, v1
  v_add_u32 v2, 2048, v2
  s_call_b64 s[62:63], L_gv
  v_cvt_pk_bf16_f32 v120, 0, v72
  v_cvt_pk_bf16_f32 v121, 0, v73
  v_cvt_pk_bf16_f32 v122, 0, v74
  v_cvt_pk_bf16_f32 v123, 0, v75
  v_cvt_pk_bf16_f32 v124, 0, v76
  v_cvt_pk_bf16_f32 v125, 0, v77
  v_cvt_pk_bf16_f32 v126, 0, v78
  v_cvt_pk_bf16_f32 v127, 0, v79
  v_cvt_pk_bf16_f32 v128, 0, v80
  v_cvt_pk_bf16_f32 v129, 0, v81
  v_cvt_pk_bf16_f32 v130, 0, v82
  v_cvt_pk_bf16_f32 v131, 0, v83
  v_cvt_pk_bf16_f32 v132, 0, v84
  v_cvt_pk_bf16_f32 v133, 0, v85
  v_cvt_pk_bf16_f32 v134, 0, v86
  v_cvt_pk_bf16_f32 v135, 0, v87
  s_mov_b32 s44, s30
  s_mov_b32 s45, s31
  s_mov_b32 s46, 1409024
  s_mov_b32 s11, 2752
  s_mov_b32 s12, 1409024
  v_mov_b32 v4, 12288
  v_mov_b32 v5, 13312
  v_lshlrev_b32 v2, 4, v1
  v_add_u32 v2, 2048, v2
  s_call_b64 s[62:63], L_gv
  v_mul_f32 v88, 0xbfb8aa3b, v120
  v_mul_f32 v89, 0xbfb8aa3b, v121
  v_mul_f32 v90, 0xbfb8aa3b, v122
  v_mul_f32 v91, 0xbfb8aa3b, v123
  v_exp_f32 v88, v88
  v_exp_f32 v89, v89
  v_exp_f32 v90, v90
  v_exp_f32 v91, v91
  s_nop 0
  v_add_f32 v88, 1.0, v88
  v_add_f32 v89, 1.0, v89
  v_add_f32 v90, 1.0, v90
  v_add_f32 v91, 1.0, v91
  v_rcp_f32 v88, v88
  v_rcp_f32 v89, v89
  v_rcp_f32 v90, v90
  v_rcp_f32 v91, v91
  s_nop 0
  v_mul_f32 v120, v120, v88
  v_mul_f32 v121, v121, v89
  v_mul_f32 v122, v122, v90
  v_mul_f32 v123, v123, v91
  v_mul_f32 v88, 0xbfb8aa3b, v124
  v_mul_f32 v89, 0xbfb8aa3b, v125
  v_mul_f32 v90, 0xbfb8aa3b, v126
  v_mul_f32 v91, 0xbfb8aa3b, v127
  v_exp_f32 v88, v88
  v_exp_f32 v89, v89
  v_exp_f32 v90, v90
  v_exp_f32 v91, v91
  s_nop 0
  v_add_f32 v88, 1.0, v88
  v_add_f32 v89, 1.0, v89
  v_add_f32 v90, 1.0, v90
  v_add_f32 v91, 1.0, v91
  v_rcp_f32 v88, v88
  v_rcp_f32 v89, v89
  v_rcp_f32 v90, v90
  v_rcp_f32 v91, v91
  s_nop 0
  v_mul_f32 v124, v124, v88
  v_mul_f32 v125, v125, v89
  v_mul_f32 v126, v126, v90
  v_mul_f32 v127, v127, v91
  v_mul_f32 v88, 0xbfb8aa3b, v128
  v_mul_f32 v89, 0xbfb8aa3b, v129
  v_mul_f32 v90, 0xbfb8aa3b, v130
  v_mul_f32 v91, 0xbfb8aa3b, v131
  v_exp_f32 v88, v88
  v_exp_f32 v89, v89
  v_exp_f32 v90, v90
  v_exp_f32 v91, v91
  s_nop 0
  v_add_f32 v88, 1.0, v88
  v_add_f32 v89, 1.0, v89
  v_add_f32 v90, 1.0, v90
  v_add_f32 v91, 1.0, v91
  v_rcp_f32 v88, v88
  v_rcp_f32 v89, v89
  v_rcp_f32 v90, v90
  v_rcp_f32 v91, v91
  s_nop 0
  v_mul_f32 v128, v128, v88
  v_mul_f32 v129, v129, v89
  v_mul_f32 v130, v130, v90
  v_mul_f32 v131, v131, v91
  v_mul_f32 v88, 0xbfb8aa3b, v132
  v_mul_f32 v89, 0xbfb8aa3b, v133
  v_mul_f32 v90, 0xbfb8aa3b, v134
  v_mul_f32 v91, 0xbfb8aa3b, v135
  v_exp_f32 v88, v88
  v_exp_f32 v89, v89
  v_exp_f32 v90, v90
  v_exp_f32 v91, v91
  s_nop 0
  v_add_f32 v88, 1.0, v88
  v_add_f32 v89, 1.0, v89
  v_add_f32 v90, 1.0, v90
  v_add_f32 v91, 1.0, v91
  v_rcp_f32 v88, v88
  v_rcp_f32 v89, v89
  v_rcp_f32 v90, v90
  v_rcp_f32 v91, v91
  s_nop 0
  v_mul_f32 v132, v132, v88
  v_mul_f32 v133, v133, v89
  v_mul_f32 v134, v134, v90
  v_mul_f32 v135, v135, v91
  v_cvt_pk_bf16_f32 v120, 0, v120
  v_cvt_pk_bf16_f32 v121, 0, v121
  v_cvt_pk_bf16_f32 v122, 0, v122
  v_cvt_pk_bf16_f32 v123, 0, v123
  v_cvt_pk_bf16_f32 v124, 0, v124
  v_cvt_pk_bf16_f32 v125, 0, v125
  v_cvt_pk_bf16_f32 v126, 0, v126
  v_cvt_pk_bf16_f32 v127, 0, v127
  v_cvt_pk_bf16_f32 v128, 0, v128
  v_cvt_pk_bf16_f32 v129, 0, v129
  v_cvt_pk_bf16_f32 v130, 0, v130
  v_cvt_pk_bf16_f32 v131, 0, v131
  v_cvt_pk_bf16_f32 v132, 0, v132
  v_cvt_pk_bf16_f32 v133, 0, v133
  v_cvt_pk_bf16_f32 v134, 0, v134
  v_cvt_pk_bf16_f32 v135, 0, v135
  v_cvt_pk_bf16_f32 v72, 0, v72
  v_cvt_pk_bf16_f32 v73, 0, v73
  v_cvt_pk_bf16_f32 v74, 0, v74
  v_cvt_pk_bf16_f32 v75, 0, v75
  v_cvt_pk_bf16_f32 v76, 0, v76
  v_cvt_pk_bf16_f32 v77, 0, v77
  v_cvt_pk_bf16_f32 v78, 0, v78
  v_cvt_pk_bf16_f32 v79, 0, v79
  v_cvt_pk_bf16_f32 v80, 0, v80
  v_cvt_pk_bf16_f32 v81, 0, v81
  v_cvt_pk_bf16_f32 v82, 0, v82
  v_cvt_pk_bf16_f32 v83, 0, v83
  v_cvt_pk_bf16_f32 v84, 0, v84
  v_cvt_pk_bf16_f32 v85, 0, v85
  v_cvt_pk_bf16_f32 v86, 0, v86
  v_cvt_pk_bf16_f32 v87, 0, v87
  v_mul_f32 v72, v72, v120
  v_mul_f32 v73, v73, v121
  v_mul_f32 v74, v74, v122
  v_mul_f32 v75, v75, v123
  v_mul_f32 v76, v76, v124
  v_mul_f32 v77, v77, v125
  v_mul_f32 v78, v78, v126
  v_mul_f32 v79, v79, v127
  v_mul_f32 v80, v80, v128
  v_mul_f32 v81, v81, v129
  v_mul_f32 v82, v82, v130
  v_mul_f32 v83, v83, v131
  v_mul_f32 v84, v84, v132
  v_mul_f32 v85, v85, v133
  v_mul_f32 v86, v86, v134
  v_mul_f32 v87, v87, v135
  v_cvt_pk_bf16_f32 v40, v72, v73
  v_cvt_pk_bf16_f32 v41, v74, v75
  v_cvt_pk_bf16_f32 v42, v76, v77
  v_cvt_pk_bf16_f32 v43, v78, v79
  v_cvt_pk_bf16_f32 v44, v80, v81
  v_cvt_pk_bf16_f32 v45, v82, v83
  v_cvt_pk_bf16_f32 v46, v84, v85
  v_cvt_pk_bf16_f32 v47, v86, v87
  v_add_u32 v3, 16384, v0
  ds_write_b128 v3, v[40:43] offset:0
  ds_write_b128 v3, v[44:47] offset:3072
  s_mov_b32 s44, s32
  s_mov_b32 s45, s33
  s_mov_b32 s46, 1409024
  s_mov_b32 s11, 1024
  s_mov_b32 s12, 1409024
  v_mov_b32 v4, 14336
  v_mov_b32 v5, 17408
  v_lshlrev_b32 v2, 4, v1
  s_call_b64 s[62:63], L_gv
  v_lshrrev_b32 v2, 1, v1
  v_lshlrev_b32 v2, 7, v2
  v_and_b32 v3, 1, v1
  v_lshl_add_u32 v2, v3, 5, v2
  v_add_u32 v2, 24576, v2
  global_load_dwordx4 v[40:43], v2, s[42:43] offset:0 sc1
  global_load_dwordx4 v[44:47], v2, s[42:43] offset:16 sc1
  global_load_dwordx4 v[48:51], v2, s[42:43] offset:64 sc1
  global_load_dwordx4 v[52:55], v2, s[42:43] offset:80 sc1
  s_waitcnt vmcnt(0)
  v_lshlrev_b32 v88, 16, v40
  v_and_b32 v89, s73, v40
  v_lshlrev_b32 v90, 16, v42
  v_and_b32 v91, s73, v42
  v_lshlrev_b32 v92, 16, v44
  v_and_b32 v93, s73, v44
  v_lshlrev_b32 v94, 16, v46
  v_and_b32 v95, s73, v46
  v_lshlrev_b32 v96, 16, v48
  v_and_b32 v97, s73, v48
  v_lshlrev_b32 v98, 16, v50
  v_and_b32 v99, s73, v50
  v_lshlrev_b32 v100, 16, v52
  v_and_b32 v101, s73, v52
  v_lshlrev_b32 v102, 16, v54
  v_and_b32 v103, s73, v54
  v_cvt_pk_bf16_f32 v72, 0, v72
  v_cvt_pk_bf16_f32 v73, 0, v73
  v_cvt_pk_bf16_f32 v74, 0, v74
  v_cvt_pk_bf16_f32 v75, 0, v75
  v_cvt_pk_bf16_f32 v76, 0, v76
  v_cvt_pk_bf16_f32 v77, 0, v77
  v_cvt_pk_bf16_f32 v78, 0, v78
  v_cvt_pk_bf16_f32 v79, 0, v79
  v_cvt_pk_bf16_f32 v80, 0, v80
  v_cvt_pk_bf16_f32 v81, 0, v81
  v_cvt_pk_bf16_f32 v82, 0, v82
  v_cvt_pk_bf16_f32 v83, 0, v83
  v_cvt_pk_bf16_f32 v84, 0, v84
  v_cvt_pk_bf16_f32 v85, 0, v85
  v_cvt_pk_bf16_f32 v86, 0, v86
  v_cvt_pk_bf16_f32 v87, 0, v87
  v_mul_f32 v72, v72, v88
  v_mul_f32 v73, v73, v89
  v_mul_f32 v74, v74, v90
  v_mul_f32 v75, v75, v91
  v_mul_f32 v76, v76, v92
  v_mul_f32 v77, v77, v93
  v_mul_f32 v78, v78, v94
  v_mul_f32 v79, v79, v95
  v_mul_f32 v80, v80, v96
  v_mul_f32 v81, v81, v97
  v_mul_f32 v82, v82, v98
  v_mul_f32 v83, v83, v99
  v_mul_f32 v84, v84, v100
  v_mul_f32 v85, v85, v101
  v_mul_f32 v86, v86, v102
  v_mul_f32 v87, v87, v103
  v_cvt_pk_bf16_f32 v72, 0, v72
  v_cvt_pk_bf16_f32 v73, 0, v73
  v_cvt_pk_bf16_f32 v74, 0, v74
  v_cvt_pk_bf16_f32 v75, 0, v75
  v_cvt_pk_bf16_f32 v76, 0, v76
  v_cvt_pk_bf16_f32 v77, 0, v77
  v_cvt_pk_bf16_f32 v78, 0, v78
  v_cvt_pk_bf16_f32 v79, 0, v79
  v_cvt_pk_bf16_f32 v80, 0, v80
  v_cvt_pk_bf16_f32 v81, 0, v81
  v_cvt_pk_bf16_f32 v82, 0, v82
  v_cvt_pk_bf16_f32 v83, 0, v83
  v_cvt_pk_bf16_f32 v84, 0, v84
  v_cvt_pk_bf16_f32 v85, 0, v85
  v_cvt_pk_bf16_f32 v86, 0, v86
  v_cvt_pk_bf16_f32 v87, 0, v87
  v_add_f32 v104, v104, v72
  v_add_f32 v105, v105, v73
  v_add_f32 v106, v106, v74
  v_add_f32 v107, v107, v75
  v_add_f32 v108, v108, v76
  v_add_f32 v109, v109, v77
  v_add_f32 v110, v110, v78
  v_add_f32 v111, v111, v79
  v_add_f32 v112, v112, v80
  v_add_f32 v113, v113, v81
  v_add_f32 v114, v114, v82
  v_add_f32 v115, v115, v83
  v_add_f32 v116, v116, v84
  v_add_f32 v117, v117, v85
  v_add_f32 v118, v118, v86
  v_add_f32 v119, v119, v87
  v_cvt_pk_bf16_f32 v104, 0, v104
  v_cvt_pk_bf16_f32 v105, 0, v105
  v_cvt_pk_bf16_f32 v106, 0, v106
  v_cvt_pk_bf16_f32 v107, 0, v107
  v_cvt_pk_bf16_f32 v108, 0, v108
  v_cvt_pk_bf16_f32 v109, 0, v109
  v_cvt_pk_bf16_f32 v110, 0, v110
  v_cvt_pk_bf16_f32 v111, 0, v111
  v_cvt_pk_bf16_f32 v112, 0, v112
  v_cvt_pk_bf16_f32 v113, 0, v113
  v_cvt_pk_bf16_f32 v114, 0, v114
  v_cvt_pk_bf16_f32 v115, 0, v115
  v_cvt_pk_bf16_f32 v116, 0, v116
  v_cvt_pk_bf16_f32 v117, 0, v117
  v_cvt_pk_bf16_f32 v118, 0, v118
  v_cvt_pk_bf16_f32 v119, 0, v119
  v_cvt_pk_bf16_f32 v40, v104, v105
  v_cvt_pk_bf16_f32 v41, v106, v107
  v_cvt_pk_bf16_f32 v42, v108, v109
  v_cvt_pk_bf16_f32 v43, v110, v111
  v_cvt_pk_bf16_f32 v44, v112, v113
  v_cvt_pk_bf16_f32 v45, v114, v115
  v_cvt_pk_bf16_f32 v46, v116, v117
  v_cvt_pk_bf16_f32 v47, v118, v119
  global_store_dwordx4 v0, v[40:43], s[38:39] offset:0 sc1
  global_store_dwordx4 v0, v[44:47], s[38:39] offset:1024 sc1
  s_endpgm
L_gv:
  v_mov_b32 v72, 0
  v_mov_b32 v73, 0
  v_mov_b32 v74, 0
  v_mov_b32 v75, 0
  v_mov_b32 v76, 0
  v_mov_b32 v77, 0
  v_mov_b32 v78, 0
  v_mov_b32 v79, 0
  v_mov_b32 v80, 0
  v_mov_b32 v81, 0
  v_mov_b32 v82, 0
  v_mov_b32 v83, 0
  v_mov_b32 v84, 0
  v_mov_b32 v85, 0
  v_mov_b32 v86, 0
  v_mov_b32 v87, 0
  s_mov_b32 s10, 0
L_gvl:
  buffer_load_dwordx4 v[40:43], v2, s[44:47], s10 offen
  s_add_u32 s10, s10, s11
  buffer_load_dwordx4 v[44:47], v2, s[44:47], s10 offen
  s_add_u32 s10, s10, s11
  buffer_load_dwordx4 v[48:51], v2, s[44:47], s10 offen
  s_add_u32 s10, s10, s11
  buffer_load_dwordx4 v[52:55], v2, s[44:47], s10 offen
  s_add_u32 s10, s10, s11
  buffer_load_dwordx4 v[56:59], v2, s[44:47], s10 offen
  s_add_u32 s10, s10, s11
  buffer_load_dwordx4 v[60:63], v2, s[44:47], s10 offen
  s_add_u32 s10, s10, s11
  buffer_load_dwordx4 v[64:67], v2, s[44:47], s10 offen
  s_add_u32 s10, s10, s11
  buffer_load_dwordx4 v[68:71], v2, s[44:47], s10 offen
  s_add_u32 s10, s10, s11
  ds_read_b128 v[88:91], v4
  ds_read_b128 v[92:95], v5
  v_add_u32 v4, 16, v4
  v_add_u32 v5, 16, v5
  s_waitcnt lgkmcnt(0)
  v_and_b32 v8, 0xffff, v88
  v_lshlrev_b32 v9, 16, v88
  v_and_b32 v10, 0xffff, v92
  v_lshlrev_b32 v11, 16, v92
  s_waitcnt vmcnt(7)
  v_dot2c_f32_bf16 v72, v8, v40
  v_dot2c_f32_bf16 v73, v9, v40
  v_dot2c_f32_bf16 v74, v8, v41
  v_dot2c_f32_bf16 v75, v9, v41
  v_dot2c_f32_bf16 v76, v8, v42
  v_dot2c_f32_bf16 v77, v9, v42
  v_dot2c_f32_bf16 v78, v8, v43
  v_dot2c_f32_bf16 v79, v9, v43
  v_dot2c_f32_bf16 v80, v10, v40
  v_dot2c_f32_bf16 v81, v11, v40
  v_dot2c_f32_bf16 v82, v10, v41
  v_dot2c_f32_bf16 v83, v11, v41
  v_dot2c_f32_bf16 v84, v10, v42
  v_dot2c_f32_bf16 v85, v11, v42
  v_dot2c_f32_bf16 v86, v10, v43
  v_dot2c_f32_bf16 v87, v11, v43
  v_lshrrev_b32 v8, 16, v88
  v_and_b32 v9, s73, v88
  v_lshrrev_b32 v10, 16, v92
  v_and_b32 v11, s73, v92
  s_waitcnt vmcnt(6)
  v_dot2c_f32_bf16 v72, v8, v44
  v_dot2c_f32_bf16 v73, v9, v44
  v_dot2c_f32_bf16 v74, v8, v45
  v_dot2c_f32_bf16 v75, v9, v45
  v_dot2c_f32_bf16 v76, v8, v46
  v_dot2c_f32_bf16 v77, v9, v46
  v_dot2c_f32_bf16 v78, v8, v47
  v_dot2c_f32_bf16 v79, v9, v47
  v_dot2c_f32_bf16 v80, v10, v44
  v_dot2c_f32_bf16 v81, v11, v44
  v_dot2c_f32_bf16 v82, v10, v45
  v_dot2c_f32_bf16 v83, v11, v45
  v_dot2c_f32_bf16 v84, v10, v46
  v_dot2c_f32_bf16 v85, v11, v46
  v_dot2c_f32_bf16 v86, v10, v47
  v_dot2c_f32_bf16 v87, v11, v47
  v_and_b32 v8, 0xffff, v89
  v_lshlrev_b32 v9, 16, v89
  v_and_b32 v10, 0xffff, v93
  v_lshlrev_b32 v11, 16, v93
  s_waitcnt vmcnt(5)
  v_dot2c_f32_bf16 v72, v8, v48
  v_dot2c_f32_bf16 v73, v9, v48
  v_dot2c_f32_bf16 v74, v8, v49
  v_dot2c_f32_bf16 v75, v9, v49
  v_dot2c_f32_bf16 v76, v8, v50
  v_dot2c_f32_bf16 v77, v9, v50
  v_dot2c_f32_bf16 v78, v8, v51
  v_dot2c_f32_bf16 v79, v9, v51
  v_dot2c_f32_bf16 v80, v10, v48
  v_dot2c_f32_bf16 v81, v11, v48
  v_dot2c_f32_bf16 v82, v10, v49
  v_dot2c_f32_bf16 v83, v11, v49
  v_dot2c_f32_bf16 v84, v10, v50
  v_dot2c_f32_bf16 v85, v11, v50
  v_dot2c_f32_bf16 v86, v10, v51
  v_dot2c_f32_bf16 v87, v11, v51
  v_lshrrev_b32 v8, 16, v89
  v_and_b32 v9, s73, v89
  v_lshrrev_b32 v10, 16, v93
  v_and_b32 v11, s73, v93
  s_waitcnt vmcnt(4)
  v_dot2c_f32_bf16 v72, v8, v52
  v_dot2c_f32_bf16 v73, v9, v52
  v_dot2c_f32_bf16 v74, v8, v53
  v_dot2c_f32_bf16 v75, v9, v53
  v_dot2c_f32_bf16 v76, v8, v54
  v_dot2c_f32_bf16 v77, v9, v54
  v_dot2c_f32_bf16 v78, v8, v55
  v_dot2c_f32_bf16 v79, v9, v55
  v_dot2c_f32_bf16 v80, v10, v52
  v_dot2c_f32_bf16 v81, v11, v52
  v_dot2c_f32_bf16 v82, v10, v53
  v_dot2c_f32_bf16 v83, v11, v53
  v_dot2c_f32_bf16 v84, v10, v54
  v_dot2c_f32_bf16 v85, v11, v54
  v_dot2c_f32_bf16 v86, v10, v55
  v_dot2c_f32_bf16 v87, v11, v55
  v_and_b32 v8, 0xffff, v90
  v_lshlrev_b32 v9, 16, v90
  v_and_b32 v10, 0xffff, v94
  v_lshlrev_b32 v11, 16, v94
  s_waitcnt vmcnt(3)
  v_dot2c_f32_bf16 v72, v8, v56
  v_dot2c_f32_bf16 v73, v9, v56
  v_dot2c_f32_bf16 v74, v8, v57
  v_dot2c_f32_bf16 v75, v9, v57
  v_dot2c_f32_bf16 v76, v8, v58
  v_dot2c_f32_bf16 v77, v9, v58
  v_dot2c_f32_bf16 v78, v8, v59
  v_dot2c_f32_bf16 v79, v9, v59
  v_dot2c_f32_bf16 v80, v10, v56
  v_dot2c_f32_bf16 v81, v11, v56
  v_dot2c_f32_bf16 v82, v10, v57
  v_dot2c_f32_bf16 v83, v11, v57
  v_dot2c_f32_bf16 v84, v10, v58
  v_dot2c_f32_bf16 v85, v11, v58
  v_dot2c_f32_bf16 v86, v10, v59
  v_dot2c_f32_bf16 v87, v11, v59
  v_lshrrev_b32 v8, 16, v90
  v_and_b32 v9, s73, v90
  v_lshrrev_b32 v10, 16, v94
  v_and_b32 v11, s73, v94
  s_waitcnt vmcnt(2)
  v_dot2c_f32_bf16 v72, v8, v60
  v_dot2c_f32_bf16 v73, v9, v60
  v_dot2c_f32_bf16 v74, v8, v61
  v_dot2c_f32_bf16 v75, v9, v61
  v_dot2c_f32_bf16 v76, v8, v62
  v_dot2c_f32_bf16 v77, v9, v62
  v_dot2c_f32_bf16 v78, v8, v63
  v_dot2c_f32_bf16 v79, v9, v63
  v_dot2c_f32_bf16 v80, v10, v60
  v_dot2c_f32_bf16 v81, v11, v60
  v_dot2c_f32_bf16 v82, v10, v61
  v_dot2c_f32_bf16 v83, v11, v61
  v_dot2c_f32_bf16 v84, v10, v62
  v_dot2c_f32_bf16 v85, v11, v62
  v_dot2c_f32_bf16 v86, v10, v63
  v_dot2c_f32_bf16 v87, v11, v63
  v_and_b32 v8, 0xffff, v91
  v_lshlrev_b32 v9, 16, v91
  v_and_b32 v10, 0xffff, v95
  v_lshlrev_b32 v11, 16, v95
  s_waitcnt vmcnt(1)
  v_dot2c_f32_bf16 v72, v8, v64
  v_dot2c_f32_bf16 v73, v9, v64
  v_dot2c_f32_bf16 v74, v8, v65
  v_dot2c_f32_bf16 v75, v9, v65
  v_dot2c_f32_bf16 v76, v8, v66
  v_dot2c_f32_bf16 v77, v9, v66
  v_dot2c_f32_bf16 v78, v8, v67
  v_dot2c_f32_bf16 v79, v9, v67
  v_dot2c_f32_bf16 v80, v10, v64
  v_dot2c_f32_bf16 v81, v11, v64
  v_dot2c_f32_bf16 v82, v10, v65
  v_dot2c_f32_bf16 v83, v11, v65
  v_dot2c_f32_bf16 v84, v10, v66
  v_dot2c_f32_bf16 v85, v11, v66
  v_dot2c_f32_bf16 v86, v10, v67
  v_dot2c_f32_bf16 v87, v11, v67
  v_lshrrev_b32 v8, 16, v91
  v_and_b32 v9, s73, v91
  v_lshrrev_b32 v10, 16, v95
  v_and_b32 v11, s73, v95
  s_waitcnt vmcnt(0)
  v_dot2c_f32_bf16 v72, v8, v68
  v_dot2c_f32_bf16 v73, v9, v68
  v_dot2c_f32_bf16 v74, v8, v69
  v_dot2c_f32_bf16 v75, v9, v69
  v_dot2c_f32_bf16 v76, v8, v70
  v_dot2c_f32_bf16 v77, v9, v70
  v_dot2c_f32_bf16 v78, v8, v71
  v_dot2c_f32_bf16 v79, v9, v71
  v_dot2c_f32_bf16 v80, v10, v68
  v_dot2c_f32_bf16 v81, v11, v68
  v_dot2c_f32_bf16 v82, v10, v69
  v_dot2c_f32_bf16 v83, v11, v69
  v_dot2c_f32_bf16 v84, v10, v70
  v_dot2c_f32_bf16 v85, v11, v70
  v_dot2c_f32_bf16 v86, v10, v71
  v_dot2c_f32_bf16 v87, v11, v71
  s_cmp_lt_u32 s10, s12
  s_cbranch_scc1 L_gvl
  s_nop 1
  s_setpc_b64 s[62:63]
L_serv:
  s_load_dwordx8 s[24:31], s[0:1], 32
  s_load_dwordx8 s[32:39], s[0:1], 64
  s_load_dwordx4 s[40:43], s[0:1], 96
  s_mov_b32 s72, 0xfffffffe
  s_mov_b32 s73, 0xffff0000
  s_cmp_ge_u32 s13, 4
  s_cbranch_scc1 L_team
  s_cmp_lt_u32 s13, 2
  s_cbranch_scc1 L_sv1
  s_getpc_b64 s[56:57]
L_pcc:
  s_sub_u32 s56, s56, L_pcc-adaLN_cond__sliding_block_cached__glu_gated_swiglu__decode_kernel
  s_subb_u32 s57, s57, 0
  s_lshr_b32 s3, s2, 5
  s_lshl1_add_u32 s3, s3, s13
  s_sub_u32 s3, s3, 2
  s_lshl_b32 s3, s3, 12
  v_lshl_add_u32 v2, v1, 6, s3
  v_min_u32 v2, L_end-adaLN_cond__sliding_block_cached__glu_gated_swiglu__decode_kernel, v2
  global_load_dword v3, v2, s[56:57]
  s_endpgm
L_sv1:
  v_mov_b32 v38, 0
  v_mov_b32 v4, -1
  v_mov_b32 v5, 0
  v_mov_b32 v6, 0
  v_mov_b32 v7, 0
  ds_write_b128 v38, v[4:7] offset:256
  ds_write_b64 v38, v[6:7] offset:312
  s_getreg_b32 s76, hwreg(HW_REG_XCC_ID, 0, 4)
  s_waitcnt lgkmcnt(0)
  s_load_dword s74, s[42:43], 0
  s_getpc_b64 s[56:57]
L_pc_30:
  s_lshr_b32 s3, s2, 5
  s_lshl3_add_u32 s3, s3, s8
  s_lshl_b32 s3, s3, 2
  s_add_u32 s3, s3, L_table-L_pc_30
  s_load_dword s14, s[56:57], s3
  s_barrier
  s_waitcnt lgkmcnt(0)
  s_mul_i32 s74, s74, 0x9e3779b1
  s_add_u32 s74, s74, 0x7f4a7c15
  s_bfe_u32 s32, s74, 0x80000
  s_bfe_u32 s33, s74, 0x80008
  s_bfe_u32 s34, s74, 0x80010
  s_bfe_u32 s35, s74, 0x80018
  s_cmp_eq_u32 s13, 0
  s_cbranch_scc1 L_sv0
  s_bfe_u32 s61, s14, 0x80010
  s_cmp_ge_u32 s61, 32
  s_cbranch_scc1 L_fin
  s_mov_b32 s70, 0
L_pl_31:
  ds_read_b32 v8, v38 offset:256
  s_waitcnt lgkmcnt(0)
  v_cmp_eq_u32 vcc, -1, v8
  s_cmp_eq_u64 vcc, 0
  s_cbranch_scc1 L_pld_32
  s_sleep 16
  s_add_u32 s70, s70, 1
  s_cmp_lt_u32 s70, 1048576
  s_cbranch_scc1 L_pl_31
L_pld_32:
  s_branch L_r_f2
L_sv0:
  s_lshr_b32 s49, s2, 5
  s_lshl3_add_u32 s50, s8, s49
  s_lshl_b32 s50, s50, 8
  s_add_u32 s50, s50, 32768
  v_and_b32 v10, 1, v1
  v_lshl_add_u32 v10, v10, 7, s50
  v_bfe_u32 v11, v1, 1, 1
  v_lshl_add_u32 v10, v11, 14, v10
  s_mov_b64 exec, 15
  global_load_dword v166, v10, s[42:43] sc1
  s_mov_b64 exec, -1
  s_cmp_ge_u32 s49, 2
  s_cbranch_scc1 L_sv0b
  s_lshl1_add_u32 s50, s8, s49
  s_lshl_b32 s50, s50, 9
  s_add_u32 s50, s50, 917504
  v_and_b32 v10, 3, v1
  v_lshl_add_u32 v10, v10, 7, s50
  v_bfe_u32 v11, v1, 2, 3
  v_lshl_add_u32 v10, v11, 13, v10
  s_mov_b32 exec_hi, 0
  global_load_dword v166, v10, s[42:43] sc1
  s_mov_b64 exec, -1
L_sv0b:
  s_add_u32 s76, s76, s74
  s_lshr_b32 s49, s2, 5
  s_lshl_b32 s50, s8, 5
  s_add_u32 s49, s49, s50
  s_lshl_b32 s49, s49, 2
  v_mov_b32 v8, s49
  v_mov_b32 v9, s76
  s_mov_b64 exec, 1
  global_store_dword v8, v9, s[42:43] offset:1024 sc1
  s_mov_b64 exec, -1
  s_lshl_b32 s54, s6, 9
  s_add_u32 s54, s54, 0
  s_lshl_b32 s55, s6, 9
  s_add_u32 s55, s55, 128
  s_lshl_b32 s56, s6, 9
  s_add_u32 s56, s56, 256
  s_mov_b32 s70, 0
L_sn_33:
  ds_read_b32 v8, v38 offset:312
  s_waitcnt lgkmcnt(0)
  v_cmp_gt_u32 vcc, 0x8, v8
  s_cmp_eq_u64 vcc, 0
  s_cbranch_scc1 L_snd_34
  s_sleep 16
  s_add_u32 s70, s70, 1
  s_cmp_lt_u32 s70, 2097152
  s_cbranch_scc1 L_sn_33
L_snd_34:
  s_load_dwordx2 s[20:21], s[42:43], s54 offset:65536 glc
  s_mov_b32 s70, 0
  s_branch L_s3wc
L_s3w:
  s_load_dwordx2 s[20:21], s[42:43], s54 offset:65536 glc
L_s3wc:
  s_waitcnt lgkmcnt(0)
  s_xor_b32 s68, s21, s74
  s_cbranch_scc0 L_s3wd
  s_sleep 8
  s_add_u32 s70, s70, 1
  s_cmp_lt_u32 s70, 262144
  s_cbranch_scc1 L_s3w
L_s3wd:
  v_mov_b32 v8, 1
  ds_write_b32 v38, v8 offset:260
  s_mov_b32 s70, 0
L_sn_35:
  ds_read_b32 v8, v38 offset:312
  s_waitcnt lgkmcnt(0)
  v_cmp_gt_u32 vcc, 0xc, v8
  s_cmp_eq_u64 vcc, 0
  s_cbranch_scc1 L_snd_36
  s_sleep 16
  s_add_u32 s70, s70, 1
  s_cmp_lt_u32 s70, 2097152
  s_cbranch_scc1 L_sn_35
L_snd_36:
  s_load_dwordx2 s[20:21], s[42:43], s54 offset:98304 glc
  s_load_dwordx2 s[24:25], s[42:43], s55 offset:98304 glc
  s_load_dwordx2 s[28:29], s[42:43], s56 offset:98304 glc
  s_mov_b32 s70, 0
  s_branch L_s3sc
L_s3s:
  s_load_dwordx2 s[20:21], s[42:43], s54 offset:98304 glc
  s_load_dwordx2 s[24:25], s[42:43], s55 offset:98304 glc
  s_load_dwordx2 s[28:29], s[42:43], s56 offset:98304 glc
L_s3sc:
  s_waitcnt lgkmcnt(0)
  s_xor_b32 s68, s21, s74
  s_xor_b32 s69, s25, s74
  s_or_b32 s68, s68, s69
  s_xor_b32 s69, s29, s74
  s_or_b32 s68, s68, s69
  s_cbranch_scc0 L_s3sd
  s_sleep 8
  s_add_u32 s70, s70, 1
  s_cmp_lt_u32 s70, 262144
  s_cbranch_scc1 L_s3s
L_s3sd:
  ds_write_b32 v38, v38 offset:256
  s_branch L_fin
L_team:
  s_and_b32 s5, s13, 3
  v_and_b32 v0, 0xff, v0
  v_mov_b32 v38, 0
  s_mov_b32 s77, 0
  s_lshr_b32 s60, s2, 5
  v_lshrrev_b32 v12, 3, v0
  v_lshlrev_b32 v12, 5, v12
  v_bfe_u32 v3, v1, 2, 1
  v_lshl_add_u32 v12, v3, 10, v12
  v_and_b32 v8, 3, v1
  v_lshl_add_u32 v37, v8, 3, v12
  v_and_b32 v12, 0xffffffdf, v12
  v_lshl_add_u32 v12, v8, 4, v12
  v_bfe_u32 v8, v1, 3, 1
  v_lshl_add_u32 v12, v8, 3, v12
  v_lshl_add_u32 v12, v3, 5, v12
  s_waitcnt lgkmcnt(0)
  s_load_dword s74, s[42:43], 0
  s_barrier
  s_cmp_ge_u32 s13, 8
  s_cbranch_scc1 L_r_mod
L_r_q:
  s_lshl3_add_u32 s61, s8, s60
  s_lshl_b32 s48, s61, 7
  s_lshl_b32 s58, s61, 8
  s_add_u32 s58, s58, 32768
  global_load_dwordx2 v[14:15], v37, s[16:17]
  s_mov_b32 s44, s22
  s_mov_b32 s45, s23
  s_mov_b32 s46, 4194304
  s_mov_b32 s47, 0x20000
  s_cmp_ge_u32 s60, 2
  s_cbranch_scc1 L_q_go
  s_mov_b32 s70, 0
L_sn_37:
  ds_read_b32 v8, v38 offset:268
  s_waitcnt lgkmcnt(0)
  v_cmp_gt_u32 vcc, 0x4, v8
  s_cmp_eq_u64 vcc, 0
  s_cbranch_scc1 L_snd_38
  s_sleep 1
  s_add_u32 s70, s70, 1
  s_cmp_lt_u32 s70, 2097152
  s_cbranch_scc1 L_sn_37
L_snd_38:
L_q_go:
  v_lshrrev_b32 v2, 3, v1
  v_and_b32 v3, 6, v2
  v_xor_b32 v3, v3, v1
  v_mul_u32_u24 v2, 8192, v2
  v_and_b32 v3, 7, v3
  v_lshl_add_u32 v2, v3, 4, v2
  s_mul_i32 s49, s5, 1048576
  s_lshl_b32 s50, s5, 14
  s_add_u32 s49, s49, s48
  s_add_u32 s50, s50, 12288
  s_add_u32 s51, s50, 16384
L_dma_39:
  s_mov_b32 m0, s50
  s_add_u32 s50, s50, 1024
  buffer_load_dwordx4 v2, s[44:47], s49 offen nt lds
  s_add_u32 s49, s49, 65536
  s_cmp_lt_u32 s50, s51
  s_cbranch_scc1 L_dma_39
L_dmae_40:
  v_mov_b32 v3, 1
  s_mov_b64 exec, 1
  ds_add_u32 v38, v3 offset:264
  s_mov_b64 exec, -1
  s_waitcnt lgkmcnt(0)
  s_mul_i32 s74, s74, 0x9e3779b1
  s_add_u32 s74, s74, 0x7f4a7c15
  v_bfe_u32 v6, v1, 2, 1
  v_lshlrev_b32 v6, 5, v6
  v_add_u32 v6, 3136, v6
  s_lshl_b32 s49, s5, 3
  v_add_u32 v5, s49, v6
  s_waitcnt vmcnt(16)
  v_lshlrev_b32 v20, 16, v14
  v_and_b32 v21, s73, v14
  v_lshlrev_b32 v22, 16, v15
  v_and_b32 v23, s73, v15
  v_add_f32 v8, v20, v21
  v_mul_f32 v9, v20, v20
  v_add_f32 v10, v22, v23
  v_mul_f32 v11, v22, v22
  v_fmac_f32 v9, v21, v21
  v_fmac_f32 v11, v23, v23
  v_add_f32 v8, v8, v10
  v_add_f32 v9, v9, v11
  s_nop 0
  v_add_f32_dpp v8, v8, v8 quad_perm:[1,0,3,2] row_mask:0xf bank_mask:0xf
  v_add_f32_dpp v9, v9, v9 quad_perm:[1,0,3,2] row_mask:0xf bank_mask:0xf
  s_nop 0
  v_add_f32_dpp v8, v8, v8 quad_perm:[2,3,0,1] row_mask:0xf bank_mask:0xf
  v_add_f32_dpp v9, v9, v9 quad_perm:[2,3,0,1] row_mask:0xf bank_mask:0xf
  s_nop 0
  v_add_f32_dpp v8, v8, v8 row_ror:8 row_mask:0xf bank_mask:0xf
  v_add_f32_dpp v9, v9, v9 row_ror:8 row_mask:0xf bank_mask:0xf
  s_nop 0
  v_mov_b32 v10, v8
  v_mov_b32 v11, v9
  s_nop 0
  v_permlane16_swap_b32 v10, v8
  v_permlane16_swap_b32 v11, v9
  v_add_f32 v8, v8, v10
  v_add_f32 v9, v9, v11
  v_mov_b32 v10, v8
  v_mov_b32 v11, v9
  s_nop 0
  v_permlane32_swap_b32 v10, v8
  v_permlane32_swap_b32 v11, v9
  v_add_f32 v8, v8, v10
  v_add_f32 v9, v9, v11
  ds_write_b64 v5, v[8:9]
  s_waitcnt vmcnt(0) lgkmcnt(0)
  s_add_u32 s77, s77, 4
  v_mov_b32 v9, 1
  s_mov_b64 exec, 1
  ds_add_u32 v38, v9 offset:312
  s_mov_b64 exec, -1
  s_mov_b32 s70, 0
L_hy_41:
  ds_read_b32 v9, v38 offset:312
  s_waitcnt lgkmcnt(0)
  v_cmp_gt_u32 vcc, s77, v9
  s_cmp_eq_u64 vcc, 0
  s_cbranch_scc1 L_hyd_42
  s_add_u32 s70, s70, 1
  s_cmp_lt_u32 s70, 2097152
  s_cbranch_scc1 L_hy_41
L_hyd_42:
  ds_read_b128 v[24:27], v6
  ds_read_b128 v[28:31], v6 offset:16
  s_waitcnt lgkmcnt(0)
  v_pk_add_f32 v[24:25], v[24:25], v[26:27]
  v_pk_add_f32 v[28:29], v[28:29], v[30:31]
  v_pk_add_f32 v[24:25], v[24:25], v[28:29]
  v_mul_f32 v8, 0x3b000000, v24
  v_mul_f32 v9, 0x3b000000, v25
  v_fma_f32 v9, -v8, v8, v9
  v_cvt_pk_bf16_f32 v8, 0, v8
  v_max_f32 v9, 0, v9
  v_cvt_pk_bf16_f32 v9, 0, v9
  v_sub_f32 v20, v20, v8
  v_sub_f32 v21, v21, v8
  v_add_f32 v9, 0x3727c5ac, v9
  v_sub_f32 v22, v22, v8
  v_sub_f32 v23, v23, v8
  v_cvt_pk_bf16_f32 v9, 0, v9
  v_cvt_pk_bf16_f32 v20, 0, v20
  v_sqrt_f32 v9, v9
  v_cvt_pk_bf16_f32 v21, 0, v21
  v_cvt_pk_bf16_f32 v9, 0, v9
  v_cvt_pk_bf16_f32 v22, 0, v22
  v_rcp_f32 v9, v9
  v_cvt_pk_bf16_f32 v23, 0, v23
  v_mul_f32 v20, v20, v9
  v_mul_f32 v21, v21, v9
  v_mul_f32 v22, v22, v9
  v_mul_f32 v23, v23, v9
  v_cvt_pk_bf16_f32 v20, 0, v20
  v_cvt_pk_bf16_f32 v21, 0, v21
  v_cvt_pk_bf16_f32 v22, 0, v22
  v_cvt_pk_bf16_f32 v23, 0, v23
  s_lshl_b32 s49, s8, 13
  s_add_u32 s49, s49, 917504
  v_lshl_add_u32 v15, v0, 4, s49
  v_add_u32 v36, 0x1000, v15
  s_mov_b64 s[64:65], -1
  s_mov_b64 s[66:67], -1
  s_mov_b64 exec, s[64:65]
  global_load_dwordx4 v[16:19], v15, s[42:43] sc1
  s_mov_b64 exec, s[66:67]
  global_load_dwordx4 v[32:35], v36, s[42:43] sc1
  s_mov_b64 exec, -1
  v_lshrrev_b32 v2, 2, v1
  v_bfe_u32 v3, v1, 1, 1
  s_lshl_b32 s49, s5, 1
  v_or_b32 v3, s49, v3
  v_and_b32 v10, 6, v2
  v_xor_b32 v3, v3, v10
  v_lshlrev_b32 v2, 7, v2
  v_lshl_add_u32 v2, v3, 4, v2
  v_and_b32 v3, 1, v1
  v_lshl_add_u32 v2, v3, 3, v2
  v_add_u32 v2, 12288, v2
  ds_read_b64_tr_b16 v[40:41], v2 offset:0
  ds_read_b64_tr_b16 v[42:43], v2 offset:2048
  ds_read_b64_tr_b16 v[44:45], v2 offset:4096
  ds_read_b64_tr_b16 v[46:47], v2 offset:6144
  ds_read_b64_tr_b16 v[48:49], v2 offset:8192
  ds_read_b64_tr_b16 v[50:51], v2 offset:10240
  ds_read_b64_tr_b16 v[52:53], v2 offset:12288
  ds_read_b64_tr_b16 v[54:55], v2 offset:14336
  ds_read_b64_tr_b16 v[56:57], v2 offset:16384
  ds_read_b64_tr_b16 v[58:59], v2 offset:18432
  ds_read_b64_tr_b16 v[60:61], v2 offset:20480
  ds_read_b64_tr_b16 v[62:63], v2 offset:22528
  s_waitcnt lgkmcnt(10)
  ds_read_b64_tr_b16 v[64:65], v2 offset:24576
  ds_read_b64_tr_b16 v[66:67], v2 offset:26624
  s_waitcnt lgkmcnt(10)
  ds_read_b64_tr_b16 v[68:69], v2 offset:28672
  ds_read_b64_tr_b16 v[70:71], v2 offset:30720
  s_waitcnt lgkmcnt(10)
  ds_read_b64_tr_b16 v[72:73], v2 offset:32768
  ds_read_b64_tr_b16 v[74:75], v2 offset:34816
  s_waitcnt lgkmcnt(10)
  ds_read_b64_tr_b16 v[76:77], v2 offset:36864
  ds_read_b64_tr_b16 v[78:79], v2 offset:38912
  s_waitcnt lgkmcnt(10)
  ds_read_b64_tr_b16 v[80:81], v2 offset:40960
  ds_read_b64_tr_b16 v[82:83], v2 offset:43008
  s_waitcnt lgkmcnt(10)
  ds_read_b64_tr_b16 v[84:85], v2 offset:45056
  ds_read_b64_tr_b16 v[86:87], v2 offset:47104
  s_waitcnt lgkmcnt(10)
  ds_read_b64_tr_b16 v[88:89], v2 offset:49152
  ds_read_b64_tr_b16 v[90:91], v2 offset:51200
  s_waitcnt lgkmcnt(10)
  ds_read_b64_tr_b16 v[92:93], v2 offset:53248
  ds_read_b64_tr_b16 v[94:95], v2 offset:55296
  s_waitcnt lgkmcnt(10)
  ds_read_b64_tr_b16 v[96:97], v2 offset:57344
  ds_read_b64_tr_b16 v[98:99], v2 offset:59392
  s_waitcnt lgkmcnt(10)
  ds_read_b64_tr_b16 v[100:101], v2 offset:61440
  ds_read_b64_tr_b16 v[102:103], v2 offset:63488
  s_waitcnt lgkmcnt(10)
  s_waitcnt lgkmcnt(0)
  v_and_b32 v13, 1, v1
  v_lshlrev_b32 v13, 14, v13
  v_lshrrev_b32 v3, 4, v1
  v_lshl_add_u32 v13, v3, 4, v13
  s_lshl_b32 s49, s5, 6
  s_add_u32 s49, s49, s58
  v_add_u32 v13, s49, v13
  v_and_b32 v14, 1, v1
  v_mul_u32_u24 v14, 1056, v14
  v_lshrrev_b32 v3, 4, v1
  v_lshl_add_u32 v14, v3, 4, v14
  v_add_u32 v14, 1024, v14
  s_mov_b32 s70, 0
  s_branch L_q_c
L_q_p:
  s_mov_b64 exec, s[64:65]
  global_load_dwordx4 v[16:19], v15, s[42:43] sc1
  s_mov_b64 exec, s[66:67]
  global_load_dwordx4 v[32:35], v36, s[42:43] sc1
  s_mov_b64 exec, -1
L_q_c:
  s_waitcnt vmcnt(0)
  v_cmp_ne_u32 s[64:65], s74, v17
  v_cmp_ne_u32 s[68:69], s74, v19
  s_or_b64 s[64:65], s[64:65], s[68:69]
  v_cmp_ne_u32 s[66:67], s74, v33
  v_cmp_ne_u32 s[68:69], s74, v35
  s_or_b64 s[66:67], s[66:67], s[68:69]
  s_or_b64 vcc, s[64:65], s[66:67]
  s_or_b32 s64, s64, 1
  s_or_b32 s66, s66, 1
  s_cmp_eq_u64 vcc, 0
  s_cbranch_scc1 L_q_ok
  s_sleep 2
  s_add_u32 s70, s70, 1
  s_cmp_lt_u32 s70, 262144
  s_cbranch_scc1 L_q_p
L_q_ok:
  v_lshlrev_b32 v28, 16, v32
  v_and_b32 v29, s73, v32
  v_lshlrev_b32 v30, 16, v34
  v_and_b32 v31, s73, v34
  v_lshlrev_b32 v24, 16, v16
  v_and_b32 v25, s73, v16
  v_lshlrev_b32 v26, 16, v18
  v_and_b32 v27, s73, v18
  v_add_f32 v28, 1.0, v28
  v_add_f32 v29, 1.0, v29
  v_add_f32 v30, 1.0, v30
  v_add_f32 v31, 1.0, v31
  v_cvt_pk_bf16_f32 v28, 0, v28
  v_cvt_pk_bf16_f32 v29, 0, v29
  v_cvt_pk_bf16_f32 v30, 0, v30
  v_cvt_pk_bf16_f32 v31, 0, v31
  v_mul_f32 v20, v20, v28
  v_mul_f32 v21, v21, v29
  v_mul_f32 v22, v22, v30
  v_mul_f32 v23, v23, v31
  v_cvt_pk_bf16_f32 v20, 0, v20
  v_cvt_pk_bf16_f32 v21, 0, v21
  v_cvt_pk_bf16_f32 v22, 0, v22
  v_cvt_pk_bf16_f32 v23, 0, v23
  v_add_f32 v20, v20, v24
  v_add_f32 v21, v21, v25
  v_add_f32 v22, v22, v26
  v_add_f32 v23, v23, v27
  v_cvt_pk_bf16_f32 v16, v20, v21
  v_cvt_pk_bf16_f32 v17, v22, v23
  ds_write_b64 v12, v[16:17] offset:1024
  s_add_u32 s77, s77, 4
  v_mov_b32 v9, 1
  s_mov_b64 exec, 1
  ds_add_u32 v38, v9 offset:312
  s_mov_b64 exec, -1
  s_mov_b32 s70, 0
L_hy_43:
  ds_read_b32 v9, v38 offset:312
  s_waitcnt lgkmcnt(0)
  v_cmp_gt_u32 vcc, s77, v9
  s_cmp_eq_u64 vcc, 0
  s_cbranch_scc1 L_hyd_44
  s_add_u32 s70, s70, 1
  s_cmp_lt_u32 s70, 2097152
  s_cbranch_scc1 L_hy_43
L_hyd_44:
  ds_read_b128 v[104:107], v14 offset:0
  ds_read_b128 v[108:111], v14 offset:64
  ds_read_b128 v[112:115], v14 offset:128
  ds_read_b128 v[116:119], v14 offset:192
  ds_read_b128 v[120:123], v14 offset:256
  ds_read_b128 v[124:127], v14 offset:320
  ds_read_b128 v[128:131], v14 offset:384
  ds_read_b128 v[132:135], v14 offset:448
  ds_read_b128 v[136:139], v14 offset:512
  ds_read_b128 v[140:143], v14 offset:576
  ds_read_b128 v[144:147], v14 offset:640
  ds_read_b128 v[148:151], v14 offset:704
  s_waitcnt lgkmcnt(11)
  v_mfma_f32_16x16x32_bf16 v[8:11], v[40:43], v[104:107], 0
  ds_read_b128 v[152:155], v14 offset:768
  s_waitcnt lgkmcnt(11)
  v_mfma_f32_16x16x32_bf16 v[8:11], v[44:47], v[108:111], v[8:11]
  ds_read_b128 v[156:159], v14 offset:832
  s_waitcnt lgkmcnt(11)
  v_mfma_f32_16x16x32_bf16 v[8:11], v[48:51], v[112:115], v[8:11]
  ds_read_b128 v[160:163], v14 offset:896
  s_waitcnt lgkmcnt(11)
  v_mfma_f32_16x16x32_bf16 v[8:11], v[52:55], v[116:119], v[8:11]
  ds_read_b128 v[164:167], v14 offset:960
  s_waitcnt lgkmcnt(11)
  v_mfma_f32_16x16x32_bf16 v[8:11], v[56:59], v[120:123], v[8:11]
  s_waitcnt lgkmcnt(10)
  v_mfma_f32_16x16x32_bf16 v[8:11], v[60:63], v[124:127], v[8:11]
  s_waitcnt lgkmcnt(9)
  v_mfma_f32_16x16x32_bf16 v[8:11], v[64:67], v[128:131], v[8:11]
  s_waitcnt lgkmcnt(8)
  v_mfma_f32_16x16x32_bf16 v[8:11], v[68:71], v[132:135], v[8:11]
  s_waitcnt lgkmcnt(7)
  v_mfma_f32_16x16x32_bf16 v[8:11], v[72:75], v[136:139], v[8:11]
  s_waitcnt lgkmcnt(6)
  v_mfma_f32_16x16x32_bf16 v[8:11], v[76:79], v[140:143], v[8:11]
  s_waitcnt lgkmcnt(5)
  v_mfma_f32_16x16x32_bf16 v[8:11], v[80:83], v[144:147], v[8:11]
  s_waitcnt lgkmcnt(4)
  v_mfma_f32_16x16x32_bf16 v[8:11], v[84:87], v[148:151], v[8:11]
  s_waitcnt lgkmcnt(3)
  v_mfma_f32_16x16x32_bf16 v[8:11], v[88:91], v[152:155], v[8:11]
  s_waitcnt lgkmcnt(2)
  v_mfma_f32_16x16x32_bf16 v[8:11], v[92:95], v[156:159], v[8:11]
  s_waitcnt lgkmcnt(1)
  v_mfma_f32_16x16x32_bf16 v[8:11], v[96:99], v[160:163], v[8:11]
  s_waitcnt lgkmcnt(0)
  v_mfma_f32_16x16x32_bf16 v[8:11], v[100:103], v[164:167], v[8:11]
  s_nop 7
  v_cvt_pk_bf16_f32 v8, v8, v9
  v_cvt_pk_bf16_f32 v10, v10, v11
  v_mov_b32 v9, s74
  v_mov_b32 v11, s74
  v_min_u32 v8, s72, v8
  v_min_u32 v10, s72, v10
  s_mov_b32 exec_lo, 0x00030003
  s_mov_b32 exec_hi, 0x00030003
  global_store_dwordx4 v13, v[8:11], s[42:43] sc1
  s_mov_b64 exec, -1
L_r_wo:
  s_xor_b32 s61, s60, 1
  s_lshl_b32 s48, s8, 19
  s_lshl_b32 s49, s61, 7
  s_add_u32 s48, s48, s49
  s_lshr_b32 s58, s8, 1
  s_lshl_b32 s58, s58, 14
  s_and_b32 s49, s8, 1
  s_lshl_b32 s49, s49, 12
  s_add_u32 s58, s58, s49
  s_lshl_b32 s49, s61, 9
  s_add_u32 s58, s58, s49
  s_add_u32 s58, s58, 2097152
  s_mov_b32 s44, s24
  s_mov_b32 s45, s25
  s_mov_b32 s46, 4194304
  s_mov_b32 s47, 0x20000
  v_lshrrev_b32 v2, 3, v1
  v_and_b32 v3, 6, v2
  v_xor_b32 v3, v3, v1
  v_mul_u32_u24 v2, 1024, v2
  v_and_b32 v3, 7, v3
  v_lshl_add_u32 v2, v3, 4, v2
  s_mul_i32 s49, s5, 131072
  s_lshl_b32 s50, s5, 14
  s_add_u32 s49, s49, s48
  s_add_u32 s50, s50, 12288
  s_add_u32 s51, s50, 16384
L_dma_45:
  s_mov_b32 m0, s50
  s_add_u32 s50, s50, 1024
  buffer_load_dwordx4 v2, s[44:47], s49 offen nt lds
  s_add_u32 s49, s49, 8192
  s_waitcnt vmcnt(2)
  s_cmp_lt_u32 s50, s51
  s_cbranch_scc1 L_dma_45
L_dmae_46:
  s_bfe_u32 s32, s74, 0x80000
  s_bfe_u32 s33, s74, 0x80008
  s_bfe_u32 s34, s74, 0x80010
  s_bfe_u32 s35, s74, 0x80018
  s_lshl2_add_u32 s49, s8, s5
  s_lshl_b32 s49, s49, 11
  s_add_u32 s49, s49, 131072
  v_lshrrev_b32 v12, 5, v1
  v_and_b32 v16, 31, v1
  v_lshlrev_b32 v15, 16, v12
  v_lshl_add_u32 v15, v16, 4, v15
  v_add_u32 v15, s49, v15
  v_mul_u32_u24 v12, 1056, v12
  v_bfe_u32 v16, v1, 3, 2
  v_lshl_add_u32 v12, v16, 6, v12
  v_and_b32 v16, 3, v1
  v_lshl_add_u32 v12, v16, 4, v12
  v_bfe_u32 v16, v1, 2, 1
  v_lshl_add_u32 v12, v16, 3, v12
  s_lshl_b32 s49, s5, 8
  v_add_u32 v12, s49, v12
  v_and_b32 v13, 1, v1
  v_lshlrev_b32 v13, 6, v13
  v_lshrrev_b32 v3, 4, v1
  v_lshl_add_u32 v13, v3, 4, v13
  s_lshl_b32 s49, s5, 7
  s_add_u32 s49, s49, s58
  v_add_u32 v13, s49, v13
  v_bfe_u32 v3, v1, 1, 1
  v_lshl_add_u32 v13, v3, 16, v13
  v_mov_b32 v36, 0xff
  global_load_dword v11, v13, s[42:43] sc1
  s_waitcnt vmcnt(0)
  s_add_u32 s77, s77, 4
  v_mov_b32 v9, 1
  s_mov_b64 exec, 1
  ds_add_u32 v38, v9 offset:312
  s_mov_b64 exec, -1
  s_mov_b32 s70, 0
L_hy_47:
  ds_read_b32 v9, v38 offset:312
  s_waitcnt lgkmcnt(0)
  v_cmp_gt_u32 vcc, s77, v9
  s_cmp_eq_u64 vcc, 0
  s_cbranch_scc1 L_hyd_48
  s_sleep 4
  s_add_u32 s70, s70, 1
  s_cmp_lt_u32 s70, 2097152
  s_cbranch_scc1 L_hy_47
L_hyd_48:
  v_lshrrev_b32 v2, 2, v1
  v_bfe_u32 v3, v1, 1, 1
  s_lshl_b32 s49, s5, 1
  v_or_b32 v3, s49, v3
  v_and_b32 v10, 6, v2
  v_xor_b32 v3, v3, v10
  v_lshlrev_b32 v2, 7, v2
  v_lshl_add_u32 v2, v3, 4, v2
  v_and_b32 v3, 1, v1
  v_lshl_add_u32 v2, v3, 3, v2
  v_add_u32 v2, 12288, v2
  ds_read_b64_tr_b16 v[40:41], v2 offset:0
  ds_read_b64_tr_b16 v[42:43], v2 offset:2048
  ds_read_b64_tr_b16 v[44:45], v2 offset:4096
  ds_read_b64_tr_b16 v[46:47], v2 offset:6144
  ds_read_b64_tr_b16 v[48:49], v2 offset:8192
  ds_read_b64_tr_b16 v[50:51], v2 offset:10240
  ds_read_b64_tr_b16 v[52:53], v2 offset:12288
  ds_read_b64_tr_b16 v[54:55], v2 offset:14336
  ds_read_b64_tr_b16 v[56:57], v2 offset:16384
  ds_read_b64_tr_b16 v[58:59], v2 offset:18432
  ds_read_b64_tr_b16 v[60:61], v2 offset:20480
  ds_read_b64_tr_b16 v[62:63], v2 offset:22528
  s_waitcnt lgkmcnt(10)
  ds_read_b64_tr_b16 v[64:65], v2 offset:24576
  ds_read_b64_tr_b16 v[66:67], v2 offset:26624
  s_waitcnt lgkmcnt(10)
  ds_read_b64_tr_b16 v[68:69], v2 offset:28672
  ds_read_b64_tr_b16 v[70:71], v2 offset:30720
  s_waitcnt lgkmcnt(10)
  ds_read_b64_tr_b16 v[72:73], v2 offset:32768
  ds_read_b64_tr_b16 v[74:75], v2 offset:34816
  s_waitcnt lgkmcnt(10)
  ds_read_b64_tr_b16 v[76:77], v2 offset:36864
  ds_read_b64_tr_b16 v[78:79], v2 offset:38912
  s_waitcnt lgkmcnt(10)
  ds_read_b64_tr_b16 v[80:81], v2 offset:40960
  ds_read_b64_tr_b16 v[82:83], v2 offset:43008
  s_waitcnt lgkmcnt(10)
  ds_read_b64_tr_b16 v[84:85], v2 offset:45056
  ds_read_b64_tr_b16 v[86:87], v2 offset:47104
  s_waitcnt lgkmcnt(10)
  ds_read_b64_tr_b16 v[88:89], v2 offset:49152
  ds_read_b64_tr_b16 v[90:91], v2 offset:51200
  s_waitcnt lgkmcnt(10)
  ds_read_b64_tr_b16 v[92:93], v2 offset:53248
  ds_read_b64_tr_b16 v[94:95], v2 offset:55296
  s_waitcnt lgkmcnt(10)
  ds_read_b64_tr_b16 v[96:97], v2 offset:57344
  ds_read_b64_tr_b16 v[98:99], v2 offset:59392
  s_waitcnt lgkmcnt(10)
  ds_read_b64_tr_b16 v[100:101], v2 offset:61440
  ds_read_b64_tr_b16 v[102:103], v2 offset:63488
  s_waitcnt lgkmcnt(10)
  s_waitcnt lgkmcnt(0)
  s_mov_b32 s70, 0
L_pl_49:
  ds_read_b32 v8, v38 offset:256
  s_waitcnt lgkmcnt(0)
  v_cmp_eq_u32 vcc, -1, v8
  s_cmp_eq_u64 vcc, 0
  s_cbranch_scc1 L_pld_50
  s_sleep 8
  s_add_u32 s70, s70, 1
  s_cmp_lt_u32 s70, 1048576
  s_cbranch_scc1 L_pl_49
L_pld_50:
  s_mov_b64 s[20:21], -1
  s_mov_b64 s[22:23], -1
  s_mov_b64 s[24:25], -1
  s_mov_b64 exec, s[20:21]
  global_load_dwordx4 v[152:155], v15, s[42:43] offset:0 sc1
  s_mov_b64 exec, s[22:23]
  global_load_dwordx4 v[156:159], v15, s[42:43] offset:512 sc1
  s_mov_b64 exec, s[24:25]
  global_load_dwordx4 v[160:163], v15, s[42:43] offset:1024 sc1
  s_mov_b64 exec, -1
  s_waitcnt vmcnt(0)
  s_mov_b32 s70, 0
  s_branch L_wo_c
L_wo_:
  s_mov_b64 exec, s[20:21]
  global_load_dwordx4 v[152:155], v15, s[42:43] offset:0 sc1
  s_mov_b64 exec, s[22:23]
  global_load_dwordx4 v[156:159], v15, s[42:43] offset:512 sc1
  s_mov_b64 exec, s[24:25]
  global_load_dwordx4 v[160:163], v15, s[42:43] offset:1024 sc1
  s_mov_b64 exec, -1
  s_waitcnt vmcnt(0)
L_wo_c:
  v_xor_b32 v136, s32, v152
  v_xor_b32 v137, s33, v153
  v_xor_b32 v138, s34, v154
  v_xor_b32 v139, s35, v155
  v_xor_b32 v140, s32, v156
  v_xor_b32 v141, s33, v157
  v_xor_b32 v142, s34, v158
  v_xor_b32 v143, s35, v159
  v_xor_b32 v144, s32, v160
  v_xor_b32 v145, s33, v161
  v_xor_b32 v146, s34, v162
  v_xor_b32 v147, s35, v163
  v_or3_b32 v28, v136, v137, v138
  v_or3_b32 v29, v140, v141, v142
  v_or3_b32 v30, v144, v145, v146
  v_or_b32 v28, v28, v139
  v_or_b32 v29, v29, v143
  v_or_b32 v30, v30, v147
  v_cmp_ne_u32_sdwa s[20:21], v28, v38 src0_sel:BYTE_0 src1_sel:DWORD
  v_cmp_ne_u32_sdwa s[22:23], v29, v38 src0_sel:BYTE_0 src1_sel:DWORD
  v_cmp_ne_u32_sdwa s[24:25], v30, v38 src0_sel:BYTE_0 src1_sel:DWORD
  v_or_b32 v136, 0x80, v136
  v_or_b32 v137, 0x80, v137
  v_or_b32 v138, 0x80, v138
  v_or_b32 v139, 0x80, v139
  v_or_b32 v140, 0x80, v140
  v_or_b32 v141, 0x80, v141
  v_or_b32 v142, 0x80, v142
  v_or_b32 v143, 0x80, v143
  v_or_b32 v144, 0x80, v144
  v_or_b32 v145, 0x80, v145
  v_or_b32 v146, 0x80, v146
  v_or_b32 v147, 0x80, v147
  v_pk_add_f32 v[16:17], v[136:137], v[140:141]
  v_pk_add_f32 v[18:19], v[138:139], v[142:143]
  v_pk_add_f32 v[16:17], v[16:17], v[144:145]
  v_pk_add_f32 v[18:19], v[18:19], v[146:147]
  s_mov_b64 vcc, s[20:21]
  s_or_b64 vcc, vcc, s[22:23]
  s_or_b64 vcc, vcc, s[24:25]
  s_or_b32 s20, s20, 1
  s_or_b32 s22, s22, 1
  s_or_b32 s24, s24, 1
  s_cmp_eq_u64 vcc, 0
  s_cbranch_scc1 L_wo_ok
  s_add_u32 s70, s70, 1
  s_cmp_lt_u32 s70, 262144
  s_cbranch_scc1 L_wo_
L_wo_ok:
  v_cvt_pk_bf16_f32 v8, v16, v17
  v_cvt_pk_bf16_f32 v9, v18, v19
  ds_write_b64 v12, v[8:9] offset:1024
  s_add_u32 s77, s77, 4
  v_mov_b32 v3, 1
  s_mov_b64 exec, 1
  ds_add_u32 v38, v3 offset:312
  s_mov_b64 exec, -1
  s_mov_b32 s70, 0
L_hy_51:
  ds_read_b32 v3, v38 offset:312
  ds_read_b128 v[104:107], v14 offset:0
  ds_read_b128 v[108:111], v14 offset:64
  ds_read_b128 v[112:115], v14 offset:128
  ds_read_b128 v[116:119], v14 offset:192
  s_waitcnt lgkmcnt(4)
  v_cmp_gt_u32 vcc, s77, v3
  s_cmp_eq_u64 vcc, 0
  s_cbranch_scc1 L_hyd_52
  s_waitcnt lgkmcnt(0)
  s_add_u32 s70, s70, 1
  s_cmp_lt_u32 s70, 2097152
  s_cbranch_scc1 L_hy_51
L_hyd_52:
  ds_read_b128 v[120:123], v14 offset:256
  ds_read_b128 v[124:127], v14 offset:320
  ds_read_b128 v[128:131], v14 offset:384
  ds_read_b128 v[132:135], v14 offset:448
  ds_read_b128 v[136:139], v14 offset:512
  ds_read_b128 v[140:143], v14 offset:576
  ds_read_b128 v[144:147], v14 offset:640
  ds_read_b128 v[148:151], v14 offset:704
  s_waitcnt lgkmcnt(11)
  v_mfma_f32_16x16x32_bf16 v[8:11], v[40:43], v[104:107], 0
  s_waitcnt lgkmcnt(10)
  v_mfma_f32_16x16x32_bf16 v[8:11], v[44:47], v[108:111], v[8:11]
  ds_read_b128 v[104:107], v14 offset:768
  s_waitcnt lgkmcnt(10)
  v_mfma_f32_16x16x32_bf16 v[8:11], v[48:51], v[112:115], v[8:11]
  ds_read_b128 v[108:111], v14 offset:832
  s_waitcnt lgkmcnt(10)
  v_mfma_f32_16x16x32_bf16 v[8:11], v[52:55], v[116:119], v[8:11]
  ds_read_b128 v[112:115], v14 offset:896
  s_waitcnt lgkmcnt(10)
  v_mfma_f32_16x16x32_bf16 v[8:11], v[56:59], v[120:123], v[8:11]
  ds_read_b128 v[116:119], v14 offset:960
  s_waitcnt lgkmcnt(10)
  v_mfma_f32_16x16x32_bf16 v[8:11], v[60:63], v[124:127], v[8:11]
  s_waitcnt lgkmcnt(9)
  v_mfma_f32_16x16x32_bf16 v[8:11], v[64:67], v[128:131], v[8:11]
  s_waitcnt lgkmcnt(8)
  v_mfma_f32_16x16x32_bf16 v[8:11], v[68:71], v[132:135], v[8:11]
  s_waitcnt lgkmcnt(7)
  v_mfma_f32_16x16x32_bf16 v[8:11], v[72:75], v[136:139], v[8:11]
  s_waitcnt lgkmcnt(6)
  v_mfma_f32_16x16x32_bf16 v[8:11], v[76:79], v[140:143], v[8:11]
  s_waitcnt lgkmcnt(5)
  v_mfma_f32_16x16x32_bf16 v[8:11], v[80:83], v[144:147], v[8:11]
  s_waitcnt lgkmcnt(4)
  v_mfma_f32_16x16x32_bf16 v[8:11], v[84:87], v[148:151], v[8:11]
  s_waitcnt lgkmcnt(3)
  v_mfma_f32_16x16x32_bf16 v[8:11], v[88:91], v[104:107], v[8:11]
  s_waitcnt lgkmcnt(2)
  v_mfma_f32_16x16x32_bf16 v[8:11], v[92:95], v[108:111], v[8:11]
  s_waitcnt lgkmcnt(1)
  v_mfma_f32_16x16x32_bf16 v[8:11], v[96:99], v[112:115], v[8:11]
  s_waitcnt lgkmcnt(0)
  v_mfma_f32_16x16x32_bf16 v[8:11], v[100:103], v[116:119], v[8:11]
  s_nop 7
  v_bfi_b32 v8, v36, s32, v8
  v_bfi_b32 v9, v36, s33, v9
  v_bfi_b32 v10, v36, s34, v10
  v_bfi_b32 v11, v36, s35, v11
  s_mov_b32 exec_lo, 0x000f000f
  s_mov_b32 exec_hi, exec_lo
  global_store_dwordx4 v13, v[8:11], s[42:43] sc1
  v_mov_b32 v3, 1
  s_mov_b64 exec, 1
  ds_add_u32 v38, v3 offset:264
  s_mov_b64 exec, -1
  s_branch L_fin
L_r_mod:
  global_load_dwordx2 v[14:15], v37, s[34:35]
  s_mov_b32 s44, s36
  s_mov_b32 s45, s37
  s_mov_b32 s46, 3145728
  s_mov_b32 s47, 0x20000
  s_cmp_ge_u32 s60, 2
  s_cbranch_scc1 L_mod2
  s_lshl1_add_u32 s61, s8, s60
  s_lshl_b32 s48, s61, 7
  s_lshl_b32 s58, s61, 9
  s_add_u32 s58, s58, 917504
  v_lshrrev_b32 v2, 3, v1
  v_and_b32 v3, 6, v2
  v_xor_b32 v3, v3, v1
  v_mul_u32_u24 v2, 6144, v2
  v_and_b32 v3, 7, v3
  v_lshl_add_u32 v2, v3, 4, v2
  s_mul_i32 s49, s5, 786432
  s_lshl_b32 s50, s5, 14
  s_add_u32 s49, s49, s48
  s_add_u32 s50, s50, 77824
  s_add_u32 s51, s50, 16384
L_dma_53:
  s_mov_b32 m0, s50
  s_add_u32 s50, s50, 1024
  buffer_load_dwordx4 v2, s[44:47], s49 offen nt lds
  s_add_u32 s49, s49, 49152
  s_cmp_lt_u32 s50, s51
  s_cbranch_scc1 L_dma_53
L_dmae_54:
  v_mov_b32 v3, 1
  s_mov_b64 exec, 1
  ds_add_u32 v38, v3 offset:268
  s_mov_b64 exec, -1
  s_getpc_b64 s[56:57]
L_pc_55:
  s_lshr_b32 s3, s2, 5
  s_lshl3_add_u32 s3, s3, s8
  s_lshl_b32 s3, s3, 2
  s_add_u32 s3, s3, L_table-L_pc_55
  s_load_dword s14, s[56:57], s3
  s_waitcnt lgkmcnt(0)
  s_mul_i32 s74, s74, 0x9e3779b1
  s_add_u32 s74, s74, 0x7f4a7c15
  s_waitcnt vmcnt(16)
  v_lshlrev_b32 v16, 16, v14
  v_and_b32 v17, s73, v14
  v_lshlrev_b32 v18, 16, v15
  v_and_b32 v19, s73, v15
  v_mul_f32 v20, 0xbfb8aa3b, v16
  v_mul_f32 v21, 0xbfb8aa3b, v17
  v_mul_f32 v22, 0xbfb8aa3b, v18
  v_mul_f32 v23, 0xbfb8aa3b, v19
  v_exp_f32 v20, v20
  v_exp_f32 v21, v21
  v_exp_f32 v22, v22
  v_exp_f32 v23, v23
  s_nop 0
  v_add_f32 v20, 1.0, v20
  v_add_f32 v21, 1.0, v21
  v_add_f32 v22, 1.0, v22
  v_add_f32 v23, 1.0, v23
  v_rcp_f32 v20, v20
  v_rcp_f32 v21, v21
  v_rcp_f32 v22, v22
  v_rcp_f32 v23, v23
  s_nop 0
  v_mul_f32 v16, v16, v20
  v_mul_f32 v17, v17, v21
  v_mul_f32 v18, v18, v22
  v_mul_f32 v19, v19, v23
  v_cvt_pk_bf16_f32 v14, v16, v17
  v_cvt_pk_bf16_f32 v15, v18, v19
  ds_write_b64 v12, v[14:15] offset:3200
  v_and_b32 v13, 1, v1
  v_lshlrev_b32 v13, 6, v13
  v_lshrrev_b32 v3, 4, v1
  v_lshl_add_u32 v13, v3, 4, v13
  s_lshl_b32 s49, s5, 7
  s_add_u32 s49, s49, s58
  v_add_u32 v13, s49, v13
  v_bfe_u32 v3, v1, 1, 3
  v_lshl_add_u32 v13, v3, 13, v13
  v_and_b32 v14, 1, v1
  v_mul_u32_u24 v14, 1056, v14
  v_lshrrev_b32 v3, 4, v1
  v_lshl_add_u32 v14, v3, 4, v14
  v_add_u32 v14, 3200, v14
  v_lshrrev_b32 v2, 2, v1
  v_bfe_u32 v3, v1, 1, 1
  s_lshl_b32 s49, s5, 1
  v_or_b32 v3, s49, v3
  v_and_b32 v10, 6, v2
  v_xor_b32 v3, v3, v10
  v_lshlrev_b32 v2, 7, v2
  v_lshl_add_u32 v2, v3, 4, v2
  v_and_b32 v3, 1, v1
  v_lshl_add_u32 v2, v3, 3, v2
  v_add_u32 v2, 77824, v2
  s_waitcnt vmcnt(0) lgkmcnt(0)
  s_add_u32 s77, s77, 4
  v_mov_b32 v9, 1
  s_mov_b64 exec, 1
  ds_add_u32 v38, v9 offset:316
  s_mov_b64 exec, -1
  s_mov_b32 s70, 0
L_hy_56:
  ds_read_b32 v9, v38 offset:316
  s_waitcnt lgkmcnt(0)
  v_cmp_gt_u32 vcc, s77, v9
  s_cmp_eq_u64 vcc, 0
  s_cbranch_scc1 L_hyd_57
  s_add_u32 s70, s70, 1
  s_cmp_lt_u32 s70, 2097152
  s_cbranch_scc1 L_hy_56
L_hyd_57:
  ds_read_b64_tr_b16 v[40:41], v2 offset:0
  ds_read_b64_tr_b16 v[42:43], v2 offset:2048
  ds_read_b128 v[104:107], v14 offset:0
  ds_read_b64_tr_b16 v[44:45], v2 offset:4096
  ds_read_b64_tr_b16 v[46:47], v2 offset:6144
  ds_read_b128 v[108:111], v14 offset:64
  ds_read_b64_tr_b16 v[48:49], v2 offset:8192
  ds_read_b64_tr_b16 v[50:51], v2 offset:10240
  ds_read_b128 v[112:115], v14 offset:128
  ds_read_b64_tr_b16 v[52:53], v2 offset:12288
  ds_read_b64_tr_b16 v[54:55], v2 offset:14336
  ds_read_b128 v[116:119], v14 offset:192
  ds_read_b64_tr_b16 v[56:57], v2 offset:16384
  ds_read_b64_tr_b16 v[58:59], v2 offset:18432
  ds_read_b128 v[120:123], v14 offset:256
  s_waitcnt lgkmcnt(12)
  v_mfma_f32_16x16x32_bf16 v[8:11], v[40:43], v[104:107], 0
  ds_read_b64_tr_b16 v[60:61], v2 offset:20480
  ds_read_b64_tr_b16 v[62:63], v2 offset:22528
  ds_read_b128 v[124:127], v14 offset:320
  s_waitcnt lgkmcnt(12)
  v_mfma_f32_16x16x32_bf16 v[8:11], v[44:47], v[108:111], v[8:11]
  ds_read_b64_tr_b16 v[64:65], v2 offset:24576
  ds_read_b64_tr_b16 v[66:67], v2 offset:26624
  ds_read_b128 v[128:131], v14 offset:384
  s_waitcnt lgkmcnt(12)
  v_mfma_f32_16x16x32_bf16 v[8:11], v[48:51], v[112:115], v[8:11]
  ds_read_b64_tr_b16 v[68:69], v2 offset:28672
  ds_read_b64_tr_b16 v[70:71], v2 offset:30720
  ds_read_b128 v[132:135], v14 offset:448
  s_waitcnt lgkmcnt(12)
  v_mfma_f32_16x16x32_bf16 v[8:11], v[52:55], v[116:119], v[8:11]
  ds_read_b64_tr_b16 v[72:73], v2 offset:32768
  ds_read_b64_tr_b16 v[74:75], v2 offset:34816
  ds_read_b128 v[136:139], v14 offset:512
  s_waitcnt lgkmcnt(12)
  v_mfma_f32_16x16x32_bf16 v[8:11], v[56:59], v[120:123], v[8:11]
  ds_read_b64_tr_b16 v[76:77], v2 offset:36864
  ds_read_b64_tr_b16 v[78:79], v2 offset:38912
  ds_read_b128 v[140:143], v14 offset:576
  s_waitcnt lgkmcnt(12)
  v_mfma_f32_16x16x32_bf16 v[8:11], v[60:63], v[124:127], v[8:11]
  ds_read_b64_tr_b16 v[80:81], v2 offset:40960
  ds_read_b64_tr_b16 v[82:83], v2 offset:43008
  ds_read_b128 v[144:147], v14 offset:640
  s_waitcnt lgkmcnt(12)
  v_mfma_f32_16x16x32_bf16 v[8:11], v[64:67], v[128:131], v[8:11]
  ds_read_b64_tr_b16 v[84:85], v2 offset:45056
  ds_read_b64_tr_b16 v[86:87], v2 offset:47104
  ds_read_b128 v[148:151], v14 offset:704
  s_waitcnt lgkmcnt(12)
  v_mfma_f32_16x16x32_bf16 v[8:11], v[68:71], v[132:135], v[8:11]
  ds_read_b64_tr_b16 v[88:89], v2 offset:49152
  ds_read_b64_tr_b16 v[90:91], v2 offset:51200
  ds_read_b128 v[152:155], v14 offset:768
  s_waitcnt lgkmcnt(12)
  v_mfma_f32_16x16x32_bf16 v[8:11], v[72:75], v[136:139], v[8:11]
  ds_read_b64_tr_b16 v[92:93], v2 offset:53248
  ds_read_b64_tr_b16 v[94:95], v2 offset:55296
  ds_read_b128 v[156:159], v14 offset:832
  s_waitcnt lgkmcnt(12)
  v_mfma_f32_16x16x32_bf16 v[8:11], v[76:79], v[140:143], v[8:11]
  ds_read_b64_tr_b16 v[96:97], v2 offset:57344
  ds_read_b64_tr_b16 v[98:99], v2 offset:59392
  ds_read_b128 v[160:163], v14 offset:896
  s_waitcnt lgkmcnt(12)
  v_mfma_f32_16x16x32_bf16 v[8:11], v[80:83], v[144:147], v[8:11]
  ds_read_b64_tr_b16 v[100:101], v2 offset:61440
  ds_read_b64_tr_b16 v[102:103], v2 offset:63488
  ds_read_b128 v[164:167], v14 offset:960
  s_waitcnt lgkmcnt(12)
  v_mfma_f32_16x16x32_bf16 v[8:11], v[84:87], v[148:151], v[8:11]
  s_waitcnt lgkmcnt(9)
  v_mfma_f32_16x16x32_bf16 v[8:11], v[88:91], v[152:155], v[8:11]
  s_waitcnt lgkmcnt(6)
  v_mfma_f32_16x16x32_bf16 v[8:11], v[92:95], v[156:159], v[8:11]
  s_waitcnt lgkmcnt(3)
  v_mfma_f32_16x16x32_bf16 v[8:11], v[96:99], v[160:163], v[8:11]
  s_waitcnt lgkmcnt(0)
  v_mfma_f32_16x16x32_bf16 v[8:11], v[100:103], v[164:167], v[8:11]
  s_nop 7
  v_cvt_pk_bf16_f32 v8, v8, v9
  v_cvt_pk_bf16_f32 v10, v10, v11
  v_mov_b32 v9, s74
  v_mov_b32 v11, s74
  global_store_dwordx4 v13, v[8:11], s[42:43] sc1
  s_mov_b64 exec, -1
  s_add_u32 s77, s77, 4
  v_mov_b32 v9, 1
  s_mov_b64 exec, 1
  ds_add_u32 v38, v9 offset:316
  s_mov_b64 exec, -1
  s_mov_b32 s70, 0
L_hy_58:
  ds_read_b32 v9, v38 offset:316
  s_waitcnt lgkmcnt(0)
  v_cmp_gt_u32 vcc, s77, v9
  s_cmp_eq_u64 vcc, 0
  s_cbranch_scc1 L_hyd_59
  s_add_u32 s70, s70, 1
  s_cmp_lt_u32 s70, 2097152
  s_cbranch_scc1 L_hy_58
L_hyd_59:
  s_branch L_mod3
L_mod2:
  s_getpc_b64 s[56:57]
L_pc_60:
  s_lshr_b32 s3, s2, 5
  s_lshl3_add_u32 s3, s3, s8
  s_lshl_b32 s3, s3, 2
  s_add_u32 s3, s3, L_table-L_pc_60
  s_load_dword s14, s[56:57], s3
  s_waitcnt lgkmcnt(0)
  s_mul_i32 s74, s74, 0x9e3779b1
  s_add_u32 s74, s74, 0x7f4a7c15
  s_waitcnt vmcnt(0)
  v_lshlrev_b32 v16, 16, v14
  v_and_b32 v17, s73, v14
  v_lshlrev_b32 v18, 16, v15
  v_and_b32 v19, s73, v15
  v_mul_f32 v20, 0xbfb8aa3b, v16
  v_mul_f32 v21, 0xbfb8aa3b, v17
  v_mul_f32 v22, 0xbfb8aa3b, v18
  v_mul_f32 v23, 0xbfb8aa3b, v19
  v_exp_f32 v20, v20
  v_exp_f32 v21, v21
  v_exp_f32 v22, v22
  v_exp_f32 v23, v23
  s_nop 0
  v_add_f32 v20, 1.0, v20
  v_add_f32 v21, 1.0, v21
  v_add_f32 v22, 1.0, v22
  v_add_f32 v23, 1.0, v23
  v_rcp_f32 v20, v20
  v_rcp_f32 v21, v21
  v_rcp_f32 v22, v22
  v_rcp_f32 v23, v23
  s_nop 0
  v_mul_f32 v16, v16, v20
  v_mul_f32 v17, v17, v21
  v_mul_f32 v18, v18, v22
  v_mul_f32 v19, v19, v23
  v_cvt_pk_bf16_f32 v14, v16, v17
  v_cvt_pk_bf16_f32 v15, v18, v19
  ds_write_b64 v12, v[14:15] offset:3200
L_mod3:
  s_mov_b32 s70, 0
L_sn_61:
  ds_read_b32 v8, v38 offset:264
  s_waitcnt lgkmcnt(0)
  v_cmp_gt_u32 vcc, 0x4, v8
  s_cmp_eq_u64 vcc, 0
  s_cbranch_scc1 L_snd_62
  s_sleep 4
  s_add_u32 s70, s70, 1
  s_cmp_lt_u32 s70, 2097152
  s_cbranch_scc1 L_sn_61
L_snd_62:
  s_and_b32 s61, s14, 0xff
  s_cmp_ge_u32 s61, 48
  s_cbranch_scc1 L_r_f1
  s_mov_b32 s70, 0
L_sn_63:
  ds_read_b32 v8, v38 offset:312
  s_waitcnt lgkmcnt(0)
  v_cmp_gt_u32 vcc, 0x8, v8
  s_cmp_eq_u64 vcc, 0
  s_cbranch_scc1 L_snd_64
  s_sleep 4
  s_add_u32 s70, s70, 1
  s_cmp_lt_u32 s70, 2097152
  s_cbranch_scc1 L_sn_63
L_snd_64:
  s_and_b32 s61, s14, 0xff
L_mod4:
  s_cmp_ge_u32 s61, 48
  s_cbranch_scc1 L_r_f1
  s_lshl_b32 s48, s61, 7
  s_lshl_b32 s58, s61, 9
  s_add_u32 s58, s58, 4096
  v_lshrrev_b32 v2, 3, v1
  v_and_b32 v3, 6, v2
  v_xor_b32 v3, v3, v1
  v_mul_u32_u24 v2, 6144, v2
  v_and_b32 v3, 7, v3
  v_lshl_add_u32 v2, v3, 4, v2
  s_mul_i32 s49, s5, 786432
  s_lshl_b32 s50, s5, 14
  s_add_u32 s49, s49, s48
  s_add_u32 s50, s50, 77824
  s_add_u32 s51, s50, 16384
L_dma_65:
  s_mov_b32 m0, s50
  s_add_u32 s50, s50, 1024
  buffer_load_dwordx4 v2, s[44:47], s49 offen nt lds
  s_add_u32 s49, s49, 49152
  s_waitcnt vmcnt(5)
  s_cmp_lt_u32 s50, s51
  s_cbranch_scc1 L_dma_65
L_dmae_66:
  v_and_b32 v13, 1, v1
  v_lshlrev_b32 v13, 6, v13
  v_lshrrev_b32 v3, 4, v1
  v_lshl_add_u32 v13, v3, 4, v13
  s_lshl_b32 s49, s5, 7
  s_add_u32 s49, s49, s58
  v_add_u32 v13, s49, v13
  v_and_b32 v14, 1, v1
  v_mul_u32_u24 v14, 1056, v14
  v_lshrrev_b32 v3, 4, v1
  v_lshl_add_u32 v14, v3, 4, v14
  v_add_u32 v14, 3200, v14
  v_lshrrev_b32 v2, 2, v1
  v_bfe_u32 v3, v1, 1, 1
  s_lshl_b32 s49, s5, 1
  v_or_b32 v3, s49, v3
  v_and_b32 v10, 6, v2
  v_xor_b32 v3, v3, v10
  v_lshlrev_b32 v2, 7, v2
  v_lshl_add_u32 v2, v3, 4, v2
  v_and_b32 v3, 1, v1
  v_lshl_add_u32 v2, v3, 3, v2
  v_add_u32 v2, 77824, v2
  s_waitcnt vmcnt(0) lgkmcnt(0)
  s_add_u32 s77, s77, 4
  v_mov_b32 v9, 1
  s_mov_b64 exec, 1
  ds_add_u32 v38, v9 offset:316
  s_mov_b64 exec, -1
  s_mov_b32 s70, 0
L_hy_67:
  ds_read_b32 v9, v38 offset:316
  s_waitcnt lgkmcnt(0)
  v_cmp_gt_u32 vcc, s77, v9
  s_cmp_eq_u64 vcc, 0
  s_cbranch_scc1 L_hyd_68
  s_sleep 4
  s_add_u32 s70, s70, 1
  s_cmp_lt_u32 s70, 2097152
  s_cbranch_scc1 L_hy_67
L_hyd_68:
  ds_read_b64_tr_b16 v[40:41], v2 offset:0
  ds_read_b64_tr_b16 v[42:43], v2 offset:2048
  ds_read_b128 v[104:107], v14 offset:0
  ds_read_b64_tr_b16 v[44:45], v2 offset:4096
  ds_read_b64_tr_b16 v[46:47], v2 offset:6144
  ds_read_b128 v[108:111], v14 offset:64
  ds_read_b64_tr_b16 v[48:49], v2 offset:8192
  ds_read_b64_tr_b16 v[50:51], v2 offset:10240
  ds_read_b128 v[112:115], v14 offset:128
  ds_read_b64_tr_b16 v[52:53], v2 offset:12288
  ds_read_b64_tr_b16 v[54:55], v2 offset:14336
  ds_read_b128 v[116:119], v14 offset:192
  ds_read_b64_tr_b16 v[56:57], v2 offset:16384
  ds_read_b64_tr_b16 v[58:59], v2 offset:18432
  ds_read_b128 v[120:123], v14 offset:256
  s_waitcnt lgkmcnt(12)
  v_mfma_f32_16x16x32_bf16 v[8:11], v[40:43], v[104:107], 0
  ds_read_b64_tr_b16 v[60:61], v2 offset:20480
  ds_read_b64_tr_b16 v[62:63], v2 offset:22528
  ds_read_b128 v[124:127], v14 offset:320
  s_waitcnt lgkmcnt(12)
  v_mfma_f32_16x16x32_bf16 v[8:11], v[44:47], v[108:111], v[8:11]
  ds_read_b64_tr_b16 v[64:65], v2 offset:24576
  ds_read_b64_tr_b16 v[66:67], v2 offset:26624
  ds_read_b128 v[128:131], v14 offset:384
  s_waitcnt lgkmcnt(12)
  v_mfma_f32_16x16x32_bf16 v[8:11], v[48:51], v[112:115], v[8:11]
  ds_read_b64_tr_b16 v[68:69], v2 offset:28672
  ds_read_b64_tr_b16 v[70:71], v2 offset:30720
  ds_read_b128 v[132:135], v14 offset:448
  s_waitcnt lgkmcnt(12)
  v_mfma_f32_16x16x32_bf16 v[8:11], v[52:55], v[116:119], v[8:11]
  ds_read_b64_tr_b16 v[72:73], v2 offset:32768
  ds_read_b64_tr_b16 v[74:75], v2 offset:34816
  ds_read_b128 v[136:139], v14 offset:512
  s_waitcnt lgkmcnt(12)
  v_mfma_f32_16x16x32_bf16 v[8:11], v[56:59], v[120:123], v[8:11]
  ds_read_b64_tr_b16 v[76:77], v2 offset:36864
  ds_read_b64_tr_b16 v[78:79], v2 offset:38912
  ds_read_b128 v[140:143], v14 offset:576
  s_waitcnt lgkmcnt(12)
  v_mfma_f32_16x16x32_bf16 v[8:11], v[60:63], v[124:127], v[8:11]
  ds_read_b64_tr_b16 v[80:81], v2 offset:40960
  ds_read_b64_tr_b16 v[82:83], v2 offset:43008
  ds_read_b128 v[144:147], v14 offset:640
  s_waitcnt lgkmcnt(12)
  v_mfma_f32_16x16x32_bf16 v[8:11], v[64:67], v[128:131], v[8:11]
  ds_read_b64_tr_b16 v[84:85], v2 offset:45056
  ds_read_b64_tr_b16 v[86:87], v2 offset:47104
  ds_read_b128 v[148:151], v14 offset:704
  s_waitcnt lgkmcnt(12)
  v_mfma_f32_16x16x32_bf16 v[8:11], v[68:71], v[132:135], v[8:11]
  ds_read_b64_tr_b16 v[88:89], v2 offset:49152
  ds_read_b64_tr_b16 v[90:91], v2 offset:51200
  ds_read_b128 v[152:155], v14 offset:768
  s_waitcnt lgkmcnt(12)
  v_mfma_f32_16x16x32_bf16 v[8:11], v[72:75], v[136:139], v[8:11]
  ds_read_b64_tr_b16 v[92:93], v2 offset:53248
  ds_read_b64_tr_b16 v[94:95], v2 offset:55296
  ds_read_b128 v[156:159], v14 offset:832
  s_waitcnt lgkmcnt(12)
  v_mfma_f32_16x16x32_bf16 v[8:11], v[76:79], v[140:143], v[8:11]
  ds_read_b64_tr_b16 v[96:97], v2 offset:57344
  ds_read_b64_tr_b16 v[98:99], v2 offset:59392
  ds_read_b128 v[160:163], v14 offset:896
  s_waitcnt lgkmcnt(12)
  v_mfma_f32_16x16x32_bf16 v[8:11], v[80:83], v[144:147], v[8:11]
  ds_read_b64_tr_b16 v[100:101], v2 offset:61440
  ds_read_b64_tr_b16 v[102:103], v2 offset:63488
  ds_read_b128 v[164:167], v14 offset:960
  s_waitcnt lgkmcnt(12)
  v_mfma_f32_16x16x32_bf16 v[8:11], v[84:87], v[148:151], v[8:11]
  s_waitcnt lgkmcnt(9)
  v_mfma_f32_16x16x32_bf16 v[8:11], v[88:91], v[152:155], v[8:11]
  s_waitcnt lgkmcnt(6)
  v_mfma_f32_16x16x32_bf16 v[8:11], v[92:95], v[156:159], v[8:11]
  s_waitcnt lgkmcnt(3)
  v_mfma_f32_16x16x32_bf16 v[8:11], v[96:99], v[160:163], v[8:11]
  s_waitcnt lgkmcnt(0)
  v_mfma_f32_16x16x32_bf16 v[8:11], v[100:103], v[164:167], v[8:11]
  s_nop 7
  v_cvt_pk_bf16_f32 v8, v8, v9
  v_cvt_pk_bf16_f32 v10, v10, v11
  v_mov_b32 v9, s74
  v_mov_b32 v11, s74
  s_mov_b32 exec_lo, 0x00030003
  s_mov_b32 exec_hi, 0x00030003
  global_store_dwordx4 v13, v[8:11], s[42:43] sc1
  s_mov_b64 exec, -1
  s_add_u32 s77, s77, 4
  v_mov_b32 v9, 1
  s_mov_b64 exec, 1
  ds_add_u32 v38, v9 offset:316
  s_mov_b64 exec, -1
  s_mov_b32 s70, 0
L_hy_69:
  ds_read_b32 v9, v38 offset:316
  s_waitcnt lgkmcnt(0)
  v_cmp_gt_u32 vcc, s77, v9
  s_cmp_eq_u64 vcc, 0
  s_cbranch_scc1 L_hyd_70
  s_add_u32 s70, s70, 1
  s_cmp_lt_u32 s70, 2097152
  s_cbranch_scc1 L_hy_69
L_hyd_70:
  s_lshr_b32 s61, s14, 24
  s_or_b32 s14, s14, 0xff000000
  s_branch L_mod4
L_r_f1:
  s_bfe_u32 s61, s14, 0x80008
  s_cmp_ge_u32 s61, 43
  s_cbranch_scc1 L_fin
  s_lshl_b32 s48, s61, 6
  s_lshl_b32 s58, s61, 7
  s_add_u32 s58, s58, 1572864
  s_cmp_lt_u32 s5, 2
  s_cselect_b32 s44, s28, s30
  s_cselect_b32 s45, s29, s31
  s_mov_b32 s46, 1409024
  s_and_b32 s54, s61, 1
  v_lshrrev_b32 v2, 2, v1
  v_mul_u32_u24 v2, 5504, v2
  s_and_b32 s49, s5, 2
  s_or_b32 s49, s49, s54
  v_xor_b32 v3, s49, v1
  v_and_b32 v3, 3, v3
  v_lshl_add_u32 v2, v3, 4, v2
  s_and_b32 s55, s5, 1
  s_mul_i32 s49, s55, 704512
  s_add_u32 s49, s49, s48
  s_mul_i32 s50, s54, 2752
  s_add_u32 s49, s49, s50
  s_lshr_b32 s50, s5, 1
  s_lshl_b32 s50, s50, 15
  s_lshl_b32 s54, s54, 14
  s_add_u32 s50, s50, s54
  s_lshl_b32 s55, s55, 13
  s_add_u32 s50, s50, s55
  s_add_u32 s50, s50, 77824
  s_mov_b32 s70, 0
L_sn_71:
  ds_read_b32 v8, v38 offset:260
  s_waitcnt lgkmcnt(0)
  v_cmp_gt_u32 vcc, 0x1, v8
  s_cmp_eq_u64 vcc, 0
  s_cbranch_scc1 L_snd_72
  s_sleep 8
  s_add_u32 s70, s70, 1
  s_cmp_lt_u32 s70, 2097152
  s_cbranch_scc1 L_sn_71
L_snd_72:
  s_add_u32 s51, s50, 8192
L_dma_73:
  s_mov_b32 m0, s50
  s_add_u32 s50, s50, 1024
  buffer_load_dwordx4 v2, s[44:47], s49 offen  lds
  s_add_u32 s49, s49, 88064
  s_waitcnt vmcnt(3)
  s_cmp_lt_u32 s50, s51
  s_cbranch_scc1 L_dma_73
L_dmae_74:
  s_andn2_b32 s54, 1, s61
  v_lshrrev_b32 v2, 2, v1
  v_mul_u32_u24 v2, 5504, v2
  s_and_b32 s49, s5, 2
  s_or_b32 s49, s49, s54
  v_xor_b32 v3, s49, v1
  v_and_b32 v3, 3, v3
  v_lshl_add_u32 v2, v3, 4, v2
  s_and_b32 s55, s5, 1
  s_mul_i32 s49, s55, 704512
  s_add_u32 s49, s49, s48
  s_mul_i32 s50, s54, 2752
  s_add_u32 s49, s49, s50
  s_lshr_b32 s50, s5, 1
  s_lshl_b32 s50, s50, 15
  s_lshl_b32 s54, s54, 14
  s_add_u32 s50, s50, s54
  s_lshl_b32 s55, s55, 13
  s_add_u32 s50, s50, s55
  s_add_u32 s50, s50, 77824
  s_add_u32 s51, s50, 8192
L_dma_75:
  s_mov_b32 m0, s50
  s_add_u32 s50, s50, 1024
  buffer_load_dwordx4 v2, s[44:47], s49 offen nt lds
  s_add_u32 s49, s49, 88064
  s_waitcnt vmcnt(3)
  s_cmp_lt_u32 s50, s51
  s_cbranch_scc1 L_dma_75
L_dmae_76:
  v_lshlrev_b32 v15, 4, v0
  v_add_u32 v39, 16384, v15
  s_and_b32 s59, s2, 1
  s_lshl_b32 s59, s59, 16
  s_add_u32 s59, s59, 2101248
  v_add_u32 v15, s59, v15
  v_lshrrev_b32 v5, 2, v0
  v_lshlrev_b32 v5, 3, v5
  v_add_u32 v5, 9536, v5
  v_lshlrev_b32 v7, 3, v1
  v_add_u32 v7, 9536, v7
  v_and_b32 v14, 7, v1
  v_mul_u32_u24 v14, 1056, v14
  v_lshrrev_b32 v3, 4, v1
  v_lshl_add_u32 v14, v3, 4, v14
  v_bfe_u32 v6, v1, 2, 2
  v_lshl_add_u32 v6, v3, 3, v6
  v_mul_u32_u24 v6, 1056, v6
  v_and_b32 v8, 3, v1
  v_lshl_add_u32 v6, v8, 3, v6
  s_lshl_b32 s49, s5, 8
  s_add_u32 s49, s49, 77824
  v_add_u32 v6, s49, v6
  v_lshlrev_b32 v10, 3, v0
  v_add_u32 v10, 10048, v10
  v_mov_b32 v8, 0
  v_mov_b32 v9, 0
  ds_write_b64 v10, v[8:9]
  v_and_b32 v13, 1, v1
  v_lshlrev_b32 v13, 6, v13
  v_lshrrev_b32 v3, 4, v1
  v_lshl_add_u32 v13, v3, 4, v13
  s_lshl_b32 s49, s5, 17
  s_add_u32 s49, s49, s58
  v_add_u32 v13, s49, v13
  v_bfe_u32 v3, v1, 1, 3
  v_lshl_add_u32 v13, v3, 14, v13
  v_lshrrev_b32 v2, 3, v1
  v_lshlrev_b32 v2, 6, v2
  v_bfe_u32 v3, v1, 2, 1
  v_lshl_add_u32 v2, v3, 14, v2
  v_and_b32 v8, 2, v1
  v_or_b32 v3, v3, v8
  v_xor_b32 v3, s5, v3
  v_lshl_add_u32 v2, v3, 4, v2
  v_lshl_add_u32 v2, v8, 14, v2
  v_and_b32 v3, 1, v1
  v_lshl_add_u32 v2, v3, 3, v2
  v_add_u32 v2, 77824, v2
  s_waitcnt vmcnt(0)
  s_add_u32 s77, s77, 4
  v_mov_b32 v9, 1
  s_mov_b64 exec, 1
  ds_add_u32 v38, v9 offset:316
  s_mov_b64 exec, -1
  s_mov_b32 s70, 0
L_hy_77:
  ds_read_b32 v9, v38 offset:316
  s_waitcnt lgkmcnt(0)
  v_cmp_gt_u32 vcc, s77, v9
  s_cmp_eq_u64 vcc, 0
  s_cbranch_scc1 L_hyd_78
  s_sleep 4
  s_add_u32 s70, s70, 1
  s_cmp_lt_u32 s70, 2097152
  s_cbranch_scc1 L_hy_77
L_hyd_78:
  ds_read_b64_tr_b16 v[40:41], v2 offset:0
  ds_read_b64_tr_b16 v[42:43], v2 offset:512
  ds_read_b64_tr_b16 v[44:45], v2 offset:1024
  ds_read_b64_tr_b16 v[46:47], v2 offset:1536
  ds_read_b64_tr_b16 v[48:49], v2 offset:2048
  ds_read_b64_tr_b16 v[50:51], v2 offset:2560
  ds_read_b64_tr_b16 v[52:53], v2 offset:3072
  ds_read_b64_tr_b16 v[54:55], v2 offset:3584
  ds_read_b64_tr_b16 v[56:57], v2 offset:4096
  ds_read_b64_tr_b16 v[58:59], v2 offset:4608
  ds_read_b64_tr_b16 v[60:61], v2 offset:5120
  ds_read_b64_tr_b16 v[62:63], v2 offset:5632
  s_waitcnt lgkmcnt(10)
  ds_read_b64_tr_b16 v[64:65], v2 offset:6144
  ds_read_b64_tr_b16 v[66:67], v2 offset:6656
  s_waitcnt lgkmcnt(10)
  ds_read_b64_tr_b16 v[68:69], v2 offset:7168
  ds_read_b64_tr_b16 v[70:71], v2 offset:7680
  s_waitcnt lgkmcnt(10)
  ds_read_b64_tr_b16 v[72:73], v2 offset:8192
  ds_read_b64_tr_b16 v[74:75], v2 offset:8704
  s_waitcnt lgkmcnt(10)
  ds_read_b64_tr_b16 v[76:77], v2 offset:9216
  ds_read_b64_tr_b16 v[78:79], v2 offset:9728
  s_waitcnt lgkmcnt(10)
  ds_read_b64_tr_b16 v[80:81], v2 offset:10240
  ds_read_b64_tr_b16 v[82:83], v2 offset:10752
  s_waitcnt lgkmcnt(10)
  ds_read_b64_tr_b16 v[84:85], v2 offset:11264
  ds_read_b64_tr_b16 v[86:87], v2 offset:11776
  s_waitcnt lgkmcnt(10)
  ds_read_b64_tr_b16 v[88:89], v2 offset:12288
  ds_read_b64_tr_b16 v[90:91], v2 offset:12800
  s_waitcnt lgkmcnt(10)
  ds_read_b64_tr_b16 v[92:93], v2 offset:13312
  ds_read_b64_tr_b16 v[94:95], v2 offset:13824
  s_waitcnt lgkmcnt(10)
  ds_read_b64_tr_b16 v[96:97], v2 offset:14336
  ds_read_b64_tr_b16 v[98:99], v2 offset:14848
  s_waitcnt lgkmcnt(10)
  ds_read_b64_tr_b16 v[100:101], v2 offset:15360
  ds_read_b64_tr_b16 v[102:103], v2 offset:15872
  s_waitcnt lgkmcnt(10)
  s_waitcnt lgkmcnt(0)
  s_add_u32 s77, s77, 4
  v_mov_b32 v9, 1
  s_mov_b64 exec, 1
  ds_add_u32 v38, v9 offset:316
  s_mov_b64 exec, -1
  s_mov_b32 s70, 0
L_hy_79:
  ds_read_b32 v9, v38 offset:316
  s_waitcnt lgkmcnt(0)
  v_cmp_gt_u32 vcc, s77, v9
  s_cmp_eq_u64 vcc, 0
  s_cbranch_scc1 L_hyd_80
  s_add_u32 s70, s70, 1
  s_cmp_lt_u32 s70, 2097152
  s_cbranch_scc1 L_hy_79
L_hyd_80:
  s_mov_b32 s44, s32
  s_mov_b32 s45, s33
  s_mov_b32 s46, 1409024
  s_mov_b32 s47, 0x20000
  v_lshlrev_b32 v2, 4, v1
  s_lshl2_add_u32 s49, s61, s5
  s_lshl_b32 s49, s49, 13
  s_mul_i32 s50, s5, 8448
  s_add_u32 s50, s50, 77824
  s_add_u32 s51, s50, 8448
L_dma_81:
  s_mov_b32 m0, s50
  s_add_u32 s50, s50, 1056
  buffer_load_dwordx4 v2, s[44:47], s49 offen nt lds
  s_add_u32 s49, s49, 1024
  s_waitcnt vmcnt(3)
  s_cmp_lt_u32 s50, s51
  s_cbranch_scc1 L_dma_81
L_dmae_82:
  s_bfe_u32 s32, s74, 0x80000
  s_bfe_u32 s33, s74, 0x80008
  s_bfe_u32 s34, s74, 0x80010
  s_bfe_u32 s35, s74, 0x80018
  v_add_u32 v4, 16384, v15
  v_add_u32 v0, 32768, v15
  v_add_u32 v36, 49152, v15
  global_load_dwordx2 v[8:9], v37, s[16:17]
  s_mov_b32 s70, 0
L_pg_83:
  global_load_dwordx4 v[136:139], v39, s[42:43] offset:-4096 sc1
  global_load_dwordx4 v[140:143], v39, s[42:43] offset:0 sc1
  v_add_u32 v3, 4096, v39
  global_load_dwordx4 v[144:147], v3, s[42:43] sc1
  s_waitcnt vmcnt(0)
  s_mov_b64 vcc, 0
  v_cmp_ne_u32 s[68:69], s74, v137
  s_or_b64 vcc, vcc, s[68:69]
  v_cmp_ne_u32 s[68:69], s74, v139
  s_or_b64 vcc, vcc, s[68:69]
  v_cmp_ne_u32 s[68:69], s74, v141
  s_or_b64 vcc, vcc, s[68:69]
  v_cmp_ne_u32 s[68:69], s74, v143
  s_or_b64 vcc, vcc, s[68:69]
  v_cmp_ne_u32 s[68:69], s74, v145
  s_or_b64 vcc, vcc, s[68:69]
  v_cmp_ne_u32 s[68:69], s74, v147
  s_or_b64 vcc, vcc, s[68:69]
  s_cmp_eq_u64 vcc, 0
  s_cbranch_scc1 L_pge_84
  s_sleep 8
  s_add_u32 s70, s70, 1
  s_cmp_lt_u32 s70, 262144
  s_cbranch_scc1 L_pg_83
L_pge_84:
  v_and_b32 v39, 1, v1
  v_lshlrev_b32 v39, 6, v39
  v_add_u32 v39, 10944, v39
  v_lshrrev_b32 v3, 4, v1
  v_lshl_add_u32 v37, v3, 4, v39
  v_bfe_u32 v3, v1, 1, 3
  v_lshlrev_b32 v3, 7, v3
  v_sub_u32 v37, v37, v3
  v_bfe_u32 v3, v1, 4, 1
  v_lshl_add_u32 v39, v3, 3, v39
  v_lshrrev_b32 v3, 5, v1
  v_lshl_add_u32 v39, v3, 2, v39
  s_lshl_b32 s49, s5, 4
  v_add_u32 v39, s49, v39
  v_lshlrev_b32 v16, 16, v8
  v_and_b32 v17, s73, v8
  v_lshlrev_b32 v18, 16, v9
  v_and_b32 v19, s73, v9
  v_lshlrev_b32 v20, 16, v136
  v_and_b32 v21, s73, v136
  v_lshlrev_b32 v22, 16, v138
  v_and_b32 v23, s73, v138
  v_lshlrev_b32 v28, 16, v144
  v_and_b32 v29, s73, v144
  v_lshlrev_b32 v30, 16, v146
  v_and_b32 v31, s73, v146
  v_add_f32 v28, 1.0, v28
  v_add_f32 v29, 1.0, v29
  v_add_f32 v30, 1.0, v30
  v_add_f32 v31, 1.0, v31
  v_cvt_pk_bf16_f32 v8, v28, v29
  v_cvt_pk_bf16_f32 v9, v30, v31
  v_mov_b32 v141, v142
  ds_write_b64 v12, v[8:9] offset:5312
  ds_write_b64 v12, v[140:141] offset:7424
  v_cvt_pk_bf16_f32 v28, 0, v28
  v_cvt_pk_bf16_f32 v29, 0, v29
  v_cvt_pk_bf16_f32 v30, 0, v30
  v_cvt_pk_bf16_f32 v31, 0, v31
  v_mul_f32 v24, v20, v28
  v_mul_f32 v25, v21, v29
  v_mul_f32 v26, v22, v30
  v_mul_f32 v27, v23, v31
  v_mul_f32 v28, v16, v28
  v_mul_f32 v29, v17, v29
  v_mul_f32 v30, v18, v30
  v_mul_f32 v31, v19, v31
  s_waitcnt lgkmcnt(0)
  s_waitcnt vmcnt(0)
  s_mov_b32 s70, 0
L_sn_85:
  ds_read_b32 v8, v38 offset:264
  s_waitcnt lgkmcnt(0)
  v_cmp_gt_u32 vcc, 0x8, v8
  s_cmp_eq_u64 vcc, 0
  s_cbranch_scc1 L_snd_86
  s_sleep 2
  s_add_u32 s70, s70, 1
  s_cmp_lt_u32 s70, 2097152
  s_cbranch_scc1 L_sn_85
L_snd_86:
  s_mov_b32 s70, 0
  s_movk_i32 s71, 0xff
  s_mov_b32 s63, s71
  s_branch L_f1_l
L_f1_p:
  s_add_u32 s70, s70, 1
  s_cmp_ge_u32 s70, 262144
  s_cbranch_scc1 L_f1_ok
  s_mov_b32 s63, s71
L_f1_l:
  s_bitcmp1_b32 s63, 0
  s_cbranch_scc0 L_fl_87
  global_load_dwordx4 v[104:107], v15, s[42:43] offset:-4096 sc1
L_fl_87:
  s_bitcmp1_b32 s63, 1
  s_cbranch_scc0 L_fl_88
  global_load_dwordx4 v[108:111], v15, s[42:43] offset:0 sc1
L_fl_88:
  s_bitcmp1_b32 s63, 2
  s_cbranch_scc0 L_fl_89
  global_load_dwordx4 v[112:115], v4, s[42:43] offset:-4096 sc1
L_fl_89:
  s_bitcmp1_b32 s63, 3
  s_cbranch_scc0 L_fl_90
  global_load_dwordx4 v[116:119], v4, s[42:43] offset:0 sc1
L_fl_90:
  s_bitcmp1_b32 s63, 4
  s_cbranch_scc0 L_fl_91
  global_load_dwordx4 v[120:123], v0, s[42:43] offset:-4096 sc1
L_fl_91:
  s_bitcmp1_b32 s63, 5
  s_cbranch_scc0 L_fl_92
  global_load_dwordx4 v[124:127], v0, s[42:43] offset:0 sc1
L_fl_92:
  s_bitcmp1_b32 s63, 6
  s_cbranch_scc0 L_fl_93
  global_load_dwordx4 v[128:131], v36, s[42:43] offset:-4096 sc1
L_fl_93:
  s_bitcmp1_b32 s63, 7
  s_cbranch_scc0 L_fl_94
  global_load_dwordx4 v[132:135], v36, s[42:43] offset:0 sc1
L_fl_94:
  s_waitcnt vmcnt(0)
  s_bitcmp1_b32 s63, 0
  s_cbranch_scc0 L_fc_95
  v_xor_b32 v104, s32, v104
  v_xor_b32 v105, s33, v105
  v_xor_b32 v106, s34, v106
  v_xor_b32 v107, s35, v107
  v_or3_b32 v8, v104, v105, v106
  v_or_b32 v8, v8, v107
  v_cmp_ne_u32_sdwa vcc, v8, v38 src0_sel:BYTE_0 src1_sel:DWORD
  s_cmp_lg_u64 vcc, 0
  s_cbranch_scc1 L_fc_95
  s_bitset0_b32 s71, 0
L_fc_95:
  s_bitcmp1_b32 s63, 1
  s_cbranch_scc0 L_fc_96
  v_xor_b32 v108, s32, v108
  v_xor_b32 v109, s33, v109
  v_xor_b32 v110, s34, v110
  v_xor_b32 v111, s35, v111
  v_or3_b32 v8, v108, v109, v110
  v_or_b32 v8, v8, v111
  v_cmp_ne_u32_sdwa vcc, v8, v38 src0_sel:BYTE_0 src1_sel:DWORD
  s_cmp_lg_u64 vcc, 0
  s_cbranch_scc1 L_fc_96
  s_bitset0_b32 s71, 1
L_fc_96:
  s_bitcmp1_b32 s63, 2
  s_cbranch_scc0 L_fc_97
  v_xor_b32 v112, s32, v112
  v_xor_b32 v113, s33, v113
  v_xor_b32 v114, s34, v114
  v_xor_b32 v115, s35, v115
  v_or3_b32 v8, v112, v113, v114
  v_or_b32 v8, v8, v115
  v_cmp_ne_u32_sdwa vcc, v8, v38 src0_sel:BYTE_0 src1_sel:DWORD
  s_cmp_lg_u64 vcc, 0
  s_cbranch_scc1 L_fc_97
  s_bitset0_b32 s71, 2
L_fc_97:
  s_bitcmp1_b32 s63, 3
  s_cbranch_scc0 L_fc_98
  v_xor_b32 v116, s32, v116
  v_xor_b32 v117, s33, v117
  v_xor_b32 v118, s34, v118
  v_xor_b32 v119, s35, v119
  v_or3_b32 v8, v116, v117, v118
  v_or_b32 v8, v8, v119
  v_cmp_ne_u32_sdwa vcc, v8, v38 src0_sel:BYTE_0 src1_sel:DWORD
  s_cmp_lg_u64 vcc, 0
  s_cbranch_scc1 L_fc_98
  s_bitset0_b32 s71, 3
L_fc_98:
  s_bitcmp1_b32 s63, 4
  s_cbranch_scc0 L_fc_99
  v_xor_b32 v120, s32, v120
  v_xor_b32 v121, s33, v121
  v_xor_b32 v122, s34, v122
  v_xor_b32 v123, s35, v123
  v_or3_b32 v8, v120, v121, v122
  v_or_b32 v8, v8, v123
  v_cmp_ne_u32_sdwa vcc, v8, v38 src0_sel:BYTE_0 src1_sel:DWORD
  s_cmp_lg_u64 vcc, 0
  s_cbranch_scc1 L_fc_99
  s_bitset0_b32 s71, 4
L_fc_99:
  s_bitcmp1_b32 s63, 5
  s_cbranch_scc0 L_fc_100
  v_xor_b32 v124, s32, v124
  v_xor_b32 v125, s33, v125
  v_xor_b32 v126, s34, v126
  v_xor_b32 v127, s35, v127
  v_or3_b32 v8, v124, v125, v126
  v_or_b32 v8, v8, v127
  v_cmp_ne_u32_sdwa vcc, v8, v38 src0_sel:BYTE_0 src1_sel:DWORD
  s_cmp_lg_u64 vcc, 0
  s_cbranch_scc1 L_fc_100
  s_bitset0_b32 s71, 5
L_fc_100:
  s_bitcmp1_b32 s63, 6
  s_cbranch_scc0 L_fc_101
  v_xor_b32 v128, s32, v128
  v_xor_b32 v129, s33, v129
  v_xor_b32 v130, s34, v130
  v_xor_b32 v131, s35, v131
  v_or3_b32 v8, v128, v129, v130
  v_or_b32 v8, v8, v131
  v_cmp_ne_u32_sdwa vcc, v8, v38 src0_sel:BYTE_0 src1_sel:DWORD
  s_cmp_lg_u64 vcc, 0
  s_cbranch_scc1 L_fc_101
  s_bitset0_b32 s71, 6
L_fc_101:
  s_bitcmp1_b32 s63, 7
  s_cbranch_scc0 L_fc_102
  v_xor_b32 v132, s32, v132
  v_xor_b32 v133, s33, v133
  v_xor_b32 v134, s34, v134
  v_xor_b32 v135, s35, v135
  v_or3_b32 v8, v132, v133, v134
  v_or_b32 v8, v8, v135
  v_cmp_ne_u32_sdwa vcc, v8, v38 src0_sel:BYTE_0 src1_sel:DWORD
  s_cmp_lg_u64 vcc, 0
  s_cbranch_scc1 L_fc_102
  s_bitset0_b32 s71, 7
L_fc_102:
  s_cmp_lg_u32 s71, 0
  s_cbranch_scc1 L_f1_p
L_f1_ok:
  v_pk_add_f32 v[136:137], v[104:105], v[108:109]
  v_pk_add_f32 v[138:139], v[106:107], v[110:111]
  v_pk_add_f32 v[144:145], v[112:113], v[116:117]
  v_pk_add_f32 v[146:147], v[114:115], v[118:119]
  v_pk_add_f32 v[152:153], v[120:121], v[124:125]
  v_pk_add_f32 v[154:155], v[122:123], v[126:127]
  v_pk_add_f32 v[160:161], v[128:129], v[132:133]
  v_pk_add_f32 v[162:163], v[130:131], v[134:135]
  v_pk_add_f32 v[136:137], v[136:137], v[144:145]
  v_pk_add_f32 v[138:139], v[138:139], v[146:147]
  v_pk_add_f32 v[152:153], v[152:153], v[160:161]
  v_pk_add_f32 v[154:155], v[154:155], v[162:163]
  v_pk_add_f32 v[136:137], v[136:137], v[152:153]
  v_pk_add_f32 v[138:139], v[138:139], v[154:155]
  v_pk_fma_f32 v[8:9], v[136:137], v[24:25], v[28:29]
  v_pk_fma_f32 v[10:11], v[138:139], v[26:27], v[30:31]
  v_cvt_pk_bf16_f32 v8, v8, v9
  v_cvt_pk_bf16_f32 v9, v10, v11
  ds_write_b64 v12, v[8:9] offset:3200
  v_pk_fma_f32 v[16:17], v[136:137], v[20:21], v[16:17]
  v_pk_fma_f32 v[18:19], v[138:139], v[22:23], v[18:19]
  v_add_f32 v24, v16, v17
  v_mul_f32 v25, v16, v16
  v_add_f32 v26, v18, v19
  v_mul_f32 v27, v18, v18
  v_fmac_f32 v25, v17, v17
  v_fmac_f32 v27, v19, v19
  v_pk_add_f32 v[24:25], v[24:25], v[26:27]
  s_nop 1
  v_add_f32_dpp v24, v24, v24 quad_perm:[1,0,3,2] row_mask:0xf bank_mask:0xf
  v_add_f32_dpp v25, v25, v25 quad_perm:[1,0,3,2] row_mask:0xf bank_mask:0xf
  s_nop 0
  v_add_f32_dpp v24, v24, v24 quad_perm:[2,3,0,1] row_mask:0xf bank_mask:0xf
  v_add_f32_dpp v25, v25, v25 quad_perm:[2,3,0,1] row_mask:0xf bank_mask:0xf
  ds_write_b64 v5, v[24:25]
  s_add_u32 s77, s77, 4
  v_mov_b32 v10, 1
  s_mov_b64 exec, 1
  ds_add_u32 v38, v10 offset:316
  s_mov_b64 exec, -1
  s_mov_b32 s70, 0
L_hy_103:
  ds_read_b32 v10, v38 offset:316
  ds_read_b128 v[136:139], v14 offset:3200
  ds_read_b128 v[140:143], v14 offset:3264
  ds_read_b128 v[144:147], v14 offset:3328
  ds_read_b128 v[148:151], v14 offset:3392
  s_waitcnt lgkmcnt(4)
  v_cmp_gt_u32 vcc, s77, v10
  s_cmp_eq_u64 vcc, 0
  s_cbranch_scc1 L_hyd_104
  s_waitcnt lgkmcnt(0)
  s_add_u32 s70, s70, 1
  s_cmp_lt_u32 s70, 2097152
  s_cbranch_scc1 L_hy_103
L_hyd_104:
  ds_read_b64 v[20:21], v7
  ds_read_b128 v[152:155], v14 offset:3456
  ds_read_b128 v[156:159], v14 offset:3520
  ds_read_b128 v[160:163], v14 offset:3584
  ds_read_b128 v[164:167], v14 offset:3648
  s_waitcnt lgkmcnt(8)
  v_mfma_f32_16x16x32_bf16 v[32:35], v[40:43], v[136:139], 0
  s_waitcnt lgkmcnt(7)
  v_mfma_f32_16x16x32_bf16 v[32:35], v[44:47], v[140:143], v[32:35]
  ds_read_b128 v[136:139], v14 offset:3712
  s_waitcnt lgkmcnt(7)
  v_mfma_f32_16x16x32_bf16 v[32:35], v[48:51], v[144:147], v[32:35]
  ds_read_b128 v[140:143], v14 offset:3776
  s_waitcnt lgkmcnt(7)
  v_mfma_f32_16x16x32_bf16 v[32:35], v[52:55], v[148:151], v[32:35]
  ds_read_b128 v[144:147], v14 offset:3840
  s_waitcnt lgkmcnt(6)
  v_mfma_f32_16x16x32_bf16 v[32:35], v[56:59], v[152:155], v[32:35]
  ds_read_b128 v[148:151], v14 offset:3904
  v_add_f32_dpp v20, v20, v20 quad_perm:[2,3,0,1] row_mask:0xf bank_mask:0xf
  v_add_f32_dpp v21, v21, v21 quad_perm:[2,3,0,1] row_mask:0xf bank_mask:0xf
  s_waitcnt lgkmcnt(6)
  v_mfma_f32_16x16x32_bf16 v[32:35], v[60:63], v[156:159], v[32:35]
  ds_read_b128 v[152:155], v14 offset:3968
  v_add_f32_dpp v20, v20, v20 row_ror:4 row_mask:0xf bank_mask:0xf
  v_add_f32_dpp v21, v21, v21 row_ror:4 row_mask:0xf bank_mask:0xf
  s_waitcnt lgkmcnt(6)
  v_mfma_f32_16x16x32_bf16 v[32:35], v[64:67], v[160:163], v[32:35]
  ds_read_b128 v[156:159], v14 offset:4032
  v_add_f32_dpp v20, v20, v20 row_ror:8 row_mask:0xf bank_mask:0xf
  v_add_f32_dpp v21, v21, v21 row_ror:8 row_mask:0xf bank_mask:0xf
  s_waitcnt lgkmcnt(6)
  v_mfma_f32_16x16x32_bf16 v[32:35], v[68:71], v[164:167], v[32:35]
  ds_read_b128 v[160:163], v14 offset:4096
  v_mov_b32 v22, v20
  v_mov_b32 v23, v21
  s_waitcnt lgkmcnt(6)
  v_mfma_f32_16x16x32_bf16 v[32:35], v[72:75], v[136:139], v[32:35]
  ds_read_b128 v[164:167], v14 offset:4160
  v_permlane16_swap_b32 v22, v20
  v_permlane16_swap_b32 v23, v21
  s_waitcnt lgkmcnt(6)
  v_mfma_f32_16x16x32_bf16 v[32:35], v[76:79], v[140:143], v[32:35]
  v_pk_add_f32 v[20:21], v[20:21], v[22:23]
  v_mov_b32 v22, v20
  v_mov_b32 v23, v21
  s_waitcnt lgkmcnt(5)
  v_mfma_f32_16x16x32_bf16 v[32:35], v[80:83], v[144:147], v[32:35]
  v_permlane32_swap_b32 v22, v20
  v_permlane32_swap_b32 v23, v21
  s_waitcnt lgkmcnt(4)
  v_mfma_f32_16x16x32_bf16 v[32:35], v[84:87], v[148:151], v[32:35]
  v_pk_add_f32 v[20:21], v[20:21], v[22:23]
  v_mul_f32 v20, 0xbb000000, v20
  s_waitcnt lgkmcnt(3)
  v_mfma_f32_16x16x32_bf16 v[32:35], v[88:91], v[152:155], v[32:35]
  v_mul_f32 v21, 0x3b000000, v21
  v_fma_f32 v21, -v20, v20, v21
  s_waitcnt lgkmcnt(2)
  v_mfma_f32_16x16x32_bf16 v[32:35], v[92:95], v[156:159], v[32:35]
  v_max_f32 v21, 0, v21
  v_add_f32 v21, 0x3727c5ac, v21
  s_waitcnt lgkmcnt(1)
  v_mfma_f32_16x16x32_bf16 v[32:35], v[96:99], v[160:163], v[32:35]
  v_rsq_f32 v21, v21
  s_waitcnt lgkmcnt(0)
  v_mfma_f32_16x16x32_bf16 v[32:35], v[100:103], v[164:167], v[32:35]
  ds_read_b64_tr_b16 v[40:41], v6 offset:0
  ds_read_b64_tr_b16 v[42:43], v6 offset:4224
  ds_read_b64_tr_b16 v[44:45], v6 offset:32
  ds_read_b64_tr_b16 v[46:47], v6 offset:4256
  ds_read_b64_tr_b16 v[48:49], v6 offset:64
  ds_read_b64_tr_b16 v[50:51], v6 offset:4288
  ds_read_b64_tr_b16 v[52:53], v6 offset:96
  ds_read_b64_tr_b16 v[54:55], v6 offset:4320
  v_fmac_f32_dpp v32, v32, v20 row_shl:2 row_mask:0xf bank_mask:0x1
  v_fmac_f32_dpp v33, v33, v20 row_shl:2 row_mask:0xf bank_mask:0x1
  v_fmac_f32_dpp v34, v34, v20 row_shl:2 row_mask:0xf bank_mask:0x1
  v_fmac_f32_dpp v35, v35, v20 row_shl:2 row_mask:0xf bank_mask:0x1
  v_mul_f32 v8, v32, v21
  v_mul_f32 v9, v33, v21
  v_mul_f32 v10, v34, v21
  v_mul_f32 v11, v35, v21
  v_add_f32_dpp v8, v32, v8 row_shl:4 row_mask:0xf bank_mask:0xf
  v_add_f32_dpp v9, v33, v9 row_shl:4 row_mask:0xf bank_mask:0xf
  v_add_f32_dpp v10, v34, v10 row_shl:4 row_mask:0xf bank_mask:0xf
  v_add_f32_dpp v11, v35, v11 row_shl:4 row_mask:0xf bank_mask:0xf
  s_waitcnt lgkmcnt(4)
  ds_read_b64_tr_b16 v[56:57], v6 offset:128
  ds_read_b64_tr_b16 v[58:59], v6 offset:4352
  ds_read_b64_tr_b16 v[60:61], v6 offset:160
  ds_read_b64_tr_b16 v[62:63], v6 offset:4384
  ds_read_b64_tr_b16 v[64:65], v6 offset:192
  ds_read_b64_tr_b16 v[66:67], v6 offset:4416
  ds_read_b64_tr_b16 v[68:69], v6 offset:224
  ds_read_b64_tr_b16 v[70:71], v6 offset:4448
  v_permlane32_swap_b32 v8, v10
  v_permlane32_swap_b32 v9, v11
  v_mul_f32 v20, 0xbfb8aa3b, v8
  v_mul_f32 v21, 0xbfb8aa3b, v9
  v_exp_f32 v20, v20
  v_exp_f32 v21, v21
  v_mul_f32 v8, v8, v10
  v_mul_f32 v9, v9, v11
  v_add_f32 v20, 1.0, v20
  v_add_f32 v21, 1.0, v21
  v_rcp_f32 v20, v20
  v_rcp_f32 v21, v21
  s_mov_b32 exec_lo, 0x00030003
  s_mov_b32 exec_hi, 0x00030003
  v_mul_f32 v8, v8, v20
  v_mul_f32 v9, v9, v21
  v_cvt_pk_bf16_f32 v8, v8, v9
  ds_write_b32 v39, v8
  s_mov_b64 exec, -1
  s_waitcnt lgkmcnt(4)
  s_add_u32 s77, s77, 4
  v_mov_b32 v10, 1
  s_mov_b64 exec, 1
  ds_add_u32 v38, v10 offset:316
  s_mov_b64 exec, -1
  s_mov_b32 s70, 0
L_hy_105:
  ds_read_b32 v10, v38 offset:316
  ds_read_b128 v[136:139], v37 offset:0
  ds_read_b128 v[140:143], v37 offset:128
  ds_read_b128 v[144:147], v37 offset:256
  ds_read_b128 v[148:151], v37 offset:384
  s_waitcnt lgkmcnt(4)
  v_cmp_gt_u32 vcc, s77, v10
  s_cmp_eq_u64 vcc, 0
  s_cbranch_scc1 L_hyd_106
  s_waitcnt lgkmcnt(0)
  s_add_u32 s70, s70, 1
  s_cmp_lt_u32 s70, 2097152
  s_cbranch_scc1 L_hy_105
L_hyd_106:
  ds_read_b128 v[152:155], v37 offset:512
  ds_read_b128 v[156:159], v37 offset:640
  ds_read_b128 v[160:163], v37 offset:768
  ds_read_b128 v[164:167], v37 offset:896
  v_mov_b32 v3, 0xff
  s_waitcnt lgkmcnt(7)
  v_mfma_f32_16x16x32_bf16 v[8:11], v[40:43], v[136:139], 0
  s_waitcnt lgkmcnt(6)
  v_mfma_f32_16x16x32_bf16 v[8:11], v[44:47], v[140:143], v[8:11]
  s_waitcnt lgkmcnt(5)
  v_mfma_f32_16x16x32_bf16 v[8:11], v[48:51], v[144:147], v[8:11]
  s_waitcnt lgkmcnt(4)
  v_mfma_f32_16x16x32_bf16 v[8:11], v[52:55], v[148:151], v[8:11]
  s_waitcnt lgkmcnt(3)
  v_mfma_f32_16x16x32_bf16 v[8:11], v[56:59], v[152:155], v[8:11]
  s_waitcnt lgkmcnt(2)
  v_mfma_f32_16x16x32_bf16 v[8:11], v[60:63], v[156:159], v[8:11]
  s_waitcnt lgkmcnt(1)
  v_mfma_f32_16x16x32_bf16 v[8:11], v[64:67], v[160:163], v[8:11]
  s_waitcnt lgkmcnt(0)
  v_mfma_f32_16x16x32_bf16 v[8:11], v[68:71], v[164:167], v[8:11]
  s_nop 7
  v_bfi_b32 v8, v3, s32, v8
  v_bfi_b32 v9, v3, s33, v9
  v_bfi_b32 v10, v3, s34, v10
  v_bfi_b32 v11, v3, s35, v11
  global_store_dwordx4 v13, v[8:11], s[42:43] sc1
  s_branch L_fin
L_r_f2:
  v_bfe_u32 v12, v1, 2, 1
  v_and_b32 v14, 3, v1
  s_lshl_b32 s49, s61, 5
  v_lshl_add_u32 v3, v14, 3, s49
  v_lshl_add_u32 v37, v12, 10, v3
  v_and_b32 v15, 7, v1
  s_lshl_b32 s49, s61, 7
  v_lshl_add_u32 v15, v15, 4, s49
  v_add_u32 v39, 16384, v15
  v_bfe_u32 v3, v1, 3, 1
  v_lshl_add_u32 v15, v3, 12, v15
  v_lshrrev_b32 v3, 4, v1
  v_lshl_add_u32 v15, v3, 14, v15
  s_and_b32 s59, s2, 1
  s_lshl_b32 s59, s59, 16
  s_add_u32 s59, s59, 2097152
  v_add_u32 v15, s59, v15
  s_lshl_b32 s49, s61, 14
  s_add_u32 s49, s49, 1574912
  v_lshl_add_u32 v36, v1, 4, s49
  global_load_dword v11, v37, s[38:39]
  s_lshl_b32 s49, s61, 14
  s_add_u32 s49, s49, 1572864
  v_min_u32 v10, 42, v1
  v_lshl_add_u32 v10, v10, 7, s49
  global_load_dword v11, v10, s[42:43] sc1
  s_lshl_b32 s49, s61, 7
  s_add_u32 s49, s49, 28672
  v_mov_b32 v10, s49
  global_load_dword v11, v10, s[42:43] sc1
  global_load_dwordx2 v[8:9], v37, s[16:17]
  s_mov_b32 s70, 0
L_pg_107:
  global_load_dwordx4 v[136:139], v39, s[42:43] offset:-4096 sc1
  v_add_u32 v3, 8192, v39
  global_load_dwordx4 v[140:143], v3, s[42:43] sc1
  s_waitcnt vmcnt(0)
  s_mov_b64 vcc, 0
  v_cmp_ne_u32 s[68:69], s74, v137
  s_or_b64 vcc, vcc, s[68:69]
  v_cmp_ne_u32 s[68:69], s74, v139
  s_or_b64 vcc, vcc, s[68:69]
  v_cmp_ne_u32 s[68:69], s74, v141
  s_or_b64 vcc, vcc, s[68:69]
  v_cmp_ne_u32 s[68:69], s74, v143
  s_or_b64 vcc, vcc, s[68:69]
  s_cmp_eq_u64 vcc, 0
  s_cbranch_scc1 L_pge_108
  s_sleep 8
  s_add_u32 s70, s70, 1
  s_cmp_lt_u32 s70, 262144
  s_cbranch_scc1 L_pg_107
L_pge_108:
  v_lshlrev_b32 v16, 16, v8
  v_and_b32 v17, s73, v8
  v_lshlrev_b32 v18, 16, v9
  v_and_b32 v19, s73, v9
  v_lshlrev_b32 v20, 16, v136
  v_and_b32 v21, s73, v136
  v_lshlrev_b32 v22, 16, v138
  v_and_b32 v23, s73, v138
  v_lshlrev_b32 v24, 16, v140
  v_and_b32 v25, s73, v140
  v_lshlrev_b32 v26, 16, v142
  v_and_b32 v27, s73, v142
  s_mov_b32 s70, 0
L_sn_109:
  ds_read_b32 v8, v38 offset:264
  s_waitcnt lgkmcnt(0)
  v_cmp_gt_u32 vcc, 0x8, v8
  s_cmp_eq_u64 vcc, 0
  s_cbranch_scc1 L_snd_110
  s_sleep 2
  s_add_u32 s70, s70, 1
  s_cmp_lt_u32 s70, 2097152
  s_cbranch_scc1 L_sn_109
L_snd_110:
  s_mov_b32 s70, 0
L_f2_a:
  global_load_dwordx4 v[136:139], v15, s[42:43] sc1
  s_waitcnt vmcnt(0)
  v_xor_b32 v136, s32, v136
  v_xor_b32 v137, s33, v137
  v_xor_b32 v138, s34, v138
  v_xor_b32 v139, s35, v139
  v_or3_b32 v3, v136, v137, v138
  v_or_b32 v3, v3, v139
  v_lshlrev_b32 v3, 24, v3
  v_cmp_ne_u32 vcc, 0, v3
  s_cmp_eq_u64 vcc, 0
  s_cbranch_scc1 L_f2_ad
  s_sleep 4
  s_add_u32 s70, s70, 1
  s_cmp_lt_u32 s70, 262144
  s_cbranch_scc1 L_f2_a
L_f2_ad:
  s_cmp_lg_u32 s61, 0
  s_cbranch_scc1 L_f2_e
  v_mov_b32 v10, s74
  s_mov_b64 exec, 1
  global_store_dword v38, v10, s[42:43] offset:0 sc1
  s_mov_b64 exec, -1
L_f2_e:
  s_nop 1
  v_add_f32_dpp v136, v136, v136 row_ror:8 row_mask:0xf bank_mask:0xf
  v_add_f32_dpp v137, v137, v137 row_ror:8 row_mask:0xf bank_mask:0xf
  v_add_f32_dpp v138, v138, v138 row_ror:8 row_mask:0xf bank_mask:0xf
  v_add_f32_dpp v139, v139, v139 row_ror:8 row_mask:0xf bank_mask:0xf
  v_mov_b32 v140, v136
  v_mov_b32 v141, v137
  v_mov_b32 v142, v138
  v_mov_b32 v143, v139
  v_permlane16_swap_b32 v140, v136
  v_permlane16_swap_b32 v141, v137
  v_permlane16_swap_b32 v142, v138
  v_permlane16_swap_b32 v143, v139
  v_add_f32 v136, v136, v140
  v_add_f32 v137, v137, v141
  v_add_f32 v138, v138, v142
  v_add_f32 v139, v139, v143
  v_mov_b32 v140, v136
  v_mov_b32 v141, v137
  v_mov_b32 v142, v138
  v_mov_b32 v143, v139
  v_permlane32_swap_b32 v140, v136
  v_permlane32_swap_b32 v141, v137
  v_permlane32_swap_b32 v142, v138
  v_permlane32_swap_b32 v143, v139
  v_add_f32 v136, v136, v140
  v_add_f32 v137, v137, v141
  v_add_f32 v138, v138, v142
  v_add_f32 v139, v139, v143
  v_cvt_pk_bf16_f32 v136, 0, v136
  v_cvt_pk_bf16_f32 v137, 0, v137
  v_cvt_pk_bf16_f32 v138, 0, v138
  v_cvt_pk_bf16_f32 v139, 0, v139
  v_mul_f32 v136, v136, v20
  v_mul_f32 v137, v137, v21
  v_mul_f32 v138, v138, v22
  v_mul_f32 v139, v139, v23
  v_cvt_pk_bf16_f32 v136, 0, v136
  v_cvt_pk_bf16_f32 v137, 0, v137
  v_cvt_pk_bf16_f32 v138, 0, v138
  v_cvt_pk_bf16_f32 v139, 0, v139
  v_add_f32 v16, v16, v136
  v_add_f32 v17, v17, v137
  v_add_f32 v18, v18, v138
  v_add_f32 v19, v19, v139
  v_cvt_pk_bf16_f32 v16, 0, v16
  v_cvt_pk_bf16_f32 v17, 0, v17
  v_cvt_pk_bf16_f32 v18, 0, v18
  v_cvt_pk_bf16_f32 v19, 0, v19
  v_mov_b32 v156, s32
  v_mov_b32 v157, s33
  v_mov_b32 v158, s34
  v_mov_b32 v159, s35
  s_mov_b64 s[20:21], -1
  s_mov_b64 s[22:23], -1
  s_mov_b64 s[24:25], -1
  s_mov_b64 s[26:27], -1
  s_mov_b64 s[28:29], -1
  s_mov_b64 s[30:31], 0xffffff
  s_mov_b64 exec, s[20:21]
  global_load_dwordx4 v[136:139], v36, s[42:43] offset:-2048 sc1
  s_mov_b64 exec, s[22:23]
  global_load_dwordx4 v[140:143], v36, s[42:43] offset:-1024 sc1
  s_mov_b64 exec, s[24:25]
  global_load_dwordx4 v[144:147], v36, s[42:43] offset:0 sc1
  s_mov_b64 exec, s[26:27]
  global_load_dwordx4 v[148:151], v36, s[42:43] offset:1024 sc1
  s_mov_b64 exec, s[28:29]
  global_load_dwordx4 v[152:155], v36, s[42:43] offset:2048 sc1
  s_mov_b64 exec, s[30:31]
  global_load_dwordx4 v[156:159], v36, s[42:43] offset:3072 sc1
  s_mov_b64 exec, -1
  s_waitcnt vmcnt(0)
  s_mov_b32 s70, 0
  s_branch L_f2_pc
L_f2_p:
  s_mov_b64 exec, s[20:21]
  global_load_dwordx4 v[136:139], v36, s[42:43] offset:-2048 sc1
  s_mov_b64 exec, s[22:23]
  global_load_dwordx4 v[140:143], v36, s[42:43] offset:-1024 sc1
  s_mov_b64 exec, s[24:25]
  global_load_dwordx4 v[144:147], v36, s[42:43] offset:0 sc1
  s_mov_b64 exec, s[26:27]
  global_load_dwordx4 v[148:151], v36, s[42:43] offset:1024 sc1
  s_mov_b64 exec, s[28:29]
  global_load_dwordx4 v[152:155], v36, s[42:43] offset:2048 sc1
  s_mov_b64 exec, s[30:31]
  global_load_dwordx4 v[156:159], v36, s[42:43] offset:3072 sc1
  s_mov_b64 exec, -1
  s_waitcnt vmcnt(0)
L_f2_pc:
  v_xor_b32 v104, s32, v136
  v_xor_b32 v105, s33, v137
  v_xor_b32 v106, s34, v138
  v_xor_b32 v107, s35, v139
  v_xor_b32 v108, s32, v140
  v_xor_b32 v109, s33, v141
  v_xor_b32 v110, s34, v142
  v_xor_b32 v111, s35, v143
  v_xor_b32 v112, s32, v144
  v_xor_b32 v113, s33, v145
  v_xor_b32 v114, s34, v146
  v_xor_b32 v115, s35, v147
  v_xor_b32 v116, s32, v148
  v_xor_b32 v117, s33, v149
  v_xor_b32 v118, s34, v150
  v_xor_b32 v119, s35, v151
  v_xor_b32 v120, s32, v152
  v_xor_b32 v121, s33, v153
  v_xor_b32 v122, s34, v154
  v_xor_b32 v123, s35, v155
  v_xor_b32 v124, s32, v156
  v_xor_b32 v125, s33, v157
  v_xor_b32 v126, s34, v158
  v_xor_b32 v127, s35, v159
  v_or3_b32 v28, v104, v105, v106
  v_or3_b32 v29, v108, v109, v110
  v_or3_b32 v30, v112, v113, v114
  v_or3_b32 v31, v116, v117, v118
  v_or3_b32 v32, v120, v121, v122
  v_or3_b32 v33, v124, v125, v126
  v_or_b32 v28, v28, v107
  v_or_b32 v29, v29, v111
  v_or_b32 v30, v30, v115
  v_or_b32 v31, v31, v119
  v_or_b32 v32, v32, v123
  v_or_b32 v33, v33, v127
  v_cmp_ne_u32_sdwa s[20:21], v28, v38 src0_sel:BYTE_0 src1_sel:DWORD
  v_cmp_ne_u32_sdwa s[22:23], v29, v38 src0_sel:BYTE_0 src1_sel:DWORD
  v_cmp_ne_u32_sdwa s[24:25], v30, v38 src0_sel:BYTE_0 src1_sel:DWORD
  v_cmp_ne_u32_sdwa s[26:27], v31, v38 src0_sel:BYTE_0 src1_sel:DWORD
  v_cmp_ne_u32_sdwa s[28:29], v32, v38 src0_sel:BYTE_0 src1_sel:DWORD
  v_cmp_ne_u32_sdwa s[30:31], v33, v38 src0_sel:BYTE_0 src1_sel:DWORD
  v_pk_add_f32 v[104:105], v[104:105], v[108:109]
  v_pk_add_f32 v[106:107], v[106:107], v[110:111]
  v_pk_add_f32 v[112:113], v[112:113], v[116:117]
  v_pk_add_f32 v[114:115], v[114:115], v[118:119]
  v_pk_add_f32 v[120:121], v[120:121], v[124:125]
  v_pk_add_f32 v[122:123], v[122:123], v[126:127]
  v_pk_add_f32 v[104:105], v[104:105], v[112:113]
  v_pk_add_f32 v[106:107], v[106:107], v[114:115]
  v_pk_add_f32 v[104:105], v[104:105], v[120:121]
  v_pk_add_f32 v[106:107], v[106:107], v[122:123]
  s_mov_b64 vcc, s[20:21]
  s_or_b64 vcc, vcc, s[22:23]
  s_or_b64 vcc, vcc, s[24:25]
  s_or_b64 vcc, vcc, s[26:27]
  s_or_b64 vcc, vcc, s[28:29]
  s_or_b64 vcc, vcc, s[30:31]
  s_or_b32 s20, s20, 1
  s_or_b32 s22, s22, 1
  s_or_b32 s24, s24, 1
  s_or_b32 s26, s26, 1
  s_or_b32 s28, s28, 1
  s_or_b32 s30, s30, 1
  s_cmp_eq_u64 vcc, 0
  s_cbranch_scc1 L_f2_pok
  s_add_u32 s70, s70, 1
  s_cmp_lt_u32 s70, 262144
  s_cbranch_scc1 L_f2_p
L_f2_pok:
  s_nop 1
  v_add_f32_dpp v104, v104, v104 row_ror:8 row_mask:0xf bank_mask:0xf
  v_add_f32_dpp v105, v105, v105 row_ror:8 row_mask:0xf bank_mask:0xf
  v_add_f32_dpp v106, v106, v106 row_ror:8 row_mask:0xf bank_mask:0xf
  v_add_f32_dpp v107, v107, v107 row_ror:8 row_mask:0xf bank_mask:0xf
  v_mov_b32 v108, v104
  v_mov_b32 v109, v105
  v_mov_b32 v110, v106
  v_mov_b32 v111, v107
  v_permlane16_swap_b32 v108, v104
  v_permlane16_swap_b32 v109, v105
  v_permlane16_swap_b32 v110, v106
  v_permlane16_swap_b32 v111, v107
  v_add_f32 v104, v104, v108
  v_add_f32 v105, v105, v109
  v_add_f32 v106, v106, v110
  v_add_f32 v107, v107, v111
  v_mov_b32 v108, v104
  v_mov_b32 v109, v105
  v_mov_b32 v110, v106
  v_mov_b32 v111, v107
  v_permlane32_swap_b32 v108, v104
  v_permlane32_swap_b32 v109, v105
  v_permlane32_swap_b32 v110, v106
  v_permlane32_swap_b32 v111, v107
  v_add_f32 v104, v104, v108
  v_add_f32 v105, v105, v109
  v_add_f32 v106, v106, v110
  v_add_f32 v107, v107, v111
  v_cvt_pk_bf16_f32 v104, 0, v104
  v_cvt_pk_bf16_f32 v105, 0, v105
  v_cvt_pk_bf16_f32 v106, 0, v106
  v_cvt_pk_bf16_f32 v107, 0, v107
  v_mul_f32 v104, v104, v24
  v_mul_f32 v105, v105, v25
  v_mul_f32 v106, v106, v26
  v_mul_f32 v107, v107, v27
  v_cvt_pk_bf16_f32 v104, 0, v104
  v_cvt_pk_bf16_f32 v105, 0, v105
  v_cvt_pk_bf16_f32 v106, 0, v106
  v_cvt_pk_bf16_f32 v107, 0, v107
  v_add_f32 v8, v104, v16
  v_add_f32 v9, v105, v17
  v_add_f32 v10, v106, v18
  v_add_f32 v11, v107, v19
  v_cvt_pk_bf16_f32 v8, v8, v9
  v_cvt_pk_bf16_f32 v9, v10, v11
  s_mov_b64 exec, 0xff
  global_store_dwordx2 v37, v[8:9], s[38:39] sc1
  s_mov_b64 exec, 1
  v_mov_b32 v10, s74
  s_lshl_b32 s49, s61, 7
  s_add_u32 s49, s49, 28672
  v_mov_b32 v11, s49
  global_store_dword v11, v10, s[42:43] sc1
L_fin:
L_end:
  s_endpgm
.p2align 7
L_table:
  .long 0xff00ff13, 0x1504ff14, 0xff08ff1b, 0x1d0cff1c, 0xff10ff23, 0xff14ff24, 0xff18ff2b, 0x2d1cff2c
  .long 0xff01ff10, 0x1705ff16, 0xff09ff18, 0x1f0dff1e, 0xff11ff20, 0xff15ff25, 0xff19ff28, 0x2f1dff2e
  .long 0x1202ff11, 0xff0605ff, 0x1a0aff19, 0xff0e10ff, 0x2212ff21, 0x2716ff26, 0x2a1aff29, 0xff1e25ff
  .long 0xffff00ff, 0xffff06ff, 0xffff0bff, 0xffff11ff, 0xffff16ff, 0xffff1bff, 0xffff20ff, 0xffff26ff
  .long 0xffff01ff, 0xffff07ff, 0xffff0cff, 0xffff12ff, 0xffff17ff, 0xffff1cff, 0xffff21ff, 0xffff27ff
  .long 0xffff02ff, 0xffff08ff, 0xffff0dff, 0xffff13ff, 0xffff18ff, 0xffff1dff, 0xffff22ff, 0xffff28ff
  .long 0xffff03ff, 0xffff09ff, 0xffff0eff, 0xffff14ff, 0xffff19ff, 0xffff1eff, 0xffff23ff, 0xffff29ff
  .long 0xff0304ff, 0xff070aff, 0xff0b0fff, 0xff0f15ff, 0xff131aff, 0xff171fff, 0xff1b24ff, 0xff1f2aff
L_touch:
  .long 0x80804101, 0x80804909, 0x80804303, 0x80808080, 0x80804b0b, 0x80804505, 0x80804d0d, 0x80808080
  .long 0x80804707, 0x80804f0f, 0x80805900, 0x80808080, 0x80805b08, 0x80805d02, 0x80805f0a, 0x80808080
  .long 0x80805804, 0x80805a0c, 0x80805c06, 0x80808080, 0x80805e0e, 0x80805140, 0x80806148, 0x80808080
  .long 0x80806942, 0x8080714a, 0x80807944, 0x80808080, 0x8080534c, 0x80806346, 0x80806b4e, 0x80808080
.section .rodata,"a"
.p2align 6
.amdhsa_kernel adaLN_cond__sliding_block_cached__glu_gated_swiglu__decode_kernel
  .amdhsa_next_free_vgpr 168
  .amdhsa_next_free_sgpr 102
  .amdhsa_accum_offset 168
  .amdhsa_group_segment_fixed_size 0
  .amdhsa_kernarg_size 112
  .amdhsa_user_sgpr_count 2
  .amdhsa_user_sgpr_kernarg_segment_ptr 1
  .amdhsa_system_sgpr_workgroup_id_x 1
.end_amdhsa_kernel
```
